```python
import torch

def _softmax(x, axis=-1):
    return torch.softmax(x, dim=axis)

def _gelu(x):
    return torch.nn.functional.gelu(x, approximate='tanh')

def _silu(x):
    return torch.nn.functional.silu(x)

def _sigmoid(x):
    return torch.sigmoid(x)

def _layernorm(x, axis=-1, eps=1e-05):
    m = x.mean(dim=axis, keepdim=True)
    v = x.var(dim=axis, keepdim=True, unbiased=False)
    return (x - m) / torch.sqrt(v + eps)

def _scatter_add(tgt, idx, src, axis=0):
    return tgt.clone().index_add_(axis, idx, src)

def _segment_sum(src, seg, n):
    out = torch.zeros((n,) + src.shape[1:], dtype=src.dtype)
    return out.index_add_(0, seg, src)

def _pad(x, pw):
    flat = tuple((v for pair in reversed(pw) for v in pair))
    return torch.nn.functional.pad(x, flat)
kernel_name = 'standalone__factorization_afm__recsys'

def setup_inputs():

    _w = lambda a: (lambda t: t.to(torch.bfloat16) if t.is_floating_point() else t)(torch.as_tensor(a))
    B, F, D, V = (1024, 26, 128, min(1000000, 100000))
    A = D
    ii, jj = tuple(torch.triu_indices(F, F, 1).unbind(0))
    return {'idx': _w((lambda lo, hi, *s: torch.randint(lo, hi, s))(0, V, B, F).to(torch.int64)), 'table': _w((lambda *s: torch.randn(*s, dtype=torch.bfloat16) * 0.8)(V, D)), 'ii': _w(ii.to(torch.int64)), 'jj': _w(jj.to(torch.int64)), 'W': _w((lambda *s: torch.randn(*s, dtype=torch.bfloat16) * 0.4)(D, A) * (1.0 / D ** 0.5)), 'b': _w((lambda *s: torch.randn(*s, dtype=torch.bfloat16) * 0.4)(A)), 'h': _w((lambda *s: torch.randn(*s, dtype=torch.bfloat16) * 0.4)(A)), 'p': _w((lambda *s: torch.randn(*s, dtype=torch.bfloat16) * 0.8)(D))}

def reference(idx, table, ii, jj, W, b, h, p):
    emb = table[idx]
    ei = emb[:, ii, :].clone()
    ej = emb[:, jj, :].clone()
    pair = ei * ej
    hid = pair @ W + b
    hid = 0.5 * (hid + torch.abs(hid))
    e = hid @ h
    alpha = _softmax(e, axis=-1)
    pooled = torch.einsum('bp,bpd->bd', alpha, pair)
    return pooled @ p
```

```asm
; @launch grid=(256,1,1) block=(256,1,1) lds=116992
.amdgcn_target "amdgcn-amd-amdhsa--gfx950"
.text
.globl standalone__factorization_afm__recsys_kernel
.p2align 8
.type standalone__factorization_afm__recsys_kernel,@function
standalone__factorization_afm__recsys_kernel:
    s_cmp_ge_u32 s2, 256
    s_cbranch_scc1 L_end
    s_load_dwordx16 s[16:31], s[0:1], 0
    s_load_dwordx2 s[32:33], s[0:1], 64
    v_lshrrev_b32 v2, 6, v0
    v_and_b32 v1, 63, v0
    v_readfirstlane_b32 s3, v2
    v_and_b32 v3, 15, v0
    s_lshl_b32 s4, s2, 2
    s_add_u32 s4, s4, s3
    s_mul_i32 s34, s4, 104
    v_lshl_add_u32 v5, v3, 2, s34
    v_min_u32 v6, 9, v3
    v_lshl_add_u32 v6, v6, 2, s34
    v_lshrrev_b32 v7, 2, v1
    v_and_b32 v8, 3, v0
    v_lshlrev_b32 v8, 4, v8
    v_lshl_add_u32 v8, v2, 6, v8
    v_lshl_add_u32 v9, v7, 11, v8
    v_lshlrev_b32 v10, 2, v1
    v_and_b32 v11, 31, v0
    v_lshl_add_u32 v11, v2, 5, v11
    v_lshlrev_b32 v12, 1, v11
    v_lshrrev_b32 v4, 4, v1
    s_waitcnt lgkmcnt(0)
    global_load_dword v13, v5, s[16:17]
    global_load_dword v14, v6, s[16:17] offset:64
    global_load_dwordx4 v[220:223], v8, s[28:29]
    global_load_dword v252, v10, s[30:31]
    global_load_ushort v253, v12, s[26:27]
    global_load_ushort v254, v12, s[28:29]
    global_load_dwordx4 v[96:99], v9, s[24:25] offset:0
    global_load_dwordx4 v[100:103], v9, s[24:25] offset:256
    global_load_dwordx4 v[104:107], v9, s[24:25] offset:512
    global_load_dwordx4 v[108:111], v9, s[24:25] offset:768
    global_load_dwordx4 v[112:115], v9, s[24:25] offset:1024
    global_load_dwordx4 v[116:119], v9, s[24:25] offset:1280
    global_load_dwordx4 v[120:123], v9, s[24:25] offset:1536
    global_load_dwordx4 v[124:127], v9, s[24:25] offset:1792
    s_mov_b32 s40, s18
    s_mov_b32 s41, s19
    s_mov_b32 s42, 25600000
    s_mov_b32 s43, 0x00020000
    s_mul_i32 s5, s3, 19008
    s_add_u32 s5, s5, 40960
    s_mov_b32 s6, 0x7fff7fff
    s_mov_b32 s7, 0x80008000
    s_mov_b32 s44, -1
    s_mov_b32 s45, 0x00ffffff
    s_mov_b32 s46, 0x0000ffff
    s_mov_b32 s47, 0x0000ffff
    s_mov_b32 s48, -1
    s_mov_b32 s49, 0x00001fff
    s_mov_b32 s52, 0x11111111
    s_mov_b32 s53, 0x11111111
    s_movk_i32 s35, 288
    s_movk_i32 s36, 144
    v_lshlrev_b32 v15, 4, v4
    v_add_u32 v244, s5, v15
    v_mad_u32_u24 v245, v3, s35, v244
    v_add_u32 v251, 0, v3
    v_mul_u32_u24 v248, 205, v251
    v_lshrrev_b32 v248, 11, v248
    v_mul_u32_u24 v238, 10, v248
    v_sub_u32 v238, v251, v238
    v_add3_u32 v239, v238, v248, 1
    v_subrev_u32 v248, 10, v239
    v_min_u32 v239, v239, v248
    v_mad_u32_u24 v238, v238, s35, v244
    v_mad_u32_u24 v239, v239, s35, v244
    v_add_u32 v251, 16, v3
    v_mul_u32_u24 v248, 205, v251
    v_lshrrev_b32 v248, 11, v248
    v_mul_u32_u24 v240, 10, v248
    v_sub_u32 v240, v251, v240
    v_add3_u32 v241, v240, v248, 1
    v_subrev_u32 v248, 10, v241
    v_min_u32 v241, v241, v248
    v_mad_u32_u24 v240, v240, s35, v244
    v_mad_u32_u24 v241, v241, s35, v244
    v_add_u32 v251, 32, v3
    v_mul_u32_u24 v248, 205, v251
    v_lshrrev_b32 v248, 11, v248
    v_mul_u32_u24 v242, 10, v248
    v_sub_u32 v242, v251, v242
    v_add3_u32 v243, v242, v248, 1
    v_subrev_u32 v248, 10, v243
    v_min_u32 v243, v243, v248
    v_mad_u32_u24 v242, v242, s35, v244
    v_mad_u32_u24 v243, v243, s35, v244
    s_waitcnt vmcnt(13)
    v_lshl_add_u32 v13, v13, 8, v15
    buffer_load_dwordx4 v[80:83], v13, s[40:43], 0 offen offset:0
    buffer_load_dwordx4 v[84:87], v13, s[40:43], 0 offen offset:64
    buffer_load_dwordx4 v[88:91], v13, s[40:43], 0 offen offset:128
    buffer_load_dwordx4 v[92:95], v13, s[40:43], 0 offen offset:192
    s_waitcnt vmcnt(16)
    v_lshl_add_u32 v14, v14, 8, v15
    buffer_load_dwordx4 v[204:207], v14, s[40:43], 0 offen offset:0
    buffer_load_dwordx4 v[208:211], v14, s[40:43], 0 offen offset:64
    buffer_load_dwordx4 v[212:215], v14, s[40:43], 0 offen offset:128
    buffer_load_dwordx4 v[216:219], v14, s[40:43], 0 offen offset:192
    s_add_u32 s37, s5, 9792
    v_lshl_add_u32 v251, v3, 2, s37
    v_mad_u32_u24 v232, v4, s36, v251
    v_add_u32 v233, 2880, v232
    v_add_u32 v232, 2304, v232
    v_lshrrev_b32 v248, 1, v4
    v_mad_u32_u24 v236, v248, s36, v251
    v_add_u32 v236, 3456, v236
    v_add3_u32 v248, v3, v4, 1
    v_and_b32 v249, 15, v248
    v_mad_u32_u24 v234, v249, s36, v251
    v_add_u32 v248, 4, v248
    v_and_b32 v249, 15, v248
    v_mad_u32_u24 v235, v249, s36, v251
    v_mul_u32_u24 v248, 205, v1
    v_lshrrev_b32 v248, 11, v248
    v_mul_u32_u24 v249, 10, v248
    v_sub_u32 v249, v1, v249
    v_add3_u32 v250, v249, v248, 1
    v_subrev_u32 v248, 10, v250
    v_min_u32 v250, v250, v248
    v_lshl_add_u32 v249, v249, 2, s37
    v_mad_u32_u24 v237, v250, s36, v249
    v_add_u32 v237, 2368, v237
    v_mad_u32_u24 v247, v3, s36, v15
    v_add_u32 v247, s37, v247
    v_and_b32 v5, 1, v7
    v_mul_u32_u24 v5, 2432, v5
    v_lshrrev_b32 v6, 1, v7
    v_mul_u32_u24 v6, 4736, v6
    v_add3_u32 v5, v5, v6, v8
    v_lshlrev_b32 v9, 5, v7
    v_lshl_add_u32 v9, v2, 9, v9
    v_lshrrev_b32 v6, 2, v3
    v_mul_u32_u24 v6, 288, v6
    v_and_b32 v13, 1, v4
    v_mul_u32_u24 v13, 2432, v13
    v_lshrrev_b32 v14, 1, v4
    v_mul_u32_u24 v14, 4736, v14
    v_add3_u32 v6, v6, v13, v14
    v_and_b32 v13, 3, v0
    v_lshl_add_u32 v6, v13, 3, v6
    v_lshrrev_b32 v13, 5, v1
    v_lshlrev_b32 v13, 9, v13
    v_lshl_add_u32 v12, v11, 2, v13
    v_cmp_lt_u32 vcc, 31, v1
    s_waitcnt vmcnt(18)
    v_and_b32 v13, s7, v252
    v_and_b32 v252, s6, v252
    v_pk_max_u16 v14, v252, v252 op_sel:[0,1] op_sel_hi:[1,0]
    s_waitcnt vmcnt(16)
    v_cndmask_b32 v253, v253, v254, vcc
    v_lshlrev_b32 v253, 16, v253
    s_waitcnt vmcnt(15)
    v_dot2_f32_bf16 v192, v96, v220, 0
    v_dot2_f32_bf16 v192, v97, v221, v192
    v_dot2_f32_bf16 v192, v98, v222, v192
    v_dot2_f32_bf16 v192, v99, v223, v192
    v_and_b32 v128, s7, v96
    v_and_b32 v96, s6, v96
    v_and_b32 v129, s7, v97
    v_and_b32 v97, s6, v97
    v_and_b32 v130, s7, v98
    v_and_b32 v98, s6, v98
    v_and_b32 v131, s7, v99
    v_and_b32 v99, s6, v99
    v_pk_max_u16 v248, v96, v97
    v_pk_max_u16 v248, v248, v98
    v_pk_max_u16 v248, v248, v99
    s_waitcnt vmcnt(14)
    v_dot2_f32_bf16 v193, v100, v220, 0
    v_dot2_f32_bf16 v193, v101, v221, v193
    v_dot2_f32_bf16 v193, v102, v222, v193
    v_dot2_f32_bf16 v193, v103, v223, v193
    v_and_b32 v132, s7, v100
    v_and_b32 v100, s6, v100
    v_and_b32 v133, s7, v101
    v_and_b32 v101, s6, v101
    v_and_b32 v134, s7, v102
    v_and_b32 v102, s6, v102
    v_and_b32 v135, s7, v103
    v_and_b32 v103, s6, v103
    v_pk_max_u16 v248, v248, v100
    v_pk_max_u16 v248, v248, v101
    v_pk_max_u16 v248, v248, v102
    v_pk_max_u16 v248, v248, v103
    s_waitcnt vmcnt(13)
    v_dot2_f32_bf16 v194, v104, v220, 0
    v_dot2_f32_bf16 v194, v105, v221, v194
    v_dot2_f32_bf16 v194, v106, v222, v194
    v_dot2_f32_bf16 v194, v107, v223, v194
    v_and_b32 v136, s7, v104
    v_and_b32 v104, s6, v104
    v_and_b32 v137, s7, v105
    v_and_b32 v105, s6, v105
    v_and_b32 v138, s7, v106
    v_and_b32 v106, s6, v106
    v_and_b32 v139, s7, v107
    v_and_b32 v107, s6, v107
    v_pk_max_u16 v248, v248, v104
    v_pk_max_u16 v248, v248, v105
    v_pk_max_u16 v248, v248, v106
    v_pk_max_u16 v248, v248, v107
    s_waitcnt vmcnt(12)
    v_dot2_f32_bf16 v195, v108, v220, 0
    v_dot2_f32_bf16 v195, v109, v221, v195
    v_dot2_f32_bf16 v195, v110, v222, v195
    v_dot2_f32_bf16 v195, v111, v223, v195
    v_and_b32 v140, s7, v108
    v_and_b32 v108, s6, v108
    v_and_b32 v141, s7, v109
    v_and_b32 v109, s6, v109
    v_and_b32 v142, s7, v110
    v_and_b32 v110, s6, v110
    v_and_b32 v143, s7, v111
    v_and_b32 v111, s6, v111
    v_pk_max_u16 v248, v248, v108
    v_pk_max_u16 v248, v248, v109
    v_pk_max_u16 v248, v248, v110
    v_pk_max_u16 v248, v248, v111
    s_waitcnt vmcnt(11)
    v_dot2_f32_bf16 v196, v112, v220, 0
    v_dot2_f32_bf16 v196, v113, v221, v196
    v_dot2_f32_bf16 v196, v114, v222, v196
    v_dot2_f32_bf16 v196, v115, v223, v196
    v_and_b32 v144, s7, v112
    v_and_b32 v112, s6, v112
    v_and_b32 v145, s7, v113
    v_and_b32 v113, s6, v113
    v_and_b32 v146, s7, v114
    v_and_b32 v114, s6, v114
    v_and_b32 v147, s7, v115
    v_and_b32 v115, s6, v115
    v_pk_max_u16 v248, v248, v112
    v_pk_max_u16 v248, v248, v113
    v_pk_max_u16 v248, v248, v114
    v_pk_max_u16 v248, v248, v115
    s_waitcnt vmcnt(10)
    v_dot2_f32_bf16 v197, v116, v220, 0
    v_dot2_f32_bf16 v197, v117, v221, v197
    v_dot2_f32_bf16 v197, v118, v222, v197
    v_dot2_f32_bf16 v197, v119, v223, v197
    v_and_b32 v148, s7, v116
    v_and_b32 v116, s6, v116
    v_and_b32 v149, s7, v117
    v_and_b32 v117, s6, v117
    v_and_b32 v150, s7, v118
    v_and_b32 v118, s6, v118
    v_and_b32 v151, s7, v119
    v_and_b32 v119, s6, v119
    v_pk_max_u16 v248, v248, v116
    v_pk_max_u16 v248, v248, v117
    v_pk_max_u16 v248, v248, v118
    v_pk_max_u16 v248, v248, v119
    s_waitcnt vmcnt(9)
    v_dot2_f32_bf16 v198, v120, v220, 0
    v_dot2_f32_bf16 v198, v121, v221, v198
    v_dot2_f32_bf16 v198, v122, v222, v198
    v_dot2_f32_bf16 v198, v123, v223, v198
    v_and_b32 v152, s7, v120
    v_and_b32 v120, s6, v120
    v_and_b32 v153, s7, v121
    v_and_b32 v121, s6, v121
    v_and_b32 v154, s7, v122
    v_and_b32 v122, s6, v122
    v_and_b32 v155, s7, v123
    v_and_b32 v123, s6, v123
    v_pk_max_u16 v248, v248, v120
    v_pk_max_u16 v248, v248, v121
    v_pk_max_u16 v248, v248, v122
    v_pk_max_u16 v248, v248, v123
    s_waitcnt vmcnt(8)
    v_dot2_f32_bf16 v199, v124, v220, 0
    v_dot2_f32_bf16 v199, v125, v221, v199
    v_dot2_f32_bf16 v199, v126, v222, v199
    v_dot2_f32_bf16 v199, v127, v223, v199
    v_and_b32 v156, s7, v124
    v_and_b32 v124, s6, v124
    v_and_b32 v157, s7, v125
    v_and_b32 v125, s6, v125
    v_and_b32 v158, s7, v126
    v_and_b32 v126, s6, v126
    v_and_b32 v159, s7, v127
    v_and_b32 v127, s6, v127
    v_pk_max_u16 v248, v248, v124
    v_pk_max_u16 v248, v248, v125
    v_pk_max_u16 v248, v248, v126
    v_pk_max_u16 v248, v248, v127
    v_pk_max_u16 v248, v248, v248 op_sel:[0,1] op_sel_hi:[1,0]
    v_add_f32_dpp v192, v192, v192 quad_perm:[1,0,3,2] row_mask:0xf bank_mask:0xf
    v_add_f32_dpp v193, v193, v193 quad_perm:[1,0,3,2] row_mask:0xf bank_mask:0xf
    v_max_u32_dpp v248, v248, v248 row_ror:8 row_mask:0xf bank_mask:0xf
    v_max_u32_dpp v14, v14, v14 row_ror:8 row_mask:0xf bank_mask:0xf
    v_add_f32_dpp v194, v194, v194 quad_perm:[1,0,3,2] row_mask:0xf bank_mask:0xf
    v_add_f32_dpp v195, v195, v195 quad_perm:[1,0,3,2] row_mask:0xf bank_mask:0xf
    v_max_u32_dpp v248, v248, v248 row_ror:4 row_mask:0xf bank_mask:0xf
    v_max_u32_dpp v14, v14, v14 row_ror:4 row_mask:0xf bank_mask:0xf
    v_add_f32_dpp v196, v196, v196 quad_perm:[1,0,3,2] row_mask:0xf bank_mask:0xf
    v_add_f32_dpp v197, v197, v197 quad_perm:[1,0,3,2] row_mask:0xf bank_mask:0xf
    v_max_u32_dpp v248, v248, v248 row_ror:2 row_mask:0xf bank_mask:0xf
    v_max_u32_dpp v14, v14, v14 row_ror:2 row_mask:0xf bank_mask:0xf
    v_add_f32_dpp v198, v198, v198 quad_perm:[1,0,3,2] row_mask:0xf bank_mask:0xf
    v_add_f32_dpp v199, v199, v199 quad_perm:[1,0,3,2] row_mask:0xf bank_mask:0xf
    v_max_u32_dpp v248, v248, v248 row_ror:1 row_mask:0xf bank_mask:0xf
    v_max_u32_dpp v14, v14, v14 row_ror:1 row_mask:0xf bank_mask:0xf
    v_add_f32_dpp v192, v192, v192 quad_perm:[2,3,0,1] row_mask:0xf bank_mask:0xf
    v_add_f32_dpp v193, v193, v193 quad_perm:[2,3,0,1] row_mask:0xf bank_mask:0xf
    v_max_u32_dpp v248, v248, v248 row_bcast:15 row_mask:0xa bank_mask:0xf
    v_max_u32_dpp v14, v14, v14 row_bcast:15 row_mask:0xa bank_mask:0xf
    v_add_f32_dpp v194, v194, v194 quad_perm:[2,3,0,1] row_mask:0xf bank_mask:0xf
    v_add_f32_dpp v195, v195, v195 quad_perm:[2,3,0,1] row_mask:0xf bank_mask:0xf
    v_max_u32_dpp v248, v248, v248 row_bcast:31 row_mask:0xc bank_mask:0xf
    v_max_u32_dpp v14, v14, v14 row_bcast:31 row_mask:0xc bank_mask:0xf
    v_add_f32_dpp v196, v196, v196 quad_perm:[2,3,0,1] row_mask:0xf bank_mask:0xf
    v_add_f32_dpp v197, v197, v197 quad_perm:[2,3,0,1] row_mask:0xf bank_mask:0xf
    v_add_f32_dpp v198, v198, v198 quad_perm:[2,3,0,1] row_mask:0xf bank_mask:0xf
    v_add_f32_dpp v199, v199, v199 quad_perm:[2,3,0,1] row_mask:0xf bank_mask:0xf
    v_readlane_b32 s34, v248, 63
    v_readlane_b32 s35, v14, 63
    s_mov_b64 exec, s[52:53]
    ds_write_b128 v9, v[192:195] offset:38912
    ds_write_b128 v9, v[196:199] offset:38928
    s_mov_b64 exec, -1
    s_bfe_u32 s34, s34, 0x80007
    s_max_u32 s34, s34, 101
    s_sub_u32 s9, 141, s34
    s_sub_u32 s34, s34, 29
    s_mul_i32 s8, s34, 0x800080
    s_bfe_u32 s35, s35, 0x80007
    s_max_u32 s35, s35, 60
    s_sub_u32 s13, s35, 134
    s_sub_u32 s35, s35, 22
    s_mul_i32 s12, s35, 0x800080
    s_sub_u32 s34, 0, s9
    v_pk_sub_u16 v96, v96, s8 clamp
    v_pk_sub_u16 v97, v97, s8 clamp
    v_pk_sub_u16 v98, v98, s8 clamp
    v_pk_sub_u16 v99, v99, s8 clamp
    v_lshl_or_b32 v96, v96, 3, v128
    v_lshl_or_b32 v97, v97, 3, v129
    v_lshl_or_b32 v98, v98, 3, v130
    v_lshl_or_b32 v99, v99, 3, v131
    ds_write_b128 v5, v[96:99] offset:0
    v_pk_sub_u16 v100, v100, s8 clamp
    v_pk_sub_u16 v101, v101, s8 clamp
    v_pk_sub_u16 v102, v102, s8 clamp
    v_pk_sub_u16 v103, v103, s8 clamp
    v_lshl_or_b32 v100, v100, 3, v132
    v_lshl_or_b32 v101, v101, 3, v133
    v_lshl_or_b32 v102, v102, 3, v134
    v_lshl_or_b32 v103, v103, 3, v135
    ds_write_b128 v5, v[100:103] offset:288
    v_pk_sub_u16 v104, v104, s8 clamp
    v_pk_sub_u16 v105, v105, s8 clamp
    v_pk_sub_u16 v106, v106, s8 clamp
    v_pk_sub_u16 v107, v107, s8 clamp
    v_lshl_or_b32 v104, v104, 3, v136
    v_lshl_or_b32 v105, v105, 3, v137
    v_lshl_or_b32 v106, v106, 3, v138
    v_lshl_or_b32 v107, v107, 3, v139
    ds_write_b128 v5, v[104:107] offset:576
    v_pk_sub_u16 v108, v108, s8 clamp
    v_pk_sub_u16 v109, v109, s8 clamp
    v_pk_sub_u16 v110, v110, s8 clamp
    v_pk_sub_u16 v111, v111, s8 clamp
    v_lshl_or_b32 v108, v108, 3, v140
    v_lshl_or_b32 v109, v109, 3, v141
    v_lshl_or_b32 v110, v110, 3, v142
    v_lshl_or_b32 v111, v111, 3, v143
    ds_write_b128 v5, v[108:111] offset:864
    v_pk_sub_u16 v112, v112, s8 clamp
    v_pk_sub_u16 v113, v113, s8 clamp
    v_pk_sub_u16 v114, v114, s8 clamp
    v_pk_sub_u16 v115, v115, s8 clamp
    v_lshl_or_b32 v112, v112, 3, v144
    v_lshl_or_b32 v113, v113, 3, v145
    v_lshl_or_b32 v114, v114, 3, v146
    v_lshl_or_b32 v115, v115, 3, v147
    ds_write_b128 v5, v[112:115] offset:1152
    v_pk_sub_u16 v116, v116, s8 clamp
    v_pk_sub_u16 v117, v117, s8 clamp
    v_pk_sub_u16 v118, v118, s8 clamp
    v_pk_sub_u16 v119, v119, s8 clamp
    v_lshl_or_b32 v116, v116, 3, v148
    v_lshl_or_b32 v117, v117, 3, v149
    v_lshl_or_b32 v118, v118, 3, v150
    v_lshl_or_b32 v119, v119, 3, v151
    ds_write_b128 v5, v[116:119] offset:1440
    v_pk_sub_u16 v120, v120, s8 clamp
    v_pk_sub_u16 v121, v121, s8 clamp
    v_pk_sub_u16 v122, v122, s8 clamp
    v_pk_sub_u16 v123, v123, s8 clamp
    v_lshl_or_b32 v120, v120, 3, v152
    v_lshl_or_b32 v121, v121, 3, v153
    v_lshl_or_b32 v122, v122, 3, v154
    v_lshl_or_b32 v123, v123, 3, v155
    ds_write_b128 v5, v[120:123] offset:1728
    v_pk_sub_u16 v124, v124, s8 clamp
    v_pk_sub_u16 v125, v125, s8 clamp
    v_pk_sub_u16 v126, v126, s8 clamp
    v_pk_sub_u16 v127, v127, s8 clamp
    v_lshl_or_b32 v124, v124, 3, v156
    v_lshl_or_b32 v125, v125, 3, v157
    v_lshl_or_b32 v126, v126, 3, v158
    v_lshl_or_b32 v127, v127, 3, v159
    ds_write_b128 v5, v[124:127] offset:2016
    v_mov_b32 v14, s9
    v_mov_b32 v254, s34
    v_cndmask_b32 v14, v14, v254, vcc
    v_ldexp_f32 v253, v253, v14
    ds_write_b32 v12, v253 offset:37888
    v_pk_sub_u16 v252, v252, s12 clamp
    v_lshl_or_b32 v252, v252, 3, v13
    v_add_u32 v10, s5, v10
    ds_write_b32 v10, v252 offset:9504
    v_lshlrev_b32 v9, 3, v1
    s_waitcnt lgkmcnt(0)
    s_barrier
    ds_read_b64 v[192:193], v9 offset:38912
    ds_read_b64 v[194:195], v9 offset:39424
    ds_read_b64 v[196:197], v9 offset:39936
    ds_read_b64 v[198:199], v9 offset:40448
    ds_read_b128 v[16:19], v15 offset:37888
    ds_read_b128 v[20:23], v15 offset:37952
    ds_read_b128 v[24:27], v15 offset:38016
    ds_read_b128 v[28:31], v15 offset:38080
    ds_read_b128 v[32:35], v15 offset:38144
    ds_read_b128 v[36:39], v15 offset:38208
    ds_read_b128 v[40:43], v15 offset:38272
    ds_read_b128 v[44:47], v15 offset:38336
    ds_read_b64_tr_b16 a[0:1], v6 offset:0
    ds_read_b64_tr_b16 a[2:3], v6 offset:1152
    ds_read_b64_tr_b16 a[4:5], v6 offset:9472
    ds_read_b64_tr_b16 a[6:7], v6 offset:10624
    s_waitcnt lgkmcnt(14)
    v_add_f32 v192, v192, v194
    ds_read_b64_tr_b16 a[8:9], v6 offset:18944
    v_add_f32 v193, v193, v195
    ds_read_b64_tr_b16 a[10:11], v6 offset:20096
    s_waitcnt lgkmcnt(14)
    v_add_f32 v196, v196, v198
    ds_read_b64_tr_b16 a[12:13], v6 offset:28416
    v_add_f32 v197, v197, v199
    ds_read_b64_tr_b16 a[14:15], v6 offset:29568
    v_add_f32 v192, v192, v196
    ds_read_b128 v[48:51], v15 offset:38400
    v_add_f32 v193, v193, v197
    ds_read_b128 v[52:55], v15 offset:38464
    v_max_f32 v14, |v192|, |v193|
    ds_read_b128 v[56:59], v15 offset:38528
    ds_read_b128 v[60:63], v15 offset:38592
    ds_read_b128 v[64:67], v15 offset:38656
    ds_read_b128 v[68:71], v15 offset:38720
    ds_read_b128 v[72:75], v15 offset:38784
    ds_read_b128 v[76:79], v15 offset:38848
    ds_read_b64_tr_b16 a[16:17], v6 offset:32
    ds_read_b64_tr_b16 a[18:19], v6 offset:1184
    ds_read_b64_tr_b16 a[20:21], v6 offset:9504
    ds_read_b64_tr_b16 a[22:23], v6 offset:10656
    ds_read_b64_tr_b16 a[24:25], v6 offset:18976
    ds_read_b64_tr_b16 a[26:27], v6 offset:20128
    ds_read_b64_tr_b16 a[28:29], v6 offset:28448
    ds_read_b64_tr_b16 a[30:31], v6 offset:29600
    ds_read_b64_tr_b16 a[32:33], v6 offset:64
    ds_read_b64_tr_b16 a[34:35], v6 offset:1216
    ds_read_b64_tr_b16 a[36:37], v6 offset:9536
    ds_read_b64_tr_b16 a[38:39], v6 offset:10688
    ds_read_b64_tr_b16 a[40:41], v6 offset:19008
    ds_read_b64_tr_b16 a[42:43], v6 offset:20160
    ds_read_b64_tr_b16 a[44:45], v6 offset:28480
    ds_read_b64_tr_b16 a[46:47], v6 offset:29632
    ds_read_b64_tr_b16 a[48:49], v6 offset:96
    ds_read_b64_tr_b16 a[50:51], v6 offset:1248
    ds_read_b64_tr_b16 a[52:53], v6 offset:9568
    s_waitcnt vmcnt(7)
    v_and_b32 v160, s7, v80
    v_and_b32 v80, s6, v80
    v_and_b32 v161, s7, v81
    ds_read_b64_tr_b16 a[54:55], v6 offset:10720
    v_and_b32 v81, s6, v81
    v_pk_max_u16 v248, v80, v81
    v_and_b32 v162, s7, v82
    ds_read_b64_tr_b16 a[56:57], v6 offset:19040
    v_and_b32 v82, s6, v82
    v_pk_max_u16 v248, v248, v82
    ds_read_b64_tr_b16 a[58:59], v6 offset:20192
    v_and_b32 v163, s7, v83
    v_and_b32 v83, s6, v83
    v_pk_max_u16 v248, v248, v83
    ds_read_b64_tr_b16 a[60:61], v6 offset:28512
    s_waitcnt vmcnt(6)
    v_and_b32 v164, s7, v84
    v_and_b32 v84, s6, v84
    ds_read_b64_tr_b16 a[62:63], v6 offset:29664
    v_pk_max_u16 v248, v248, v84
    v_and_b32 v165, s7, v85
    v_and_b32 v85, s6, v85
    ds_read_b64_tr_b16 a[64:65], v6 offset:128
    v_pk_max_u16 v248, v248, v85
    v_and_b32 v166, s7, v86
    ds_read_b64_tr_b16 a[66:67], v6 offset:1280
    v_and_b32 v86, s6, v86
    v_pk_max_u16 v248, v248, v86
    v_and_b32 v167, s7, v87
    ds_read_b64_tr_b16 a[68:69], v6 offset:9600
    v_and_b32 v87, s6, v87
    v_pk_max_u16 v248, v248, v87
    s_waitcnt vmcnt(5)
    v_and_b32 v168, s7, v88
    ds_read_b64_tr_b16 a[70:71], v6 offset:10752
    v_and_b32 v88, s6, v88
    v_pk_max_u16 v248, v248, v88
    ds_read_b64_tr_b16 a[72:73], v6 offset:19072
    v_and_b32 v169, s7, v89
    v_and_b32 v89, s6, v89
    v_pk_max_u16 v248, v248, v89
    ds_read_b64_tr_b16 a[74:75], v6 offset:20224
    v_and_b32 v170, s7, v90
    v_and_b32 v90, s6, v90
    ds_read_b64_tr_b16 a[76:77], v6 offset:28544
    v_pk_max_u16 v248, v248, v90
    v_and_b32 v171, s7, v91
    v_and_b32 v91, s6, v91
    ds_read_b64_tr_b16 a[78:79], v6 offset:29696
    v_pk_max_u16 v248, v248, v91
    s_waitcnt vmcnt(4)
    v_and_b32 v172, s7, v92
    ds_read_b64_tr_b16 a[80:81], v6 offset:160
    v_and_b32 v92, s6, v92
    v_pk_max_u16 v248, v248, v92
    v_and_b32 v173, s7, v93
    ds_read_b64_tr_b16 a[82:83], v6 offset:1312
    v_and_b32 v93, s6, v93
    v_pk_max_u16 v248, v248, v93
    v_and_b32 v174, s7, v94
    ds_read_b64_tr_b16 a[84:85], v6 offset:9632
    v_and_b32 v94, s6, v94
    v_pk_max_u16 v248, v248, v94
    ds_read_b64_tr_b16 a[86:87], v6 offset:10784
    v_and_b32 v175, s7, v95
    v_and_b32 v95, s6, v95
    v_pk_max_u16 v248, v248, v95
    ds_read_b64_tr_b16 a[88:89], v6 offset:19104
    s_waitcnt vmcnt(3)
    v_and_b32 v176, s7, v204
    v_and_b32 v204, s6, v204
    ds_read_b64_tr_b16 a[90:91], v6 offset:20256
    v_pk_max_u16 v248, v248, v204
    v_and_b32 v177, s7, v205
    v_and_b32 v205, s6, v205
    ds_read_b64_tr_b16 a[92:93], v6 offset:28576
    v_pk_max_u16 v248, v248, v205
    v_and_b32 v178, s7, v206
    ds_read_b64_tr_b16 a[94:95], v6 offset:29728
    v_and_b32 v206, s6, v206
    v_pk_max_u16 v248, v248, v206
    v_and_b32 v179, s7, v207
    ds_read_b64_tr_b16 a[96:97], v6 offset:192
    v_and_b32 v207, s6, v207
    v_pk_max_u16 v248, v248, v207
    s_waitcnt vmcnt(2)
    v_and_b32 v180, s7, v208
    ds_read_b64_tr_b16 a[98:99], v6 offset:1344
    v_and_b32 v208, s6, v208
    v_pk_max_u16 v248, v248, v208
    ds_read_b64_tr_b16 a[100:101], v6 offset:9664
    v_and_b32 v181, s7, v209
    v_and_b32 v209, s6, v209
    v_pk_max_u16 v248, v248, v209
    ds_read_b64_tr_b16 a[102:103], v6 offset:10816
    v_and_b32 v182, s7, v210
    v_and_b32 v210, s6, v210
    ds_read_b64_tr_b16 a[104:105], v6 offset:19136
    v_pk_max_u16 v248, v248, v210
    v_and_b32 v183, s7, v211
    v_and_b32 v211, s6, v211
    ds_read_b64_tr_b16 a[106:107], v6 offset:20288
    v_pk_max_u16 v248, v248, v211
    s_waitcnt vmcnt(1)
    v_and_b32 v184, s7, v212
    ds_read_b64_tr_b16 a[108:109], v6 offset:28608
    v_and_b32 v212, s6, v212
    v_pk_max_u16 v248, v248, v212
    v_and_b32 v185, s7, v213
    ds_read_b64_tr_b16 a[110:111], v6 offset:29760
    v_and_b32 v213, s6, v213
    v_pk_max_u16 v248, v248, v213
    v_and_b32 v186, s7, v214
    ds_read_b64_tr_b16 a[112:113], v6 offset:224
    v_and_b32 v214, s6, v214
    v_pk_max_u16 v248, v248, v214
    ds_read_b64_tr_b16 a[114:115], v6 offset:1376
    v_and_b32 v187, s7, v215
    v_and_b32 v215, s6, v215
    v_pk_max_u16 v248, v248, v215
    ds_read_b64_tr_b16 a[116:117], v6 offset:9696
    s_waitcnt vmcnt(0)
    v_and_b32 v188, s7, v216
    v_and_b32 v216, s6, v216
    ds_read_b64_tr_b16 a[118:119], v6 offset:10848
    v_pk_max_u16 v248, v248, v216
    v_and_b32 v189, s7, v217
    v_and_b32 v217, s6, v217
    ds_read_b64_tr_b16 a[120:121], v6 offset:19168
    v_pk_max_u16 v248, v248, v217
    v_and_b32 v190, s7, v218
    ds_read_b64_tr_b16 a[122:123], v6 offset:20320
    v_and_b32 v218, s6, v218
    v_pk_max_u16 v248, v248, v218
    v_and_b32 v191, s7, v219
    ds_read_b64_tr_b16 a[124:125], v6 offset:28640
    v_and_b32 v219, s6, v219
    v_pk_max_u16 v248, v248, v219
    ds_read_b64_tr_b16 a[126:127], v6 offset:29792
    v_pk_max_u16 v248, v248, v248 op_sel:[0,1] op_sel_hi:[1,0]
    v_mov_b32_dpp v246, v245 row_ror:15 row_mask:0xf bank_mask:0xf
    s_nop 0
    v_max_u32_dpp v248, v248, v248 row_ror:8 row_mask:0xf bank_mask:0xf
    v_max_u32_dpp v14, v14, v14 row_ror:8 row_mask:0xf bank_mask:0xf
    s_nop 0
    v_max_u32_dpp v248, v248, v248 row_ror:4 row_mask:0xf bank_mask:0xf
    v_max_u32_dpp v14, v14, v14 row_ror:4 row_mask:0xf bank_mask:0xf
    s_nop 0
    v_max_u32_dpp v248, v248, v248 row_ror:2 row_mask:0xf bank_mask:0xf
    v_max_u32_dpp v14, v14, v14 row_ror:2 row_mask:0xf bank_mask:0xf
    s_nop 0
    v_max_u32_dpp v248, v248, v248 row_ror:1 row_mask:0xf bank_mask:0xf
    v_max_u32_dpp v14, v14, v14 row_ror:1 row_mask:0xf bank_mask:0xf
    s_nop 0
    v_max_u32_dpp v248, v248, v248 row_bcast:15 row_mask:0xa bank_mask:0xf
    v_max_u32_dpp v14, v14, v14 row_bcast:15 row_mask:0xa bank_mask:0xf
    s_nop 0
    v_max_u32_dpp v248, v248, v248 row_bcast:31 row_mask:0xc bank_mask:0xf
    v_max_u32_dpp v14, v14, v14 row_bcast:31 row_mask:0xc bank_mask:0xf
    v_readlane_b32 s34, v248, 63
    v_readlane_b32 s35, v14, 63
    s_bfe_u32 s34, s34, 0x80007
    s_max_u32 s34, s34, 104
    s_min_u32 s34, s34, 190
    s_sub_u32 s36, s34, 22
    s_mul_i32 s10, s36, 0x800080
    v_pk_sub_u16 v80, v80, s10 clamp
    v_pk_sub_u16 v81, v81, s10 clamp
    v_pk_sub_u16 v82, v82, s10 clamp
    v_pk_sub_u16 v83, v83, s10 clamp
    v_lshl_or_b32 v80, v80, 3, v160
    v_lshl_or_b32 v81, v81, 3, v161
    v_lshl_or_b32 v82, v82, 3, v162
    v_lshl_or_b32 v83, v83, 3, v163
    ds_write_b128 v245, v[80:83] offset:0
    v_pk_sub_u16 v84, v84, s10 clamp
    v_pk_sub_u16 v85, v85, s10 clamp
    v_pk_sub_u16 v86, v86, s10 clamp
    v_pk_sub_u16 v87, v87, s10 clamp
    v_lshl_or_b32 v84, v84, 3, v164
    v_lshl_or_b32 v85, v85, 3, v165
    v_lshl_or_b32 v86, v86, 3, v166
    v_lshl_or_b32 v87, v87, 3, v167
    ds_write_b128 v245, v[84:87] offset:64
    v_pk_sub_u16 v88, v88, s10 clamp
    v_pk_sub_u16 v89, v89, s10 clamp
    v_pk_sub_u16 v90, v90, s10 clamp
    v_pk_sub_u16 v91, v91, s10 clamp
    v_lshl_or_b32 v88, v88, 3, v168
    v_lshl_or_b32 v89, v89, 3, v169
    v_lshl_or_b32 v90, v90, 3, v170
    v_lshl_or_b32 v91, v91, 3, v171
    ds_write_b128 v245, v[88:91] offset:128
    v_pk_sub_u16 v92, v92, s10 clamp
    v_pk_sub_u16 v93, v93, s10 clamp
    v_pk_sub_u16 v94, v94, s10 clamp
    v_pk_sub_u16 v95, v95, s10 clamp
    v_lshl_or_b32 v92, v92, 3, v172
    v_lshl_or_b32 v93, v93, 3, v173
    v_lshl_or_b32 v94, v94, 3, v174
    v_lshl_or_b32 v95, v95, 3, v175
    ds_write_b128 v245, v[92:95] offset:192
    ds_read_b128 v[140:143], v246 offset:192
    ds_read_b128 v[136:139], v246 offset:128
    ds_read_b128 v[132:135], v246 offset:64
    ds_read_b128 v[128:131], v246 offset:0
    s_sub_u32 s11, 134, s34
    s_lshl_b32 s11, s11, 1
    s_sub_u32 s13, s13, s11
    s_add_u32 s36, s11, 1
    s_lshl_b32 s36, s36, 23
    s_sub_u32 s15, 0x3fb8aa3b, s36
    s_lshr_b32 s35, s35, 23
    s_max_u32 s35, s35, 60
    s_sub_u32 s37, 134, s35
    s_sub_u32 s35, s35, 7
    s_lshl_b32 s14, s35, 23
    v_pk_sub_u16 v204, v204, s10 clamp
    v_pk_sub_u16 v205, v205, s10 clamp
    v_pk_sub_u16 v206, v206, s10 clamp
    v_pk_sub_u16 v207, v207, s10 clamp
    v_lshl_or_b32 v204, v204, 3, v176
    v_lshl_or_b32 v205, v205, 3, v177
    v_lshl_or_b32 v206, v206, 3, v178
    v_lshl_or_b32 v207, v207, 3, v179
    ds_write_b128 v245, v[204:207] offset:4608
    v_pk_sub_u16 v208, v208, s10 clamp
    v_pk_sub_u16 v209, v209, s10 clamp
    v_pk_sub_u16 v210, v210, s10 clamp
    v_pk_sub_u16 v211, v211, s10 clamp
    v_lshl_or_b32 v208, v208, 3, v180
    v_lshl_or_b32 v209, v209, 3, v181
    v_lshl_or_b32 v210, v210, 3, v182
    v_lshl_or_b32 v211, v211, 3, v183
    ds_write_b128 v245, v[208:211] offset:4672
    v_pk_sub_u16 v212, v212, s10 clamp
    v_pk_sub_u16 v213, v213, s10 clamp
    v_pk_sub_u16 v214, v214, s10 clamp
    v_pk_sub_u16 v215, v215, s10 clamp
    v_lshl_or_b32 v212, v212, 3, v184
    v_lshl_or_b32 v213, v213, 3, v185
    v_lshl_or_b32 v214, v214, 3, v186
    v_lshl_or_b32 v215, v215, 3, v187
    ds_write_b128 v245, v[212:215] offset:4736
    v_pk_sub_u16 v216, v216, s10 clamp
    v_pk_sub_u16 v217, v217, s10 clamp
    v_pk_sub_u16 v218, v218, s10 clamp
    v_pk_sub_u16 v219, v219, s10 clamp
    v_lshl_or_b32 v216, v216, 3, v188
    v_lshl_or_b32 v217, v217, 3, v189
    v_lshl_or_b32 v218, v218, 3, v190
    v_lshl_or_b32 v219, v219, 3, v191
    ds_write_b128 v245, v[216:219] offset:4800
    v_ldexp_f32 v192, v192, s37
    v_ldexp_f32 v193, v193, s37
    v_cvt_pk_f16_f32 v192, v192, v193
    ds_write_b32 v10, v192 offset:9216
    s_waitcnt lgkmcnt(15)
    v_ldexp_f32 v16, v16, s11
    v_ldexp_f32 v17, v17, s11
    v_ldexp_f32 v18, v18, s11
    v_ldexp_f32 v19, v19, s11
    s_waitcnt lgkmcnt(5)
    v_pk_mul_f16 v128, v128, v80
    v_pk_mul_f16 v129, v129, v81
    v_pk_mul_f16 v130, v130, v82
    v_pk_mul_f16 v131, v131, v83
    v_pk_mul_f16 v132, v132, v84
    v_pk_mul_f16 v133, v133, v85
    v_pk_mul_f16 v134, v134, v86
    v_pk_mul_f16 v135, v135, v87
    v_mfma_f32_16x16x32_f16 v[96:99], a[0:3], v[128:131], v[16:19]
    v_pk_mul_f16 v136, v136, v88
    v_pk_mul_f16 v137, v137, v89
    v_pk_mul_f16 v138, v138, v90
    v_pk_mul_f16 v139, v139, v91
    v_mfma_f32_16x16x32_f16 v[96:99], a[4:7], v[132:135], v[96:99]
    v_pk_mul_f16 v140, v140, v92
    v_pk_mul_f16 v141, v141, v93
    v_pk_mul_f16 v142, v142, v94
    v_pk_mul_f16 v143, v143, v95
    v_mfma_f32_16x16x32_f16 v[96:99], a[8:11], v[136:139], v[96:99]
    v_ldexp_f32 v20, v20, s11
    v_ldexp_f32 v21, v21, s11
    v_ldexp_f32 v22, v22, s11
    v_ldexp_f32 v23, v23, s11
    v_mfma_f32_16x16x32_f16 v[96:99], a[12:15], v[140:143], v[96:99]
    v_mov_b32_dpp v246, v245 row_ror:14 row_mask:0xf bank_mask:0xf
    ds_read_b128 v[156:159], v246 offset:192
    v_mfma_f32_16x16x32_f16 v[100:103], a[16:19], v[128:131], v[20:23]
    ds_read_b128 v[152:155], v246 offset:128
    ds_read_b128 v[148:151], v246 offset:64
    v_mfma_f32_16x16x32_f16 v[100:103], a[20:23], v[132:135], v[100:103]
    ds_read_b128 v[144:147], v246 offset:0
    v_ldexp_f32 v24, v24, s11
    v_mfma_f32_16x16x32_f16 v[100:103], a[24:27], v[136:139], v[100:103]
    v_ldexp_f32 v25, v25, s11
    v_ldexp_f32 v26, v26, s11
    v_ldexp_f32 v27, v27, s11
    v_mfma_f32_16x16x32_f16 v[100:103], a[28:31], v[140:143], v[100:103]
    v_ldexp_f32 v28, v28, s11
    v_ldexp_f32 v29, v29, s11
    v_mfma_f32_16x16x32_f16 v[104:107], a[32:35], v[128:131], v[24:27]
    v_ldexp_f32 v30, v30, s11
    v_ldexp_f32 v31, v31, s11
    v_mfma_f32_16x16x32_f16 v[104:107], a[36:39], v[132:135], v[104:107]
    v_mul_f32 v184, |v96|, v48
    v_mul_f32 v200, |v97|, v49
    v_mfma_f32_16x16x32_f16 v[104:107], a[40:43], v[136:139], v[104:107]
    v_fma_f32 v184, |v98|, v50, v184
    v_fma_f32 v200, |v99|, v51, v200
    v_mfma_f32_16x16x32_f16 v[104:107], a[44:47], v[140:143], v[104:107]
    v_ldexp_f32 v32, v32, s11
    v_ldexp_f32 v33, v33, s11
    v_mfma_f32_16x16x32_f16 v[108:111], a[48:51], v[128:131], v[28:31]
    v_ldexp_f32 v34, v34, s11
    v_ldexp_f32 v35, v35, s11
    v_mfma_f32_16x16x32_f16 v[108:111], a[52:55], v[132:135], v[108:111]
    s_waitcnt lgkmcnt(0)
    v_pk_mul_f16 v144, v144, v80
    v_mfma_f32_16x16x32_f16 v[108:111], a[56:59], v[136:139], v[108:111]
    v_pk_mul_f16 v145, v145, v81
    v_fma_f32 v184, |v100|, v52, v184
    v_mfma_f32_16x16x32_f16 v[108:111], a[60:63], v[140:143], v[108:111]
    v_fma_f32 v200, |v101|, v53, v200
    v_fma_f32 v184, |v102|, v54, v184
    v_mfma_f32_16x16x32_f16 v[112:115], a[64:67], v[128:131], v[32:35]
    v_fma_f32 v200, |v103|, v55, v200
    v_pk_mul_f16 v146, v146, v82
    v_mfma_f32_16x16x32_f16 v[112:115], a[68:71], v[132:135], v[112:115]
    v_pk_mul_f16 v147, v147, v83
    v_pk_mul_f16 v148, v148, v84
    v_mfma_f32_16x16x32_f16 v[112:115], a[72:75], v[136:139], v[112:115]
    v_ldexp_f32 v36, v36, s11
    v_ldexp_f32 v37, v37, s11
    v_ldexp_f32 v38, v38, s11
    v_ldexp_f32 v39, v39, s11
    v_mfma_f32_16x16x32_f16 v[112:115], a[76:79], v[140:143], v[112:115]
    v_pk_mul_f16 v149, v149, v85
    v_fma_f32 v184, |v104|, v56, v184
    v_mfma_f32_16x16x32_f16 v[116:119], a[80:83], v[128:131], v[36:39]
    v_fma_f32 v200, |v105|, v57, v200
    v_fma_f32 v184, |v106|, v58, v184
    v_fma_f32 v200, |v107|, v59, v200
    v_pk_mul_f16 v150, v150, v86
    v_mfma_f32_16x16x32_f16 v[116:119], a[84:87], v[132:135], v[116:119]
    v_pk_mul_f16 v151, v151, v87
    v_pk_mul_f16 v152, v152, v88
    v_mfma_f32_16x16x32_f16 v[116:119], a[88:91], v[136:139], v[116:119]
    v_ldexp_f32 v40, v40, s11
    v_ldexp_f32 v41, v41, s11
    v_ldexp_f32 v42, v42, s11
    v_ldexp_f32 v43, v43, s11
    v_mfma_f32_16x16x32_f16 v[116:119], a[92:95], v[140:143], v[116:119]
    v_pk_mul_f16 v153, v153, v89
    v_fma_f32 v184, |v108|, v60, v184
    v_mfma_f32_16x16x32_f16 v[120:123], a[96:99], v[128:131], v[40:43]
    v_fma_f32 v200, |v109|, v61, v200
    v_fma_f32 v184, |v110|, v62, v184
    v_fma_f32 v200, |v111|, v63, v200
    v_pk_mul_f16 v154, v154, v90
    v_mfma_f32_16x16x32_f16 v[120:123], a[100:103], v[132:135], v[120:123]
    v_pk_mul_f16 v155, v155, v91
    v_pk_mul_f16 v156, v156, v92
    v_mfma_f32_16x16x32_f16 v[120:123], a[104:107], v[136:139], v[120:123]
    v_ldexp_f32 v44, v44, s11
    v_ldexp_f32 v45, v45, s11
    v_ldexp_f32 v46, v46, s11
    v_ldexp_f32 v47, v47, s11
    v_mfma_f32_16x16x32_f16 v[120:123], a[108:111], v[140:143], v[120:123]
    v_pk_mul_f16 v157, v157, v93
    v_fma_f32 v184, |v112|, v64, v184
    v_mfma_f32_16x16x32_f16 v[124:127], a[112:115], v[128:131], v[44:47]
    v_fma_f32 v200, |v113|, v65, v200
    v_fma_f32 v184, |v114|, v66, v184
    v_fma_f32 v200, |v115|, v67, v200
    v_pk_mul_f16 v158, v158, v94
    v_mfma_f32_16x16x32_f16 v[124:127], a[116:119], v[132:135], v[124:127]
    v_pk_mul_f16 v159, v159, v95
    v_fma_f32 v184, |v116|, v68, v184
    v_mfma_f32_16x16x32_f16 v[124:127], a[120:123], v[136:139], v[124:127]
    v_fma_f32 v200, |v117|, v69, v200
    v_fma_f32 v184, |v118|, v70, v184
    v_mfma_f32_16x16x32_f16 v[124:127], a[124:127], v[140:143], v[124:127]
    v_fma_f32 v200, |v119|, v71, v200
    v_mov_b32_dpp v246, v245 row_ror:13 row_mask:0xf bank_mask:0xf
    v_mfma_f32_16x16x32_f16 v[96:99], a[0:3], v[144:147], v[16:19]
    ds_read_b128 v[172:175], v244 offset:9408
    ds_read_b128 v[168:171], v244 offset:9344
    v_mfma_f32_16x16x32_f16 v[96:99], a[4:7], v[148:151], v[96:99]
    ds_read_b128 v[164:167], v244 offset:9280
    ds_read_b128 v[160:163], v244 offset:9216
    v_mfma_f32_16x16x32_f16 v[96:99], a[8:11], v[152:155], v[96:99]
    ds_read_b128 v[140:143], v246 offset:192
    ds_read_b128 v[136:139], v246 offset:128
    v_mfma_f32_16x16x32_f16 v[96:99], a[12:15], v[156:159], v[96:99]
    ds_read_b128 v[132:135], v246 offset:64
    ds_read_b128 v[128:131], v246 offset:0
    v_mfma_f32_16x16x32_f16 v[100:103], a[16:19], v[144:147], v[20:23]
    v_fma_f32 v184, |v120|, v72, v184
    v_fma_f32 v200, |v121|, v73, v200
    v_fma_f32 v184, |v122|, v74, v184
    v_fma_f32 v200, |v123|, v75, v200
    v_mfma_f32_16x16x32_f16 v[100:103], a[20:23], v[148:151], v[100:103]
    v_fma_f32 v184, |v124|, v76, v184
    v_fma_f32 v200, |v125|, v77, v200
    v_mfma_f32_16x16x32_f16 v[100:103], a[24:27], v[152:155], v[100:103]
    v_fma_f32 v184, |v126|, v78, v184
    v_fma_f32 v200, |v127|, v79, v200
    v_mfma_f32_16x16x32_f16 v[100:103], a[28:31], v[156:159], v[100:103]
    v_add_f32 v184, v184, v200
    v_mul_f32 v185, |v96|, v48
    v_mfma_f32_16x16x32_f16 v[104:107], a[32:35], v[144:147], v[24:27]
    v_mul_f32 v201, |v97|, v49
    v_fma_f32 v185, |v98|, v50, v185
    v_mfma_f32_16x16x32_f16 v[104:107], a[36:39], v[148:151], v[104:107]
    v_fma_f32 v201, |v99|, v51, v201
    v_mfma_f32_16x16x32_f16 v[104:107], a[40:43], v[152:155], v[104:107]
    s_waitcnt lgkmcnt(0)
    v_pk_mul_f16 v128, v128, v80
    v_mfma_f32_16x16x32_f16 v[104:107], a[44:47], v[156:159], v[104:107]
    v_pk_mul_f16 v129, v129, v81
    v_pk_mul_f16 v130, v130, v82
    v_mfma_f32_16x16x32_f16 v[108:111], a[48:51], v[144:147], v[28:31]
    v_fma_f32 v185, |v100|, v52, v185
    v_fma_f32 v201, |v101|, v53, v201
    v_mfma_f32_16x16x32_f16 v[108:111], a[52:55], v[148:151], v[108:111]
    v_fma_f32 v185, |v102|, v54, v185
    v_fma_f32 v201, |v103|, v55, v201
    v_mfma_f32_16x16x32_f16 v[108:111], a[56:59], v[152:155], v[108:111]
    v_pk_mul_f16 v131, v131, v83
    v_pk_mul_f16 v132, v132, v84
    v_mfma_f32_16x16x32_f16 v[108:111], a[60:63], v[156:159], v[108:111]
    v_fma_f32 v185, |v104|, v56, v185
    v_fma_f32 v201, |v105|, v57, v201
    v_mfma_f32_16x16x32_f16 v[112:115], a[64:67], v[144:147], v[32:35]
    v_fma_f32 v185, |v106|, v58, v185
    v_fma_f32 v201, |v107|, v59, v201
    v_mfma_f32_16x16x32_f16 v[112:115], a[68:71], v[148:151], v[112:115]
    v_pk_mul_f16 v133, v133, v85
    v_pk_mul_f16 v134, v134, v86
    v_mfma_f32_16x16x32_f16 v[112:115], a[72:75], v[152:155], v[112:115]
    v_fma_f32 v185, |v108|, v60, v185
    v_fma_f32 v201, |v109|, v61, v201
    v_mfma_f32_16x16x32_f16 v[112:115], a[76:79], v[156:159], v[112:115]
    v_fma_f32 v185, |v110|, v62, v185
    v_fma_f32 v201, |v111|, v63, v201
    v_mfma_f32_16x16x32_f16 v[116:119], a[80:83], v[144:147], v[36:39]
    v_pk_mul_f16 v135, v135, v87
    v_pk_mul_f16 v136, v136, v88
    v_mfma_f32_16x16x32_f16 v[116:119], a[84:87], v[148:151], v[116:119]
    v_pk_mul_f16 v137, v137, v89
    v_pk_mul_f16 v138, v138, v90
    v_mfma_f32_16x16x32_f16 v[116:119], a[88:91], v[152:155], v[116:119]
    v_fma_f32 v185, |v112|, v64, v185
    v_fma_f32 v201, |v113|, v65, v201
    v_mfma_f32_16x16x32_f16 v[116:119], a[92:95], v[156:159], v[116:119]
    v_fma_f32 v185, |v114|, v66, v185
    v_fma_f32 v201, |v115|, v67, v201
    v_mfma_f32_16x16x32_f16 v[120:123], a[96:99], v[144:147], v[40:43]
    v_pk_mul_f16 v160, v160, v80
    v_mfma_f32_16x16x32_f16 v[120:123], a[100:103], v[148:151], v[120:123]
    v_pk_mul_f16 v161, v161, v81
    v_pk_mul_f16 v162, v162, v82
    v_mfma_f32_16x16x32_f16 v[120:123], a[104:107], v[152:155], v[120:123]
    v_pk_mul_f16 v163, v163, v83
    v_pk_mul_f16 v164, v164, v84
    v_mfma_f32_16x16x32_f16 v[120:123], a[108:111], v[156:159], v[120:123]
    v_pk_mul_f16 v165, v165, v85
    v_pk_mul_f16 v166, v166, v86
    v_mfma_f32_16x16x32_f16 v[124:127], a[112:115], v[144:147], v[44:47]
    v_pk_mul_f16 v167, v167, v87
    v_pk_mul_f16 v168, v168, v88
    v_mfma_f32_16x16x32_f16 v[124:127], a[116:119], v[148:151], v[124:127]
    v_pk_mul_f16 v169, v169, v89
    v_pk_mul_f16 v170, v170, v90
    v_mfma_f32_16x16x32_f16 v[124:127], a[120:123], v[152:155], v[124:127]
    v_pk_mul_f16 v171, v171, v91
    v_pk_mul_f16 v172, v172, v92
    v_pk_mul_f16 v173, v173, v93
    v_pk_mul_f16 v174, v174, v94
    v_pk_mul_f16 v175, v175, v95
    v_mfma_f32_16x16x32_f16 v[124:127], a[124:127], v[156:159], v[124:127]
    v_pk_mul_f16 v139, v139, v91
    v_fma_f32 v185, |v116|, v68, v185
    v_mfma_f32_16x16x32_f16 v[220:223], v[160:163], v[80:83], 0
    v_fma_f32 v201, |v117|, v69, v201
    v_fma_f32 v185, |v118|, v70, v185
    v_fma_f32 v201, |v119|, v71, v201
    v_pk_mul_f16 v140, v140, v92
    v_mfma_f32_16x16x32_f16 v[220:223], v[164:167], v[84:87], v[220:223]
    v_pk_mul_f16 v141, v141, v93
    v_fma_f32 v185, |v120|, v72, v185
    v_mfma_f32_16x16x32_f16 v[220:223], v[168:171], v[88:91], v[220:223]
    v_fma_f32 v201, |v121|, v73, v201
    v_fma_f32 v185, |v122|, v74, v185
    v_mfma_f32_16x16x32_f16 v[220:223], v[172:175], v[92:95], v[220:223]
    v_fma_f32 v201, |v123|, v75, v201
    v_pk_mul_f16 v142, v142, v94
    v_mfma_f32_16x16x32_f16 v[224:227], v[160:163], v[204:207], 0
    v_pk_mul_f16 v143, v143, v95
    v_fma_f32 v185, |v124|, v76, v185
    v_mfma_f32_16x16x32_f16 v[224:227], v[164:167], v[208:211], v[224:227]
    v_fma_f32 v201, |v125|, v77, v201
    v_fma_f32 v185, |v126|, v78, v185
    v_mfma_f32_16x16x32_f16 v[224:227], v[168:171], v[212:215], v[224:227]
    v_fma_f32 v201, |v127|, v79, v201
    v_mov_b32_dpp v246, v245 row_ror:12 row_mask:0xf bank_mask:0xf
    v_mfma_f32_16x16x32_f16 v[224:227], v[172:175], v[216:219], v[224:227]
    v_add_f32 v185, v185, v201
    ds_write_b128 v247, v[220:223] offset:0
    v_mfma_f32_16x16x32_f16 v[96:99], a[0:3], v[128:131], v[16:19]
    ds_read_b128 v[156:159], v246 offset:192
    ds_read_b128 v[152:155], v246 offset:128
    v_mfma_f32_16x16x32_f16 v[96:99], a[4:7], v[132:135], v[96:99]
    ds_read_b128 v[148:151], v246 offset:64
    ds_read_b128 v[144:147], v246 offset:0
    v_mfma_f32_16x16x32_f16 v[96:99], a[8:11], v[136:139], v[96:99]
    ds_write_b128 v247, v[224:227] offset:2304
    ds_read_b128 v[172:175], v244 offset:9696
    v_mfma_f32_16x16x32_f16 v[96:99], a[12:15], v[140:143], v[96:99]
    ds_read_b128 v[168:171], v244 offset:9632
    ds_read_b128 v[164:167], v244 offset:9568
    v_mfma_f32_16x16x32_f16 v[100:103], a[16:19], v[128:131], v[20:23]
    ds_read_b128 v[160:163], v244 offset:9504
    v_mfma_f32_16x16x32_f16 v[100:103], a[20:23], v[132:135], v[100:103]
    v_mfma_f32_16x16x32_f16 v[100:103], a[24:27], v[136:139], v[100:103]
    s_nop 1
    v_mul_f32 v186, |v96|, v48
    v_mul_f32 v200, |v97|, v49
    v_mfma_f32_16x16x32_f16 v[100:103], a[28:31], v[140:143], v[100:103]
    v_fma_f32 v186, |v98|, v50, v186
    v_fma_f32 v200, |v99|, v51, v200
    v_mfma_f32_16x16x32_f16 v[104:107], a[32:35], v[128:131], v[24:27]
    v_mfma_f32_16x16x32_f16 v[104:107], a[36:39], v[132:135], v[104:107]
    v_mfma_f32_16x16x32_f16 v[104:107], a[40:43], v[136:139], v[104:107]
    s_waitcnt lgkmcnt(5)
    v_pk_mul_f16 v144, v144, v80
    v_mfma_f32_16x16x32_f16 v[104:107], a[44:47], v[140:143], v[104:107]
    v_pk_mul_f16 v145, v145, v81
    v_pk_mul_f16 v146, v146, v82
    v_mfma_f32_16x16x32_f16 v[108:111], a[48:51], v[128:131], v[28:31]
    v_pk_mul_f16 v147, v147, v83
    v_fma_f32 v186, |v100|, v52, v186
    v_mfma_f32_16x16x32_f16 v[108:111], a[52:55], v[132:135], v[108:111]
    v_fma_f32 v200, |v101|, v53, v200
    v_fma_f32 v186, |v102|, v54, v186
    v_mfma_f32_16x16x32_f16 v[108:111], a[56:59], v[136:139], v[108:111]
    v_fma_f32 v200, |v103|, v55, v200
    v_pk_mul_f16 v148, v148, v84
    v_mfma_f32_16x16x32_f16 v[108:111], a[60:63], v[140:143], v[108:111]
    v_pk_mul_f16 v149, v149, v85
    v_pk_mul_f16 v150, v150, v86
    v_mfma_f32_16x16x32_f16 v[112:115], a[64:67], v[128:131], v[32:35]
    v_fma_f32 v186, |v104|, v56, v186
    v_fma_f32 v200, |v105|, v57, v200
    v_mfma_f32_16x16x32_f16 v[112:115], a[68:71], v[132:135], v[112:115]
    v_fma_f32 v186, |v106|, v58, v186
    v_fma_f32 v200, |v107|, v59, v200
    v_mfma_f32_16x16x32_f16 v[112:115], a[72:75], v[136:139], v[112:115]
    v_pk_mul_f16 v151, v151, v87
    v_pk_mul_f16 v152, v152, v88
    v_mfma_f32_16x16x32_f16 v[112:115], a[76:79], v[140:143], v[112:115]
    v_pk_mul_f16 v153, v153, v89
    v_pk_mul_f16 v154, v154, v90
    v_mfma_f32_16x16x32_f16 v[116:119], a[80:83], v[128:131], v[36:39]
    v_fma_f32 v186, |v108|, v60, v186
    v_fma_f32 v200, |v109|, v61, v200
    v_mfma_f32_16x16x32_f16 v[116:119], a[84:87], v[132:135], v[116:119]
    v_fma_f32 v186, |v110|, v62, v186
    v_fma_f32 v200, |v111|, v63, v200
    v_mfma_f32_16x16x32_f16 v[116:119], a[88:91], v[136:139], v[116:119]
    v_pk_mul_f16 v155, v155, v91
    v_pk_mul_f16 v156, v156, v92
    v_mfma_f32_16x16x32_f16 v[116:119], a[92:95], v[140:143], v[116:119]
    v_pk_mul_f16 v157, v157, v93
    v_fma_f32 v186, |v112|, v64, v186
    v_mfma_f32_16x16x32_f16 v[120:123], a[96:99], v[128:131], v[40:43]
    v_fma_f32 v200, |v113|, v65, v200
    v_fma_f32 v186, |v114|, v66, v186
    v_mfma_f32_16x16x32_f16 v[120:123], a[100:103], v[132:135], v[120:123]
    v_fma_f32 v200, |v115|, v67, v200
    v_pk_mul_f16 v158, v158, v94
    v_mfma_f32_16x16x32_f16 v[120:123], a[104:107], v[136:139], v[120:123]
    v_pk_mul_f16 v159, v159, v95
    v_fma_f32 v186, |v116|, v68, v186
    v_mfma_f32_16x16x32_f16 v[120:123], a[108:111], v[140:143], v[120:123]
    v_fma_f32 v200, |v117|, v69, v200
    v_fma_f32 v186, |v118|, v70, v186
    v_mfma_f32_16x16x32_f16 v[124:127], a[112:115], v[128:131], v[44:47]
    v_fma_f32 v200, |v119|, v71, v200
    v_mov_b32_dpp v246, v245 row_ror:11 row_mask:0xf bank_mask:0xf
    v_mfma_f32_16x16x32_f16 v[124:127], a[116:119], v[132:135], v[124:127]
    s_waitcnt lgkmcnt(0)
    v_pk_mul_f16 v160, v160, v80
    v_mfma_f32_16x16x32_f16 v[124:127], a[120:123], v[136:139], v[124:127]
    v_fma_f32 v186, |v120|, v72, v186
    v_fma_f32 v200, |v121|, v73, v200
    v_mfma_f32_16x16x32_f16 v[124:127], a[124:127], v[140:143], v[124:127]
    v_fma_f32 v186, |v122|, v74, v186
    v_fma_f32 v200, |v123|, v75, v200
    v_mfma_f32_16x16x32_f16 v[96:99], a[0:3], v[144:147], v[16:19]
    ds_read_b128 v[140:143], v246 offset:192
    ds_read_b128 v[136:139], v246 offset:128
    v_mfma_f32_16x16x32_f16 v[96:99], a[4:7], v[148:151], v[96:99]
    ds_read_b128 v[132:135], v246 offset:64
    ds_read_b128 v[128:131], v246 offset:0
    v_mfma_f32_16x16x32_f16 v[96:99], a[8:11], v[152:155], v[96:99]
    v_fma_f32 v186, |v124|, v76, v186
    v_fma_f32 v200, |v125|, v77, v200
    v_mfma_f32_16x16x32_f16 v[96:99], a[12:15], v[156:159], v[96:99]
    v_fma_f32 v186, |v126|, v78, v186
    v_fma_f32 v200, |v127|, v79, v200
    v_mfma_f32_16x16x32_f16 v[100:103], a[16:19], v[144:147], v[20:23]
    v_add_f32 v186, v186, v200
    v_pk_mul_f16 v161, v161, v81
    v_mfma_f32_16x16x32_f16 v[100:103], a[20:23], v[148:151], v[100:103]
    v_pk_mul_f16 v162, v162, v82
    v_pk_mul_f16 v163, v163, v83
    v_mfma_f32_16x16x32_f16 v[100:103], a[24:27], v[152:155], v[100:103]
    v_mul_f32 v187, |v96|, v48
    v_mul_f32 v201, |v97|, v49
    v_mfma_f32_16x16x32_f16 v[100:103], a[28:31], v[156:159], v[100:103]
    v_fma_f32 v187, |v98|, v50, v187
    v_fma_f32 v201, |v99|, v51, v201
    v_mfma_f32_16x16x32_f16 v[104:107], a[32:35], v[144:147], v[24:27]
    v_pk_mul_f16 v164, v164, v84
    v_pk_mul_f16 v165, v165, v85
    v_mfma_f32_16x16x32_f16 v[104:107], a[36:39], v[148:151], v[104:107]
    v_pk_mul_f16 v166, v166, v86
    v_pk_mul_f16 v167, v167, v87
    v_mfma_f32_16x16x32_f16 v[104:107], a[40:43], v[152:155], v[104:107]
    s_waitcnt lgkmcnt(0)
    v_pk_mul_f16 v128, v128, v80
    v_mfma_f32_16x16x32_f16 v[104:107], a[44:47], v[156:159], v[104:107]
    v_pk_mul_f16 v129, v129, v81
    v_pk_mul_f16 v130, v130, v82
    v_mfma_f32_16x16x32_f16 v[108:111], a[48:51], v[144:147], v[28:31]
    v_fma_f32 v187, |v100|, v52, v187
    v_fma_f32 v201, |v101|, v53, v201
    v_mfma_f32_16x16x32_f16 v[108:111], a[52:55], v[148:151], v[108:111]
    v_fma_f32 v187, |v102|, v54, v187
    v_fma_f32 v201, |v103|, v55, v201
    v_mfma_f32_16x16x32_f16 v[108:111], a[56:59], v[152:155], v[108:111]
    v_pk_mul_f16 v131, v131, v83
    v_pk_mul_f16 v132, v132, v84
    v_mfma_f32_16x16x32_f16 v[108:111], a[60:63], v[156:159], v[108:111]
    v_fma_f32 v187, |v104|, v56, v187
    v_fma_f32 v201, |v105|, v57, v201
    v_mfma_f32_16x16x32_f16 v[112:115], a[64:67], v[144:147], v[32:35]
    v_fma_f32 v187, |v106|, v58, v187
    v_fma_f32 v201, |v107|, v59, v201
    v_mfma_f32_16x16x32_f16 v[112:115], a[68:71], v[148:151], v[112:115]
    v_pk_mul_f16 v133, v133, v85
    v_pk_mul_f16 v134, v134, v86
    v_mfma_f32_16x16x32_f16 v[112:115], a[72:75], v[152:155], v[112:115]
    v_fma_f32 v187, |v108|, v60, v187
    v_fma_f32 v201, |v109|, v61, v201
    v_mfma_f32_16x16x32_f16 v[112:115], a[76:79], v[156:159], v[112:115]
    v_fma_f32 v187, |v110|, v62, v187
    v_fma_f32 v201, |v111|, v63, v201
    v_mfma_f32_16x16x32_f16 v[116:119], a[80:83], v[144:147], v[36:39]
    v_pk_mul_f16 v135, v135, v87
    v_pk_mul_f16 v136, v136, v88
    v_mfma_f32_16x16x32_f16 v[116:119], a[84:87], v[148:151], v[116:119]
    v_pk_mul_f16 v137, v137, v89
    v_pk_mul_f16 v138, v138, v90
    v_mfma_f32_16x16x32_f16 v[116:119], a[88:91], v[152:155], v[116:119]
    v_fma_f32 v187, |v112|, v64, v187
    v_fma_f32 v201, |v113|, v65, v201
    v_mfma_f32_16x16x32_f16 v[116:119], a[92:95], v[156:159], v[116:119]
    v_fma_f32 v187, |v114|, v66, v187
    v_fma_f32 v201, |v115|, v67, v201
    v_mfma_f32_16x16x32_f16 v[120:123], a[96:99], v[144:147], v[40:43]
    v_pk_mul_f16 v168, v168, v88
    v_pk_mul_f16 v169, v169, v89
    v_mfma_f32_16x16x32_f16 v[120:123], a[100:103], v[148:151], v[120:123]
    v_pk_mul_f16 v170, v170, v90
    v_pk_mul_f16 v171, v171, v91
    v_mfma_f32_16x16x32_f16 v[120:123], a[104:107], v[152:155], v[120:123]
    v_pk_mul_f16 v172, v172, v92
    v_pk_mul_f16 v173, v173, v93
    v_mfma_f32_16x16x32_f16 v[120:123], a[108:111], v[156:159], v[120:123]
    v_pk_mul_f16 v174, v174, v94
    v_pk_mul_f16 v175, v175, v95
    v_mfma_f32_16x16x32_f16 v[124:127], a[112:115], v[144:147], v[44:47]
    v_pk_mul_f16 v139, v139, v91
    v_fma_f32 v187, |v116|, v68, v187
    v_mfma_f32_16x16x32_f16 v[124:127], a[116:119], v[148:151], v[124:127]
    v_fma_f32 v201, |v117|, v69, v201
    v_fma_f32 v187, |v118|, v70, v187
    v_mfma_f32_16x16x32_f16 v[124:127], a[120:123], v[152:155], v[124:127]
    v_fma_f32 v201, |v119|, v71, v201
    v_pk_mul_f16 v140, v140, v92
    v_mfma_f32_16x16x32_f16 v[124:127], a[124:127], v[156:159], v[124:127]
    v_pk_mul_f16 v141, v141, v93
    v_fma_f32 v187, |v120|, v72, v187
    v_mfma_f32_16x16x32_f16 v[220:223], v[160:163], v[80:83], 0
    v_fma_f32 v201, |v121|, v73, v201
    v_fma_f32 v187, |v122|, v74, v187
    v_mfma_f32_16x16x32_f16 v[220:223], v[164:167], v[84:87], v[220:223]
    v_fma_f32 v201, |v123|, v75, v201
    v_pk_mul_f16 v142, v142, v94
    v_mfma_f32_16x16x32_f16 v[220:223], v[168:171], v[88:91], v[220:223]
    v_pk_mul_f16 v143, v143, v95
    v_fma_f32 v187, |v124|, v76, v187
    v_mfma_f32_16x16x32_f16 v[220:223], v[172:175], v[92:95], v[220:223]
    v_fma_f32 v201, |v125|, v77, v201
    v_fma_f32 v187, |v126|, v78, v187
    v_mfma_f32_16x16x32_f16 v[224:227], v[160:163], v[204:207], 0
    v_fma_f32 v201, |v127|, v79, v201
    v_mov_b32_dpp v246, v245 row_ror:10 row_mask:0xf bank_mask:0xf
    v_mfma_f32_16x16x32_f16 v[224:227], v[164:167], v[208:211], v[224:227]
    v_add_f32 v187, v187, v201
    v_mfma_f32_16x16x32_f16 v[224:227], v[168:171], v[212:215], v[224:227]
    ds_write_b128 v247, v[220:223] offset:4608
    v_mfma_f32_16x16x32_f16 v[224:227], v[172:175], v[216:219], v[224:227]
    v_mfma_f32_16x16x32_f16 v[96:99], a[0:3], v[128:131], v[16:19]
    ds_read_b128 v[156:159], v246 offset:192
    ds_read_b128 v[152:155], v246 offset:128
    v_mfma_f32_16x16x32_f16 v[96:99], a[4:7], v[132:135], v[96:99]
    ds_read_b128 v[148:151], v246 offset:64
    ds_read_b128 v[144:147], v246 offset:0
    v_mfma_f32_16x16x32_f16 v[96:99], a[8:11], v[136:139], v[96:99]
    s_nop 0
    ds_write_b128 v247, v[224:227] offset:6912
    ds_read_b128 v[172:175], v244 offset:9408
    v_mfma_f32_16x16x32_f16 v[96:99], a[12:15], v[140:143], v[96:99]
    ds_read_b128 v[168:171], v244 offset:9344
    ds_read_b128 v[164:167], v244 offset:9280
    v_mfma_f32_16x16x32_f16 v[100:103], a[16:19], v[128:131], v[20:23]
    ds_read_b128 v[160:163], v244 offset:9216
    v_mfma_f32_16x16x32_f16 v[100:103], a[20:23], v[132:135], v[100:103]
    v_mfma_f32_16x16x32_f16 v[100:103], a[24:27], v[136:139], v[100:103]
    s_nop 1
    v_mul_f32 v188, |v96|, v48
    v_mul_f32 v200, |v97|, v49
    v_mfma_f32_16x16x32_f16 v[100:103], a[28:31], v[140:143], v[100:103]
    v_fma_f32 v188, |v98|, v50, v188
    v_fma_f32 v200, |v99|, v51, v200
    v_mfma_f32_16x16x32_f16 v[104:107], a[32:35], v[128:131], v[24:27]
    v_mfma_f32_16x16x32_f16 v[104:107], a[36:39], v[132:135], v[104:107]
    v_mfma_f32_16x16x32_f16 v[104:107], a[40:43], v[136:139], v[104:107]
    s_waitcnt lgkmcnt(5)
    v_pk_mul_f16 v144, v144, v80
    v_mfma_f32_16x16x32_f16 v[104:107], a[44:47], v[140:143], v[104:107]
    v_pk_mul_f16 v145, v145, v81
    v_pk_mul_f16 v146, v146, v82
    v_mfma_f32_16x16x32_f16 v[108:111], a[48:51], v[128:131], v[28:31]
    v_pk_mul_f16 v147, v147, v83
    v_fma_f32 v188, |v100|, v52, v188
    v_mfma_f32_16x16x32_f16 v[108:111], a[52:55], v[132:135], v[108:111]
    v_fma_f32 v200, |v101|, v53, v200
    v_fma_f32 v188, |v102|, v54, v188
    v_mfma_f32_16x16x32_f16 v[108:111], a[56:59], v[136:139], v[108:111]
    v_fma_f32 v200, |v103|, v55, v200
    v_pk_mul_f16 v148, v148, v84
    v_mfma_f32_16x16x32_f16 v[108:111], a[60:63], v[140:143], v[108:111]
    v_pk_mul_f16 v149, v149, v85
    v_pk_mul_f16 v150, v150, v86
    v_mfma_f32_16x16x32_f16 v[112:115], a[64:67], v[128:131], v[32:35]
    v_fma_f32 v188, |v104|, v56, v188
    v_fma_f32 v200, |v105|, v57, v200
    v_mfma_f32_16x16x32_f16 v[112:115], a[68:71], v[132:135], v[112:115]
    v_fma_f32 v188, |v106|, v58, v188
    v_fma_f32 v200, |v107|, v59, v200
    v_mfma_f32_16x16x32_f16 v[112:115], a[72:75], v[136:139], v[112:115]
    v_pk_mul_f16 v151, v151, v87
    v_pk_mul_f16 v152, v152, v88
    v_mfma_f32_16x16x32_f16 v[112:115], a[76:79], v[140:143], v[112:115]
    v_pk_mul_f16 v153, v153, v89
    v_pk_mul_f16 v154, v154, v90
    v_mfma_f32_16x16x32_f16 v[116:119], a[80:83], v[128:131], v[36:39]
    v_fma_f32 v188, |v108|, v60, v188
    v_fma_f32 v200, |v109|, v61, v200
    v_mfma_f32_16x16x32_f16 v[116:119], a[84:87], v[132:135], v[116:119]
    v_fma_f32 v188, |v110|, v62, v188
    v_fma_f32 v200, |v111|, v63, v200
    v_mfma_f32_16x16x32_f16 v[116:119], a[88:91], v[136:139], v[116:119]
    v_pk_mul_f16 v155, v155, v91
    v_pk_mul_f16 v156, v156, v92
    v_mfma_f32_16x16x32_f16 v[116:119], a[92:95], v[140:143], v[116:119]
    v_pk_mul_f16 v157, v157, v93
    v_fma_f32 v188, |v112|, v64, v188
    v_mfma_f32_16x16x32_f16 v[120:123], a[96:99], v[128:131], v[40:43]
    v_fma_f32 v200, |v113|, v65, v200
    v_fma_f32 v188, |v114|, v66, v188
    v_mfma_f32_16x16x32_f16 v[120:123], a[100:103], v[132:135], v[120:123]
    v_fma_f32 v200, |v115|, v67, v200
    v_pk_mul_f16 v158, v158, v94
    v_mfma_f32_16x16x32_f16 v[120:123], a[104:107], v[136:139], v[120:123]
    v_pk_mul_f16 v159, v159, v95
    v_fma_f32 v188, |v116|, v68, v188
    v_mfma_f32_16x16x32_f16 v[120:123], a[108:111], v[140:143], v[120:123]
    v_fma_f32 v200, |v117|, v69, v200
    v_fma_f32 v188, |v118|, v70, v188
    v_mfma_f32_16x16x32_f16 v[124:127], a[112:115], v[128:131], v[44:47]
    v_fma_f32 v200, |v119|, v71, v200
    v_mov_b32_dpp v246, v245 row_ror:9 row_mask:0xf bank_mask:0xf
    v_mfma_f32_16x16x32_f16 v[124:127], a[116:119], v[132:135], v[124:127]
    s_waitcnt lgkmcnt(0)
    v_pk_mul_f16 v160, v160, v204
    v_mfma_f32_16x16x32_f16 v[124:127], a[120:123], v[136:139], v[124:127]
    v_fma_f32 v188, |v120|, v72, v188
    v_fma_f32 v200, |v121|, v73, v200
    v_mfma_f32_16x16x32_f16 v[124:127], a[124:127], v[140:143], v[124:127]
    v_fma_f32 v188, |v122|, v74, v188
    v_fma_f32 v200, |v123|, v75, v200
    v_mfma_f32_16x16x32_f16 v[96:99], a[0:3], v[144:147], v[16:19]
    ds_read_b128 v[140:143], v246 offset:192
    ds_read_b128 v[136:139], v246 offset:128
    v_mfma_f32_16x16x32_f16 v[96:99], a[4:7], v[148:151], v[96:99]
    ds_read_b128 v[132:135], v246 offset:64
    ds_read_b128 v[128:131], v246 offset:0
    v_mfma_f32_16x16x32_f16 v[96:99], a[8:11], v[152:155], v[96:99]
    v_fma_f32 v188, |v124|, v76, v188
    v_fma_f32 v200, |v125|, v77, v200
    v_mfma_f32_16x16x32_f16 v[96:99], a[12:15], v[156:159], v[96:99]
    v_fma_f32 v188, |v126|, v78, v188
    v_fma_f32 v200, |v127|, v79, v200
    v_mfma_f32_16x16x32_f16 v[100:103], a[16:19], v[144:147], v[20:23]
    v_add_f32 v188, v188, v200
    v_pk_mul_f16 v161, v161, v205
    v_mfma_f32_16x16x32_f16 v[100:103], a[20:23], v[148:151], v[100:103]
    v_pk_mul_f16 v162, v162, v206
    v_pk_mul_f16 v163, v163, v207
    v_mfma_f32_16x16x32_f16 v[100:103], a[24:27], v[152:155], v[100:103]
    v_mul_f32 v189, |v96|, v48
    v_mul_f32 v201, |v97|, v49
    v_mfma_f32_16x16x32_f16 v[100:103], a[28:31], v[156:159], v[100:103]
    v_fma_f32 v189, |v98|, v50, v189
    v_fma_f32 v201, |v99|, v51, v201
    v_mfma_f32_16x16x32_f16 v[104:107], a[32:35], v[144:147], v[24:27]
    v_pk_mul_f16 v164, v164, v208
    v_pk_mul_f16 v165, v165, v209
    v_mfma_f32_16x16x32_f16 v[104:107], a[36:39], v[148:151], v[104:107]
    v_pk_mul_f16 v166, v166, v210
    v_pk_mul_f16 v167, v167, v211
    v_mfma_f32_16x16x32_f16 v[104:107], a[40:43], v[152:155], v[104:107]
    s_waitcnt lgkmcnt(0)
    v_pk_mul_f16 v128, v128, v80
    v_mfma_f32_16x16x32_f16 v[104:107], a[44:47], v[156:159], v[104:107]
    v_pk_mul_f16 v129, v129, v81
    v_pk_mul_f16 v130, v130, v82
    v_mfma_f32_16x16x32_f16 v[108:111], a[48:51], v[144:147], v[28:31]
    v_fma_f32 v189, |v100|, v52, v189
    v_fma_f32 v201, |v101|, v53, v201
    v_mfma_f32_16x16x32_f16 v[108:111], a[52:55], v[148:151], v[108:111]
    v_fma_f32 v189, |v102|, v54, v189
    v_fma_f32 v201, |v103|, v55, v201
    v_mfma_f32_16x16x32_f16 v[108:111], a[56:59], v[152:155], v[108:111]
    v_pk_mul_f16 v131, v131, v83
    v_pk_mul_f16 v132, v132, v84
    v_mfma_f32_16x16x32_f16 v[108:111], a[60:63], v[156:159], v[108:111]
    v_pk_mul_f16 v133, v133, v85
    v_fma_f32 v189, |v104|, v56, v189
    v_mfma_f32_16x16x32_f16 v[112:115], a[64:67], v[144:147], v[32:35]
    v_fma_f32 v201, |v105|, v57, v201
    v_fma_f32 v189, |v106|, v58, v189
    v_mfma_f32_16x16x32_f16 v[112:115], a[68:71], v[148:151], v[112:115]
    v_fma_f32 v201, |v107|, v59, v201
    v_pk_mul_f16 v134, v134, v86
    v_mfma_f32_16x16x32_f16 v[112:115], a[72:75], v[152:155], v[112:115]
    v_pk_mul_f16 v135, v135, v87
    v_pk_mul_f16 v136, v136, v88
    v_mfma_f32_16x16x32_f16 v[112:115], a[76:79], v[156:159], v[112:115]
    v_fma_f32 v189, |v108|, v60, v189
    v_fma_f32 v201, |v109|, v61, v201
    v_mfma_f32_16x16x32_f16 v[116:119], a[80:83], v[144:147], v[36:39]
    v_fma_f32 v189, |v110|, v62, v189
    v_fma_f32 v201, |v111|, v63, v201
    v_mfma_f32_16x16x32_f16 v[116:119], a[84:87], v[148:151], v[116:119]
    v_pk_mul_f16 v137, v137, v89
    v_pk_mul_f16 v138, v138, v90
    v_mfma_f32_16x16x32_f16 v[116:119], a[88:91], v[152:155], v[116:119]
    v_fma_f32 v189, |v112|, v64, v189
    v_fma_f32 v201, |v113|, v65, v201
    v_mfma_f32_16x16x32_f16 v[116:119], a[92:95], v[156:159], v[116:119]
    v_fma_f32 v189, |v114|, v66, v189
    v_fma_f32 v201, |v115|, v67, v201
    v_mfma_f32_16x16x32_f16 v[120:123], a[96:99], v[144:147], v[40:43]
    v_pk_mul_f16 v139, v139, v91
    v_pk_mul_f16 v140, v140, v92
    v_mfma_f32_16x16x32_f16 v[120:123], a[100:103], v[148:151], v[120:123]
    v_pk_mul_f16 v168, v168, v212
    v_pk_mul_f16 v169, v169, v213
    v_mfma_f32_16x16x32_f16 v[120:123], a[104:107], v[152:155], v[120:123]
    v_pk_mul_f16 v170, v170, v214
    v_pk_mul_f16 v171, v171, v215
    v_mfma_f32_16x16x32_f16 v[120:123], a[108:111], v[156:159], v[120:123]
    v_pk_mul_f16 v172, v172, v216
    v_pk_mul_f16 v173, v173, v217
    v_mfma_f32_16x16x32_f16 v[124:127], a[112:115], v[144:147], v[44:47]
    v_pk_mul_f16 v174, v174, v218
    v_pk_mul_f16 v175, v175, v219
    v_mfma_f32_16x16x32_f16 v[124:127], a[116:119], v[148:151], v[124:127]
    v_pk_mul_f16 v141, v141, v93
    v_fma_f32 v189, |v116|, v68, v189
    v_mfma_f32_16x16x32_f16 v[124:127], a[120:123], v[152:155], v[124:127]
    v_fma_f32 v201, |v117|, v69, v201
    v_fma_f32 v189, |v118|, v70, v189
    v_mfma_f32_16x16x32_f16 v[124:127], a[124:127], v[156:159], v[124:127]
    v_fma_f32 v201, |v119|, v71, v201
    v_pk_mul_f16 v142, v142, v94
    v_mfma_f32_16x16x32_f16 v[228:231], v[160:163], v[204:207], 0
    v_pk_mul_f16 v143, v143, v95
    v_fma_f32 v189, |v120|, v72, v189
    v_mfma_f32_16x16x32_f16 v[228:231], v[164:167], v[208:211], v[228:231]
    v_fma_f32 v201, |v121|, v73, v201
    v_fma_f32 v189, |v122|, v74, v189
    v_mfma_f32_16x16x32_f16 v[228:231], v[168:171], v[212:215], v[228:231]
    v_fma_f32 v201, |v123|, v75, v201
    v_mov_b32_dpp v246, v245 row_ror:8 row_mask:0xf bank_mask:0xf
    v_mfma_f32_16x16x32_f16 v[228:231], v[172:175], v[216:219], v[228:231]
    v_fma_f32 v189, |v124|, v76, v189
    v_fma_f32 v201, |v125|, v77, v201
    v_mfma_f32_16x16x32_f16 v[96:99], a[0:3], v[128:131], v[16:19]
    ds_read_b128 v[156:159], v246 offset:192
    ds_read_b128 v[152:155], v246 offset:128
    v_mfma_f32_16x16x32_f16 v[96:99], a[4:7], v[132:135], v[96:99]
    ds_read_b128 v[148:151], v246 offset:64
    ds_read_b128 v[144:147], v246 offset:0
    v_mfma_f32_16x16x32_f16 v[96:99], a[8:11], v[136:139], v[96:99]
    v_fma_f32 v189, |v126|, v78, v189
    v_fma_f32 v201, |v127|, v79, v201
    v_mfma_f32_16x16x32_f16 v[96:99], a[12:15], v[140:143], v[96:99]
    v_add_f32 v189, v189, v201
    ds_write_b128 v247, v[228:231] offset:2368
    v_mfma_f32_16x16x32_f16 v[100:103], a[16:19], v[128:131], v[20:23]
    ds_read_b128 v[172:175], v244 offset:9696
    ds_read_b128 v[168:171], v244 offset:9632
    v_mfma_f32_16x16x32_f16 v[100:103], a[20:23], v[132:135], v[100:103]
    ds_read_b128 v[164:167], v244 offset:9568
    ds_read_b128 v[160:163], v244 offset:9504
    v_mfma_f32_16x16x32_f16 v[100:103], a[24:27], v[136:139], v[100:103]
    v_mul_f32 v190, |v96|, v48
    v_mul_f32 v200, |v97|, v49
    v_mfma_f32_16x16x32_f16 v[100:103], a[28:31], v[140:143], v[100:103]
    v_fma_f32 v190, |v98|, v50, v190
    v_fma_f32 v200, |v99|, v51, v200
    v_mfma_f32_16x16x32_f16 v[104:107], a[32:35], v[128:131], v[24:27]
    v_mfma_f32_16x16x32_f16 v[104:107], a[36:39], v[132:135], v[104:107]
    v_mfma_f32_16x16x32_f16 v[104:107], a[40:43], v[136:139], v[104:107]
    s_waitcnt lgkmcnt(5)
    v_pk_mul_f16 v144, v144, v80
    v_mfma_f32_16x16x32_f16 v[104:107], a[44:47], v[140:143], v[104:107]
    v_pk_mul_f16 v145, v145, v81
    v_pk_mul_f16 v146, v146, v82
    v_mfma_f32_16x16x32_f16 v[108:111], a[48:51], v[128:131], v[28:31]
    v_pk_mul_f16 v147, v147, v83
    v_fma_f32 v190, |v100|, v52, v190
    v_mfma_f32_16x16x32_f16 v[108:111], a[52:55], v[132:135], v[108:111]
    v_fma_f32 v200, |v101|, v53, v200
    v_fma_f32 v190, |v102|, v54, v190
    v_mfma_f32_16x16x32_f16 v[108:111], a[56:59], v[136:139], v[108:111]
    v_fma_f32 v200, |v103|, v55, v200
    v_pk_mul_f16 v148, v148, v84
    v_mfma_f32_16x16x32_f16 v[108:111], a[60:63], v[140:143], v[108:111]
    v_pk_mul_f16 v149, v149, v85
    v_pk_mul_f16 v150, v150, v86
    v_mfma_f32_16x16x32_f16 v[112:115], a[64:67], v[128:131], v[32:35]
    v_fma_f32 v190, |v104|, v56, v190
    v_fma_f32 v200, |v105|, v57, v200
    v_mfma_f32_16x16x32_f16 v[112:115], a[68:71], v[132:135], v[112:115]
    v_fma_f32 v190, |v106|, v58, v190
    v_fma_f32 v200, |v107|, v59, v200
    v_mfma_f32_16x16x32_f16 v[112:115], a[72:75], v[136:139], v[112:115]
    v_pk_mul_f16 v151, v151, v87
    v_pk_mul_f16 v152, v152, v88
    v_mfma_f32_16x16x32_f16 v[112:115], a[76:79], v[140:143], v[112:115]
    v_pk_mul_f16 v153, v153, v89
    v_pk_mul_f16 v154, v154, v90
    v_mfma_f32_16x16x32_f16 v[116:119], a[80:83], v[128:131], v[36:39]
    v_fma_f32 v190, |v108|, v60, v190
    v_fma_f32 v200, |v109|, v61, v200
    v_mfma_f32_16x16x32_f16 v[116:119], a[84:87], v[132:135], v[116:119]
    v_fma_f32 v190, |v110|, v62, v190
    v_fma_f32 v200, |v111|, v63, v200
    v_mfma_f32_16x16x32_f16 v[116:119], a[88:91], v[136:139], v[116:119]
    v_pk_mul_f16 v155, v155, v91
    v_pk_mul_f16 v156, v156, v92
    v_mfma_f32_16x16x32_f16 v[116:119], a[92:95], v[140:143], v[116:119]
    v_pk_mul_f16 v157, v157, v93
    v_fma_f32 v190, |v112|, v64, v190
    v_mfma_f32_16x16x32_f16 v[120:123], a[96:99], v[128:131], v[40:43]
    v_fma_f32 v200, |v113|, v65, v200
    v_fma_f32 v190, |v114|, v66, v190
    v_mfma_f32_16x16x32_f16 v[120:123], a[100:103], v[132:135], v[120:123]
    v_fma_f32 v200, |v115|, v67, v200
    v_pk_mul_f16 v158, v158, v94
    v_mfma_f32_16x16x32_f16 v[120:123], a[104:107], v[136:139], v[120:123]
    v_pk_mul_f16 v159, v159, v95
    v_fma_f32 v190, |v116|, v68, v190
    v_mfma_f32_16x16x32_f16 v[120:123], a[108:111], v[140:143], v[120:123]
    v_fma_f32 v200, |v117|, v69, v200
    v_fma_f32 v190, |v118|, v70, v190
    v_mfma_f32_16x16x32_f16 v[124:127], a[112:115], v[128:131], v[44:47]
    v_fma_f32 v200, |v119|, v71, v200
    v_mfma_f32_16x16x32_f16 v[124:127], a[116:119], v[132:135], v[124:127]
    s_waitcnt lgkmcnt(0)
    v_pk_mul_f16 v160, v160, v204
    v_mfma_f32_16x16x32_f16 v[124:127], a[120:123], v[136:139], v[124:127]
    v_fma_f32 v190, |v120|, v72, v190
    v_fma_f32 v200, |v121|, v73, v200
    v_mfma_f32_16x16x32_f16 v[124:127], a[124:127], v[140:143], v[124:127]
    v_fma_f32 v190, |v122|, v74, v190
    v_fma_f32 v200, |v123|, v75, v200
    v_mfma_f32_16x16x32_f16 v[96:99], a[0:3], v[144:147], v[16:19]
    ds_read_b128 v[140:143], v244 offset:4800
    ds_read_b128 v[136:139], v244 offset:4736
    v_mfma_f32_16x16x32_f16 v[96:99], a[4:7], v[148:151], v[96:99]
    ds_read_b128 v[132:135], v244 offset:4672
    ds_read_b128 v[128:131], v244 offset:4608
    v_mfma_f32_16x16x32_f16 v[96:99], a[8:11], v[152:155], v[96:99]
    v_fma_f32 v190, |v124|, v76, v190
    v_fma_f32 v200, |v125|, v77, v200
    v_mfma_f32_16x16x32_f16 v[96:99], a[12:15], v[156:159], v[96:99]
    v_fma_f32 v190, |v126|, v78, v190
    v_fma_f32 v200, |v127|, v79, v200
    v_mfma_f32_16x16x32_f16 v[100:103], a[16:19], v[144:147], v[20:23]
    v_add_f32 v190, v190, v200
    v_pk_mul_f16 v161, v161, v205
    v_mfma_f32_16x16x32_f16 v[100:103], a[20:23], v[148:151], v[100:103]
    v_pk_mul_f16 v162, v162, v206
    v_pk_mul_f16 v163, v163, v207
    v_mfma_f32_16x16x32_f16 v[100:103], a[24:27], v[152:155], v[100:103]
    v_mul_f32 v191, |v96|, v48
    v_mul_f32 v201, |v97|, v49
    v_mfma_f32_16x16x32_f16 v[100:103], a[28:31], v[156:159], v[100:103]
    v_fma_f32 v191, |v98|, v50, v191
    v_fma_f32 v201, |v99|, v51, v201
    v_mfma_f32_16x16x32_f16 v[104:107], a[32:35], v[144:147], v[24:27]
    v_pk_mul_f16 v164, v164, v208
    v_pk_mul_f16 v165, v165, v209
    v_mfma_f32_16x16x32_f16 v[104:107], a[36:39], v[148:151], v[104:107]
    v_pk_mul_f16 v166, v166, v210
    v_pk_mul_f16 v167, v167, v211
    v_mfma_f32_16x16x32_f16 v[104:107], a[40:43], v[152:155], v[104:107]
    s_waitcnt lgkmcnt(0)
    v_pk_mul_f16 v128, v128, v80
    v_mfma_f32_16x16x32_f16 v[104:107], a[44:47], v[156:159], v[104:107]
    v_pk_mul_f16 v129, v129, v81
    v_pk_mul_f16 v130, v130, v82
    v_mfma_f32_16x16x32_f16 v[108:111], a[48:51], v[144:147], v[28:31]
    v_fma_f32 v191, |v100|, v52, v191
    v_fma_f32 v201, |v101|, v53, v201
    v_mfma_f32_16x16x32_f16 v[108:111], a[52:55], v[148:151], v[108:111]
    v_fma_f32 v191, |v102|, v54, v191
    v_fma_f32 v201, |v103|, v55, v201
    v_mfma_f32_16x16x32_f16 v[108:111], a[56:59], v[152:155], v[108:111]
    v_pk_mul_f16 v131, v131, v83
    v_pk_mul_f16 v132, v132, v84
    v_mfma_f32_16x16x32_f16 v[108:111], a[60:63], v[156:159], v[108:111]
    v_pk_mul_f16 v133, v133, v85
    v_fma_f32 v191, |v104|, v56, v191
    v_mfma_f32_16x16x32_f16 v[112:115], a[64:67], v[144:147], v[32:35]
    v_fma_f32 v201, |v105|, v57, v201
    v_fma_f32 v191, |v106|, v58, v191
    v_mfma_f32_16x16x32_f16 v[112:115], a[68:71], v[148:151], v[112:115]
    v_fma_f32 v201, |v107|, v59, v201
    v_pk_mul_f16 v134, v134, v86
    v_mfma_f32_16x16x32_f16 v[112:115], a[72:75], v[152:155], v[112:115]
    v_pk_mul_f16 v135, v135, v87
    v_pk_mul_f16 v136, v136, v88
    v_mfma_f32_16x16x32_f16 v[112:115], a[76:79], v[156:159], v[112:115]
    v_fma_f32 v191, |v108|, v60, v191
    v_fma_f32 v201, |v109|, v61, v201
    v_mfma_f32_16x16x32_f16 v[116:119], a[80:83], v[144:147], v[36:39]
    v_fma_f32 v191, |v110|, v62, v191
    v_fma_f32 v201, |v111|, v63, v201
    v_mfma_f32_16x16x32_f16 v[116:119], a[84:87], v[148:151], v[116:119]
    v_pk_mul_f16 v137, v137, v89
    v_pk_mul_f16 v138, v138, v90
    v_mfma_f32_16x16x32_f16 v[116:119], a[88:91], v[152:155], v[116:119]
    v_fma_f32 v191, |v112|, v64, v191
    v_fma_f32 v201, |v113|, v65, v201
    v_mfma_f32_16x16x32_f16 v[116:119], a[92:95], v[156:159], v[116:119]
    v_fma_f32 v191, |v114|, v66, v191
    v_fma_f32 v201, |v115|, v67, v201
    v_mfma_f32_16x16x32_f16 v[120:123], a[96:99], v[144:147], v[40:43]
    v_pk_mul_f16 v139, v139, v91
    v_pk_mul_f16 v140, v140, v92
    v_mfma_f32_16x16x32_f16 v[120:123], a[100:103], v[148:151], v[120:123]
    v_pk_mul_f16 v168, v168, v212
    v_pk_mul_f16 v169, v169, v213
    v_mfma_f32_16x16x32_f16 v[120:123], a[104:107], v[152:155], v[120:123]
    v_pk_mul_f16 v170, v170, v214
    v_pk_mul_f16 v171, v171, v215
    v_mfma_f32_16x16x32_f16 v[120:123], a[108:111], v[156:159], v[120:123]
    v_pk_mul_f16 v172, v172, v216
    v_pk_mul_f16 v173, v173, v217
    v_mfma_f32_16x16x32_f16 v[124:127], a[112:115], v[144:147], v[44:47]
    v_pk_mul_f16 v174, v174, v218
    v_pk_mul_f16 v175, v175, v219
    v_mfma_f32_16x16x32_f16 v[124:127], a[116:119], v[148:151], v[124:127]
    v_pk_mul_f16 v141, v141, v93
    v_fma_f32 v191, |v116|, v68, v191
    v_mfma_f32_16x16x32_f16 v[124:127], a[120:123], v[152:155], v[124:127]
    v_fma_f32 v201, |v117|, v69, v201
    v_fma_f32 v191, |v118|, v70, v191
    v_mfma_f32_16x16x32_f16 v[124:127], a[124:127], v[156:159], v[124:127]
    v_fma_f32 v201, |v119|, v71, v201
    v_pk_mul_f16 v142, v142, v94
    v_mfma_f32_16x16x32_f16 v[228:231], v[160:163], v[204:207], 0
    v_pk_mul_f16 v143, v143, v95
    v_fma_f32 v191, |v120|, v72, v191
    v_mfma_f32_16x16x32_f16 v[228:231], v[164:167], v[208:211], v[228:231]
    v_fma_f32 v201, |v121|, v73, v201
    v_fma_f32 v191, |v122|, v74, v191
    v_mfma_f32_16x16x32_f16 v[228:231], v[168:171], v[212:215], v[228:231]
    v_fma_f32 v201, |v123|, v75, v201
    v_fma_f32 v191, |v124|, v76, v191
    v_mfma_f32_16x16x32_f16 v[228:231], v[172:175], v[216:219], v[228:231]
    v_fma_f32 v201, |v125|, v77, v201
    v_fma_f32 v191, |v126|, v78, v191
    v_mfma_f32_16x16x32_f16 v[96:99], a[0:3], v[128:131], v[16:19]
    ds_read_b128 v[156:159], v244 offset:5088
    ds_read_b128 v[152:155], v244 offset:5024
    v_mfma_f32_16x16x32_f16 v[96:99], a[4:7], v[132:135], v[96:99]
    ds_read_b128 v[148:151], v244 offset:4960
    ds_read_b128 v[144:147], v244 offset:4896
    v_mfma_f32_16x16x32_f16 v[96:99], a[8:11], v[136:139], v[96:99]
    v_fma_f32 v201, |v127|, v79, v201
    v_add_f32 v191, v191, v201
    v_mfma_f32_16x16x32_f16 v[96:99], a[12:15], v[140:143], v[96:99]
    ds_write_b128 v247, v[228:231] offset:6976
    v_mfma_f32_16x16x32_f16 v[100:103], a[16:19], v[128:131], v[20:23]
    v_mfma_f32_16x16x32_f16 v[100:103], a[20:23], v[132:135], v[100:103]
    v_mfma_f32_16x16x32_f16 v[100:103], a[24:27], v[136:139], v[100:103]
    s_nop 3
    v_mul_f32 v176, |v96|, v48
    v_mul_f32 v200, |v97|, v49
    v_mfma_f32_16x16x32_f16 v[100:103], a[28:31], v[140:143], v[100:103]
    v_fma_f32 v176, |v98|, v50, v176
    v_fma_f32 v200, |v99|, v51, v200
    v_mfma_f32_16x16x32_f16 v[104:107], a[32:35], v[128:131], v[24:27]
    v_mfma_f32_16x16x32_f16 v[104:107], a[36:39], v[132:135], v[104:107]
    v_mfma_f32_16x16x32_f16 v[104:107], a[40:43], v[136:139], v[104:107]
    s_waitcnt lgkmcnt(1)
    v_pk_mul_f16 v144, v144, v80
    v_mfma_f32_16x16x32_f16 v[104:107], a[44:47], v[140:143], v[104:107]
    v_pk_mul_f16 v145, v145, v81
    v_pk_mul_f16 v146, v146, v82
    v_mfma_f32_16x16x32_f16 v[108:111], a[48:51], v[128:131], v[28:31]
    v_pk_mul_f16 v147, v147, v83
    v_fma_f32 v176, |v100|, v52, v176
    v_mfma_f32_16x16x32_f16 v[108:111], a[52:55], v[132:135], v[108:111]
    v_fma_f32 v200, |v101|, v53, v200
    v_fma_f32 v176, |v102|, v54, v176
    v_mfma_f32_16x16x32_f16 v[108:111], a[56:59], v[136:139], v[108:111]
    v_fma_f32 v200, |v103|, v55, v200
    v_pk_mul_f16 v148, v148, v84
    v_mfma_f32_16x16x32_f16 v[108:111], a[60:63], v[140:143], v[108:111]
    v_pk_mul_f16 v149, v149, v85
    v_pk_mul_f16 v150, v150, v86
    v_mfma_f32_16x16x32_f16 v[112:115], a[64:67], v[128:131], v[32:35]
    v_fma_f32 v176, |v104|, v56, v176
    v_fma_f32 v200, |v105|, v57, v200
    v_mfma_f32_16x16x32_f16 v[112:115], a[68:71], v[132:135], v[112:115]
    v_fma_f32 v176, |v106|, v58, v176
    v_fma_f32 v200, |v107|, v59, v200
    v_mfma_f32_16x16x32_f16 v[112:115], a[72:75], v[136:139], v[112:115]
    v_pk_mul_f16 v151, v151, v87
    v_pk_mul_f16 v152, v152, v88
    v_mfma_f32_16x16x32_f16 v[112:115], a[76:79], v[140:143], v[112:115]
    v_pk_mul_f16 v153, v153, v89
    v_pk_mul_f16 v154, v154, v90
    v_mfma_f32_16x16x32_f16 v[116:119], a[80:83], v[128:131], v[36:39]
    v_fma_f32 v176, |v108|, v60, v176
    v_fma_f32 v200, |v109|, v61, v200
    v_mfma_f32_16x16x32_f16 v[116:119], a[84:87], v[132:135], v[116:119]
    v_fma_f32 v176, |v110|, v62, v176
    v_fma_f32 v200, |v111|, v63, v200
    v_mfma_f32_16x16x32_f16 v[116:119], a[88:91], v[136:139], v[116:119]
    v_pk_mul_f16 v155, v155, v91
    v_pk_mul_f16 v156, v156, v92
    v_mfma_f32_16x16x32_f16 v[116:119], a[92:95], v[140:143], v[116:119]
    v_pk_mul_f16 v157, v157, v93
    v_fma_f32 v176, |v112|, v64, v176
    v_mfma_f32_16x16x32_f16 v[120:123], a[96:99], v[128:131], v[40:43]
    v_fma_f32 v200, |v113|, v65, v200
    v_fma_f32 v176, |v114|, v66, v176
    v_mfma_f32_16x16x32_f16 v[120:123], a[100:103], v[132:135], v[120:123]
    v_fma_f32 v200, |v115|, v67, v200
    v_pk_mul_f16 v158, v158, v94
    v_mfma_f32_16x16x32_f16 v[120:123], a[104:107], v[136:139], v[120:123]
    v_pk_mul_f16 v159, v159, v95
    v_fma_f32 v176, |v116|, v68, v176
    v_mfma_f32_16x16x32_f16 v[120:123], a[108:111], v[140:143], v[120:123]
    v_fma_f32 v200, |v117|, v69, v200
    v_fma_f32 v176, |v118|, v70, v176
    v_mfma_f32_16x16x32_f16 v[124:127], a[112:115], v[128:131], v[44:47]
    v_fma_f32 v200, |v119|, v71, v200
    ds_read2st64_b32 v[220:221], v232 offset0:0 offset1:18
    v_mfma_f32_16x16x32_f16 v[124:127], a[116:119], v[132:135], v[124:127]
    ds_read2st64_b32 v[222:223], v233 offset0:0 offset1:18
    ds_read2st64_b32 v[224:225], v234 offset0:0 offset1:18
    v_mfma_f32_16x16x32_f16 v[124:127], a[120:123], v[136:139], v[124:127]
    v_fma_f32 v176, |v120|, v72, v176
    v_fma_f32 v200, |v121|, v73, v200
    v_mfma_f32_16x16x32_f16 v[124:127], a[124:127], v[140:143], v[124:127]
    v_fma_f32 v176, |v122|, v74, v176
    v_fma_f32 v200, |v123|, v75, v200
    v_mfma_f32_16x16x32_f16 v[96:99], a[0:3], v[144:147], v[16:19]
    ds_read_b128 v[140:143], v244 offset:5376
    ds_read_b128 v[136:139], v244 offset:5312
    v_mfma_f32_16x16x32_f16 v[96:99], a[4:7], v[148:151], v[96:99]
    ds_read_b128 v[132:135], v244 offset:5248
    ds_read_b128 v[128:131], v244 offset:5184
    v_mfma_f32_16x16x32_f16 v[96:99], a[8:11], v[152:155], v[96:99]
    v_fma_f32 v176, |v124|, v76, v176
    v_fma_f32 v200, |v125|, v77, v200
    v_mfma_f32_16x16x32_f16 v[96:99], a[12:15], v[156:159], v[96:99]
    v_fma_f32 v176, |v126|, v78, v176
    v_fma_f32 v200, |v127|, v79, v200
    v_mfma_f32_16x16x32_f16 v[100:103], a[16:19], v[144:147], v[20:23]
    v_add_f32 v176, v176, v200
    ds_read2st64_b32 v[226:227], v235 offset0:0 offset1:18
    v_mfma_f32_16x16x32_f16 v[100:103], a[20:23], v[148:151], v[100:103]
    ds_read2st64_b32 v[228:229], v236 offset0:0 offset1:18
    ds_read2st64_b32 v[230:231], v237 offset0:0 offset1:18
    v_mfma_f32_16x16x32_f16 v[100:103], a[24:27], v[152:155], v[100:103]
    v_mul_f32 v177, |v96|, v48
    v_mul_f32 v201, |v97|, v49
    v_mfma_f32_16x16x32_f16 v[100:103], a[28:31], v[156:159], v[100:103]
    v_fma_f32 v177, |v98|, v50, v177
    v_fma_f32 v201, |v99|, v51, v201
    v_mfma_f32_16x16x32_f16 v[104:107], a[32:35], v[144:147], v[24:27]
    v_mfma_f32_16x16x32_f16 v[104:107], a[36:39], v[148:151], v[104:107]
    v_mfma_f32_16x16x32_f16 v[104:107], a[40:43], v[152:155], v[104:107]
    s_waitcnt lgkmcnt(3)
    v_pk_mul_f16 v128, v128, v80
    v_mfma_f32_16x16x32_f16 v[104:107], a[44:47], v[156:159], v[104:107]
    v_pk_mul_f16 v129, v129, v81
    v_pk_mul_f16 v130, v130, v82
    v_mfma_f32_16x16x32_f16 v[108:111], a[48:51], v[144:147], v[28:31]
    v_pk_mul_f16 v131, v131, v83
    v_fma_f32 v177, |v100|, v52, v177
    v_mfma_f32_16x16x32_f16 v[108:111], a[52:55], v[148:151], v[108:111]
    v_fma_f32 v201, |v101|, v53, v201
    v_fma_f32 v177, |v102|, v54, v177
    v_mfma_f32_16x16x32_f16 v[108:111], a[56:59], v[152:155], v[108:111]
    v_fma_f32 v201, |v103|, v55, v201
    v_pk_mul_f16 v132, v132, v84
    v_mfma_f32_16x16x32_f16 v[108:111], a[60:63], v[156:159], v[108:111]
    v_pk_mul_f16 v133, v133, v85
    v_pk_mul_f16 v134, v134, v86
    v_mfma_f32_16x16x32_f16 v[112:115], a[64:67], v[144:147], v[32:35]
    v_fma_f32 v177, |v104|, v56, v177
    v_fma_f32 v201, |v105|, v57, v201
    v_mfma_f32_16x16x32_f16 v[112:115], a[68:71], v[148:151], v[112:115]
    v_fma_f32 v177, |v106|, v58, v177
    v_fma_f32 v201, |v107|, v59, v201
    v_mfma_f32_16x16x32_f16 v[112:115], a[72:75], v[152:155], v[112:115]
    v_pk_mul_f16 v135, v135, v87
    v_pk_mul_f16 v136, v136, v88
    v_mfma_f32_16x16x32_f16 v[112:115], a[76:79], v[156:159], v[112:115]
    v_pk_mul_f16 v137, v137, v89
    v_pk_mul_f16 v138, v138, v90
    v_mfma_f32_16x16x32_f16 v[116:119], a[80:83], v[144:147], v[36:39]
    v_fma_f32 v177, |v108|, v60, v177
    v_fma_f32 v201, |v109|, v61, v201
    v_mfma_f32_16x16x32_f16 v[116:119], a[84:87], v[148:151], v[116:119]
    v_fma_f32 v177, |v110|, v62, v177
    v_fma_f32 v201, |v111|, v63, v201
    v_mfma_f32_16x16x32_f16 v[116:119], a[88:91], v[152:155], v[116:119]
    v_pk_mul_f16 v139, v139, v91
    v_pk_mul_f16 v140, v140, v92
    v_mfma_f32_16x16x32_f16 v[116:119], a[92:95], v[156:159], v[116:119]
    v_pk_mul_f16 v141, v141, v93
    v_fma_f32 v177, |v112|, v64, v177
    v_mfma_f32_16x16x32_f16 v[120:123], a[96:99], v[144:147], v[40:43]
    v_fma_f32 v201, |v113|, v65, v201
    v_fma_f32 v177, |v114|, v66, v177
    v_mfma_f32_16x16x32_f16 v[120:123], a[100:103], v[148:151], v[120:123]
    v_fma_f32 v201, |v115|, v67, v201
    v_pk_mul_f16 v142, v142, v94
    v_mfma_f32_16x16x32_f16 v[120:123], a[104:107], v[152:155], v[120:123]
    v_pk_mul_f16 v143, v143, v95
    v_fma_f32 v177, |v116|, v68, v177
    v_mfma_f32_16x16x32_f16 v[120:123], a[108:111], v[156:159], v[120:123]
    v_fma_f32 v201, |v117|, v69, v201
    v_fma_f32 v177, |v118|, v70, v177
    v_mfma_f32_16x16x32_f16 v[124:127], a[112:115], v[144:147], v[44:47]
    v_fma_f32 v201, |v119|, v71, v201
    v_mov_b32 v251, 0xff800000
    v_mfma_f32_16x16x32_f16 v[124:127], a[116:119], v[148:151], v[124:127]
    v_permlane32_swap_b32 v184, v186
    v_mfma_f32_16x16x32_f16 v[124:127], a[120:123], v[152:155], v[124:127]
    v_fma_f32 v177, |v120|, v72, v177
    v_fma_f32 v201, |v121|, v73, v201
    v_mfma_f32_16x16x32_f16 v[124:127], a[124:127], v[156:159], v[124:127]
    v_fma_f32 v177, |v122|, v74, v177
    v_fma_f32 v201, |v123|, v75, v201
    v_mfma_f32_16x16x32_f16 v[96:99], a[0:3], v[128:131], v[16:19]
    ds_read_b128 v[156:159], v244 offset:5664
    ds_read_b128 v[152:155], v244 offset:5600
    v_mfma_f32_16x16x32_f16 v[96:99], a[4:7], v[132:135], v[96:99]
    ds_read_b128 v[148:151], v244 offset:5536
    ds_read_b128 v[144:147], v244 offset:5472
    v_mfma_f32_16x16x32_f16 v[96:99], a[8:11], v[136:139], v[96:99]
    v_fma_f32 v177, |v124|, v76, v177
    v_fma_f32 v201, |v125|, v77, v201
    v_mfma_f32_16x16x32_f16 v[96:99], a[12:15], v[140:143], v[96:99]
    v_fma_f32 v177, |v126|, v78, v177
    v_fma_f32 v201, |v127|, v79, v201
    v_mfma_f32_16x16x32_f16 v[100:103], a[16:19], v[128:131], v[20:23]
    v_add_f32 v177, v177, v201
    v_permlane32_swap_b32 v185, v187
    v_mfma_f32_16x16x32_f16 v[100:103], a[20:23], v[132:135], v[100:103]
    v_add_f32 v184, v184, v186
    v_add_f32 v185, v185, v187
    v_mfma_f32_16x16x32_f16 v[100:103], a[24:27], v[136:139], v[100:103]
    v_mul_f32 v178, |v96|, v48
    v_mul_f32 v200, |v97|, v49
    v_mfma_f32_16x16x32_f16 v[100:103], a[28:31], v[140:143], v[100:103]
    v_fma_f32 v178, |v98|, v50, v178
    v_fma_f32 v200, |v99|, v51, v200
    v_mfma_f32_16x16x32_f16 v[104:107], a[32:35], v[128:131], v[24:27]
    v_permlane16_swap_b32 v184, v185
    v_add_f32 v184, v184, v185
    v_mfma_f32_16x16x32_f16 v[104:107], a[36:39], v[132:135], v[104:107]
    v_fma_f32 v184, v224, s14, v184
    v_mov_b32 v248, v184
    v_mfma_f32_16x16x32_f16 v[104:107], a[40:43], v[136:139], v[104:107]
    s_waitcnt lgkmcnt(0)
    v_pk_mul_f16 v144, v144, v80
    v_mfma_f32_16x16x32_f16 v[104:107], a[44:47], v[140:143], v[104:107]
    v_pk_mul_f16 v145, v145, v81
    v_pk_mul_f16 v146, v146, v82
    v_mfma_f32_16x16x32_f16 v[108:111], a[48:51], v[128:131], v[28:31]
    v_pk_mul_f16 v147, v147, v83
    v_fma_f32 v178, |v100|, v52, v178
    v_mfma_f32_16x16x32_f16 v[108:111], a[52:55], v[132:135], v[108:111]
    v_fma_f32 v200, |v101|, v53, v200
    v_fma_f32 v178, |v102|, v54, v178
    v_mfma_f32_16x16x32_f16 v[108:111], a[56:59], v[136:139], v[108:111]
    v_fma_f32 v200, |v103|, v55, v200
    v_pk_mul_f16 v148, v148, v84
    v_mfma_f32_16x16x32_f16 v[108:111], a[60:63], v[140:143], v[108:111]
    v_pk_mul_f16 v149, v149, v85
    v_pk_mul_f16 v150, v150, v86
    v_mfma_f32_16x16x32_f16 v[112:115], a[64:67], v[128:131], v[32:35]
    v_fma_f32 v178, |v104|, v56, v178
    v_fma_f32 v200, |v105|, v57, v200
    v_mfma_f32_16x16x32_f16 v[112:115], a[68:71], v[132:135], v[112:115]
    v_fma_f32 v178, |v106|, v58, v178
    v_fma_f32 v200, |v107|, v59, v200
    v_mfma_f32_16x16x32_f16 v[112:115], a[72:75], v[136:139], v[112:115]
    v_pk_mul_f16 v151, v151, v87
    v_pk_mul_f16 v152, v152, v88
    v_mfma_f32_16x16x32_f16 v[112:115], a[76:79], v[140:143], v[112:115]
    v_pk_mul_f16 v153, v153, v89
    v_pk_mul_f16 v154, v154, v90
    v_mfma_f32_16x16x32_f16 v[116:119], a[80:83], v[128:131], v[36:39]
    v_fma_f32 v178, |v108|, v60, v178
    v_fma_f32 v200, |v109|, v61, v200
    v_mfma_f32_16x16x32_f16 v[116:119], a[84:87], v[132:135], v[116:119]
    v_fma_f32 v178, |v110|, v62, v178
    v_fma_f32 v200, |v111|, v63, v200
    v_mfma_f32_16x16x32_f16 v[116:119], a[88:91], v[136:139], v[116:119]
    v_pk_mul_f16 v155, v155, v91
    v_pk_mul_f16 v156, v156, v92
    v_mfma_f32_16x16x32_f16 v[116:119], a[92:95], v[140:143], v[116:119]
    v_pk_mul_f16 v157, v157, v93
    v_fma_f32 v178, |v112|, v64, v178
    v_mfma_f32_16x16x32_f16 v[120:123], a[96:99], v[128:131], v[40:43]
    v_fma_f32 v200, |v113|, v65, v200
    v_fma_f32 v178, |v114|, v66, v178
    v_mfma_f32_16x16x32_f16 v[120:123], a[100:103], v[132:135], v[120:123]
    v_fma_f32 v200, |v115|, v67, v200
    v_pk_mul_f16 v158, v158, v94
    v_mfma_f32_16x16x32_f16 v[120:123], a[104:107], v[136:139], v[120:123]
    v_pk_mul_f16 v159, v159, v95
    v_fma_f32 v178, |v116|, v68, v178
    v_mfma_f32_16x16x32_f16 v[120:123], a[108:111], v[140:143], v[120:123]
    v_fma_f32 v200, |v117|, v69, v200
    v_fma_f32 v178, |v118|, v70, v178
    v_mfma_f32_16x16x32_f16 v[124:127], a[112:115], v[128:131], v[44:47]
    v_fma_f32 v200, |v119|, v71, v200
    v_permlane32_swap_b32 v188, v190
    v_mfma_f32_16x16x32_f16 v[124:127], a[116:119], v[132:135], v[124:127]
    v_permlane32_swap_b32 v189, v191
    v_add_f32 v188, v188, v190
    v_mfma_f32_16x16x32_f16 v[124:127], a[120:123], v[136:139], v[124:127]
    v_fma_f32 v178, |v120|, v72, v178
    v_fma_f32 v200, |v121|, v73, v200
    v_mfma_f32_16x16x32_f16 v[124:127], a[124:127], v[140:143], v[124:127]
    v_fma_f32 v178, |v122|, v74, v178
    v_fma_f32 v200, |v123|, v75, v200
    v_mfma_f32_16x16x32_f16 v[96:99], a[0:3], v[144:147], v[16:19]
    ds_read_b128 v[140:143], v244 offset:5952
    ds_read_b128 v[136:139], v244 offset:5888
    v_mfma_f32_16x16x32_f16 v[96:99], a[4:7], v[148:151], v[96:99]
    ds_read_b128 v[132:135], v244 offset:5824
    ds_read_b128 v[128:131], v244 offset:5760
    v_mfma_f32_16x16x32_f16 v[96:99], a[8:11], v[152:155], v[96:99]
    v_fma_f32 v178, |v124|, v76, v178
    v_fma_f32 v200, |v125|, v77, v200
    v_mfma_f32_16x16x32_f16 v[96:99], a[12:15], v[156:159], v[96:99]
    v_fma_f32 v178, |v126|, v78, v178
    v_fma_f32 v200, |v127|, v79, v200
    v_mfma_f32_16x16x32_f16 v[100:103], a[16:19], v[144:147], v[20:23]
    v_add_f32 v178, v178, v200
    v_add_f32 v189, v189, v191
    v_mfma_f32_16x16x32_f16 v[100:103], a[20:23], v[148:151], v[100:103]
    s_nop 0
    v_permlane16_swap_b32 v188, v189
    v_add_f32 v188, v188, v189
    v_mfma_f32_16x16x32_f16 v[100:103], a[24:27], v[152:155], v[100:103]
    v_mul_f32 v179, |v96|, v48
    v_mul_f32 v201, |v97|, v49
    v_mfma_f32_16x16x32_f16 v[100:103], a[28:31], v[156:159], v[100:103]
    v_fma_f32 v179, |v98|, v50, v179
    v_fma_f32 v201, |v99|, v51, v201
    v_mfma_f32_16x16x32_f16 v[104:107], a[32:35], v[144:147], v[24:27]
    v_fma_f32 v188, v226, s14, v188
    v_cndmask_b32 v188, v251, v188, s[44:45]
    v_mfma_f32_16x16x32_f16 v[104:107], a[36:39], v[148:151], v[104:107]
    v_max_f32 v248, v248, v188
    v_mfma_f32_16x16x32_f16 v[104:107], a[40:43], v[152:155], v[104:107]
    s_waitcnt lgkmcnt(0)
    v_pk_mul_f16 v128, v128, v80
    v_mfma_f32_16x16x32_f16 v[104:107], a[44:47], v[156:159], v[104:107]
    v_pk_mul_f16 v129, v129, v81
    v_pk_mul_f16 v130, v130, v82
    v_mfma_f32_16x16x32_f16 v[108:111], a[48:51], v[144:147], v[28:31]
    v_pk_mul_f16 v131, v131, v83
    v_fma_f32 v179, |v100|, v52, v179
    v_mfma_f32_16x16x32_f16 v[108:111], a[52:55], v[148:151], v[108:111]
    v_fma_f32 v201, |v101|, v53, v201
    v_fma_f32 v179, |v102|, v54, v179
    v_mfma_f32_16x16x32_f16 v[108:111], a[56:59], v[152:155], v[108:111]
    v_fma_f32 v201, |v103|, v55, v201
    v_pk_mul_f16 v132, v132, v84
    v_mfma_f32_16x16x32_f16 v[108:111], a[60:63], v[156:159], v[108:111]
    v_pk_mul_f16 v133, v133, v85
    v_pk_mul_f16 v134, v134, v86
    v_mfma_f32_16x16x32_f16 v[112:115], a[64:67], v[144:147], v[32:35]
    v_fma_f32 v179, |v104|, v56, v179
    v_fma_f32 v201, |v105|, v57, v201
    v_mfma_f32_16x16x32_f16 v[112:115], a[68:71], v[148:151], v[112:115]
    v_fma_f32 v179, |v106|, v58, v179
    v_fma_f32 v201, |v107|, v59, v201
    v_mfma_f32_16x16x32_f16 v[112:115], a[72:75], v[152:155], v[112:115]
    v_pk_mul_f16 v135, v135, v87
    v_pk_mul_f16 v136, v136, v88
    v_mfma_f32_16x16x32_f16 v[112:115], a[76:79], v[156:159], v[112:115]
    v_pk_mul_f16 v137, v137, v89
    v_pk_mul_f16 v138, v138, v90
    v_mfma_f32_16x16x32_f16 v[116:119], a[80:83], v[144:147], v[36:39]
    v_fma_f32 v179, |v108|, v60, v179
    v_fma_f32 v201, |v109|, v61, v201
    v_mfma_f32_16x16x32_f16 v[116:119], a[84:87], v[148:151], v[116:119]
    v_fma_f32 v179, |v110|, v62, v179
    v_fma_f32 v201, |v111|, v63, v201
    v_mfma_f32_16x16x32_f16 v[116:119], a[88:91], v[152:155], v[116:119]
    v_pk_mul_f16 v139, v139, v91
    v_pk_mul_f16 v140, v140, v92
    v_mfma_f32_16x16x32_f16 v[116:119], a[92:95], v[156:159], v[116:119]
    v_pk_mul_f16 v141, v141, v93
    v_fma_f32 v179, |v112|, v64, v179
    v_mfma_f32_16x16x32_f16 v[120:123], a[96:99], v[144:147], v[40:43]
    v_fma_f32 v201, |v113|, v65, v201
    v_fma_f32 v179, |v114|, v66, v179
    v_mfma_f32_16x16x32_f16 v[120:123], a[100:103], v[148:151], v[120:123]
    v_fma_f32 v201, |v115|, v67, v201
    v_pk_mul_f16 v142, v142, v94
    v_mfma_f32_16x16x32_f16 v[120:123], a[104:107], v[152:155], v[120:123]
    v_pk_mul_f16 v143, v143, v95
    v_fma_f32 v179, |v116|, v68, v179
    v_mfma_f32_16x16x32_f16 v[120:123], a[108:111], v[156:159], v[120:123]
    v_fma_f32 v201, |v117|, v69, v201
    v_fma_f32 v179, |v118|, v70, v179
    v_mfma_f32_16x16x32_f16 v[124:127], a[112:115], v[144:147], v[44:47]
    v_fma_f32 v201, |v119|, v71, v201
    v_mfma_f32_16x16x32_f16 v[124:127], a[116:119], v[148:151], v[124:127]
    v_mfma_f32_16x16x32_f16 v[124:127], a[120:123], v[152:155], v[124:127]
    s_nop 1
    v_fma_f32 v179, |v120|, v72, v179
    v_fma_f32 v201, |v121|, v73, v201
    v_mfma_f32_16x16x32_f16 v[124:127], a[124:127], v[156:159], v[124:127]
    v_fma_f32 v179, |v122|, v74, v179
    v_fma_f32 v201, |v123|, v75, v201
    v_mfma_f32_16x16x32_f16 v[96:99], a[0:3], v[128:131], v[16:19]
    ds_read_b128 v[156:159], v244 offset:6240
    ds_read_b128 v[152:155], v244 offset:6176
    v_mfma_f32_16x16x32_f16 v[96:99], a[4:7], v[132:135], v[96:99]
    ds_read_b128 v[148:151], v244 offset:6112
    ds_read_b128 v[144:147], v244 offset:6048
    v_mfma_f32_16x16x32_f16 v[96:99], a[8:11], v[136:139], v[96:99]
    v_fma_f32 v179, |v124|, v76, v179
    v_fma_f32 v201, |v125|, v77, v201
    v_mfma_f32_16x16x32_f16 v[96:99], a[12:15], v[140:143], v[96:99]
    v_fma_f32 v179, |v126|, v78, v179
    v_fma_f32 v201, |v127|, v79, v201
    v_mfma_f32_16x16x32_f16 v[100:103], a[16:19], v[128:131], v[20:23]
    v_add_f32 v179, v179, v201
    v_mfma_f32_16x16x32_f16 v[100:103], a[20:23], v[132:135], v[100:103]
    v_mfma_f32_16x16x32_f16 v[100:103], a[24:27], v[136:139], v[100:103]
    s_nop 1
    v_mul_f32 v180, |v96|, v48
    v_mul_f32 v200, |v97|, v49
    v_mfma_f32_16x16x32_f16 v[100:103], a[28:31], v[140:143], v[100:103]
    v_fma_f32 v180, |v98|, v50, v180
    v_fma_f32 v200, |v99|, v51, v200
    v_mfma_f32_16x16x32_f16 v[104:107], a[32:35], v[128:131], v[24:27]
    v_mfma_f32_16x16x32_f16 v[104:107], a[36:39], v[132:135], v[104:107]
    v_mfma_f32_16x16x32_f16 v[104:107], a[40:43], v[136:139], v[104:107]
    s_waitcnt lgkmcnt(0)
    v_pk_mul_f16 v144, v144, v80
    v_mfma_f32_16x16x32_f16 v[104:107], a[44:47], v[140:143], v[104:107]
    v_pk_mul_f16 v145, v145, v81
    v_pk_mul_f16 v146, v146, v82
    v_mfma_f32_16x16x32_f16 v[108:111], a[48:51], v[128:131], v[28:31]
    v_pk_mul_f16 v147, v147, v83
    v_fma_f32 v180, |v100|, v52, v180
    v_mfma_f32_16x16x32_f16 v[108:111], a[52:55], v[132:135], v[108:111]
    v_fma_f32 v200, |v101|, v53, v200
    v_fma_f32 v180, |v102|, v54, v180
    v_mfma_f32_16x16x32_f16 v[108:111], a[56:59], v[136:139], v[108:111]
    v_fma_f32 v200, |v103|, v55, v200
    v_pk_mul_f16 v148, v148, v84
    v_mfma_f32_16x16x32_f16 v[108:111], a[60:63], v[140:143], v[108:111]
    v_pk_mul_f16 v149, v149, v85
    v_pk_mul_f16 v150, v150, v86
    v_mfma_f32_16x16x32_f16 v[112:115], a[64:67], v[128:131], v[32:35]
    v_fma_f32 v180, |v104|, v56, v180
    v_fma_f32 v200, |v105|, v57, v200
    v_mfma_f32_16x16x32_f16 v[112:115], a[68:71], v[132:135], v[112:115]
    v_fma_f32 v180, |v106|, v58, v180
    v_fma_f32 v200, |v107|, v59, v200
    v_mfma_f32_16x16x32_f16 v[112:115], a[72:75], v[136:139], v[112:115]
    v_pk_mul_f16 v151, v151, v87
    v_pk_mul_f16 v152, v152, v88
    v_mfma_f32_16x16x32_f16 v[112:115], a[76:79], v[140:143], v[112:115]
    v_pk_mul_f16 v153, v153, v89
    v_pk_mul_f16 v154, v154, v90
    v_mfma_f32_16x16x32_f16 v[116:119], a[80:83], v[128:131], v[36:39]
    v_fma_f32 v180, |v108|, v60, v180
    v_fma_f32 v200, |v109|, v61, v200
    v_mfma_f32_16x16x32_f16 v[116:119], a[84:87], v[132:135], v[116:119]
    v_fma_f32 v180, |v110|, v62, v180
    v_fma_f32 v200, |v111|, v63, v200
    v_mfma_f32_16x16x32_f16 v[116:119], a[88:91], v[136:139], v[116:119]
    v_pk_mul_f16 v155, v155, v91
    v_pk_mul_f16 v156, v156, v92
    v_mfma_f32_16x16x32_f16 v[116:119], a[92:95], v[140:143], v[116:119]
    v_pk_mul_f16 v157, v157, v93
    v_fma_f32 v180, |v112|, v64, v180
    v_mfma_f32_16x16x32_f16 v[120:123], a[96:99], v[128:131], v[40:43]
    v_fma_f32 v200, |v113|, v65, v200
    v_fma_f32 v180, |v114|, v66, v180
    v_mfma_f32_16x16x32_f16 v[120:123], a[100:103], v[132:135], v[120:123]
    v_fma_f32 v200, |v115|, v67, v200
    v_pk_mul_f16 v158, v158, v94
    v_mfma_f32_16x16x32_f16 v[120:123], a[104:107], v[136:139], v[120:123]
    v_pk_mul_f16 v159, v159, v95
    v_fma_f32 v180, |v116|, v68, v180
    v_mfma_f32_16x16x32_f16 v[120:123], a[108:111], v[140:143], v[120:123]
    v_fma_f32 v200, |v117|, v69, v200
    v_fma_f32 v180, |v118|, v70, v180
    v_mfma_f32_16x16x32_f16 v[124:127], a[112:115], v[128:131], v[44:47]
    v_fma_f32 v200, |v119|, v71, v200
    v_permlane32_swap_b32 v176, v178
    v_mfma_f32_16x16x32_f16 v[124:127], a[116:119], v[132:135], v[124:127]
    v_permlane32_swap_b32 v177, v179
    v_add_f32 v176, v176, v178
    v_mfma_f32_16x16x32_f16 v[124:127], a[120:123], v[136:139], v[124:127]
    v_fma_f32 v180, |v120|, v72, v180
    v_fma_f32 v200, |v121|, v73, v200
    v_mfma_f32_16x16x32_f16 v[124:127], a[124:127], v[140:143], v[124:127]
    v_fma_f32 v180, |v122|, v74, v180
    v_fma_f32 v200, |v123|, v75, v200
    v_mfma_f32_16x16x32_f16 v[96:99], a[0:3], v[144:147], v[16:19]
    ds_read_b128 v[140:143], v244 offset:6528
    ds_read_b128 v[136:139], v244 offset:6464
    v_mfma_f32_16x16x32_f16 v[96:99], a[4:7], v[148:151], v[96:99]
    ds_read_b128 v[132:135], v244 offset:6400
    ds_read_b128 v[128:131], v244 offset:6336
    v_mfma_f32_16x16x32_f16 v[96:99], a[8:11], v[152:155], v[96:99]
    v_fma_f32 v180, |v124|, v76, v180
    v_fma_f32 v200, |v125|, v77, v200
    v_mfma_f32_16x16x32_f16 v[96:99], a[12:15], v[156:159], v[96:99]
    v_fma_f32 v180, |v126|, v78, v180
    v_fma_f32 v200, |v127|, v79, v200
    v_mfma_f32_16x16x32_f16 v[100:103], a[16:19], v[144:147], v[20:23]
    v_add_f32 v180, v180, v200
    v_add_f32 v177, v177, v179
    v_mfma_f32_16x16x32_f16 v[100:103], a[20:23], v[148:151], v[100:103]
    s_nop 0
    v_permlane16_swap_b32 v176, v177
    v_add_f32 v176, v176, v177
    v_mfma_f32_16x16x32_f16 v[100:103], a[24:27], v[152:155], v[100:103]
    v_mul_f32 v181, |v96|, v48
    v_mul_f32 v201, |v97|, v49
    v_mfma_f32_16x16x32_f16 v[100:103], a[28:31], v[156:159], v[100:103]
    v_fma_f32 v181, |v98|, v50, v181
    v_fma_f32 v201, |v99|, v51, v201
    v_mfma_f32_16x16x32_f16 v[104:107], a[32:35], v[144:147], v[24:27]
    v_fma_f32 v176, v220, s14, v176
    v_max_f32 v248, v248, v176
    v_mfma_f32_16x16x32_f16 v[104:107], a[36:39], v[148:151], v[104:107]
    v_mfma_f32_16x16x32_f16 v[104:107], a[40:43], v[152:155], v[104:107]
    s_waitcnt lgkmcnt(0)
    v_pk_mul_f16 v128, v128, v80
    v_mfma_f32_16x16x32_f16 v[104:107], a[44:47], v[156:159], v[104:107]
    v_pk_mul_f16 v129, v129, v81
    v_pk_mul_f16 v130, v130, v82
    v_mfma_f32_16x16x32_f16 v[108:111], a[48:51], v[144:147], v[28:31]
    v_pk_mul_f16 v131, v131, v83
    v_fma_f32 v181, |v100|, v52, v181
    v_mfma_f32_16x16x32_f16 v[108:111], a[52:55], v[148:151], v[108:111]
    v_fma_f32 v201, |v101|, v53, v201
    v_fma_f32 v181, |v102|, v54, v181
    v_mfma_f32_16x16x32_f16 v[108:111], a[56:59], v[152:155], v[108:111]
    v_fma_f32 v201, |v103|, v55, v201
    v_pk_mul_f16 v132, v132, v84
    v_mfma_f32_16x16x32_f16 v[108:111], a[60:63], v[156:159], v[108:111]
    v_pk_mul_f16 v133, v133, v85
    v_pk_mul_f16 v134, v134, v86
    v_mfma_f32_16x16x32_f16 v[112:115], a[64:67], v[144:147], v[32:35]
    v_fma_f32 v181, |v104|, v56, v181
    v_fma_f32 v201, |v105|, v57, v201
    v_mfma_f32_16x16x32_f16 v[112:115], a[68:71], v[148:151], v[112:115]
    v_fma_f32 v181, |v106|, v58, v181
    v_fma_f32 v201, |v107|, v59, v201
    v_mfma_f32_16x16x32_f16 v[112:115], a[72:75], v[152:155], v[112:115]
    v_pk_mul_f16 v135, v135, v87
    v_pk_mul_f16 v136, v136, v88
    v_mfma_f32_16x16x32_f16 v[112:115], a[76:79], v[156:159], v[112:115]
    v_pk_mul_f16 v137, v137, v89
    v_pk_mul_f16 v138, v138, v90
    v_mfma_f32_16x16x32_f16 v[116:119], a[80:83], v[144:147], v[36:39]
    v_fma_f32 v181, |v108|, v60, v181
    v_fma_f32 v201, |v109|, v61, v201
    v_mfma_f32_16x16x32_f16 v[116:119], a[84:87], v[148:151], v[116:119]
    v_fma_f32 v181, |v110|, v62, v181
    v_fma_f32 v201, |v111|, v63, v201
    v_mfma_f32_16x16x32_f16 v[116:119], a[88:91], v[152:155], v[116:119]
    v_pk_mul_f16 v139, v139, v91
    v_pk_mul_f16 v140, v140, v92
    v_mfma_f32_16x16x32_f16 v[116:119], a[92:95], v[156:159], v[116:119]
    v_pk_mul_f16 v141, v141, v93
    v_fma_f32 v181, |v112|, v64, v181
    v_mfma_f32_16x16x32_f16 v[120:123], a[96:99], v[144:147], v[40:43]
    v_fma_f32 v201, |v113|, v65, v201
    v_fma_f32 v181, |v114|, v66, v181
    v_mfma_f32_16x16x32_f16 v[120:123], a[100:103], v[148:151], v[120:123]
    v_fma_f32 v201, |v115|, v67, v201
    v_pk_mul_f16 v142, v142, v94
    v_mfma_f32_16x16x32_f16 v[120:123], a[104:107], v[152:155], v[120:123]
    v_pk_mul_f16 v143, v143, v95
    v_fma_f32 v181, |v116|, v68, v181
    v_mfma_f32_16x16x32_f16 v[120:123], a[108:111], v[156:159], v[120:123]
    v_fma_f32 v201, |v117|, v69, v201
    v_fma_f32 v181, |v118|, v70, v181
    v_mfma_f32_16x16x32_f16 v[124:127], a[112:115], v[144:147], v[44:47]
    v_fma_f32 v201, |v119|, v71, v201
    v_mfma_f32_16x16x32_f16 v[124:127], a[116:119], v[148:151], v[124:127]
    v_mfma_f32_16x16x32_f16 v[124:127], a[120:123], v[152:155], v[124:127]
    s_nop 1
    v_fma_f32 v181, |v120|, v72, v181
    v_fma_f32 v201, |v121|, v73, v201
    v_mfma_f32_16x16x32_f16 v[124:127], a[124:127], v[156:159], v[124:127]
    v_fma_f32 v181, |v122|, v74, v181
    v_fma_f32 v201, |v123|, v75, v201
    v_mfma_f32_16x16x32_f16 v[96:99], a[0:3], v[128:131], v[16:19]
    ds_read_b128 v[156:159], v244 offset:6816
    ds_read_b128 v[152:155], v244 offset:6752
    v_mfma_f32_16x16x32_f16 v[96:99], a[4:7], v[132:135], v[96:99]
    ds_read_b128 v[148:151], v244 offset:6688
    ds_read_b128 v[144:147], v244 offset:6624
    v_mfma_f32_16x16x32_f16 v[96:99], a[8:11], v[136:139], v[96:99]
    v_fma_f32 v181, |v124|, v76, v181
    v_fma_f32 v201, |v125|, v77, v201
    v_mfma_f32_16x16x32_f16 v[96:99], a[12:15], v[140:143], v[96:99]
    v_fma_f32 v181, |v126|, v78, v181
    v_fma_f32 v201, |v127|, v79, v201
    v_mfma_f32_16x16x32_f16 v[100:103], a[16:19], v[128:131], v[20:23]
    v_add_f32 v181, v181, v201
    v_mfma_f32_16x16x32_f16 v[100:103], a[20:23], v[132:135], v[100:103]
    v_mfma_f32_16x16x32_f16 v[100:103], a[24:27], v[136:139], v[100:103]
    s_nop 1
    v_mul_f32 v182, |v96|, v48
    v_mul_f32 v200, |v97|, v49
    v_mfma_f32_16x16x32_f16 v[100:103], a[28:31], v[140:143], v[100:103]
    v_fma_f32 v182, |v98|, v50, v182
    v_fma_f32 v200, |v99|, v51, v200
    v_mfma_f32_16x16x32_f16 v[104:107], a[32:35], v[128:131], v[24:27]
    v_mfma_f32_16x16x32_f16 v[104:107], a[36:39], v[132:135], v[104:107]
    v_mfma_f32_16x16x32_f16 v[104:107], a[40:43], v[136:139], v[104:107]
    s_waitcnt lgkmcnt(0)
    v_pk_mul_f16 v144, v144, v80
    v_mfma_f32_16x16x32_f16 v[104:107], a[44:47], v[140:143], v[104:107]
    v_pk_mul_f16 v145, v145, v81
    v_pk_mul_f16 v146, v146, v82
    v_mfma_f32_16x16x32_f16 v[108:111], a[48:51], v[128:131], v[28:31]
    v_pk_mul_f16 v147, v147, v83
    v_fma_f32 v182, |v100|, v52, v182
    v_mfma_f32_16x16x32_f16 v[108:111], a[52:55], v[132:135], v[108:111]
    v_fma_f32 v200, |v101|, v53, v200
    v_fma_f32 v182, |v102|, v54, v182
    v_mfma_f32_16x16x32_f16 v[108:111], a[56:59], v[136:139], v[108:111]
    v_fma_f32 v200, |v103|, v55, v200
    v_pk_mul_f16 v148, v148, v84
    v_mfma_f32_16x16x32_f16 v[108:111], a[60:63], v[140:143], v[108:111]
    v_pk_mul_f16 v149, v149, v85
    v_pk_mul_f16 v150, v150, v86
    v_mfma_f32_16x16x32_f16 v[112:115], a[64:67], v[128:131], v[32:35]
    v_fma_f32 v182, |v104|, v56, v182
    v_fma_f32 v200, |v105|, v57, v200
    v_mfma_f32_16x16x32_f16 v[112:115], a[68:71], v[132:135], v[112:115]
    v_fma_f32 v182, |v106|, v58, v182
    v_fma_f32 v200, |v107|, v59, v200
    v_mfma_f32_16x16x32_f16 v[112:115], a[72:75], v[136:139], v[112:115]
    v_pk_mul_f16 v151, v151, v87
    v_pk_mul_f16 v152, v152, v88
    v_mfma_f32_16x16x32_f16 v[112:115], a[76:79], v[140:143], v[112:115]
    v_pk_mul_f16 v153, v153, v89
    v_pk_mul_f16 v154, v154, v90
    v_mfma_f32_16x16x32_f16 v[116:119], a[80:83], v[128:131], v[36:39]
    v_fma_f32 v182, |v108|, v60, v182
    v_fma_f32 v200, |v109|, v61, v200
    v_mfma_f32_16x16x32_f16 v[116:119], a[84:87], v[132:135], v[116:119]
    v_fma_f32 v182, |v110|, v62, v182
    v_fma_f32 v200, |v111|, v63, v200
    v_mfma_f32_16x16x32_f16 v[116:119], a[88:91], v[136:139], v[116:119]
    v_pk_mul_f16 v155, v155, v91
    v_pk_mul_f16 v156, v156, v92
    v_mfma_f32_16x16x32_f16 v[116:119], a[92:95], v[140:143], v[116:119]
    v_pk_mul_f16 v157, v157, v93
    v_fma_f32 v182, |v112|, v64, v182
    v_mfma_f32_16x16x32_f16 v[120:123], a[96:99], v[128:131], v[40:43]
    v_fma_f32 v200, |v113|, v65, v200
    v_fma_f32 v182, |v114|, v66, v182
    v_mfma_f32_16x16x32_f16 v[120:123], a[100:103], v[132:135], v[120:123]
    v_fma_f32 v200, |v115|, v67, v200
    v_pk_mul_f16 v158, v158, v94
    v_mfma_f32_16x16x32_f16 v[120:123], a[104:107], v[136:139], v[120:123]
    v_pk_mul_f16 v159, v159, v95
    v_fma_f32 v182, |v116|, v68, v182
    v_mfma_f32_16x16x32_f16 v[120:123], a[108:111], v[140:143], v[120:123]
    v_fma_f32 v200, |v117|, v69, v200
    v_fma_f32 v182, |v118|, v70, v182
    v_mfma_f32_16x16x32_f16 v[124:127], a[112:115], v[128:131], v[44:47]
    v_fma_f32 v200, |v119|, v71, v200
    v_mfma_f32_16x16x32_f16 v[124:127], a[116:119], v[132:135], v[124:127]
    v_mfma_f32_16x16x32_f16 v[124:127], a[120:123], v[136:139], v[124:127]
    s_nop 1
    v_fma_f32 v182, |v120|, v72, v182
    v_fma_f32 v200, |v121|, v73, v200
    v_mfma_f32_16x16x32_f16 v[124:127], a[124:127], v[140:143], v[124:127]
    v_fma_f32 v182, |v122|, v74, v182
    v_fma_f32 v200, |v123|, v75, v200
    v_mfma_f32_16x16x32_f16 v[96:99], a[0:3], v[144:147], v[16:19]
    ds_read_b128 v[216:219], v238 offset:4800
    ds_read_b128 v[212:215], v238 offset:4736
    v_mfma_f32_16x16x32_f16 v[96:99], a[4:7], v[148:151], v[96:99]
    ds_read_b128 v[208:211], v238 offset:4672
    ds_read_b128 v[204:207], v238 offset:4608
    v_mfma_f32_16x16x32_f16 v[96:99], a[8:11], v[152:155], v[96:99]
    ds_read_b128 v[140:143], v239 offset:4800
    ds_read_b128 v[136:139], v239 offset:4736
    v_mfma_f32_16x16x32_f16 v[96:99], a[12:15], v[156:159], v[96:99]
    ds_read_b128 v[132:135], v239 offset:4672
    ds_read_b128 v[128:131], v239 offset:4608
    v_mfma_f32_16x16x32_f16 v[100:103], a[16:19], v[144:147], v[20:23]
    v_fma_f32 v182, |v124|, v76, v182
    v_fma_f32 v200, |v125|, v77, v200
    v_mfma_f32_16x16x32_f16 v[100:103], a[20:23], v[148:151], v[100:103]
    v_fma_f32 v182, |v126|, v78, v182
    v_fma_f32 v200, |v127|, v79, v200
    v_mfma_f32_16x16x32_f16 v[100:103], a[24:27], v[152:155], v[100:103]
    v_add_f32 v182, v182, v200
    v_mul_f32 v183, |v96|, v48
    v_mfma_f32_16x16x32_f16 v[100:103], a[28:31], v[156:159], v[100:103]
    v_mul_f32 v201, |v97|, v49
    v_fma_f32 v183, |v98|, v50, v183
    v_mfma_f32_16x16x32_f16 v[104:107], a[32:35], v[144:147], v[24:27]
    v_fma_f32 v201, |v99|, v51, v201
    v_mfma_f32_16x16x32_f16 v[104:107], a[36:39], v[148:151], v[104:107]
    v_mfma_f32_16x16x32_f16 v[104:107], a[40:43], v[152:155], v[104:107]
    s_nop 1
    v_fma_f32 v183, |v100|, v52, v183
    v_fma_f32 v201, |v101|, v53, v201
    v_mfma_f32_16x16x32_f16 v[104:107], a[44:47], v[156:159], v[104:107]
    v_fma_f32 v183, |v102|, v54, v183
    v_fma_f32 v201, |v103|, v55, v201
    v_mfma_f32_16x16x32_f16 v[108:111], a[48:51], v[144:147], v[28:31]
    s_waitcnt lgkmcnt(0)
    v_pk_mul_f16 v128, v128, v204
    v_mfma_f32_16x16x32_f16 v[108:111], a[52:55], v[148:151], v[108:111]
    v_pk_mul_f16 v129, v129, v205
    v_pk_mul_f16 v130, v130, v206
    v_mfma_f32_16x16x32_f16 v[108:111], a[56:59], v[152:155], v[108:111]
    v_pk_mul_f16 v131, v131, v207
    v_pk_mul_f16 v132, v132, v208
    v_mfma_f32_16x16x32_f16 v[108:111], a[60:63], v[156:159], v[108:111]
    v_pk_mul_f16 v133, v133, v209
    v_pk_mul_f16 v134, v134, v210
    v_mfma_f32_16x16x32_f16 v[112:115], a[64:67], v[144:147], v[32:35]
    v_fma_f32 v183, |v104|, v56, v183
    v_fma_f32 v201, |v105|, v57, v201
    v_mfma_f32_16x16x32_f16 v[112:115], a[68:71], v[148:151], v[112:115]
    v_fma_f32 v183, |v106|, v58, v183
    v_fma_f32 v201, |v107|, v59, v201
    v_mfma_f32_16x16x32_f16 v[112:115], a[72:75], v[152:155], v[112:115]
    v_pk_mul_f16 v135, v135, v211
    v_pk_mul_f16 v136, v136, v212
    v_mfma_f32_16x16x32_f16 v[112:115], a[76:79], v[156:159], v[112:115]
    v_pk_mul_f16 v137, v137, v213
    v_fma_f32 v183, |v108|, v60, v183
    v_mfma_f32_16x16x32_f16 v[116:119], a[80:83], v[144:147], v[36:39]
    v_fma_f32 v201, |v109|, v61, v201
    v_fma_f32 v183, |v110|, v62, v183
    v_mfma_f32_16x16x32_f16 v[116:119], a[84:87], v[148:151], v[116:119]
    v_fma_f32 v201, |v111|, v63, v201
    v_pk_mul_f16 v138, v138, v214
    v_mfma_f32_16x16x32_f16 v[116:119], a[88:91], v[152:155], v[116:119]
    v_pk_mul_f16 v139, v139, v215
    v_pk_mul_f16 v140, v140, v216
    v_mfma_f32_16x16x32_f16 v[116:119], a[92:95], v[156:159], v[116:119]
    v_pk_mul_f16 v141, v141, v217
    v_fma_f32 v183, |v112|, v64, v183
    v_mfma_f32_16x16x32_f16 v[120:123], a[96:99], v[144:147], v[40:43]
    v_fma_f32 v201, |v113|, v65, v201
    v_fma_f32 v183, |v114|, v66, v183
    v_mfma_f32_16x16x32_f16 v[120:123], a[100:103], v[148:151], v[120:123]
    v_fma_f32 v201, |v115|, v67, v201
    v_pk_mul_f16 v142, v142, v218
    v_mfma_f32_16x16x32_f16 v[120:123], a[104:107], v[152:155], v[120:123]
    v_pk_mul_f16 v143, v143, v219
    v_fma_f32 v183, |v116|, v68, v183
    v_mfma_f32_16x16x32_f16 v[120:123], a[108:111], v[156:159], v[120:123]
    v_fma_f32 v201, |v117|, v69, v201
    v_fma_f32 v183, |v118|, v70, v183
    v_mfma_f32_16x16x32_f16 v[124:127], a[112:115], v[144:147], v[44:47]
    v_fma_f32 v201, |v119|, v71, v201
    v_mfma_f32_16x16x32_f16 v[124:127], a[116:119], v[148:151], v[124:127]
    v_mfma_f32_16x16x32_f16 v[124:127], a[120:123], v[152:155], v[124:127]
    s_nop 1
    v_fma_f32 v183, |v120|, v72, v183
    v_fma_f32 v201, |v121|, v73, v201
    v_mfma_f32_16x16x32_f16 v[124:127], a[124:127], v[156:159], v[124:127]
    v_fma_f32 v183, |v122|, v74, v183
    v_fma_f32 v201, |v123|, v75, v201
    v_mfma_f32_16x16x32_f16 v[96:99], a[0:3], v[128:131], v[16:19]
    ds_read_b128 v[216:219], v240 offset:4800
    ds_read_b128 v[212:215], v240 offset:4736
    v_mfma_f32_16x16x32_f16 v[96:99], a[4:7], v[132:135], v[96:99]
    ds_read_b128 v[208:211], v240 offset:4672
    ds_read_b128 v[204:207], v240 offset:4608
    v_mfma_f32_16x16x32_f16 v[96:99], a[8:11], v[136:139], v[96:99]
    ds_read_b128 v[156:159], v241 offset:4800
    ds_read_b128 v[152:155], v241 offset:4736
    v_mfma_f32_16x16x32_f16 v[96:99], a[12:15], v[140:143], v[96:99]
    ds_read_b128 v[148:151], v241 offset:4672
    ds_read_b128 v[144:147], v241 offset:4608
    v_mfma_f32_16x16x32_f16 v[100:103], a[16:19], v[128:131], v[20:23]
    v_fma_f32 v183, |v124|, v76, v183
    v_fma_f32 v201, |v125|, v77, v201
    v_mfma_f32_16x16x32_f16 v[100:103], a[20:23], v[132:135], v[100:103]
    v_fma_f32 v183, |v126|, v78, v183
    v_fma_f32 v201, |v127|, v79, v201
    v_mfma_f32_16x16x32_f16 v[100:103], a[24:27], v[136:139], v[100:103]
    v_add_f32 v183, v183, v201
    v_mul_f32 v196, |v96|, v48
    v_mfma_f32_16x16x32_f16 v[100:103], a[28:31], v[140:143], v[100:103]
    v_mul_f32 v200, |v97|, v49
    v_fma_f32 v196, |v98|, v50, v196
    v_mfma_f32_16x16x32_f16 v[104:107], a[32:35], v[128:131], v[24:27]
    v_fma_f32 v200, |v99|, v51, v200
    v_mfma_f32_16x16x32_f16 v[104:107], a[36:39], v[132:135], v[104:107]
    v_mfma_f32_16x16x32_f16 v[104:107], a[40:43], v[136:139], v[104:107]
    s_nop 1
    v_fma_f32 v196, |v100|, v52, v196
    v_fma_f32 v200, |v101|, v53, v200
    v_mfma_f32_16x16x32_f16 v[104:107], a[44:47], v[140:143], v[104:107]
    v_fma_f32 v196, |v102|, v54, v196
    v_fma_f32 v200, |v103|, v55, v200
    v_mfma_f32_16x16x32_f16 v[108:111], a[48:51], v[128:131], v[28:31]
    s_waitcnt lgkmcnt(0)
    v_pk_mul_f16 v144, v144, v204
    v_mfma_f32_16x16x32_f16 v[108:111], a[52:55], v[132:135], v[108:111]
    v_pk_mul_f16 v145, v145, v205
    v_pk_mul_f16 v146, v146, v206
    v_mfma_f32_16x16x32_f16 v[108:111], a[56:59], v[136:139], v[108:111]
    v_pk_mul_f16 v147, v147, v207
    v_pk_mul_f16 v148, v148, v208
    v_mfma_f32_16x16x32_f16 v[108:111], a[60:63], v[140:143], v[108:111]
    v_pk_mul_f16 v149, v149, v209
    v_pk_mul_f16 v150, v150, v210
    v_mfma_f32_16x16x32_f16 v[112:115], a[64:67], v[128:131], v[32:35]
    v_fma_f32 v196, |v104|, v56, v196
    v_fma_f32 v200, |v105|, v57, v200
    v_mfma_f32_16x16x32_f16 v[112:115], a[68:71], v[132:135], v[112:115]
    v_fma_f32 v196, |v106|, v58, v196
    v_fma_f32 v200, |v107|, v59, v200
    v_mfma_f32_16x16x32_f16 v[112:115], a[72:75], v[136:139], v[112:115]
    v_pk_mul_f16 v151, v151, v211
    v_pk_mul_f16 v152, v152, v212
    v_mfma_f32_16x16x32_f16 v[112:115], a[76:79], v[140:143], v[112:115]
    v_pk_mul_f16 v153, v153, v213
    v_fma_f32 v196, |v108|, v60, v196
    v_mfma_f32_16x16x32_f16 v[116:119], a[80:83], v[128:131], v[36:39]
    v_fma_f32 v200, |v109|, v61, v200
    v_fma_f32 v196, |v110|, v62, v196
    v_mfma_f32_16x16x32_f16 v[116:119], a[84:87], v[132:135], v[116:119]
    v_fma_f32 v200, |v111|, v63, v200
    v_pk_mul_f16 v154, v154, v214
    v_mfma_f32_16x16x32_f16 v[116:119], a[88:91], v[136:139], v[116:119]
    v_pk_mul_f16 v155, v155, v215
    v_pk_mul_f16 v156, v156, v216
    v_mfma_f32_16x16x32_f16 v[116:119], a[92:95], v[140:143], v[116:119]
    v_pk_mul_f16 v157, v157, v217
    v_fma_f32 v196, |v112|, v64, v196
    v_mfma_f32_16x16x32_f16 v[120:123], a[96:99], v[128:131], v[40:43]
    v_fma_f32 v200, |v113|, v65, v200
    v_fma_f32 v196, |v114|, v66, v196
    v_mfma_f32_16x16x32_f16 v[120:123], a[100:103], v[132:135], v[120:123]
    v_fma_f32 v200, |v115|, v67, v200
    v_pk_mul_f16 v158, v158, v218
    v_mfma_f32_16x16x32_f16 v[120:123], a[104:107], v[136:139], v[120:123]
    v_pk_mul_f16 v159, v159, v219
    v_fma_f32 v196, |v116|, v68, v196
    v_mfma_f32_16x16x32_f16 v[120:123], a[108:111], v[140:143], v[120:123]
    v_fma_f32 v200, |v117|, v69, v200
    v_fma_f32 v196, |v118|, v70, v196
    v_mfma_f32_16x16x32_f16 v[124:127], a[112:115], v[128:131], v[44:47]
    v_fma_f32 v200, |v119|, v71, v200
    v_permlane32_swap_b32 v180, v182
    v_mfma_f32_16x16x32_f16 v[124:127], a[116:119], v[132:135], v[124:127]
    v_permlane32_swap_b32 v181, v183
    v_add_f32 v180, v180, v182
    v_mfma_f32_16x16x32_f16 v[124:127], a[120:123], v[136:139], v[124:127]
    v_fma_f32 v196, |v120|, v72, v196
    v_fma_f32 v200, |v121|, v73, v200
    v_mfma_f32_16x16x32_f16 v[124:127], a[124:127], v[140:143], v[124:127]
    v_fma_f32 v196, |v122|, v74, v196
    v_fma_f32 v200, |v123|, v75, v200
    v_mfma_f32_16x16x32_f16 v[96:99], a[0:3], v[144:147], v[16:19]
    ds_read_b128 v[216:219], v242 offset:4800
    ds_read_b128 v[212:215], v242 offset:4736
    v_mfma_f32_16x16x32_f16 v[96:99], a[4:7], v[148:151], v[96:99]
    ds_read_b128 v[208:211], v242 offset:4672
    ds_read_b128 v[204:207], v242 offset:4608
    v_mfma_f32_16x16x32_f16 v[96:99], a[8:11], v[152:155], v[96:99]
    ds_read_b128 v[140:143], v243 offset:4800
    ds_read_b128 v[136:139], v243 offset:4736
    v_mfma_f32_16x16x32_f16 v[96:99], a[12:15], v[156:159], v[96:99]
    ds_read_b128 v[132:135], v243 offset:4672
    ds_read_b128 v[128:131], v243 offset:4608
    v_mfma_f32_16x16x32_f16 v[100:103], a[16:19], v[144:147], v[20:23]
    v_fma_f32 v196, |v124|, v76, v196
    v_fma_f32 v200, |v125|, v77, v200
    v_mfma_f32_16x16x32_f16 v[100:103], a[20:23], v[148:151], v[100:103]
    v_fma_f32 v196, |v126|, v78, v196
    v_fma_f32 v200, |v127|, v79, v200
    v_mfma_f32_16x16x32_f16 v[100:103], a[24:27], v[152:155], v[100:103]
    v_add_f32 v196, v196, v200
    v_mul_f32 v197, |v96|, v48
    v_mfma_f32_16x16x32_f16 v[100:103], a[28:31], v[156:159], v[100:103]
    v_mul_f32 v201, |v97|, v49
    v_fma_f32 v197, |v98|, v50, v197
    v_mfma_f32_16x16x32_f16 v[104:107], a[32:35], v[144:147], v[24:27]
    v_fma_f32 v201, |v99|, v51, v201
    v_add_f32 v181, v181, v183
    v_mfma_f32_16x16x32_f16 v[104:107], a[36:39], v[148:151], v[104:107]
    s_nop 0
    v_permlane16_swap_b32 v180, v181
    v_add_f32 v180, v180, v181
    v_mfma_f32_16x16x32_f16 v[104:107], a[40:43], v[152:155], v[104:107]
    v_fma_f32 v197, |v100|, v52, v197
    v_fma_f32 v201, |v101|, v53, v201
    v_mfma_f32_16x16x32_f16 v[104:107], a[44:47], v[156:159], v[104:107]
    v_fma_f32 v197, |v102|, v54, v197
    v_fma_f32 v201, |v103|, v55, v201
    v_mfma_f32_16x16x32_f16 v[108:111], a[48:51], v[144:147], v[28:31]
    s_waitcnt lgkmcnt(0)
    v_pk_mul_f16 v128, v128, v204
    v_mfma_f32_16x16x32_f16 v[108:111], a[52:55], v[148:151], v[108:111]
    v_pk_mul_f16 v129, v129, v205
    v_pk_mul_f16 v130, v130, v206
    v_mfma_f32_16x16x32_f16 v[108:111], a[56:59], v[152:155], v[108:111]
    v_pk_mul_f16 v131, v131, v207
    v_pk_mul_f16 v132, v132, v208
    v_mfma_f32_16x16x32_f16 v[108:111], a[60:63], v[156:159], v[108:111]
    v_pk_mul_f16 v133, v133, v209
    v_pk_mul_f16 v134, v134, v210
    v_mfma_f32_16x16x32_f16 v[112:115], a[64:67], v[144:147], v[32:35]
    v_fma_f32 v197, |v104|, v56, v197
    v_fma_f32 v201, |v105|, v57, v201
    v_mfma_f32_16x16x32_f16 v[112:115], a[68:71], v[148:151], v[112:115]
    v_fma_f32 v197, |v106|, v58, v197
    v_fma_f32 v201, |v107|, v59, v201
    v_mfma_f32_16x16x32_f16 v[112:115], a[72:75], v[152:155], v[112:115]
    v_pk_mul_f16 v135, v135, v211
    v_pk_mul_f16 v136, v136, v212
    v_mfma_f32_16x16x32_f16 v[112:115], a[76:79], v[156:159], v[112:115]
    v_pk_mul_f16 v137, v137, v213
    v_fma_f32 v197, |v108|, v60, v197
    v_mfma_f32_16x16x32_f16 v[116:119], a[80:83], v[144:147], v[36:39]
    v_fma_f32 v201, |v109|, v61, v201
    v_fma_f32 v197, |v110|, v62, v197
    v_mfma_f32_16x16x32_f16 v[116:119], a[84:87], v[148:151], v[116:119]
    v_fma_f32 v201, |v111|, v63, v201
    v_pk_mul_f16 v138, v138, v214
    v_mfma_f32_16x16x32_f16 v[116:119], a[88:91], v[152:155], v[116:119]
    v_pk_mul_f16 v139, v139, v215
    v_pk_mul_f16 v140, v140, v216
    v_mfma_f32_16x16x32_f16 v[116:119], a[92:95], v[156:159], v[116:119]
    v_pk_mul_f16 v141, v141, v217
    v_fma_f32 v197, |v112|, v64, v197
    v_mfma_f32_16x16x32_f16 v[120:123], a[96:99], v[144:147], v[40:43]
    v_fma_f32 v201, |v113|, v65, v201
    v_fma_f32 v197, |v114|, v66, v197
    v_mfma_f32_16x16x32_f16 v[120:123], a[100:103], v[148:151], v[120:123]
    v_fma_f32 v201, |v115|, v67, v201
    v_pk_mul_f16 v142, v142, v218
    v_mfma_f32_16x16x32_f16 v[120:123], a[104:107], v[152:155], v[120:123]
    v_pk_mul_f16 v143, v143, v219
    v_fma_f32 v197, |v116|, v68, v197
    v_mfma_f32_16x16x32_f16 v[120:123], a[108:111], v[156:159], v[120:123]
    v_fma_f32 v201, |v117|, v69, v201
    v_fma_f32 v197, |v118|, v70, v197
    v_mfma_f32_16x16x32_f16 v[124:127], a[112:115], v[144:147], v[44:47]
    v_fma_f32 v201, |v119|, v71, v201
    v_fma_f32 v180, v222, s14, v180
    v_mfma_f32_16x16x32_f16 v[124:127], a[116:119], v[148:151], v[124:127]
    v_max_f32 v248, v248, v180
    v_mfma_f32_16x16x32_f16 v[124:127], a[120:123], v[152:155], v[124:127]
    v_fma_f32 v197, |v120|, v72, v197
    v_fma_f32 v201, |v121|, v73, v201
    v_mfma_f32_16x16x32_f16 v[124:127], a[124:127], v[156:159], v[124:127]
    v_fma_f32 v197, |v122|, v74, v197
    v_fma_f32 v201, |v123|, v75, v201
    v_mfma_f32_16x16x32_f16 v[96:99], a[0:3], v[128:131], v[16:19]
    ds_read_b128 v[156:159], v244 offset:7104
    ds_read_b128 v[152:155], v244 offset:7040
    v_mfma_f32_16x16x32_f16 v[96:99], a[4:7], v[132:135], v[96:99]
    ds_read_b128 v[148:151], v244 offset:6976
    ds_read_b128 v[144:147], v244 offset:6912
    v_mfma_f32_16x16x32_f16 v[96:99], a[8:11], v[136:139], v[96:99]
    v_fma_f32 v197, |v124|, v76, v197
    v_fma_f32 v201, |v125|, v77, v201
    v_mfma_f32_16x16x32_f16 v[96:99], a[12:15], v[140:143], v[96:99]
    v_fma_f32 v197, |v126|, v78, v197
    v_fma_f32 v201, |v127|, v79, v201
    v_mfma_f32_16x16x32_f16 v[100:103], a[16:19], v[128:131], v[20:23]
    v_add_f32 v197, v197, v201
    v_mfma_f32_16x16x32_f16 v[100:103], a[20:23], v[132:135], v[100:103]
    v_mfma_f32_16x16x32_f16 v[100:103], a[24:27], v[136:139], v[100:103]
    s_nop 1
    v_mul_f32 v198, |v96|, v48
    v_mul_f32 v200, |v97|, v49
    v_mfma_f32_16x16x32_f16 v[100:103], a[28:31], v[140:143], v[100:103]
    v_fma_f32 v198, |v98|, v50, v198
    v_fma_f32 v200, |v99|, v51, v200
    v_mfma_f32_16x16x32_f16 v[104:107], a[32:35], v[128:131], v[24:27]
    v_mfma_f32_16x16x32_f16 v[104:107], a[36:39], v[132:135], v[104:107]
    v_mfma_f32_16x16x32_f16 v[104:107], a[40:43], v[136:139], v[104:107]
    s_waitcnt lgkmcnt(0)
    v_pk_mul_f16 v144, v144, v80
    v_mfma_f32_16x16x32_f16 v[104:107], a[44:47], v[140:143], v[104:107]
    v_pk_mul_f16 v145, v145, v81
    v_pk_mul_f16 v146, v146, v82
    v_mfma_f32_16x16x32_f16 v[108:111], a[48:51], v[128:131], v[28:31]
    v_pk_mul_f16 v147, v147, v83
    v_fma_f32 v198, |v100|, v52, v198
    v_mfma_f32_16x16x32_f16 v[108:111], a[52:55], v[132:135], v[108:111]
    v_fma_f32 v200, |v101|, v53, v200
    v_fma_f32 v198, |v102|, v54, v198
    v_mfma_f32_16x16x32_f16 v[108:111], a[56:59], v[136:139], v[108:111]
    v_fma_f32 v200, |v103|, v55, v200
    v_pk_mul_f16 v148, v148, v84
    v_mfma_f32_16x16x32_f16 v[108:111], a[60:63], v[140:143], v[108:111]
    v_pk_mul_f16 v149, v149, v85
    v_pk_mul_f16 v150, v150, v86
    v_mfma_f32_16x16x32_f16 v[112:115], a[64:67], v[128:131], v[32:35]
    v_fma_f32 v198, |v104|, v56, v198
    v_fma_f32 v200, |v105|, v57, v200
    v_mfma_f32_16x16x32_f16 v[112:115], a[68:71], v[132:135], v[112:115]
    v_fma_f32 v198, |v106|, v58, v198
    v_fma_f32 v200, |v107|, v59, v200
    v_mfma_f32_16x16x32_f16 v[112:115], a[72:75], v[136:139], v[112:115]
    v_pk_mul_f16 v151, v151, v87
    v_pk_mul_f16 v152, v152, v88
    v_mfma_f32_16x16x32_f16 v[112:115], a[76:79], v[140:143], v[112:115]
    v_pk_mul_f16 v153, v153, v89
    v_pk_mul_f16 v154, v154, v90
    v_mfma_f32_16x16x32_f16 v[116:119], a[80:83], v[128:131], v[36:39]
    v_fma_f32 v198, |v108|, v60, v198
    v_fma_f32 v200, |v109|, v61, v200
    v_mfma_f32_16x16x32_f16 v[116:119], a[84:87], v[132:135], v[116:119]
    v_fma_f32 v198, |v110|, v62, v198
    v_fma_f32 v200, |v111|, v63, v200
    v_mfma_f32_16x16x32_f16 v[116:119], a[88:91], v[136:139], v[116:119]
    v_pk_mul_f16 v155, v155, v91
    v_pk_mul_f16 v156, v156, v92
    v_mfma_f32_16x16x32_f16 v[116:119], a[92:95], v[140:143], v[116:119]
    v_pk_mul_f16 v157, v157, v93
    v_fma_f32 v198, |v112|, v64, v198
    v_mfma_f32_16x16x32_f16 v[120:123], a[96:99], v[128:131], v[40:43]
    v_fma_f32 v200, |v113|, v65, v200
    v_fma_f32 v198, |v114|, v66, v198
    v_mfma_f32_16x16x32_f16 v[120:123], a[100:103], v[132:135], v[120:123]
    v_fma_f32 v200, |v115|, v67, v200
    v_pk_mul_f16 v158, v158, v94
    v_mfma_f32_16x16x32_f16 v[120:123], a[104:107], v[136:139], v[120:123]
    v_pk_mul_f16 v159, v159, v95
    v_fma_f32 v198, |v116|, v68, v198
    v_mfma_f32_16x16x32_f16 v[120:123], a[108:111], v[140:143], v[120:123]
    v_fma_f32 v200, |v117|, v69, v200
    v_fma_f32 v198, |v118|, v70, v198
    v_mfma_f32_16x16x32_f16 v[124:127], a[112:115], v[128:131], v[44:47]
    v_fma_f32 v200, |v119|, v71, v200
    v_mfma_f32_16x16x32_f16 v[124:127], a[116:119], v[132:135], v[124:127]
    v_mfma_f32_16x16x32_f16 v[124:127], a[120:123], v[136:139], v[124:127]
    s_nop 1
    v_fma_f32 v198, |v120|, v72, v198
    v_fma_f32 v200, |v121|, v73, v200
    v_mfma_f32_16x16x32_f16 v[124:127], a[124:127], v[140:143], v[124:127]
    v_fma_f32 v198, |v122|, v74, v198
    v_fma_f32 v200, |v123|, v75, v200
    v_mfma_f32_16x16x32_f16 v[96:99], a[0:3], v[144:147], v[16:19]
    ds_read_b128 v[140:143], v244 offset:7392
    ds_read_b128 v[136:139], v244 offset:7328
    v_mfma_f32_16x16x32_f16 v[96:99], a[4:7], v[148:151], v[96:99]
    ds_read_b128 v[132:135], v244 offset:7264
    ds_read_b128 v[128:131], v244 offset:7200
    v_mfma_f32_16x16x32_f16 v[96:99], a[8:11], v[152:155], v[96:99]
    v_fma_f32 v198, |v124|, v76, v198
    v_fma_f32 v200, |v125|, v77, v200
    v_mfma_f32_16x16x32_f16 v[96:99], a[12:15], v[156:159], v[96:99]
    v_fma_f32 v198, |v126|, v78, v198
    v_fma_f32 v200, |v127|, v79, v200
    v_mfma_f32_16x16x32_f16 v[100:103], a[16:19], v[144:147], v[20:23]
    v_add_f32 v198, v198, v200
    v_mfma_f32_16x16x32_f16 v[100:103], a[20:23], v[148:151], v[100:103]
    v_mfma_f32_16x16x32_f16 v[100:103], a[24:27], v[152:155], v[100:103]
    s_nop 1
    v_mul_f32 v192, |v96|, v48
    v_mul_f32 v201, |v97|, v49
    v_mfma_f32_16x16x32_f16 v[100:103], a[28:31], v[156:159], v[100:103]
    v_fma_f32 v192, |v98|, v50, v192
    v_fma_f32 v201, |v99|, v51, v201
    v_mfma_f32_16x16x32_f16 v[104:107], a[32:35], v[144:147], v[24:27]
    v_mfma_f32_16x16x32_f16 v[104:107], a[36:39], v[148:151], v[104:107]
    v_mfma_f32_16x16x32_f16 v[104:107], a[40:43], v[152:155], v[104:107]
    s_waitcnt lgkmcnt(0)
    v_pk_mul_f16 v128, v128, v80
    v_mfma_f32_16x16x32_f16 v[104:107], a[44:47], v[156:159], v[104:107]
    v_pk_mul_f16 v129, v129, v81
    v_pk_mul_f16 v130, v130, v82
    v_mfma_f32_16x16x32_f16 v[108:111], a[48:51], v[144:147], v[28:31]
    v_pk_mul_f16 v131, v131, v83
    v_fma_f32 v192, |v100|, v52, v192
    v_mfma_f32_16x16x32_f16 v[108:111], a[52:55], v[148:151], v[108:111]
    v_fma_f32 v201, |v101|, v53, v201
    v_fma_f32 v192, |v102|, v54, v192
    v_mfma_f32_16x16x32_f16 v[108:111], a[56:59], v[152:155], v[108:111]
    v_fma_f32 v201, |v103|, v55, v201
    v_pk_mul_f16 v132, v132, v84
    v_mfma_f32_16x16x32_f16 v[108:111], a[60:63], v[156:159], v[108:111]
    v_pk_mul_f16 v133, v133, v85
    v_pk_mul_f16 v134, v134, v86
    v_mfma_f32_16x16x32_f16 v[112:115], a[64:67], v[144:147], v[32:35]
    v_fma_f32 v192, |v104|, v56, v192
    v_fma_f32 v201, |v105|, v57, v201
    v_mfma_f32_16x16x32_f16 v[112:115], a[68:71], v[148:151], v[112:115]
    v_fma_f32 v192, |v106|, v58, v192
    v_fma_f32 v201, |v107|, v59, v201
    v_mfma_f32_16x16x32_f16 v[112:115], a[72:75], v[152:155], v[112:115]
    v_pk_mul_f16 v135, v135, v87
    v_pk_mul_f16 v136, v136, v88
    v_mfma_f32_16x16x32_f16 v[112:115], a[76:79], v[156:159], v[112:115]
    v_pk_mul_f16 v137, v137, v89
    v_pk_mul_f16 v138, v138, v90
    v_mfma_f32_16x16x32_f16 v[116:119], a[80:83], v[144:147], v[36:39]
    v_fma_f32 v192, |v108|, v60, v192
    v_fma_f32 v201, |v109|, v61, v201
    v_mfma_f32_16x16x32_f16 v[116:119], a[84:87], v[148:151], v[116:119]
    v_fma_f32 v192, |v110|, v62, v192
    v_fma_f32 v201, |v111|, v63, v201
    v_mfma_f32_16x16x32_f16 v[116:119], a[88:91], v[152:155], v[116:119]
    v_pk_mul_f16 v139, v139, v91
    v_pk_mul_f16 v140, v140, v92
    v_mfma_f32_16x16x32_f16 v[116:119], a[92:95], v[156:159], v[116:119]
    v_pk_mul_f16 v141, v141, v93
    v_fma_f32 v192, |v112|, v64, v192
    v_mfma_f32_16x16x32_f16 v[120:123], a[96:99], v[144:147], v[40:43]
    v_fma_f32 v201, |v113|, v65, v201
    v_fma_f32 v192, |v114|, v66, v192
    v_mfma_f32_16x16x32_f16 v[120:123], a[100:103], v[148:151], v[120:123]
    v_fma_f32 v201, |v115|, v67, v201
    v_pk_mul_f16 v142, v142, v94
    v_mfma_f32_16x16x32_f16 v[120:123], a[104:107], v[152:155], v[120:123]
    v_pk_mul_f16 v143, v143, v95
    v_fma_f32 v192, |v116|, v68, v192
    v_mfma_f32_16x16x32_f16 v[120:123], a[108:111], v[156:159], v[120:123]
    v_fma_f32 v201, |v117|, v69, v201
    v_fma_f32 v192, |v118|, v70, v192
    v_mfma_f32_16x16x32_f16 v[124:127], a[112:115], v[144:147], v[44:47]
    v_fma_f32 v201, |v119|, v71, v201
    v_permlane32_swap_b32 v196, v198
    v_mfma_f32_16x16x32_f16 v[124:127], a[116:119], v[148:151], v[124:127]
    v_permlane32_swap_b32 v197, v199
    v_add_f32 v196, v196, v198
    v_mfma_f32_16x16x32_f16 v[124:127], a[120:123], v[152:155], v[124:127]
    v_fma_f32 v192, |v120|, v72, v192
    v_fma_f32 v201, |v121|, v73, v201
    v_mfma_f32_16x16x32_f16 v[124:127], a[124:127], v[156:159], v[124:127]
    v_fma_f32 v192, |v122|, v74, v192
    v_fma_f32 v201, |v123|, v75, v201
    v_mfma_f32_16x16x32_f16 v[96:99], a[0:3], v[128:131], v[16:19]
    v_add_f32 v197, v197, v199
    s_nop 1
    v_permlane16_swap_b32 v196, v197
    v_mfma_f32_16x16x32_f16 v[96:99], a[4:7], v[132:135], v[96:99]
    v_add_f32 v196, v196, v197
    v_fma_f32 v196, v230, s14, v196
    v_mfma_f32_16x16x32_f16 v[96:99], a[8:11], v[136:139], v[96:99]
    v_fma_f32 v192, |v124|, v76, v192
    v_fma_f32 v201, |v125|, v77, v201
    v_mfma_f32_16x16x32_f16 v[96:99], a[12:15], v[140:143], v[96:99]
    v_fma_f32 v192, |v126|, v78, v192
    v_fma_f32 v201, |v127|, v79, v201
    v_mfma_f32_16x16x32_f16 v[100:103], a[16:19], v[128:131], v[20:23]
    v_add_f32 v192, v192, v201
    v_cndmask_b32 v196, v251, v196, s[48:49]
    v_mfma_f32_16x16x32_f16 v[100:103], a[20:23], v[132:135], v[100:103]
    v_max_f32 v248, v248, v196
    v_mfma_f32_16x16x32_f16 v[100:103], a[24:27], v[136:139], v[100:103]
    v_mul_f32 v194, |v96|, v48
    v_mul_f32 v200, |v97|, v49
    v_mfma_f32_16x16x32_f16 v[100:103], a[28:31], v[140:143], v[100:103]
    v_fma_f32 v194, |v98|, v50, v194
    v_fma_f32 v200, |v99|, v51, v200
    v_mfma_f32_16x16x32_f16 v[104:107], a[32:35], v[128:131], v[24:27]
    v_mfma_f32_16x16x32_f16 v[104:107], a[36:39], v[132:135], v[104:107]
    v_mfma_f32_16x16x32_f16 v[104:107], a[40:43], v[136:139], v[104:107]
    s_nop 2
    v_fma_f32 v194, |v100|, v52, v194
    v_fma_f32 v200, |v101|, v53, v200
    v_mfma_f32_16x16x32_f16 v[104:107], a[44:47], v[140:143], v[104:107]
    v_fma_f32 v194, |v102|, v54, v194
    v_fma_f32 v200, |v103|, v55, v200
    v_mfma_f32_16x16x32_f16 v[108:111], a[48:51], v[128:131], v[28:31]
    v_mfma_f32_16x16x32_f16 v[108:111], a[52:55], v[132:135], v[108:111]
    v_mfma_f32_16x16x32_f16 v[108:111], a[56:59], v[136:139], v[108:111]
    s_nop 2
    v_fma_f32 v194, |v104|, v56, v194
    v_fma_f32 v200, |v105|, v57, v200
    v_mfma_f32_16x16x32_f16 v[108:111], a[60:63], v[140:143], v[108:111]
    v_fma_f32 v194, |v106|, v58, v194
    v_fma_f32 v200, |v107|, v59, v200
    v_mfma_f32_16x16x32_f16 v[112:115], a[64:67], v[128:131], v[32:35]
    v_mfma_f32_16x16x32_f16 v[112:115], a[68:71], v[132:135], v[112:115]
    v_mfma_f32_16x16x32_f16 v[112:115], a[72:75], v[136:139], v[112:115]
    s_nop 2
    v_fma_f32 v194, |v108|, v60, v194
    v_fma_f32 v200, |v109|, v61, v200
    v_mfma_f32_16x16x32_f16 v[112:115], a[76:79], v[140:143], v[112:115]
    v_fma_f32 v194, |v110|, v62, v194
    v_fma_f32 v200, |v111|, v63, v200
    v_mfma_f32_16x16x32_f16 v[116:119], a[80:83], v[128:131], v[36:39]
    v_mfma_f32_16x16x32_f16 v[116:119], a[84:87], v[132:135], v[116:119]
    v_mfma_f32_16x16x32_f16 v[116:119], a[88:91], v[136:139], v[116:119]
    s_nop 2
    v_fma_f32 v194, |v112|, v64, v194
    v_fma_f32 v200, |v113|, v65, v200
    v_mfma_f32_16x16x32_f16 v[116:119], a[92:95], v[140:143], v[116:119]
    v_fma_f32 v194, |v114|, v66, v194
    v_fma_f32 v200, |v115|, v67, v200
    v_mfma_f32_16x16x32_f16 v[120:123], a[96:99], v[128:131], v[40:43]
    v_mfma_f32_16x16x32_f16 v[120:123], a[100:103], v[132:135], v[120:123]
    v_mfma_f32_16x16x32_f16 v[120:123], a[104:107], v[136:139], v[120:123]
    s_nop 2
    v_fma_f32 v194, |v116|, v68, v194
    v_fma_f32 v200, |v117|, v69, v200
    v_mfma_f32_16x16x32_f16 v[120:123], a[108:111], v[140:143], v[120:123]
    v_fma_f32 v194, |v118|, v70, v194
    v_fma_f32 v200, |v119|, v71, v200
    v_mfma_f32_16x16x32_f16 v[124:127], a[112:115], v[128:131], v[44:47]
    v_mfma_f32_16x16x32_f16 v[124:127], a[116:119], v[132:135], v[124:127]
    v_mfma_f32_16x16x32_f16 v[124:127], a[120:123], v[136:139], v[124:127]
    s_nop 2
    v_fma_f32 v194, |v120|, v72, v194
    v_fma_f32 v200, |v121|, v73, v200
    v_mfma_f32_16x16x32_f16 v[124:127], a[124:127], v[140:143], v[124:127]
    v_fma_f32 v194, |v122|, v74, v194
    v_fma_f32 v200, |v123|, v75, v200
    s_nop 5
    v_fma_f32 v194, |v124|, v76, v194
    v_fma_f32 v200, |v125|, v77, v200
    v_fma_f32 v194, |v126|, v78, v194
    v_fma_f32 v200, |v127|, v79, v200
    v_add_f32 v194, v194, v200
    s_nop 1
    v_permlane32_swap_b32 v192, v194
    v_add_f32 v192, v192, v194
    v_mov_b32 v193, v192
    s_nop 1
    v_permlane16_swap_b32 v192, v193
    v_add_f32 v192, v192, v193
    v_fma_f32 v192, v228, s14, v192
    v_cndmask_b32 v192, v251, v192, s[46:47]
    v_max_f32 v248, v248, v192
    s_nop 1
    v_max_f32_dpp v248, v248, v248 row_ror:8 row_mask:0xf bank_mask:0xf
    s_nop 1
    v_max_f32_dpp v248, v248, v248 row_ror:4 row_mask:0xf bank_mask:0xf
    s_nop 1
    v_max_f32_dpp v248, v248, v248 row_ror:2 row_mask:0xf bank_mask:0xf
    s_nop 1
    v_max_f32_dpp v248, v248, v248 row_ror:1 row_mask:0xf bank_mask:0xf
    s_nop 1
    v_max_f32_dpp v248, v248, v248 row_bcast:15 row_mask:0xa bank_mask:0xf
    s_nop 1
    v_max_f32_dpp v248, v248, v248 row_bcast:31 row_mask:0xc bank_mask:0xf
    s_nop 0
    v_readlane_b32 s50, v248, 63
    s_nop 1
    v_subrev_f32 v176, s50, v176
    v_subrev_f32 v180, s50, v180
    v_subrev_f32 v184, s50, v184
    v_subrev_f32 v188, s50, v188
    v_subrev_f32 v192, s50, v192
    v_subrev_f32 v196, s50, v196
    v_mul_f32 v176, s15, v176
    v_mul_f32 v180, s15, v180
    v_mul_f32 v184, s15, v184
    v_mul_f32 v188, s15, v188
    v_mul_f32 v192, s15, v192
    v_mul_f32 v196, s15, v196
    v_exp_f32 v176, v176
    v_exp_f32 v180, v180
    v_exp_f32 v184, v184
    v_exp_f32 v188, v188
    v_exp_f32 v192, v192
    v_exp_f32 v196, v196
    v_add_f32 v249, v176, v180
    v_mul_f32 v250, v176, v221
    v_fmac_f32 v250, v180, v223
    v_add_f32 v249, v249, v184
    v_fmac_f32 v250, v184, v225
    v_add_f32 v249, v249, v188
    v_fmac_f32 v250, v188, v227
    v_add_f32 v249, v249, v192
    v_fmac_f32 v250, v192, v229
    v_add_f32 v249, v249, v196
    v_fmac_f32 v250, v196, v231
    s_nop 0
    v_add_f32_dpp v249, v249, v249 row_ror:8 row_mask:0xf bank_mask:0xf
    v_add_f32_dpp v250, v250, v250 row_ror:8 row_mask:0xf bank_mask:0xf
    s_nop 0
    v_add_f32_dpp v249, v249, v249 row_ror:4 row_mask:0xf bank_mask:0xf
    v_add_f32_dpp v250, v250, v250 row_ror:4 row_mask:0xf bank_mask:0xf
    s_nop 0
    v_add_f32_dpp v249, v249, v249 row_ror:2 row_mask:0xf bank_mask:0xf
    v_add_f32_dpp v250, v250, v250 row_ror:2 row_mask:0xf bank_mask:0xf
    s_nop 0
    v_add_f32_dpp v249, v249, v249 row_ror:1 row_mask:0xf bank_mask:0xf
    v_add_f32_dpp v250, v250, v250 row_ror:1 row_mask:0xf bank_mask:0xf
    s_nop 0
    v_add_f32_dpp v249, v249, v249 row_bcast:15 row_mask:0xa bank_mask:0xf
    v_add_f32_dpp v250, v250, v250 row_bcast:15 row_mask:0xa bank_mask:0xf
    s_nop 0
    v_add_f32_dpp v249, v249, v249 row_bcast:31 row_mask:0xc bank_mask:0xf
    v_add_f32_dpp v250, v250, v250 row_bcast:31 row_mask:0xc bank_mask:0xf
    v_rcp_f32 v249, v249
    s_lshl_b32 s34, s4, 1
    v_mov_b32 v2, s34
    v_mul_f32 v250, v250, v249
    v_ldexp_f32 v250, v250, s13
    s_mov_b32 exec_lo, 0
    s_mov_b32 exec_hi, 0x80000000
    v_cvt_pk_bf16_f32 v250, v250, v250
    global_store_short v2, v250, s[32:33]
L_end:
s_endpgm
.section .rodata,"a"
.p2align 6
.amdhsa_kernel standalone__factorization_afm__recsys_kernel
  .amdhsa_next_free_vgpr 384
  .amdhsa_next_free_sgpr 102
  .amdhsa_accum_offset 256
  .amdhsa_group_segment_fixed_size 0
  .amdhsa_kernarg_size 88
  .amdhsa_user_sgpr_count 2
  .amdhsa_user_sgpr_kernarg_segment_ptr 1
  .amdhsa_system_sgpr_workgroup_id_x 1
.end_amdhsa_kernel
```

```asm
; @launch grid=(256,1,1) block=(256,1,1) lds=116992
.amdgcn_target "amdgcn-amd-amdhsa--gfx950"
.text
.globl standalone__factorization_afm__recsys_kernel
.p2align 12
.fill 832, 4, 0xbf800000
.p2align 8
.type standalone__factorization_afm__recsys_kernel,@function
standalone__factorization_afm__recsys_kernel:
    s_cmp_ge_u32 s2, 256
    s_cbranch_scc1 L_end
    s_load_dwordx16 s[16:31], s[0:1], 0
    s_load_dwordx2 s[32:33], s[0:1], 64
    s_getpc_b64 s[96:97]
L_pc:
    v_and_b32 v1, 63, v0
    v_lshlrev_b32 v120, 4, v1
    v_add_u32 v120, L_tab-L_pc, v120
    global_load_dwordx4 v[128:131], v120, s[96:97]
    s_bfe_u32 s7, s2, 0x20003
    s_lshl_b32 s7, s7, 13
    v_lshl_add_u32 v200, v0, 5, s7
    v_lshrrev_b32 v2, 6, v0
    v_min_u32 v200, L_end-L_pc, v200
    v_readfirstlane_b32 s3, v2
    global_load_dword v251, v200, s[96:97]
    global_load_dwordx2 v[132:133], v120, s[96:97] offset:1024
    global_load_dwordx4 v[232:235], v120, s[96:97] offset:2048
    global_load_dwordx3 v[236:238], v120, s[96:97] offset:3072
    v_bfe_u32 v4, v0, 4, 2
    s_lshl2_add_u32 s4, s2, s3
    s_mul_i32 s6, s4, 104
    s_add_u32 s7, s6, 76
    v_lshlrev_b32 v123, 4, v0
    v_and_b32 v14, 0xf0, v123
    v_mad_u32_u24 v121, v4, 28, s6
    v_and_b32 v126, 31, v0
    v_lshlrev_b32 v125, 6, v2
    v_min_u32 v122, s7, v121
    v_lshl_or_b32 v126, v126, 1, v125
    v_lshlrev_b32 v125, 2, v1
    v_add_u32 v112, 4096, v123
    v_add_u32 v113, 12288, v123
    v_add_u32 v114, 20480, v123
    v_add_u32 v115, 28672, v123
    s_waitcnt lgkmcnt(0)
    global_load_dwordx4 v[204:207], v121, s[16:17]
    global_load_dwordx3 v[208:210], v122, s[16:17] offset:16
    s_barrier
    global_load_dwordx4 v[220:223], v14, s[28:29]
    global_load_ushort v12, v126, s[26:27]
    global_load_ushort v13, v126, s[28:29]
    global_load_dword v252, v125, s[30:31]
    global_load_dwordx4 v[16:19], v112, s[24:25] offset:-4096
    global_load_dwordx4 v[20:23], v112, s[24:25] offset:0
    global_load_dwordx4 v[24:27], v113, s[24:25] offset:-4096
    global_load_dwordx4 v[28:31], v113, s[24:25] offset:0
    global_load_dwordx4 v[32:35], v114, s[24:25] offset:-4096
    global_load_dwordx4 v[36:39], v114, s[24:25] offset:0
    global_load_dwordx4 v[40:43], v115, s[24:25] offset:-4096
    global_load_dwordx4 v[44:47], v115, s[24:25] offset:0
    s_add_u32 s94, s96, L_ctab-L_pc
    s_addc_u32 s95, s97, 0
    s_load_dwordx16 s[36:51], s[94:95], 0
    s_load_dwordx4 s[52:55], s[94:95], 64
    s_mov_b32 s56, s18
    s_mov_b32 s57, s19
    s_mov_b32 s58, 25600000
    s_mov_b32 s59, 0x00020000
    s_mul_i32 s5, s3, 19008
    s_lshr_b32 s7, s3, 1
    s_mul_i32 s6, s3, 1152
    s_lshl_b32 s7, s7, 7
    s_add_u32 s6, s6, s7
    s_lshl_b32 s8, s3, 7
    s_add_u32 s5, s5, 40960
    v_lshlrev_b32 v127, 4, v1
    v_lshl_add_u32 v3, v2, 2, v127
    s_mov_b64 exec, 0
    s_cmp_eq_u32 s3, 0
    s_cbranch_scc1 L_pad0
    s_cmp_eq_u32 s3, 1
    s_cbranch_scc1 L_pad1
    s_cmp_eq_u32 s3, 2
    s_cbranch_scc1 L_pad2
    s_branch L_pad3
L_hopret:
    s_mov_b64 exec, -1
    s_waitcnt vmcnt(18)
    v_add_u32_sdwa v5, v128, s6 dst_sel:DWORD dst_unused:UNUSED_PAD src0_sel:WORD_0 src1_sel:DWORD
    s_waitcnt vmcnt(13)
    v_lshl_add_u32 v204, v204, 8, v14
    v_lshl_add_u32 v205, v205, 8, v14
    v_lshl_add_u32 v206, v206, 8, v14
    v_lshl_add_u32 v207, v207, 8, v14
    buffer_load_dwordx4 v[144:147], v204, s[56:59], 0 offen
    buffer_load_dwordx4 v[148:151], v205, s[56:59], 0 offen
    buffer_load_dwordx4 v[152:155], v206, s[56:59], 0 offen
    buffer_load_dwordx4 v[156:159], v207, s[56:59], 0 offen
    s_waitcnt vmcnt(16)
    v_lshl_add_u32 v208, v208, 8, v14
    v_lshl_add_u32 v209, v209, 8, v14
    v_lshl_add_u32 v210, v210, 8, v14
    v_add_u32_sdwa v7, v128, s8 dst_sel:DWORD dst_unused:UNUSED_PAD src0_sel:WORD_1 src1_sel:DWORD
    v_add_u32_sdwa v8, v129, s8 dst_sel:DWORD dst_unused:UNUSED_PAD src0_sel:WORD_0 src1_sel:DWORD
    v_lshrrev_b32 v9, 16, v129
    v_and_b32 v6, 0xffff, v130
    v_lshrrev_b32 v15, 16, v130
    v_add_u32_sdwa v203, v131, s5 dst_sel:DWORD dst_unused:UNUSED_PAD src0_sel:WORD_0 src1_sel:DWORD
    v_add_u32_sdwa v246, v131, s5 dst_sel:DWORD dst_unused:UNUSED_PAD src0_sel:WORD_1 src1_sel:DWORD
    v_add_u32_sdwa v201, v132, s5 dst_sel:DWORD dst_unused:UNUSED_PAD src0_sel:WORD_0 src1_sel:DWORD
    v_add_u32_sdwa v245, v132, s5 dst_sel:DWORD dst_unused:UNUSED_PAD src0_sel:WORD_1 src1_sel:DWORD
    v_add_u32_sdwa v202, v133, s5 dst_sel:DWORD dst_unused:UNUSED_PAD src0_sel:WORD_0 src1_sel:DWORD
    v_lshrrev_b32 v10, 16, v133
    s_waitcnt lgkmcnt(0)
L_wconv:
    s_waitcnt vmcnt(11)
    v_lshlrev_b32 v96, 16, v16
    v_and_b32 v97, s46, v16
    v_dot2_f32_bf16 v112, v16, v220, 0
    v_lshlrev_b32 v98, 16, v17
    v_and_b32 v99, s46, v17
    v_dot2_f32_bf16 v112, v17, v221, v112
    v_lshlrev_b32 v100, 16, v18
    v_and_b32 v101, s46, v18
    v_dot2_f32_bf16 v112, v18, v222, v112
    v_lshlrev_b32 v102, 16, v19
    v_and_b32 v103, s46, v19
    v_dot2_f32_bf16 v112, v19, v223, v112
    v_cvt_pkrtz_f16_f32 v48, v96, v97
    v_cvt_pkrtz_f16_f32 v49, v98, v99
    v_cvt_pkrtz_f16_f32 v50, v100, v101
    v_cvt_pkrtz_f16_f32 v51, v102, v103
    v_or_b32 v248, v48, v49
    v_or3_b32 v248, v248, v50, v51
    ds_write_b128 v5, v[48:51] offset:0
    s_waitcnt vmcnt(10)
    v_lshlrev_b32 v104, 16, v20
    v_and_b32 v105, s46, v20
    v_dot2_f32_bf16 v113, v20, v220, 0
    v_lshlrev_b32 v106, 16, v21
    v_and_b32 v107, s46, v21
    v_dot2_f32_bf16 v113, v21, v221, v113
    v_lshlrev_b32 v108, 16, v22
    v_and_b32 v109, s46, v22
    v_dot2_f32_bf16 v113, v22, v222, v113
    v_lshlrev_b32 v110, 16, v23
    v_and_b32 v111, s46, v23
    v_dot2_f32_bf16 v113, v23, v223, v113
    v_cvt_pkrtz_f16_f32 v52, v104, v105
    v_cvt_pkrtz_f16_f32 v53, v106, v107
    v_cvt_pkrtz_f16_f32 v54, v108, v109
    v_cvt_pkrtz_f16_f32 v55, v110, v111
    v_or3_b32 v248, v248, v52, v53
    v_add_f32_dpp v112, v112, v112 row_ror:8 row_mask:0xf bank_mask:0x3
    v_or3_b32 v248, v248, v54, v55
    ds_write_b128 v5, v[52:55] offset:4736
    s_waitcnt vmcnt(9)
    v_lshlrev_b32 v96, 16, v24
    v_and_b32 v97, s46, v24
    v_dot2_f32_bf16 v114, v24, v220, 0
    v_lshlrev_b32 v98, 16, v25
    v_and_b32 v99, s46, v25
    v_dot2_f32_bf16 v114, v25, v221, v114
    v_lshlrev_b32 v100, 16, v26
    v_and_b32 v101, s46, v26
    v_dot2_f32_bf16 v114, v26, v222, v114
    v_lshlrev_b32 v102, 16, v27
    v_and_b32 v103, s46, v27
    v_dot2_f32_bf16 v114, v27, v223, v114
    v_cvt_pkrtz_f16_f32 v56, v96, v97
    v_cvt_pkrtz_f16_f32 v57, v98, v99
    v_cvt_pkrtz_f16_f32 v58, v100, v101
    v_cvt_pkrtz_f16_f32 v59, v102, v103
    v_or3_b32 v248, v248, v56, v57
    v_add_f32_dpp v112, v113, v113 row_ror:8 row_mask:0xf bank_mask:0xc
    v_or3_b32 v248, v248, v58, v59
    ds_write_b128 v5, v[56:59] offset:9472
    s_waitcnt vmcnt(8)
    v_lshlrev_b32 v104, 16, v28
    v_and_b32 v105, s46, v28
    v_dot2_f32_bf16 v115, v28, v220, 0
    v_lshlrev_b32 v106, 16, v29
    v_and_b32 v107, s46, v29
    v_dot2_f32_bf16 v115, v29, v221, v115
    v_lshlrev_b32 v108, 16, v30
    v_and_b32 v109, s46, v30
    v_dot2_f32_bf16 v115, v30, v222, v115
    v_lshlrev_b32 v110, 16, v31
    v_and_b32 v111, s46, v31
    v_dot2_f32_bf16 v115, v31, v223, v115
    v_cvt_pkrtz_f16_f32 v60, v104, v105
    v_cvt_pkrtz_f16_f32 v61, v106, v107
    v_cvt_pkrtz_f16_f32 v62, v108, v109
    v_cvt_pkrtz_f16_f32 v63, v110, v111
    v_or3_b32 v248, v248, v60, v61
    v_add_f32_dpp v114, v114, v114 row_ror:8 row_mask:0xf bank_mask:0x3
    v_or3_b32 v248, v248, v62, v63
    v_add_f32_dpp v112, v112, v112 row_half_mirror row_mask:0xf bank_mask:0x5
    ds_write_b128 v5, v[60:63] offset:14208
    s_waitcnt vmcnt(7)
    v_lshlrev_b32 v96, 16, v32
    v_and_b32 v97, s46, v32
    v_dot2_f32_bf16 v116, v32, v220, 0
    v_lshlrev_b32 v98, 16, v33
    v_and_b32 v99, s46, v33
    v_dot2_f32_bf16 v116, v33, v221, v116
    v_lshlrev_b32 v100, 16, v34
    v_and_b32 v101, s46, v34
    v_dot2_f32_bf16 v116, v34, v222, v116
    v_lshlrev_b32 v102, 16, v35
    v_and_b32 v103, s46, v35
    v_dot2_f32_bf16 v116, v35, v223, v116
    v_cvt_pkrtz_f16_f32 v64, v96, v97
    v_cvt_pkrtz_f16_f32 v65, v98, v99
    v_cvt_pkrtz_f16_f32 v66, v100, v101
    v_cvt_pkrtz_f16_f32 v67, v102, v103
    v_or3_b32 v248, v248, v64, v65
    v_add_f32_dpp v114, v115, v115 row_ror:8 row_mask:0xf bank_mask:0xc
    v_or3_b32 v248, v248, v66, v67
    ds_write_b128 v5, v[64:67] offset:18944
    s_waitcnt vmcnt(6)
    v_lshlrev_b32 v104, 16, v36
    v_and_b32 v105, s46, v36
    v_dot2_f32_bf16 v117, v36, v220, 0
    v_lshlrev_b32 v106, 16, v37
    v_and_b32 v107, s46, v37
    v_dot2_f32_bf16 v117, v37, v221, v117
    v_lshlrev_b32 v108, 16, v38
    v_and_b32 v109, s46, v38
    v_dot2_f32_bf16 v117, v38, v222, v117
    v_lshlrev_b32 v110, 16, v39
    v_and_b32 v111, s46, v39
    v_dot2_f32_bf16 v117, v39, v223, v117
    v_cvt_pkrtz_f16_f32 v68, v104, v105
    v_cvt_pkrtz_f16_f32 v69, v106, v107
    v_cvt_pkrtz_f16_f32 v70, v108, v109
    v_cvt_pkrtz_f16_f32 v71, v110, v111
    v_or3_b32 v248, v248, v68, v69
    v_add_f32_dpp v116, v116, v116 row_ror:8 row_mask:0xf bank_mask:0x3
    v_or3_b32 v248, v248, v70, v71
    v_add_f32_dpp v112, v114, v114 row_half_mirror row_mask:0xf bank_mask:0xa
    ds_write_b128 v5, v[68:71] offset:23680
    s_waitcnt vmcnt(5)
    v_lshlrev_b32 v96, 16, v40
    v_and_b32 v97, s46, v40
    v_dot2_f32_bf16 v118, v40, v220, 0
    v_lshlrev_b32 v98, 16, v41
    v_and_b32 v99, s46, v41
    v_dot2_f32_bf16 v118, v41, v221, v118
    v_lshlrev_b32 v100, 16, v42
    v_and_b32 v101, s46, v42
    v_dot2_f32_bf16 v118, v42, v222, v118
    v_lshlrev_b32 v102, 16, v43
    v_and_b32 v103, s46, v43
    v_dot2_f32_bf16 v118, v43, v223, v118
    v_cvt_pkrtz_f16_f32 v72, v96, v97
    v_cvt_pkrtz_f16_f32 v73, v98, v99
    v_cvt_pkrtz_f16_f32 v74, v100, v101
    v_cvt_pkrtz_f16_f32 v75, v102, v103
    v_or3_b32 v248, v248, v72, v73
    v_add_f32_dpp v116, v117, v117 row_ror:8 row_mask:0xf bank_mask:0xc
    v_or3_b32 v248, v248, v74, v75
    v_add_f32_dpp v112, v112, v112 quad_perm:[1,0,3,2] row_mask:0xf bank_mask:0xf
    ds_write_b128 v5, v[72:75] offset:28416
    s_waitcnt vmcnt(4)
    v_lshlrev_b32 v104, 16, v44
    v_and_b32 v105, s46, v44
    v_dot2_f32_bf16 v119, v44, v220, 0
    v_lshlrev_b32 v106, 16, v45
    v_and_b32 v107, s46, v45
    v_dot2_f32_bf16 v119, v45, v221, v119
    v_lshlrev_b32 v108, 16, v46
    v_and_b32 v109, s46, v46
    v_dot2_f32_bf16 v119, v46, v222, v119
    v_lshlrev_b32 v110, 16, v47
    v_and_b32 v111, s46, v47
    v_dot2_f32_bf16 v119, v47, v223, v119
    v_cvt_pkrtz_f16_f32 v76, v104, v105
    v_cvt_pkrtz_f16_f32 v77, v106, v107
    v_cvt_pkrtz_f16_f32 v78, v108, v109
    v_cvt_pkrtz_f16_f32 v79, v110, v111
    v_or3_b32 v248, v248, v76, v77
    v_add_f32_dpp v116, v116, v116 row_half_mirror row_mask:0xf bank_mask:0x5
    v_or3_b32 v248, v248, v78, v79
    v_add_f32_dpp v118, v118, v118 row_ror:8 row_mask:0xf bank_mask:0x3
    ds_write_b128 v5, v[76:79] offset:33152
    v_cmp_lt_u32 vcc, 31, v1
    v_add_f32_dpp v118, v119, v119 row_ror:8 row_mask:0xf bank_mask:0xc
    v_add_f32_dpp v112, v112, v112 quad_perm:[2,3,0,1] row_mask:0xf bank_mask:0xf
    v_cndmask_b32 v120, v12, v13, vcc
    v_add_f32_dpp v116, v118, v118 row_half_mirror row_mask:0xf bank_mask:0xa
    v_lshlrev_b32 v120, 16, v120
    v_ldexp_f32 v120, v120, v9
    v_add_f32_dpp v116, v116, v116 quad_perm:[1,0,3,2] row_mask:0xf bank_mask:0xf
    ds_write_b32 v3, v248 offset:39424
    ds_write_b32 v8, v120 offset:37888
    v_add_f32_dpp v113, v116, v116 quad_perm:[2,3,0,1] row_mask:0xf bank_mask:0xf
    s_mov_b64 exec, s[42:43]
    ds_write_b64 v7, v[112:113]
    s_mov_b64 exec, -1
    s_waitcnt lgkmcnt(0)
    s_barrier
    ds_read_b128 v[112:115], v127 offset:39424
    ds_read_b64_tr_b16 a[0:1], v6 offset:0
    ds_read_b64_tr_b16 a[2:3], v6 offset:1152
    ds_read_b64_tr_b16 a[4:5], v6 offset:9472
    ds_read_b64_tr_b16 a[6:7], v6 offset:10624
    ds_read_b64_tr_b16 a[8:9], v6 offset:18944
    ds_read_b64_tr_b16 a[10:11], v6 offset:20096
    ds_read_b64_tr_b16 a[12:13], v6 offset:28416
    ds_read_b64_tr_b16 a[14:15], v6 offset:29568
    ds_read_b64_tr_b16 a[16:17], v6 offset:32
    ds_read_b64_tr_b16 a[18:19], v6 offset:1184
    ds_read_b64_tr_b16 a[20:21], v6 offset:9504
    ds_read_b64_tr_b16 a[22:23], v6 offset:10656
    ds_read_b64_tr_b16 a[24:25], v6 offset:18976
    ds_read_b64_tr_b16 a[26:27], v6 offset:20128
    ds_read_b64_tr_b16 a[28:29], v6 offset:28448
    ds_read_b64_tr_b16 a[30:31], v6 offset:29600
    ds_read_b64_tr_b16 a[32:33], v6 offset:64
    ds_read_b64_tr_b16 a[34:35], v6 offset:1216
    ds_read_b64_tr_b16 a[36:37], v6 offset:9536
    ds_read_b64_tr_b16 a[38:39], v6 offset:10688
    ds_read_b64_tr_b16 a[40:41], v6 offset:19008
    ds_read_b64_tr_b16 a[42:43], v6 offset:20160
    ds_read_b64_tr_b16 a[44:45], v6 offset:28480
    ds_read_b64_tr_b16 a[46:47], v6 offset:29632
    s_waitcnt lgkmcnt(15)
    v_or3_b32 v112, v112, v113, v114
    v_or_b32 v112, v112, v115
    v_and_b32 v121, s52, v112
    v_and_b32 v122, 0x20002000, v112
    v_cmp_ne_u32 vcc, 0, v121
    v_cmp_ge_u32 s[92:93], v122, s53
    s_cbranch_vccnz L_wfix
    s_cmp_eq_u64 s[92:93], 0
    s_cbranch_scc1 L_wfix
    buffer_load_dwordx4 v[160:163], v208, s[56:59], 0 offen
    buffer_load_dwordx4 v[164:167], v209, s[56:59], 0 offen
    buffer_load_dwordx4 v[168:171], v210, s[56:59], 0 offen
    ds_read_b128 v[16:19], v15 offset:37888
    ds_read_b128 v[20:23], v15 offset:37952
    ds_read_b128 v[24:27], v15 offset:38016
    ds_read_b128 v[28:31], v15 offset:38080
    ds_read_b128 v[32:35], v15 offset:38144
    ds_read_b128 v[36:39], v15 offset:38208
    ds_read_b128 v[40:43], v15 offset:38272
    ds_read_b128 v[44:47], v15 offset:38336
    ds_read_b128 v[48:51], v15 offset:38400
    ds_read_b128 v[52:55], v15 offset:38464
    ds_read_b128 v[56:59], v15 offset:38528
    ds_read_b64_tr_b16 a[48:49], v6 offset:96
    ds_read_b64_tr_b16 a[50:51], v6 offset:1248
    ds_read_b64_tr_b16 a[52:53], v6 offset:9568
    ds_read_b64_tr_b16 a[54:55], v6 offset:10720
    ds_read_b64_tr_b16 a[56:57], v6 offset:19040
    ds_read_b64_tr_b16 a[58:59], v6 offset:20192
    ds_read_b64_tr_b16 a[60:61], v6 offset:28512
    ds_read_b64_tr_b16 a[62:63], v6 offset:29664
    ds_read_b128 v[60:63], v15 offset:38592
    ds_read_b64_tr_b16 a[64:65], v6 offset:128
    ds_read_b64_tr_b16 a[66:67], v6 offset:1280
    ds_read_b64_tr_b16 a[68:69], v6 offset:9600
    ds_read_b64_tr_b16 a[70:71], v6 offset:10752
    ds_read_b64_tr_b16 a[72:73], v6 offset:19072
    ds_read_b64_tr_b16 a[74:75], v6 offset:20224
    ds_read_b64_tr_b16 a[76:77], v6 offset:28544
    ds_read_b64_tr_b16 a[78:79], v6 offset:29696
    ds_read_b128 v[64:67], v15 offset:38656
    ds_read_b64_tr_b16 a[80:81], v6 offset:160
    ds_read_b64_tr_b16 a[82:83], v6 offset:1312
    ds_read_b64_tr_b16 a[84:85], v6 offset:9632
    ds_read_b64_tr_b16 a[86:87], v6 offset:10784
    ds_read_b64_tr_b16 a[88:89], v6 offset:19104
    ds_read_b64_tr_b16 a[90:91], v6 offset:20256
    ds_read_b64_tr_b16 a[92:93], v6 offset:28576
    ds_read_b64_tr_b16 a[94:95], v6 offset:29728
    ds_read_b128 v[68:71], v15 offset:38720
    ds_read_b64_tr_b16 a[96:97], v6 offset:192
    ds_read_b64_tr_b16 a[98:99], v6 offset:1344
    ds_read_b64_tr_b16 a[100:101], v6 offset:9664
    ds_read_b64_tr_b16 a[102:103], v6 offset:10816
    ds_read_b64_tr_b16 a[104:105], v6 offset:19136
    ds_read_b64_tr_b16 a[106:107], v6 offset:20288
    ds_read_b64_tr_b16 a[108:109], v6 offset:28608
    ds_read_b64_tr_b16 a[110:111], v6 offset:29760
    ds_read_b128 v[72:75], v15 offset:38784
    ds_read_b64_tr_b16 a[112:113], v6 offset:224
    ds_read_b64_tr_b16 a[114:115], v6 offset:1376
    ds_read_b64_tr_b16 a[116:117], v6 offset:9696
    ds_read_b64_tr_b16 a[118:119], v6 offset:10848
    ds_read_b64_tr_b16 a[120:121], v6 offset:19168
    ds_read_b64_tr_b16 a[122:123], v6 offset:20320
    ds_read_b64_tr_b16 a[124:125], v6 offset:28640
    ds_read_b64_tr_b16 a[126:127], v6 offset:29792
    ds_read_b128 v[76:79], v15 offset:38848
L_econv:
    s_waitcnt vmcnt(6)
    v_lshl_add_u32 v96, v144, 16, s48
    v_add_u32_sdwa v97, v144, s49 dst_sel:WORD_1 dst_unused:UNUSED_PAD src0_sel:WORD_1 src1_sel:DWORD
    v_lshl_add_u32 v98, v145, 16, s48
    v_add_u32_sdwa v99, v145, s49 dst_sel:WORD_1 dst_unused:UNUSED_PAD src0_sel:WORD_1 src1_sel:DWORD
    v_lshl_add_u32 v100, v146, 16, s48
    v_add_u32_sdwa v101, v146, s49 dst_sel:WORD_1 dst_unused:UNUSED_PAD src0_sel:WORD_1 src1_sel:DWORD
    v_lshl_add_u32 v102, v147, 16, s48
    v_add_u32_sdwa v103, v147, s49 dst_sel:WORD_1 dst_unused:UNUSED_PAD src0_sel:WORD_1 src1_sel:DWORD
    v_cvt_pkrtz_f16_f32 v172, v96, v97
    v_max_f32 v248, |v96|, |v97|
    v_cvt_pkrtz_f16_f32 v173, v98, v99
    v_max_f32 v249, |v98|, |v99|
    v_cvt_pkrtz_f16_f32 v174, v100, v101
    v_max3_f32 v248, v248, |v100|, |v101|
    v_cvt_pkrtz_f16_f32 v175, v102, v103
    v_max3_f32 v249, v249, |v102|, |v103|
    ds_write_b128 v203, v[172:175] offset:0
    s_waitcnt vmcnt(5)
    v_lshl_add_u32 v104, v148, 16, s48
    v_add_u32_sdwa v105, v148, s49 dst_sel:WORD_1 dst_unused:UNUSED_PAD src0_sel:WORD_1 src1_sel:DWORD
    v_lshl_add_u32 v106, v149, 16, s48
    v_add_u32_sdwa v107, v149, s49 dst_sel:WORD_1 dst_unused:UNUSED_PAD src0_sel:WORD_1 src1_sel:DWORD
    v_lshl_add_u32 v108, v150, 16, s48
    v_add_u32_sdwa v109, v150, s49 dst_sel:WORD_1 dst_unused:UNUSED_PAD src0_sel:WORD_1 src1_sel:DWORD
    v_lshl_add_u32 v110, v151, 16, s48
    v_add_u32_sdwa v111, v151, s49 dst_sel:WORD_1 dst_unused:UNUSED_PAD src0_sel:WORD_1 src1_sel:DWORD
    v_cvt_pkrtz_f16_f32 v176, v104, v105
    v_max3_f32 v248, v248, |v104|, |v105|
    v_cvt_pkrtz_f16_f32 v177, v106, v107
    v_max3_f32 v249, v249, |v106|, |v107|
    v_cvt_pkrtz_f16_f32 v178, v108, v109
    v_max3_f32 v248, v248, |v108|, |v109|
    v_cvt_pkrtz_f16_f32 v179, v110, v111
    v_max3_f32 v249, v249, |v110|, |v111|
    ds_write_b128 v203, v[176:179] offset:1152
    s_waitcnt vmcnt(4)
    v_lshl_add_u32 v96, v152, 16, s48
    v_add_u32_sdwa v97, v152, s49 dst_sel:WORD_1 dst_unused:UNUSED_PAD src0_sel:WORD_1 src1_sel:DWORD
    v_lshl_add_u32 v98, v153, 16, s48
    v_add_u32_sdwa v99, v153, s49 dst_sel:WORD_1 dst_unused:UNUSED_PAD src0_sel:WORD_1 src1_sel:DWORD
    v_lshl_add_u32 v100, v154, 16, s48
    v_add_u32_sdwa v101, v154, s49 dst_sel:WORD_1 dst_unused:UNUSED_PAD src0_sel:WORD_1 src1_sel:DWORD
    v_lshl_add_u32 v102, v155, 16, s48
    v_add_u32_sdwa v103, v155, s49 dst_sel:WORD_1 dst_unused:UNUSED_PAD src0_sel:WORD_1 src1_sel:DWORD
    v_cvt_pkrtz_f16_f32 v180, v96, v97
    v_max3_f32 v248, v248, |v96|, |v97|
    v_cvt_pkrtz_f16_f32 v181, v98, v99
    v_max3_f32 v249, v249, |v98|, |v99|
    v_cvt_pkrtz_f16_f32 v182, v100, v101
    v_max3_f32 v248, v248, |v100|, |v101|
    v_cvt_pkrtz_f16_f32 v183, v102, v103
    v_max3_f32 v249, v249, |v102|, |v103|
    ds_write_b128 v203, v[180:183] offset:2304
    s_waitcnt vmcnt(3)
    v_lshl_add_u32 v104, v156, 16, s48
    v_add_u32_sdwa v105, v156, s49 dst_sel:WORD_1 dst_unused:UNUSED_PAD src0_sel:WORD_1 src1_sel:DWORD
    v_lshl_add_u32 v106, v157, 16, s48
    v_add_u32_sdwa v107, v157, s49 dst_sel:WORD_1 dst_unused:UNUSED_PAD src0_sel:WORD_1 src1_sel:DWORD
    v_lshl_add_u32 v108, v158, 16, s48
    v_add_u32_sdwa v109, v158, s49 dst_sel:WORD_1 dst_unused:UNUSED_PAD src0_sel:WORD_1 src1_sel:DWORD
    v_lshl_add_u32 v110, v159, 16, s48
    v_add_u32_sdwa v111, v159, s49 dst_sel:WORD_1 dst_unused:UNUSED_PAD src0_sel:WORD_1 src1_sel:DWORD
    v_cvt_pkrtz_f16_f32 v184, v104, v105
    v_max3_f32 v248, v248, |v104|, |v105|
    v_cvt_pkrtz_f16_f32 v185, v106, v107
    v_max3_f32 v249, v249, |v106|, |v107|
    v_cvt_pkrtz_f16_f32 v186, v108, v109
    v_max3_f32 v248, v248, |v108|, |v109|
    v_cvt_pkrtz_f16_f32 v187, v110, v111
    v_max3_f32 v249, v249, |v110|, |v111|
    ds_write_b128 v203, v[184:187] offset:3456
    ds_read_b128 v[80:83], v246 offset:0
    ds_read_b128 v[128:131], v201 offset:0
    ds_read_b128 v[84:87], v246 offset:64
    ds_read_b128 v[132:135], v201 offset:64
    ds_read_b128 v[88:91], v246 offset:128
    ds_read_b128 v[136:139], v201 offset:128
    ds_read_b128 v[92:95], v246 offset:192
    ds_read_b128 v[140:143], v201 offset:192
    s_waitcnt lgkmcnt(6)
    v_pk_mul_f16 v128, v128, v80
    v_pk_mul_f16 v129, v129, v81
    v_pk_mul_f16 v130, v130, v82
    v_pk_mul_f16 v131, v131, v83
    s_nop 1
    v_mfma_f32_16x16x32_f16 v[96:99], a[0:3], v[128:131], v[16:19]
    s_waitcnt lgkmcnt(4)
    v_pk_mul_f16 v132, v132, v84
    v_pk_mul_f16 v133, v133, v85
    v_mfma_f32_16x16x32_f16 v[100:103], a[16:19], v[128:131], v[20:23]
    v_pk_mul_f16 v134, v134, v86
    v_pk_mul_f16 v135, v135, v87
    v_mfma_f32_16x16x32_f16 v[104:107], a[32:35], v[128:131], v[24:27]
    s_waitcnt lgkmcnt(2)
    v_pk_mul_f16 v136, v136, v88
    v_pk_mul_f16 v137, v137, v89
    v_mfma_f32_16x16x32_f16 v[96:99], a[4:7], v[132:135], v[96:99]
    v_pk_mul_f16 v138, v138, v90
    v_pk_mul_f16 v139, v139, v91
    v_mfma_f32_16x16x32_f16 v[100:103], a[20:23], v[132:135], v[100:103]
    s_waitcnt lgkmcnt(0)
    v_pk_mul_f16 v140, v140, v92
    v_pk_mul_f16 v141, v141, v93
    v_mfma_f32_16x16x32_f16 v[104:107], a[36:39], v[132:135], v[104:107]
    v_pk_mul_f16 v142, v142, v94
    v_pk_mul_f16 v143, v143, v95
    v_mov_b32_dpp v247, v246 row_ror:14 row_mask:0xf bank_mask:0xf
    ds_read_b128 v[156:159], v247 offset:192
    ds_read_b128 v[152:155], v247 offset:128
    ds_read_b128 v[148:151], v247 offset:64
    ds_read_b128 v[144:147], v247 offset:0
    v_mfma_f32_16x16x32_f16 v[96:99], a[8:11], v[136:139], v[96:99]
    ds_read2_b32 v[192:193], v10 offset0:0 offset1:8
    v_mov_b32 v251, 0xff800000
    v_mfma_f32_16x16x32_f16 v[100:103], a[24:27], v[136:139], v[100:103]
    v_mfma_f32_16x16x32_f16 v[104:107], a[40:43], v[136:139], v[104:107]
    v_mfma_f32_16x16x32_f16 v[96:99], a[12:15], v[140:143], v[96:99]
    v_mfma_f32_16x16x32_f16 v[100:103], a[28:31], v[140:143], v[100:103]
    v_mfma_f32_16x16x32_f16 v[104:107], a[44:47], v[140:143], v[104:107]
    v_mfma_f32_16x16x32_f16 v[108:111], a[48:51], v[128:131], v[28:31]
    v_mfma_f32_16x16x32_f16 v[108:111], a[52:55], v[132:135], v[108:111]
    v_mfma_f32_16x16x32_f16 v[108:111], a[56:59], v[136:139], v[108:111]
    s_waitcnt lgkmcnt(1)
    v_pk_mul_f16 v144, v144, v80
    v_pk_mul_f16 v145, v145, v81
    v_mfma_f32_16x16x32_f16 v[108:111], a[60:63], v[140:143], v[108:111]
    v_and_b32 v253, s44, v252
    v_mul_f32 v184, |v96|, v48
    v_mfma_f32_16x16x32_f16 v[112:115], a[64:67], v[128:131], v[32:35]
    v_pk_max_u16 v254, v253, v253 op_sel:[0,1] op_sel_hi:[1,0]
    v_fma_f32 v184, |v97|, v49, v184
    v_mfma_f32_16x16x32_f16 v[112:115], a[68:71], v[132:135], v[112:115]
    v_pk_mul_f16 v146, v146, v82
    v_fma_f32 v184, |v98|, v50, v184
    v_mfma_f32_16x16x32_f16 v[112:115], a[72:75], v[136:139], v[112:115]
    v_pk_mul_f16 v147, v147, v83
    v_fma_f32 v184, |v99|, v51, v184
    v_mfma_f32_16x16x32_f16 v[112:115], a[76:79], v[140:143], v[112:115]
    v_pk_mul_f16 v148, v148, v84
    v_fma_f32 v184, |v100|, v52, v184
    v_mfma_f32_16x16x32_f16 v[116:119], a[80:83], v[128:131], v[36:39]
    v_pk_mul_f16 v149, v149, v85
    v_fma_f32 v184, |v101|, v53, v184
    v_mfma_f32_16x16x32_f16 v[116:119], a[84:87], v[132:135], v[116:119]
    v_pk_mul_f16 v150, v150, v86
    v_fma_f32 v184, |v102|, v54, v184
    v_mfma_f32_16x16x32_f16 v[116:119], a[88:91], v[136:139], v[116:119]
    v_pk_mul_f16 v151, v151, v87
    v_fma_f32 v184, |v103|, v55, v184
    v_mfma_f32_16x16x32_f16 v[116:119], a[92:95], v[140:143], v[116:119]
    v_pk_mul_f16 v152, v152, v88
    v_fma_f32 v184, |v104|, v56, v184
    v_mfma_f32_16x16x32_f16 v[120:123], a[96:99], v[128:131], v[40:43]
    v_pk_mul_f16 v153, v153, v89
    v_fma_f32 v184, |v105|, v57, v184
    v_mfma_f32_16x16x32_f16 v[120:123], a[100:103], v[132:135], v[120:123]
    v_pk_mul_f16 v154, v154, v90
    v_fma_f32 v184, |v106|, v58, v184
    v_mfma_f32_16x16x32_f16 v[120:123], a[104:107], v[136:139], v[120:123]
    v_pk_mul_f16 v155, v155, v91
    v_fma_f32 v184, |v107|, v59, v184
    v_mfma_f32_16x16x32_f16 v[120:123], a[108:111], v[140:143], v[120:123]
    v_pk_mul_f16 v156, v156, v92
    v_fma_f32 v184, |v108|, v60, v184
    v_mfma_f32_16x16x32_f16 v[124:127], a[112:115], v[128:131], v[44:47]
    v_pk_mul_f16 v157, v157, v93
    v_fma_f32 v184, |v109|, v61, v184
    v_mfma_f32_16x16x32_f16 v[124:127], a[116:119], v[132:135], v[124:127]
    v_pk_mul_f16 v158, v158, v94
    v_fma_f32 v184, |v110|, v62, v184
    v_mfma_f32_16x16x32_f16 v[124:127], a[120:123], v[136:139], v[124:127]
    v_pk_mul_f16 v159, v159, v95
    v_fma_f32 v184, |v111|, v63, v184
    v_mfma_f32_16x16x32_f16 v[124:127], a[124:127], v[140:143], v[124:127]
    v_mov_b32_dpp v247, v246 row_ror:13 row_mask:0xf bank_mask:0xf
    v_fma_f32 v184, |v112|, v64, v184
    v_mfma_f32_16x16x32_f16 v[96:99], a[0:3], v[144:147], v[16:19]
    ds_read_b128 v[140:143], v247 offset:192
    v_fma_f32 v184, |v113|, v65, v184
    v_mfma_f32_16x16x32_f16 v[96:99], a[4:7], v[148:151], v[96:99]
    ds_read_b128 v[136:139], v247 offset:128
    v_fma_f32 v184, |v114|, v66, v184
    v_mfma_f32_16x16x32_f16 v[96:99], a[8:11], v[152:155], v[96:99]
    ds_read_b128 v[132:135], v247 offset:64
    v_fma_f32 v184, |v115|, v67, v184
    v_mfma_f32_16x16x32_f16 v[96:99], a[12:15], v[156:159], v[96:99]
    ds_read_b128 v[128:131], v247 offset:0
    v_fma_f32 v184, |v116|, v68, v184
    v_mfma_f32_16x16x32_f16 v[100:103], a[16:19], v[144:147], v[20:23]
    s_waitcnt lgkmcnt(4)
    v_max_f32 v255, |v192|, |v193|
    v_fma_f32 v184, |v117|, v69, v184
    v_mfma_f32_16x16x32_f16 v[100:103], a[20:23], v[148:151], v[100:103]
    v_max_u32_dpp v254, v254, v254 row_ror:8 row_mask:0xf bank_mask:0xf
    v_fma_f32 v184, |v118|, v70, v184
    v_mfma_f32_16x16x32_f16 v[100:103], a[24:27], v[152:155], v[100:103]
L_pad0:
    s_cbranch_execz L_hopret
    v_max_u32_dpp v255, v255, v255 row_ror:8 row_mask:0xf bank_mask:0xf
    v_fma_f32 v184, |v119|, v71, v184
    v_mfma_f32_16x16x32_f16 v[100:103], a[28:31], v[156:159], v[100:103]
    v_max_u32_dpp v254, v254, v254 row_ror:4 row_mask:0xf bank_mask:0xf
    v_fma_f32 v184, |v120|, v72, v184
    v_mfma_f32_16x16x32_f16 v[104:107], a[32:35], v[144:147], v[24:27]
    s_waitcnt vmcnt(2)
    v_lshl_add_u32 v220, v160, 16, s48
    v_fma_f32 v184, |v121|, v73, v184
    v_mfma_f32_16x16x32_f16 v[104:107], a[36:39], v[148:151], v[104:107]
    v_add_u32_sdwa v221, v160, s49 dst_sel:WORD_1 dst_unused:UNUSED_PAD src0_sel:WORD_1 src1_sel:DWORD
    v_fma_f32 v184, |v122|, v74, v184
    v_mfma_f32_16x16x32_f16 v[104:107], a[40:43], v[152:155], v[104:107]
    v_lshl_add_u32 v222, v161, 16, s48
    v_fma_f32 v184, |v123|, v75, v184
    v_mfma_f32_16x16x32_f16 v[104:107], a[44:47], v[156:159], v[104:107]
    v_add_u32_sdwa v223, v161, s49 dst_sel:WORD_1 dst_unused:UNUSED_PAD src0_sel:WORD_1 src1_sel:DWORD
    v_fma_f32 v184, |v124|, v76, v184
    v_mfma_f32_16x16x32_f16 v[108:111], a[48:51], v[144:147], v[28:31]
    v_lshl_add_u32 v224, v162, 16, s48
    v_fma_f32 v184, |v125|, v77, v184
    v_mfma_f32_16x16x32_f16 v[108:111], a[52:55], v[148:151], v[108:111]
    v_add_u32_sdwa v225, v162, s49 dst_sel:WORD_1 dst_unused:UNUSED_PAD src0_sel:WORD_1 src1_sel:DWORD
    v_fma_f32 v184, |v126|, v78, v184
    v_mfma_f32_16x16x32_f16 v[108:111], a[56:59], v[152:155], v[108:111]
    v_lshl_add_u32 v226, v163, 16, s48
    v_fma_f32 v184, |v127|, v79, v184
    v_mfma_f32_16x16x32_f16 v[108:111], a[60:63], v[156:159], v[108:111]
    s_waitcnt lgkmcnt(0)
    v_pk_mul_f16 v128, v128, v80
    v_mul_f32 v185, |v96|, v48
    v_mfma_f32_16x16x32_f16 v[112:115], a[64:67], v[144:147], v[32:35]
    v_pk_mul_f16 v129, v129, v81
    v_fma_f32 v185, |v97|, v49, v185
    v_mfma_f32_16x16x32_f16 v[112:115], a[68:71], v[148:151], v[112:115]
    v_pk_mul_f16 v130, v130, v82
    v_fma_f32 v185, |v98|, v50, v185
    v_mfma_f32_16x16x32_f16 v[112:115], a[72:75], v[152:155], v[112:115]
    v_pk_mul_f16 v131, v131, v83
    v_fma_f32 v185, |v99|, v51, v185
    v_mfma_f32_16x16x32_f16 v[112:115], a[76:79], v[156:159], v[112:115]
    v_pk_mul_f16 v132, v132, v84
    v_fma_f32 v185, |v100|, v52, v185
    v_mfma_f32_16x16x32_f16 v[116:119], a[80:83], v[144:147], v[36:39]
    v_pk_mul_f16 v133, v133, v85
    v_fma_f32 v185, |v101|, v53, v185
    v_mfma_f32_16x16x32_f16 v[116:119], a[84:87], v[148:151], v[116:119]
    v_pk_mul_f16 v134, v134, v86
    v_fma_f32 v185, |v102|, v54, v185
    v_mfma_f32_16x16x32_f16 v[116:119], a[88:91], v[152:155], v[116:119]
    v_pk_mul_f16 v135, v135, v87
    v_fma_f32 v185, |v103|, v55, v185
    v_mfma_f32_16x16x32_f16 v[116:119], a[92:95], v[156:159], v[116:119]
    v_pk_mul_f16 v136, v136, v88
    v_fma_f32 v185, |v104|, v56, v185
    v_mfma_f32_16x16x32_f16 v[120:123], a[96:99], v[144:147], v[40:43]
    v_pk_mul_f16 v137, v137, v89
    v_fma_f32 v185, |v105|, v57, v185
    v_mfma_f32_16x16x32_f16 v[120:123], a[100:103], v[148:151], v[120:123]
    v_pk_mul_f16 v138, v138, v90
    v_fma_f32 v185, |v106|, v58, v185
    v_mfma_f32_16x16x32_f16 v[120:123], a[104:107], v[152:155], v[120:123]
    v_pk_mul_f16 v139, v139, v91
    v_fma_f32 v185, |v107|, v59, v185
    v_mfma_f32_16x16x32_f16 v[120:123], a[108:111], v[156:159], v[120:123]
    v_pk_mul_f16 v140, v140, v92
    v_fma_f32 v185, |v108|, v60, v185
    v_mfma_f32_16x16x32_f16 v[124:127], a[112:115], v[144:147], v[44:47]
    v_pk_mul_f16 v141, v141, v93
    v_fma_f32 v185, |v109|, v61, v185
    v_mfma_f32_16x16x32_f16 v[124:127], a[116:119], v[148:151], v[124:127]
    v_pk_mul_f16 v142, v142, v94
    v_fma_f32 v185, |v110|, v62, v185
    v_mfma_f32_16x16x32_f16 v[124:127], a[120:123], v[152:155], v[124:127]
    v_pk_mul_f16 v143, v143, v95
    v_fma_f32 v185, |v111|, v63, v185
    v_mfma_f32_16x16x32_f16 v[124:127], a[124:127], v[156:159], v[124:127]
    v_mov_b32_dpp v247, v246 row_ror:12 row_mask:0xf bank_mask:0xf
    v_fma_f32 v185, |v112|, v64, v185
    v_mfma_f32_16x16x32_f16 v[96:99], a[0:3], v[128:131], v[16:19]
    ds_read_b128 v[156:159], v247 offset:192
    v_fma_f32 v185, |v113|, v65, v185
    v_mfma_f32_16x16x32_f16 v[96:99], a[4:7], v[132:135], v[96:99]
    ds_read_b128 v[152:155], v247 offset:128
    v_fma_f32 v185, |v114|, v66, v185
    v_mfma_f32_16x16x32_f16 v[96:99], a[8:11], v[136:139], v[96:99]
    ds_read_b128 v[148:151], v247 offset:64
    v_fma_f32 v185, |v115|, v67, v185
    v_mfma_f32_16x16x32_f16 v[96:99], a[12:15], v[140:143], v[96:99]
    ds_read_b128 v[144:147], v247 offset:0
    v_fma_f32 v185, |v116|, v68, v185
    v_mfma_f32_16x16x32_f16 v[100:103], a[16:19], v[128:131], v[20:23]
    v_add_u32_sdwa v227, v163, s49 dst_sel:WORD_1 dst_unused:UNUSED_PAD src0_sel:WORD_1 src1_sel:DWORD
    v_fma_f32 v185, |v117|, v69, v185
    v_mfma_f32_16x16x32_f16 v[100:103], a[20:23], v[132:135], v[100:103]
    v_cvt_pkrtz_f16_f32 v204, v220, v221
    v_fma_f32 v185, |v118|, v70, v185
    v_mfma_f32_16x16x32_f16 v[100:103], a[24:27], v[136:139], v[100:103]
    v_max3_f32 v248, v248, |v220|, |v221|
    v_fma_f32 v185, |v119|, v71, v185
    v_mfma_f32_16x16x32_f16 v[100:103], a[28:31], v[140:143], v[100:103]
    v_cvt_pkrtz_f16_f32 v205, v222, v223
    v_fma_f32 v185, |v120|, v72, v185
    v_mfma_f32_16x16x32_f16 v[104:107], a[32:35], v[128:131], v[24:27]
    v_max3_f32 v249, v249, |v222|, |v223|
    v_fma_f32 v185, |v121|, v73, v185
    v_mfma_f32_16x16x32_f16 v[104:107], a[36:39], v[132:135], v[104:107]
    v_cvt_pkrtz_f16_f32 v206, v224, v225
    v_fma_f32 v185, |v122|, v74, v185
    v_mfma_f32_16x16x32_f16 v[104:107], a[40:43], v[136:139], v[104:107]
    v_max3_f32 v248, v248, |v224|, |v225|
    v_fma_f32 v185, |v123|, v75, v185
    v_mfma_f32_16x16x32_f16 v[104:107], a[44:47], v[140:143], v[104:107]
    v_cvt_pkrtz_f16_f32 v207, v226, v227
    v_fma_f32 v185, |v124|, v76, v185
    v_mfma_f32_16x16x32_f16 v[108:111], a[48:51], v[128:131], v[28:31]
    v_max3_f32 v249, v249, |v226|, |v227|
    v_fma_f32 v185, |v125|, v77, v185
    v_mfma_f32_16x16x32_f16 v[108:111], a[52:55], v[132:135], v[108:111]
    ds_write_b128 v203, v[204:207] offset:4608
    v_mfma_f32_16x16x32_f16 v[108:111], a[56:59], v[136:139], v[108:111]
    s_waitcnt vmcnt(1)
    v_lshl_add_u32 v220, v164, 16, s48
    v_fma_f32 v185, |v126|, v78, v185
    v_mfma_f32_16x16x32_f16 v[108:111], a[60:63], v[140:143], v[108:111]
    s_waitcnt lgkmcnt(1)
    v_pk_mul_f16 v144, v144, v80
    v_fma_f32 v185, |v127|, v79, v185
    v_mfma_f32_16x16x32_f16 v[112:115], a[64:67], v[128:131], v[32:35]
    v_pk_mul_f16 v145, v145, v81
    v_mul_f32 v186, |v96|, v48
    v_mfma_f32_16x16x32_f16 v[112:115], a[68:71], v[132:135], v[112:115]
    v_pk_mul_f16 v146, v146, v82
    v_fma_f32 v186, |v97|, v49, v186
    v_mfma_f32_16x16x32_f16 v[112:115], a[72:75], v[136:139], v[112:115]
    v_pk_mul_f16 v147, v147, v83
    v_fma_f32 v186, |v98|, v50, v186
    v_mfma_f32_16x16x32_f16 v[112:115], a[76:79], v[140:143], v[112:115]
    v_pk_mul_f16 v148, v148, v84
    v_fma_f32 v186, |v99|, v51, v186
    v_mfma_f32_16x16x32_f16 v[116:119], a[80:83], v[128:131], v[36:39]
    v_pk_mul_f16 v149, v149, v85
    v_fma_f32 v186, |v100|, v52, v186
    v_mfma_f32_16x16x32_f16 v[116:119], a[84:87], v[132:135], v[116:119]
    v_pk_mul_f16 v150, v150, v86
    v_fma_f32 v186, |v101|, v53, v186
    v_mfma_f32_16x16x32_f16 v[116:119], a[88:91], v[136:139], v[116:119]
    v_pk_mul_f16 v151, v151, v87
    v_fma_f32 v186, |v102|, v54, v186
    v_mfma_f32_16x16x32_f16 v[116:119], a[92:95], v[140:143], v[116:119]
    v_pk_mul_f16 v152, v152, v88
    v_fma_f32 v186, |v103|, v55, v186
    v_mfma_f32_16x16x32_f16 v[120:123], a[96:99], v[128:131], v[40:43]
    v_pk_mul_f16 v153, v153, v89
    v_fma_f32 v186, |v104|, v56, v186
    v_mfma_f32_16x16x32_f16 v[120:123], a[100:103], v[132:135], v[120:123]
    v_pk_mul_f16 v154, v154, v90
    v_fma_f32 v186, |v105|, v57, v186
    v_mfma_f32_16x16x32_f16 v[120:123], a[104:107], v[136:139], v[120:123]
    v_pk_mul_f16 v155, v155, v91
    v_fma_f32 v186, |v106|, v58, v186
    v_mfma_f32_16x16x32_f16 v[120:123], a[108:111], v[140:143], v[120:123]
    v_pk_mul_f16 v156, v156, v92
    v_fma_f32 v186, |v107|, v59, v186
    v_mfma_f32_16x16x32_f16 v[124:127], a[112:115], v[128:131], v[44:47]
    v_pk_mul_f16 v157, v157, v93
    v_fma_f32 v186, |v108|, v60, v186
    v_mfma_f32_16x16x32_f16 v[124:127], a[116:119], v[132:135], v[124:127]
    v_pk_mul_f16 v158, v158, v94
    v_fma_f32 v186, |v109|, v61, v186
    v_mfma_f32_16x16x32_f16 v[124:127], a[120:123], v[136:139], v[124:127]
    v_pk_mul_f16 v159, v159, v95
    v_fma_f32 v186, |v110|, v62, v186
    v_mfma_f32_16x16x32_f16 v[124:127], a[124:127], v[140:143], v[124:127]
    v_mov_b32_dpp v247, v246 row_ror:11 row_mask:0xf bank_mask:0xf
    v_fma_f32 v186, |v111|, v63, v186
    v_mfma_f32_16x16x32_f16 v[96:99], a[0:3], v[144:147], v[16:19]
    ds_read_b128 v[140:143], v247 offset:192
    v_fma_f32 v186, |v112|, v64, v186
    v_mfma_f32_16x16x32_f16 v[96:99], a[4:7], v[148:151], v[96:99]
    ds_read_b128 v[136:139], v247 offset:128
    v_fma_f32 v186, |v113|, v65, v186
    v_mfma_f32_16x16x32_f16 v[96:99], a[8:11], v[152:155], v[96:99]
    ds_read_b128 v[132:135], v247 offset:64
    v_fma_f32 v186, |v114|, v66, v186
    v_mfma_f32_16x16x32_f16 v[96:99], a[12:15], v[156:159], v[96:99]
    ds_read_b128 v[128:131], v247 offset:0
    v_fma_f32 v186, |v115|, v67, v186
    v_mfma_f32_16x16x32_f16 v[100:103], a[16:19], v[144:147], v[20:23]
    v_add_u32_sdwa v221, v164, s49 dst_sel:WORD_1 dst_unused:UNUSED_PAD src0_sel:WORD_1 src1_sel:DWORD
    v_fma_f32 v186, |v116|, v68, v186
    v_mfma_f32_16x16x32_f16 v[100:103], a[20:23], v[148:151], v[100:103]
    v_lshl_add_u32 v222, v165, 16, s48
    v_fma_f32 v186, |v117|, v69, v186
    v_mfma_f32_16x16x32_f16 v[100:103], a[24:27], v[152:155], v[100:103]
    v_add_u32_sdwa v223, v165, s49 dst_sel:WORD_1 dst_unused:UNUSED_PAD src0_sel:WORD_1 src1_sel:DWORD
    v_fma_f32 v186, |v118|, v70, v186
    v_mfma_f32_16x16x32_f16 v[100:103], a[28:31], v[156:159], v[100:103]
    v_lshl_add_u32 v224, v166, 16, s48
    v_fma_f32 v186, |v119|, v71, v186
    v_mfma_f32_16x16x32_f16 v[104:107], a[32:35], v[144:147], v[24:27]
    v_add_u32_sdwa v225, v166, s49 dst_sel:WORD_1 dst_unused:UNUSED_PAD src0_sel:WORD_1 src1_sel:DWORD
    v_fma_f32 v186, |v120|, v72, v186
    v_mfma_f32_16x16x32_f16 v[104:107], a[36:39], v[148:151], v[104:107]
    v_lshl_add_u32 v226, v167, 16, s48
    v_fma_f32 v186, |v121|, v73, v186
    v_mfma_f32_16x16x32_f16 v[104:107], a[40:43], v[152:155], v[104:107]
    v_add_u32_sdwa v227, v167, s49 dst_sel:WORD_1 dst_unused:UNUSED_PAD src0_sel:WORD_1 src1_sel:DWORD
    v_fma_f32 v186, |v122|, v74, v186
    v_mfma_f32_16x16x32_f16 v[104:107], a[44:47], v[156:159], v[104:107]
    v_cvt_pkrtz_f16_f32 v208, v220, v221
    v_fma_f32 v186, |v123|, v75, v186
    v_mfma_f32_16x16x32_f16 v[108:111], a[48:51], v[144:147], v[28:31]
    v_max3_f32 v248, v248, |v220|, |v221|
    v_fma_f32 v186, |v124|, v76, v186
    v_mfma_f32_16x16x32_f16 v[108:111], a[52:55], v[148:151], v[108:111]
    v_cvt_pkrtz_f16_f32 v209, v222, v223
    v_fma_f32 v186, |v125|, v77, v186
    v_mfma_f32_16x16x32_f16 v[108:111], a[56:59], v[152:155], v[108:111]
    v_max3_f32 v249, v249, |v222|, |v223|
    v_fma_f32 v186, |v126|, v78, v186
    v_mfma_f32_16x16x32_f16 v[108:111], a[60:63], v[156:159], v[108:111]
    s_waitcnt lgkmcnt(0)
    v_pk_mul_f16 v128, v128, v80
    v_fma_f32 v186, |v127|, v79, v186
    v_mfma_f32_16x16x32_f16 v[112:115], a[64:67], v[144:147], v[32:35]
    v_pk_mul_f16 v129, v129, v81
    v_mul_f32 v187, |v96|, v48
    v_mfma_f32_16x16x32_f16 v[112:115], a[68:71], v[148:151], v[112:115]
    v_pk_mul_f16 v130, v130, v82
    v_fma_f32 v187, |v97|, v49, v187
    v_mfma_f32_16x16x32_f16 v[112:115], a[72:75], v[152:155], v[112:115]
    v_pk_mul_f16 v131, v131, v83
    v_fma_f32 v187, |v98|, v50, v187
    v_mfma_f32_16x16x32_f16 v[112:115], a[76:79], v[156:159], v[112:115]
    v_pk_mul_f16 v132, v132, v84
    v_fma_f32 v187, |v99|, v51, v187
    v_mfma_f32_16x16x32_f16 v[116:119], a[80:83], v[144:147], v[36:39]
    v_pk_mul_f16 v133, v133, v85
    v_fma_f32 v187, |v100|, v52, v187
    v_mfma_f32_16x16x32_f16 v[116:119], a[84:87], v[148:151], v[116:119]
    v_pk_mul_f16 v134, v134, v86
    v_fma_f32 v187, |v101|, v53, v187
    v_mfma_f32_16x16x32_f16 v[116:119], a[88:91], v[152:155], v[116:119]
    v_pk_mul_f16 v135, v135, v87
    v_fma_f32 v187, |v102|, v54, v187
    v_mfma_f32_16x16x32_f16 v[116:119], a[92:95], v[156:159], v[116:119]
    v_pk_mul_f16 v136, v136, v88
    v_fma_f32 v187, |v103|, v55, v187
    v_mfma_f32_16x16x32_f16 v[120:123], a[96:99], v[144:147], v[40:43]
    v_pk_mul_f16 v137, v137, v89
    v_fma_f32 v187, |v104|, v56, v187
    v_mfma_f32_16x16x32_f16 v[120:123], a[100:103], v[148:151], v[120:123]
    v_pk_mul_f16 v138, v138, v90
    v_fma_f32 v187, |v105|, v57, v187
    v_mfma_f32_16x16x32_f16 v[120:123], a[104:107], v[152:155], v[120:123]
    v_pk_mul_f16 v139, v139, v91
    v_fma_f32 v187, |v106|, v58, v187
    v_mfma_f32_16x16x32_f16 v[120:123], a[108:111], v[156:159], v[120:123]
    v_pk_mul_f16 v140, v140, v92
    v_fma_f32 v187, |v107|, v59, v187
    v_mfma_f32_16x16x32_f16 v[124:127], a[112:115], v[144:147], v[44:47]
    v_pk_mul_f16 v141, v141, v93
    v_fma_f32 v187, |v108|, v60, v187
    v_mfma_f32_16x16x32_f16 v[124:127], a[116:119], v[148:151], v[124:127]
    v_pk_mul_f16 v142, v142, v94
    v_fma_f32 v187, |v109|, v61, v187
    v_mfma_f32_16x16x32_f16 v[124:127], a[120:123], v[152:155], v[124:127]
    v_pk_mul_f16 v143, v143, v95
    v_fma_f32 v187, |v110|, v62, v187
    v_mfma_f32_16x16x32_f16 v[124:127], a[124:127], v[156:159], v[124:127]
    v_mov_b32_dpp v247, v246 row_ror:10 row_mask:0xf bank_mask:0xf
    v_fma_f32 v187, |v111|, v63, v187
    v_mfma_f32_16x16x32_f16 v[96:99], a[0:3], v[128:131], v[16:19]
    ds_read_b128 v[156:159], v247 offset:192
    v_fma_f32 v187, |v112|, v64, v187
    v_mfma_f32_16x16x32_f16 v[96:99], a[4:7], v[132:135], v[96:99]
    ds_read_b128 v[152:155], v247 offset:128
    v_fma_f32 v187, |v113|, v65, v187
    v_mfma_f32_16x16x32_f16 v[96:99], a[8:11], v[136:139], v[96:99]
    ds_read_b128 v[148:151], v247 offset:64
    v_fma_f32 v187, |v114|, v66, v187
    v_mfma_f32_16x16x32_f16 v[96:99], a[12:15], v[140:143], v[96:99]
    ds_read_b128 v[144:147], v247 offset:0
    v_fma_f32 v187, |v115|, v67, v187
    v_mfma_f32_16x16x32_f16 v[100:103], a[16:19], v[128:131], v[20:23]
    v_cvt_pkrtz_f16_f32 v210, v224, v225
    v_fma_f32 v187, |v116|, v68, v187
    v_mfma_f32_16x16x32_f16 v[100:103], a[20:23], v[132:135], v[100:103]
    v_max3_f32 v248, v248, |v224|, |v225|
    v_fma_f32 v187, |v117|, v69, v187
    v_mfma_f32_16x16x32_f16 v[100:103], a[24:27], v[136:139], v[100:103]
    v_cvt_pkrtz_f16_f32 v211, v226, v227
    v_fma_f32 v187, |v118|, v70, v187
    v_mfma_f32_16x16x32_f16 v[100:103], a[28:31], v[140:143], v[100:103]
    v_max3_f32 v249, v249, |v226|, |v227|
    v_fma_f32 v187, |v119|, v71, v187
    v_mfma_f32_16x16x32_f16 v[104:107], a[32:35], v[128:131], v[24:27]
    ds_write_b128 v203, v[208:211] offset:5472
    v_fma_f32 v187, |v120|, v72, v187
    v_mfma_f32_16x16x32_f16 v[104:107], a[36:39], v[132:135], v[104:107]
    s_waitcnt vmcnt(0)
    v_lshl_add_u32 v220, v168, 16, s48
    v_fma_f32 v187, |v121|, v73, v187
    v_mfma_f32_16x16x32_f16 v[104:107], a[40:43], v[136:139], v[104:107]
    v_add_u32_sdwa v221, v168, s49 dst_sel:WORD_1 dst_unused:UNUSED_PAD src0_sel:WORD_1 src1_sel:DWORD
    v_fma_f32 v187, |v122|, v74, v187
    v_mfma_f32_16x16x32_f16 v[104:107], a[44:47], v[140:143], v[104:107]
    v_lshl_add_u32 v222, v169, 16, s48
    v_fma_f32 v187, |v123|, v75, v187
    v_mfma_f32_16x16x32_f16 v[108:111], a[48:51], v[128:131], v[28:31]
    v_add_u32_sdwa v223, v169, s49 dst_sel:WORD_1 dst_unused:UNUSED_PAD src0_sel:WORD_1 src1_sel:DWORD
    v_fma_f32 v187, |v124|, v76, v187
    v_mfma_f32_16x16x32_f16 v[108:111], a[52:55], v[132:135], v[108:111]
    v_lshl_add_u32 v224, v170, 16, s48
    v_fma_f32 v187, |v125|, v77, v187
    v_mfma_f32_16x16x32_f16 v[108:111], a[56:59], v[136:139], v[108:111]
    v_add_u32_sdwa v225, v170, s49 dst_sel:WORD_1 dst_unused:UNUSED_PAD src0_sel:WORD_1 src1_sel:DWORD
    v_fma_f32 v187, |v126|, v78, v187
    v_mfma_f32_16x16x32_f16 v[108:111], a[60:63], v[140:143], v[108:111]
    s_waitcnt lgkmcnt(1)
    v_pk_mul_f16 v144, v144, v80
    v_fma_f32 v187, |v127|, v79, v187
    v_mfma_f32_16x16x32_f16 v[112:115], a[64:67], v[128:131], v[32:35]
    v_pk_mul_f16 v145, v145, v81
    v_mul_f32 v188, |v96|, v48
    v_mfma_f32_16x16x32_f16 v[112:115], a[68:71], v[132:135], v[112:115]
    v_pk_mul_f16 v146, v146, v82
    v_fma_f32 v188, |v97|, v49, v188
    v_mfma_f32_16x16x32_f16 v[112:115], a[72:75], v[136:139], v[112:115]
    v_pk_mul_f16 v147, v147, v83
    v_fma_f32 v188, |v98|, v50, v188
    v_mfma_f32_16x16x32_f16 v[112:115], a[76:79], v[140:143], v[112:115]
    v_pk_mul_f16 v148, v148, v84
    v_fma_f32 v188, |v99|, v51, v188
    v_mfma_f32_16x16x32_f16 v[116:119], a[80:83], v[128:131], v[36:39]
    v_pk_mul_f16 v149, v149, v85
    v_fma_f32 v188, |v100|, v52, v188
    v_mfma_f32_16x16x32_f16 v[116:119], a[84:87], v[132:135], v[116:119]
    v_pk_mul_f16 v150, v150, v86
    v_fma_f32 v188, |v101|, v53, v188
    v_mfma_f32_16x16x32_f16 v[116:119], a[88:91], v[136:139], v[116:119]
    v_pk_mul_f16 v151, v151, v87
    v_fma_f32 v188, |v102|, v54, v188
    v_mfma_f32_16x16x32_f16 v[116:119], a[92:95], v[140:143], v[116:119]
    v_pk_mul_f16 v152, v152, v88
    v_fma_f32 v188, |v103|, v55, v188
    v_mfma_f32_16x16x32_f16 v[120:123], a[96:99], v[128:131], v[40:43]
    v_pk_mul_f16 v153, v153, v89
    v_fma_f32 v188, |v104|, v56, v188
    v_mfma_f32_16x16x32_f16 v[120:123], a[100:103], v[132:135], v[120:123]
    v_pk_mul_f16 v154, v154, v90
    v_fma_f32 v188, |v105|, v57, v188
    v_mfma_f32_16x16x32_f16 v[120:123], a[104:107], v[136:139], v[120:123]
    v_pk_mul_f16 v155, v155, v91
    v_fma_f32 v188, |v106|, v58, v188
    v_mfma_f32_16x16x32_f16 v[120:123], a[108:111], v[140:143], v[120:123]
    v_pk_mul_f16 v156, v156, v92
    v_fma_f32 v188, |v107|, v59, v188
    v_mfma_f32_16x16x32_f16 v[124:127], a[112:115], v[128:131], v[44:47]
    v_pk_mul_f16 v157, v157, v93
    v_fma_f32 v188, |v108|, v60, v188
    v_mfma_f32_16x16x32_f16 v[124:127], a[116:119], v[132:135], v[124:127]
    v_pk_mul_f16 v158, v158, v94
    v_fma_f32 v188, |v109|, v61, v188
    v_mfma_f32_16x16x32_f16 v[124:127], a[120:123], v[136:139], v[124:127]
    v_pk_mul_f16 v159, v159, v95
    v_fma_f32 v188, |v110|, v62, v188
    v_mfma_f32_16x16x32_f16 v[124:127], a[124:127], v[140:143], v[124:127]
    v_mov_b32_dpp v247, v246 row_ror:9 row_mask:0xf bank_mask:0xf
    v_fma_f32 v188, |v111|, v63, v188
    v_mfma_f32_16x16x32_f16 v[96:99], a[0:3], v[144:147], v[16:19]
    ds_read_b128 v[140:143], v247 offset:192
    v_fma_f32 v188, |v112|, v64, v188
    v_mfma_f32_16x16x32_f16 v[96:99], a[4:7], v[148:151], v[96:99]
    ds_read_b128 v[136:139], v247 offset:128
    v_fma_f32 v188, |v113|, v65, v188
    v_mfma_f32_16x16x32_f16 v[96:99], a[8:11], v[152:155], v[96:99]
    ds_read_b128 v[132:135], v247 offset:64
    v_fma_f32 v188, |v114|, v66, v188
    v_mfma_f32_16x16x32_f16 v[96:99], a[12:15], v[156:159], v[96:99]
    ds_read_b128 v[128:131], v247 offset:0
    v_fma_f32 v188, |v115|, v67, v188
    v_mfma_f32_16x16x32_f16 v[100:103], a[16:19], v[144:147], v[20:23]
    v_lshl_add_u32 v226, v171, 16, s48
    v_fma_f32 v188, |v116|, v68, v188
    v_mfma_f32_16x16x32_f16 v[100:103], a[20:23], v[148:151], v[100:103]
    v_add_u32_sdwa v227, v171, s49 dst_sel:WORD_1 dst_unused:UNUSED_PAD src0_sel:WORD_1 src1_sel:DWORD
    v_fma_f32 v188, |v117|, v69, v188
    v_mfma_f32_16x16x32_f16 v[100:103], a[24:27], v[152:155], v[100:103]
    v_cvt_pkrtz_f16_f32 v212, v220, v221
    v_fma_f32 v188, |v118|, v70, v188
    v_mfma_f32_16x16x32_f16 v[100:103], a[28:31], v[156:159], v[100:103]
    v_max3_f32 v248, v248, |v220|, |v221|
    v_fma_f32 v188, |v119|, v71, v188
    v_mfma_f32_16x16x32_f16 v[104:107], a[32:35], v[144:147], v[24:27]
    v_cvt_pkrtz_f16_f32 v213, v222, v223
    v_fma_f32 v188, |v120|, v72, v188
    v_mfma_f32_16x16x32_f16 v[104:107], a[36:39], v[148:151], v[104:107]
    v_max3_f32 v249, v249, |v222|, |v223|
    v_fma_f32 v188, |v121|, v73, v188
    v_mfma_f32_16x16x32_f16 v[104:107], a[40:43], v[152:155], v[104:107]
    v_cvt_pkrtz_f16_f32 v214, v224, v225
    v_fma_f32 v188, |v122|, v74, v188
    v_mfma_f32_16x16x32_f16 v[104:107], a[44:47], v[156:159], v[104:107]
    v_max3_f32 v248, v248, |v224|, |v225|
    v_fma_f32 v188, |v123|, v75, v188
    v_mfma_f32_16x16x32_f16 v[108:111], a[48:51], v[144:147], v[28:31]
    v_cvt_pkrtz_f16_f32 v215, v226, v227
    v_fma_f32 v188, |v124|, v76, v188
    v_mfma_f32_16x16x32_f16 v[108:111], a[52:55], v[148:151], v[108:111]
    v_max3_f32 v249, v249, |v226|, |v227|
    v_fma_f32 v188, |v125|, v77, v188
    v_mfma_f32_16x16x32_f16 v[108:111], a[56:59], v[152:155], v[108:111]
    ds_write_b128 v203, v[212:215] offset:6336
    v_fma_f32 v188, |v126|, v78, v188
    v_mfma_f32_16x16x32_f16 v[108:111], a[60:63], v[156:159], v[108:111]
    s_waitcnt lgkmcnt(1)
    v_pk_mul_f16 v128, v128, v80
    v_fma_f32 v188, |v127|, v79, v188
    v_mfma_f32_16x16x32_f16 v[112:115], a[64:67], v[144:147], v[32:35]
    v_pk_mul_f16 v129, v129, v81
    v_mul_f32 v189, |v96|, v48
    v_mfma_f32_16x16x32_f16 v[112:115], a[68:71], v[148:151], v[112:115]
    v_pk_mul_f16 v130, v130, v82
    v_fma_f32 v189, |v97|, v49, v189
    v_mfma_f32_16x16x32_f16 v[112:115], a[72:75], v[152:155], v[112:115]
    v_pk_mul_f16 v131, v131, v83
    v_fma_f32 v189, |v98|, v50, v189
    v_mfma_f32_16x16x32_f16 v[112:115], a[76:79], v[156:159], v[112:115]
    v_pk_mul_f16 v132, v132, v84
    v_fma_f32 v189, |v99|, v51, v189
    v_mfma_f32_16x16x32_f16 v[116:119], a[80:83], v[144:147], v[36:39]
    v_pk_mul_f16 v133, v133, v85
    v_fma_f32 v189, |v100|, v52, v189
    v_mfma_f32_16x16x32_f16 v[116:119], a[84:87], v[148:151], v[116:119]
    v_pk_mul_f16 v134, v134, v86
    v_fma_f32 v189, |v101|, v53, v189
    v_mfma_f32_16x16x32_f16 v[116:119], a[88:91], v[152:155], v[116:119]
    v_pk_mul_f16 v135, v135, v87
    v_fma_f32 v189, |v102|, v54, v189
    v_mfma_f32_16x16x32_f16 v[116:119], a[92:95], v[156:159], v[116:119]
    v_pk_mul_f16 v136, v136, v88
    v_fma_f32 v189, |v103|, v55, v189
    v_mfma_f32_16x16x32_f16 v[120:123], a[96:99], v[144:147], v[40:43]
    v_pk_mul_f16 v137, v137, v89
    v_fma_f32 v189, |v104|, v56, v189
    v_mfma_f32_16x16x32_f16 v[120:123], a[100:103], v[148:151], v[120:123]
    v_pk_mul_f16 v138, v138, v90
    v_fma_f32 v189, |v105|, v57, v189
    v_mfma_f32_16x16x32_f16 v[120:123], a[104:107], v[152:155], v[120:123]
    v_pk_mul_f16 v139, v139, v91
    v_fma_f32 v189, |v106|, v58, v189
    v_mfma_f32_16x16x32_f16 v[120:123], a[108:111], v[156:159], v[120:123]
    v_pk_mul_f16 v140, v140, v92
    v_fma_f32 v189, |v107|, v59, v189
    v_mfma_f32_16x16x32_f16 v[124:127], a[112:115], v[144:147], v[44:47]
    v_pk_mul_f16 v141, v141, v93
    v_fma_f32 v189, |v108|, v60, v189
    v_mfma_f32_16x16x32_f16 v[124:127], a[116:119], v[148:151], v[124:127]
    v_pk_mul_f16 v142, v142, v94
    v_fma_f32 v189, |v109|, v61, v189
    v_mfma_f32_16x16x32_f16 v[124:127], a[120:123], v[152:155], v[124:127]
    v_pk_mul_f16 v143, v143, v95
    v_fma_f32 v189, |v110|, v62, v189
    v_mfma_f32_16x16x32_f16 v[124:127], a[124:127], v[156:159], v[124:127]
    v_mov_b32_dpp v247, v246 row_ror:8 row_mask:0xf bank_mask:0xf
    v_fma_f32 v189, |v111|, v63, v189
    v_mfma_f32_16x16x32_f16 v[96:99], a[0:3], v[128:131], v[16:19]
    ds_read_b128 v[156:159], v247 offset:192
    v_fma_f32 v189, |v112|, v64, v189
    v_mfma_f32_16x16x32_f16 v[96:99], a[4:7], v[132:135], v[96:99]
    ds_read_b128 v[152:155], v247 offset:128
    v_fma_f32 v189, |v113|, v65, v189
    v_mfma_f32_16x16x32_f16 v[96:99], a[8:11], v[136:139], v[96:99]
    ds_read_b128 v[148:151], v247 offset:64
    v_fma_f32 v189, |v114|, v66, v189
    v_mfma_f32_16x16x32_f16 v[96:99], a[12:15], v[140:143], v[96:99]
    ds_read_b128 v[144:147], v247 offset:0
    v_fma_f32 v189, |v115|, v67, v189
    v_mfma_f32_16x16x32_f16 v[100:103], a[16:19], v[128:131], v[20:23]
    v_max_f32 v248, v248, v249
    v_fma_f32 v189, |v116|, v68, v189
    v_mfma_f32_16x16x32_f16 v[100:103], a[20:23], v[132:135], v[100:103]
    v_cmp_le_f32 vcc, s50, v248
    v_fma_f32 v189, |v117|, v69, v189
    v_mfma_f32_16x16x32_f16 v[100:103], a[24:27], v[136:139], v[100:103]
    v_cmp_nlt_f32 s[92:93], v248, s51
    v_fma_f32 v189, |v118|, v70, v189
    v_mfma_f32_16x16x32_f16 v[100:103], a[28:31], v[140:143], v[100:103]
    s_cbranch_vccnz L_efix
    v_fma_f32 v189, |v119|, v71, v189
    v_mfma_f32_16x16x32_f16 v[104:107], a[32:35], v[128:131], v[24:27]
    s_cmp_eq_u64 s[92:93], 0
    s_cbranch_scc1 L_efix
    v_fma_f32 v189, |v120|, v72, v189
    v_mfma_f32_16x16x32_f16 v[104:107], a[36:39], v[132:135], v[104:107]
    ds_read_b128 v[204:207], v202 offset:4608
    v_fma_f32 v189, |v121|, v73, v189
    v_mfma_f32_16x16x32_f16 v[104:107], a[40:43], v[136:139], v[104:107]
    ds_read_b128 v[208:211], v202 offset:4672
    v_fma_f32 v189, |v122|, v74, v189
    v_mfma_f32_16x16x32_f16 v[104:107], a[44:47], v[140:143], v[104:107]
    ds_read_b128 v[212:215], v202 offset:4736
    v_fma_f32 v189, |v123|, v75, v189
    v_mfma_f32_16x16x32_f16 v[108:111], a[48:51], v[128:131], v[28:31]
    ds_read_b128 v[216:219], v202 offset:4800
    v_fma_f32 v189, |v124|, v76, v189
    v_mfma_f32_16x16x32_f16 v[108:111], a[52:55], v[132:135], v[108:111]
    v_add_u32_sdwa v11, v238, s5 dst_sel:DWORD dst_unused:UNUSED_PAD src0_sel:WORD_1 src1_sel:DWORD
    v_fma_f32 v189, |v125|, v77, v189
    v_mfma_f32_16x16x32_f16 v[108:111], a[56:59], v[136:139], v[108:111]
    v_add_u32_sdwa v238, v238, s5 dst_sel:DWORD dst_unused:UNUSED_PAD src0_sel:WORD_0 src1_sel:DWORD
    v_fma_f32 v189, |v126|, v78, v189
    v_mfma_f32_16x16x32_f16 v[108:111], a[60:63], v[140:143], v[108:111]
    s_waitcnt lgkmcnt(4)
    v_pk_mul_f16 v144, v144, v80
    v_fma_f32 v189, |v127|, v79, v189
    v_mfma_f32_16x16x32_f16 v[112:115], a[64:67], v[128:131], v[32:35]
L_pad1:
    s_cbranch_execz L_hopret
    v_pk_mul_f16 v145, v145, v81
    v_mul_f32 v190, |v96|, v48
    v_mfma_f32_16x16x32_f16 v[112:115], a[68:71], v[132:135], v[112:115]
    v_pk_mul_f16 v146, v146, v82
    v_fma_f32 v190, |v97|, v49, v190
    v_mfma_f32_16x16x32_f16 v[112:115], a[72:75], v[136:139], v[112:115]
    v_pk_mul_f16 v147, v147, v83
    v_fma_f32 v190, |v98|, v50, v190
    v_mfma_f32_16x16x32_f16 v[112:115], a[76:79], v[140:143], v[112:115]
    v_pk_mul_f16 v148, v148, v84
    v_fma_f32 v190, |v99|, v51, v190
    v_mfma_f32_16x16x32_f16 v[116:119], a[80:83], v[128:131], v[36:39]
    v_pk_mul_f16 v149, v149, v85
    v_fma_f32 v190, |v100|, v52, v190
    v_mfma_f32_16x16x32_f16 v[116:119], a[84:87], v[132:135], v[116:119]
    v_pk_mul_f16 v150, v150, v86
    v_fma_f32 v190, |v101|, v53, v190
    v_mfma_f32_16x16x32_f16 v[116:119], a[88:91], v[136:139], v[116:119]
    v_pk_mul_f16 v151, v151, v87
    v_fma_f32 v190, |v102|, v54, v190
    v_mfma_f32_16x16x32_f16 v[116:119], a[92:95], v[140:143], v[116:119]
    v_pk_mul_f16 v152, v152, v88
    v_fma_f32 v190, |v103|, v55, v190
    v_mfma_f32_16x16x32_f16 v[120:123], a[96:99], v[128:131], v[40:43]
    v_pk_mul_f16 v153, v153, v89
    v_fma_f32 v190, |v104|, v56, v190
    v_mfma_f32_16x16x32_f16 v[120:123], a[100:103], v[132:135], v[120:123]
    v_pk_mul_f16 v154, v154, v90
    v_fma_f32 v190, |v105|, v57, v190
    v_mfma_f32_16x16x32_f16 v[120:123], a[104:107], v[136:139], v[120:123]
    v_pk_mul_f16 v155, v155, v91
    v_fma_f32 v190, |v106|, v58, v190
    v_mfma_f32_16x16x32_f16 v[120:123], a[108:111], v[140:143], v[120:123]
    v_pk_mul_f16 v156, v156, v92
    v_fma_f32 v190, |v107|, v59, v190
    v_mfma_f32_16x16x32_f16 v[124:127], a[112:115], v[128:131], v[44:47]
    v_pk_mul_f16 v157, v157, v93
    v_fma_f32 v190, |v108|, v60, v190
    v_mfma_f32_16x16x32_f16 v[124:127], a[116:119], v[132:135], v[124:127]
    v_pk_mul_f16 v158, v158, v94
    v_fma_f32 v190, |v109|, v61, v190
    v_mfma_f32_16x16x32_f16 v[124:127], a[120:123], v[136:139], v[124:127]
    v_pk_mul_f16 v159, v159, v95
    v_fma_f32 v190, |v110|, v62, v190
    v_mfma_f32_16x16x32_f16 v[124:127], a[124:127], v[140:143], v[124:127]
    v_max_u32_dpp v255, v255, v255 row_ror:4 row_mask:0xf bank_mask:0xf
    v_fma_f32 v190, |v111|, v63, v190
    v_mfma_f32_16x16x32_f16 v[96:99], a[0:3], v[144:147], v[16:19]
    ds_read_b128 v[140:143], v245 offset:4800
    v_fma_f32 v190, |v112|, v64, v190
    v_mfma_f32_16x16x32_f16 v[96:99], a[4:7], v[148:151], v[96:99]
    ds_read_b128 v[136:139], v245 offset:4736
    v_fma_f32 v190, |v113|, v65, v190
    v_mfma_f32_16x16x32_f16 v[96:99], a[8:11], v[152:155], v[96:99]
    ds_read_b128 v[132:135], v245 offset:4672
    v_fma_f32 v190, |v114|, v66, v190
    v_mfma_f32_16x16x32_f16 v[96:99], a[12:15], v[156:159], v[96:99]
    ds_read_b128 v[128:131], v245 offset:4608
    v_fma_f32 v190, |v115|, v67, v190
    v_mfma_f32_16x16x32_f16 v[100:103], a[16:19], v[144:147], v[20:23]
    v_max_u32_dpp v254, v254, v254 row_ror:2 row_mask:0xf bank_mask:0xf
    v_fma_f32 v190, |v116|, v68, v190
    v_mfma_f32_16x16x32_f16 v[100:103], a[20:23], v[148:151], v[100:103]
    v_max_u32_dpp v255, v255, v255 row_ror:2 row_mask:0xf bank_mask:0xf
    v_fma_f32 v190, |v117|, v69, v190
    v_mfma_f32_16x16x32_f16 v[100:103], a[24:27], v[152:155], v[100:103]
    v_max_u32_dpp v254, v254, v254 row_ror:1 row_mask:0xf bank_mask:0xf
    v_fma_f32 v190, |v118|, v70, v190
    v_mfma_f32_16x16x32_f16 v[100:103], a[28:31], v[156:159], v[100:103]
    v_max_u32_dpp v255, v255, v255 row_ror:1 row_mask:0xf bank_mask:0xf
    v_fma_f32 v190, |v119|, v71, v190
    v_mfma_f32_16x16x32_f16 v[104:107], a[32:35], v[144:147], v[24:27]
    v_max_u32_dpp v254, v254, v254 row_bcast:15 row_mask:0xa bank_mask:0xf
    v_fma_f32 v190, |v120|, v72, v190
    v_mfma_f32_16x16x32_f16 v[104:107], a[36:39], v[148:151], v[104:107]
    v_max_u32_dpp v255, v255, v255 row_bcast:15 row_mask:0xa bank_mask:0xf
    v_fma_f32 v190, |v121|, v73, v190
    v_mfma_f32_16x16x32_f16 v[104:107], a[40:43], v[152:155], v[104:107]
    v_max_u32_dpp v254, v254, v254 row_bcast:31 row_mask:0xc bank_mask:0xf
    v_fma_f32 v190, |v122|, v74, v190
    v_mfma_f32_16x16x32_f16 v[104:107], a[44:47], v[156:159], v[104:107]
    v_max_u32_dpp v255, v255, v255 row_bcast:31 row_mask:0xc bank_mask:0xf
    v_fma_f32 v190, |v123|, v75, v190
    v_mfma_f32_16x16x32_f16 v[108:111], a[48:51], v[144:147], v[28:31]
    v_readlane_b32 s34, v254, 63
    v_fma_f32 v190, |v124|, v76, v190
    v_mfma_f32_16x16x32_f16 v[108:111], a[52:55], v[148:151], v[108:111]
    v_readlane_b32 s35, v255, 63
    s_bfe_u32 s34, s34, 0x80007
    v_fma_f32 v190, |v125|, v77, v190
    v_mfma_f32_16x16x32_f16 v[108:111], a[56:59], v[152:155], v[108:111]
    s_max_u32 s34, s34, 60
    s_waitcnt lgkmcnt(0)
    v_pk_mul_f16 v128, v128, v80
    v_fma_f32 v190, |v126|, v78, v190
    v_mfma_f32_16x16x32_f16 v[108:111], a[60:63], v[156:159], v[108:111]
    s_sub_u32 s11, s34, 134
    v_pk_mul_f16 v129, v129, v81
    v_fma_f32 v190, |v127|, v79, v190
    v_mfma_f32_16x16x32_f16 v[112:115], a[64:67], v[144:147], v[32:35]
    s_sub_u32 s11, s11, s54
    v_pk_mul_f16 v130, v130, v82
    v_mul_f32 v191, |v96|, v48
    v_mfma_f32_16x16x32_f16 v[112:115], a[68:71], v[148:151], v[112:115]
    s_sub_u32 s34, s34, 22
    v_pk_mul_f16 v131, v131, v83
    v_fma_f32 v191, |v97|, v49, v191
    v_mfma_f32_16x16x32_f16 v[112:115], a[72:75], v[152:155], v[112:115]
    s_mul_i32 s10, s34, 0x800080
    v_pk_mul_f16 v132, v132, v84
    v_fma_f32 v191, |v98|, v50, v191
    v_mfma_f32_16x16x32_f16 v[112:115], a[76:79], v[156:159], v[112:115]
    s_lshr_b32 s35, s35, 23
    v_pk_mul_f16 v133, v133, v85
    v_fma_f32 v191, |v99|, v51, v191
    v_mfma_f32_16x16x32_f16 v[116:119], a[80:83], v[144:147], v[36:39]
    s_max_u32 s35, s35, 60
    v_pk_mul_f16 v134, v134, v86
    v_fma_f32 v191, |v100|, v52, v191
    v_mfma_f32_16x16x32_f16 v[116:119], a[84:87], v[148:151], v[116:119]
    s_sub_u32 s34, 134, s35
    v_pk_mul_f16 v135, v135, v87
    v_fma_f32 v191, |v101|, v53, v191
    v_mfma_f32_16x16x32_f16 v[116:119], a[88:91], v[152:155], v[116:119]
    s_sub_u32 s35, s35, 7
    v_pk_mul_f16 v136, v136, v88
    v_fma_f32 v191, |v102|, v54, v191
    v_mfma_f32_16x16x32_f16 v[116:119], a[92:95], v[156:159], v[116:119]
    s_lshl_b32 s12, s35, 23
    v_and_b32 v254, s45, v252
    v_fma_f32 v191, |v103|, v55, v191
    v_mfma_f32_16x16x32_f16 v[120:123], a[96:99], v[144:147], v[40:43]
    v_pk_mul_f16 v137, v137, v89
    v_fma_f32 v191, |v104|, v56, v191
    v_mfma_f32_16x16x32_f16 v[120:123], a[100:103], v[148:151], v[120:123]
    v_pk_mul_f16 v138, v138, v90
    v_fma_f32 v191, |v105|, v57, v191
    v_mfma_f32_16x16x32_f16 v[120:123], a[104:107], v[152:155], v[120:123]
    v_pk_mul_f16 v139, v139, v91
    v_fma_f32 v191, |v106|, v58, v191
    v_mfma_f32_16x16x32_f16 v[120:123], a[108:111], v[156:159], v[120:123]
    v_pk_mul_f16 v140, v140, v92
    v_fma_f32 v191, |v107|, v59, v191
    v_mfma_f32_16x16x32_f16 v[124:127], a[112:115], v[144:147], v[44:47]
    v_pk_mul_f16 v141, v141, v93
    v_fma_f32 v191, |v108|, v60, v191
    v_mfma_f32_16x16x32_f16 v[124:127], a[116:119], v[148:151], v[124:127]
    v_pk_mul_f16 v142, v142, v94
    v_fma_f32 v191, |v109|, v61, v191
    v_mfma_f32_16x16x32_f16 v[124:127], a[120:123], v[152:155], v[124:127]
    v_pk_mul_f16 v143, v143, v95
    v_fma_f32 v191, |v110|, v62, v191
    v_mfma_f32_16x16x32_f16 v[124:127], a[124:127], v[156:159], v[124:127]
    v_ldexp_f32 v192, v192, s34
    v_fma_f32 v191, |v111|, v63, v191
    v_mfma_f32_16x16x32_f16 v[96:99], a[0:3], v[128:131], v[16:19]
    ds_read_b128 v[156:159], v245 offset:5088
    v_fma_f32 v191, |v112|, v64, v191
    v_mfma_f32_16x16x32_f16 v[96:99], a[4:7], v[132:135], v[96:99]
    ds_read_b128 v[152:155], v245 offset:5024
    v_fma_f32 v191, |v113|, v65, v191
    v_mfma_f32_16x16x32_f16 v[96:99], a[8:11], v[136:139], v[96:99]
    ds_read_b128 v[148:151], v245 offset:4960
    v_fma_f32 v191, |v114|, v66, v191
    v_mfma_f32_16x16x32_f16 v[96:99], a[12:15], v[140:143], v[96:99]
    ds_read_b128 v[144:147], v245 offset:4896
    v_fma_f32 v191, |v115|, v67, v191
    v_mfma_f32_16x16x32_f16 v[100:103], a[16:19], v[128:131], v[20:23]
    v_ldexp_f32 v193, v193, s34
    v_fma_f32 v191, |v116|, v68, v191
    v_mfma_f32_16x16x32_f16 v[100:103], a[20:23], v[132:135], v[100:103]
    v_pk_sub_u16 v253, v253, s10 clamp
    v_fma_f32 v191, |v117|, v69, v191
    v_mfma_f32_16x16x32_f16 v[100:103], a[24:27], v[136:139], v[100:103]
    v_cvt_pk_f16_f32 v192, v192, v193
    v_fma_f32 v191, |v118|, v70, v191
    v_mfma_f32_16x16x32_f16 v[100:103], a[28:31], v[140:143], v[100:103]
    v_lshl_or_b32 v253, v253, 3, v254
    v_fma_f32 v191, |v119|, v71, v191
    v_mfma_f32_16x16x32_f16 v[104:107], a[32:35], v[128:131], v[24:27]
    ds_write_b32 v11, v192 offset:9216
    v_fma_f32 v191, |v120|, v72, v191
    v_mfma_f32_16x16x32_f16 v[104:107], a[36:39], v[132:135], v[104:107]
    ds_write_b32 v11, v253 offset:9504
    v_fma_f32 v191, |v121|, v73, v191
    v_mfma_f32_16x16x32_f16 v[104:107], a[40:43], v[136:139], v[104:107]
    ds_read_b128 v[172:175], v245 offset:9408
    v_fma_f32 v191, |v122|, v74, v191
    v_mfma_f32_16x16x32_f16 v[104:107], a[44:47], v[140:143], v[104:107]
    ds_read_b128 v[168:171], v245 offset:9344
    v_fma_f32 v191, |v123|, v75, v191
    v_mfma_f32_16x16x32_f16 v[108:111], a[48:51], v[128:131], v[28:31]
    ds_read_b128 v[164:167], v245 offset:9280
    v_fma_f32 v191, |v124|, v76, v191
    v_mfma_f32_16x16x32_f16 v[108:111], a[52:55], v[132:135], v[108:111]
    ds_read_b128 v[160:163], v245 offset:9216
    v_fma_f32 v191, |v125|, v77, v191
    v_mfma_f32_16x16x32_f16 v[108:111], a[56:59], v[136:139], v[108:111]
    s_waitcnt lgkmcnt(6)
    v_pk_mul_f16 v144, v144, v80
    v_fma_f32 v191, |v126|, v78, v191
    v_mfma_f32_16x16x32_f16 v[108:111], a[60:63], v[140:143], v[108:111]
    v_pk_mul_f16 v145, v145, v81
    v_fma_f32 v191, |v127|, v79, v191
    v_mfma_f32_16x16x32_f16 v[112:115], a[64:67], v[128:131], v[32:35]
    v_pk_mul_f16 v146, v146, v82
    v_mul_f32 v176, |v96|, v48
    v_mfma_f32_16x16x32_f16 v[112:115], a[68:71], v[132:135], v[112:115]
    v_pk_mul_f16 v147, v147, v83
    v_fma_f32 v176, |v97|, v49, v176
    v_mfma_f32_16x16x32_f16 v[112:115], a[72:75], v[136:139], v[112:115]
    v_pk_mul_f16 v148, v148, v84
    v_fma_f32 v176, |v98|, v50, v176
    v_mfma_f32_16x16x32_f16 v[112:115], a[76:79], v[140:143], v[112:115]
    v_pk_mul_f16 v149, v149, v85
    v_fma_f32 v176, |v99|, v51, v176
    v_mfma_f32_16x16x32_f16 v[116:119], a[80:83], v[128:131], v[36:39]
    v_pk_mul_f16 v150, v150, v86
    v_fma_f32 v176, |v100|, v52, v176
    v_mfma_f32_16x16x32_f16 v[116:119], a[84:87], v[132:135], v[116:119]
    v_pk_mul_f16 v151, v151, v87
    v_fma_f32 v176, |v101|, v53, v176
    v_mfma_f32_16x16x32_f16 v[116:119], a[88:91], v[136:139], v[116:119]
    s_waitcnt lgkmcnt(0)
    v_pk_mul_f16 v160, v160, v80
    v_fma_f32 v176, |v102|, v54, v176
    v_mfma_f32_16x16x32_f16 v[116:119], a[92:95], v[140:143], v[116:119]
    v_pk_mul_f16 v152, v152, v88
    v_fma_f32 v176, |v103|, v55, v176
    v_mfma_f32_16x16x32_f16 v[120:123], a[96:99], v[128:131], v[40:43]
    v_pk_mul_f16 v153, v153, v89
    v_fma_f32 v176, |v104|, v56, v176
    v_mfma_f32_16x16x32_f16 v[120:123], a[100:103], v[132:135], v[120:123]
    v_pk_mul_f16 v154, v154, v90
    v_fma_f32 v176, |v105|, v57, v176
    v_mfma_f32_16x16x32_f16 v[120:123], a[104:107], v[136:139], v[120:123]
    v_pk_mul_f16 v155, v155, v91
    v_fma_f32 v176, |v106|, v58, v176
    v_mfma_f32_16x16x32_f16 v[120:123], a[108:111], v[140:143], v[120:123]
    v_pk_mul_f16 v156, v156, v92
    v_fma_f32 v176, |v107|, v59, v176
    v_mfma_f32_16x16x32_f16 v[124:127], a[112:115], v[128:131], v[44:47]
    v_pk_mul_f16 v157, v157, v93
    v_fma_f32 v176, |v108|, v60, v176
    v_mfma_f32_16x16x32_f16 v[124:127], a[116:119], v[132:135], v[124:127]
    v_pk_mul_f16 v158, v158, v94
    v_fma_f32 v176, |v109|, v61, v176
    v_mfma_f32_16x16x32_f16 v[124:127], a[120:123], v[136:139], v[124:127]
    v_pk_mul_f16 v159, v159, v95
    v_fma_f32 v176, |v110|, v62, v176
    v_mfma_f32_16x16x32_f16 v[124:127], a[124:127], v[140:143], v[124:127]
    v_pk_mul_f16 v161, v161, v81
    v_fma_f32 v176, |v111|, v63, v176
    v_mfma_f32_16x16x32_f16 v[96:99], a[0:3], v[144:147], v[16:19]
    ds_read_b128 v[140:143], v245 offset:5376
    v_fma_f32 v176, |v112|, v64, v176
    v_mfma_f32_16x16x32_f16 v[96:99], a[4:7], v[148:151], v[96:99]
    ds_read_b128 v[136:139], v245 offset:5312
    v_fma_f32 v176, |v113|, v65, v176
    v_mfma_f32_16x16x32_f16 v[96:99], a[8:11], v[152:155], v[96:99]
    ds_read_b128 v[132:135], v245 offset:5248
    v_fma_f32 v176, |v114|, v66, v176
    v_mfma_f32_16x16x32_f16 v[96:99], a[12:15], v[156:159], v[96:99]
    ds_read_b128 v[128:131], v245 offset:5184
    v_fma_f32 v176, |v115|, v67, v176
    v_mfma_f32_16x16x32_f16 v[100:103], a[16:19], v[144:147], v[20:23]
    v_pk_mul_f16 v162, v162, v82
    v_fma_f32 v176, |v116|, v68, v176
    v_mfma_f32_16x16x32_f16 v[100:103], a[20:23], v[148:151], v[100:103]
    v_pk_mul_f16 v163, v163, v83
    v_fma_f32 v176, |v117|, v69, v176
    v_mfma_f32_16x16x32_f16 v[100:103], a[24:27], v[152:155], v[100:103]
    v_pk_mul_f16 v164, v164, v84
    v_fma_f32 v176, |v118|, v70, v176
    v_mfma_f32_16x16x32_f16 v[100:103], a[28:31], v[156:159], v[100:103]
    v_pk_mul_f16 v165, v165, v85
    v_fma_f32 v176, |v119|, v71, v176
    v_mfma_f32_16x16x32_f16 v[104:107], a[32:35], v[144:147], v[24:27]
    v_pk_mul_f16 v166, v166, v86
    v_fma_f32 v176, |v120|, v72, v176
    v_mfma_f32_16x16x32_f16 v[104:107], a[36:39], v[148:151], v[104:107]
    v_pk_mul_f16 v167, v167, v87
    v_fma_f32 v176, |v121|, v73, v176
    v_mfma_f32_16x16x32_f16 v[104:107], a[40:43], v[152:155], v[104:107]
    v_pk_mul_f16 v168, v168, v88
    v_fma_f32 v176, |v122|, v74, v176
    v_mfma_f32_16x16x32_f16 v[104:107], a[44:47], v[156:159], v[104:107]
    v_pk_mul_f16 v169, v169, v89
    v_fma_f32 v176, |v123|, v75, v176
    v_mfma_f32_16x16x32_f16 v[108:111], a[48:51], v[144:147], v[28:31]
    v_pk_mul_f16 v170, v170, v90
    v_fma_f32 v176, |v124|, v76, v176
    v_mfma_f32_16x16x32_f16 v[108:111], a[52:55], v[148:151], v[108:111]
    v_pk_mul_f16 v171, v171, v91
    v_fma_f32 v176, |v125|, v77, v176
    v_mfma_f32_16x16x32_f16 v[108:111], a[56:59], v[152:155], v[108:111]
    v_pk_mul_f16 v172, v172, v92
    v_fma_f32 v176, |v126|, v78, v176
    v_mfma_f32_16x16x32_f16 v[108:111], a[60:63], v[156:159], v[108:111]
    s_waitcnt lgkmcnt(0)
    v_pk_mul_f16 v128, v128, v80
    v_fma_f32 v176, |v127|, v79, v176
    v_mfma_f32_16x16x32_f16 v[112:115], a[64:67], v[144:147], v[32:35]
    v_pk_mul_f16 v129, v129, v81
    v_mul_f32 v177, |v96|, v48
    v_mfma_f32_16x16x32_f16 v[112:115], a[68:71], v[148:151], v[112:115]
    v_pk_mul_f16 v130, v130, v82
    v_fma_f32 v177, |v97|, v49, v177
    v_mfma_f32_16x16x32_f16 v[112:115], a[72:75], v[152:155], v[112:115]
    v_pk_mul_f16 v131, v131, v83
    v_fma_f32 v177, |v98|, v50, v177
    v_mfma_f32_16x16x32_f16 v[112:115], a[76:79], v[156:159], v[112:115]
    v_pk_mul_f16 v132, v132, v84
    v_fma_f32 v177, |v99|, v51, v177
    v_mfma_f32_16x16x32_f16 v[116:119], a[80:83], v[144:147], v[36:39]
    v_pk_mul_f16 v133, v133, v85
    v_fma_f32 v177, |v100|, v52, v177
    v_mfma_f32_16x16x32_f16 v[116:119], a[84:87], v[148:151], v[116:119]
    v_pk_mul_f16 v134, v134, v86
    v_fma_f32 v177, |v101|, v53, v177
    v_mfma_f32_16x16x32_f16 v[116:119], a[88:91], v[152:155], v[116:119]
    v_pk_mul_f16 v135, v135, v87
    v_fma_f32 v177, |v102|, v54, v177
    v_mfma_f32_16x16x32_f16 v[116:119], a[92:95], v[156:159], v[116:119]
    v_pk_mul_f16 v136, v136, v88
    v_fma_f32 v177, |v103|, v55, v177
    v_mfma_f32_16x16x32_f16 v[120:123], a[96:99], v[144:147], v[40:43]
    v_pk_mul_f16 v137, v137, v89
    v_fma_f32 v177, |v104|, v56, v177
    v_mfma_f32_16x16x32_f16 v[120:123], a[100:103], v[148:151], v[120:123]
    v_pk_mul_f16 v138, v138, v90
    v_fma_f32 v177, |v105|, v57, v177
    v_mfma_f32_16x16x32_f16 v[120:123], a[104:107], v[152:155], v[120:123]
    v_pk_mul_f16 v139, v139, v91
    v_fma_f32 v177, |v106|, v58, v177
    v_mfma_f32_16x16x32_f16 v[120:123], a[108:111], v[156:159], v[120:123]
    v_pk_mul_f16 v140, v140, v92
    v_fma_f32 v177, |v107|, v59, v177
    v_mfma_f32_16x16x32_f16 v[124:127], a[112:115], v[144:147], v[44:47]
    v_pk_mul_f16 v141, v141, v93
    v_fma_f32 v177, |v108|, v60, v177
    v_mfma_f32_16x16x32_f16 v[124:127], a[116:119], v[148:151], v[124:127]
    v_pk_mul_f16 v142, v142, v94
    v_fma_f32 v177, |v109|, v61, v177
    v_mfma_f32_16x16x32_f16 v[124:127], a[120:123], v[152:155], v[124:127]
    v_pk_mul_f16 v143, v143, v95
    v_fma_f32 v177, |v110|, v62, v177
    v_mfma_f32_16x16x32_f16 v[124:127], a[124:127], v[156:159], v[124:127]
    v_pk_mul_f16 v173, v173, v93
    v_fma_f32 v177, |v111|, v63, v177
    v_mfma_f32_16x16x32_f16 v[96:99], a[0:3], v[128:131], v[16:19]
    ds_read_b128 v[156:159], v245 offset:5664
    v_fma_f32 v177, |v112|, v64, v177
    v_mfma_f32_16x16x32_f16 v[96:99], a[4:7], v[132:135], v[96:99]
    ds_read_b128 v[152:155], v245 offset:5600
    v_fma_f32 v177, |v113|, v65, v177
    v_mfma_f32_16x16x32_f16 v[96:99], a[8:11], v[136:139], v[96:99]
    ds_read_b128 v[148:151], v245 offset:5536
    v_fma_f32 v177, |v114|, v66, v177
    v_mfma_f32_16x16x32_f16 v[96:99], a[12:15], v[140:143], v[96:99]
    ds_read_b128 v[144:147], v245 offset:5472
    v_fma_f32 v177, |v115|, v67, v177
    v_mfma_f32_16x16x32_f16 v[100:103], a[16:19], v[128:131], v[20:23]
    v_pk_mul_f16 v174, v174, v94
    v_fma_f32 v177, |v116|, v68, v177
    v_mfma_f32_16x16x32_f16 v[100:103], a[20:23], v[132:135], v[100:103]
    v_pk_mul_f16 v175, v175, v95
    v_fma_f32 v177, |v117|, v69, v177
    v_mfma_f32_16x16x32_f16 v[100:103], a[24:27], v[136:139], v[100:103]
    v_add_u32_sdwa v239, v232, s5 dst_sel:DWORD dst_unused:UNUSED_PAD src0_sel:WORD_1 src1_sel:DWORD
    v_fma_f32 v177, |v118|, v70, v177
    v_mfma_f32_16x16x32_f16 v[100:103], a[28:31], v[140:143], v[100:103]
    v_add_u32_sdwa v232, v232, s5 dst_sel:DWORD dst_unused:UNUSED_PAD src0_sel:WORD_0 src1_sel:DWORD
    v_fma_f32 v177, |v119|, v71, v177
    v_mfma_f32_16x16x32_f16 v[220:223], v[160:163], v[80:83], 0
    v_add_u32_sdwa v240, v233, s5 dst_sel:DWORD dst_unused:UNUSED_PAD src0_sel:WORD_1 src1_sel:DWORD
    v_fma_f32 v177, |v120|, v72, v177
    v_mfma_f32_16x16x32_f16 v[220:223], v[164:167], v[84:87], v[220:223]
    v_add_u32_sdwa v233, v233, s5 dst_sel:DWORD dst_unused:UNUSED_PAD src0_sel:WORD_0 src1_sel:DWORD
    v_fma_f32 v177, |v121|, v73, v177
    v_mfma_f32_16x16x32_f16 v[220:223], v[168:171], v[88:91], v[220:223]
    v_add_u32_sdwa v241, v234, s5 dst_sel:DWORD dst_unused:UNUSED_PAD src0_sel:WORD_1 src1_sel:DWORD
    v_fma_f32 v177, |v122|, v74, v177
    v_mfma_f32_16x16x32_f16 v[220:223], v[172:175], v[92:95], v[220:223]
    v_add_u32_sdwa v234, v234, s5 dst_sel:DWORD dst_unused:UNUSED_PAD src0_sel:WORD_0 src1_sel:DWORD
    v_fma_f32 v177, |v123|, v75, v177
    v_mfma_f32_16x16x32_f16 v[224:227], v[160:163], v[204:207], 0
    s_waitcnt lgkmcnt(0)
    v_pk_mul_f16 v144, v144, v80
    v_fma_f32 v177, |v124|, v76, v177
    v_mfma_f32_16x16x32_f16 v[224:227], v[164:167], v[208:211], v[224:227]
    v_pk_mul_f16 v145, v145, v81
    v_fma_f32 v177, |v125|, v77, v177
    v_mfma_f32_16x16x32_f16 v[224:227], v[168:171], v[212:215], v[224:227]
    v_pk_mul_f16 v146, v146, v82
    v_fma_f32 v177, |v126|, v78, v177
    v_mfma_f32_16x16x32_f16 v[224:227], v[172:175], v[216:219], v[224:227]
    ds_read_b128 v[172:175], v245 offset:9696
    v_fma_f32 v177, |v127|, v79, v177
    v_mfma_f32_16x16x32_f16 v[104:107], a[32:35], v[128:131], v[24:27]
    ds_read_b128 v[168:171], v245 offset:9632
    v_mul_f32 v178, |v96|, v48
    v_mfma_f32_16x16x32_f16 v[104:107], a[36:39], v[132:135], v[104:107]
    ds_read_b128 v[164:167], v245 offset:9568
    v_fma_f32 v178, |v97|, v49, v178
    v_mfma_f32_16x16x32_f16 v[104:107], a[40:43], v[136:139], v[104:107]
    ds_write_b128 v238, v[220:223] offset:0
    v_mfma_f32_16x16x32_f16 v[104:107], a[44:47], v[140:143], v[104:107]
    ds_write_b128 v238, v[224:227] offset:2304
    v_mfma_f32_16x16x32_f16 v[108:111], a[48:51], v[128:131], v[28:31]
    ds_read_b128 v[160:163], v245 offset:9504
    v_fma_f32 v178, |v98|, v50, v178
    v_mfma_f32_16x16x32_f16 v[108:111], a[52:55], v[132:135], v[108:111]
    v_pk_mul_f16 v147, v147, v83
    v_fma_f32 v178, |v99|, v51, v178
    v_mfma_f32_16x16x32_f16 v[108:111], a[56:59], v[136:139], v[108:111]
    v_pk_mul_f16 v148, v148, v84
    v_fma_f32 v178, |v100|, v52, v178
    v_mfma_f32_16x16x32_f16 v[108:111], a[60:63], v[140:143], v[108:111]
    v_pk_mul_f16 v149, v149, v85
    v_fma_f32 v178, |v101|, v53, v178
    v_mfma_f32_16x16x32_f16 v[112:115], a[64:67], v[128:131], v[32:35]
    v_pk_mul_f16 v150, v150, v86
    v_fma_f32 v178, |v102|, v54, v178
    v_mfma_f32_16x16x32_f16 v[112:115], a[68:71], v[132:135], v[112:115]
    v_pk_mul_f16 v151, v151, v87
    v_fma_f32 v178, |v103|, v55, v178
    v_mfma_f32_16x16x32_f16 v[112:115], a[72:75], v[136:139], v[112:115]
    v_pk_mul_f16 v152, v152, v88
    v_fma_f32 v178, |v104|, v56, v178
    v_mfma_f32_16x16x32_f16 v[112:115], a[76:79], v[140:143], v[112:115]
    v_pk_mul_f16 v153, v153, v89
    v_fma_f32 v178, |v105|, v57, v178
    v_mfma_f32_16x16x32_f16 v[116:119], a[80:83], v[128:131], v[36:39]
    v_pk_mul_f16 v154, v154, v90
    v_fma_f32 v178, |v106|, v58, v178
    v_mfma_f32_16x16x32_f16 v[116:119], a[84:87], v[132:135], v[116:119]
    s_waitcnt lgkmcnt(0)
    v_pk_mul_f16 v160, v160, v80
    v_fma_f32 v178, |v107|, v59, v178
    v_mfma_f32_16x16x32_f16 v[116:119], a[88:91], v[136:139], v[116:119]
    v_pk_mul_f16 v161, v161, v81
    v_fma_f32 v178, |v108|, v60, v178
    v_mfma_f32_16x16x32_f16 v[116:119], a[92:95], v[140:143], v[116:119]
    v_pk_mul_f16 v162, v162, v82
    v_fma_f32 v178, |v109|, v61, v178
    v_mfma_f32_16x16x32_f16 v[120:123], a[96:99], v[128:131], v[40:43]
    v_pk_mul_f16 v163, v163, v83
    v_fma_f32 v178, |v110|, v62, v178
    v_mfma_f32_16x16x32_f16 v[120:123], a[100:103], v[132:135], v[120:123]
    v_pk_mul_f16 v164, v164, v84
    v_fma_f32 v178, |v111|, v63, v178
    v_mfma_f32_16x16x32_f16 v[120:123], a[104:107], v[136:139], v[120:123]
    v_pk_mul_f16 v155, v155, v91
    v_fma_f32 v178, |v112|, v64, v178
    v_mfma_f32_16x16x32_f16 v[120:123], a[108:111], v[140:143], v[120:123]
    v_pk_mul_f16 v156, v156, v92
    v_fma_f32 v178, |v113|, v65, v178
    v_mfma_f32_16x16x32_f16 v[124:127], a[112:115], v[128:131], v[44:47]
    v_pk_mul_f16 v157, v157, v93
    v_fma_f32 v178, |v114|, v66, v178
    v_mfma_f32_16x16x32_f16 v[124:127], a[116:119], v[132:135], v[124:127]
    v_pk_mul_f16 v158, v158, v94
    v_fma_f32 v178, |v115|, v67, v178
    v_mfma_f32_16x16x32_f16 v[124:127], a[120:123], v[136:139], v[124:127]
    v_pk_mul_f16 v159, v159, v95
    v_fma_f32 v178, |v116|, v68, v178
    v_mfma_f32_16x16x32_f16 v[124:127], a[124:127], v[140:143], v[124:127]
    v_pk_mul_f16 v165, v165, v85
    v_fma_f32 v178, |v117|, v69, v178
    v_mfma_f32_16x16x32_f16 v[96:99], a[0:3], v[144:147], v[16:19]
    ds_read_b128 v[140:143], v245 offset:5952
    v_fma_f32 v178, |v118|, v70, v178
    v_mfma_f32_16x16x32_f16 v[96:99], a[4:7], v[148:151], v[96:99]
    ds_read_b128 v[136:139], v245 offset:5888
    v_fma_f32 v178, |v119|, v71, v178
    v_mfma_f32_16x16x32_f16 v[96:99], a[8:11], v[152:155], v[96:99]
    ds_read_b128 v[132:135], v245 offset:5824
    v_fma_f32 v178, |v120|, v72, v178
    v_mfma_f32_16x16x32_f16 v[96:99], a[12:15], v[156:159], v[96:99]
    ds_read_b128 v[128:131], v245 offset:5760
    v_fma_f32 v178, |v121|, v73, v178
    v_mfma_f32_16x16x32_f16 v[100:103], a[16:19], v[144:147], v[20:23]
    v_pk_mul_f16 v166, v166, v86
    v_fma_f32 v178, |v122|, v74, v178
    v_mfma_f32_16x16x32_f16 v[100:103], a[20:23], v[148:151], v[100:103]
    v_pk_mul_f16 v167, v167, v87
    v_fma_f32 v178, |v123|, v75, v178
    v_mfma_f32_16x16x32_f16 v[100:103], a[24:27], v[152:155], v[100:103]
    v_pk_mul_f16 v168, v168, v88
    v_fma_f32 v178, |v124|, v76, v178
    v_mfma_f32_16x16x32_f16 v[100:103], a[28:31], v[156:159], v[100:103]
    v_pk_mul_f16 v169, v169, v89
    v_fma_f32 v178, |v125|, v77, v178
    v_mfma_f32_16x16x32_f16 v[104:107], a[32:35], v[144:147], v[24:27]
    v_pk_mul_f16 v170, v170, v90
    v_fma_f32 v178, |v126|, v78, v178
    v_mfma_f32_16x16x32_f16 v[104:107], a[36:39], v[148:151], v[104:107]
    v_pk_mul_f16 v171, v171, v91
    v_fma_f32 v178, |v127|, v79, v178
    v_mfma_f32_16x16x32_f16 v[104:107], a[40:43], v[152:155], v[104:107]
    v_pk_mul_f16 v172, v172, v92
    v_mul_f32 v179, |v96|, v48
    v_mfma_f32_16x16x32_f16 v[104:107], a[44:47], v[156:159], v[104:107]
    v_pk_mul_f16 v173, v173, v93
    v_fma_f32 v179, |v97|, v49, v179
    v_mfma_f32_16x16x32_f16 v[108:111], a[48:51], v[144:147], v[28:31]
    v_pk_mul_f16 v174, v174, v94
    v_fma_f32 v179, |v98|, v50, v179
    v_mfma_f32_16x16x32_f16 v[108:111], a[52:55], v[148:151], v[108:111]
    v_pk_mul_f16 v175, v175, v95
    v_fma_f32 v179, |v99|, v51, v179
    v_mfma_f32_16x16x32_f16 v[108:111], a[56:59], v[152:155], v[108:111]
    s_waitcnt lgkmcnt(0)
    v_pk_mul_f16 v128, v128, v80
    v_fma_f32 v179, |v100|, v52, v179
    v_mfma_f32_16x16x32_f16 v[108:111], a[60:63], v[156:159], v[108:111]
    v_pk_mul_f16 v129, v129, v81
    v_fma_f32 v179, |v101|, v53, v179
    v_mfma_f32_16x16x32_f16 v[220:223], v[160:163], v[80:83], 0
L_pad2:
    s_cbranch_execz L_hopret
    v_pk_mul_f16 v130, v130, v82
    v_fma_f32 v179, |v102|, v54, v179
    v_mfma_f32_16x16x32_f16 v[220:223], v[164:167], v[84:87], v[220:223]
    v_pk_mul_f16 v131, v131, v83
    v_fma_f32 v179, |v103|, v55, v179
    v_mfma_f32_16x16x32_f16 v[220:223], v[168:171], v[88:91], v[220:223]
    v_pk_mul_f16 v132, v132, v84
    v_fma_f32 v179, |v104|, v56, v179
    v_mfma_f32_16x16x32_f16 v[220:223], v[172:175], v[92:95], v[220:223]
    v_pk_mul_f16 v133, v133, v85
    v_fma_f32 v179, |v105|, v57, v179
    v_mfma_f32_16x16x32_f16 v[224:227], v[160:163], v[204:207], 0
    v_pk_mul_f16 v134, v134, v86
    v_fma_f32 v179, |v106|, v58, v179
    v_mfma_f32_16x16x32_f16 v[224:227], v[164:167], v[208:211], v[224:227]
    v_pk_mul_f16 v135, v135, v87
    v_fma_f32 v179, |v107|, v59, v179
    v_mfma_f32_16x16x32_f16 v[224:227], v[168:171], v[212:215], v[224:227]
    v_pk_mul_f16 v136, v136, v88
    v_pk_mul_f16 v137, v137, v89
    v_mfma_f32_16x16x32_f16 v[224:227], v[172:175], v[216:219], v[224:227]
    ds_read_b128 v[172:175], v245 offset:9408
    ds_read_b128 v[168:171], v245 offset:9344
    v_mfma_f32_16x16x32_f16 v[112:115], a[64:67], v[144:147], v[32:35]
    ds_read_b128 v[164:167], v245 offset:9280
    ds_read_b128 v[160:163], v245 offset:9216
    v_mfma_f32_16x16x32_f16 v[112:115], a[68:71], v[148:151], v[112:115]
    v_pk_mul_f16 v138, v138, v90
    v_pk_mul_f16 v139, v139, v91
    v_mfma_f32_16x16x32_f16 v[112:115], a[72:75], v[152:155], v[112:115]
    ds_write_b128 v238, v[220:223] offset:4608
    v_mfma_f32_16x16x32_f16 v[112:115], a[76:79], v[156:159], v[112:115]
    ds_write_b128 v238, v[224:227] offset:6912
    v_mfma_f32_16x16x32_f16 v[116:119], a[80:83], v[144:147], v[36:39]
    v_pk_mul_f16 v140, v140, v92
    v_fma_f32 v179, |v108|, v60, v179
    v_mfma_f32_16x16x32_f16 v[116:119], a[84:87], v[148:151], v[116:119]
    v_pk_mul_f16 v141, v141, v93
    v_fma_f32 v179, |v109|, v61, v179
    v_mfma_f32_16x16x32_f16 v[116:119], a[88:91], v[152:155], v[116:119]
    v_pk_mul_f16 v142, v142, v94
    v_fma_f32 v179, |v110|, v62, v179
    v_mfma_f32_16x16x32_f16 v[116:119], a[92:95], v[156:159], v[116:119]
    v_pk_mul_f16 v143, v143, v95
    v_fma_f32 v179, |v111|, v63, v179
    v_mfma_f32_16x16x32_f16 v[120:123], a[96:99], v[144:147], v[40:43]
    v_add_u32_sdwa v242, v235, s5 dst_sel:DWORD dst_unused:UNUSED_PAD src0_sel:WORD_1 src1_sel:DWORD
    v_fma_f32 v179, |v112|, v64, v179
    v_mfma_f32_16x16x32_f16 v[120:123], a[100:103], v[148:151], v[120:123]
    s_waitcnt lgkmcnt(2)
    v_pk_mul_f16 v160, v160, v204
    v_fma_f32 v179, |v113|, v65, v179
    v_mfma_f32_16x16x32_f16 v[120:123], a[104:107], v[152:155], v[120:123]
    v_pk_mul_f16 v161, v161, v205
    v_fma_f32 v179, |v114|, v66, v179
    v_mfma_f32_16x16x32_f16 v[120:123], a[108:111], v[156:159], v[120:123]
    v_pk_mul_f16 v162, v162, v206
    v_fma_f32 v179, |v115|, v67, v179
    v_mfma_f32_16x16x32_f16 v[124:127], a[112:115], v[144:147], v[44:47]
    v_pk_mul_f16 v163, v163, v207
    v_fma_f32 v179, |v116|, v68, v179
    v_mfma_f32_16x16x32_f16 v[124:127], a[116:119], v[148:151], v[124:127]
    v_pk_mul_f16 v164, v164, v208
    v_fma_f32 v179, |v117|, v69, v179
    v_mfma_f32_16x16x32_f16 v[124:127], a[120:123], v[152:155], v[124:127]
    v_pk_mul_f16 v165, v165, v209
    v_fma_f32 v179, |v118|, v70, v179
    v_mfma_f32_16x16x32_f16 v[124:127], a[124:127], v[156:159], v[124:127]
    v_pk_mul_f16 v166, v166, v210
    v_fma_f32 v179, |v119|, v71, v179
    v_mfma_f32_16x16x32_f16 v[96:99], a[0:3], v[128:131], v[16:19]
    ds_read_b128 v[156:159], v245 offset:6240
    v_fma_f32 v179, |v120|, v72, v179
    v_mfma_f32_16x16x32_f16 v[96:99], a[4:7], v[132:135], v[96:99]
    ds_read_b128 v[152:155], v245 offset:6176
    v_fma_f32 v179, |v121|, v73, v179
    v_mfma_f32_16x16x32_f16 v[96:99], a[8:11], v[136:139], v[96:99]
    ds_read_b128 v[148:151], v245 offset:6112
    v_fma_f32 v179, |v122|, v74, v179
    v_mfma_f32_16x16x32_f16 v[96:99], a[12:15], v[140:143], v[96:99]
    ds_read_b128 v[144:147], v245 offset:6048
    v_fma_f32 v179, |v123|, v75, v179
    v_mfma_f32_16x16x32_f16 v[100:103], a[16:19], v[128:131], v[20:23]
    v_pk_mul_f16 v167, v167, v211
    v_fma_f32 v179, |v124|, v76, v179
    v_mfma_f32_16x16x32_f16 v[100:103], a[20:23], v[132:135], v[100:103]
    v_pk_mul_f16 v168, v168, v212
    v_fma_f32 v179, |v125|, v77, v179
    v_mfma_f32_16x16x32_f16 v[100:103], a[24:27], v[136:139], v[100:103]
    v_pk_mul_f16 v169, v169, v213
    v_fma_f32 v179, |v126|, v78, v179
    v_mfma_f32_16x16x32_f16 v[100:103], a[28:31], v[140:143], v[100:103]
    v_pk_mul_f16 v170, v170, v214
    v_fma_f32 v179, |v127|, v79, v179
    v_mfma_f32_16x16x32_f16 v[104:107], a[32:35], v[128:131], v[24:27]
    v_pk_mul_f16 v171, v171, v215
    v_mul_f32 v180, |v96|, v48
    v_mfma_f32_16x16x32_f16 v[104:107], a[36:39], v[132:135], v[104:107]
    v_pk_mul_f16 v172, v172, v216
    v_fma_f32 v180, |v97|, v49, v180
    v_mfma_f32_16x16x32_f16 v[104:107], a[40:43], v[136:139], v[104:107]
    v_pk_mul_f16 v173, v173, v217
    v_fma_f32 v180, |v98|, v50, v180
    v_mfma_f32_16x16x32_f16 v[104:107], a[44:47], v[140:143], v[104:107]
    v_pk_mul_f16 v174, v174, v218
    v_fma_f32 v180, |v99|, v51, v180
    v_mfma_f32_16x16x32_f16 v[108:111], a[48:51], v[128:131], v[28:31]
    v_pk_mul_f16 v175, v175, v219
    v_fma_f32 v180, |v100|, v52, v180
    v_mfma_f32_16x16x32_f16 v[108:111], a[52:55], v[132:135], v[108:111]
    s_waitcnt lgkmcnt(0)
    v_pk_mul_f16 v144, v144, v80
    v_fma_f32 v180, |v101|, v53, v180
    v_mfma_f32_16x16x32_f16 v[108:111], a[56:59], v[136:139], v[108:111]
    v_pk_mul_f16 v145, v145, v81
    v_fma_f32 v180, |v102|, v54, v180
    v_mfma_f32_16x16x32_f16 v[108:111], a[60:63], v[140:143], v[108:111]
    v_pk_mul_f16 v146, v146, v82
    v_fma_f32 v180, |v103|, v55, v180
    v_mfma_f32_16x16x32_f16 v[228:231], v[160:163], v[204:207], 0
    v_pk_mul_f16 v147, v147, v83
    v_fma_f32 v180, |v104|, v56, v180
    v_mfma_f32_16x16x32_f16 v[228:231], v[164:167], v[208:211], v[228:231]
    v_pk_mul_f16 v148, v148, v84
    v_fma_f32 v180, |v105|, v57, v180
    v_mfma_f32_16x16x32_f16 v[228:231], v[168:171], v[212:215], v[228:231]
    v_pk_mul_f16 v149, v149, v85
    v_fma_f32 v180, |v106|, v58, v180
    v_mfma_f32_16x16x32_f16 v[228:231], v[172:175], v[216:219], v[228:231]
    ds_read_b128 v[172:175], v245 offset:9696
    v_fma_f32 v180, |v107|, v59, v180
    v_mfma_f32_16x16x32_f16 v[112:115], a[64:67], v[128:131], v[32:35]
    ds_read_b128 v[168:171], v245 offset:9632
    ds_read_b128 v[164:167], v245 offset:9568
    v_mfma_f32_16x16x32_f16 v[112:115], a[68:71], v[132:135], v[112:115]
    ds_read_b128 v[160:163], v245 offset:9504
    v_pk_mul_f16 v150, v150, v86
    v_mfma_f32_16x16x32_f16 v[112:115], a[72:75], v[136:139], v[112:115]
    ds_write_b128 v238, v[228:231] offset:2368
    v_mfma_f32_16x16x32_f16 v[112:115], a[76:79], v[140:143], v[112:115]
    v_pk_mul_f16 v151, v151, v87
    v_fma_f32 v180, |v108|, v60, v180
    v_mfma_f32_16x16x32_f16 v[116:119], a[80:83], v[128:131], v[36:39]
    v_pk_mul_f16 v152, v152, v88
    v_fma_f32 v180, |v109|, v61, v180
    v_mfma_f32_16x16x32_f16 v[116:119], a[84:87], v[132:135], v[116:119]
    v_pk_mul_f16 v153, v153, v89
    v_fma_f32 v180, |v110|, v62, v180
    v_mfma_f32_16x16x32_f16 v[116:119], a[88:91], v[136:139], v[116:119]
    v_pk_mul_f16 v154, v154, v90
    v_fma_f32 v180, |v111|, v63, v180
    v_mfma_f32_16x16x32_f16 v[116:119], a[92:95], v[140:143], v[116:119]
    v_pk_mul_f16 v155, v155, v91
    v_fma_f32 v180, |v112|, v64, v180
    v_mfma_f32_16x16x32_f16 v[120:123], a[96:99], v[128:131], v[40:43]
    v_pk_mul_f16 v156, v156, v92
    v_fma_f32 v180, |v113|, v65, v180
    v_mfma_f32_16x16x32_f16 v[120:123], a[100:103], v[132:135], v[120:123]
    v_pk_mul_f16 v157, v157, v93
    v_fma_f32 v180, |v114|, v66, v180
    v_mfma_f32_16x16x32_f16 v[120:123], a[104:107], v[136:139], v[120:123]
    s_waitcnt lgkmcnt(1)
    v_pk_mul_f16 v160, v160, v204
    v_fma_f32 v180, |v115|, v67, v180
    v_mfma_f32_16x16x32_f16 v[120:123], a[108:111], v[140:143], v[120:123]
    v_pk_mul_f16 v161, v161, v205
    v_fma_f32 v180, |v116|, v68, v180
    v_mfma_f32_16x16x32_f16 v[124:127], a[112:115], v[128:131], v[44:47]
    v_pk_mul_f16 v162, v162, v206
    v_fma_f32 v180, |v117|, v69, v180
    v_mfma_f32_16x16x32_f16 v[124:127], a[116:119], v[132:135], v[124:127]
    v_pk_mul_f16 v158, v158, v94
    v_fma_f32 v180, |v118|, v70, v180
    v_mfma_f32_16x16x32_f16 v[124:127], a[120:123], v[136:139], v[124:127]
    v_pk_mul_f16 v159, v159, v95
    v_fma_f32 v180, |v119|, v71, v180
    v_mfma_f32_16x16x32_f16 v[124:127], a[124:127], v[140:143], v[124:127]
    v_pk_mul_f16 v163, v163, v207
    v_fma_f32 v180, |v120|, v72, v180
    v_mfma_f32_16x16x32_f16 v[96:99], a[0:3], v[144:147], v[16:19]
    ds_read_b128 v[140:143], v245 offset:6528
    v_fma_f32 v180, |v121|, v73, v180
    v_mfma_f32_16x16x32_f16 v[96:99], a[4:7], v[148:151], v[96:99]
    ds_read_b128 v[136:139], v245 offset:6464
    v_fma_f32 v180, |v122|, v74, v180
    v_mfma_f32_16x16x32_f16 v[96:99], a[8:11], v[152:155], v[96:99]
    ds_read_b128 v[132:135], v245 offset:6400
    v_fma_f32 v180, |v123|, v75, v180
    v_mfma_f32_16x16x32_f16 v[96:99], a[12:15], v[156:159], v[96:99]
    ds_read_b128 v[128:131], v245 offset:6336
    v_fma_f32 v180, |v124|, v76, v180
    v_mfma_f32_16x16x32_f16 v[100:103], a[16:19], v[144:147], v[20:23]
    v_pk_mul_f16 v164, v164, v208
    v_fma_f32 v180, |v125|, v77, v180
    v_mfma_f32_16x16x32_f16 v[100:103], a[20:23], v[148:151], v[100:103]
    v_pk_mul_f16 v165, v165, v209
    v_fma_f32 v180, |v126|, v78, v180
    v_mfma_f32_16x16x32_f16 v[100:103], a[24:27], v[152:155], v[100:103]
    v_pk_mul_f16 v166, v166, v210
    v_fma_f32 v180, |v127|, v79, v180
    v_mfma_f32_16x16x32_f16 v[100:103], a[28:31], v[156:159], v[100:103]
    v_pk_mul_f16 v167, v167, v211
    v_mul_f32 v181, |v96|, v48
    v_mfma_f32_16x16x32_f16 v[104:107], a[32:35], v[144:147], v[24:27]
    v_pk_mul_f16 v168, v168, v212
    v_fma_f32 v181, |v97|, v49, v181
    v_mfma_f32_16x16x32_f16 v[104:107], a[36:39], v[148:151], v[104:107]
    v_pk_mul_f16 v169, v169, v213
    v_fma_f32 v181, |v98|, v50, v181
    v_mfma_f32_16x16x32_f16 v[104:107], a[40:43], v[152:155], v[104:107]
    v_pk_mul_f16 v170, v170, v214
    v_fma_f32 v181, |v99|, v51, v181
    v_mfma_f32_16x16x32_f16 v[104:107], a[44:47], v[156:159], v[104:107]
    v_pk_mul_f16 v171, v171, v215
    v_fma_f32 v181, |v100|, v52, v181
    v_mfma_f32_16x16x32_f16 v[108:111], a[48:51], v[144:147], v[28:31]
    v_pk_mul_f16 v172, v172, v216
    v_fma_f32 v181, |v101|, v53, v181
    v_mfma_f32_16x16x32_f16 v[108:111], a[52:55], v[148:151], v[108:111]
    v_pk_mul_f16 v173, v173, v217
    v_fma_f32 v181, |v102|, v54, v181
    v_mfma_f32_16x16x32_f16 v[108:111], a[56:59], v[152:155], v[108:111]
    v_pk_mul_f16 v174, v174, v218
    v_fma_f32 v181, |v103|, v55, v181
    v_mfma_f32_16x16x32_f16 v[108:111], a[60:63], v[156:159], v[108:111]
    s_waitcnt lgkmcnt(0)
    v_pk_mul_f16 v128, v128, v80
    v_fma_f32 v181, |v104|, v56, v181
    v_mfma_f32_16x16x32_f16 v[112:115], a[64:67], v[144:147], v[32:35]
    v_pk_mul_f16 v129, v129, v81
    v_fma_f32 v181, |v105|, v57, v181
    v_mfma_f32_16x16x32_f16 v[112:115], a[68:71], v[148:151], v[112:115]
    v_pk_mul_f16 v130, v130, v82
    v_fma_f32 v181, |v106|, v58, v181
    v_mfma_f32_16x16x32_f16 v[112:115], a[72:75], v[152:155], v[112:115]
    v_pk_mul_f16 v131, v131, v83
    v_fma_f32 v181, |v107|, v59, v181
    v_mfma_f32_16x16x32_f16 v[112:115], a[76:79], v[156:159], v[112:115]
    v_pk_mul_f16 v132, v132, v84
    v_fma_f32 v181, |v108|, v60, v181
    v_mfma_f32_16x16x32_f16 v[116:119], a[80:83], v[144:147], v[36:39]
    v_pk_mul_f16 v133, v133, v85
    v_fma_f32 v181, |v109|, v61, v181
    v_mfma_f32_16x16x32_f16 v[116:119], a[84:87], v[148:151], v[116:119]
    v_pk_mul_f16 v134, v134, v86
    v_fma_f32 v181, |v110|, v62, v181
    v_mfma_f32_16x16x32_f16 v[116:119], a[88:91], v[152:155], v[116:119]
    v_pk_mul_f16 v135, v135, v87
    v_fma_f32 v181, |v111|, v63, v181
    v_mfma_f32_16x16x32_f16 v[116:119], a[92:95], v[156:159], v[116:119]
    v_pk_mul_f16 v136, v136, v88
    v_fma_f32 v181, |v112|, v64, v181
    v_mfma_f32_16x16x32_f16 v[120:123], a[96:99], v[144:147], v[40:43]
    v_pk_mul_f16 v137, v137, v89
    v_fma_f32 v181, |v113|, v65, v181
    v_mfma_f32_16x16x32_f16 v[120:123], a[100:103], v[148:151], v[120:123]
    v_pk_mul_f16 v138, v138, v90
    v_fma_f32 v181, |v114|, v66, v181
    v_mfma_f32_16x16x32_f16 v[120:123], a[104:107], v[152:155], v[120:123]
    v_pk_mul_f16 v139, v139, v91
    v_fma_f32 v181, |v115|, v67, v181
    v_mfma_f32_16x16x32_f16 v[120:123], a[108:111], v[156:159], v[120:123]
    v_pk_mul_f16 v140, v140, v92
    v_fma_f32 v181, |v116|, v68, v181
    v_mfma_f32_16x16x32_f16 v[124:127], a[112:115], v[144:147], v[44:47]
    v_pk_mul_f16 v141, v141, v93
    v_fma_f32 v181, |v117|, v69, v181
    v_mfma_f32_16x16x32_f16 v[124:127], a[116:119], v[148:151], v[124:127]
    v_pk_mul_f16 v142, v142, v94
    v_fma_f32 v181, |v118|, v70, v181
    v_mfma_f32_16x16x32_f16 v[124:127], a[120:123], v[152:155], v[124:127]
    v_pk_mul_f16 v143, v143, v95
    v_fma_f32 v181, |v119|, v71, v181
    v_mfma_f32_16x16x32_f16 v[124:127], a[124:127], v[156:159], v[124:127]
    v_pk_mul_f16 v175, v175, v219
    v_fma_f32 v181, |v120|, v72, v181
    v_mfma_f32_16x16x32_f16 v[96:99], a[0:3], v[128:131], v[16:19]
    ds_read_b128 v[156:159], v245 offset:6816
    v_fma_f32 v181, |v121|, v73, v181
    v_mfma_f32_16x16x32_f16 v[96:99], a[4:7], v[132:135], v[96:99]
    ds_read_b128 v[152:155], v245 offset:6752
    v_fma_f32 v181, |v122|, v74, v181
    v_mfma_f32_16x16x32_f16 v[96:99], a[8:11], v[136:139], v[96:99]
    ds_read_b128 v[148:151], v245 offset:6688
    v_fma_f32 v181, |v123|, v75, v181
    v_mfma_f32_16x16x32_f16 v[96:99], a[12:15], v[140:143], v[96:99]
    ds_read_b128 v[144:147], v245 offset:6624
    v_fma_f32 v181, |v124|, v76, v181
    v_mfma_f32_16x16x32_f16 v[228:231], v[160:163], v[204:207], 0
    v_add_u32_sdwa v235, v235, s5 dst_sel:DWORD dst_unused:UNUSED_PAD src0_sel:WORD_0 src1_sel:DWORD
    v_fma_f32 v181, |v125|, v77, v181
    v_mfma_f32_16x16x32_f16 v[228:231], v[164:167], v[208:211], v[228:231]
    v_add_u32_sdwa v243, v236, s5 dst_sel:DWORD dst_unused:UNUSED_PAD src0_sel:WORD_1 src1_sel:DWORD
    v_fma_f32 v181, |v126|, v78, v181
    v_mfma_f32_16x16x32_f16 v[228:231], v[168:171], v[212:215], v[228:231]
    v_add_u32_sdwa v236, v236, s5 dst_sel:DWORD dst_unused:UNUSED_PAD src0_sel:WORD_0 src1_sel:DWORD
    v_fma_f32 v181, |v127|, v79, v181
    v_mfma_f32_16x16x32_f16 v[228:231], v[172:175], v[216:219], v[228:231]
    v_add_u32_sdwa v244, v237, s5 dst_sel:DWORD dst_unused:UNUSED_PAD src0_sel:WORD_1 src1_sel:DWORD
    v_add_u32_sdwa v237, v237, s5 dst_sel:DWORD dst_unused:UNUSED_PAD src0_sel:WORD_0 src1_sel:DWORD
    v_mfma_f32_16x16x32_f16 v[100:103], a[16:19], v[128:131], v[20:23]
    v_permlane32_swap_b32 v184, v186
    v_mfma_f32_16x16x32_f16 v[100:103], a[20:23], v[132:135], v[100:103]
    v_permlane32_swap_b32 v185, v187
    v_mfma_f32_16x16x32_f16 v[100:103], a[24:27], v[136:139], v[100:103]
    v_add_f32 v184, v184, v186
    v_mul_f32 v182, |v96|, v48
    v_mfma_f32_16x16x32_f16 v[100:103], a[28:31], v[140:143], v[100:103]
    ds_write_b128 v238, v[228:231] offset:6976
    v_mfma_f32_16x16x32_f16 v[104:107], a[32:35], v[128:131], v[24:27]
    ds_read2st64_b32 v[230:231], v237 offset0:0 offset1:18
    v_fma_f32 v182, |v97|, v49, v182
    v_mfma_f32_16x16x32_f16 v[104:107], a[36:39], v[132:135], v[104:107]
    ds_read2st64_b32 v[228:229], v236 offset0:0 offset1:18
    v_fma_f32 v182, |v98|, v50, v182
    v_mfma_f32_16x16x32_f16 v[104:107], a[40:43], v[136:139], v[104:107]
    ds_read2st64_b32 v[222:223], v233 offset0:0 offset1:18
    v_fma_f32 v182, |v99|, v51, v182
    v_mfma_f32_16x16x32_f16 v[104:107], a[44:47], v[140:143], v[104:107]
    ds_read2st64_b32 v[220:221], v232 offset0:0 offset1:18
    v_fma_f32 v182, |v100|, v52, v182
    v_mfma_f32_16x16x32_f16 v[108:111], a[48:51], v[128:131], v[28:31]
    ds_read2st64_b32 v[226:227], v235 offset0:0 offset1:18
    v_fma_f32 v182, |v101|, v53, v182
    v_mfma_f32_16x16x32_f16 v[108:111], a[52:55], v[132:135], v[108:111]
    ds_read2st64_b32 v[224:225], v234 offset0:0 offset1:18
    v_fma_f32 v182, |v102|, v54, v182
    v_mfma_f32_16x16x32_f16 v[108:111], a[56:59], v[136:139], v[108:111]
    s_waitcnt lgkmcnt(7)
    v_pk_mul_f16 v144, v144, v80
    v_fma_f32 v182, |v103|, v55, v182
    v_mfma_f32_16x16x32_f16 v[108:111], a[60:63], v[140:143], v[108:111]
    v_pk_mul_f16 v145, v145, v81
    v_fma_f32 v182, |v104|, v56, v182
    v_mfma_f32_16x16x32_f16 v[112:115], a[64:67], v[128:131], v[32:35]
    v_pk_mul_f16 v146, v146, v82
    v_fma_f32 v182, |v105|, v57, v182
    v_mfma_f32_16x16x32_f16 v[112:115], a[68:71], v[132:135], v[112:115]
    v_pk_mul_f16 v147, v147, v83
    v_fma_f32 v182, |v106|, v58, v182
    v_mfma_f32_16x16x32_f16 v[112:115], a[72:75], v[136:139], v[112:115]
    v_pk_mul_f16 v148, v148, v84
    v_fma_f32 v182, |v107|, v59, v182
    v_mfma_f32_16x16x32_f16 v[112:115], a[76:79], v[140:143], v[112:115]
    v_pk_mul_f16 v149, v149, v85
    v_fma_f32 v182, |v108|, v60, v182
    v_mfma_f32_16x16x32_f16 v[116:119], a[80:83], v[128:131], v[36:39]
    v_pk_mul_f16 v150, v150, v86
    v_fma_f32 v182, |v109|, v61, v182
    v_mfma_f32_16x16x32_f16 v[116:119], a[84:87], v[132:135], v[116:119]
    v_pk_mul_f16 v151, v151, v87
    v_fma_f32 v182, |v110|, v62, v182
    v_mfma_f32_16x16x32_f16 v[116:119], a[88:91], v[136:139], v[116:119]
    v_pk_mul_f16 v152, v152, v88
    v_fma_f32 v182, |v111|, v63, v182
    v_mfma_f32_16x16x32_f16 v[116:119], a[92:95], v[140:143], v[116:119]
    v_pk_mul_f16 v153, v153, v89
    v_fma_f32 v182, |v112|, v64, v182
    v_mfma_f32_16x16x32_f16 v[120:123], a[96:99], v[128:131], v[40:43]
    v_pk_mul_f16 v154, v154, v90
    v_fma_f32 v182, |v113|, v65, v182
    v_mfma_f32_16x16x32_f16 v[120:123], a[100:103], v[132:135], v[120:123]
    v_pk_mul_f16 v155, v155, v91
    v_fma_f32 v182, |v114|, v66, v182
    v_mfma_f32_16x16x32_f16 v[120:123], a[104:107], v[136:139], v[120:123]
    v_pk_mul_f16 v156, v156, v92
    v_fma_f32 v182, |v115|, v67, v182
    v_mfma_f32_16x16x32_f16 v[120:123], a[108:111], v[140:143], v[120:123]
    v_pk_mul_f16 v157, v157, v93
    v_fma_f32 v182, |v116|, v68, v182
    v_mfma_f32_16x16x32_f16 v[124:127], a[112:115], v[128:131], v[44:47]
    v_pk_mul_f16 v158, v158, v94
    v_fma_f32 v182, |v117|, v69, v182
    v_mfma_f32_16x16x32_f16 v[124:127], a[116:119], v[132:135], v[124:127]
    v_pk_mul_f16 v159, v159, v95
    v_fma_f32 v182, |v118|, v70, v182
    v_mfma_f32_16x16x32_f16 v[124:127], a[120:123], v[136:139], v[124:127]
    v_add_f32 v185, v185, v187
    v_fma_f32 v182, |v119|, v71, v182
    v_mfma_f32_16x16x32_f16 v[124:127], a[124:127], v[140:143], v[124:127]
    v_permlane16_swap_b32 v184, v185
    v_mfma_f32_16x16x32_f16 v[96:99], a[0:3], v[144:147], v[16:19]
    ds_read_b128 v[140:143], v245 offset:7104
    v_fma_f32 v182, |v120|, v72, v182
    v_mfma_f32_16x16x32_f16 v[96:99], a[4:7], v[148:151], v[96:99]
    ds_read_b128 v[136:139], v245 offset:7040
    v_fma_f32 v182, |v121|, v73, v182
    v_mfma_f32_16x16x32_f16 v[96:99], a[8:11], v[152:155], v[96:99]
    ds_read_b128 v[132:135], v245 offset:6976
    v_fma_f32 v182, |v122|, v74, v182
    v_mfma_f32_16x16x32_f16 v[96:99], a[12:15], v[156:159], v[96:99]
    ds_read_b128 v[128:131], v245 offset:6912
    v_fma_f32 v182, |v123|, v75, v182
    v_mfma_f32_16x16x32_f16 v[100:103], a[16:19], v[144:147], v[20:23]
    v_add_f32 v184, v184, v185
    v_fma_f32 v182, |v124|, v76, v182
    v_mfma_f32_16x16x32_f16 v[100:103], a[20:23], v[148:151], v[100:103]
    s_waitcnt lgkmcnt(4)
    v_fma_f32 v184, v224, s12, v184
    v_fma_f32 v182, |v125|, v77, v182
    v_mfma_f32_16x16x32_f16 v[100:103], a[24:27], v[152:155], v[100:103]
    v_permlane32_swap_b32 v188, v190
    v_mfma_f32_16x16x32_f16 v[100:103], a[28:31], v[156:159], v[100:103]
    v_permlane32_swap_b32 v189, v191
    v_mfma_f32_16x16x32_f16 v[104:107], a[32:35], v[144:147], v[24:27]
    v_add_f32 v188, v188, v190
    v_fma_f32 v182, |v126|, v78, v182
    v_mfma_f32_16x16x32_f16 v[104:107], a[36:39], v[148:151], v[104:107]
    v_add_f32 v189, v189, v191
    v_fma_f32 v182, |v127|, v79, v182
    v_mfma_f32_16x16x32_f16 v[104:107], a[40:43], v[152:155], v[104:107]
    v_permlane16_swap_b32 v188, v189
    v_mfma_f32_16x16x32_f16 v[104:107], a[44:47], v[156:159], v[104:107]
    v_add_f32 v188, v188, v189
    v_mul_f32 v183, |v96|, v48
    v_mfma_f32_16x16x32_f16 v[108:111], a[48:51], v[144:147], v[28:31]
    s_waitcnt lgkmcnt(0)
    v_pk_mul_f16 v128, v128, v80
    v_fma_f32 v183, |v97|, v49, v183
    v_mfma_f32_16x16x32_f16 v[108:111], a[52:55], v[148:151], v[108:111]
    v_pk_mul_f16 v129, v129, v81
    v_fma_f32 v183, |v98|, v50, v183
    v_mfma_f32_16x16x32_f16 v[108:111], a[56:59], v[152:155], v[108:111]
    v_pk_mul_f16 v130, v130, v82
    v_fma_f32 v183, |v99|, v51, v183
    v_mfma_f32_16x16x32_f16 v[108:111], a[60:63], v[156:159], v[108:111]
    v_pk_mul_f16 v131, v131, v83
    v_fma_f32 v183, |v100|, v52, v183
    v_mfma_f32_16x16x32_f16 v[112:115], a[64:67], v[144:147], v[32:35]
    v_pk_mul_f16 v132, v132, v84
    v_fma_f32 v183, |v101|, v53, v183
    v_mfma_f32_16x16x32_f16 v[112:115], a[68:71], v[148:151], v[112:115]
    v_pk_mul_f16 v133, v133, v85
    v_fma_f32 v183, |v102|, v54, v183
    v_mfma_f32_16x16x32_f16 v[112:115], a[72:75], v[152:155], v[112:115]
    v_pk_mul_f16 v134, v134, v86
    v_fma_f32 v183, |v103|, v55, v183
    v_mfma_f32_16x16x32_f16 v[112:115], a[76:79], v[156:159], v[112:115]
    v_pk_mul_f16 v135, v135, v87
    v_fma_f32 v183, |v104|, v56, v183
    v_mfma_f32_16x16x32_f16 v[116:119], a[80:83], v[144:147], v[36:39]
    v_pk_mul_f16 v136, v136, v88
    v_fma_f32 v183, |v105|, v57, v183
    v_mfma_f32_16x16x32_f16 v[116:119], a[84:87], v[148:151], v[116:119]
    v_pk_mul_f16 v137, v137, v89
    v_fma_f32 v183, |v106|, v58, v183
    v_mfma_f32_16x16x32_f16 v[116:119], a[88:91], v[152:155], v[116:119]
    v_pk_mul_f16 v138, v138, v90
    v_fma_f32 v183, |v107|, v59, v183
    v_mfma_f32_16x16x32_f16 v[116:119], a[92:95], v[156:159], v[116:119]
    v_pk_mul_f16 v139, v139, v91
    v_fma_f32 v183, |v108|, v60, v183
    v_mfma_f32_16x16x32_f16 v[120:123], a[96:99], v[144:147], v[40:43]
    v_pk_mul_f16 v140, v140, v92
    v_fma_f32 v183, |v109|, v61, v183
    v_mfma_f32_16x16x32_f16 v[120:123], a[100:103], v[148:151], v[120:123]
    v_pk_mul_f16 v141, v141, v93
    v_fma_f32 v183, |v110|, v62, v183
    v_mfma_f32_16x16x32_f16 v[120:123], a[104:107], v[152:155], v[120:123]
    v_pk_mul_f16 v142, v142, v94
    v_fma_f32 v183, |v111|, v63, v183
    v_mfma_f32_16x16x32_f16 v[120:123], a[108:111], v[156:159], v[120:123]
    v_pk_mul_f16 v143, v143, v95
    v_fma_f32 v183, |v112|, v64, v183
    v_mfma_f32_16x16x32_f16 v[124:127], a[112:115], v[144:147], v[44:47]
    v_fma_f32 v188, v226, s12, v188
    v_fma_f32 v183, |v113|, v65, v183
    v_mfma_f32_16x16x32_f16 v[124:127], a[116:119], v[148:151], v[124:127]
    v_cndmask_b32 v188, v251, v188, s[36:37]
    v_fma_f32 v183, |v114|, v66, v183
    v_mfma_f32_16x16x32_f16 v[124:127], a[120:123], v[152:155], v[124:127]
    v_permlane32_swap_b32 v176, v178
    v_mfma_f32_16x16x32_f16 v[124:127], a[124:127], v[156:159], v[124:127]
    v_permlane32_swap_b32 v177, v179
    v_mfma_f32_16x16x32_f16 v[96:99], a[0:3], v[128:131], v[16:19]
    ds_read_b128 v[156:159], v245 offset:7392
    v_fma_f32 v183, |v115|, v67, v183
    v_mfma_f32_16x16x32_f16 v[96:99], a[4:7], v[132:135], v[96:99]
    ds_read_b128 v[152:155], v245 offset:7328
    v_fma_f32 v183, |v116|, v68, v183
    v_mfma_f32_16x16x32_f16 v[96:99], a[8:11], v[136:139], v[96:99]
    ds_read_b128 v[148:151], v245 offset:7264
    v_fma_f32 v183, |v117|, v69, v183
    v_mfma_f32_16x16x32_f16 v[96:99], a[12:15], v[140:143], v[96:99]
    ds_read_b128 v[144:147], v245 offset:7200
    v_fma_f32 v183, |v118|, v70, v183
    v_mfma_f32_16x16x32_f16 v[100:103], a[16:19], v[128:131], v[20:23]
    v_add_f32 v176, v176, v178
    v_fma_f32 v183, |v119|, v71, v183
    v_mfma_f32_16x16x32_f16 v[100:103], a[20:23], v[132:135], v[100:103]
    v_add_f32 v177, v177, v179
    v_fma_f32 v183, |v120|, v72, v183
    v_mfma_f32_16x16x32_f16 v[100:103], a[24:27], v[136:139], v[100:103]
    v_permlane16_swap_b32 v176, v177
    v_mfma_f32_16x16x32_f16 v[100:103], a[28:31], v[140:143], v[100:103]
    v_add_f32 v176, v176, v177
    v_fma_f32 v183, |v121|, v73, v183
    v_mfma_f32_16x16x32_f16 v[104:107], a[32:35], v[128:131], v[24:27]
    v_fma_f32 v176, v220, s12, v176
    v_fma_f32 v183, |v122|, v74, v183
    v_mfma_f32_16x16x32_f16 v[104:107], a[36:39], v[132:135], v[104:107]
    v_max3_f32 v248, v184, v188, v176
    v_fma_f32 v183, |v123|, v75, v183
    v_mfma_f32_16x16x32_f16 v[104:107], a[40:43], v[136:139], v[104:107]
    v_fma_f32 v183, |v124|, v76, v183
    v_fma_f32 v183, |v125|, v77, v183
    v_mfma_f32_16x16x32_f16 v[104:107], a[44:47], v[140:143], v[104:107]
    v_fma_f32 v183, |v126|, v78, v183
    v_fma_f32 v183, |v127|, v79, v183
    v_mfma_f32_16x16x32_f16 v[108:111], a[48:51], v[128:131], v[28:31]
    s_waitcnt lgkmcnt(0)
    v_pk_mul_f16 v144, v144, v80
    v_mul_f32 v192, |v96|, v48
    v_mfma_f32_16x16x32_f16 v[108:111], a[52:55], v[132:135], v[108:111]
    v_pk_mul_f16 v145, v145, v81
    v_fma_f32 v192, |v97|, v49, v192
    v_mfma_f32_16x16x32_f16 v[108:111], a[56:59], v[136:139], v[108:111]
    v_pk_mul_f16 v146, v146, v82
    v_fma_f32 v192, |v98|, v50, v192
    v_mfma_f32_16x16x32_f16 v[108:111], a[60:63], v[140:143], v[108:111]
    v_pk_mul_f16 v147, v147, v83
    v_fma_f32 v192, |v99|, v51, v192
    v_mfma_f32_16x16x32_f16 v[112:115], a[64:67], v[128:131], v[32:35]
L_pad3:
    s_cbranch_execz L_hopret
    v_pk_mul_f16 v148, v148, v84
    v_fma_f32 v192, |v100|, v52, v192
    v_mfma_f32_16x16x32_f16 v[112:115], a[68:71], v[132:135], v[112:115]
    v_pk_mul_f16 v149, v149, v85
    v_fma_f32 v192, |v101|, v53, v192
    v_mfma_f32_16x16x32_f16 v[112:115], a[72:75], v[136:139], v[112:115]
    v_pk_mul_f16 v150, v150, v86
    v_fma_f32 v192, |v102|, v54, v192
    v_mfma_f32_16x16x32_f16 v[112:115], a[76:79], v[140:143], v[112:115]
    v_pk_mul_f16 v151, v151, v87
    v_fma_f32 v192, |v103|, v55, v192
    v_mfma_f32_16x16x32_f16 v[116:119], a[80:83], v[128:131], v[36:39]
    v_pk_mul_f16 v152, v152, v88
    v_fma_f32 v192, |v104|, v56, v192
    v_mfma_f32_16x16x32_f16 v[116:119], a[84:87], v[132:135], v[116:119]
    v_pk_mul_f16 v153, v153, v89
    v_fma_f32 v192, |v105|, v57, v192
    v_mfma_f32_16x16x32_f16 v[116:119], a[88:91], v[136:139], v[116:119]
    v_pk_mul_f16 v154, v154, v90
    v_fma_f32 v192, |v106|, v58, v192
    v_mfma_f32_16x16x32_f16 v[116:119], a[92:95], v[140:143], v[116:119]
    v_pk_mul_f16 v155, v155, v91
    v_fma_f32 v192, |v107|, v59, v192
    v_mfma_f32_16x16x32_f16 v[120:123], a[96:99], v[128:131], v[40:43]
    v_pk_mul_f16 v156, v156, v92
    v_fma_f32 v192, |v108|, v60, v192
    v_mfma_f32_16x16x32_f16 v[120:123], a[100:103], v[132:135], v[120:123]
    v_pk_mul_f16 v157, v157, v93
    v_fma_f32 v192, |v109|, v61, v192
    v_mfma_f32_16x16x32_f16 v[120:123], a[104:107], v[136:139], v[120:123]
    v_pk_mul_f16 v158, v158, v94
    v_fma_f32 v192, |v110|, v62, v192
    v_mfma_f32_16x16x32_f16 v[120:123], a[108:111], v[140:143], v[120:123]
    v_pk_mul_f16 v159, v159, v95
    v_fma_f32 v192, |v111|, v63, v192
    v_mfma_f32_16x16x32_f16 v[124:127], a[112:115], v[128:131], v[44:47]
    ds_read_b128 v[216:219], v239 offset:4800
    v_fma_f32 v192, |v112|, v64, v192
    v_mfma_f32_16x16x32_f16 v[124:127], a[116:119], v[132:135], v[124:127]
    ds_read_b128 v[212:215], v239 offset:4736
    v_fma_f32 v192, |v113|, v65, v192
    v_mfma_f32_16x16x32_f16 v[124:127], a[120:123], v[136:139], v[124:127]
    ds_read_b128 v[208:211], v239 offset:4672
    v_fma_f32 v192, |v114|, v66, v192
    v_mfma_f32_16x16x32_f16 v[124:127], a[124:127], v[140:143], v[124:127]
    ds_read_b128 v[204:207], v239 offset:4608
    v_fma_f32 v192, |v115|, v67, v192
    v_mfma_f32_16x16x32_f16 v[96:99], a[0:3], v[144:147], v[16:19]
    ds_read_b128 v[140:143], v240 offset:4800
    v_fma_f32 v192, |v116|, v68, v192
    v_mfma_f32_16x16x32_f16 v[96:99], a[4:7], v[148:151], v[96:99]
    ds_read_b128 v[136:139], v240 offset:4736
    v_fma_f32 v192, |v117|, v69, v192
    v_mfma_f32_16x16x32_f16 v[96:99], a[8:11], v[152:155], v[96:99]
    ds_read_b128 v[132:135], v240 offset:4672
    v_fma_f32 v192, |v118|, v70, v192
    v_mfma_f32_16x16x32_f16 v[96:99], a[12:15], v[156:159], v[96:99]
    ds_read_b128 v[128:131], v240 offset:4608
    v_fma_f32 v192, |v119|, v71, v192
    v_mfma_f32_16x16x32_f16 v[100:103], a[16:19], v[144:147], v[20:23]
    v_permlane32_swap_b32 v180, v182
    v_mfma_f32_16x16x32_f16 v[100:103], a[20:23], v[148:151], v[100:103]
    v_permlane32_swap_b32 v181, v183
    v_mfma_f32_16x16x32_f16 v[100:103], a[24:27], v[152:155], v[100:103]
    v_add_f32 v180, v180, v182
    v_fma_f32 v192, |v120|, v72, v192
    v_mfma_f32_16x16x32_f16 v[100:103], a[28:31], v[156:159], v[100:103]
    v_add_f32 v181, v181, v183
    v_fma_f32 v192, |v121|, v73, v192
    v_mfma_f32_16x16x32_f16 v[104:107], a[32:35], v[144:147], v[24:27]
    v_permlane16_swap_b32 v180, v181
    v_mfma_f32_16x16x32_f16 v[104:107], a[36:39], v[148:151], v[104:107]
    v_add_f32 v180, v180, v181
    v_fma_f32 v192, |v122|, v74, v192
    v_mfma_f32_16x16x32_f16 v[104:107], a[40:43], v[152:155], v[104:107]
    v_fma_f32 v180, v222, s12, v180
    v_fma_f32 v192, |v123|, v75, v192
    v_mfma_f32_16x16x32_f16 v[104:107], a[44:47], v[156:159], v[104:107]
    v_fma_f32 v192, |v124|, v76, v192
    v_fma_f32 v192, |v125|, v77, v192
    v_mfma_f32_16x16x32_f16 v[108:111], a[48:51], v[144:147], v[28:31]
    s_waitcnt lgkmcnt(0)
    v_pk_mul_f16 v128, v128, v204
    v_fma_f32 v192, |v126|, v78, v192
    v_mfma_f32_16x16x32_f16 v[108:111], a[52:55], v[148:151], v[108:111]
    v_pk_mul_f16 v129, v129, v205
    v_fma_f32 v192, |v127|, v79, v192
    v_mfma_f32_16x16x32_f16 v[108:111], a[56:59], v[152:155], v[108:111]
    v_pk_mul_f16 v130, v130, v206
    v_mul_f32 v194, |v96|, v48
    v_mfma_f32_16x16x32_f16 v[108:111], a[60:63], v[156:159], v[108:111]
    v_pk_mul_f16 v131, v131, v207
    v_fma_f32 v194, |v97|, v49, v194
    v_mfma_f32_16x16x32_f16 v[112:115], a[64:67], v[144:147], v[32:35]
    v_pk_mul_f16 v132, v132, v208
    v_fma_f32 v194, |v98|, v50, v194
    v_mfma_f32_16x16x32_f16 v[112:115], a[68:71], v[148:151], v[112:115]
    v_pk_mul_f16 v133, v133, v209
    v_fma_f32 v194, |v99|, v51, v194
    v_mfma_f32_16x16x32_f16 v[112:115], a[72:75], v[152:155], v[112:115]
    v_pk_mul_f16 v134, v134, v210
    v_fma_f32 v194, |v100|, v52, v194
    v_mfma_f32_16x16x32_f16 v[112:115], a[76:79], v[156:159], v[112:115]
    v_pk_mul_f16 v135, v135, v211
    v_fma_f32 v194, |v101|, v53, v194
    v_mfma_f32_16x16x32_f16 v[116:119], a[80:83], v[144:147], v[36:39]
    v_pk_mul_f16 v136, v136, v212
    v_fma_f32 v194, |v102|, v54, v194
    v_mfma_f32_16x16x32_f16 v[116:119], a[84:87], v[148:151], v[116:119]
    v_pk_mul_f16 v137, v137, v213
    v_fma_f32 v194, |v103|, v55, v194
    v_mfma_f32_16x16x32_f16 v[116:119], a[88:91], v[152:155], v[116:119]
    v_pk_mul_f16 v138, v138, v214
    v_fma_f32 v194, |v104|, v56, v194
    v_mfma_f32_16x16x32_f16 v[116:119], a[92:95], v[156:159], v[116:119]
    v_pk_mul_f16 v139, v139, v215
    v_fma_f32 v194, |v105|, v57, v194
    v_mfma_f32_16x16x32_f16 v[120:123], a[96:99], v[144:147], v[40:43]
    v_pk_mul_f16 v140, v140, v216
    v_fma_f32 v194, |v106|, v58, v194
    v_mfma_f32_16x16x32_f16 v[120:123], a[100:103], v[148:151], v[120:123]
    v_pk_mul_f16 v141, v141, v217
    v_fma_f32 v194, |v107|, v59, v194
    v_mfma_f32_16x16x32_f16 v[120:123], a[104:107], v[152:155], v[120:123]
    v_pk_mul_f16 v142, v142, v218
    v_fma_f32 v194, |v108|, v60, v194
    v_mfma_f32_16x16x32_f16 v[120:123], a[108:111], v[156:159], v[120:123]
    v_pk_mul_f16 v143, v143, v219
    v_fma_f32 v194, |v109|, v61, v194
    v_mfma_f32_16x16x32_f16 v[124:127], a[112:115], v[144:147], v[44:47]
    ds_read_b128 v[216:219], v243 offset:4800
    v_fma_f32 v194, |v110|, v62, v194
    v_mfma_f32_16x16x32_f16 v[124:127], a[116:119], v[148:151], v[124:127]
    ds_read_b128 v[212:215], v243 offset:4736
    v_fma_f32 v194, |v111|, v63, v194
    v_mfma_f32_16x16x32_f16 v[124:127], a[120:123], v[152:155], v[124:127]
    ds_read_b128 v[208:211], v243 offset:4672
    v_fma_f32 v194, |v112|, v64, v194
    v_mfma_f32_16x16x32_f16 v[124:127], a[124:127], v[156:159], v[124:127]
    ds_read_b128 v[204:207], v243 offset:4608
    v_fma_f32 v194, |v113|, v65, v194
    v_mfma_f32_16x16x32_f16 v[96:99], a[0:3], v[128:131], v[16:19]
    ds_read_b128 v[156:159], v244 offset:4800
    v_fma_f32 v194, |v114|, v66, v194
    v_mfma_f32_16x16x32_f16 v[96:99], a[4:7], v[132:135], v[96:99]
    ds_read_b128 v[152:155], v244 offset:4736
    v_fma_f32 v194, |v115|, v67, v194
    v_mfma_f32_16x16x32_f16 v[96:99], a[8:11], v[136:139], v[96:99]
    ds_read_b128 v[148:151], v244 offset:4672
    v_fma_f32 v194, |v116|, v68, v194
    v_mfma_f32_16x16x32_f16 v[96:99], a[12:15], v[140:143], v[96:99]
    ds_read_b128 v[144:147], v244 offset:4608
    v_fma_f32 v194, |v117|, v69, v194
    v_mfma_f32_16x16x32_f16 v[100:103], a[16:19], v[128:131], v[20:23]
    v_fma_f32 v194, |v118|, v70, v194
    v_fma_f32 v194, |v119|, v71, v194
    v_mfma_f32_16x16x32_f16 v[100:103], a[20:23], v[132:135], v[100:103]
    v_fma_f32 v194, |v120|, v72, v194
    v_fma_f32 v194, |v121|, v73, v194
    v_mfma_f32_16x16x32_f16 v[100:103], a[24:27], v[136:139], v[100:103]
    v_fma_f32 v194, |v122|, v74, v194
    v_fma_f32 v194, |v123|, v75, v194
    v_mfma_f32_16x16x32_f16 v[100:103], a[28:31], v[140:143], v[100:103]
    v_fma_f32 v194, |v124|, v76, v194
    v_fma_f32 v194, |v125|, v77, v194
    v_mfma_f32_16x16x32_f16 v[104:107], a[32:35], v[128:131], v[24:27]
    v_fma_f32 v194, |v126|, v78, v194
    v_mfma_f32_16x16x32_f16 v[104:107], a[36:39], v[132:135], v[104:107]
    v_fma_f32 v194, |v127|, v79, v194
    v_mul_f32 v196, |v96|, v48
    v_mfma_f32_16x16x32_f16 v[104:107], a[40:43], v[136:139], v[104:107]
    v_permlane32_swap_b32 v192, v194
    v_mfma_f32_16x16x32_f16 v[104:107], a[44:47], v[140:143], v[104:107]
    v_add_f32 v192, v192, v194
    v_fma_f32 v196, |v97|, v49, v196
    v_mfma_f32_16x16x32_f16 v[108:111], a[48:51], v[128:131], v[28:31]
    s_waitcnt lgkmcnt(0)
    v_pk_mul_f16 v144, v144, v204
    v_fma_f32 v196, |v98|, v50, v196
    v_mfma_f32_16x16x32_f16 v[108:111], a[52:55], v[132:135], v[108:111]
    v_pk_mul_f16 v145, v145, v205
    v_fma_f32 v196, |v99|, v51, v196
    v_mfma_f32_16x16x32_f16 v[108:111], a[56:59], v[136:139], v[108:111]
    v_pk_mul_f16 v146, v146, v206
    v_fma_f32 v196, |v100|, v52, v196
    v_mfma_f32_16x16x32_f16 v[108:111], a[60:63], v[140:143], v[108:111]
    v_pk_mul_f16 v147, v147, v207
    v_fma_f32 v196, |v101|, v53, v196
    v_mfma_f32_16x16x32_f16 v[112:115], a[64:67], v[128:131], v[32:35]
    v_pk_mul_f16 v148, v148, v208
    v_fma_f32 v196, |v102|, v54, v196
    v_mfma_f32_16x16x32_f16 v[112:115], a[68:71], v[132:135], v[112:115]
    v_pk_mul_f16 v149, v149, v209
    v_fma_f32 v196, |v103|, v55, v196
    v_mfma_f32_16x16x32_f16 v[112:115], a[72:75], v[136:139], v[112:115]
    v_pk_mul_f16 v150, v150, v210
    v_fma_f32 v196, |v104|, v56, v196
    v_mfma_f32_16x16x32_f16 v[112:115], a[76:79], v[140:143], v[112:115]
    v_pk_mul_f16 v151, v151, v211
    v_fma_f32 v196, |v105|, v57, v196
    v_mfma_f32_16x16x32_f16 v[116:119], a[80:83], v[128:131], v[36:39]
    v_pk_mul_f16 v152, v152, v212
    v_fma_f32 v196, |v106|, v58, v196
    v_mfma_f32_16x16x32_f16 v[116:119], a[84:87], v[132:135], v[116:119]
    v_pk_mul_f16 v153, v153, v213
    v_fma_f32 v196, |v107|, v59, v196
    v_mfma_f32_16x16x32_f16 v[116:119], a[88:91], v[136:139], v[116:119]
    v_pk_mul_f16 v154, v154, v214
    v_fma_f32 v196, |v108|, v60, v196
    v_mfma_f32_16x16x32_f16 v[116:119], a[92:95], v[140:143], v[116:119]
    v_pk_mul_f16 v155, v155, v215
    v_fma_f32 v196, |v109|, v61, v196
    v_mfma_f32_16x16x32_f16 v[120:123], a[96:99], v[128:131], v[40:43]
    v_pk_mul_f16 v156, v156, v216
    v_fma_f32 v196, |v110|, v62, v196
    v_mfma_f32_16x16x32_f16 v[120:123], a[100:103], v[132:135], v[120:123]
    v_pk_mul_f16 v157, v157, v217
    v_fma_f32 v196, |v111|, v63, v196
    v_mfma_f32_16x16x32_f16 v[120:123], a[104:107], v[136:139], v[120:123]
    v_pk_mul_f16 v158, v158, v218
    v_fma_f32 v196, |v112|, v64, v196
    v_mfma_f32_16x16x32_f16 v[120:123], a[108:111], v[140:143], v[120:123]
    v_pk_mul_f16 v159, v159, v219
    v_fma_f32 v196, |v113|, v65, v196
    v_mfma_f32_16x16x32_f16 v[124:127], a[112:115], v[128:131], v[44:47]
    ds_read_b128 v[216:219], v241 offset:4800
    v_fma_f32 v196, |v114|, v66, v196
    v_mfma_f32_16x16x32_f16 v[124:127], a[116:119], v[132:135], v[124:127]
    ds_read_b128 v[212:215], v241 offset:4736
    v_fma_f32 v196, |v115|, v67, v196
    v_mfma_f32_16x16x32_f16 v[124:127], a[120:123], v[136:139], v[124:127]
    ds_read_b128 v[208:211], v241 offset:4672
    v_fma_f32 v196, |v116|, v68, v196
    v_mfma_f32_16x16x32_f16 v[124:127], a[124:127], v[140:143], v[124:127]
    ds_read_b128 v[204:207], v241 offset:4608
    v_fma_f32 v196, |v117|, v69, v196
    v_mfma_f32_16x16x32_f16 v[96:99], a[0:3], v[144:147], v[16:19]
    ds_read_b128 v[140:143], v242 offset:4800
    v_fma_f32 v196, |v118|, v70, v196
    v_mfma_f32_16x16x32_f16 v[96:99], a[4:7], v[148:151], v[96:99]
    ds_read_b128 v[136:139], v242 offset:4736
    v_fma_f32 v196, |v119|, v71, v196
    v_mfma_f32_16x16x32_f16 v[96:99], a[8:11], v[152:155], v[96:99]
    ds_read_b128 v[132:135], v242 offset:4672
    v_fma_f32 v196, |v120|, v72, v196
    v_mfma_f32_16x16x32_f16 v[96:99], a[12:15], v[156:159], v[96:99]
    ds_read_b128 v[128:131], v242 offset:4608
    v_fma_f32 v196, |v121|, v73, v196
    v_mfma_f32_16x16x32_f16 v[100:103], a[16:19], v[144:147], v[20:23]
    v_mov_b32 v193, v192
    v_fma_f32 v196, |v122|, v74, v196
    v_mfma_f32_16x16x32_f16 v[100:103], a[20:23], v[148:151], v[100:103]
    v_permlane16_swap_b32 v192, v193
    v_mfma_f32_16x16x32_f16 v[100:103], a[24:27], v[152:155], v[100:103]
    v_add_f32 v192, v192, v193
    v_fma_f32 v196, |v123|, v75, v196
    v_mfma_f32_16x16x32_f16 v[100:103], a[28:31], v[156:159], v[100:103]
    v_fma_f32 v192, v228, s12, v192
    v_fma_f32 v196, |v124|, v76, v196
    v_mfma_f32_16x16x32_f16 v[104:107], a[32:35], v[144:147], v[24:27]
    v_cndmask_b32 v192, v251, v192, s[38:39]
    v_fma_f32 v196, |v125|, v77, v196
    v_mfma_f32_16x16x32_f16 v[104:107], a[36:39], v[148:151], v[104:107]
    v_max3_f32 v248, v248, v180, v192
    v_fma_f32 v196, |v126|, v78, v196
    v_mfma_f32_16x16x32_f16 v[104:107], a[40:43], v[152:155], v[104:107]
    v_max_f32_dpp v248, v248, v248 row_ror:8 row_mask:0xf bank_mask:0xf
    v_fma_f32 v196, |v127|, v79, v196
    v_mfma_f32_16x16x32_f16 v[104:107], a[44:47], v[156:159], v[104:107]
    v_max_f32_dpp v248, v248, v248 row_ror:4 row_mask:0xf bank_mask:0xf
    v_mul_f32 v198, |v96|, v48
    v_mfma_f32_16x16x32_f16 v[108:111], a[48:51], v[144:147], v[28:31]
    s_waitcnt lgkmcnt(0)
    v_pk_mul_f16 v128, v128, v204
    v_fma_f32 v198, |v97|, v49, v198
    v_mfma_f32_16x16x32_f16 v[108:111], a[52:55], v[148:151], v[108:111]
    v_pk_mul_f16 v129, v129, v205
    v_fma_f32 v198, |v98|, v50, v198
    v_mfma_f32_16x16x32_f16 v[108:111], a[56:59], v[152:155], v[108:111]
    v_pk_mul_f16 v130, v130, v206
    v_fma_f32 v198, |v99|, v51, v198
    v_mfma_f32_16x16x32_f16 v[108:111], a[60:63], v[156:159], v[108:111]
    v_pk_mul_f16 v131, v131, v207
    v_fma_f32 v198, |v100|, v52, v198
    v_mfma_f32_16x16x32_f16 v[112:115], a[64:67], v[144:147], v[32:35]
    v_pk_mul_f16 v132, v132, v208
    v_fma_f32 v198, |v101|, v53, v198
    v_mfma_f32_16x16x32_f16 v[112:115], a[68:71], v[148:151], v[112:115]
    v_pk_mul_f16 v133, v133, v209
    v_fma_f32 v198, |v102|, v54, v198
    v_mfma_f32_16x16x32_f16 v[112:115], a[72:75], v[152:155], v[112:115]
    v_pk_mul_f16 v134, v134, v210
    v_fma_f32 v198, |v103|, v55, v198
    v_mfma_f32_16x16x32_f16 v[112:115], a[76:79], v[156:159], v[112:115]
    v_pk_mul_f16 v135, v135, v211
    v_fma_f32 v198, |v104|, v56, v198
    v_mfma_f32_16x16x32_f16 v[116:119], a[80:83], v[144:147], v[36:39]
    v_pk_mul_f16 v136, v136, v212
    v_fma_f32 v198, |v105|, v57, v198
    v_mfma_f32_16x16x32_f16 v[116:119], a[84:87], v[148:151], v[116:119]
    v_pk_mul_f16 v137, v137, v213
    v_fma_f32 v198, |v106|, v58, v198
    v_mfma_f32_16x16x32_f16 v[116:119], a[88:91], v[152:155], v[116:119]
    v_pk_mul_f16 v138, v138, v214
    v_fma_f32 v198, |v107|, v59, v198
    v_mfma_f32_16x16x32_f16 v[116:119], a[92:95], v[156:159], v[116:119]
    v_pk_mul_f16 v139, v139, v215
    v_fma_f32 v198, |v108|, v60, v198
    v_mfma_f32_16x16x32_f16 v[120:123], a[96:99], v[144:147], v[40:43]
    v_pk_mul_f16 v140, v140, v216
    v_fma_f32 v198, |v109|, v61, v198
    v_mfma_f32_16x16x32_f16 v[120:123], a[100:103], v[148:151], v[120:123]
    v_pk_mul_f16 v141, v141, v217
    v_fma_f32 v198, |v110|, v62, v198
    v_mfma_f32_16x16x32_f16 v[120:123], a[104:107], v[152:155], v[120:123]
    v_pk_mul_f16 v142, v142, v218
    v_fma_f32 v198, |v111|, v63, v198
    v_mfma_f32_16x16x32_f16 v[120:123], a[108:111], v[156:159], v[120:123]
    v_pk_mul_f16 v143, v143, v219
    v_fma_f32 v198, |v112|, v64, v198
    v_mfma_f32_16x16x32_f16 v[124:127], a[112:115], v[144:147], v[44:47]
    v_max_f32_dpp v248, v248, v248 row_ror:2 row_mask:0xf bank_mask:0xf
    v_fma_f32 v198, |v113|, v65, v198
    v_mfma_f32_16x16x32_f16 v[124:127], a[116:119], v[148:151], v[124:127]
    v_max_f32_dpp v248, v248, v248 row_ror:1 row_mask:0xf bank_mask:0xf
    v_fma_f32 v198, |v114|, v66, v198
    v_mfma_f32_16x16x32_f16 v[124:127], a[120:123], v[152:155], v[124:127]
    v_max_f32_dpp v248, v248, v248 row_bcast:15 row_mask:0xa bank_mask:0xf
    v_fma_f32 v198, |v115|, v67, v198
    v_mfma_f32_16x16x32_f16 v[124:127], a[124:127], v[156:159], v[124:127]
    v_max_f32_dpp v248, v248, v248 row_bcast:31 row_mask:0xc bank_mask:0xf
    v_fma_f32 v198, |v116|, v68, v198
    v_mfma_f32_16x16x32_f16 v[96:99], a[0:3], v[128:131], v[16:19]
    v_readlane_b32 s14, v248, 63
    v_fma_f32 v198, |v117|, v69, v198
    v_mfma_f32_16x16x32_f16 v[96:99], a[4:7], v[132:135], v[96:99]
    v_subrev_f32 v184, s14, v184
    v_fma_f32 v198, |v118|, v70, v198
    v_mfma_f32_16x16x32_f16 v[96:99], a[8:11], v[136:139], v[96:99]
    v_subrev_f32 v188, s14, v188
    v_fma_f32 v198, |v119|, v71, v198
    v_mfma_f32_16x16x32_f16 v[96:99], a[12:15], v[140:143], v[96:99]
    v_subrev_f32 v176, s14, v176
    v_fma_f32 v198, |v120|, v72, v198
    v_mfma_f32_16x16x32_f16 v[100:103], a[16:19], v[128:131], v[20:23]
    v_subrev_f32 v180, s14, v180
    v_fma_f32 v198, |v121|, v73, v198
    v_mfma_f32_16x16x32_f16 v[100:103], a[20:23], v[132:135], v[100:103]
    v_subrev_f32 v192, s14, v192
    v_fma_f32 v198, |v122|, v74, v198
    v_mfma_f32_16x16x32_f16 v[100:103], a[24:27], v[136:139], v[100:103]
    v_mul_f32 v184, s55, v184
    v_fma_f32 v198, |v123|, v75, v198
    v_mfma_f32_16x16x32_f16 v[100:103], a[28:31], v[140:143], v[100:103]
    v_mul_f32 v188, s55, v188
    v_fma_f32 v198, |v124|, v76, v198
    v_mfma_f32_16x16x32_f16 v[104:107], a[32:35], v[128:131], v[24:27]
    v_mul_f32 v176, s55, v176
    v_fma_f32 v198, |v125|, v77, v198
    v_mfma_f32_16x16x32_f16 v[104:107], a[36:39], v[132:135], v[104:107]
    v_mul_f32 v180, s55, v180
    v_fma_f32 v198, |v126|, v78, v198
    v_mfma_f32_16x16x32_f16 v[104:107], a[40:43], v[136:139], v[104:107]
    v_mul_f32 v192, s55, v192
    v_fma_f32 v198, |v127|, v79, v198
    v_mfma_f32_16x16x32_f16 v[104:107], a[44:47], v[140:143], v[104:107]
    v_exp_f32 v184, v184
    v_mfma_f32_16x16x32_f16 v[108:111], a[48:51], v[128:131], v[28:31]
    v_exp_f32 v188, v188
    v_mfma_f32_16x16x32_f16 v[108:111], a[52:55], v[132:135], v[108:111]
    v_exp_f32 v176, v176
    v_mfma_f32_16x16x32_f16 v[108:111], a[56:59], v[136:139], v[108:111]
    v_exp_f32 v180, v180
    v_mfma_f32_16x16x32_f16 v[108:111], a[60:63], v[140:143], v[108:111]
    v_exp_f32 v192, v192
    v_mfma_f32_16x16x32_f16 v[112:115], a[64:67], v[128:131], v[32:35]
    v_add_f32 v249, v184, v188
    v_mul_f32 v197, |v96|, v48
    v_mfma_f32_16x16x32_f16 v[112:115], a[68:71], v[132:135], v[112:115]
    v_mul_f32 v250, v184, v225
    v_mul_f32 v200, |v97|, v49
    v_mfma_f32_16x16x32_f16 v[112:115], a[72:75], v[136:139], v[112:115]
    v_fmac_f32 v250, v188, v227
    v_fma_f32 v197, |v98|, v50, v197
    v_mfma_f32_16x16x32_f16 v[112:115], a[76:79], v[140:143], v[112:115]
    v_add_f32 v249, v249, v176
    v_fma_f32 v200, |v99|, v51, v200
    v_mfma_f32_16x16x32_f16 v[116:119], a[80:83], v[128:131], v[36:39]
    v_fmac_f32 v250, v176, v221
    v_fma_f32 v197, |v100|, v52, v197
    v_mfma_f32_16x16x32_f16 v[116:119], a[84:87], v[132:135], v[116:119]
    v_add_f32 v249, v249, v180
    v_fma_f32 v200, |v101|, v53, v200
    v_mfma_f32_16x16x32_f16 v[116:119], a[88:91], v[136:139], v[116:119]
    v_fmac_f32 v250, v180, v223
    v_fma_f32 v197, |v102|, v54, v197
    v_mfma_f32_16x16x32_f16 v[116:119], a[92:95], v[140:143], v[116:119]
    v_add_f32 v249, v249, v192
    v_fma_f32 v200, |v103|, v55, v200
    v_mfma_f32_16x16x32_f16 v[120:123], a[96:99], v[128:131], v[40:43]
    v_fmac_f32 v250, v192, v229
    s_lshl_b32 s6, s4, 1
    v_fma_f32 v197, |v104|, v56, v197
    v_mfma_f32_16x16x32_f16 v[120:123], a[100:103], v[132:135], v[120:123]
    v_mov_b32 v2, s6
    v_fma_f32 v200, |v105|, v57, v200
    v_mfma_f32_16x16x32_f16 v[120:123], a[104:107], v[136:139], v[120:123]
    v_mov_b32 v176, s14
    v_fma_f32 v197, |v106|, v58, v197
    v_mfma_f32_16x16x32_f16 v[120:123], a[108:111], v[140:143], v[120:123]
    v_permlane32_swap_b32 v196, v198
    v_mfma_f32_16x16x32_f16 v[124:127], a[112:115], v[128:131], v[44:47]
    v_add_f32 v196, v196, v198
    v_fma_f32 v200, |v107|, v59, v200
    v_mfma_f32_16x16x32_f16 v[124:127], a[116:119], v[132:135], v[124:127]
    v_fma_f32 v197, |v108|, v60, v197
    v_fma_f32 v200, |v109|, v61, v200
    v_mfma_f32_16x16x32_f16 v[124:127], a[120:123], v[136:139], v[124:127]
    v_fma_f32 v197, |v110|, v62, v197
    v_fma_f32 v200, |v111|, v63, v200
    v_mfma_f32_16x16x32_f16 v[124:127], a[124:127], v[140:143], v[124:127]
    v_fma_f32 v197, |v112|, v64, v197
    v_fma_f32 v200, |v113|, v65, v200
    v_fma_f32 v197, |v114|, v66, v197
    v_fma_f32 v200, |v115|, v67, v200
    v_fma_f32 v197, |v116|, v68, v197
    v_fma_f32 v200, |v117|, v69, v200
    v_fma_f32 v197, |v118|, v70, v197
    v_fma_f32 v200, |v119|, v71, v200
    v_fma_f32 v197, |v120|, v72, v197
    v_fma_f32 v200, |v121|, v73, v200
    v_fma_f32 v197, |v122|, v74, v197
    v_fma_f32 v200, |v123|, v75, v200
    v_fma_f32 v197, |v124|, v76, v197
    v_fma_f32 v200, |v125|, v77, v200
    v_fma_f32 v197, |v126|, v78, v197
    v_fma_f32 v200, |v127|, v79, v200
    v_add_f32 v197, v197, v200
    s_nop 1
    v_permlane32_swap_b32 v197, v199
    v_add_f32 v197, v197, v199
    s_nop 1
    v_permlane16_swap_b32 v196, v197
    v_fma_f32 v196, v230, s12, v196
    v_add_f32 v196, v196, v197
    v_cndmask_b32 v196, v251, v196, s[40:41]
    v_max_f32 v248, s14, v196
    s_nop 1
    v_max_f32_dpp v248, v248, v248 row_ror:8 row_mask:0xf bank_mask:0xf
    s_nop 1
    v_max_f32_dpp v248, v248, v248 row_ror:4 row_mask:0xf bank_mask:0xf
    s_nop 1
    v_max_f32_dpp v248, v248, v248 row_ror:2 row_mask:0xf bank_mask:0xf
    s_nop 1
    v_max_f32_dpp v248, v248, v248 row_ror:1 row_mask:0xf bank_mask:0xf
    s_nop 1
    v_max_f32_dpp v248, v248, v248 row_bcast:15 row_mask:0xa bank_mask:0xf
    s_nop 1
    v_max_f32_dpp v248, v248, v248 row_bcast:31 row_mask:0xc bank_mask:0xf
    s_nop 0
    v_readlane_b32 s13, v248, 63
    s_nop 1
    v_subrev_f32 v196, s13, v196
    v_subrev_f32 v176, s13, v176
    v_mul_f32 v196, s55, v196
    v_mul_f32 v176, s55, v176
    v_exp_f32 v196, v196
    v_exp_f32 v176, v176
    v_mul_f32 v199, v196, v231
    v_fma_f32 v249, v249, v176, v196
    v_fma_f32 v250, v250, v176, v199
    s_nop 0
    v_add_f32_dpp v249, v249, v249 row_ror:8 row_mask:0xf bank_mask:0xf
    v_add_f32_dpp v250, v250, v250 row_ror:8 row_mask:0xf bank_mask:0xf
    s_nop 0
    v_add_f32_dpp v249, v249, v249 row_ror:4 row_mask:0xf bank_mask:0xf
    v_add_f32_dpp v250, v250, v250 row_ror:4 row_mask:0xf bank_mask:0xf
    s_nop 0
    v_add_f32_dpp v249, v249, v249 row_ror:2 row_mask:0xf bank_mask:0xf
    v_add_f32_dpp v250, v250, v250 row_ror:2 row_mask:0xf bank_mask:0xf
    s_nop 0
    v_add_f32_dpp v249, v249, v249 row_ror:1 row_mask:0xf bank_mask:0xf
    v_add_f32_dpp v250, v250, v250 row_ror:1 row_mask:0xf bank_mask:0xf
    s_nop 0
    v_add_f32_dpp v249, v249, v249 row_bcast:15 row_mask:0xa bank_mask:0xf
    v_add_f32_dpp v250, v250, v250 row_bcast:15 row_mask:0xa bank_mask:0xf
    s_nop 0
    v_add_f32_dpp v249, v249, v249 row_bcast:31 row_mask:0xc bank_mask:0xf
    v_add_f32_dpp v250, v250, v250 row_bcast:31 row_mask:0xc bank_mask:0xf
    v_rcp_f32 v249, v249
    v_ldexp_f32 v250, v250, s11
    s_mov_b32 exec_lo, 0
    s_mov_b32 exec_hi, 0x80000000
    v_mul_f32 v250, v250, v249
    v_cvt_pk_bf16_f32 v250, v250, v250
    global_store_short v2, v250, s[32:33]
L_end:
    s_endpgm
L_wfix:
    s_waitcnt lgkmcnt(0)
    s_nop 7
    s_mov_b32 s8, 0x07060302
    v_mov_b32 v121, 0
    v_and_b32 v122, s44, v16
    v_pk_max_u16 v121, v121, v122
    v_and_b32 v122, s44, v17
    v_pk_max_u16 v121, v121, v122
    v_and_b32 v122, s44, v18
    v_pk_max_u16 v121, v121, v122
    v_and_b32 v122, s44, v19
    v_pk_max_u16 v121, v121, v122
    v_and_b32 v122, s44, v20
    v_pk_max_u16 v121, v121, v122
    v_and_b32 v122, s44, v21
    v_pk_max_u16 v121, v121, v122
    v_and_b32 v122, s44, v22
    v_pk_max_u16 v121, v121, v122
    v_and_b32 v122, s44, v23
    v_pk_max_u16 v121, v121, v122
    v_and_b32 v122, s44, v24
    v_pk_max_u16 v121, v121, v122
    v_and_b32 v122, s44, v25
    v_pk_max_u16 v121, v121, v122
    v_and_b32 v122, s44, v26
    v_pk_max_u16 v121, v121, v122
    v_and_b32 v122, s44, v27
    v_pk_max_u16 v121, v121, v122
    v_and_b32 v122, s44, v28
    v_pk_max_u16 v121, v121, v122
    v_and_b32 v122, s44, v29
    v_pk_max_u16 v121, v121, v122
    v_and_b32 v122, s44, v30
    v_pk_max_u16 v121, v121, v122
    v_and_b32 v122, s44, v31
    v_pk_max_u16 v121, v121, v122
    v_and_b32 v122, s44, v32
    v_pk_max_u16 v121, v121, v122
    v_and_b32 v122, s44, v33
    v_pk_max_u16 v121, v121, v122
    v_and_b32 v122, s44, v34
    v_pk_max_u16 v121, v121, v122
    v_and_b32 v122, s44, v35
    v_pk_max_u16 v121, v121, v122
    v_and_b32 v122, s44, v36
    v_pk_max_u16 v121, v121, v122
    v_and_b32 v122, s44, v37
    v_pk_max_u16 v121, v121, v122
    v_and_b32 v122, s44, v38
    v_pk_max_u16 v121, v121, v122
    v_and_b32 v122, s44, v39
    v_pk_max_u16 v121, v121, v122
    v_and_b32 v122, s44, v40
    v_pk_max_u16 v121, v121, v122
    v_and_b32 v122, s44, v41
    v_pk_max_u16 v121, v121, v122
    v_and_b32 v122, s44, v42
    v_pk_max_u16 v121, v121, v122
    v_and_b32 v122, s44, v43
    v_pk_max_u16 v121, v121, v122
    v_and_b32 v122, s44, v44
    v_pk_max_u16 v121, v121, v122
    v_and_b32 v122, s44, v45
    v_pk_max_u16 v121, v121, v122
    v_and_b32 v122, s44, v46
    v_pk_max_u16 v121, v121, v122
    v_and_b32 v122, s44, v47
    v_pk_max_u16 v121, v121, v122
    s_barrier
    ds_write_b32 v3, v121 offset:39424
    s_waitcnt lgkmcnt(0)
    s_barrier
    ds_read_b128 v[112:115], v127 offset:39424
    s_waitcnt lgkmcnt(0)
    v_pk_max_u16 v121, v121, v112
    v_pk_max_u16 v121, v121, v113
    v_pk_max_u16 v121, v121, v114
    v_pk_max_u16 v121, v121, v115
    s_barrier
    v_pk_max_u16 v121, v121, v121 op_sel:[0,1] op_sel_hi:[1,0]
    s_nop 1
    v_max_u32_dpp v121, v121, v121 row_ror:8 row_mask:0xf bank_mask:0xf
    s_nop 1
    v_max_u32_dpp v121, v121, v121 row_ror:4 row_mask:0xf bank_mask:0xf
    s_nop 1
    v_max_u32_dpp v121, v121, v121 row_ror:2 row_mask:0xf bank_mask:0xf
    s_nop 1
    v_max_u32_dpp v121, v121, v121 row_ror:1 row_mask:0xf bank_mask:0xf
    s_nop 1
    v_max_u32_dpp v121, v121, v121 row_bcast:15 row_mask:0xa bank_mask:0xf
    s_nop 1
    v_max_u32_dpp v121, v121, v121 row_bcast:31 row_mask:0xc bank_mask:0xf
    s_nop 0
    v_readlane_b32 s6, v121, 63
    s_nop 0
    s_bfe_u32 s6, s6, 0x80007
    s_max_u32 s6, s6, 87
    s_sub_u32 s47, 127, s6
    s_sub_u32 s7, 0, s47
    v_lshlrev_b32 v121, 16, v16
    v_and_b32 v122, s46, v16
    v_ldexp_f32 v121, v121, s47
    v_ldexp_f32 v122, v122, s47
    v_perm_b32 v16, v122, v121, s8
    v_lshlrev_b32 v121, 16, v17
    v_and_b32 v122, s46, v17
    v_ldexp_f32 v121, v121, s47
    v_ldexp_f32 v122, v122, s47
    v_perm_b32 v17, v122, v121, s8
    v_lshlrev_b32 v121, 16, v18
    v_and_b32 v122, s46, v18
    v_ldexp_f32 v121, v121, s47
    v_ldexp_f32 v122, v122, s47
    v_perm_b32 v18, v122, v121, s8
    v_lshlrev_b32 v121, 16, v19
    v_and_b32 v122, s46, v19
    v_ldexp_f32 v121, v121, s47
    v_ldexp_f32 v122, v122, s47
    v_perm_b32 v19, v122, v121, s8
    v_lshlrev_b32 v121, 16, v20
    v_and_b32 v122, s46, v20
    v_ldexp_f32 v121, v121, s47
    v_ldexp_f32 v122, v122, s47
    v_perm_b32 v20, v122, v121, s8
    v_lshlrev_b32 v121, 16, v21
    v_and_b32 v122, s46, v21
    v_ldexp_f32 v121, v121, s47
    v_ldexp_f32 v122, v122, s47
    v_perm_b32 v21, v122, v121, s8
    v_lshlrev_b32 v121, 16, v22
    v_and_b32 v122, s46, v22
    v_ldexp_f32 v121, v121, s47
    v_ldexp_f32 v122, v122, s47
    v_perm_b32 v22, v122, v121, s8
    v_lshlrev_b32 v121, 16, v23
    v_and_b32 v122, s46, v23
    v_ldexp_f32 v121, v121, s47
    v_ldexp_f32 v122, v122, s47
    v_perm_b32 v23, v122, v121, s8
    v_lshlrev_b32 v121, 16, v24
    v_and_b32 v122, s46, v24
    v_ldexp_f32 v121, v121, s47
    v_ldexp_f32 v122, v122, s47
    v_perm_b32 v24, v122, v121, s8
    v_lshlrev_b32 v121, 16, v25
    v_and_b32 v122, s46, v25
    v_ldexp_f32 v121, v121, s47
    v_ldexp_f32 v122, v122, s47
    v_perm_b32 v25, v122, v121, s8
    v_lshlrev_b32 v121, 16, v26
    v_and_b32 v122, s46, v26
    v_ldexp_f32 v121, v121, s47
    v_ldexp_f32 v122, v122, s47
    v_perm_b32 v26, v122, v121, s8
    v_lshlrev_b32 v121, 16, v27
    v_and_b32 v122, s46, v27
    v_ldexp_f32 v121, v121, s47
    v_ldexp_f32 v122, v122, s47
    v_perm_b32 v27, v122, v121, s8
    v_lshlrev_b32 v121, 16, v28
    v_and_b32 v122, s46, v28
    v_ldexp_f32 v121, v121, s47
    v_ldexp_f32 v122, v122, s47
    v_perm_b32 v28, v122, v121, s8
    v_lshlrev_b32 v121, 16, v29
    v_and_b32 v122, s46, v29
    v_ldexp_f32 v121, v121, s47
    v_ldexp_f32 v122, v122, s47
    v_perm_b32 v29, v122, v121, s8
    v_lshlrev_b32 v121, 16, v30
    v_and_b32 v122, s46, v30
    v_ldexp_f32 v121, v121, s47
    v_ldexp_f32 v122, v122, s47
    v_perm_b32 v30, v122, v121, s8
    v_lshlrev_b32 v121, 16, v31
    v_and_b32 v122, s46, v31
    v_ldexp_f32 v121, v121, s47
    v_ldexp_f32 v122, v122, s47
    v_perm_b32 v31, v122, v121, s8
    v_lshlrev_b32 v121, 16, v32
    v_and_b32 v122, s46, v32
    v_ldexp_f32 v121, v121, s47
    v_ldexp_f32 v122, v122, s47
    v_perm_b32 v32, v122, v121, s8
    v_lshlrev_b32 v121, 16, v33
    v_and_b32 v122, s46, v33
    v_ldexp_f32 v121, v121, s47
    v_ldexp_f32 v122, v122, s47
    v_perm_b32 v33, v122, v121, s8
    v_lshlrev_b32 v121, 16, v34
    v_and_b32 v122, s46, v34
    v_ldexp_f32 v121, v121, s47
    v_ldexp_f32 v122, v122, s47
    v_perm_b32 v34, v122, v121, s8
    v_lshlrev_b32 v121, 16, v35
    v_and_b32 v122, s46, v35
    v_ldexp_f32 v121, v121, s47
    v_ldexp_f32 v122, v122, s47
    v_perm_b32 v35, v122, v121, s8
    v_lshlrev_b32 v121, 16, v36
    v_and_b32 v122, s46, v36
    v_ldexp_f32 v121, v121, s47
    v_ldexp_f32 v122, v122, s47
    v_perm_b32 v36, v122, v121, s8
    v_lshlrev_b32 v121, 16, v37
    v_and_b32 v122, s46, v37
    v_ldexp_f32 v121, v121, s47
    v_ldexp_f32 v122, v122, s47
    v_perm_b32 v37, v122, v121, s8
    v_lshlrev_b32 v121, 16, v38
    v_and_b32 v122, s46, v38
    v_ldexp_f32 v121, v121, s47
    v_ldexp_f32 v122, v122, s47
    v_perm_b32 v38, v122, v121, s8
    v_lshlrev_b32 v121, 16, v39
    v_and_b32 v122, s46, v39
    v_ldexp_f32 v121, v121, s47
    v_ldexp_f32 v122, v122, s47
    v_perm_b32 v39, v122, v121, s8
    v_lshlrev_b32 v121, 16, v40
    v_and_b32 v122, s46, v40
    v_ldexp_f32 v121, v121, s47
    v_ldexp_f32 v122, v122, s47
    v_perm_b32 v40, v122, v121, s8
    v_lshlrev_b32 v121, 16, v41
    v_and_b32 v122, s46, v41
    v_ldexp_f32 v121, v121, s47
    v_ldexp_f32 v122, v122, s47
    v_perm_b32 v41, v122, v121, s8
    v_lshlrev_b32 v121, 16, v42
    v_and_b32 v122, s46, v42
    v_ldexp_f32 v121, v121, s47
    v_ldexp_f32 v122, v122, s47
    v_perm_b32 v42, v122, v121, s8
    v_lshlrev_b32 v121, 16, v43
    v_and_b32 v122, s46, v43
    v_ldexp_f32 v121, v121, s47
    v_ldexp_f32 v122, v122, s47
    v_perm_b32 v43, v122, v121, s8
    v_lshlrev_b32 v121, 16, v44
    v_and_b32 v122, s46, v44
    v_ldexp_f32 v121, v121, s47
    v_ldexp_f32 v122, v122, s47
    v_perm_b32 v44, v122, v121, s8
    v_lshlrev_b32 v121, 16, v45
    v_and_b32 v122, s46, v45
    v_ldexp_f32 v121, v121, s47
    v_ldexp_f32 v122, v122, s47
    v_perm_b32 v45, v122, v121, s8
    v_lshlrev_b32 v121, 16, v46
    v_and_b32 v122, s46, v46
    v_ldexp_f32 v121, v121, s47
    v_ldexp_f32 v122, v122, s47
    v_perm_b32 v46, v122, v121, s8
    v_lshlrev_b32 v121, 16, v47
    v_and_b32 v122, s46, v47
    v_ldexp_f32 v121, v121, s47
    v_ldexp_f32 v122, v122, s47
    v_perm_b32 v47, v122, v121, s8
    v_lshlrev_b32 v121, 16, v220
    v_and_b32 v122, s46, v220
    v_ldexp_f32 v121, v121, s7
    v_ldexp_f32 v122, v122, s7
    v_perm_b32 v220, v122, v121, s8
    v_lshlrev_b32 v121, 16, v221
    v_and_b32 v122, s46, v221
    v_ldexp_f32 v121, v121, s7
    v_ldexp_f32 v122, v122, s7
    v_perm_b32 v221, v122, v121, s8
    v_lshlrev_b32 v121, 16, v222
    v_and_b32 v122, s46, v222
    v_ldexp_f32 v121, v121, s7
    v_ldexp_f32 v122, v122, s7
    v_perm_b32 v222, v122, v121, s8
    v_lshlrev_b32 v121, 16, v223
    v_and_b32 v122, s46, v223
    v_ldexp_f32 v121, v121, s7
    v_ldexp_f32 v122, v122, s7
    v_perm_b32 v223, v122, v121, s8
    s_add_u32 s6, s47, 10
    v_cmp_lt_u32 vcc, 31, v1
    v_mov_b32 v121, s6
    v_mov_b32 v122, s7
    v_cndmask_b32 v9, v121, v122, vcc
    s_mov_b32 s52, 0
    s_mov_b32 s53, 0
    s_nop 7
    s_branch L_wconv
L_efix:
    s_waitcnt vmcnt(0) lgkmcnt(0)
    s_nop 15
    s_mul_i32 s6, s4, 104
    v_mul_u32_u24 v121, 28, v4
    v_min_u32 v122, 76, v121
    v_add_u32 v121, s6, v121
    v_add_u32 v122, s6, v122
    global_load_dwordx4 v[204:207], v121, s[16:17]
    global_load_dwordx3 v[208:210], v122, s[16:17] offset:16
    s_waitcnt vmcnt(1)
    v_lshl_add_u32 v204, v204, 8, v14
    v_lshl_add_u32 v205, v205, 8, v14
    v_lshl_add_u32 v206, v206, 8, v14
    v_lshl_add_u32 v207, v207, 8, v14
    s_waitcnt vmcnt(0)
    v_lshl_add_u32 v208, v208, 8, v14
    v_lshl_add_u32 v209, v209, 8, v14
    v_lshl_add_u32 v210, v210, 8, v14
    buffer_load_dwordx4 v[144:147], v204, s[56:59], 0 offen
    buffer_load_dwordx4 v[148:151], v205, s[56:59], 0 offen
    buffer_load_dwordx4 v[152:155], v206, s[56:59], 0 offen
    buffer_load_dwordx4 v[156:159], v207, s[56:59], 0 offen
    buffer_load_dwordx4 v[160:163], v208, s[56:59], 0 offen
    buffer_load_dwordx4 v[164:167], v209, s[56:59], 0 offen
    buffer_load_dwordx4 v[168:171], v210, s[56:59], 0 offen
    s_waitcnt vmcnt(0)
    s_mov_b32 s8, 0x07060302
    v_mov_b32 v121, 0
    v_and_b32 v122, s44, v144
    v_pk_max_u16 v121, v121, v122
    v_and_b32 v122, s44, v145
    v_pk_max_u16 v121, v121, v122
    v_and_b32 v122, s44, v146
    v_pk_max_u16 v121, v121, v122
    v_and_b32 v122, s44, v147
    v_pk_max_u16 v121, v121, v122
    v_and_b32 v122, s44, v148
    v_pk_max_u16 v121, v121, v122
    v_and_b32 v122, s44, v149
    v_pk_max_u16 v121, v121, v122
    v_and_b32 v122, s44, v150
    v_pk_max_u16 v121, v121, v122
    v_and_b32 v122, s44, v151
    v_pk_max_u16 v121, v121, v122
    v_and_b32 v122, s44, v152
    v_pk_max_u16 v121, v121, v122
    v_and_b32 v122, s44, v153
    v_pk_max_u16 v121, v121, v122
    v_and_b32 v122, s44, v154
    v_pk_max_u16 v121, v121, v122
    v_and_b32 v122, s44, v155
    v_pk_max_u16 v121, v121, v122
    v_and_b32 v122, s44, v156
    v_pk_max_u16 v121, v121, v122
    v_and_b32 v122, s44, v157
    v_pk_max_u16 v121, v121, v122
    v_and_b32 v122, s44, v158
    v_pk_max_u16 v121, v121, v122
    v_and_b32 v122, s44, v159
    v_pk_max_u16 v121, v121, v122
    v_and_b32 v122, s44, v160
    v_pk_max_u16 v121, v121, v122
    v_and_b32 v122, s44, v161
    v_pk_max_u16 v121, v121, v122
    v_and_b32 v122, s44, v162
    v_pk_max_u16 v121, v121, v122
    v_and_b32 v122, s44, v163
    v_pk_max_u16 v121, v121, v122
    v_and_b32 v122, s44, v164
    v_pk_max_u16 v121, v121, v122
    v_and_b32 v122, s44, v165
    v_pk_max_u16 v121, v121, v122
    v_and_b32 v122, s44, v166
    v_pk_max_u16 v121, v121, v122
    v_and_b32 v122, s44, v167
    v_pk_max_u16 v121, v121, v122
    v_and_b32 v122, s44, v168
    v_pk_max_u16 v121, v121, v122
    v_and_b32 v122, s44, v169
    v_pk_max_u16 v121, v121, v122
    v_and_b32 v122, s44, v170
    v_pk_max_u16 v121, v121, v122
    v_and_b32 v122, s44, v171
    v_pk_max_u16 v121, v121, v122
    v_pk_max_u16 v121, v121, v121 op_sel:[0,1] op_sel_hi:[1,0]
    s_nop 1
    v_max_u32_dpp v121, v121, v121 row_ror:8 row_mask:0xf bank_mask:0xf
    s_nop 1
    v_max_u32_dpp v121, v121, v121 row_ror:4 row_mask:0xf bank_mask:0xf
    s_nop 1
    v_max_u32_dpp v121, v121, v121 row_ror:2 row_mask:0xf bank_mask:0xf
    s_nop 1
    v_max_u32_dpp v121, v121, v121 row_ror:1 row_mask:0xf bank_mask:0xf
    s_nop 1
    v_max_u32_dpp v121, v121, v121 row_bcast:15 row_mask:0xa bank_mask:0xf
    s_nop 1
    v_max_u32_dpp v121, v121, v121 row_bcast:31 row_mask:0xc bank_mask:0xf
    s_nop 0
    v_readlane_b32 s6, v121, 63
    s_nop 0
    s_bfe_u32 s6, s6, 0x80007
    s_max_u32 s6, s6, 104
    s_min_u32 s6, s6, 190
    s_sub_u32 s6, 129, s6
    v_lshlrev_b32 v121, 16, v144
    v_and_b32 v122, s46, v144
    v_ldexp_f32 v121, v121, s6
    v_ldexp_f32 v122, v122, s6
    v_perm_b32 v144, v122, v121, s8
    v_lshlrev_b32 v121, 16, v145
    v_and_b32 v122, s46, v145
    v_ldexp_f32 v121, v121, s6
    v_ldexp_f32 v122, v122, s6
    v_perm_b32 v145, v122, v121, s8
    v_lshlrev_b32 v121, 16, v146
    v_and_b32 v122, s46, v146
    v_ldexp_f32 v121, v121, s6
    v_ldexp_f32 v122, v122, s6
    v_perm_b32 v146, v122, v121, s8
    v_lshlrev_b32 v121, 16, v147
    v_and_b32 v122, s46, v147
    v_ldexp_f32 v121, v121, s6
    v_ldexp_f32 v122, v122, s6
    v_perm_b32 v147, v122, v121, s8
    v_lshlrev_b32 v121, 16, v148
    v_and_b32 v122, s46, v148
    v_ldexp_f32 v121, v121, s6
    v_ldexp_f32 v122, v122, s6
    v_perm_b32 v148, v122, v121, s8
    v_lshlrev_b32 v121, 16, v149
    v_and_b32 v122, s46, v149
    v_ldexp_f32 v121, v121, s6
    v_ldexp_f32 v122, v122, s6
    v_perm_b32 v149, v122, v121, s8
    v_lshlrev_b32 v121, 16, v150
    v_and_b32 v122, s46, v150
    v_ldexp_f32 v121, v121, s6
    v_ldexp_f32 v122, v122, s6
    v_perm_b32 v150, v122, v121, s8
    v_lshlrev_b32 v121, 16, v151
    v_and_b32 v122, s46, v151
    v_ldexp_f32 v121, v121, s6
    v_ldexp_f32 v122, v122, s6
    v_perm_b32 v151, v122, v121, s8
    v_lshlrev_b32 v121, 16, v152
    v_and_b32 v122, s46, v152
    v_ldexp_f32 v121, v121, s6
    v_ldexp_f32 v122, v122, s6
    v_perm_b32 v152, v122, v121, s8
    v_lshlrev_b32 v121, 16, v153
    v_and_b32 v122, s46, v153
    v_ldexp_f32 v121, v121, s6
    v_ldexp_f32 v122, v122, s6
    v_perm_b32 v153, v122, v121, s8
    v_lshlrev_b32 v121, 16, v154
    v_and_b32 v122, s46, v154
    v_ldexp_f32 v121, v121, s6
    v_ldexp_f32 v122, v122, s6
    v_perm_b32 v154, v122, v121, s8
    v_lshlrev_b32 v121, 16, v155
    v_and_b32 v122, s46, v155
    v_ldexp_f32 v121, v121, s6
    v_ldexp_f32 v122, v122, s6
    v_perm_b32 v155, v122, v121, s8
    v_lshlrev_b32 v121, 16, v156
    v_and_b32 v122, s46, v156
    v_ldexp_f32 v121, v121, s6
    v_ldexp_f32 v122, v122, s6
    v_perm_b32 v156, v122, v121, s8
    v_lshlrev_b32 v121, 16, v157
    v_and_b32 v122, s46, v157
    v_ldexp_f32 v121, v121, s6
    v_ldexp_f32 v122, v122, s6
    v_perm_b32 v157, v122, v121, s8
    v_lshlrev_b32 v121, 16, v158
    v_and_b32 v122, s46, v158
    v_ldexp_f32 v121, v121, s6
    v_ldexp_f32 v122, v122, s6
    v_perm_b32 v158, v122, v121, s8
    v_lshlrev_b32 v121, 16, v159
    v_and_b32 v122, s46, v159
    v_ldexp_f32 v121, v121, s6
    v_ldexp_f32 v122, v122, s6
    v_perm_b32 v159, v122, v121, s8
    v_lshlrev_b32 v121, 16, v160
    v_and_b32 v122, s46, v160
    v_ldexp_f32 v121, v121, s6
    v_ldexp_f32 v122, v122, s6
    v_perm_b32 v160, v122, v121, s8
    v_lshlrev_b32 v121, 16, v161
    v_and_b32 v122, s46, v161
    v_ldexp_f32 v121, v121, s6
    v_ldexp_f32 v122, v122, s6
    v_perm_b32 v161, v122, v121, s8
    v_lshlrev_b32 v121, 16, v162
    v_and_b32 v122, s46, v162
    v_ldexp_f32 v121, v121, s6
    v_ldexp_f32 v122, v122, s6
    v_perm_b32 v162, v122, v121, s8
    v_lshlrev_b32 v121, 16, v163
    v_and_b32 v122, s46, v163
    v_ldexp_f32 v121, v121, s6
    v_ldexp_f32 v122, v122, s6
    v_perm_b32 v163, v122, v121, s8
    v_lshlrev_b32 v121, 16, v164
    v_and_b32 v122, s46, v164
    v_ldexp_f32 v121, v121, s6
    v_ldexp_f32 v122, v122, s6
    v_perm_b32 v164, v122, v121, s8
    v_lshlrev_b32 v121, 16, v165
    v_and_b32 v122, s46, v165
    v_ldexp_f32 v121, v121, s6
    v_ldexp_f32 v122, v122, s6
    v_perm_b32 v165, v122, v121, s8
    v_lshlrev_b32 v121, 16, v166
    v_and_b32 v122, s46, v166
    v_ldexp_f32 v121, v121, s6
    v_ldexp_f32 v122, v122, s6
    v_perm_b32 v166, v122, v121, s8
    v_lshlrev_b32 v121, 16, v167
    v_and_b32 v122, s46, v167
    v_ldexp_f32 v121, v121, s6
    v_ldexp_f32 v122, v122, s6
    v_perm_b32 v167, v122, v121, s8
    v_lshlrev_b32 v121, 16, v168
    v_and_b32 v122, s46, v168
    v_ldexp_f32 v121, v121, s6
    v_ldexp_f32 v122, v122, s6
    v_perm_b32 v168, v122, v121, s8
    v_lshlrev_b32 v121, 16, v169
    v_and_b32 v122, s46, v169
    v_ldexp_f32 v121, v121, s6
    v_ldexp_f32 v122, v122, s6
    v_perm_b32 v169, v122, v121, s8
    v_lshlrev_b32 v121, 16, v170
    v_and_b32 v122, s46, v170
    v_ldexp_f32 v121, v121, s6
    v_ldexp_f32 v122, v122, s6
    v_perm_b32 v170, v122, v121, s8
    v_lshlrev_b32 v121, 16, v171
    v_and_b32 v122, s46, v171
    v_ldexp_f32 v121, v121, s6
    v_ldexp_f32 v122, v122, s6
    v_perm_b32 v171, v122, v121, s8
    s_lshl_b32 s6, s6, 1
    v_ldexp_f32 v16, v16, s6
    v_ldexp_f32 v17, v17, s6
    v_ldexp_f32 v18, v18, s6
    v_ldexp_f32 v19, v19, s6
    v_ldexp_f32 v20, v20, s6
    v_ldexp_f32 v21, v21, s6
    v_ldexp_f32 v22, v22, s6
    v_ldexp_f32 v23, v23, s6
    v_ldexp_f32 v24, v24, s6
    v_ldexp_f32 v25, v25, s6
    v_ldexp_f32 v26, v26, s6
    v_ldexp_f32 v27, v27, s6
    v_ldexp_f32 v28, v28, s6
    v_ldexp_f32 v29, v29, s6
    v_ldexp_f32 v30, v30, s6
    v_ldexp_f32 v31, v31, s6
    v_ldexp_f32 v32, v32, s6
    v_ldexp_f32 v33, v33, s6
    v_ldexp_f32 v34, v34, s6
    v_ldexp_f32 v35, v35, s6
    v_ldexp_f32 v36, v36, s6
    v_ldexp_f32 v37, v37, s6
    v_ldexp_f32 v38, v38, s6
    v_ldexp_f32 v39, v39, s6
    v_ldexp_f32 v40, v40, s6
    v_ldexp_f32 v41, v41, s6
    v_ldexp_f32 v42, v42, s6
    v_ldexp_f32 v43, v43, s6
    v_ldexp_f32 v44, v44, s6
    v_ldexp_f32 v45, v45, s6
    v_ldexp_f32 v46, v46, s6
    v_ldexp_f32 v47, v47, s6
    s_add_u32 s54, s54, s6
    s_lshl_b32 s6, s6, 23
    s_sub_u32 s55, s55, s6
    s_mov_b32 s50, 0x7fc00000
    s_mov_b32 s51, 0
    s_nop 7
    s_branch L_econv
s_endpgm
.p2align 7
.type L_tab,@object
L_tab:
.long 0x98000000, 0xa0000, 0x0, 0x0
.long 0x98020010, 0xa0004, 0x8, 0x1200010
.long 0x98040020, 0xa0008, 0x10, 0x2400020
.long 0x98060030, 0xa000c, 0x18, 0x3600030
.long 0x98080040, 0xa0010, 0x120, 0x4800040
.long 0x980a0050, 0xa0014, 0x128, 0x5a00050
.long 0x980c0060, 0xa0018, 0x130, 0x6c00060
.long 0x980e0070, 0xa001c, 0x138, 0x7e00070
.long 0x98100080, 0xa0020, 0x240, 0x9000080
.long 0x98120090, 0xa0024, 0x248, 0xa200090
.long 0x981400a0, 0xa0028, 0x250, 0xb4000a0
.long 0x981600b0, 0xa002c, 0x258, 0xc6000b0
.long 0x981800c0, 0xa0030, 0x360, 0xd8000c0
.long 0x981a00d0, 0xa0034, 0x368, 0xea000d0
.long 0x981c00e0, 0xa0038, 0x370, 0xfc000e0
.long 0x981e00f0, 0xa003c, 0x378, 0x10e000f0
.long 0x98200120, 0xa0040, 0x100980, 0x100120
.long 0x98220130, 0xa0044, 0x100988, 0x1300130
.long 0x98240140, 0xa0048, 0x100990, 0x2500140
.long 0x98260150, 0xa004c, 0x100998, 0x3700150
.long 0x98280160, 0xa0050, 0x100aa0, 0x4900160
.long 0x982a0170, 0xa0054, 0x100aa8, 0x5b00170
.long 0x982c0180, 0xa0058, 0x100ab0, 0x6d00180
.long 0x982e0190, 0xa005c, 0x100ab8, 0x7f00190
.long 0x983001a0, 0xa0060, 0x100bc0, 0x91001a0
.long 0x983201b0, 0xa0064, 0x100bc8, 0xa3001b0
.long 0x983401c0, 0xa0068, 0x100bd0, 0xb5001c0
.long 0x983601d0, 0xa006c, 0x100bd8, 0xc7001d0
.long 0x983801e0, 0xa0070, 0x100ce0, 0xd9001e0
.long 0x983a01f0, 0xa0074, 0x100ce8, 0xeb001f0
.long 0x983c0200, 0xa0078, 0x100cf0, 0xfd00200
.long 0x983e0210, 0xa007c, 0x100cf8, 0x10f00210
.long 0x98400240, 0x200, 0x201280, 0x200240
.long 0x98420250, 0x204, 0x201288, 0x1400250
.long 0x98440260, 0x208, 0x201290, 0x2600260
.long 0x98460270, 0x20c, 0x201298, 0x3800270
.long 0x98480280, 0x210, 0x2013a0, 0x4a00280
.long 0x984a0290, 0x214, 0x2013a8, 0x5c00290
.long 0x984c02a0, 0x218, 0x2013b0, 0x6e002a0
.long 0x984e02b0, 0x21c, 0x2013b8, 0x80002b0
.long 0x985002c0, 0x220, 0x2014c0, 0x92002c0
.long 0x985202d0, 0x224, 0x2014c8, 0xa4002d0
.long 0x985402e0, 0x228, 0x2014d0, 0xb6002e0
.long 0x985602f0, 0x22c, 0x2014d8, 0xc8002f0
.long 0x98580300, 0x230, 0x2015e0, 0xda00300
.long 0x985a0310, 0x234, 0x2015e8, 0xec00310
.long 0x985c0320, 0x238, 0x2015f0, 0xfe00320
.long 0x985e0330, 0x23c, 0x2015f8, 0x11000330
.long 0x98600360, 0x240, 0x301c00, 0x300360
.long 0x98620370, 0x244, 0x301c08, 0x1500370
.long 0x98640380, 0x248, 0x301c10, 0x2700380
.long 0x98660390, 0x24c, 0x301c18, 0x3900390
.long 0x986803a0, 0x250, 0x301d20, 0x4b003a0
.long 0x986a03b0, 0x254, 0x301d28, 0x5d003b0
.long 0x986c03c0, 0x258, 0x301d30, 0x6f003c0
.long 0x986e03d0, 0x25c, 0x301d38, 0x81003d0
.long 0x987003e0, 0x260, 0x301e40, 0x93003e0
.long 0x987203f0, 0x264, 0x301e48, 0xa5003f0
.long 0x98740400, 0x268, 0x301e50, 0xb700400
.long 0x98760410, 0x26c, 0x301e58, 0xc900410
.long 0x98780420, 0x270, 0x301f60, 0xdb00420
.long 0x987a0430, 0x274, 0x301f68, 0xed00430
.long 0x987c0440, 0x278, 0x301f70, 0xff00440
.long 0x987e0450, 0x27c, 0x301f78, 0x11100450
.long 0x120, 0x98000000, 0x0, 0x0
.long 0x240, 0x98400120, 0x0, 0x0
.long 0x360, 0x98800240, 0x0, 0x0
.long 0x480, 0x98c00360, 0x0, 0x0
.long 0x5a0, 0x99000480, 0x0, 0x0
.long 0x6c0, 0x994005a0, 0x0, 0x0
.long 0x7e0, 0x998006c0, 0x0, 0x0
.long 0x900, 0x99c007e0, 0x0, 0x0
.long 0xa20, 0x98100900, 0x0, 0x0
.long 0xb40, 0x98500a20, 0x0, 0x0
.long 0xc60, 0x98900a20, 0x0, 0x0
.long 0xd80, 0x98d00a20, 0x0, 0x0
.long 0xea0, 0x99100a20, 0x0, 0x0
.long 0xfc0, 0x99500a20, 0x0, 0x0
.long 0x10e0, 0x99900a20, 0x0, 0x0
.long 0x0, 0x99d00a20, 0x0, 0x0
.long 0x100130, 0x98080010, 0x0, 0x0
.long 0x100250, 0x98480130, 0x0, 0x0
.long 0x100370, 0x98880250, 0x0, 0x0
.long 0x100490, 0x98c80370, 0x0, 0x0
.long 0x1005b0, 0x99080490, 0x0, 0x0
.long 0x1006d0, 0x994805b0, 0x0, 0x0
.long 0x1007f0, 0x998806d0, 0x0, 0x0
.long 0x100910, 0x99c807f0, 0x0, 0x0
.long 0x100a30, 0x98180910, 0x0, 0x0
.long 0x100b50, 0x98580a30, 0x0, 0x0
.long 0x100c70, 0x98980a30, 0x0, 0x0
.long 0x100d90, 0x98d80a30, 0x0, 0x0
.long 0x100eb0, 0x99180a30, 0x0, 0x0
.long 0x100fd0, 0x99580a30, 0x0, 0x0
.long 0x1010f0, 0x99980a30, 0x0, 0x0
.long 0x100010, 0x99d80a30, 0x0, 0x0
.long 0x200140, 0x98040020, 0x0, 0x0
.long 0x200260, 0x98440140, 0x0, 0x0
.long 0x200380, 0x98840260, 0x0, 0x0
.long 0x2004a0, 0x98c40380, 0x0, 0x0
.long 0x2005c0, 0x990404a0, 0x0, 0x0
.long 0x2006e0, 0x994405c0, 0x0, 0x0
.long 0x200800, 0x998406e0, 0x0, 0x0
.long 0x200920, 0x99c40800, 0x0, 0x0
.long 0x200a40, 0x98140920, 0x0, 0x0
.long 0x200b60, 0x98540a40, 0x0, 0x0
.long 0x200c80, 0x98940a40, 0x0, 0x0
.long 0x200da0, 0x98d40a40, 0x0, 0x0
.long 0x200ec0, 0x99140a40, 0x0, 0x0
.long 0x200fe0, 0x99540a40, 0x0, 0x0
.long 0x201100, 0x99940a40, 0x0, 0x0
.long 0x200020, 0x99d40a40, 0x0, 0x0
.long 0x300150, 0x980c0030, 0x0, 0x0
.long 0x300270, 0x984c0150, 0x0, 0x0
.long 0x300390, 0x988c0270, 0x0, 0x0
.long 0x3004b0, 0x98cc0390, 0x0, 0x0
.long 0x3005d0, 0x990c04b0, 0x0, 0x0
.long 0x3006f0, 0x994c05d0, 0x0, 0x0
.long 0x300810, 0x998c06f0, 0x0, 0x0
.long 0x300930, 0x99cc0810, 0x0, 0x0
.long 0x300a50, 0x981c0930, 0x0, 0x0
.long 0x300b70, 0x985c0a50, 0x0, 0x0
.long 0x300c90, 0x989c0a50, 0x0, 0x0
.long 0x300db0, 0x98dc0a50, 0x0, 0x0
.long 0x300ed0, 0x991c0a50, 0x0, 0x0
.long 0x300ff0, 0x995c0a50, 0x0, 0x0
.long 0x301110, 0x999c0a50, 0x0, 0x0
.long 0x300030, 0x99dc0a50, 0x0, 0x0
.long 0x2f40, 0x1203180, 0x6c026d0, 0x9002910
.long 0x1202f44, 0x2403184, 0x7e02764, 0xa2029a4
.long 0x2402f48, 0x3603188, 0x90027f8, 0x2a38
.long 0x3602f4c, 0x480318c, 0xa20288c, 0x1202acc
.long 0x4802f50, 0x5a03190, 0x2920, 0x3602b60
.long 0x5a02f54, 0x6c03194, 0x12029b4, 0x4802bf4
.long 0x6c02f58, 0x7e03198, 0x2402a48, 0x5a02c88
.long 0x7e02f5c, 0x900319c, 0x3602adc, 0x6c02d1c
.long 0x9002f60, 0xa2031a0, 0x4802b70, 0x7e02db0
.long 0xa202f64, 0x31a4, 0x5a02c04, 0x9002e44
.long 0x2f68, 0x24031a8, 0x6c02c98, 0xa202ed8
.long 0x1202f6c, 0x36031ac, 0x7e02d2c, 0x266c
.long 0x2402f70, 0x48031b0, 0x9002dc0, 0x1202700
.long 0x3602f74, 0x5a031b4, 0xa202e54, 0x2402794
.long 0x4802f78, 0x6c031b8, 0x2ee8, 0x4802828
.long 0x5a02f7c, 0x7e031bc, 0x120267c, 0x5a028bc
.long 0x102fd0, 0x1303210, 0x6d02760, 0x91029a0
.long 0x1302fd4, 0x2503214, 0x7f027f4, 0xa302a34
.long 0x2502fd8, 0x3703218, 0x9102888, 0x102ac8
.long 0x3702fdc, 0x490321c, 0xa30291c, 0x1302b5c
.long 0x4902fe0, 0x5b03220, 0x1029b0, 0x3702bf0
.long 0x5b02fe4, 0x6d03224, 0x1302a44, 0x4902c84
.long 0x6d02fe8, 0x7f03228, 0x2502ad8, 0x5b02d18
.long 0x7f02fec, 0x910322c, 0x3702b6c, 0x6d02dac
.long 0x9102ff0, 0xa303230, 0x4902c00, 0x7f02e40
.long 0xa302ff4, 0x103234, 0x5b02c94, 0x9102ed4
.long 0x102ff8, 0x2503238, 0x6d02d28, 0xa302668
.long 0x1302ffc, 0x370323c, 0x7f02dbc, 0x1026fc
.long 0x2503000, 0x4903240, 0x9102e50, 0x1302790
.long 0x3703004, 0x5b03244, 0xa302ee4, 0x2502824
.long 0x4903008, 0x6d03248, 0x102678, 0x49028b8
.long 0x5b0300c, 0x7f0324c, 0x130270c, 0x5b0294c
.long 0x203060, 0x14032a0, 0x6e027f0, 0x9202a30
.long 0x1403064, 0x26032a4, 0x8002884, 0xa402ac4
.long 0x2603068, 0x38032a8, 0x9202918, 0x202b58
.long 0x380306c, 0x4a032ac, 0xa4029ac, 0x1402bec
.long 0x4a03070, 0x5c032b0, 0x202a40, 0x3802c80
.long 0x5c03074, 0x6e032b4, 0x1402ad4, 0x4a02d14
.long 0x6e03078, 0x80032b8, 0x2602b68, 0x5c02da8
.long 0x800307c, 0x92032bc, 0x3802bfc, 0x6e02e3c
.long 0x9203080, 0xa4032c0, 0x4a02c90, 0x8002ed0
.long 0xa403084, 0x2032c4, 0x5c02d24, 0x9202664
.long 0x203088, 0x26032c8, 0x6e02db8, 0xa4026f8
.long 0x140308c, 0x38032cc, 0x8002e4c, 0x20278c
.long 0x2603090, 0x4a032d0, 0x9202ee0, 0x1402820
.long 0x3803094, 0x5c032d4, 0xa402674, 0x26028b4
.long 0x4a03098, 0x6e032d8, 0x202708, 0x4a02948
.long 0x5c0309c, 0x80032dc, 0x140279c, 0x5c029dc
.long 0x3030f0, 0x1503330, 0x6f02880, 0x9302ac0
.long 0x15030f4, 0x2703334, 0x8102914, 0xa502b54
.long 0x27030f8, 0x3903338, 0x93029a8, 0x302be8
.long 0x39030fc, 0x4b0333c, 0xa502a3c, 0x1502c7c
.long 0x4b03100, 0x5d03340, 0x302ad0, 0x3902d10
.long 0x5d03104, 0x6f03344, 0x1502b64, 0x4b02da4
.long 0x6f03108, 0x8103348, 0x2702bf8, 0x5d02e38
.long 0x810310c, 0x930334c, 0x3902c8c, 0x6f02ecc
.long 0x9303110, 0xa503350, 0x4b02d20, 0x8102660
.long 0xa503114, 0x303354, 0x5d02db4, 0x93026f4
.long 0x303118, 0x2703358, 0x6f02e48, 0xa502788
.long 0x150311c, 0x390335c, 0x8102edc, 0x30281c
.long 0x2703120, 0x4b03360, 0x9302670, 0x15028b0
.long 0x3903124, 0x5d03364, 0xa502704, 0x2702944
.long 0x4b03128, 0x6f03368, 0x302798, 0x4b029d8
.long 0x5d0312c, 0x810336c, 0x150282c, 0x5d02a6c
.long 0x24033c0, 0x6c03010, 0x2640, 0x0
.long 0x36033c4, 0x7e030a4, 0x426d0, 0x0
.long 0x48033c8, 0x9003138, 0x82760, 0x0
.long 0x5a033cc, 0xa2031cc, 0xc27f0, 0x0
.long 0x6c033d0, 0x3260, 0x102880, 0x0
.long 0x7e033d4, 0x12032f4, 0x142910, 0x0
.long 0x90033d8, 0x2403388, 0x1829a0, 0x0
.long 0xa2033dc, 0x360341c, 0x1c2a30, 0x0
.long 0x33e0, 0x5a034b0, 0x202ac0, 0x0
.long 0x12033e4, 0x6c02fa4, 0x242b50, 0x0
.long 0x24033e8, 0x7e030a0, 0x282be0, 0x0
.long 0x36033ec, 0x9003134, 0x2c2c70, 0x0
.long 0x48033f0, 0xa2031c8, 0x302d00, 0x0
.long 0x5a033f4, 0x325c, 0x342d90, 0x0
.long 0x6c033f8, 0x12032f0, 0x382e20, 0x0
.long 0x7e033fc, 0x2403384, 0x3c2eb0, 0x0
.long 0x25033c0, 0x6d03418, 0x402650, 0x0
.long 0x37033c4, 0x7f034ac, 0x4426e0, 0x0
.long 0x49033c8, 0x9102fa0, 0x482770, 0x0
.long 0x5b033cc, 0xa303034, 0x4c2800, 0x0
.long 0x6d033d0, 0x103130, 0x502890, 0x0
.long 0x7f033d4, 0x13031c4, 0x542920, 0x0
.long 0x91033d8, 0x2503258, 0x5829b0, 0x0
.long 0xa3033dc, 0x37032ec, 0x5c2a40, 0x0
.long 0x1033e0, 0x5b03380, 0x602ad0, 0x0
.long 0x13033e4, 0x6d03414, 0x642b60, 0x0
.long 0x25033e8, 0x7f034a8, 0x682bf0, 0x0
.long 0x37033ec, 0x9102f9c, 0x6c2c80, 0x0
.long 0x49033f0, 0xa303030, 0x702d10, 0x0
.long 0x5b033f4, 0x1030c4, 0x742da0, 0x0
.long 0x6d033f8, 0x13031c0, 0x782e30, 0x0
.long 0x7f033fc, 0x2503254, 0x7c2ec0, 0x0
.long 0x2603450, 0x6e032e8, 0x802660, 0x0
.long 0x3803454, 0x800337c, 0x8426f0, 0x0
.long 0x4a03458, 0x9203410, 0x882780, 0x0
.long 0x5c0345c, 0xa4034a4, 0x8c2810, 0x0
.long 0x6e03460, 0x202f98, 0x9028a0, 0x0
.long 0x8003464, 0x140302c, 0x942930, 0x0
.long 0x9203468, 0x26030c0, 0x9829c0, 0x0
.long 0xa40346c, 0x3803154, 0x9c2a50, 0x0
.long 0x203470, 0x5c03250, 0xa02ae0, 0x0
.long 0x1403474, 0x6e032e4, 0xa42b70, 0x0
.long 0x2603478, 0x8003378, 0xa82c00, 0x0
.long 0x380347c, 0x920340c, 0xac2c90, 0x0
.long 0x4a03480, 0xa4034a0, 0xb02d20, 0x0
.long 0x5c03484, 0x202f94, 0xb42db0, 0x0
.long 0x6e03488, 0x1403028, 0xb82e40, 0x0
.long 0x800348c, 0x26030bc, 0xbc2ed0, 0x0
.long 0x2703450, 0x6f03150, 0xc02670, 0x0
.long 0x3903454, 0x81031e4, 0xc42700, 0x0
.long 0x4b03458, 0x93032e0, 0xc82790, 0x0
.long 0x5d0345c, 0xa503374, 0xcc2820, 0x0
.long 0x6f03460, 0x303408, 0xd028b0, 0x0
.long 0x8103464, 0x150349c, 0xd42940, 0x0
.long 0x9303468, 0x2702f90, 0xd829d0, 0x0
.long 0xa50346c, 0x3903024, 0xdc2a60, 0x0
.long 0x303470, 0x5d030b8, 0xe02af0, 0x0
.long 0x1503474, 0x6f0314c, 0xe42b80, 0x0
.long 0x2703478, 0x81031e0, 0xe82c10, 0x0
.long 0x390347c, 0x9303274, 0xec2ca0, 0x0
.long 0x4b03480, 0xa503370, 0xf02d30, 0x0
.long 0x5d03484, 0x303404, 0xf42dc0, 0x0
.long 0x6f03488, 0x1503498, 0xf82e50, 0x0
.long 0x810348c, 0x2702f8c, 0xfc2ee0, 0x0
L_ctab:
.long 0xffffffff, 0xffffff, 0xffff, 0xffff, 0xffffffff, 0x1fff, 0x11111111, 0x11111111, 0x7fff7fff, 0x80008000, 0xffff0000, 0x0, 0x2800000, 0x280, 0x43800000, 0x41000000, 0x40004000, 0x1, 0xa, 0x3a38aa3b
.size L_tab, .-L_tab
.section .rodata,"a"
.p2align 6
.amdhsa_kernel standalone__factorization_afm__recsys_kernel
  .amdhsa_next_free_vgpr 384
  .amdhsa_next_free_sgpr 102
  .amdhsa_accum_offset 256
  .amdhsa_group_segment_fixed_size 0
  .amdhsa_kernarg_size 88
  .amdhsa_user_sgpr_count 2
  .amdhsa_user_sgpr_kernarg_segment_ptr 1
  .amdhsa_system_sgpr_workgroup_id_x 1
.end_amdhsa_kernel
```

```asm
; @launch grid=(256,1,1) block=(256,1,1) lds=116992
.amdgcn_target "amdgcn-amd-amdhsa--gfx950"
.text
.globl standalone__factorization_afm__recsys_kernel
.p2align 12
.fill 832, 4, 0xbf800000
.p2align 8
.type standalone__factorization_afm__recsys_kernel,@function
standalone__factorization_afm__recsys_kernel:
    s_cmp_ge_u32 s2, 256
    s_cbranch_scc1 L_end
    s_load_dwordx16 s[16:31], s[0:1], 0
    s_load_dwordx2 s[32:33], s[0:1], 64
    s_getpc_b64 s[96:97]
L_pc:
    v_and_b32 v1, 63, v0
    v_lshlrev_b32 v120, 4, v1
    v_add_u32 v120, L_tab-L_pc, v120
    global_load_dwordx4 v[128:131], v120, s[96:97]
    s_bfe_u32 s7, s2, 0x20003
    s_lshl_b32 s7, s7, 13
    v_lshl_add_u32 v200, v0, 5, s7
    v_lshrrev_b32 v2, 6, v0
    v_min_u32 v200, L_end-L_pc, v200
    v_readfirstlane_b32 s3, v2
    global_load_dword v251, v200, s[96:97]
    global_load_dwordx2 v[132:133], v120, s[96:97] offset:1024
    global_load_dwordx4 v[232:235], v120, s[96:97] offset:2048
    global_load_dwordx3 v[236:238], v120, s[96:97] offset:3072
    v_bfe_u32 v4, v0, 4, 2
    s_lshl2_add_u32 s4, s2, s3
    s_mul_i32 s6, s4, 104
    s_add_u32 s7, s6, 76
    v_lshlrev_b32 v123, 4, v0
    v_and_b32 v14, 0xf0, v123
    v_mad_u32_u24 v121, v4, 28, s6
    v_and_b32 v126, 31, v0
    v_lshlrev_b32 v125, 6, v2
    v_min_u32 v122, s7, v121
    v_lshl_or_b32 v126, v126, 1, v125
    v_lshlrev_b32 v125, 2, v1
    v_add_u32 v112, 4096, v123
    v_add_u32 v113, 12288, v123
    v_add_u32 v114, 20480, v123
    v_add_u32 v115, 28672, v123
    s_waitcnt lgkmcnt(0)
    global_load_dwordx4 v[204:207], v121, s[16:17]
    global_load_dwordx3 v[208:210], v122, s[16:17] offset:16
    s_barrier
    global_load_dwordx4 v[48:51], v112, s[24:25] offset:-4096
    global_load_dwordx4 v[52:55], v112, s[24:25] offset:0
    global_load_dwordx4 v[56:59], v113, s[24:25] offset:-4096
    global_load_dwordx4 v[60:63], v113, s[24:25] offset:0
    global_load_dwordx4 v[64:67], v114, s[24:25] offset:-4096
    global_load_dwordx4 v[68:71], v114, s[24:25] offset:0
    global_load_dwordx4 v[72:75], v115, s[24:25] offset:-4096
    global_load_dwordx4 v[76:79], v115, s[24:25] offset:0
    global_load_dwordx4 v[220:223], v14, s[28:29]
    global_load_ushort v13, v126, s[28:29]
    global_load_ushort v12, v126, s[26:27]
    global_load_dword v252, v125, s[30:31]
    s_add_u32 s94, s96, L_ctab-L_pc
    s_addc_u32 s95, s97, 0
    s_load_dwordx16 s[36:51], s[94:95], 0
    s_load_dwordx4 s[52:55], s[94:95], 64
    s_mov_b32 s56, s18
    s_mov_b32 s57, s19
    s_mov_b32 s58, 25600000
    s_mov_b32 s59, 0x00020000
    s_mul_i32 s5, s3, 19008
    s_lshr_b32 s7, s3, 1
    s_mul_i32 s6, s3, 1152
    s_lshl_b32 s7, s7, 7
    s_add_u32 s6, s6, s7
    s_lshl_b32 s8, s3, 7
    s_add_u32 s5, s5, 40960
    v_lshlrev_b32 v127, 4, v1
    v_lshl_add_u32 v3, v2, 2, v127
    s_mov_b64 exec, 0
    s_cmp_eq_u32 s3, 0
    s_cbranch_scc1 L_pad0
    s_cmp_eq_u32 s3, 1
    s_cbranch_scc1 L_pad1
    s_cmp_eq_u32 s3, 2
    s_cbranch_scc1 L_pad2
    s_branch L_pad3
L_hopret:
    s_mov_b64 exec, -1
    s_waitcnt vmcnt(18)
    v_add_u32_sdwa v5, v128, s6 dst_sel:DWORD dst_unused:UNUSED_PAD src0_sel:WORD_0 src1_sel:DWORD
    s_waitcnt vmcnt(13)
    v_lshl_add_u32 v204, v204, 8, v14
    v_lshl_add_u32 v205, v205, 8, v14
    v_lshl_add_u32 v206, v206, 8, v14
    v_lshl_add_u32 v207, v207, 8, v14
    buffer_load_dwordx4 v[144:147], v204, s[56:59], 0 offen
    buffer_load_dwordx4 v[148:151], v205, s[56:59], 0 offen
    buffer_load_dwordx4 v[152:155], v206, s[56:59], 0 offen
    buffer_load_dwordx4 v[156:159], v207, s[56:59], 0 offen
    s_waitcnt vmcnt(16)
    v_lshl_add_u32 v208, v208, 8, v14
    v_lshl_add_u32 v209, v209, 8, v14
    v_lshl_add_u32 v210, v210, 8, v14
    v_add_u32_sdwa v7, v128, s8 dst_sel:DWORD dst_unused:UNUSED_PAD src0_sel:WORD_1 src1_sel:DWORD
    v_add_u32_sdwa v8, v129, s8 dst_sel:DWORD dst_unused:UNUSED_PAD src0_sel:WORD_0 src1_sel:DWORD
    v_lshrrev_b32 v9, 16, v129
    v_and_b32 v6, 0xffff, v130
    v_lshrrev_b32 v15, 16, v130
    v_lshrrev_b32 v0, 16, v130
    v_add_u32_sdwa v203, v131, s5 dst_sel:DWORD dst_unused:UNUSED_PAD src0_sel:WORD_0 src1_sel:DWORD
    v_add_u32_sdwa v246, v131, s5 dst_sel:DWORD dst_unused:UNUSED_PAD src0_sel:WORD_1 src1_sel:DWORD
    v_add_u32_sdwa v201, v132, s5 dst_sel:DWORD dst_unused:UNUSED_PAD src0_sel:WORD_0 src1_sel:DWORD
    v_add_u32_sdwa v245, v132, s5 dst_sel:DWORD dst_unused:UNUSED_PAD src0_sel:WORD_1 src1_sel:DWORD
    v_add_u32_sdwa v202, v133, s5 dst_sel:DWORD dst_unused:UNUSED_PAD src0_sel:WORD_0 src1_sel:DWORD
    v_lshrrev_b32 v10, 16, v133
    s_mov_b32 s13, 0xffff0000
    s_mov_b32 s90, 0x11111111
    s_mov_b32 s91, 0x11111111
L_wconv:
    s_waitcnt vmcnt(15)
    v_lshlrev_b32 v96, 16, v48
    v_and_b32 v97, s13, v48
    v_lshlrev_b32 v98, 16, v49
    v_and_b32 v99, s13, v49
    v_lshlrev_b32 v100, 16, v50
    v_and_b32 v101, s13, v50
    v_lshlrev_b32 v102, 16, v51
    v_and_b32 v103, s13, v51
    v_cvt_pkrtz_f16_f32 v16, v96, v97
    v_cvt_pkrtz_f16_f32 v17, v98, v99
    v_cvt_pkrtz_f16_f32 v18, v100, v101
    v_cvt_pkrtz_f16_f32 v19, v102, v103
    ds_write_b128 v5, v[16:19] offset:0
    v_or_b32 v248, v16, v17
    v_or3_b32 v248, v248, v18, v19
    s_waitcnt vmcnt(14)
    v_lshlrev_b32 v104, 16, v52
    v_and_b32 v105, s13, v52
    v_lshlrev_b32 v106, 16, v53
    v_and_b32 v107, s13, v53
    v_lshlrev_b32 v108, 16, v54
    v_and_b32 v109, s13, v54
    v_lshlrev_b32 v110, 16, v55
    v_and_b32 v111, s13, v55
    v_cvt_pkrtz_f16_f32 v20, v104, v105
    v_cvt_pkrtz_f16_f32 v21, v106, v107
    v_cvt_pkrtz_f16_f32 v22, v108, v109
    v_cvt_pkrtz_f16_f32 v23, v110, v111
    ds_write_b128 v5, v[20:23] offset:4736
    v_or3_b32 v248, v248, v20, v21
    v_or3_b32 v248, v248, v22, v23
    s_waitcnt vmcnt(13)
    v_lshlrev_b32 v96, 16, v56
    v_and_b32 v97, s13, v56
    v_lshlrev_b32 v98, 16, v57
    v_and_b32 v99, s13, v57
    v_lshlrev_b32 v100, 16, v58
    v_and_b32 v101, s13, v58
    v_lshlrev_b32 v102, 16, v59
    v_and_b32 v103, s13, v59
    v_cvt_pkrtz_f16_f32 v24, v96, v97
    v_cvt_pkrtz_f16_f32 v25, v98, v99
    v_cvt_pkrtz_f16_f32 v26, v100, v101
    v_cvt_pkrtz_f16_f32 v27, v102, v103
    ds_write_b128 v5, v[24:27] offset:9472
    v_or3_b32 v248, v248, v24, v25
    v_or3_b32 v248, v248, v26, v27
    s_waitcnt vmcnt(12)
    v_lshlrev_b32 v104, 16, v60
    v_and_b32 v105, s13, v60
    v_lshlrev_b32 v106, 16, v61
    v_and_b32 v107, s13, v61
    v_lshlrev_b32 v108, 16, v62
    v_and_b32 v109, s13, v62
    v_lshlrev_b32 v110, 16, v63
    v_and_b32 v111, s13, v63
    v_cvt_pkrtz_f16_f32 v28, v104, v105
    v_cvt_pkrtz_f16_f32 v29, v106, v107
    v_cvt_pkrtz_f16_f32 v30, v108, v109
    v_cvt_pkrtz_f16_f32 v31, v110, v111
    ds_write_b128 v5, v[28:31] offset:14208
    v_or3_b32 v248, v248, v28, v29
    v_or3_b32 v248, v248, v30, v31
    s_waitcnt vmcnt(11)
    v_lshlrev_b32 v96, 16, v64
    v_and_b32 v97, s13, v64
    v_lshlrev_b32 v98, 16, v65
    v_and_b32 v99, s13, v65
    v_lshlrev_b32 v100, 16, v66
    v_and_b32 v101, s13, v66
    v_lshlrev_b32 v102, 16, v67
    v_and_b32 v103, s13, v67
    v_cvt_pkrtz_f16_f32 v32, v96, v97
    v_cvt_pkrtz_f16_f32 v33, v98, v99
    v_cvt_pkrtz_f16_f32 v34, v100, v101
    v_cvt_pkrtz_f16_f32 v35, v102, v103
    ds_write_b128 v5, v[32:35] offset:18944
    v_or3_b32 v248, v248, v32, v33
    s_waitcnt vmcnt(7)
    v_dot2_f32_bf16 v112, v48, v220, 0
    v_or3_b32 v248, v248, v34, v35
    v_dot2_f32_bf16 v113, v52, v220, 0
    v_dot2_f32_bf16 v112, v49, v221, v112
    v_dot2_f32_bf16 v113, v53, v221, v113
    v_dot2_f32_bf16 v112, v50, v222, v112
    v_dot2_f32_bf16 v113, v54, v222, v113
    v_dot2_f32_bf16 v112, v51, v223, v112
    v_dot2_f32_bf16 v113, v55, v223, v113
    v_dot2_f32_bf16 v114, v56, v220, 0
    v_dot2_f32_bf16 v115, v60, v220, 0
    v_lshlrev_b32 v104, 16, v68
    v_and_b32 v105, s13, v68
    v_lshlrev_b32 v106, 16, v69
    v_and_b32 v107, s13, v69
    v_lshlrev_b32 v108, 16, v70
    v_and_b32 v109, s13, v70
    v_lshlrev_b32 v110, 16, v71
    v_and_b32 v111, s13, v71
    v_cvt_pkrtz_f16_f32 v36, v104, v105
    v_cvt_pkrtz_f16_f32 v37, v106, v107
    v_cvt_pkrtz_f16_f32 v38, v108, v109
    v_cvt_pkrtz_f16_f32 v39, v110, v111
    ds_write_b128 v5, v[36:39] offset:23680
    v_or3_b32 v248, v248, v36, v37
    v_dot2_f32_bf16 v114, v57, v221, v114
    v_or3_b32 v248, v248, v38, v39
    v_dot2_f32_bf16 v115, v61, v221, v115
    v_dot2_f32_bf16 v114, v58, v222, v114
    v_dot2_f32_bf16 v115, v62, v222, v115
    v_dot2_f32_bf16 v114, v59, v223, v114
    v_dot2_f32_bf16 v115, v63, v223, v115
    v_add_f32_dpp v112, v112, v112 row_ror:8 row_mask:0xf bank_mask:0x3
    v_dot2_f32_bf16 v116, v64, v220, 0
    v_dot2_f32_bf16 v117, v68, v220, 0
    v_dot2_f32_bf16 v116, v65, v221, v116
    v_lshlrev_b32 v96, 16, v72
    v_and_b32 v97, s13, v72
    v_lshlrev_b32 v98, 16, v73
    v_and_b32 v99, s13, v73
    v_lshlrev_b32 v100, 16, v74
    v_and_b32 v101, s13, v74
    v_lshlrev_b32 v102, 16, v75
    v_and_b32 v103, s13, v75
    v_cvt_pkrtz_f16_f32 v40, v96, v97
    v_cvt_pkrtz_f16_f32 v41, v98, v99
    v_cvt_pkrtz_f16_f32 v42, v100, v101
    v_cvt_pkrtz_f16_f32 v43, v102, v103
    ds_write_b128 v5, v[40:43] offset:28416
    v_or3_b32 v248, v248, v40, v41
    v_dot2_f32_bf16 v117, v69, v221, v117
    v_or3_b32 v248, v248, v42, v43
    v_add_f32_dpp v112, v113, v113 row_ror:8 row_mask:0xf bank_mask:0xc
    v_add_f32_dpp v114, v114, v114 row_ror:8 row_mask:0xf bank_mask:0x3
    v_dot2_f32_bf16 v116, v66, v222, v116
    v_dot2_f32_bf16 v117, v70, v222, v117
    v_dot2_f32_bf16 v116, v67, v223, v116
    v_dot2_f32_bf16 v117, v71, v223, v117
    v_add_f32_dpp v114, v115, v115 row_ror:8 row_mask:0xf bank_mask:0xc
    v_add_f32_dpp v112, v112, v112 row_half_mirror row_mask:0xf bank_mask:0x5
    v_dot2_f32_bf16 v118, v72, v220, 0
    v_lshlrev_b32 v104, 16, v76
    v_and_b32 v105, s13, v76
    v_lshlrev_b32 v106, 16, v77
    v_and_b32 v107, s13, v77
    v_lshlrev_b32 v108, 16, v78
    v_and_b32 v109, s13, v78
    v_lshlrev_b32 v110, 16, v79
    v_and_b32 v111, s13, v79
    v_cvt_pkrtz_f16_f32 v44, v104, v105
    v_cvt_pkrtz_f16_f32 v45, v106, v107
    v_cvt_pkrtz_f16_f32 v46, v108, v109
    v_cvt_pkrtz_f16_f32 v47, v110, v111
    ds_write_b128 v5, v[44:47] offset:33152
    v_or3_b32 v248, v248, v44, v45
    v_dot2_f32_bf16 v119, v76, v220, 0
    v_or3_b32 v248, v248, v46, v47
    v_dot2_f32_bf16 v118, v73, v221, v118
    v_dot2_f32_bf16 v119, v77, v221, v119
    v_add_f32_dpp v112, v114, v114 row_half_mirror row_mask:0xf bank_mask:0xa
    v_add_f32_dpp v116, v116, v116 row_ror:8 row_mask:0xf bank_mask:0x3
    v_dot2_f32_bf16 v118, v74, v222, v118
    v_dot2_f32_bf16 v119, v78, v222, v119
    v_dot2_f32_bf16 v118, v75, v223, v118
    v_dot2_f32_bf16 v119, v79, v223, v119
    v_add_f32_dpp v116, v117, v117 row_ror:8 row_mask:0xf bank_mask:0xc
    v_add_f32_dpp v112, v112, v112 quad_perm:[1,0,3,2] row_mask:0xf bank_mask:0xf
    v_cmp_lt_u32 vcc, 31, v1
    v_add_f32_dpp v118, v118, v118 row_ror:8 row_mask:0xf bank_mask:0x3
    v_add_f32_dpp v116, v116, v116 row_half_mirror row_mask:0xf bank_mask:0x5
    s_waitcnt vmcnt(5)
    v_cndmask_b32 v120, v12, v13, vcc
    v_add_f32_dpp v118, v119, v119 row_ror:8 row_mask:0xf bank_mask:0xc
    v_add_f32_dpp v112, v112, v112 quad_perm:[2,3,0,1] row_mask:0xf bank_mask:0xf
    v_lshlrev_b32 v120, 16, v120
    v_add_f32_dpp v116, v118, v118 row_half_mirror row_mask:0xf bank_mask:0xa
    v_ldexp_f32 v120, v120, v9
    ds_write_b32 v3, v248 offset:39424
    v_add_f32_dpp v116, v116, v116 quad_perm:[1,0,3,2] row_mask:0xf bank_mask:0xf
    ds_write_b32 v8, v120 offset:37888
    s_nop 0
    v_add_f32_dpp v113, v116, v116 quad_perm:[2,3,0,1] row_mask:0xf bank_mask:0xf
    s_mov_b64 exec, s[90:91]
    ds_write_b64 v7, v[112:113]
    s_mov_b64 exec, -1
    s_waitcnt lgkmcnt(0)
    s_barrier
    ds_read_b128 v[112:115], v127 offset:39424
    ds_read_b64_tr_b16 a[0:1], v6 offset:0
    ds_read_b64_tr_b16 a[2:3], v6 offset:1152
    ds_read_b64_tr_b16 a[4:5], v6 offset:9472
    ds_read_b64_tr_b16 a[6:7], v6 offset:10624
    ds_read_b64_tr_b16 a[8:9], v6 offset:18944
    ds_read_b64_tr_b16 a[10:11], v6 offset:20096
    ds_read_b64_tr_b16 a[12:13], v6 offset:28416
    ds_read_b64_tr_b16 a[14:15], v6 offset:29568
    ds_read_b64_tr_b16 a[16:17], v6 offset:32
    ds_read_b64_tr_b16 a[18:19], v6 offset:1184
    ds_read_b64_tr_b16 a[20:21], v6 offset:9504
    ds_read_b64_tr_b16 a[22:23], v6 offset:10656
    ds_read_b64_tr_b16 a[24:25], v6 offset:18976
    ds_read_b64_tr_b16 a[26:27], v6 offset:20128
    ds_read_b64_tr_b16 a[28:29], v6 offset:28448
    ds_read_b64_tr_b16 a[30:31], v6 offset:29600
    s_waitcnt lgkmcnt(15)
    v_or3_b32 v112, v112, v113, v114
    v_or_b32 v112, v112, v115
    v_and_b32 v121, s52, v112
    v_and_b32 v122, 0x20002000, v112
    v_cmp_ne_u32 vcc, 0, v121
    v_cmp_ge_u32 s[92:93], v122, s53
    s_cbranch_vccnz L_wfix
    s_cmp_eq_u64 s[92:93], 0
    s_cbranch_scc1 L_wfix
    buffer_load_dwordx4 v[160:163], v208, s[56:59], 0 offen
    buffer_load_dwordx4 v[164:167], v209, s[56:59], 0 offen
    buffer_load_dwordx4 v[168:171], v210, s[56:59], 0 offen
L_econv:
    s_waitcnt vmcnt(6)
    v_lshl_add_u32 v96, v144, 16, s48
    v_add_u32_sdwa v97, v144, s49 dst_sel:WORD_1 dst_unused:UNUSED_PAD src0_sel:WORD_1 src1_sel:DWORD
    v_lshl_add_u32 v98, v145, 16, s48
    v_add_u32_sdwa v99, v145, s49 dst_sel:WORD_1 dst_unused:UNUSED_PAD src0_sel:WORD_1 src1_sel:DWORD
    v_lshl_add_u32 v100, v146, 16, s48
    v_add_u32_sdwa v101, v146, s49 dst_sel:WORD_1 dst_unused:UNUSED_PAD src0_sel:WORD_1 src1_sel:DWORD
    v_lshl_add_u32 v102, v147, 16, s48
    v_add_u32_sdwa v103, v147, s49 dst_sel:WORD_1 dst_unused:UNUSED_PAD src0_sel:WORD_1 src1_sel:DWORD
    v_cvt_pkrtz_f16_f32 v172, v96, v97
    v_max_f32 v248, |v96|, |v97|
    v_cvt_pkrtz_f16_f32 v173, v98, v99
    v_max_f32 v249, |v98|, |v99|
    v_cvt_pkrtz_f16_f32 v174, v100, v101
    v_max3_f32 v248, v248, |v100|, |v101|
    v_cvt_pkrtz_f16_f32 v175, v102, v103
    v_max3_f32 v249, v249, |v102|, |v103|
    ds_write_b128 v203, v[172:175] offset:0
    ds_read_b128 v[16:19], v0 offset:37888
    ds_read_b128 v[20:23], v0 offset:37952
    ds_read_b128 v[24:27], v0 offset:38016
    s_waitcnt vmcnt(5)
    v_lshl_add_u32 v104, v148, 16, s48
    v_add_u32_sdwa v105, v148, s49 dst_sel:WORD_1 dst_unused:UNUSED_PAD src0_sel:WORD_1 src1_sel:DWORD
    v_lshl_add_u32 v106, v149, 16, s48
    v_add_u32_sdwa v107, v149, s49 dst_sel:WORD_1 dst_unused:UNUSED_PAD src0_sel:WORD_1 src1_sel:DWORD
    v_lshl_add_u32 v108, v150, 16, s48
    v_add_u32_sdwa v109, v150, s49 dst_sel:WORD_1 dst_unused:UNUSED_PAD src0_sel:WORD_1 src1_sel:DWORD
    v_lshl_add_u32 v110, v151, 16, s48
    v_add_u32_sdwa v111, v151, s49 dst_sel:WORD_1 dst_unused:UNUSED_PAD src0_sel:WORD_1 src1_sel:DWORD
    v_cvt_pkrtz_f16_f32 v176, v104, v105
    v_max3_f32 v248, v248, |v104|, |v105|
    v_cvt_pkrtz_f16_f32 v177, v106, v107
    v_max3_f32 v249, v249, |v106|, |v107|
    v_cvt_pkrtz_f16_f32 v178, v108, v109
    v_max3_f32 v248, v248, |v108|, |v109|
    v_cvt_pkrtz_f16_f32 v179, v110, v111
    v_max3_f32 v249, v249, |v110|, |v111|
    ds_write_b128 v203, v[176:179] offset:1152
    s_waitcnt vmcnt(4)
    v_lshl_add_u32 v96, v152, 16, s48
    v_add_u32_sdwa v97, v152, s49 dst_sel:WORD_1 dst_unused:UNUSED_PAD src0_sel:WORD_1 src1_sel:DWORD
    v_lshl_add_u32 v98, v153, 16, s48
    v_add_u32_sdwa v99, v153, s49 dst_sel:WORD_1 dst_unused:UNUSED_PAD src0_sel:WORD_1 src1_sel:DWORD
    v_lshl_add_u32 v100, v154, 16, s48
    v_add_u32_sdwa v101, v154, s49 dst_sel:WORD_1 dst_unused:UNUSED_PAD src0_sel:WORD_1 src1_sel:DWORD
    v_lshl_add_u32 v102, v155, 16, s48
    v_add_u32_sdwa v103, v155, s49 dst_sel:WORD_1 dst_unused:UNUSED_PAD src0_sel:WORD_1 src1_sel:DWORD
    v_cvt_pkrtz_f16_f32 v180, v96, v97
    v_cvt_pkrtz_f16_f32 v181, v98, v99
    v_cvt_pkrtz_f16_f32 v182, v100, v101
    v_cvt_pkrtz_f16_f32 v183, v102, v103
    ds_write_b128 v203, v[180:183] offset:2304
    s_waitcnt vmcnt(3)
    v_lshl_add_u32 v104, v156, 16, s48
    v_add_u32_sdwa v105, v156, s49 dst_sel:WORD_1 dst_unused:UNUSED_PAD src0_sel:WORD_1 src1_sel:DWORD
    v_lshl_add_u32 v106, v157, 16, s48
    v_add_u32_sdwa v107, v157, s49 dst_sel:WORD_1 dst_unused:UNUSED_PAD src0_sel:WORD_1 src1_sel:DWORD
    v_lshl_add_u32 v108, v158, 16, s48
    v_add_u32_sdwa v109, v158, s49 dst_sel:WORD_1 dst_unused:UNUSED_PAD src0_sel:WORD_1 src1_sel:DWORD
    v_lshl_add_u32 v110, v159, 16, s48
    v_add_u32_sdwa v111, v159, s49 dst_sel:WORD_1 dst_unused:UNUSED_PAD src0_sel:WORD_1 src1_sel:DWORD
    v_cvt_pkrtz_f16_f32 v184, v104, v105
    v_cvt_pkrtz_f16_f32 v185, v106, v107
    v_cvt_pkrtz_f16_f32 v186, v108, v109
    v_cvt_pkrtz_f16_f32 v187, v110, v111
    ds_write_b128 v203, v[184:187] offset:3456
    ds_read_b128 v[80:83], v246 offset:0
    ds_read_b128 v[128:131], v201 offset:0
    ds_read_b128 v[84:87], v246 offset:64
    ds_read_b128 v[132:135], v201 offset:64
    ds_read_b128 v[88:91], v246 offset:128
    ds_read_b128 v[136:139], v201 offset:128
    ds_read_b128 v[92:95], v246 offset:192
    ds_read_b128 v[140:143], v201 offset:192
    ds_read_b64_tr_b16 a[32:33], v6 offset:64
    ds_read_b64_tr_b16 a[34:35], v6 offset:1216
    ds_read_b64_tr_b16 a[36:37], v6 offset:9536
    ds_read_b64_tr_b16 a[38:39], v6 offset:10688
    ds_read_b64_tr_b16 a[40:41], v6 offset:19008
    ds_read_b64_tr_b16 a[42:43], v6 offset:20160
    ds_read_b64_tr_b16 a[44:45], v6 offset:28480
    ds_read_b64_tr_b16 a[46:47], v6 offset:29632
    v_max3_f32 v248, v248, |v96|, |v97|
    v_max3_f32 v249, v249, |v98|, |v99|
    v_max3_f32 v248, v248, |v100|, |v101|
    v_max3_f32 v249, v249, |v102|, |v103|
    v_max3_f32 v248, v248, |v104|, |v105|
    v_max3_f32 v249, v249, |v106|, |v107|
    v_max3_f32 v248, v248, |v108|, |v109|
    v_max3_f32 v249, v249, |v110|, |v111|
    s_waitcnt lgkmcnt(14)
    v_pk_mul_f16 v128, v128, v80
    v_pk_mul_f16 v129, v129, v81
    v_pk_mul_f16 v130, v130, v82
    v_pk_mul_f16 v131, v131, v83
    s_nop 1
    v_mfma_f32_16x16x32_f16 v[96:99], a[0:3], v[128:131], v[16:19]
    ds_read_b128 v[28:31], v0 offset:38080
    ds_read_b64_tr_b16 a[60:61], v6 offset:28512
    s_waitcnt lgkmcnt(14)
    v_pk_mul_f16 v132, v132, v84
    v_pk_mul_f16 v133, v133, v85
    v_mfma_f32_16x16x32_f16 v[100:103], a[16:19], v[128:131], v[20:23]
    ds_read_b64_tr_b16 a[62:63], v6 offset:29664
    ds_read_b64_tr_b16 a[56:57], v6 offset:19040
    v_pk_mul_f16 v134, v134, v86
    v_pk_mul_f16 v135, v135, v87
    s_waitcnt lgkmcnt(10)
    v_mfma_f32_16x16x32_f16 v[104:107], a[32:35], v[128:131], v[24:27]
    ds_read_b64_tr_b16 a[58:59], v6 offset:20192
    ds_read_b64_tr_b16 a[52:53], v6 offset:9568
    v_pk_mul_f16 v136, v136, v88
    v_pk_mul_f16 v137, v137, v89
    v_mfma_f32_16x16x32_f16 v[96:99], a[4:7], v[132:135], v[96:99]
    ds_read_b64_tr_b16 a[54:55], v6 offset:10720
    ds_read_b64_tr_b16 a[48:49], v6 offset:96
    v_pk_mul_f16 v138, v138, v90
    v_pk_mul_f16 v139, v139, v91
    v_mfma_f32_16x16x32_f16 v[100:103], a[20:23], v[132:135], v[100:103]
    ds_read_b64_tr_b16 a[50:51], v6 offset:1248
    ds_read_b128 v[48:51], v15 offset:38400
    v_pk_mul_f16 v140, v140, v92
    v_pk_mul_f16 v141, v141, v93
    s_waitcnt lgkmcnt(14)
    v_mfma_f32_16x16x32_f16 v[104:107], a[36:39], v[132:135], v[104:107]
    ds_read_b128 v[52:55], v15 offset:38464
    ds_read_b128 v[56:59], v15 offset:38528
    v_pk_mul_f16 v142, v142, v94
    v_pk_mul_f16 v143, v143, v95
    v_mov_b32_dpp v247, v246 row_ror:14 row_mask:0xf bank_mask:0xf
    ds_read_b128 v[156:159], v247 offset:192
    ds_read_b128 v[152:155], v247 offset:128
    ds_read_b128 v[148:151], v247 offset:64
    ds_read_b128 v[144:147], v247 offset:0
    v_mfma_f32_16x16x32_f16 v[96:99], a[8:11], v[136:139], v[96:99]
    ds_read_b128 v[32:35], v0 offset:38144
    ds_read_b64_tr_b16 a[76:77], v6 offset:28544
    ds_read2_b32 v[192:193], v10 offset0:0 offset1:8
    v_mov_b32 v251, 0xff800000
    v_mfma_f32_16x16x32_f16 v[100:103], a[24:27], v[136:139], v[100:103]
    ds_read_b64_tr_b16 a[78:79], v6 offset:29696
    ds_read_b64_tr_b16 a[72:73], v6 offset:19072
    s_waitcnt lgkmcnt(15)
    v_mfma_f32_16x16x32_f16 v[104:107], a[40:43], v[136:139], v[104:107]
    ds_read_b64_tr_b16 a[74:75], v6 offset:20224
    ds_read_b64_tr_b16 a[68:69], v6 offset:9600
    v_mfma_f32_16x16x32_f16 v[96:99], a[12:15], v[140:143], v[96:99]
    ds_read_b64_tr_b16 a[70:71], v6 offset:10752
    ds_read_b64_tr_b16 a[64:65], v6 offset:128
    ds_read_b64_tr_b16 a[66:67], v6 offset:1280
    v_mfma_f32_16x16x32_f16 v[100:103], a[28:31], v[140:143], v[100:103]
    ds_read_b128 v[60:63], v15 offset:38592
    ds_read_b128 v[36:39], v0 offset:38208
    v_mfma_f32_16x16x32_f16 v[104:107], a[44:47], v[140:143], v[104:107]
    ds_read_b64_tr_b16 a[92:93], v6 offset:28576
    ds_read_b64_tr_b16 a[94:95], v6 offset:29728
    s_waitcnt lgkmcnt(15)
    v_mfma_f32_16x16x32_f16 v[108:111], a[48:51], v[128:131], v[28:31]
    ds_read_b64_tr_b16 a[88:89], v6 offset:19104
    ds_read_b64_tr_b16 a[90:91], v6 offset:20256
    v_mul_f32 v184, |v96|, v48
    v_fma_f32 v184, |v97|, v49, v184
    v_mfma_f32_16x16x32_f16 v[108:111], a[52:55], v[132:135], v[108:111]
    ds_read_b64_tr_b16 a[84:85], v6 offset:9632
    ds_read_b64_tr_b16 a[86:87], v6 offset:10784
    ds_read_b64_tr_b16 a[80:81], v6 offset:160
    ds_read_b64_tr_b16 a[82:83], v6 offset:1312
    v_fma_f32 v184, |v98|, v50, v184
    v_fma_f32 v184, |v99|, v51, v184
    v_mfma_f32_16x16x32_f16 v[108:111], a[56:59], v[136:139], v[108:111]
    ds_read_b128 v[64:67], v15 offset:38656
    ds_read_b128 v[40:43], v0 offset:38272
    s_waitcnt lgkmcnt(15)
    v_pk_mul_f16 v144, v144, v80
    v_fma_f32 v184, |v100|, v52, v184
    v_mfma_f32_16x16x32_f16 v[108:111], a[60:63], v[140:143], v[108:111]
    ds_read_b64_tr_b16 a[108:109], v6 offset:28608
    ds_read_b64_tr_b16 a[110:111], v6 offset:29760
    v_and_b32 v253, s44, v252
    v_fma_f32 v184, |v101|, v53, v184
    s_waitcnt lgkmcnt(14)
    v_mfma_f32_16x16x32_f16 v[112:115], a[64:67], v[128:131], v[32:35]
    ds_read_b64_tr_b16 a[104:105], v6 offset:19136
    ds_read_b64_tr_b16 a[106:107], v6 offset:20288
    v_pk_mul_f16 v145, v145, v81
    v_fma_f32 v184, |v102|, v54, v184
    v_mfma_f32_16x16x32_f16 v[112:115], a[68:71], v[132:135], v[112:115]
    ds_read_b64_tr_b16 a[100:101], v6 offset:9664
    ds_read_b64_tr_b16 a[102:103], v6 offset:10816
    ds_read_b64_tr_b16 a[96:97], v6 offset:192
    ds_read_b64_tr_b16 a[98:99], v6 offset:1344
    v_pk_mul_f16 v146, v146, v82
    v_fma_f32 v184, |v103|, v55, v184
    v_mfma_f32_16x16x32_f16 v[112:115], a[72:75], v[136:139], v[112:115]
    ds_read_b128 v[68:71], v15 offset:38720
    ds_read_b128 v[44:47], v0 offset:38336
    v_pk_mul_f16 v147, v147, v83
    v_fma_f32 v184, |v104|, v56, v184
    v_mfma_f32_16x16x32_f16 v[112:115], a[76:79], v[140:143], v[112:115]
    ds_read_b64_tr_b16 a[124:125], v6 offset:28640
    ds_read_b64_tr_b16 a[126:127], v6 offset:29792
    v_pk_mul_f16 v148, v148, v84
    v_fma_f32 v184, |v105|, v57, v184
    s_waitcnt lgkmcnt(14)
    v_mfma_f32_16x16x32_f16 v[116:119], a[80:83], v[128:131], v[36:39]
    ds_read_b64_tr_b16 a[120:121], v6 offset:19168
    ds_read_b64_tr_b16 a[122:123], v6 offset:20320
    v_pk_mul_f16 v149, v149, v85
    v_fma_f32 v184, |v106|, v58, v184
    v_mfma_f32_16x16x32_f16 v[116:119], a[84:87], v[132:135], v[116:119]
    ds_read_b64_tr_b16 a[116:117], v6 offset:9696
    ds_read_b64_tr_b16 a[118:119], v6 offset:10848
    ds_read_b64_tr_b16 a[112:113], v6 offset:224
    ds_read_b64_tr_b16 a[114:115], v6 offset:1376
    v_pk_mul_f16 v150, v150, v86
    v_fma_f32 v184, |v107|, v59, v184
    v_mfma_f32_16x16x32_f16 v[116:119], a[88:91], v[136:139], v[116:119]
    ds_read_b128 v[72:75], v15 offset:38784
    ds_read_b128 v[76:79], v15 offset:38848
    v_pk_mul_f16 v151, v151, v87
    v_fma_f32 v184, |v108|, v60, v184
    v_mfma_f32_16x16x32_f16 v[116:119], a[92:95], v[140:143], v[116:119]
    v_pk_mul_f16 v152, v152, v88
    v_fma_f32 v184, |v109|, v61, v184
    s_waitcnt lgkmcnt(12)
    v_mfma_f32_16x16x32_f16 v[120:123], a[96:99], v[128:131], v[40:43]
    v_pk_mul_f16 v153, v153, v89
    v_fma_f32 v184, |v110|, v62, v184
    v_mfma_f32_16x16x32_f16 v[120:123], a[100:103], v[132:135], v[120:123]
    v_pk_mul_f16 v154, v154, v90
    v_fma_f32 v184, |v111|, v63, v184
    v_mfma_f32_16x16x32_f16 v[120:123], a[104:107], v[136:139], v[120:123]
    v_pk_mul_f16 v155, v155, v91
    v_fma_f32 v184, |v112|, v64, v184
    v_mfma_f32_16x16x32_f16 v[120:123], a[108:111], v[140:143], v[120:123]
    v_pk_mul_f16 v156, v156, v92
    v_fma_f32 v184, |v113|, v65, v184
    s_waitcnt lgkmcnt(2)
    v_mfma_f32_16x16x32_f16 v[124:127], a[112:115], v[128:131], v[44:47]
    v_pk_mul_f16 v157, v157, v93
    v_fma_f32 v184, |v114|, v66, v184
    v_mfma_f32_16x16x32_f16 v[124:127], a[116:119], v[132:135], v[124:127]
    v_pk_mul_f16 v158, v158, v94
    v_fma_f32 v184, |v115|, v67, v184
    v_mfma_f32_16x16x32_f16 v[124:127], a[120:123], v[136:139], v[124:127]
    v_pk_mul_f16 v159, v159, v95
    v_fma_f32 v184, |v116|, v68, v184
    v_mfma_f32_16x16x32_f16 v[124:127], a[124:127], v[140:143], v[124:127]
    v_mov_b32_dpp v247, v246 row_ror:13 row_mask:0xf bank_mask:0xf
    v_fma_f32 v184, |v117|, v69, v184
    v_mfma_f32_16x16x32_f16 v[96:99], a[0:3], v[144:147], v[16:19]
    ds_read_b128 v[140:143], v247 offset:192
    v_fma_f32 v184, |v118|, v70, v184
    v_mfma_f32_16x16x32_f16 v[96:99], a[4:7], v[148:151], v[96:99]
    ds_read_b128 v[136:139], v247 offset:128
    v_fma_f32 v184, |v119|, v71, v184
    v_mfma_f32_16x16x32_f16 v[96:99], a[8:11], v[152:155], v[96:99]
    ds_read_b128 v[132:135], v247 offset:64
    s_waitcnt lgkmcnt(4)
    v_fma_f32 v184, |v120|, v72, v184
    v_mfma_f32_16x16x32_f16 v[96:99], a[12:15], v[156:159], v[96:99]
L_pad0:
    s_cbranch_execz L_hopret
    ds_read_b128 v[128:131], v247 offset:0
    v_fma_f32 v184, |v121|, v73, v184
    v_mfma_f32_16x16x32_f16 v[100:103], a[16:19], v[144:147], v[20:23]
    v_pk_max_u16 v254, v253, v253 op_sel:[0,1] op_sel_hi:[1,0]
    v_fma_f32 v184, |v122|, v74, v184
    v_mfma_f32_16x16x32_f16 v[100:103], a[20:23], v[148:151], v[100:103]
    v_max_f32 v255, |v192|, |v193|
    v_fma_f32 v184, |v123|, v75, v184
    v_mfma_f32_16x16x32_f16 v[100:103], a[24:27], v[152:155], v[100:103]
    v_max_u32_dpp v254, v254, v254 row_ror:8 row_mask:0xf bank_mask:0xf
    s_waitcnt lgkmcnt(4)
    v_fma_f32 v184, |v124|, v76, v184
    v_mfma_f32_16x16x32_f16 v[100:103], a[28:31], v[156:159], v[100:103]
    v_max_u32_dpp v255, v255, v255 row_ror:8 row_mask:0xf bank_mask:0xf
    v_fma_f32 v184, |v125|, v77, v184
    v_mfma_f32_16x16x32_f16 v[104:107], a[32:35], v[144:147], v[24:27]
    s_waitcnt vmcnt(2)
    v_lshl_add_u32 v220, v160, 16, s48
    v_fma_f32 v184, |v126|, v78, v184
    v_mfma_f32_16x16x32_f16 v[104:107], a[36:39], v[148:151], v[104:107]
    v_add_u32_sdwa v221, v160, s49 dst_sel:WORD_1 dst_unused:UNUSED_PAD src0_sel:WORD_1 src1_sel:DWORD
    v_fma_f32 v184, |v127|, v79, v184
    v_mfma_f32_16x16x32_f16 v[104:107], a[40:43], v[152:155], v[104:107]
    v_lshl_add_u32 v222, v161, 16, s48
    v_mul_f32 v185, |v96|, v48
    v_mfma_f32_16x16x32_f16 v[104:107], a[44:47], v[156:159], v[104:107]
    v_add_u32_sdwa v223, v161, s49 dst_sel:WORD_1 dst_unused:UNUSED_PAD src0_sel:WORD_1 src1_sel:DWORD
    v_fma_f32 v185, |v97|, v49, v185
    v_mfma_f32_16x16x32_f16 v[108:111], a[48:51], v[144:147], v[28:31]
    v_lshl_add_u32 v224, v162, 16, s48
    v_fma_f32 v185, |v98|, v50, v185
    v_mfma_f32_16x16x32_f16 v[108:111], a[52:55], v[148:151], v[108:111]
    v_add_u32_sdwa v225, v162, s49 dst_sel:WORD_1 dst_unused:UNUSED_PAD src0_sel:WORD_1 src1_sel:DWORD
    v_fma_f32 v185, |v99|, v51, v185
    v_mfma_f32_16x16x32_f16 v[108:111], a[56:59], v[152:155], v[108:111]
    v_lshl_add_u32 v226, v163, 16, s48
    v_fma_f32 v185, |v100|, v52, v185
    v_mfma_f32_16x16x32_f16 v[108:111], a[60:63], v[156:159], v[108:111]
    s_waitcnt lgkmcnt(0)
    v_pk_mul_f16 v128, v128, v80
    v_fma_f32 v185, |v101|, v53, v185
    v_mfma_f32_16x16x32_f16 v[112:115], a[64:67], v[144:147], v[32:35]
    v_pk_mul_f16 v129, v129, v81
    v_fma_f32 v185, |v102|, v54, v185
    v_mfma_f32_16x16x32_f16 v[112:115], a[68:71], v[148:151], v[112:115]
    v_pk_mul_f16 v130, v130, v82
    v_fma_f32 v185, |v103|, v55, v185
    v_mfma_f32_16x16x32_f16 v[112:115], a[72:75], v[152:155], v[112:115]
    v_pk_mul_f16 v131, v131, v83
    v_fma_f32 v185, |v104|, v56, v185
    v_mfma_f32_16x16x32_f16 v[112:115], a[76:79], v[156:159], v[112:115]
    v_pk_mul_f16 v132, v132, v84
    v_fma_f32 v185, |v105|, v57, v185
    v_mfma_f32_16x16x32_f16 v[116:119], a[80:83], v[144:147], v[36:39]
    v_pk_mul_f16 v133, v133, v85
    v_fma_f32 v185, |v106|, v58, v185
    v_mfma_f32_16x16x32_f16 v[116:119], a[84:87], v[148:151], v[116:119]
    v_pk_mul_f16 v134, v134, v86
    v_fma_f32 v185, |v107|, v59, v185
    v_mfma_f32_16x16x32_f16 v[116:119], a[88:91], v[152:155], v[116:119]
    v_pk_mul_f16 v135, v135, v87
    v_fma_f32 v185, |v108|, v60, v185
    v_mfma_f32_16x16x32_f16 v[116:119], a[92:95], v[156:159], v[116:119]
    v_pk_mul_f16 v136, v136, v88
    v_fma_f32 v185, |v109|, v61, v185
    v_mfma_f32_16x16x32_f16 v[120:123], a[96:99], v[144:147], v[40:43]
    v_pk_mul_f16 v137, v137, v89
    v_fma_f32 v185, |v110|, v62, v185
    v_mfma_f32_16x16x32_f16 v[120:123], a[100:103], v[148:151], v[120:123]
    v_pk_mul_f16 v138, v138, v90
    v_fma_f32 v185, |v111|, v63, v185
    v_mfma_f32_16x16x32_f16 v[120:123], a[104:107], v[152:155], v[120:123]
    v_pk_mul_f16 v139, v139, v91
    v_fma_f32 v185, |v112|, v64, v185
    v_mfma_f32_16x16x32_f16 v[120:123], a[108:111], v[156:159], v[120:123]
    v_pk_mul_f16 v140, v140, v92
    v_fma_f32 v185, |v113|, v65, v185
    v_mfma_f32_16x16x32_f16 v[124:127], a[112:115], v[144:147], v[44:47]
    v_pk_mul_f16 v141, v141, v93
    v_fma_f32 v185, |v114|, v66, v185
    v_mfma_f32_16x16x32_f16 v[124:127], a[116:119], v[148:151], v[124:127]
    v_pk_mul_f16 v142, v142, v94
    v_fma_f32 v185, |v115|, v67, v185
    v_mfma_f32_16x16x32_f16 v[124:127], a[120:123], v[152:155], v[124:127]
    v_pk_mul_f16 v143, v143, v95
    v_fma_f32 v185, |v116|, v68, v185
    v_mfma_f32_16x16x32_f16 v[124:127], a[124:127], v[156:159], v[124:127]
    v_mov_b32_dpp v247, v246 row_ror:12 row_mask:0xf bank_mask:0xf
    v_fma_f32 v185, |v117|, v69, v185
    v_mfma_f32_16x16x32_f16 v[96:99], a[0:3], v[128:131], v[16:19]
    ds_read_b128 v[156:159], v247 offset:192
    v_fma_f32 v185, |v118|, v70, v185
    v_mfma_f32_16x16x32_f16 v[96:99], a[4:7], v[132:135], v[96:99]
    ds_read_b128 v[152:155], v247 offset:128
    v_fma_f32 v185, |v119|, v71, v185
    v_mfma_f32_16x16x32_f16 v[96:99], a[8:11], v[136:139], v[96:99]
    ds_read_b128 v[148:151], v247 offset:64
    v_fma_f32 v185, |v120|, v72, v185
    v_mfma_f32_16x16x32_f16 v[96:99], a[12:15], v[140:143], v[96:99]
    ds_read_b128 v[144:147], v247 offset:0
    v_fma_f32 v185, |v121|, v73, v185
    v_mfma_f32_16x16x32_f16 v[100:103], a[16:19], v[128:131], v[20:23]
    v_add_u32_sdwa v227, v163, s49 dst_sel:WORD_1 dst_unused:UNUSED_PAD src0_sel:WORD_1 src1_sel:DWORD
    v_fma_f32 v185, |v122|, v74, v185
    v_mfma_f32_16x16x32_f16 v[100:103], a[20:23], v[132:135], v[100:103]
    v_cvt_pkrtz_f16_f32 v204, v220, v221
    v_fma_f32 v185, |v123|, v75, v185
    v_mfma_f32_16x16x32_f16 v[100:103], a[24:27], v[136:139], v[100:103]
    v_max3_f32 v248, v248, |v220|, |v221|
    v_fma_f32 v185, |v124|, v76, v185
    v_mfma_f32_16x16x32_f16 v[100:103], a[28:31], v[140:143], v[100:103]
    v_cvt_pkrtz_f16_f32 v205, v222, v223
    v_fma_f32 v185, |v125|, v77, v185
    v_mfma_f32_16x16x32_f16 v[104:107], a[32:35], v[128:131], v[24:27]
    v_max3_f32 v249, v249, |v222|, |v223|
    v_fma_f32 v185, |v126|, v78, v185
    v_mfma_f32_16x16x32_f16 v[104:107], a[36:39], v[132:135], v[104:107]
    v_cvt_pkrtz_f16_f32 v206, v224, v225
    v_fma_f32 v185, |v127|, v79, v185
    v_mfma_f32_16x16x32_f16 v[104:107], a[40:43], v[136:139], v[104:107]
    v_max3_f32 v248, v248, |v224|, |v225|
    v_mul_f32 v186, |v96|, v48
    v_mfma_f32_16x16x32_f16 v[104:107], a[44:47], v[140:143], v[104:107]
    v_cvt_pkrtz_f16_f32 v207, v226, v227
    v_fma_f32 v186, |v97|, v49, v186
    v_mfma_f32_16x16x32_f16 v[108:111], a[48:51], v[128:131], v[28:31]
    v_max3_f32 v249, v249, |v226|, |v227|
    v_fma_f32 v186, |v98|, v50, v186
    v_mfma_f32_16x16x32_f16 v[108:111], a[52:55], v[132:135], v[108:111]
    ds_write_b128 v203, v[204:207] offset:4608
    v_mfma_f32_16x16x32_f16 v[108:111], a[56:59], v[136:139], v[108:111]
    s_waitcnt vmcnt(1)
    v_lshl_add_u32 v220, v164, 16, s48
    v_fma_f32 v186, |v99|, v51, v186
    v_mfma_f32_16x16x32_f16 v[108:111], a[60:63], v[140:143], v[108:111]
    s_waitcnt lgkmcnt(1)
    v_pk_mul_f16 v144, v144, v80
    v_fma_f32 v186, |v100|, v52, v186
    v_mfma_f32_16x16x32_f16 v[112:115], a[64:67], v[128:131], v[32:35]
    v_pk_mul_f16 v145, v145, v81
    v_fma_f32 v186, |v101|, v53, v186
    v_mfma_f32_16x16x32_f16 v[112:115], a[68:71], v[132:135], v[112:115]
    v_pk_mul_f16 v146, v146, v82
    v_fma_f32 v186, |v102|, v54, v186
    v_mfma_f32_16x16x32_f16 v[112:115], a[72:75], v[136:139], v[112:115]
    v_pk_mul_f16 v147, v147, v83
    v_fma_f32 v186, |v103|, v55, v186
    v_mfma_f32_16x16x32_f16 v[112:115], a[76:79], v[140:143], v[112:115]
    v_pk_mul_f16 v148, v148, v84
    v_fma_f32 v186, |v104|, v56, v186
    v_mfma_f32_16x16x32_f16 v[116:119], a[80:83], v[128:131], v[36:39]
    v_pk_mul_f16 v149, v149, v85
    v_fma_f32 v186, |v105|, v57, v186
    v_mfma_f32_16x16x32_f16 v[116:119], a[84:87], v[132:135], v[116:119]
    v_pk_mul_f16 v150, v150, v86
    v_fma_f32 v186, |v106|, v58, v186
    v_mfma_f32_16x16x32_f16 v[116:119], a[88:91], v[136:139], v[116:119]
    v_pk_mul_f16 v151, v151, v87
    v_fma_f32 v186, |v107|, v59, v186
    v_mfma_f32_16x16x32_f16 v[116:119], a[92:95], v[140:143], v[116:119]
    v_pk_mul_f16 v152, v152, v88
    v_fma_f32 v186, |v108|, v60, v186
    v_mfma_f32_16x16x32_f16 v[120:123], a[96:99], v[128:131], v[40:43]
    v_pk_mul_f16 v153, v153, v89
    v_fma_f32 v186, |v109|, v61, v186
    v_mfma_f32_16x16x32_f16 v[120:123], a[100:103], v[132:135], v[120:123]
    v_pk_mul_f16 v154, v154, v90
    v_fma_f32 v186, |v110|, v62, v186
    v_mfma_f32_16x16x32_f16 v[120:123], a[104:107], v[136:139], v[120:123]
    v_pk_mul_f16 v155, v155, v91
    v_fma_f32 v186, |v111|, v63, v186
    v_mfma_f32_16x16x32_f16 v[120:123], a[108:111], v[140:143], v[120:123]
    v_pk_mul_f16 v156, v156, v92
    v_fma_f32 v186, |v112|, v64, v186
    v_mfma_f32_16x16x32_f16 v[124:127], a[112:115], v[128:131], v[44:47]
    v_pk_mul_f16 v157, v157, v93
    v_fma_f32 v186, |v113|, v65, v186
    v_mfma_f32_16x16x32_f16 v[124:127], a[116:119], v[132:135], v[124:127]
    v_pk_mul_f16 v158, v158, v94
    v_fma_f32 v186, |v114|, v66, v186
    v_mfma_f32_16x16x32_f16 v[124:127], a[120:123], v[136:139], v[124:127]
    v_pk_mul_f16 v159, v159, v95
    v_fma_f32 v186, |v115|, v67, v186
    v_mfma_f32_16x16x32_f16 v[124:127], a[124:127], v[140:143], v[124:127]
    v_mov_b32_dpp v247, v246 row_ror:11 row_mask:0xf bank_mask:0xf
    v_fma_f32 v186, |v116|, v68, v186
    v_mfma_f32_16x16x32_f16 v[96:99], a[0:3], v[144:147], v[16:19]
    ds_read_b128 v[140:143], v247 offset:192
    v_fma_f32 v186, |v117|, v69, v186
    v_mfma_f32_16x16x32_f16 v[96:99], a[4:7], v[148:151], v[96:99]
    ds_read_b128 v[136:139], v247 offset:128
    v_fma_f32 v186, |v118|, v70, v186
    v_mfma_f32_16x16x32_f16 v[96:99], a[8:11], v[152:155], v[96:99]
    ds_read_b128 v[132:135], v247 offset:64
    v_fma_f32 v186, |v119|, v71, v186
    v_mfma_f32_16x16x32_f16 v[96:99], a[12:15], v[156:159], v[96:99]
    ds_read_b128 v[128:131], v247 offset:0
    v_fma_f32 v186, |v120|, v72, v186
    v_mfma_f32_16x16x32_f16 v[100:103], a[16:19], v[144:147], v[20:23]
    v_add_u32_sdwa v221, v164, s49 dst_sel:WORD_1 dst_unused:UNUSED_PAD src0_sel:WORD_1 src1_sel:DWORD
    v_fma_f32 v186, |v121|, v73, v186
    v_mfma_f32_16x16x32_f16 v[100:103], a[20:23], v[148:151], v[100:103]
    v_lshl_add_u32 v222, v165, 16, s48
    v_fma_f32 v186, |v122|, v74, v186
    v_mfma_f32_16x16x32_f16 v[100:103], a[24:27], v[152:155], v[100:103]
    v_add_u32_sdwa v223, v165, s49 dst_sel:WORD_1 dst_unused:UNUSED_PAD src0_sel:WORD_1 src1_sel:DWORD
    v_fma_f32 v186, |v123|, v75, v186
    v_mfma_f32_16x16x32_f16 v[100:103], a[28:31], v[156:159], v[100:103]
    v_lshl_add_u32 v224, v166, 16, s48
    v_fma_f32 v186, |v124|, v76, v186
    v_mfma_f32_16x16x32_f16 v[104:107], a[32:35], v[144:147], v[24:27]
    v_add_u32_sdwa v225, v166, s49 dst_sel:WORD_1 dst_unused:UNUSED_PAD src0_sel:WORD_1 src1_sel:DWORD
    v_fma_f32 v186, |v125|, v77, v186
    v_mfma_f32_16x16x32_f16 v[104:107], a[36:39], v[148:151], v[104:107]
    v_lshl_add_u32 v226, v167, 16, s48
    v_fma_f32 v186, |v126|, v78, v186
    v_mfma_f32_16x16x32_f16 v[104:107], a[40:43], v[152:155], v[104:107]
    v_add_u32_sdwa v227, v167, s49 dst_sel:WORD_1 dst_unused:UNUSED_PAD src0_sel:WORD_1 src1_sel:DWORD
    v_fma_f32 v186, |v127|, v79, v186
    v_mfma_f32_16x16x32_f16 v[104:107], a[44:47], v[156:159], v[104:107]
    v_cvt_pkrtz_f16_f32 v208, v220, v221
    v_mul_f32 v187, |v96|, v48
    v_mfma_f32_16x16x32_f16 v[108:111], a[48:51], v[144:147], v[28:31]
    v_max3_f32 v248, v248, |v220|, |v221|
    v_fma_f32 v187, |v97|, v49, v187
    v_mfma_f32_16x16x32_f16 v[108:111], a[52:55], v[148:151], v[108:111]
    v_cvt_pkrtz_f16_f32 v209, v222, v223
    v_fma_f32 v187, |v98|, v50, v187
    v_mfma_f32_16x16x32_f16 v[108:111], a[56:59], v[152:155], v[108:111]
    v_max3_f32 v249, v249, |v222|, |v223|
    v_fma_f32 v187, |v99|, v51, v187
    v_mfma_f32_16x16x32_f16 v[108:111], a[60:63], v[156:159], v[108:111]
    s_waitcnt lgkmcnt(0)
    v_pk_mul_f16 v128, v128, v80
    v_fma_f32 v187, |v100|, v52, v187
    v_mfma_f32_16x16x32_f16 v[112:115], a[64:67], v[144:147], v[32:35]
    v_pk_mul_f16 v129, v129, v81
    v_fma_f32 v187, |v101|, v53, v187
    v_mfma_f32_16x16x32_f16 v[112:115], a[68:71], v[148:151], v[112:115]
    v_pk_mul_f16 v130, v130, v82
    v_fma_f32 v187, |v102|, v54, v187
    v_mfma_f32_16x16x32_f16 v[112:115], a[72:75], v[152:155], v[112:115]
    v_pk_mul_f16 v131, v131, v83
    v_fma_f32 v187, |v103|, v55, v187
    v_mfma_f32_16x16x32_f16 v[112:115], a[76:79], v[156:159], v[112:115]
    v_pk_mul_f16 v132, v132, v84
    v_fma_f32 v187, |v104|, v56, v187
    v_mfma_f32_16x16x32_f16 v[116:119], a[80:83], v[144:147], v[36:39]
    v_pk_mul_f16 v133, v133, v85
    v_fma_f32 v187, |v105|, v57, v187
    v_mfma_f32_16x16x32_f16 v[116:119], a[84:87], v[148:151], v[116:119]
    v_pk_mul_f16 v134, v134, v86
    v_fma_f32 v187, |v106|, v58, v187
    v_mfma_f32_16x16x32_f16 v[116:119], a[88:91], v[152:155], v[116:119]
    v_pk_mul_f16 v135, v135, v87
    v_fma_f32 v187, |v107|, v59, v187
    v_mfma_f32_16x16x32_f16 v[116:119], a[92:95], v[156:159], v[116:119]
    v_pk_mul_f16 v136, v136, v88
    v_fma_f32 v187, |v108|, v60, v187
    v_mfma_f32_16x16x32_f16 v[120:123], a[96:99], v[144:147], v[40:43]
    v_pk_mul_f16 v137, v137, v89
    v_fma_f32 v187, |v109|, v61, v187
    v_mfma_f32_16x16x32_f16 v[120:123], a[100:103], v[148:151], v[120:123]
    v_pk_mul_f16 v138, v138, v90
    v_fma_f32 v187, |v110|, v62, v187
    v_mfma_f32_16x16x32_f16 v[120:123], a[104:107], v[152:155], v[120:123]
    v_pk_mul_f16 v139, v139, v91
    v_fma_f32 v187, |v111|, v63, v187
    v_mfma_f32_16x16x32_f16 v[120:123], a[108:111], v[156:159], v[120:123]
    v_pk_mul_f16 v140, v140, v92
    v_fma_f32 v187, |v112|, v64, v187
    v_mfma_f32_16x16x32_f16 v[124:127], a[112:115], v[144:147], v[44:47]
    v_pk_mul_f16 v141, v141, v93
    v_fma_f32 v187, |v113|, v65, v187
    v_mfma_f32_16x16x32_f16 v[124:127], a[116:119], v[148:151], v[124:127]
    v_pk_mul_f16 v142, v142, v94
    v_fma_f32 v187, |v114|, v66, v187
    v_mfma_f32_16x16x32_f16 v[124:127], a[120:123], v[152:155], v[124:127]
    v_pk_mul_f16 v143, v143, v95
    v_fma_f32 v187, |v115|, v67, v187
    v_mfma_f32_16x16x32_f16 v[124:127], a[124:127], v[156:159], v[124:127]
    v_mov_b32_dpp v247, v246 row_ror:10 row_mask:0xf bank_mask:0xf
    v_fma_f32 v187, |v116|, v68, v187
    v_mfma_f32_16x16x32_f16 v[96:99], a[0:3], v[128:131], v[16:19]
    ds_read_b128 v[156:159], v247 offset:192
    v_fma_f32 v187, |v117|, v69, v187
    v_mfma_f32_16x16x32_f16 v[96:99], a[4:7], v[132:135], v[96:99]
    ds_read_b128 v[152:155], v247 offset:128
    v_fma_f32 v187, |v118|, v70, v187
    v_mfma_f32_16x16x32_f16 v[96:99], a[8:11], v[136:139], v[96:99]
    ds_read_b128 v[148:151], v247 offset:64
    v_fma_f32 v187, |v119|, v71, v187
    v_mfma_f32_16x16x32_f16 v[96:99], a[12:15], v[140:143], v[96:99]
    ds_read_b128 v[144:147], v247 offset:0
    v_fma_f32 v187, |v120|, v72, v187
    v_mfma_f32_16x16x32_f16 v[100:103], a[16:19], v[128:131], v[20:23]
    v_cvt_pkrtz_f16_f32 v210, v224, v225
    v_fma_f32 v187, |v121|, v73, v187
    v_mfma_f32_16x16x32_f16 v[100:103], a[20:23], v[132:135], v[100:103]
    v_max3_f32 v248, v248, |v224|, |v225|
    v_fma_f32 v187, |v122|, v74, v187
    v_mfma_f32_16x16x32_f16 v[100:103], a[24:27], v[136:139], v[100:103]
    v_cvt_pkrtz_f16_f32 v211, v226, v227
    v_fma_f32 v187, |v123|, v75, v187
    v_mfma_f32_16x16x32_f16 v[100:103], a[28:31], v[140:143], v[100:103]
    v_max3_f32 v249, v249, |v226|, |v227|
    v_fma_f32 v187, |v124|, v76, v187
    v_mfma_f32_16x16x32_f16 v[104:107], a[32:35], v[128:131], v[24:27]
    ds_write_b128 v203, v[208:211] offset:5472
    v_mfma_f32_16x16x32_f16 v[104:107], a[36:39], v[132:135], v[104:107]
    s_waitcnt vmcnt(0)
    v_lshl_add_u32 v220, v168, 16, s48
    v_fma_f32 v187, |v125|, v77, v187
    v_mfma_f32_16x16x32_f16 v[104:107], a[40:43], v[136:139], v[104:107]
    v_add_u32_sdwa v221, v168, s49 dst_sel:WORD_1 dst_unused:UNUSED_PAD src0_sel:WORD_1 src1_sel:DWORD
    v_fma_f32 v187, |v126|, v78, v187
    v_mfma_f32_16x16x32_f16 v[104:107], a[44:47], v[140:143], v[104:107]
    v_lshl_add_u32 v222, v169, 16, s48
    v_fma_f32 v187, |v127|, v79, v187
    v_mfma_f32_16x16x32_f16 v[108:111], a[48:51], v[128:131], v[28:31]
    v_add_u32_sdwa v223, v169, s49 dst_sel:WORD_1 dst_unused:UNUSED_PAD src0_sel:WORD_1 src1_sel:DWORD
    v_mul_f32 v188, |v96|, v48
    v_mfma_f32_16x16x32_f16 v[108:111], a[52:55], v[132:135], v[108:111]
    v_lshl_add_u32 v224, v170, 16, s48
    v_fma_f32 v188, |v97|, v49, v188
    v_mfma_f32_16x16x32_f16 v[108:111], a[56:59], v[136:139], v[108:111]
    v_add_u32_sdwa v225, v170, s49 dst_sel:WORD_1 dst_unused:UNUSED_PAD src0_sel:WORD_1 src1_sel:DWORD
    v_fma_f32 v188, |v98|, v50, v188
    v_mfma_f32_16x16x32_f16 v[108:111], a[60:63], v[140:143], v[108:111]
    s_waitcnt lgkmcnt(1)
    v_pk_mul_f16 v144, v144, v80
    v_fma_f32 v188, |v99|, v51, v188
    v_mfma_f32_16x16x32_f16 v[112:115], a[64:67], v[128:131], v[32:35]
    v_pk_mul_f16 v145, v145, v81
    v_fma_f32 v188, |v100|, v52, v188
    v_mfma_f32_16x16x32_f16 v[112:115], a[68:71], v[132:135], v[112:115]
    v_pk_mul_f16 v146, v146, v82
    v_fma_f32 v188, |v101|, v53, v188
    v_mfma_f32_16x16x32_f16 v[112:115], a[72:75], v[136:139], v[112:115]
    v_pk_mul_f16 v147, v147, v83
    v_fma_f32 v188, |v102|, v54, v188
    v_mfma_f32_16x16x32_f16 v[112:115], a[76:79], v[140:143], v[112:115]
    v_pk_mul_f16 v148, v148, v84
    v_fma_f32 v188, |v103|, v55, v188
    v_mfma_f32_16x16x32_f16 v[116:119], a[80:83], v[128:131], v[36:39]
    v_pk_mul_f16 v149, v149, v85
    v_fma_f32 v188, |v104|, v56, v188
    v_mfma_f32_16x16x32_f16 v[116:119], a[84:87], v[132:135], v[116:119]
    v_pk_mul_f16 v150, v150, v86
    v_fma_f32 v188, |v105|, v57, v188
    v_mfma_f32_16x16x32_f16 v[116:119], a[88:91], v[136:139], v[116:119]
    v_pk_mul_f16 v151, v151, v87
    v_fma_f32 v188, |v106|, v58, v188
    v_mfma_f32_16x16x32_f16 v[116:119], a[92:95], v[140:143], v[116:119]
    v_pk_mul_f16 v152, v152, v88
    v_fma_f32 v188, |v107|, v59, v188
    v_mfma_f32_16x16x32_f16 v[120:123], a[96:99], v[128:131], v[40:43]
    v_pk_mul_f16 v153, v153, v89
    v_fma_f32 v188, |v108|, v60, v188
    v_mfma_f32_16x16x32_f16 v[120:123], a[100:103], v[132:135], v[120:123]
    v_pk_mul_f16 v154, v154, v90
    v_fma_f32 v188, |v109|, v61, v188
    v_mfma_f32_16x16x32_f16 v[120:123], a[104:107], v[136:139], v[120:123]
    v_pk_mul_f16 v155, v155, v91
    v_fma_f32 v188, |v110|, v62, v188
    v_mfma_f32_16x16x32_f16 v[120:123], a[108:111], v[140:143], v[120:123]
    v_pk_mul_f16 v156, v156, v92
    v_fma_f32 v188, |v111|, v63, v188
    v_mfma_f32_16x16x32_f16 v[124:127], a[112:115], v[128:131], v[44:47]
    v_pk_mul_f16 v157, v157, v93
    v_fma_f32 v188, |v112|, v64, v188
    v_mfma_f32_16x16x32_f16 v[124:127], a[116:119], v[132:135], v[124:127]
    v_pk_mul_f16 v158, v158, v94
    v_fma_f32 v188, |v113|, v65, v188
    v_mfma_f32_16x16x32_f16 v[124:127], a[120:123], v[136:139], v[124:127]
    v_pk_mul_f16 v159, v159, v95
    v_fma_f32 v188, |v114|, v66, v188
    v_mfma_f32_16x16x32_f16 v[124:127], a[124:127], v[140:143], v[124:127]
    v_mov_b32_dpp v247, v246 row_ror:9 row_mask:0xf bank_mask:0xf
    v_fma_f32 v188, |v115|, v67, v188
    v_mfma_f32_16x16x32_f16 v[96:99], a[0:3], v[144:147], v[16:19]
    ds_read_b128 v[140:143], v247 offset:192
    v_fma_f32 v188, |v116|, v68, v188
    v_mfma_f32_16x16x32_f16 v[96:99], a[4:7], v[148:151], v[96:99]
    ds_read_b128 v[136:139], v247 offset:128
    v_fma_f32 v188, |v117|, v69, v188
    v_mfma_f32_16x16x32_f16 v[96:99], a[8:11], v[152:155], v[96:99]
    ds_read_b128 v[132:135], v247 offset:64
    v_fma_f32 v188, |v118|, v70, v188
    v_mfma_f32_16x16x32_f16 v[96:99], a[12:15], v[156:159], v[96:99]
    ds_read_b128 v[128:131], v247 offset:0
    v_fma_f32 v188, |v119|, v71, v188
    v_mfma_f32_16x16x32_f16 v[100:103], a[16:19], v[144:147], v[20:23]
    v_lshl_add_u32 v226, v171, 16, s48
    v_fma_f32 v188, |v120|, v72, v188
    v_mfma_f32_16x16x32_f16 v[100:103], a[20:23], v[148:151], v[100:103]
    v_add_u32_sdwa v227, v171, s49 dst_sel:WORD_1 dst_unused:UNUSED_PAD src0_sel:WORD_1 src1_sel:DWORD
    v_fma_f32 v188, |v121|, v73, v188
    v_mfma_f32_16x16x32_f16 v[100:103], a[24:27], v[152:155], v[100:103]
    v_cvt_pkrtz_f16_f32 v212, v220, v221
    v_fma_f32 v188, |v122|, v74, v188
    v_mfma_f32_16x16x32_f16 v[100:103], a[28:31], v[156:159], v[100:103]
    v_max3_f32 v248, v248, |v220|, |v221|
    v_fma_f32 v188, |v123|, v75, v188
    v_mfma_f32_16x16x32_f16 v[104:107], a[32:35], v[144:147], v[24:27]
    v_cvt_pkrtz_f16_f32 v213, v222, v223
    v_fma_f32 v188, |v124|, v76, v188
    v_mfma_f32_16x16x32_f16 v[104:107], a[36:39], v[148:151], v[104:107]
    v_max3_f32 v249, v249, |v222|, |v223|
    v_fma_f32 v188, |v125|, v77, v188
    v_mfma_f32_16x16x32_f16 v[104:107], a[40:43], v[152:155], v[104:107]
    v_cvt_pkrtz_f16_f32 v214, v224, v225
    v_fma_f32 v188, |v126|, v78, v188
    v_mfma_f32_16x16x32_f16 v[104:107], a[44:47], v[156:159], v[104:107]
    v_max3_f32 v248, v248, |v224|, |v225|
    v_fma_f32 v188, |v127|, v79, v188
    v_mfma_f32_16x16x32_f16 v[108:111], a[48:51], v[144:147], v[28:31]
    v_cvt_pkrtz_f16_f32 v215, v226, v227
    v_mul_f32 v189, |v96|, v48
    v_mfma_f32_16x16x32_f16 v[108:111], a[52:55], v[148:151], v[108:111]
    v_max3_f32 v249, v249, |v226|, |v227|
    v_fma_f32 v189, |v97|, v49, v189
    v_mfma_f32_16x16x32_f16 v[108:111], a[56:59], v[152:155], v[108:111]
    ds_write_b128 v203, v[212:215] offset:6336
    v_mfma_f32_16x16x32_f16 v[108:111], a[60:63], v[156:159], v[108:111]
    s_waitcnt lgkmcnt(1)
    v_pk_mul_f16 v128, v128, v80
    v_fma_f32 v189, |v98|, v50, v189
    v_mfma_f32_16x16x32_f16 v[112:115], a[64:67], v[144:147], v[32:35]
    v_pk_mul_f16 v129, v129, v81
    v_fma_f32 v189, |v99|, v51, v189
    v_mfma_f32_16x16x32_f16 v[112:115], a[68:71], v[148:151], v[112:115]
    v_pk_mul_f16 v130, v130, v82
    v_fma_f32 v189, |v100|, v52, v189
    v_mfma_f32_16x16x32_f16 v[112:115], a[72:75], v[152:155], v[112:115]
    v_pk_mul_f16 v131, v131, v83
    v_fma_f32 v189, |v101|, v53, v189
    v_mfma_f32_16x16x32_f16 v[112:115], a[76:79], v[156:159], v[112:115]
    v_pk_mul_f16 v132, v132, v84
    v_fma_f32 v189, |v102|, v54, v189
    v_mfma_f32_16x16x32_f16 v[116:119], a[80:83], v[144:147], v[36:39]
    v_pk_mul_f16 v133, v133, v85
    v_fma_f32 v189, |v103|, v55, v189
    v_mfma_f32_16x16x32_f16 v[116:119], a[84:87], v[148:151], v[116:119]
    v_pk_mul_f16 v134, v134, v86
    v_fma_f32 v189, |v104|, v56, v189
    v_mfma_f32_16x16x32_f16 v[116:119], a[88:91], v[152:155], v[116:119]
    v_pk_mul_f16 v135, v135, v87
    v_fma_f32 v189, |v105|, v57, v189
    v_mfma_f32_16x16x32_f16 v[116:119], a[92:95], v[156:159], v[116:119]
    v_pk_mul_f16 v136, v136, v88
    v_fma_f32 v189, |v106|, v58, v189
    v_mfma_f32_16x16x32_f16 v[120:123], a[96:99], v[144:147], v[40:43]
    v_pk_mul_f16 v137, v137, v89
    v_fma_f32 v189, |v107|, v59, v189
    v_mfma_f32_16x16x32_f16 v[120:123], a[100:103], v[148:151], v[120:123]
    v_pk_mul_f16 v138, v138, v90
    v_fma_f32 v189, |v108|, v60, v189
    v_mfma_f32_16x16x32_f16 v[120:123], a[104:107], v[152:155], v[120:123]
    v_pk_mul_f16 v139, v139, v91
    v_fma_f32 v189, |v109|, v61, v189
    v_mfma_f32_16x16x32_f16 v[120:123], a[108:111], v[156:159], v[120:123]
    v_pk_mul_f16 v140, v140, v92
    v_fma_f32 v189, |v110|, v62, v189
    v_mfma_f32_16x16x32_f16 v[124:127], a[112:115], v[144:147], v[44:47]
    v_pk_mul_f16 v141, v141, v93
    v_fma_f32 v189, |v111|, v63, v189
    v_mfma_f32_16x16x32_f16 v[124:127], a[116:119], v[148:151], v[124:127]
    v_pk_mul_f16 v142, v142, v94
    v_fma_f32 v189, |v112|, v64, v189
    v_mfma_f32_16x16x32_f16 v[124:127], a[120:123], v[152:155], v[124:127]
    v_pk_mul_f16 v143, v143, v95
    v_fma_f32 v189, |v113|, v65, v189
    v_mfma_f32_16x16x32_f16 v[124:127], a[124:127], v[156:159], v[124:127]
    v_mov_b32_dpp v247, v246 row_ror:8 row_mask:0xf bank_mask:0xf
    v_fma_f32 v189, |v114|, v66, v189
    v_mfma_f32_16x16x32_f16 v[96:99], a[0:3], v[128:131], v[16:19]
    ds_read_b128 v[156:159], v247 offset:192
    v_fma_f32 v189, |v115|, v67, v189
    v_mfma_f32_16x16x32_f16 v[96:99], a[4:7], v[132:135], v[96:99]
    ds_read_b128 v[152:155], v247 offset:128
    v_fma_f32 v189, |v116|, v68, v189
    v_mfma_f32_16x16x32_f16 v[96:99], a[8:11], v[136:139], v[96:99]
    ds_read_b128 v[148:151], v247 offset:64
    v_fma_f32 v189, |v117|, v69, v189
    v_mfma_f32_16x16x32_f16 v[96:99], a[12:15], v[140:143], v[96:99]
    ds_read_b128 v[144:147], v247 offset:0
    v_fma_f32 v189, |v118|, v70, v189
    v_mfma_f32_16x16x32_f16 v[100:103], a[16:19], v[128:131], v[20:23]
    v_max_f32 v248, v248, v249
    v_fma_f32 v189, |v119|, v71, v189
    v_mfma_f32_16x16x32_f16 v[100:103], a[20:23], v[132:135], v[100:103]
    v_cmp_le_f32 vcc, s50, v248
    v_fma_f32 v189, |v120|, v72, v189
    v_mfma_f32_16x16x32_f16 v[100:103], a[24:27], v[136:139], v[100:103]
    v_cmp_nlt_f32 s[92:93], v248, s51
    v_fma_f32 v189, |v121|, v73, v189
    v_mfma_f32_16x16x32_f16 v[100:103], a[28:31], v[140:143], v[100:103]
    s_cbranch_vccnz L_efix
    v_mfma_f32_16x16x32_f16 v[104:107], a[32:35], v[128:131], v[24:27]
    s_cmp_eq_u64 s[92:93], 0
    s_cbranch_scc1 L_efix
    v_mfma_f32_16x16x32_f16 v[104:107], a[36:39], v[132:135], v[104:107]
    ds_read_b128 v[204:207], v202 offset:4608
    v_fma_f32 v189, |v122|, v74, v189
    v_mfma_f32_16x16x32_f16 v[104:107], a[40:43], v[136:139], v[104:107]
    ds_read_b128 v[208:211], v202 offset:4672
    v_fma_f32 v189, |v123|, v75, v189
    v_mfma_f32_16x16x32_f16 v[104:107], a[44:47], v[140:143], v[104:107]
    ds_read_b128 v[212:215], v202 offset:4736
    v_fma_f32 v189, |v124|, v76, v189
    v_mfma_f32_16x16x32_f16 v[108:111], a[48:51], v[128:131], v[28:31]
    ds_read_b128 v[216:219], v202 offset:4800
    v_fma_f32 v189, |v125|, v77, v189
    v_mfma_f32_16x16x32_f16 v[108:111], a[52:55], v[132:135], v[108:111]
    v_add_u32_sdwa v11, v238, s5 dst_sel:DWORD dst_unused:UNUSED_PAD src0_sel:WORD_1 src1_sel:DWORD
    v_fma_f32 v189, |v126|, v78, v189
    v_mfma_f32_16x16x32_f16 v[108:111], a[56:59], v[136:139], v[108:111]
L_pad1:
    s_cbranch_execz L_hopret
    v_add_u32_sdwa v238, v238, s5 dst_sel:DWORD dst_unused:UNUSED_PAD src0_sel:WORD_0 src1_sel:DWORD
    v_fma_f32 v189, |v127|, v79, v189
    v_mfma_f32_16x16x32_f16 v[108:111], a[60:63], v[140:143], v[108:111]
    s_waitcnt lgkmcnt(4)
    v_pk_mul_f16 v144, v144, v80
    v_mul_f32 v190, |v96|, v48
    v_mfma_f32_16x16x32_f16 v[112:115], a[64:67], v[128:131], v[32:35]
    v_pk_mul_f16 v145, v145, v81
    v_fma_f32 v190, |v97|, v49, v190
    v_mfma_f32_16x16x32_f16 v[112:115], a[68:71], v[132:135], v[112:115]
    v_pk_mul_f16 v146, v146, v82
    v_fma_f32 v190, |v98|, v50, v190
    v_mfma_f32_16x16x32_f16 v[112:115], a[72:75], v[136:139], v[112:115]
    v_pk_mul_f16 v147, v147, v83
    v_fma_f32 v190, |v99|, v51, v190
    v_mfma_f32_16x16x32_f16 v[112:115], a[76:79], v[140:143], v[112:115]
    v_pk_mul_f16 v148, v148, v84
    v_fma_f32 v190, |v100|, v52, v190
    v_mfma_f32_16x16x32_f16 v[116:119], a[80:83], v[128:131], v[36:39]
    v_pk_mul_f16 v149, v149, v85
    v_fma_f32 v190, |v101|, v53, v190
    v_mfma_f32_16x16x32_f16 v[116:119], a[84:87], v[132:135], v[116:119]
    v_pk_mul_f16 v150, v150, v86
    v_fma_f32 v190, |v102|, v54, v190
    v_mfma_f32_16x16x32_f16 v[116:119], a[88:91], v[136:139], v[116:119]
    v_pk_mul_f16 v151, v151, v87
    v_fma_f32 v190, |v103|, v55, v190
    v_mfma_f32_16x16x32_f16 v[116:119], a[92:95], v[140:143], v[116:119]
    v_pk_mul_f16 v152, v152, v88
    v_fma_f32 v190, |v104|, v56, v190
    v_mfma_f32_16x16x32_f16 v[120:123], a[96:99], v[128:131], v[40:43]
    v_pk_mul_f16 v153, v153, v89
    v_fma_f32 v190, |v105|, v57, v190
    v_mfma_f32_16x16x32_f16 v[120:123], a[100:103], v[132:135], v[120:123]
    v_pk_mul_f16 v154, v154, v90
    v_fma_f32 v190, |v106|, v58, v190
    v_mfma_f32_16x16x32_f16 v[120:123], a[104:107], v[136:139], v[120:123]
    v_pk_mul_f16 v155, v155, v91
    v_fma_f32 v190, |v107|, v59, v190
    v_mfma_f32_16x16x32_f16 v[120:123], a[108:111], v[140:143], v[120:123]
    v_pk_mul_f16 v156, v156, v92
    v_fma_f32 v190, |v108|, v60, v190
    v_mfma_f32_16x16x32_f16 v[124:127], a[112:115], v[128:131], v[44:47]
    v_pk_mul_f16 v157, v157, v93
    v_fma_f32 v190, |v109|, v61, v190
    v_mfma_f32_16x16x32_f16 v[124:127], a[116:119], v[132:135], v[124:127]
    v_pk_mul_f16 v158, v158, v94
    v_fma_f32 v190, |v110|, v62, v190
    v_mfma_f32_16x16x32_f16 v[124:127], a[120:123], v[136:139], v[124:127]
    v_pk_mul_f16 v159, v159, v95
    v_fma_f32 v190, |v111|, v63, v190
    v_mfma_f32_16x16x32_f16 v[124:127], a[124:127], v[140:143], v[124:127]
    v_max_u32_dpp v254, v254, v254 row_ror:4 row_mask:0xf bank_mask:0xf
    v_fma_f32 v190, |v112|, v64, v190
    v_mfma_f32_16x16x32_f16 v[96:99], a[0:3], v[144:147], v[16:19]
    ds_read_b128 v[140:143], v245 offset:4800
    v_fma_f32 v190, |v113|, v65, v190
    v_mfma_f32_16x16x32_f16 v[96:99], a[4:7], v[148:151], v[96:99]
    ds_read_b128 v[136:139], v245 offset:4736
    v_fma_f32 v190, |v114|, v66, v190
    v_mfma_f32_16x16x32_f16 v[96:99], a[8:11], v[152:155], v[96:99]
    ds_read_b128 v[132:135], v245 offset:4672
    v_fma_f32 v190, |v115|, v67, v190
    v_mfma_f32_16x16x32_f16 v[96:99], a[12:15], v[156:159], v[96:99]
    ds_read_b128 v[128:131], v245 offset:4608
    v_fma_f32 v190, |v116|, v68, v190
    v_mfma_f32_16x16x32_f16 v[100:103], a[16:19], v[144:147], v[20:23]
    v_max_u32_dpp v255, v255, v255 row_ror:4 row_mask:0xf bank_mask:0xf
    v_fma_f32 v190, |v117|, v69, v190
    v_mfma_f32_16x16x32_f16 v[100:103], a[20:23], v[148:151], v[100:103]
    v_max_u32_dpp v254, v254, v254 row_ror:2 row_mask:0xf bank_mask:0xf
    v_fma_f32 v190, |v118|, v70, v190
    v_mfma_f32_16x16x32_f16 v[100:103], a[24:27], v[152:155], v[100:103]
    v_max_u32_dpp v255, v255, v255 row_ror:2 row_mask:0xf bank_mask:0xf
    v_fma_f32 v190, |v119|, v71, v190
    v_mfma_f32_16x16x32_f16 v[100:103], a[28:31], v[156:159], v[100:103]
    v_max_u32_dpp v254, v254, v254 row_ror:1 row_mask:0xf bank_mask:0xf
    v_fma_f32 v190, |v120|, v72, v190
    v_mfma_f32_16x16x32_f16 v[104:107], a[32:35], v[144:147], v[24:27]
    v_max_u32_dpp v255, v255, v255 row_ror:1 row_mask:0xf bank_mask:0xf
    v_fma_f32 v190, |v121|, v73, v190
    v_mfma_f32_16x16x32_f16 v[104:107], a[36:39], v[148:151], v[104:107]
    v_max_u32_dpp v254, v254, v254 row_bcast:15 row_mask:0xa bank_mask:0xf
    v_fma_f32 v190, |v122|, v74, v190
    v_mfma_f32_16x16x32_f16 v[104:107], a[40:43], v[152:155], v[104:107]
    v_max_u32_dpp v255, v255, v255 row_bcast:15 row_mask:0xa bank_mask:0xf
    v_fma_f32 v190, |v123|, v75, v190
    v_mfma_f32_16x16x32_f16 v[104:107], a[44:47], v[156:159], v[104:107]
    v_max_u32_dpp v254, v254, v254 row_bcast:31 row_mask:0xc bank_mask:0xf
    v_fma_f32 v190, |v124|, v76, v190
    v_mfma_f32_16x16x32_f16 v[108:111], a[48:51], v[144:147], v[28:31]
    v_max_u32_dpp v255, v255, v255 row_bcast:31 row_mask:0xc bank_mask:0xf
    v_fma_f32 v190, |v125|, v77, v190
    v_mfma_f32_16x16x32_f16 v[108:111], a[52:55], v[148:151], v[108:111]
    v_readlane_b32 s34, v254, 63
    v_fma_f32 v190, |v126|, v78, v190
    v_mfma_f32_16x16x32_f16 v[108:111], a[56:59], v[152:155], v[108:111]
    v_readlane_b32 s35, v255, 63
    s_bfe_u32 s34, s34, 0x80007
    v_fma_f32 v190, |v127|, v79, v190
    v_mfma_f32_16x16x32_f16 v[108:111], a[60:63], v[156:159], v[108:111]
    s_waitcnt lgkmcnt(0)
    v_pk_mul_f16 v128, v128, v80
    s_max_u32 s34, s34, 60
    v_mul_f32 v191, |v96|, v48
    v_mfma_f32_16x16x32_f16 v[112:115], a[64:67], v[144:147], v[32:35]
    v_pk_mul_f16 v129, v129, v81
    s_sub_u32 s11, s34, 134
    v_fma_f32 v191, |v97|, v49, v191
    v_mfma_f32_16x16x32_f16 v[112:115], a[68:71], v[148:151], v[112:115]
    v_pk_mul_f16 v130, v130, v82
    s_sub_u32 s11, s11, s54
    v_fma_f32 v191, |v98|, v50, v191
    v_mfma_f32_16x16x32_f16 v[112:115], a[72:75], v[152:155], v[112:115]
    v_pk_mul_f16 v131, v131, v83
    s_sub_u32 s34, s34, 22
    v_fma_f32 v191, |v99|, v51, v191
    v_mfma_f32_16x16x32_f16 v[112:115], a[76:79], v[156:159], v[112:115]
    v_pk_mul_f16 v132, v132, v84
    s_mul_i32 s10, s34, 0x800080
    v_fma_f32 v191, |v100|, v52, v191
    v_mfma_f32_16x16x32_f16 v[116:119], a[80:83], v[144:147], v[36:39]
    v_pk_mul_f16 v133, v133, v85
    s_lshr_b32 s35, s35, 23
    v_fma_f32 v191, |v101|, v53, v191
    v_mfma_f32_16x16x32_f16 v[116:119], a[84:87], v[148:151], v[116:119]
    v_pk_mul_f16 v134, v134, v86
    s_max_u32 s35, s35, 60
    v_fma_f32 v191, |v102|, v54, v191
    v_mfma_f32_16x16x32_f16 v[116:119], a[88:91], v[152:155], v[116:119]
    v_pk_mul_f16 v135, v135, v87
    s_sub_u32 s34, 134, s35
    v_fma_f32 v191, |v103|, v55, v191
    v_mfma_f32_16x16x32_f16 v[116:119], a[92:95], v[156:159], v[116:119]
    v_pk_mul_f16 v136, v136, v88
    s_sub_u32 s35, s35, 7
    v_fma_f32 v191, |v104|, v56, v191
    v_mfma_f32_16x16x32_f16 v[120:123], a[96:99], v[144:147], v[40:43]
    v_pk_mul_f16 v137, v137, v89
    s_lshl_b32 s12, s35, 23
    v_fma_f32 v191, |v105|, v57, v191
    v_mfma_f32_16x16x32_f16 v[120:123], a[100:103], v[148:151], v[120:123]
    v_pk_mul_f16 v138, v138, v90
    v_fma_f32 v191, |v106|, v58, v191
    v_mfma_f32_16x16x32_f16 v[120:123], a[104:107], v[152:155], v[120:123]
    v_pk_mul_f16 v139, v139, v91
    v_fma_f32 v191, |v107|, v59, v191
    v_mfma_f32_16x16x32_f16 v[120:123], a[108:111], v[156:159], v[120:123]
    v_pk_mul_f16 v140, v140, v92
    v_fma_f32 v191, |v108|, v60, v191
    v_mfma_f32_16x16x32_f16 v[124:127], a[112:115], v[144:147], v[44:47]
    v_pk_mul_f16 v141, v141, v93
    v_fma_f32 v191, |v109|, v61, v191
    v_mfma_f32_16x16x32_f16 v[124:127], a[116:119], v[148:151], v[124:127]
    v_pk_mul_f16 v142, v142, v94
    v_fma_f32 v191, |v110|, v62, v191
    v_mfma_f32_16x16x32_f16 v[124:127], a[120:123], v[152:155], v[124:127]
    v_pk_mul_f16 v143, v143, v95
    v_fma_f32 v191, |v111|, v63, v191
    v_mfma_f32_16x16x32_f16 v[124:127], a[124:127], v[156:159], v[124:127]
    v_and_b32 v254, s45, v252
    v_fma_f32 v191, |v112|, v64, v191
    v_mfma_f32_16x16x32_f16 v[96:99], a[0:3], v[128:131], v[16:19]
    ds_read_b128 v[156:159], v245 offset:5088
    v_fma_f32 v191, |v113|, v65, v191
    v_mfma_f32_16x16x32_f16 v[96:99], a[4:7], v[132:135], v[96:99]
    ds_read_b128 v[152:155], v245 offset:5024
    v_fma_f32 v191, |v114|, v66, v191
    v_mfma_f32_16x16x32_f16 v[96:99], a[8:11], v[136:139], v[96:99]
    ds_read_b128 v[148:151], v245 offset:4960
    v_fma_f32 v191, |v115|, v67, v191
    v_mfma_f32_16x16x32_f16 v[96:99], a[12:15], v[140:143], v[96:99]
    ds_read_b128 v[144:147], v245 offset:4896
    v_fma_f32 v191, |v116|, v68, v191
    v_mfma_f32_16x16x32_f16 v[100:103], a[16:19], v[128:131], v[20:23]
    v_ldexp_f32 v192, v192, s34
    v_fma_f32 v191, |v117|, v69, v191
    v_mfma_f32_16x16x32_f16 v[100:103], a[20:23], v[132:135], v[100:103]
    v_ldexp_f32 v193, v193, s34
    v_fma_f32 v191, |v118|, v70, v191
    v_mfma_f32_16x16x32_f16 v[100:103], a[24:27], v[136:139], v[100:103]
    v_pk_sub_u16 v253, v253, s10 clamp
    v_fma_f32 v191, |v119|, v71, v191
    v_mfma_f32_16x16x32_f16 v[100:103], a[28:31], v[140:143], v[100:103]
    v_cvt_pk_f16_f32 v192, v192, v193
    v_fma_f32 v191, |v120|, v72, v191
    v_mfma_f32_16x16x32_f16 v[104:107], a[32:35], v[128:131], v[24:27]
    v_lshl_or_b32 v253, v253, 3, v254
    v_fma_f32 v191, |v121|, v73, v191
    v_mfma_f32_16x16x32_f16 v[104:107], a[36:39], v[132:135], v[104:107]
    ds_write_b32 v11, v192 offset:9216
    v_mfma_f32_16x16x32_f16 v[104:107], a[40:43], v[136:139], v[104:107]
    ds_write_b32 v11, v253 offset:9504
    v_fma_f32 v191, |v122|, v74, v191
    v_mfma_f32_16x16x32_f16 v[104:107], a[44:47], v[140:143], v[104:107]
    ds_read_b128 v[172:175], v245 offset:9408
    v_fma_f32 v191, |v123|, v75, v191
    v_mfma_f32_16x16x32_f16 v[108:111], a[48:51], v[128:131], v[28:31]
    ds_read_b128 v[168:171], v245 offset:9344
    v_fma_f32 v191, |v124|, v76, v191
    v_mfma_f32_16x16x32_f16 v[108:111], a[52:55], v[132:135], v[108:111]
    ds_read_b128 v[164:167], v245 offset:9280
    v_fma_f32 v191, |v125|, v77, v191
    v_mfma_f32_16x16x32_f16 v[108:111], a[56:59], v[136:139], v[108:111]
    ds_read_b128 v[160:163], v245 offset:9216
    v_fma_f32 v191, |v126|, v78, v191
    v_mfma_f32_16x16x32_f16 v[108:111], a[60:63], v[140:143], v[108:111]
    s_waitcnt lgkmcnt(6)
    v_pk_mul_f16 v144, v144, v80
    v_fma_f32 v191, |v127|, v79, v191
    v_mfma_f32_16x16x32_f16 v[112:115], a[64:67], v[128:131], v[32:35]
    v_pk_mul_f16 v145, v145, v81
    v_mul_f32 v176, |v96|, v48
    v_mfma_f32_16x16x32_f16 v[112:115], a[68:71], v[132:135], v[112:115]
    v_pk_mul_f16 v146, v146, v82
    v_fma_f32 v176, |v97|, v49, v176
    v_mfma_f32_16x16x32_f16 v[112:115], a[72:75], v[136:139], v[112:115]
    v_pk_mul_f16 v147, v147, v83
    v_fma_f32 v176, |v98|, v50, v176
    v_mfma_f32_16x16x32_f16 v[112:115], a[76:79], v[140:143], v[112:115]
    v_pk_mul_f16 v148, v148, v84
    v_fma_f32 v176, |v99|, v51, v176
    v_mfma_f32_16x16x32_f16 v[116:119], a[80:83], v[128:131], v[36:39]
    v_pk_mul_f16 v149, v149, v85
    v_fma_f32 v176, |v100|, v52, v176
    v_mfma_f32_16x16x32_f16 v[116:119], a[84:87], v[132:135], v[116:119]
    v_pk_mul_f16 v150, v150, v86
    v_fma_f32 v176, |v101|, v53, v176
    v_mfma_f32_16x16x32_f16 v[116:119], a[88:91], v[136:139], v[116:119]
    v_pk_mul_f16 v151, v151, v87
    v_fma_f32 v176, |v102|, v54, v176
    v_mfma_f32_16x16x32_f16 v[116:119], a[92:95], v[140:143], v[116:119]
    v_pk_mul_f16 v152, v152, v88
    v_fma_f32 v176, |v103|, v55, v176
    v_mfma_f32_16x16x32_f16 v[120:123], a[96:99], v[128:131], v[40:43]
    v_pk_mul_f16 v153, v153, v89
    v_fma_f32 v176, |v104|, v56, v176
    v_mfma_f32_16x16x32_f16 v[120:123], a[100:103], v[132:135], v[120:123]
    v_pk_mul_f16 v154, v154, v90
    v_fma_f32 v176, |v105|, v57, v176
    v_mfma_f32_16x16x32_f16 v[120:123], a[104:107], v[136:139], v[120:123]
    v_pk_mul_f16 v155, v155, v91
    v_fma_f32 v176, |v106|, v58, v176
    v_mfma_f32_16x16x32_f16 v[120:123], a[108:111], v[140:143], v[120:123]
    v_pk_mul_f16 v156, v156, v92
    v_fma_f32 v176, |v107|, v59, v176
    v_mfma_f32_16x16x32_f16 v[124:127], a[112:115], v[128:131], v[44:47]
    v_pk_mul_f16 v157, v157, v93
    v_fma_f32 v176, |v108|, v60, v176
    v_mfma_f32_16x16x32_f16 v[124:127], a[116:119], v[132:135], v[124:127]
    v_pk_mul_f16 v158, v158, v94
    v_fma_f32 v176, |v109|, v61, v176
    v_mfma_f32_16x16x32_f16 v[124:127], a[120:123], v[136:139], v[124:127]
    v_pk_mul_f16 v159, v159, v95
    v_fma_f32 v176, |v110|, v62, v176
    v_mfma_f32_16x16x32_f16 v[124:127], a[124:127], v[140:143], v[124:127]
    s_waitcnt lgkmcnt(0)
    v_pk_mul_f16 v160, v160, v80
    v_fma_f32 v176, |v111|, v63, v176
    v_mfma_f32_16x16x32_f16 v[96:99], a[0:3], v[144:147], v[16:19]
    ds_read_b128 v[140:143], v245 offset:5376
    v_fma_f32 v176, |v112|, v64, v176
    v_mfma_f32_16x16x32_f16 v[96:99], a[4:7], v[148:151], v[96:99]
    ds_read_b128 v[136:139], v245 offset:5312
    v_fma_f32 v176, |v113|, v65, v176
    v_mfma_f32_16x16x32_f16 v[96:99], a[8:11], v[152:155], v[96:99]
    ds_read_b128 v[132:135], v245 offset:5248
    v_fma_f32 v176, |v114|, v66, v176
    v_mfma_f32_16x16x32_f16 v[96:99], a[12:15], v[156:159], v[96:99]
    ds_read_b128 v[128:131], v245 offset:5184
    v_fma_f32 v176, |v115|, v67, v176
    v_mfma_f32_16x16x32_f16 v[100:103], a[16:19], v[144:147], v[20:23]
    v_pk_mul_f16 v161, v161, v81
    v_fma_f32 v176, |v116|, v68, v176
    v_mfma_f32_16x16x32_f16 v[100:103], a[20:23], v[148:151], v[100:103]
    v_pk_mul_f16 v162, v162, v82
    v_fma_f32 v176, |v117|, v69, v176
    v_mfma_f32_16x16x32_f16 v[100:103], a[24:27], v[152:155], v[100:103]
    v_pk_mul_f16 v163, v163, v83
    v_fma_f32 v176, |v118|, v70, v176
    v_mfma_f32_16x16x32_f16 v[100:103], a[28:31], v[156:159], v[100:103]
    v_pk_mul_f16 v164, v164, v84
    v_fma_f32 v176, |v119|, v71, v176
    v_mfma_f32_16x16x32_f16 v[104:107], a[32:35], v[144:147], v[24:27]
    v_pk_mul_f16 v165, v165, v85
    v_fma_f32 v176, |v120|, v72, v176
    v_mfma_f32_16x16x32_f16 v[104:107], a[36:39], v[148:151], v[104:107]
    v_pk_mul_f16 v166, v166, v86
    v_fma_f32 v176, |v121|, v73, v176
    v_mfma_f32_16x16x32_f16 v[104:107], a[40:43], v[152:155], v[104:107]
    v_pk_mul_f16 v167, v167, v87
    v_fma_f32 v176, |v122|, v74, v176
    v_mfma_f32_16x16x32_f16 v[104:107], a[44:47], v[156:159], v[104:107]
    v_pk_mul_f16 v168, v168, v88
    v_fma_f32 v176, |v123|, v75, v176
    v_mfma_f32_16x16x32_f16 v[108:111], a[48:51], v[144:147], v[28:31]
    v_pk_mul_f16 v169, v169, v89
    v_fma_f32 v176, |v124|, v76, v176
    v_mfma_f32_16x16x32_f16 v[108:111], a[52:55], v[148:151], v[108:111]
    v_pk_mul_f16 v170, v170, v90
    v_fma_f32 v176, |v125|, v77, v176
    v_mfma_f32_16x16x32_f16 v[108:111], a[56:59], v[152:155], v[108:111]
    v_pk_mul_f16 v171, v171, v91
    v_fma_f32 v176, |v126|, v78, v176
    v_mfma_f32_16x16x32_f16 v[108:111], a[60:63], v[156:159], v[108:111]
    s_waitcnt lgkmcnt(0)
    v_pk_mul_f16 v128, v128, v80
    v_fma_f32 v176, |v127|, v79, v176
    v_mfma_f32_16x16x32_f16 v[112:115], a[64:67], v[144:147], v[32:35]
    v_pk_mul_f16 v129, v129, v81
    v_mul_f32 v177, |v96|, v48
    v_mfma_f32_16x16x32_f16 v[112:115], a[68:71], v[148:151], v[112:115]
    v_pk_mul_f16 v130, v130, v82
    v_fma_f32 v177, |v97|, v49, v177
    v_mfma_f32_16x16x32_f16 v[112:115], a[72:75], v[152:155], v[112:115]
    v_pk_mul_f16 v131, v131, v83
    v_fma_f32 v177, |v98|, v50, v177
    v_mfma_f32_16x16x32_f16 v[112:115], a[76:79], v[156:159], v[112:115]
    v_pk_mul_f16 v132, v132, v84
    v_fma_f32 v177, |v99|, v51, v177
    v_mfma_f32_16x16x32_f16 v[116:119], a[80:83], v[144:147], v[36:39]
    v_pk_mul_f16 v133, v133, v85
    v_fma_f32 v177, |v100|, v52, v177
    v_mfma_f32_16x16x32_f16 v[116:119], a[84:87], v[148:151], v[116:119]
    v_pk_mul_f16 v134, v134, v86
    v_fma_f32 v177, |v101|, v53, v177
    v_mfma_f32_16x16x32_f16 v[116:119], a[88:91], v[152:155], v[116:119]
    v_pk_mul_f16 v135, v135, v87
    v_fma_f32 v177, |v102|, v54, v177
    v_mfma_f32_16x16x32_f16 v[116:119], a[92:95], v[156:159], v[116:119]
    v_pk_mul_f16 v136, v136, v88
    v_fma_f32 v177, |v103|, v55, v177
    v_mfma_f32_16x16x32_f16 v[120:123], a[96:99], v[144:147], v[40:43]
    v_pk_mul_f16 v137, v137, v89
    v_fma_f32 v177, |v104|, v56, v177
    v_mfma_f32_16x16x32_f16 v[120:123], a[100:103], v[148:151], v[120:123]
    v_pk_mul_f16 v138, v138, v90
    v_fma_f32 v177, |v105|, v57, v177
    v_mfma_f32_16x16x32_f16 v[120:123], a[104:107], v[152:155], v[120:123]
    v_pk_mul_f16 v139, v139, v91
    v_fma_f32 v177, |v106|, v58, v177
    v_mfma_f32_16x16x32_f16 v[120:123], a[108:111], v[156:159], v[120:123]
    v_pk_mul_f16 v140, v140, v92
    v_fma_f32 v177, |v107|, v59, v177
    v_mfma_f32_16x16x32_f16 v[124:127], a[112:115], v[144:147], v[44:47]
    v_pk_mul_f16 v141, v141, v93
    v_fma_f32 v177, |v108|, v60, v177
    v_mfma_f32_16x16x32_f16 v[124:127], a[116:119], v[148:151], v[124:127]
    v_pk_mul_f16 v142, v142, v94
    v_fma_f32 v177, |v109|, v61, v177
    v_mfma_f32_16x16x32_f16 v[124:127], a[120:123], v[152:155], v[124:127]
    v_pk_mul_f16 v143, v143, v95
    v_fma_f32 v177, |v110|, v62, v177
    v_mfma_f32_16x16x32_f16 v[124:127], a[124:127], v[156:159], v[124:127]
    v_pk_mul_f16 v172, v172, v92
    v_fma_f32 v177, |v111|, v63, v177
    v_mfma_f32_16x16x32_f16 v[96:99], a[0:3], v[128:131], v[16:19]
    ds_read_b128 v[156:159], v245 offset:5664
    v_fma_f32 v177, |v112|, v64, v177
    v_mfma_f32_16x16x32_f16 v[96:99], a[4:7], v[132:135], v[96:99]
    ds_read_b128 v[152:155], v245 offset:5600
    v_fma_f32 v177, |v113|, v65, v177
    v_mfma_f32_16x16x32_f16 v[96:99], a[8:11], v[136:139], v[96:99]
    ds_read_b128 v[148:151], v245 offset:5536
    v_fma_f32 v177, |v114|, v66, v177
    v_mfma_f32_16x16x32_f16 v[96:99], a[12:15], v[140:143], v[96:99]
    ds_read_b128 v[144:147], v245 offset:5472
    v_fma_f32 v177, |v115|, v67, v177
    v_mfma_f32_16x16x32_f16 v[100:103], a[16:19], v[128:131], v[20:23]
    v_pk_mul_f16 v173, v173, v93
    v_fma_f32 v177, |v116|, v68, v177
    v_mfma_f32_16x16x32_f16 v[100:103], a[20:23], v[132:135], v[100:103]
    v_pk_mul_f16 v174, v174, v94
    v_fma_f32 v177, |v117|, v69, v177
    v_mfma_f32_16x16x32_f16 v[100:103], a[24:27], v[136:139], v[100:103]
    v_pk_mul_f16 v175, v175, v95
    v_fma_f32 v177, |v118|, v70, v177
    v_mfma_f32_16x16x32_f16 v[100:103], a[28:31], v[140:143], v[100:103]
    v_add_u32_sdwa v239, v232, s5 dst_sel:DWORD dst_unused:UNUSED_PAD src0_sel:WORD_1 src1_sel:DWORD
    v_fma_f32 v177, |v119|, v71, v177
    v_mfma_f32_16x16x32_f16 v[220:223], v[160:163], v[80:83], 0
    v_add_u32_sdwa v232, v232, s5 dst_sel:DWORD dst_unused:UNUSED_PAD src0_sel:WORD_0 src1_sel:DWORD
    v_fma_f32 v177, |v120|, v72, v177
    v_mfma_f32_16x16x32_f16 v[220:223], v[164:167], v[84:87], v[220:223]
    v_add_u32_sdwa v240, v233, s5 dst_sel:DWORD dst_unused:UNUSED_PAD src0_sel:WORD_1 src1_sel:DWORD
    v_fma_f32 v177, |v121|, v73, v177
    v_mfma_f32_16x16x32_f16 v[220:223], v[168:171], v[88:91], v[220:223]
    v_add_u32_sdwa v233, v233, s5 dst_sel:DWORD dst_unused:UNUSED_PAD src0_sel:WORD_0 src1_sel:DWORD
    v_fma_f32 v177, |v122|, v74, v177
    v_mfma_f32_16x16x32_f16 v[220:223], v[172:175], v[92:95], v[220:223]
    v_add_u32_sdwa v241, v234, s5 dst_sel:DWORD dst_unused:UNUSED_PAD src0_sel:WORD_1 src1_sel:DWORD
    v_fma_f32 v177, |v123|, v75, v177
    v_mfma_f32_16x16x32_f16 v[224:227], v[160:163], v[204:207], 0
    s_waitcnt lgkmcnt(0)
    v_pk_mul_f16 v144, v144, v80
    v_fma_f32 v177, |v124|, v76, v177
    v_mfma_f32_16x16x32_f16 v[224:227], v[164:167], v[208:211], v[224:227]
    v_pk_mul_f16 v145, v145, v81
    v_fma_f32 v177, |v125|, v77, v177
    v_mfma_f32_16x16x32_f16 v[224:227], v[168:171], v[212:215], v[224:227]
    v_pk_mul_f16 v146, v146, v82
    v_fma_f32 v177, |v126|, v78, v177
    v_mfma_f32_16x16x32_f16 v[224:227], v[172:175], v[216:219], v[224:227]
    ds_read_b128 v[172:175], v245 offset:9696
    v_fma_f32 v177, |v127|, v79, v177
    v_mfma_f32_16x16x32_f16 v[104:107], a[32:35], v[128:131], v[24:27]
    ds_read_b128 v[168:171], v245 offset:9632
    v_mul_f32 v178, |v96|, v48
    v_mfma_f32_16x16x32_f16 v[104:107], a[36:39], v[132:135], v[104:107]
    ds_read_b128 v[164:167], v245 offset:9568
    v_fma_f32 v178, |v97|, v49, v178
    v_mfma_f32_16x16x32_f16 v[104:107], a[40:43], v[136:139], v[104:107]
    ds_write_b128 v238, v[220:223] offset:0
    v_mfma_f32_16x16x32_f16 v[104:107], a[44:47], v[140:143], v[104:107]
    ds_write_b128 v238, v[224:227] offset:2304
    v_mfma_f32_16x16x32_f16 v[108:111], a[48:51], v[128:131], v[28:31]
    ds_read_b128 v[160:163], v245 offset:9504
    v_fma_f32 v178, |v98|, v50, v178
    v_mfma_f32_16x16x32_f16 v[108:111], a[52:55], v[132:135], v[108:111]
    v_pk_mul_f16 v147, v147, v83
    v_fma_f32 v178, |v99|, v51, v178
    v_mfma_f32_16x16x32_f16 v[108:111], a[56:59], v[136:139], v[108:111]
    v_pk_mul_f16 v148, v148, v84
    v_fma_f32 v178, |v100|, v52, v178
    v_mfma_f32_16x16x32_f16 v[108:111], a[60:63], v[140:143], v[108:111]
    v_pk_mul_f16 v149, v149, v85
    v_fma_f32 v178, |v101|, v53, v178
    v_mfma_f32_16x16x32_f16 v[112:115], a[64:67], v[128:131], v[32:35]
    v_pk_mul_f16 v150, v150, v86
    v_fma_f32 v178, |v102|, v54, v178
    v_mfma_f32_16x16x32_f16 v[112:115], a[68:71], v[132:135], v[112:115]
    v_pk_mul_f16 v151, v151, v87
    v_fma_f32 v178, |v103|, v55, v178
    v_mfma_f32_16x16x32_f16 v[112:115], a[72:75], v[136:139], v[112:115]
    v_pk_mul_f16 v152, v152, v88
    v_fma_f32 v178, |v104|, v56, v178
    v_mfma_f32_16x16x32_f16 v[112:115], a[76:79], v[140:143], v[112:115]
    v_pk_mul_f16 v153, v153, v89
    v_fma_f32 v178, |v105|, v57, v178
    v_mfma_f32_16x16x32_f16 v[116:119], a[80:83], v[128:131], v[36:39]
    v_pk_mul_f16 v154, v154, v90
    v_fma_f32 v178, |v106|, v58, v178
    v_mfma_f32_16x16x32_f16 v[116:119], a[84:87], v[132:135], v[116:119]
    s_waitcnt lgkmcnt(0)
    v_pk_mul_f16 v160, v160, v80
    v_fma_f32 v178, |v107|, v59, v178
    v_mfma_f32_16x16x32_f16 v[116:119], a[88:91], v[136:139], v[116:119]
    v_pk_mul_f16 v161, v161, v81
    v_fma_f32 v178, |v108|, v60, v178
    v_mfma_f32_16x16x32_f16 v[116:119], a[92:95], v[140:143], v[116:119]
    v_pk_mul_f16 v162, v162, v82
    v_fma_f32 v178, |v109|, v61, v178
    v_mfma_f32_16x16x32_f16 v[120:123], a[96:99], v[128:131], v[40:43]
    v_pk_mul_f16 v163, v163, v83
    v_fma_f32 v178, |v110|, v62, v178
    v_mfma_f32_16x16x32_f16 v[120:123], a[100:103], v[132:135], v[120:123]
    v_pk_mul_f16 v164, v164, v84
    v_fma_f32 v178, |v111|, v63, v178
    v_mfma_f32_16x16x32_f16 v[120:123], a[104:107], v[136:139], v[120:123]
    v_pk_mul_f16 v155, v155, v91
    v_fma_f32 v178, |v112|, v64, v178
    v_mfma_f32_16x16x32_f16 v[120:123], a[108:111], v[140:143], v[120:123]
    v_pk_mul_f16 v156, v156, v92
    v_fma_f32 v178, |v113|, v65, v178
    v_mfma_f32_16x16x32_f16 v[124:127], a[112:115], v[128:131], v[44:47]
    v_pk_mul_f16 v157, v157, v93
    v_fma_f32 v178, |v114|, v66, v178
    v_mfma_f32_16x16x32_f16 v[124:127], a[116:119], v[132:135], v[124:127]
    v_pk_mul_f16 v158, v158, v94
    v_fma_f32 v178, |v115|, v67, v178
    v_mfma_f32_16x16x32_f16 v[124:127], a[120:123], v[136:139], v[124:127]
    v_pk_mul_f16 v159, v159, v95
    v_fma_f32 v178, |v116|, v68, v178
    v_mfma_f32_16x16x32_f16 v[124:127], a[124:127], v[140:143], v[124:127]
    v_pk_mul_f16 v165, v165, v85
    v_fma_f32 v178, |v117|, v69, v178
    v_mfma_f32_16x16x32_f16 v[96:99], a[0:3], v[144:147], v[16:19]
    ds_read_b128 v[140:143], v245 offset:5952
    v_fma_f32 v178, |v118|, v70, v178
    v_mfma_f32_16x16x32_f16 v[96:99], a[4:7], v[148:151], v[96:99]
    ds_read_b128 v[136:139], v245 offset:5888
    v_fma_f32 v178, |v119|, v71, v178
    v_mfma_f32_16x16x32_f16 v[96:99], a[8:11], v[152:155], v[96:99]
    ds_read_b128 v[132:135], v245 offset:5824
    v_fma_f32 v178, |v120|, v72, v178
    v_mfma_f32_16x16x32_f16 v[96:99], a[12:15], v[156:159], v[96:99]
    ds_read_b128 v[128:131], v245 offset:5760
    v_fma_f32 v178, |v121|, v73, v178
    v_mfma_f32_16x16x32_f16 v[100:103], a[16:19], v[144:147], v[20:23]
    v_pk_mul_f16 v166, v166, v86
    v_fma_f32 v178, |v122|, v74, v178
    v_mfma_f32_16x16x32_f16 v[100:103], a[20:23], v[148:151], v[100:103]
    v_pk_mul_f16 v167, v167, v87
    v_fma_f32 v178, |v123|, v75, v178
    v_mfma_f32_16x16x32_f16 v[100:103], a[24:27], v[152:155], v[100:103]
    v_pk_mul_f16 v168, v168, v88
    v_fma_f32 v178, |v124|, v76, v178
    v_mfma_f32_16x16x32_f16 v[100:103], a[28:31], v[156:159], v[100:103]
    v_pk_mul_f16 v169, v169, v89
    v_fma_f32 v178, |v125|, v77, v178
    v_mfma_f32_16x16x32_f16 v[104:107], a[32:35], v[144:147], v[24:27]
    v_pk_mul_f16 v170, v170, v90
    v_fma_f32 v178, |v126|, v78, v178
    v_mfma_f32_16x16x32_f16 v[104:107], a[36:39], v[148:151], v[104:107]
    v_pk_mul_f16 v171, v171, v91
    v_fma_f32 v178, |v127|, v79, v178
    v_mfma_f32_16x16x32_f16 v[104:107], a[40:43], v[152:155], v[104:107]
    v_pk_mul_f16 v172, v172, v92
    v_mul_f32 v179, |v96|, v48
    v_mfma_f32_16x16x32_f16 v[104:107], a[44:47], v[156:159], v[104:107]
    v_pk_mul_f16 v173, v173, v93
    v_fma_f32 v179, |v97|, v49, v179
    v_mfma_f32_16x16x32_f16 v[108:111], a[48:51], v[144:147], v[28:31]
    v_pk_mul_f16 v174, v174, v94
    v_fma_f32 v179, |v98|, v50, v179
    v_mfma_f32_16x16x32_f16 v[108:111], a[52:55], v[148:151], v[108:111]
    v_pk_mul_f16 v175, v175, v95
    v_fma_f32 v179, |v99|, v51, v179
    v_mfma_f32_16x16x32_f16 v[108:111], a[56:59], v[152:155], v[108:111]
L_pad2:
    s_cbranch_execz L_hopret
    s_waitcnt lgkmcnt(0)
    v_pk_mul_f16 v128, v128, v80
    v_fma_f32 v179, |v100|, v52, v179
    v_mfma_f32_16x16x32_f16 v[108:111], a[60:63], v[156:159], v[108:111]
    v_pk_mul_f16 v129, v129, v81
    v_fma_f32 v179, |v101|, v53, v179
    v_mfma_f32_16x16x32_f16 v[220:223], v[160:163], v[80:83], 0
    v_pk_mul_f16 v130, v130, v82
    v_fma_f32 v179, |v102|, v54, v179
    v_mfma_f32_16x16x32_f16 v[220:223], v[164:167], v[84:87], v[220:223]
    v_pk_mul_f16 v131, v131, v83
    v_fma_f32 v179, |v103|, v55, v179
    v_mfma_f32_16x16x32_f16 v[220:223], v[168:171], v[88:91], v[220:223]
    v_pk_mul_f16 v132, v132, v84
    v_fma_f32 v179, |v104|, v56, v179
    v_mfma_f32_16x16x32_f16 v[220:223], v[172:175], v[92:95], v[220:223]
    v_pk_mul_f16 v133, v133, v85
    v_fma_f32 v179, |v105|, v57, v179
    v_mfma_f32_16x16x32_f16 v[224:227], v[160:163], v[204:207], 0
    v_pk_mul_f16 v134, v134, v86
    v_fma_f32 v179, |v106|, v58, v179
    v_mfma_f32_16x16x32_f16 v[224:227], v[164:167], v[208:211], v[224:227]
    v_pk_mul_f16 v135, v135, v87
    v_fma_f32 v179, |v107|, v59, v179
    v_mfma_f32_16x16x32_f16 v[224:227], v[168:171], v[212:215], v[224:227]
    v_pk_mul_f16 v136, v136, v88
    v_pk_mul_f16 v137, v137, v89
    v_mfma_f32_16x16x32_f16 v[224:227], v[172:175], v[216:219], v[224:227]
    ds_read_b128 v[172:175], v245 offset:9408
    ds_read_b128 v[168:171], v245 offset:9344
    v_mfma_f32_16x16x32_f16 v[112:115], a[64:67], v[144:147], v[32:35]
    ds_read_b128 v[164:167], v245 offset:9280
    ds_read_b128 v[160:163], v245 offset:9216
    v_mfma_f32_16x16x32_f16 v[112:115], a[68:71], v[148:151], v[112:115]
    v_pk_mul_f16 v138, v138, v90
    v_pk_mul_f16 v139, v139, v91
    v_mfma_f32_16x16x32_f16 v[112:115], a[72:75], v[152:155], v[112:115]
    ds_write_b128 v238, v[220:223] offset:4608
    v_mfma_f32_16x16x32_f16 v[112:115], a[76:79], v[156:159], v[112:115]
    ds_write_b128 v238, v[224:227] offset:6912
    v_mfma_f32_16x16x32_f16 v[116:119], a[80:83], v[144:147], v[36:39]
    v_pk_mul_f16 v140, v140, v92
    v_fma_f32 v179, |v108|, v60, v179
    v_mfma_f32_16x16x32_f16 v[116:119], a[84:87], v[148:151], v[116:119]
    v_pk_mul_f16 v141, v141, v93
    v_fma_f32 v179, |v109|, v61, v179
    v_mfma_f32_16x16x32_f16 v[116:119], a[88:91], v[152:155], v[116:119]
    v_pk_mul_f16 v142, v142, v94
    v_fma_f32 v179, |v110|, v62, v179
    v_mfma_f32_16x16x32_f16 v[116:119], a[92:95], v[156:159], v[116:119]
    v_pk_mul_f16 v143, v143, v95
    v_fma_f32 v179, |v111|, v63, v179
    v_mfma_f32_16x16x32_f16 v[120:123], a[96:99], v[144:147], v[40:43]
    v_add_u32_sdwa v234, v234, s5 dst_sel:DWORD dst_unused:UNUSED_PAD src0_sel:WORD_0 src1_sel:DWORD
    v_fma_f32 v179, |v112|, v64, v179
    v_mfma_f32_16x16x32_f16 v[120:123], a[100:103], v[148:151], v[120:123]
    s_waitcnt lgkmcnt(2)
    v_pk_mul_f16 v160, v160, v204
    v_fma_f32 v179, |v113|, v65, v179
    v_mfma_f32_16x16x32_f16 v[120:123], a[104:107], v[152:155], v[120:123]
    v_pk_mul_f16 v161, v161, v205
    v_fma_f32 v179, |v114|, v66, v179
    v_mfma_f32_16x16x32_f16 v[120:123], a[108:111], v[156:159], v[120:123]
    v_pk_mul_f16 v162, v162, v206
    v_fma_f32 v179, |v115|, v67, v179
    v_mfma_f32_16x16x32_f16 v[124:127], a[112:115], v[144:147], v[44:47]
    v_pk_mul_f16 v163, v163, v207
    v_fma_f32 v179, |v116|, v68, v179
    v_mfma_f32_16x16x32_f16 v[124:127], a[116:119], v[148:151], v[124:127]
    v_pk_mul_f16 v164, v164, v208
    v_fma_f32 v179, |v117|, v69, v179
    v_mfma_f32_16x16x32_f16 v[124:127], a[120:123], v[152:155], v[124:127]
    v_pk_mul_f16 v165, v165, v209
    v_fma_f32 v179, |v118|, v70, v179
    v_mfma_f32_16x16x32_f16 v[124:127], a[124:127], v[156:159], v[124:127]
    v_pk_mul_f16 v166, v166, v210
    v_fma_f32 v179, |v119|, v71, v179
    v_mfma_f32_16x16x32_f16 v[96:99], a[0:3], v[128:131], v[16:19]
    ds_read_b128 v[156:159], v245 offset:6240
    v_fma_f32 v179, |v120|, v72, v179
    v_mfma_f32_16x16x32_f16 v[96:99], a[4:7], v[132:135], v[96:99]
    ds_read_b128 v[152:155], v245 offset:6176
    v_fma_f32 v179, |v121|, v73, v179
    v_mfma_f32_16x16x32_f16 v[96:99], a[8:11], v[136:139], v[96:99]
    ds_read_b128 v[148:151], v245 offset:6112
    v_fma_f32 v179, |v122|, v74, v179
    v_mfma_f32_16x16x32_f16 v[96:99], a[12:15], v[140:143], v[96:99]
    ds_read_b128 v[144:147], v245 offset:6048
    v_fma_f32 v179, |v123|, v75, v179
    v_mfma_f32_16x16x32_f16 v[100:103], a[16:19], v[128:131], v[20:23]
    v_pk_mul_f16 v167, v167, v211
    v_fma_f32 v179, |v124|, v76, v179
    v_mfma_f32_16x16x32_f16 v[100:103], a[20:23], v[132:135], v[100:103]
    v_pk_mul_f16 v168, v168, v212
    v_fma_f32 v179, |v125|, v77, v179
    v_mfma_f32_16x16x32_f16 v[100:103], a[24:27], v[136:139], v[100:103]
    v_pk_mul_f16 v169, v169, v213
    v_fma_f32 v179, |v126|, v78, v179
    v_mfma_f32_16x16x32_f16 v[100:103], a[28:31], v[140:143], v[100:103]
    v_pk_mul_f16 v170, v170, v214
    v_fma_f32 v179, |v127|, v79, v179
    v_mfma_f32_16x16x32_f16 v[104:107], a[32:35], v[128:131], v[24:27]
    v_pk_mul_f16 v171, v171, v215
    v_mul_f32 v180, |v96|, v48
    v_mfma_f32_16x16x32_f16 v[104:107], a[36:39], v[132:135], v[104:107]
    v_pk_mul_f16 v172, v172, v216
    v_fma_f32 v180, |v97|, v49, v180
    v_mfma_f32_16x16x32_f16 v[104:107], a[40:43], v[136:139], v[104:107]
    v_pk_mul_f16 v173, v173, v217
    v_fma_f32 v180, |v98|, v50, v180
    v_mfma_f32_16x16x32_f16 v[104:107], a[44:47], v[140:143], v[104:107]
    v_pk_mul_f16 v174, v174, v218
    v_fma_f32 v180, |v99|, v51, v180
    v_mfma_f32_16x16x32_f16 v[108:111], a[48:51], v[128:131], v[28:31]
    v_pk_mul_f16 v175, v175, v219
    v_fma_f32 v180, |v100|, v52, v180
    v_mfma_f32_16x16x32_f16 v[108:111], a[52:55], v[132:135], v[108:111]
    s_waitcnt lgkmcnt(0)
    v_pk_mul_f16 v144, v144, v80
    v_fma_f32 v180, |v101|, v53, v180
    v_mfma_f32_16x16x32_f16 v[108:111], a[56:59], v[136:139], v[108:111]
    v_pk_mul_f16 v145, v145, v81
    v_fma_f32 v180, |v102|, v54, v180
    v_mfma_f32_16x16x32_f16 v[108:111], a[60:63], v[140:143], v[108:111]
    v_pk_mul_f16 v146, v146, v82
    v_fma_f32 v180, |v103|, v55, v180
    v_mfma_f32_16x16x32_f16 v[228:231], v[160:163], v[204:207], 0
    v_pk_mul_f16 v147, v147, v83
    v_fma_f32 v180, |v104|, v56, v180
    v_mfma_f32_16x16x32_f16 v[228:231], v[164:167], v[208:211], v[228:231]
    v_pk_mul_f16 v148, v148, v84
    v_fma_f32 v180, |v105|, v57, v180
    v_mfma_f32_16x16x32_f16 v[228:231], v[168:171], v[212:215], v[228:231]
    v_pk_mul_f16 v149, v149, v85
    v_fma_f32 v180, |v106|, v58, v180
    v_mfma_f32_16x16x32_f16 v[228:231], v[172:175], v[216:219], v[228:231]
    ds_read_b128 v[172:175], v245 offset:9696
    v_fma_f32 v180, |v107|, v59, v180
    v_mfma_f32_16x16x32_f16 v[112:115], a[64:67], v[128:131], v[32:35]
    ds_read_b128 v[168:171], v245 offset:9632
    ds_read_b128 v[164:167], v245 offset:9568
    v_mfma_f32_16x16x32_f16 v[112:115], a[68:71], v[132:135], v[112:115]
    ds_read_b128 v[160:163], v245 offset:9504
    v_pk_mul_f16 v150, v150, v86
    v_mfma_f32_16x16x32_f16 v[112:115], a[72:75], v[136:139], v[112:115]
    ds_write_b128 v238, v[228:231] offset:2368
    v_mfma_f32_16x16x32_f16 v[112:115], a[76:79], v[140:143], v[112:115]
    v_pk_mul_f16 v151, v151, v87
    v_fma_f32 v180, |v108|, v60, v180
    v_mfma_f32_16x16x32_f16 v[116:119], a[80:83], v[128:131], v[36:39]
    v_pk_mul_f16 v152, v152, v88
    v_fma_f32 v180, |v109|, v61, v180
    v_mfma_f32_16x16x32_f16 v[116:119], a[84:87], v[132:135], v[116:119]
    v_pk_mul_f16 v153, v153, v89
    v_fma_f32 v180, |v110|, v62, v180
    v_mfma_f32_16x16x32_f16 v[116:119], a[88:91], v[136:139], v[116:119]
    v_pk_mul_f16 v154, v154, v90
    v_fma_f32 v180, |v111|, v63, v180
    v_mfma_f32_16x16x32_f16 v[116:119], a[92:95], v[140:143], v[116:119]
    v_pk_mul_f16 v155, v155, v91
    v_fma_f32 v180, |v112|, v64, v180
    v_mfma_f32_16x16x32_f16 v[120:123], a[96:99], v[128:131], v[40:43]
    v_pk_mul_f16 v156, v156, v92
    v_fma_f32 v180, |v113|, v65, v180
    v_mfma_f32_16x16x32_f16 v[120:123], a[100:103], v[132:135], v[120:123]
    v_pk_mul_f16 v157, v157, v93
    v_fma_f32 v180, |v114|, v66, v180
    v_mfma_f32_16x16x32_f16 v[120:123], a[104:107], v[136:139], v[120:123]
    s_waitcnt lgkmcnt(1)
    v_pk_mul_f16 v160, v160, v204
    v_fma_f32 v180, |v115|, v67, v180
    v_mfma_f32_16x16x32_f16 v[120:123], a[108:111], v[140:143], v[120:123]
    v_pk_mul_f16 v161, v161, v205
    v_fma_f32 v180, |v116|, v68, v180
    v_mfma_f32_16x16x32_f16 v[124:127], a[112:115], v[128:131], v[44:47]
    v_pk_mul_f16 v162, v162, v206
    v_fma_f32 v180, |v117|, v69, v180
    v_mfma_f32_16x16x32_f16 v[124:127], a[116:119], v[132:135], v[124:127]
    v_pk_mul_f16 v158, v158, v94
    v_fma_f32 v180, |v118|, v70, v180
    v_mfma_f32_16x16x32_f16 v[124:127], a[120:123], v[136:139], v[124:127]
    v_pk_mul_f16 v159, v159, v95
    v_fma_f32 v180, |v119|, v71, v180
    v_mfma_f32_16x16x32_f16 v[124:127], a[124:127], v[140:143], v[124:127]
    v_pk_mul_f16 v163, v163, v207
    v_fma_f32 v180, |v120|, v72, v180
    v_mfma_f32_16x16x32_f16 v[96:99], a[0:3], v[144:147], v[16:19]
    ds_read_b128 v[140:143], v245 offset:6528
    v_fma_f32 v180, |v121|, v73, v180
    v_mfma_f32_16x16x32_f16 v[96:99], a[4:7], v[148:151], v[96:99]
    ds_read_b128 v[136:139], v245 offset:6464
    v_fma_f32 v180, |v122|, v74, v180
    v_mfma_f32_16x16x32_f16 v[96:99], a[8:11], v[152:155], v[96:99]
    ds_read_b128 v[132:135], v245 offset:6400
    v_fma_f32 v180, |v123|, v75, v180
    v_mfma_f32_16x16x32_f16 v[96:99], a[12:15], v[156:159], v[96:99]
    ds_read_b128 v[128:131], v245 offset:6336
    v_fma_f32 v180, |v124|, v76, v180
    v_mfma_f32_16x16x32_f16 v[100:103], a[16:19], v[144:147], v[20:23]
    v_pk_mul_f16 v164, v164, v208
    v_fma_f32 v180, |v125|, v77, v180
    v_mfma_f32_16x16x32_f16 v[100:103], a[20:23], v[148:151], v[100:103]
    v_pk_mul_f16 v165, v165, v209
    v_fma_f32 v180, |v126|, v78, v180
    v_mfma_f32_16x16x32_f16 v[100:103], a[24:27], v[152:155], v[100:103]
    v_pk_mul_f16 v166, v166, v210
    v_fma_f32 v180, |v127|, v79, v180
    v_mfma_f32_16x16x32_f16 v[100:103], a[28:31], v[156:159], v[100:103]
    v_pk_mul_f16 v167, v167, v211
    v_mul_f32 v181, |v96|, v48
    v_mfma_f32_16x16x32_f16 v[104:107], a[32:35], v[144:147], v[24:27]
    v_pk_mul_f16 v168, v168, v212
    v_fma_f32 v181, |v97|, v49, v181
    v_mfma_f32_16x16x32_f16 v[104:107], a[36:39], v[148:151], v[104:107]
    v_pk_mul_f16 v169, v169, v213
    v_fma_f32 v181, |v98|, v50, v181
    v_mfma_f32_16x16x32_f16 v[104:107], a[40:43], v[152:155], v[104:107]
    v_pk_mul_f16 v170, v170, v214
    v_fma_f32 v181, |v99|, v51, v181
    v_mfma_f32_16x16x32_f16 v[104:107], a[44:47], v[156:159], v[104:107]
    v_pk_mul_f16 v171, v171, v215
    v_fma_f32 v181, |v100|, v52, v181
    v_mfma_f32_16x16x32_f16 v[108:111], a[48:51], v[144:147], v[28:31]
    v_pk_mul_f16 v172, v172, v216
    v_fma_f32 v181, |v101|, v53, v181
    v_mfma_f32_16x16x32_f16 v[108:111], a[52:55], v[148:151], v[108:111]
    v_pk_mul_f16 v173, v173, v217
    v_fma_f32 v181, |v102|, v54, v181
    v_mfma_f32_16x16x32_f16 v[108:111], a[56:59], v[152:155], v[108:111]
    v_pk_mul_f16 v174, v174, v218
    v_fma_f32 v181, |v103|, v55, v181
    v_mfma_f32_16x16x32_f16 v[108:111], a[60:63], v[156:159], v[108:111]
    s_waitcnt lgkmcnt(0)
    v_pk_mul_f16 v128, v128, v80
    v_fma_f32 v181, |v104|, v56, v181
    v_mfma_f32_16x16x32_f16 v[112:115], a[64:67], v[144:147], v[32:35]
    v_pk_mul_f16 v129, v129, v81
    v_fma_f32 v181, |v105|, v57, v181
    v_mfma_f32_16x16x32_f16 v[112:115], a[68:71], v[148:151], v[112:115]
    v_pk_mul_f16 v130, v130, v82
    v_fma_f32 v181, |v106|, v58, v181
    v_mfma_f32_16x16x32_f16 v[112:115], a[72:75], v[152:155], v[112:115]
    v_pk_mul_f16 v131, v131, v83
    v_fma_f32 v181, |v107|, v59, v181
    v_mfma_f32_16x16x32_f16 v[112:115], a[76:79], v[156:159], v[112:115]
    v_pk_mul_f16 v132, v132, v84
    v_fma_f32 v181, |v108|, v60, v181
    v_mfma_f32_16x16x32_f16 v[116:119], a[80:83], v[144:147], v[36:39]
    v_pk_mul_f16 v133, v133, v85
    v_fma_f32 v181, |v109|, v61, v181
    v_mfma_f32_16x16x32_f16 v[116:119], a[84:87], v[148:151], v[116:119]
    v_pk_mul_f16 v134, v134, v86
    v_fma_f32 v181, |v110|, v62, v181
    v_mfma_f32_16x16x32_f16 v[116:119], a[88:91], v[152:155], v[116:119]
    v_pk_mul_f16 v135, v135, v87
    v_fma_f32 v181, |v111|, v63, v181
    v_mfma_f32_16x16x32_f16 v[116:119], a[92:95], v[156:159], v[116:119]
    v_pk_mul_f16 v136, v136, v88
    v_fma_f32 v181, |v112|, v64, v181
    v_mfma_f32_16x16x32_f16 v[120:123], a[96:99], v[144:147], v[40:43]
    v_pk_mul_f16 v137, v137, v89
    v_fma_f32 v181, |v113|, v65, v181
    v_mfma_f32_16x16x32_f16 v[120:123], a[100:103], v[148:151], v[120:123]
    v_pk_mul_f16 v138, v138, v90
    v_fma_f32 v181, |v114|, v66, v181
    v_mfma_f32_16x16x32_f16 v[120:123], a[104:107], v[152:155], v[120:123]
    v_pk_mul_f16 v139, v139, v91
    v_fma_f32 v181, |v115|, v67, v181
    v_mfma_f32_16x16x32_f16 v[120:123], a[108:111], v[156:159], v[120:123]
    v_pk_mul_f16 v140, v140, v92
    v_fma_f32 v181, |v116|, v68, v181
    v_mfma_f32_16x16x32_f16 v[124:127], a[112:115], v[144:147], v[44:47]
    v_pk_mul_f16 v141, v141, v93
    v_fma_f32 v181, |v117|, v69, v181
    v_mfma_f32_16x16x32_f16 v[124:127], a[116:119], v[148:151], v[124:127]
    v_pk_mul_f16 v142, v142, v94
    v_fma_f32 v181, |v118|, v70, v181
    v_mfma_f32_16x16x32_f16 v[124:127], a[120:123], v[152:155], v[124:127]
    v_pk_mul_f16 v143, v143, v95
    v_fma_f32 v181, |v119|, v71, v181
    v_mfma_f32_16x16x32_f16 v[124:127], a[124:127], v[156:159], v[124:127]
    v_pk_mul_f16 v175, v175, v219
    v_fma_f32 v181, |v120|, v72, v181
    v_mfma_f32_16x16x32_f16 v[96:99], a[0:3], v[128:131], v[16:19]
    ds_read_b128 v[156:159], v245 offset:6816
    v_fma_f32 v181, |v121|, v73, v181
    v_mfma_f32_16x16x32_f16 v[96:99], a[4:7], v[132:135], v[96:99]
    ds_read_b128 v[152:155], v245 offset:6752
    v_fma_f32 v181, |v122|, v74, v181
    v_mfma_f32_16x16x32_f16 v[96:99], a[8:11], v[136:139], v[96:99]
    ds_read_b128 v[148:151], v245 offset:6688
    v_fma_f32 v181, |v123|, v75, v181
    v_mfma_f32_16x16x32_f16 v[96:99], a[12:15], v[140:143], v[96:99]
    ds_read_b128 v[144:147], v245 offset:6624
    v_fma_f32 v181, |v124|, v76, v181
    v_mfma_f32_16x16x32_f16 v[228:231], v[160:163], v[204:207], 0
    v_add_u32_sdwa v242, v235, s5 dst_sel:DWORD dst_unused:UNUSED_PAD src0_sel:WORD_1 src1_sel:DWORD
    v_fma_f32 v181, |v125|, v77, v181
    v_mfma_f32_16x16x32_f16 v[228:231], v[164:167], v[208:211], v[228:231]
    v_add_u32_sdwa v235, v235, s5 dst_sel:DWORD dst_unused:UNUSED_PAD src0_sel:WORD_0 src1_sel:DWORD
    v_fma_f32 v181, |v126|, v78, v181
    v_mfma_f32_16x16x32_f16 v[228:231], v[168:171], v[212:215], v[228:231]
    v_add_u32_sdwa v243, v236, s5 dst_sel:DWORD dst_unused:UNUSED_PAD src0_sel:WORD_1 src1_sel:DWORD
    v_fma_f32 v181, |v127|, v79, v181
    v_mfma_f32_16x16x32_f16 v[228:231], v[172:175], v[216:219], v[228:231]
    v_add_u32_sdwa v236, v236, s5 dst_sel:DWORD dst_unused:UNUSED_PAD src0_sel:WORD_0 src1_sel:DWORD
    v_add_u32_sdwa v244, v237, s5 dst_sel:DWORD dst_unused:UNUSED_PAD src0_sel:WORD_1 src1_sel:DWORD
    v_mfma_f32_16x16x32_f16 v[100:103], a[16:19], v[128:131], v[20:23]
    v_add_u32_sdwa v237, v237, s5 dst_sel:DWORD dst_unused:UNUSED_PAD src0_sel:WORD_0 src1_sel:DWORD
    v_mfma_f32_16x16x32_f16 v[100:103], a[20:23], v[132:135], v[100:103]
    v_permlane32_swap_b32 v184, v186
    v_mfma_f32_16x16x32_f16 v[100:103], a[24:27], v[136:139], v[100:103]
    v_permlane32_swap_b32 v185, v187
    v_mfma_f32_16x16x32_f16 v[100:103], a[28:31], v[140:143], v[100:103]
    ds_write_b128 v238, v[228:231] offset:6976
    v_mfma_f32_16x16x32_f16 v[104:107], a[32:35], v[128:131], v[24:27]
    ds_read2st64_b32 v[230:231], v237 offset0:0 offset1:18
    v_mul_f32 v182, |v96|, v48
    v_mfma_f32_16x16x32_f16 v[104:107], a[36:39], v[132:135], v[104:107]
    ds_read2st64_b32 v[228:229], v236 offset0:0 offset1:18
    v_fma_f32 v182, |v97|, v49, v182
    v_mfma_f32_16x16x32_f16 v[104:107], a[40:43], v[136:139], v[104:107]
    ds_read2st64_b32 v[222:223], v233 offset0:0 offset1:18
    v_fma_f32 v182, |v98|, v50, v182
    v_mfma_f32_16x16x32_f16 v[104:107], a[44:47], v[140:143], v[104:107]
    ds_read2st64_b32 v[220:221], v232 offset0:0 offset1:18
    v_fma_f32 v182, |v99|, v51, v182
    v_mfma_f32_16x16x32_f16 v[108:111], a[48:51], v[128:131], v[28:31]
    ds_read2st64_b32 v[226:227], v235 offset0:0 offset1:18
    v_fma_f32 v182, |v100|, v52, v182
    v_mfma_f32_16x16x32_f16 v[108:111], a[52:55], v[132:135], v[108:111]
    ds_read2st64_b32 v[224:225], v234 offset0:0 offset1:18
    v_fma_f32 v182, |v101|, v53, v182
    v_mfma_f32_16x16x32_f16 v[108:111], a[56:59], v[136:139], v[108:111]
    s_waitcnt lgkmcnt(7)
    v_pk_mul_f16 v144, v144, v80
    v_fma_f32 v182, |v102|, v54, v182
    v_mfma_f32_16x16x32_f16 v[108:111], a[60:63], v[140:143], v[108:111]
    v_pk_mul_f16 v145, v145, v81
    v_fma_f32 v182, |v103|, v55, v182
    v_mfma_f32_16x16x32_f16 v[112:115], a[64:67], v[128:131], v[32:35]
    v_pk_mul_f16 v146, v146, v82
    v_fma_f32 v182, |v104|, v56, v182
    v_mfma_f32_16x16x32_f16 v[112:115], a[68:71], v[132:135], v[112:115]
    v_pk_mul_f16 v147, v147, v83
    v_fma_f32 v182, |v105|, v57, v182
    v_mfma_f32_16x16x32_f16 v[112:115], a[72:75], v[136:139], v[112:115]
    v_pk_mul_f16 v148, v148, v84
    v_fma_f32 v182, |v106|, v58, v182
    v_mfma_f32_16x16x32_f16 v[112:115], a[76:79], v[140:143], v[112:115]
    v_pk_mul_f16 v149, v149, v85
    v_fma_f32 v182, |v107|, v59, v182
    v_mfma_f32_16x16x32_f16 v[116:119], a[80:83], v[128:131], v[36:39]
    v_pk_mul_f16 v150, v150, v86
    v_fma_f32 v182, |v108|, v60, v182
    v_mfma_f32_16x16x32_f16 v[116:119], a[84:87], v[132:135], v[116:119]
    v_pk_mul_f16 v151, v151, v87
    v_fma_f32 v182, |v109|, v61, v182
    v_mfma_f32_16x16x32_f16 v[116:119], a[88:91], v[136:139], v[116:119]
    v_pk_mul_f16 v152, v152, v88
    v_fma_f32 v182, |v110|, v62, v182
    v_mfma_f32_16x16x32_f16 v[116:119], a[92:95], v[140:143], v[116:119]
    v_pk_mul_f16 v153, v153, v89
    v_fma_f32 v182, |v111|, v63, v182
    v_mfma_f32_16x16x32_f16 v[120:123], a[96:99], v[128:131], v[40:43]
    v_pk_mul_f16 v154, v154, v90
    v_fma_f32 v182, |v112|, v64, v182
    v_mfma_f32_16x16x32_f16 v[120:123], a[100:103], v[132:135], v[120:123]
    v_pk_mul_f16 v155, v155, v91
    v_fma_f32 v182, |v113|, v65, v182
    v_mfma_f32_16x16x32_f16 v[120:123], a[104:107], v[136:139], v[120:123]
    v_pk_mul_f16 v156, v156, v92
    v_fma_f32 v182, |v114|, v66, v182
    v_mfma_f32_16x16x32_f16 v[120:123], a[108:111], v[140:143], v[120:123]
    v_pk_mul_f16 v157, v157, v93
    v_fma_f32 v182, |v115|, v67, v182
    v_mfma_f32_16x16x32_f16 v[124:127], a[112:115], v[128:131], v[44:47]
    v_pk_mul_f16 v158, v158, v94
    v_fma_f32 v182, |v116|, v68, v182
    v_mfma_f32_16x16x32_f16 v[124:127], a[116:119], v[132:135], v[124:127]
    v_pk_mul_f16 v159, v159, v95
    v_fma_f32 v182, |v117|, v69, v182
    v_mfma_f32_16x16x32_f16 v[124:127], a[120:123], v[136:139], v[124:127]
    v_add_f32 v184, v184, v186
    v_fma_f32 v182, |v118|, v70, v182
    v_mfma_f32_16x16x32_f16 v[124:127], a[124:127], v[140:143], v[124:127]
    v_add_f32 v185, v185, v187
    v_fma_f32 v182, |v119|, v71, v182
    v_mfma_f32_16x16x32_f16 v[96:99], a[0:3], v[144:147], v[16:19]
    ds_read_b128 v[140:143], v245 offset:7104
    v_fma_f32 v182, |v120|, v72, v182
    v_mfma_f32_16x16x32_f16 v[96:99], a[4:7], v[148:151], v[96:99]
    ds_read_b128 v[136:139], v245 offset:7040
    v_fma_f32 v182, |v121|, v73, v182
    v_mfma_f32_16x16x32_f16 v[96:99], a[8:11], v[152:155], v[96:99]
    ds_read_b128 v[132:135], v245 offset:6976
    v_fma_f32 v182, |v122|, v74, v182
    v_mfma_f32_16x16x32_f16 v[96:99], a[12:15], v[156:159], v[96:99]
    ds_read_b128 v[128:131], v245 offset:6912
    v_fma_f32 v182, |v123|, v75, v182
    v_mfma_f32_16x16x32_f16 v[100:103], a[16:19], v[144:147], v[20:23]
    v_permlane16_swap_b32 v184, v185
    v_mfma_f32_16x16x32_f16 v[100:103], a[20:23], v[148:151], v[100:103]
    v_add_f32 v184, v184, v185
    v_fma_f32 v182, |v124|, v76, v182
    v_mfma_f32_16x16x32_f16 v[100:103], a[24:27], v[152:155], v[100:103]
    s_waitcnt lgkmcnt(4)
    v_fma_f32 v184, v224, s12, v184
    v_fma_f32 v182, |v125|, v77, v182
    v_mfma_f32_16x16x32_f16 v[100:103], a[28:31], v[156:159], v[100:103]
    v_permlane32_swap_b32 v188, v190
    v_mfma_f32_16x16x32_f16 v[104:107], a[32:35], v[144:147], v[24:27]
    v_permlane32_swap_b32 v189, v191
    v_mfma_f32_16x16x32_f16 v[104:107], a[36:39], v[148:151], v[104:107]
    v_add_f32 v188, v188, v190
    v_fma_f32 v182, |v126|, v78, v182
    v_mfma_f32_16x16x32_f16 v[104:107], a[40:43], v[152:155], v[104:107]
    v_add_f32 v189, v189, v191
    v_fma_f32 v182, |v127|, v79, v182
    v_mfma_f32_16x16x32_f16 v[104:107], a[44:47], v[156:159], v[104:107]
    v_permlane16_swap_b32 v188, v189
    v_mfma_f32_16x16x32_f16 v[108:111], a[48:51], v[144:147], v[28:31]
    s_waitcnt lgkmcnt(0)
    v_pk_mul_f16 v128, v128, v80
    v_mul_f32 v183, |v96|, v48
    v_mfma_f32_16x16x32_f16 v[108:111], a[52:55], v[148:151], v[108:111]
    v_pk_mul_f16 v129, v129, v81
    v_fma_f32 v183, |v97|, v49, v183
    v_mfma_f32_16x16x32_f16 v[108:111], a[56:59], v[152:155], v[108:111]
    v_pk_mul_f16 v130, v130, v82
    v_fma_f32 v183, |v98|, v50, v183
    v_mfma_f32_16x16x32_f16 v[108:111], a[60:63], v[156:159], v[108:111]
    v_pk_mul_f16 v131, v131, v83
    v_fma_f32 v183, |v99|, v51, v183
    v_mfma_f32_16x16x32_f16 v[112:115], a[64:67], v[144:147], v[32:35]
    v_pk_mul_f16 v132, v132, v84
    v_fma_f32 v183, |v100|, v52, v183
    v_mfma_f32_16x16x32_f16 v[112:115], a[68:71], v[148:151], v[112:115]
    v_pk_mul_f16 v133, v133, v85
    v_fma_f32 v183, |v101|, v53, v183
    v_mfma_f32_16x16x32_f16 v[112:115], a[72:75], v[152:155], v[112:115]
    v_pk_mul_f16 v134, v134, v86
    v_fma_f32 v183, |v102|, v54, v183
    v_mfma_f32_16x16x32_f16 v[112:115], a[76:79], v[156:159], v[112:115]
    v_pk_mul_f16 v135, v135, v87
    v_fma_f32 v183, |v103|, v55, v183
    v_mfma_f32_16x16x32_f16 v[116:119], a[80:83], v[144:147], v[36:39]
    v_pk_mul_f16 v136, v136, v88
    v_fma_f32 v183, |v104|, v56, v183
    v_mfma_f32_16x16x32_f16 v[116:119], a[84:87], v[148:151], v[116:119]
    v_pk_mul_f16 v137, v137, v89
    v_fma_f32 v183, |v105|, v57, v183
    v_mfma_f32_16x16x32_f16 v[116:119], a[88:91], v[152:155], v[116:119]
    v_pk_mul_f16 v138, v138, v90
    v_fma_f32 v183, |v106|, v58, v183
    v_mfma_f32_16x16x32_f16 v[116:119], a[92:95], v[156:159], v[116:119]
    v_pk_mul_f16 v139, v139, v91
    v_fma_f32 v183, |v107|, v59, v183
    v_mfma_f32_16x16x32_f16 v[120:123], a[96:99], v[144:147], v[40:43]
    v_pk_mul_f16 v140, v140, v92
    v_fma_f32 v183, |v108|, v60, v183
    v_mfma_f32_16x16x32_f16 v[120:123], a[100:103], v[148:151], v[120:123]
    v_pk_mul_f16 v141, v141, v93
    v_fma_f32 v183, |v109|, v61, v183
    v_mfma_f32_16x16x32_f16 v[120:123], a[104:107], v[152:155], v[120:123]
    v_pk_mul_f16 v142, v142, v94
    v_fma_f32 v183, |v110|, v62, v183
    v_mfma_f32_16x16x32_f16 v[120:123], a[108:111], v[156:159], v[120:123]
    v_pk_mul_f16 v143, v143, v95
    v_fma_f32 v183, |v111|, v63, v183
    v_mfma_f32_16x16x32_f16 v[124:127], a[112:115], v[144:147], v[44:47]
    v_add_f32 v188, v188, v189
    v_fma_f32 v183, |v112|, v64, v183
    v_mfma_f32_16x16x32_f16 v[124:127], a[116:119], v[148:151], v[124:127]
    v_fma_f32 v188, v226, s12, v188
    v_fma_f32 v183, |v113|, v65, v183
    v_mfma_f32_16x16x32_f16 v[124:127], a[120:123], v[152:155], v[124:127]
    v_cndmask_b32 v188, v251, v188, s[36:37]
    v_fma_f32 v183, |v114|, v66, v183
    v_mfma_f32_16x16x32_f16 v[124:127], a[124:127], v[156:159], v[124:127]
    v_permlane32_swap_b32 v176, v178
    v_mfma_f32_16x16x32_f16 v[96:99], a[0:3], v[128:131], v[16:19]
    ds_read_b128 v[156:159], v245 offset:7392
    v_fma_f32 v183, |v115|, v67, v183
    v_mfma_f32_16x16x32_f16 v[96:99], a[4:7], v[132:135], v[96:99]
    ds_read_b128 v[152:155], v245 offset:7328
    v_fma_f32 v183, |v116|, v68, v183
    v_mfma_f32_16x16x32_f16 v[96:99], a[8:11], v[136:139], v[96:99]
    ds_read_b128 v[148:151], v245 offset:7264
    v_fma_f32 v183, |v117|, v69, v183
    v_mfma_f32_16x16x32_f16 v[96:99], a[12:15], v[140:143], v[96:99]
    ds_read_b128 v[144:147], v245 offset:7200
    v_fma_f32 v183, |v118|, v70, v183
    v_mfma_f32_16x16x32_f16 v[100:103], a[16:19], v[128:131], v[20:23]
    v_permlane32_swap_b32 v177, v179
    v_mfma_f32_16x16x32_f16 v[100:103], a[20:23], v[132:135], v[100:103]
    v_add_f32 v176, v176, v178
    v_fma_f32 v183, |v119|, v71, v183
    v_mfma_f32_16x16x32_f16 v[100:103], a[24:27], v[136:139], v[100:103]
    v_add_f32 v177, v177, v179
    v_fma_f32 v183, |v120|, v72, v183
    v_mfma_f32_16x16x32_f16 v[100:103], a[28:31], v[140:143], v[100:103]
    v_permlane16_swap_b32 v176, v177
    v_mfma_f32_16x16x32_f16 v[104:107], a[32:35], v[128:131], v[24:27]
    v_add_f32 v176, v176, v177
    v_fma_f32 v183, |v121|, v73, v183
    v_mfma_f32_16x16x32_f16 v[104:107], a[36:39], v[132:135], v[104:107]
    v_fma_f32 v176, v220, s12, v176
    v_fma_f32 v183, |v122|, v74, v183
    v_mfma_f32_16x16x32_f16 v[104:107], a[40:43], v[136:139], v[104:107]
    v_max3_f32 v248, v184, v188, v176
    v_fma_f32 v183, |v123|, v75, v183
    v_mfma_f32_16x16x32_f16 v[104:107], a[44:47], v[140:143], v[104:107]
    v_fma_f32 v183, |v124|, v76, v183
    v_fma_f32 v183, |v125|, v77, v183
    v_mfma_f32_16x16x32_f16 v[108:111], a[48:51], v[128:131], v[28:31]
    s_waitcnt lgkmcnt(0)
    v_pk_mul_f16 v144, v144, v80
    v_fma_f32 v183, |v126|, v78, v183
    v_mfma_f32_16x16x32_f16 v[108:111], a[52:55], v[132:135], v[108:111]
    v_pk_mul_f16 v145, v145, v81
    v_fma_f32 v183, |v127|, v79, v183
    v_mfma_f32_16x16x32_f16 v[108:111], a[56:59], v[136:139], v[108:111]
    v_pk_mul_f16 v146, v146, v82
    v_mul_f32 v192, |v96|, v48
    v_mfma_f32_16x16x32_f16 v[108:111], a[60:63], v[140:143], v[108:111]
L_pad3:
    s_cbranch_execz L_hopret
    v_pk_mul_f16 v147, v147, v83
    v_fma_f32 v192, |v97|, v49, v192
    v_mfma_f32_16x16x32_f16 v[112:115], a[64:67], v[128:131], v[32:35]
    v_pk_mul_f16 v148, v148, v84
    v_fma_f32 v192, |v98|, v50, v192
    v_mfma_f32_16x16x32_f16 v[112:115], a[68:71], v[132:135], v[112:115]
    v_pk_mul_f16 v149, v149, v85
    v_fma_f32 v192, |v99|, v51, v192
    v_mfma_f32_16x16x32_f16 v[112:115], a[72:75], v[136:139], v[112:115]
    v_pk_mul_f16 v150, v150, v86
    v_fma_f32 v192, |v100|, v52, v192
    v_mfma_f32_16x16x32_f16 v[112:115], a[76:79], v[140:143], v[112:115]
    v_pk_mul_f16 v151, v151, v87
    v_fma_f32 v192, |v101|, v53, v192
    v_mfma_f32_16x16x32_f16 v[116:119], a[80:83], v[128:131], v[36:39]
    v_pk_mul_f16 v152, v152, v88
    v_fma_f32 v192, |v102|, v54, v192
    v_mfma_f32_16x16x32_f16 v[116:119], a[84:87], v[132:135], v[116:119]
    v_pk_mul_f16 v153, v153, v89
    v_fma_f32 v192, |v103|, v55, v192
    v_mfma_f32_16x16x32_f16 v[116:119], a[88:91], v[136:139], v[116:119]
    v_pk_mul_f16 v154, v154, v90
    v_fma_f32 v192, |v104|, v56, v192
    v_mfma_f32_16x16x32_f16 v[116:119], a[92:95], v[140:143], v[116:119]
    v_pk_mul_f16 v155, v155, v91
    v_fma_f32 v192, |v105|, v57, v192
    v_mfma_f32_16x16x32_f16 v[120:123], a[96:99], v[128:131], v[40:43]
    v_pk_mul_f16 v156, v156, v92
    v_fma_f32 v192, |v106|, v58, v192
    v_mfma_f32_16x16x32_f16 v[120:123], a[100:103], v[132:135], v[120:123]
    v_pk_mul_f16 v157, v157, v93
    v_fma_f32 v192, |v107|, v59, v192
    v_mfma_f32_16x16x32_f16 v[120:123], a[104:107], v[136:139], v[120:123]
    v_pk_mul_f16 v158, v158, v94
    v_fma_f32 v192, |v108|, v60, v192
    v_mfma_f32_16x16x32_f16 v[120:123], a[108:111], v[140:143], v[120:123]
    v_pk_mul_f16 v159, v159, v95
    v_fma_f32 v192, |v109|, v61, v192
    v_mfma_f32_16x16x32_f16 v[124:127], a[112:115], v[128:131], v[44:47]
    ds_read_b128 v[216:219], v239 offset:4800
    v_fma_f32 v192, |v110|, v62, v192
    v_mfma_f32_16x16x32_f16 v[124:127], a[116:119], v[132:135], v[124:127]
    ds_read_b128 v[212:215], v239 offset:4736
    v_fma_f32 v192, |v111|, v63, v192
    v_mfma_f32_16x16x32_f16 v[124:127], a[120:123], v[136:139], v[124:127]
    ds_read_b128 v[208:211], v239 offset:4672
    v_fma_f32 v192, |v112|, v64, v192
    v_mfma_f32_16x16x32_f16 v[124:127], a[124:127], v[140:143], v[124:127]
    ds_read_b128 v[204:207], v239 offset:4608
    v_fma_f32 v192, |v113|, v65, v192
    v_mfma_f32_16x16x32_f16 v[96:99], a[0:3], v[144:147], v[16:19]
    ds_read_b128 v[140:143], v240 offset:4800
    v_fma_f32 v192, |v114|, v66, v192
    v_mfma_f32_16x16x32_f16 v[96:99], a[4:7], v[148:151], v[96:99]
    ds_read_b128 v[136:139], v240 offset:4736
    v_fma_f32 v192, |v115|, v67, v192
    v_mfma_f32_16x16x32_f16 v[96:99], a[8:11], v[152:155], v[96:99]
    ds_read_b128 v[132:135], v240 offset:4672
    v_fma_f32 v192, |v116|, v68, v192
    v_mfma_f32_16x16x32_f16 v[96:99], a[12:15], v[156:159], v[96:99]
    ds_read_b128 v[128:131], v240 offset:4608
    v_fma_f32 v192, |v117|, v69, v192
    v_mfma_f32_16x16x32_f16 v[100:103], a[16:19], v[144:147], v[20:23]
    v_permlane32_swap_b32 v180, v182
    v_mfma_f32_16x16x32_f16 v[100:103], a[20:23], v[148:151], v[100:103]
    v_permlane32_swap_b32 v181, v183
    v_mfma_f32_16x16x32_f16 v[100:103], a[24:27], v[152:155], v[100:103]
    v_add_f32 v180, v180, v182
    v_fma_f32 v192, |v118|, v70, v192
    v_mfma_f32_16x16x32_f16 v[100:103], a[28:31], v[156:159], v[100:103]
    v_add_f32 v181, v181, v183
    v_fma_f32 v192, |v119|, v71, v192
    v_mfma_f32_16x16x32_f16 v[104:107], a[32:35], v[144:147], v[24:27]
    v_permlane16_swap_b32 v180, v181
    v_fma_f32 v192, |v120|, v72, v192
    v_mfma_f32_16x16x32_f16 v[104:107], a[36:39], v[148:151], v[104:107]
    v_add_f32 v180, v180, v181
    v_fma_f32 v192, |v121|, v73, v192
    v_mfma_f32_16x16x32_f16 v[104:107], a[40:43], v[152:155], v[104:107]
    v_fma_f32 v180, v222, s12, v180
    v_fma_f32 v192, |v122|, v74, v192
    v_mfma_f32_16x16x32_f16 v[104:107], a[44:47], v[156:159], v[104:107]
    v_fma_f32 v192, |v123|, v75, v192
    v_fma_f32 v192, |v124|, v76, v192
    v_mfma_f32_16x16x32_f16 v[108:111], a[48:51], v[144:147], v[28:31]
    s_waitcnt lgkmcnt(0)
    v_pk_mul_f16 v128, v128, v204
    v_fma_f32 v192, |v125|, v77, v192
    v_mfma_f32_16x16x32_f16 v[108:111], a[52:55], v[148:151], v[108:111]
    v_pk_mul_f16 v129, v129, v205
    v_fma_f32 v192, |v126|, v78, v192
    v_mfma_f32_16x16x32_f16 v[108:111], a[56:59], v[152:155], v[108:111]
    v_pk_mul_f16 v130, v130, v206
    v_fma_f32 v192, |v127|, v79, v192
    v_mfma_f32_16x16x32_f16 v[108:111], a[60:63], v[156:159], v[108:111]
    v_pk_mul_f16 v131, v131, v207
    v_mul_f32 v194, |v96|, v48
    v_mfma_f32_16x16x32_f16 v[112:115], a[64:67], v[144:147], v[32:35]
    v_pk_mul_f16 v132, v132, v208
    v_fma_f32 v194, |v97|, v49, v194
    v_mfma_f32_16x16x32_f16 v[112:115], a[68:71], v[148:151], v[112:115]
    v_pk_mul_f16 v133, v133, v209
    v_fma_f32 v194, |v98|, v50, v194
    v_mfma_f32_16x16x32_f16 v[112:115], a[72:75], v[152:155], v[112:115]
    v_pk_mul_f16 v134, v134, v210
    v_fma_f32 v194, |v99|, v51, v194
    v_mfma_f32_16x16x32_f16 v[112:115], a[76:79], v[156:159], v[112:115]
    v_pk_mul_f16 v135, v135, v211
    v_fma_f32 v194, |v100|, v52, v194
    v_mfma_f32_16x16x32_f16 v[116:119], a[80:83], v[144:147], v[36:39]
    v_pk_mul_f16 v136, v136, v212
    v_fma_f32 v194, |v101|, v53, v194
    v_mfma_f32_16x16x32_f16 v[116:119], a[84:87], v[148:151], v[116:119]
    v_pk_mul_f16 v137, v137, v213
    v_fma_f32 v194, |v102|, v54, v194
    v_mfma_f32_16x16x32_f16 v[116:119], a[88:91], v[152:155], v[116:119]
    v_pk_mul_f16 v138, v138, v214
    v_fma_f32 v194, |v103|, v55, v194
    v_mfma_f32_16x16x32_f16 v[116:119], a[92:95], v[156:159], v[116:119]
    v_pk_mul_f16 v139, v139, v215
    v_fma_f32 v194, |v104|, v56, v194
    v_mfma_f32_16x16x32_f16 v[120:123], a[96:99], v[144:147], v[40:43]
    v_pk_mul_f16 v140, v140, v216
    v_fma_f32 v194, |v105|, v57, v194
    v_mfma_f32_16x16x32_f16 v[120:123], a[100:103], v[148:151], v[120:123]
    v_pk_mul_f16 v141, v141, v217
    v_fma_f32 v194, |v106|, v58, v194
    v_mfma_f32_16x16x32_f16 v[120:123], a[104:107], v[152:155], v[120:123]
    v_pk_mul_f16 v142, v142, v218
    v_fma_f32 v194, |v107|, v59, v194
    v_mfma_f32_16x16x32_f16 v[120:123], a[108:111], v[156:159], v[120:123]
    v_pk_mul_f16 v143, v143, v219
    v_fma_f32 v194, |v108|, v60, v194
    v_mfma_f32_16x16x32_f16 v[124:127], a[112:115], v[144:147], v[44:47]
    ds_read_b128 v[216:219], v243 offset:4800
    v_fma_f32 v194, |v109|, v61, v194
    v_mfma_f32_16x16x32_f16 v[124:127], a[116:119], v[148:151], v[124:127]
    ds_read_b128 v[212:215], v243 offset:4736
    v_fma_f32 v194, |v110|, v62, v194
    v_mfma_f32_16x16x32_f16 v[124:127], a[120:123], v[152:155], v[124:127]
    ds_read_b128 v[208:211], v243 offset:4672
    v_fma_f32 v194, |v111|, v63, v194
    v_mfma_f32_16x16x32_f16 v[124:127], a[124:127], v[156:159], v[124:127]
    ds_read_b128 v[204:207], v243 offset:4608
    v_fma_f32 v194, |v112|, v64, v194
    v_mfma_f32_16x16x32_f16 v[96:99], a[0:3], v[128:131], v[16:19]
    ds_read_b128 v[156:159], v244 offset:4800
    v_fma_f32 v194, |v113|, v65, v194
    v_mfma_f32_16x16x32_f16 v[96:99], a[4:7], v[132:135], v[96:99]
    ds_read_b128 v[152:155], v244 offset:4736
    v_fma_f32 v194, |v114|, v66, v194
    v_mfma_f32_16x16x32_f16 v[96:99], a[8:11], v[136:139], v[96:99]
    ds_read_b128 v[148:151], v244 offset:4672
    v_fma_f32 v194, |v115|, v67, v194
    v_mfma_f32_16x16x32_f16 v[96:99], a[12:15], v[140:143], v[96:99]
    ds_read_b128 v[144:147], v244 offset:4608
    v_fma_f32 v194, |v116|, v68, v194
    v_mfma_f32_16x16x32_f16 v[100:103], a[16:19], v[128:131], v[20:23]
    v_fma_f32 v194, |v117|, v69, v194
    v_fma_f32 v194, |v118|, v70, v194
    v_mfma_f32_16x16x32_f16 v[100:103], a[20:23], v[132:135], v[100:103]
    v_fma_f32 v194, |v119|, v71, v194
    v_fma_f32 v194, |v120|, v72, v194
    v_mfma_f32_16x16x32_f16 v[100:103], a[24:27], v[136:139], v[100:103]
    v_fma_f32 v194, |v121|, v73, v194
    v_fma_f32 v194, |v122|, v74, v194
    v_mfma_f32_16x16x32_f16 v[100:103], a[28:31], v[140:143], v[100:103]
    v_fma_f32 v194, |v123|, v75, v194
    v_fma_f32 v194, |v124|, v76, v194
    v_mfma_f32_16x16x32_f16 v[104:107], a[32:35], v[128:131], v[24:27]
    v_fma_f32 v194, |v125|, v77, v194
    v_fma_f32 v194, |v126|, v78, v194
    v_mfma_f32_16x16x32_f16 v[104:107], a[36:39], v[132:135], v[104:107]
    v_fma_f32 v194, |v127|, v79, v194
    v_mul_f32 v196, |v96|, v48
    v_mfma_f32_16x16x32_f16 v[104:107], a[40:43], v[136:139], v[104:107]
    v_permlane32_swap_b32 v192, v194
    v_mfma_f32_16x16x32_f16 v[104:107], a[44:47], v[140:143], v[104:107]
    v_add_f32 v192, v192, v194
    v_fma_f32 v196, |v97|, v49, v196
    v_mfma_f32_16x16x32_f16 v[108:111], a[48:51], v[128:131], v[28:31]
    s_waitcnt lgkmcnt(0)
    v_pk_mul_f16 v144, v144, v204
    v_fma_f32 v196, |v98|, v50, v196
    v_mfma_f32_16x16x32_f16 v[108:111], a[52:55], v[132:135], v[108:111]
    v_pk_mul_f16 v145, v145, v205
    v_fma_f32 v196, |v99|, v51, v196
    v_mfma_f32_16x16x32_f16 v[108:111], a[56:59], v[136:139], v[108:111]
    v_pk_mul_f16 v146, v146, v206
    v_fma_f32 v196, |v100|, v52, v196
    v_mfma_f32_16x16x32_f16 v[108:111], a[60:63], v[140:143], v[108:111]
    v_pk_mul_f16 v147, v147, v207
    v_fma_f32 v196, |v101|, v53, v196
    v_mfma_f32_16x16x32_f16 v[112:115], a[64:67], v[128:131], v[32:35]
    v_pk_mul_f16 v148, v148, v208
    v_fma_f32 v196, |v102|, v54, v196
    v_mfma_f32_16x16x32_f16 v[112:115], a[68:71], v[132:135], v[112:115]
    v_pk_mul_f16 v149, v149, v209
    v_fma_f32 v196, |v103|, v55, v196
    v_mfma_f32_16x16x32_f16 v[112:115], a[72:75], v[136:139], v[112:115]
    v_pk_mul_f16 v150, v150, v210
    v_fma_f32 v196, |v104|, v56, v196
    v_mfma_f32_16x16x32_f16 v[112:115], a[76:79], v[140:143], v[112:115]
    v_pk_mul_f16 v151, v151, v211
    v_fma_f32 v196, |v105|, v57, v196
    v_mfma_f32_16x16x32_f16 v[116:119], a[80:83], v[128:131], v[36:39]
    v_pk_mul_f16 v152, v152, v212
    v_fma_f32 v196, |v106|, v58, v196
    v_mfma_f32_16x16x32_f16 v[116:119], a[84:87], v[132:135], v[116:119]
    v_pk_mul_f16 v153, v153, v213
    v_fma_f32 v196, |v107|, v59, v196
    v_mfma_f32_16x16x32_f16 v[116:119], a[88:91], v[136:139], v[116:119]
    v_pk_mul_f16 v154, v154, v214
    v_fma_f32 v196, |v108|, v60, v196
    v_mfma_f32_16x16x32_f16 v[116:119], a[92:95], v[140:143], v[116:119]
    v_pk_mul_f16 v155, v155, v215
    v_fma_f32 v196, |v109|, v61, v196
    v_mfma_f32_16x16x32_f16 v[120:123], a[96:99], v[128:131], v[40:43]
    v_pk_mul_f16 v156, v156, v216
    v_fma_f32 v196, |v110|, v62, v196
    v_mfma_f32_16x16x32_f16 v[120:123], a[100:103], v[132:135], v[120:123]
    v_pk_mul_f16 v157, v157, v217
    v_fma_f32 v196, |v111|, v63, v196
    v_mfma_f32_16x16x32_f16 v[120:123], a[104:107], v[136:139], v[120:123]
    v_pk_mul_f16 v158, v158, v218
    v_fma_f32 v196, |v112|, v64, v196
    v_mfma_f32_16x16x32_f16 v[120:123], a[108:111], v[140:143], v[120:123]
    v_pk_mul_f16 v159, v159, v219
    v_fma_f32 v196, |v113|, v65, v196
    v_mfma_f32_16x16x32_f16 v[124:127], a[112:115], v[128:131], v[44:47]
    ds_read_b128 v[216:219], v241 offset:4800
    v_fma_f32 v196, |v114|, v66, v196
    v_mfma_f32_16x16x32_f16 v[124:127], a[116:119], v[132:135], v[124:127]
    ds_read_b128 v[212:215], v241 offset:4736
    v_fma_f32 v196, |v115|, v67, v196
    v_mfma_f32_16x16x32_f16 v[124:127], a[120:123], v[136:139], v[124:127]
    ds_read_b128 v[208:211], v241 offset:4672
    v_fma_f32 v196, |v116|, v68, v196
    v_mfma_f32_16x16x32_f16 v[124:127], a[124:127], v[140:143], v[124:127]
    ds_read_b128 v[204:207], v241 offset:4608
    v_fma_f32 v196, |v117|, v69, v196
    v_mfma_f32_16x16x32_f16 v[96:99], a[0:3], v[144:147], v[16:19]
    ds_read_b128 v[140:143], v242 offset:4800
    v_fma_f32 v196, |v118|, v70, v196
    v_mfma_f32_16x16x32_f16 v[96:99], a[4:7], v[148:151], v[96:99]
    ds_read_b128 v[136:139], v242 offset:4736
    v_fma_f32 v196, |v119|, v71, v196
    v_mfma_f32_16x16x32_f16 v[96:99], a[8:11], v[152:155], v[96:99]
    ds_read_b128 v[132:135], v242 offset:4672
    v_fma_f32 v196, |v120|, v72, v196
    v_mfma_f32_16x16x32_f16 v[96:99], a[12:15], v[156:159], v[96:99]
    ds_read_b128 v[128:131], v242 offset:4608
    v_fma_f32 v196, |v121|, v73, v196
    v_mfma_f32_16x16x32_f16 v[100:103], a[16:19], v[144:147], v[20:23]
    v_mov_b32 v193, v192
    v_fma_f32 v196, |v122|, v74, v196
    v_mfma_f32_16x16x32_f16 v[100:103], a[20:23], v[148:151], v[100:103]
    v_permlane16_swap_b32 v192, v193
    v_mfma_f32_16x16x32_f16 v[100:103], a[24:27], v[152:155], v[100:103]
    v_add_f32 v192, v192, v193
    v_fma_f32 v196, |v123|, v75, v196
    v_mfma_f32_16x16x32_f16 v[100:103], a[28:31], v[156:159], v[100:103]
    v_fma_f32 v192, v228, s12, v192
    v_fma_f32 v196, |v124|, v76, v196
    v_mfma_f32_16x16x32_f16 v[104:107], a[32:35], v[144:147], v[24:27]
    v_cndmask_b32 v192, v251, v192, s[38:39]
    v_fma_f32 v196, |v125|, v77, v196
    v_mfma_f32_16x16x32_f16 v[104:107], a[36:39], v[148:151], v[104:107]
    v_max3_f32 v248, v248, v180, v192
    v_fma_f32 v196, |v126|, v78, v196
    v_mfma_f32_16x16x32_f16 v[104:107], a[40:43], v[152:155], v[104:107]
    v_max_f32_dpp v248, v248, v248 row_ror:8 row_mask:0xf bank_mask:0xf
    v_fma_f32 v196, |v127|, v79, v196
    v_mfma_f32_16x16x32_f16 v[104:107], a[44:47], v[156:159], v[104:107]
    v_max_f32_dpp v248, v248, v248 row_ror:4 row_mask:0xf bank_mask:0xf
    v_mul_f32 v198, |v96|, v48
    v_mfma_f32_16x16x32_f16 v[108:111], a[48:51], v[144:147], v[28:31]
    s_waitcnt lgkmcnt(0)
    v_pk_mul_f16 v128, v128, v204
    v_fma_f32 v198, |v97|, v49, v198
    v_mfma_f32_16x16x32_f16 v[108:111], a[52:55], v[148:151], v[108:111]
    v_pk_mul_f16 v129, v129, v205
    v_fma_f32 v198, |v98|, v50, v198
    v_mfma_f32_16x16x32_f16 v[108:111], a[56:59], v[152:155], v[108:111]
    v_pk_mul_f16 v130, v130, v206
    v_fma_f32 v198, |v99|, v51, v198
    v_mfma_f32_16x16x32_f16 v[108:111], a[60:63], v[156:159], v[108:111]
    v_pk_mul_f16 v131, v131, v207
    v_fma_f32 v198, |v100|, v52, v198
    v_mfma_f32_16x16x32_f16 v[112:115], a[64:67], v[144:147], v[32:35]
    v_pk_mul_f16 v132, v132, v208
    v_fma_f32 v198, |v101|, v53, v198
    v_mfma_f32_16x16x32_f16 v[112:115], a[68:71], v[148:151], v[112:115]
    v_pk_mul_f16 v133, v133, v209
    v_fma_f32 v198, |v102|, v54, v198
    v_mfma_f32_16x16x32_f16 v[112:115], a[72:75], v[152:155], v[112:115]
    v_pk_mul_f16 v134, v134, v210
    v_fma_f32 v198, |v103|, v55, v198
    v_mfma_f32_16x16x32_f16 v[112:115], a[76:79], v[156:159], v[112:115]
    v_pk_mul_f16 v135, v135, v211
    v_fma_f32 v198, |v104|, v56, v198
    v_mfma_f32_16x16x32_f16 v[116:119], a[80:83], v[144:147], v[36:39]
    v_pk_mul_f16 v136, v136, v212
    v_fma_f32 v198, |v105|, v57, v198
    v_mfma_f32_16x16x32_f16 v[116:119], a[84:87], v[148:151], v[116:119]
    v_pk_mul_f16 v137, v137, v213
    v_fma_f32 v198, |v106|, v58, v198
    v_mfma_f32_16x16x32_f16 v[116:119], a[88:91], v[152:155], v[116:119]
    v_pk_mul_f16 v138, v138, v214
    v_fma_f32 v198, |v107|, v59, v198
    v_mfma_f32_16x16x32_f16 v[116:119], a[92:95], v[156:159], v[116:119]
    v_pk_mul_f16 v139, v139, v215
    v_fma_f32 v198, |v108|, v60, v198
    v_mfma_f32_16x16x32_f16 v[120:123], a[96:99], v[144:147], v[40:43]
    v_pk_mul_f16 v140, v140, v216
    v_fma_f32 v198, |v109|, v61, v198
    v_mfma_f32_16x16x32_f16 v[120:123], a[100:103], v[148:151], v[120:123]
    v_pk_mul_f16 v141, v141, v217
    v_fma_f32 v198, |v110|, v62, v198
    v_mfma_f32_16x16x32_f16 v[120:123], a[104:107], v[152:155], v[120:123]
    v_pk_mul_f16 v142, v142, v218
    v_fma_f32 v198, |v111|, v63, v198
    v_mfma_f32_16x16x32_f16 v[120:123], a[108:111], v[156:159], v[120:123]
    v_pk_mul_f16 v143, v143, v219
    v_fma_f32 v198, |v112|, v64, v198
    v_mfma_f32_16x16x32_f16 v[124:127], a[112:115], v[144:147], v[44:47]
    v_max_f32_dpp v248, v248, v248 row_ror:2 row_mask:0xf bank_mask:0xf
    v_fma_f32 v198, |v113|, v65, v198
    v_mfma_f32_16x16x32_f16 v[124:127], a[116:119], v[148:151], v[124:127]
    v_max_f32_dpp v248, v248, v248 row_ror:1 row_mask:0xf bank_mask:0xf
    v_fma_f32 v198, |v114|, v66, v198
    v_mfma_f32_16x16x32_f16 v[124:127], a[120:123], v[152:155], v[124:127]
    v_max_f32_dpp v248, v248, v248 row_bcast:15 row_mask:0xa bank_mask:0xf
    v_fma_f32 v198, |v115|, v67, v198
    v_mfma_f32_16x16x32_f16 v[124:127], a[124:127], v[156:159], v[124:127]
    v_max_f32_dpp v248, v248, v248 row_bcast:31 row_mask:0xc bank_mask:0xf
    v_fma_f32 v198, |v116|, v68, v198
    v_mfma_f32_16x16x32_f16 v[96:99], a[0:3], v[128:131], v[16:19]
    v_readlane_b32 s14, v248, 63
    v_fma_f32 v198, |v117|, v69, v198
    v_mfma_f32_16x16x32_f16 v[96:99], a[4:7], v[132:135], v[96:99]
    v_subrev_f32 v184, s14, v184
    v_fma_f32 v198, |v118|, v70, v198
    v_mfma_f32_16x16x32_f16 v[96:99], a[8:11], v[136:139], v[96:99]
    v_subrev_f32 v188, s14, v188
    v_fma_f32 v198, |v119|, v71, v198
    v_mfma_f32_16x16x32_f16 v[96:99], a[12:15], v[140:143], v[96:99]
    v_subrev_f32 v176, s14, v176
    v_fma_f32 v198, |v120|, v72, v198
    v_mfma_f32_16x16x32_f16 v[100:103], a[16:19], v[128:131], v[20:23]
    v_subrev_f32 v180, s14, v180
    v_fma_f32 v198, |v121|, v73, v198
    v_mfma_f32_16x16x32_f16 v[100:103], a[20:23], v[132:135], v[100:103]
    v_subrev_f32 v192, s14, v192
    v_fma_f32 v198, |v122|, v74, v198
    v_mfma_f32_16x16x32_f16 v[100:103], a[24:27], v[136:139], v[100:103]
    v_mul_f32 v184, s55, v184
    v_fma_f32 v198, |v123|, v75, v198
    v_mfma_f32_16x16x32_f16 v[100:103], a[28:31], v[140:143], v[100:103]
    v_mul_f32 v188, s55, v188
    v_fma_f32 v198, |v124|, v76, v198
    v_mfma_f32_16x16x32_f16 v[104:107], a[32:35], v[128:131], v[24:27]
    v_mul_f32 v176, s55, v176
    v_fma_f32 v198, |v125|, v77, v198
    v_mfma_f32_16x16x32_f16 v[104:107], a[36:39], v[132:135], v[104:107]
    v_mul_f32 v180, s55, v180
    v_fma_f32 v198, |v126|, v78, v198
    v_mfma_f32_16x16x32_f16 v[104:107], a[40:43], v[136:139], v[104:107]
    v_mul_f32 v192, s55, v192
    v_fma_f32 v198, |v127|, v79, v198
    v_mfma_f32_16x16x32_f16 v[104:107], a[44:47], v[140:143], v[104:107]
    v_exp_f32 v184, v184
    v_mfma_f32_16x16x32_f16 v[108:111], a[48:51], v[128:131], v[28:31]
    v_exp_f32 v188, v188
    v_mfma_f32_16x16x32_f16 v[108:111], a[52:55], v[132:135], v[108:111]
    v_exp_f32 v176, v176
    v_mfma_f32_16x16x32_f16 v[108:111], a[56:59], v[136:139], v[108:111]
    v_exp_f32 v180, v180
    v_mfma_f32_16x16x32_f16 v[108:111], a[60:63], v[140:143], v[108:111]
    v_exp_f32 v192, v192
    v_mfma_f32_16x16x32_f16 v[112:115], a[64:67], v[128:131], v[32:35]
    v_add_f32 v249, v184, v188
    v_mul_f32 v197, |v96|, v48
    v_mfma_f32_16x16x32_f16 v[112:115], a[68:71], v[132:135], v[112:115]
    v_mul_f32 v250, v184, v225
    v_mul_f32 v200, |v97|, v49
    v_mfma_f32_16x16x32_f16 v[112:115], a[72:75], v[136:139], v[112:115]
    v_fmac_f32 v250, v188, v227
    v_fma_f32 v197, |v98|, v50, v197
    v_mfma_f32_16x16x32_f16 v[112:115], a[76:79], v[140:143], v[112:115]
    v_add_f32 v249, v249, v176
    v_fma_f32 v200, |v99|, v51, v200
    v_mfma_f32_16x16x32_f16 v[116:119], a[80:83], v[128:131], v[36:39]
    v_fmac_f32 v250, v176, v221
    v_fma_f32 v197, |v100|, v52, v197
    v_mfma_f32_16x16x32_f16 v[116:119], a[84:87], v[132:135], v[116:119]
    v_add_f32 v249, v249, v180
    v_fma_f32 v200, |v101|, v53, v200
    v_mfma_f32_16x16x32_f16 v[116:119], a[88:91], v[136:139], v[116:119]
    v_fmac_f32 v250, v180, v223
    v_fma_f32 v197, |v102|, v54, v197
    v_mfma_f32_16x16x32_f16 v[116:119], a[92:95], v[140:143], v[116:119]
    v_add_f32 v249, v249, v192
    v_fma_f32 v200, |v103|, v55, v200
    v_mfma_f32_16x16x32_f16 v[120:123], a[96:99], v[128:131], v[40:43]
    v_fmac_f32 v250, v192, v229
    s_lshl_b32 s6, s4, 1
    v_fma_f32 v197, |v104|, v56, v197
    v_mfma_f32_16x16x32_f16 v[120:123], a[100:103], v[132:135], v[120:123]
    v_mov_b32 v2, s6
    v_fma_f32 v200, |v105|, v57, v200
    v_mfma_f32_16x16x32_f16 v[120:123], a[104:107], v[136:139], v[120:123]
    v_permlane32_swap_b32 v196, v198
    v_mfma_f32_16x16x32_f16 v[120:123], a[108:111], v[140:143], v[120:123]
    v_add_f32 v196, v196, v198
    v_fma_f32 v197, |v106|, v58, v197
    v_mfma_f32_16x16x32_f16 v[124:127], a[112:115], v[128:131], v[44:47]
    v_fma_f32 v200, |v107|, v59, v200
    v_fma_f32 v197, |v108|, v60, v197
    v_mfma_f32_16x16x32_f16 v[124:127], a[116:119], v[132:135], v[124:127]
    v_fma_f32 v200, |v109|, v61, v200
    v_fma_f32 v197, |v110|, v62, v197
    v_mfma_f32_16x16x32_f16 v[124:127], a[120:123], v[136:139], v[124:127]
    v_fma_f32 v200, |v111|, v63, v200
    v_fma_f32 v197, |v112|, v64, v197
    v_mfma_f32_16x16x32_f16 v[124:127], a[124:127], v[140:143], v[124:127]
    v_fma_f32 v200, |v113|, v65, v200
    v_fma_f32 v197, |v114|, v66, v197
    v_fma_f32 v200, |v115|, v67, v200
    v_fma_f32 v197, |v116|, v68, v197
    v_fma_f32 v200, |v117|, v69, v200
    v_fma_f32 v197, |v118|, v70, v197
    v_fma_f32 v200, |v119|, v71, v200
    v_fma_f32 v197, |v120|, v72, v197
    v_fma_f32 v200, |v121|, v73, v200
    v_fma_f32 v197, |v122|, v74, v197
    v_fma_f32 v200, |v123|, v75, v200
    v_fma_f32 v197, |v124|, v76, v197
    v_fma_f32 v200, |v125|, v77, v200
    v_fma_f32 v197, |v126|, v78, v197
    v_fma_f32 v200, |v127|, v79, v200
    v_add_f32 v197, v197, v200
    s_nop 1
    v_permlane32_swap_b32 v197, v199
    v_add_f32 v197, v197, v199
    s_nop 1
    v_permlane16_swap_b32 v196, v197
    v_fma_f32 v196, v230, s12, v196
    v_add_f32 v196, v196, v197
    v_cndmask_b32 v196, v251, v196, s[40:41]
    v_subrev_f32 v197, s14, v196
    v_mul_f32 v197, s55, v197
    v_cmp_lt_f32 vcc, 4.0, v197
    v_exp_f32 v197, v197
    s_cbranch_vccnz L_tailmax
    v_add_f32 v249, v249, v197
    v_fmac_f32 v250, v197, v231
L_tailsum:
    s_nop 0
    v_add_f32_dpp v249, v249, v249 row_ror:8 row_mask:0xf bank_mask:0xf
    v_add_f32_dpp v250, v250, v250 row_ror:8 row_mask:0xf bank_mask:0xf
    s_nop 0
    v_add_f32_dpp v249, v249, v249 row_ror:4 row_mask:0xf bank_mask:0xf
    v_add_f32_dpp v250, v250, v250 row_ror:4 row_mask:0xf bank_mask:0xf
    s_nop 0
    v_add_f32_dpp v249, v249, v249 row_ror:2 row_mask:0xf bank_mask:0xf
    v_add_f32_dpp v250, v250, v250 row_ror:2 row_mask:0xf bank_mask:0xf
    s_nop 0
    v_add_f32_dpp v249, v249, v249 row_ror:1 row_mask:0xf bank_mask:0xf
    v_add_f32_dpp v250, v250, v250 row_ror:1 row_mask:0xf bank_mask:0xf
    s_nop 0
    v_add_f32_dpp v249, v249, v249 row_bcast:15 row_mask:0xa bank_mask:0xf
    v_add_f32_dpp v250, v250, v250 row_bcast:15 row_mask:0xa bank_mask:0xf
    s_nop 0
    v_add_f32_dpp v249, v249, v249 row_bcast:31 row_mask:0xc bank_mask:0xf
    v_add_f32_dpp v250, v250, v250 row_bcast:31 row_mask:0xc bank_mask:0xf
    v_rcp_f32 v249, v249
    v_ldexp_f32 v250, v250, s11
    s_mov_b32 exec_lo, 0
    s_mov_b32 exec_hi, 0x80000000
    v_mul_f32 v250, v250, v249
    v_cvt_pk_bf16_f32 v250, v250, v250
    global_store_short v2, v250, s[32:33]
L_end:
    s_endpgm
L_wfix:
    s_waitcnt lgkmcnt(0)
    s_nop 7
    s_mov_b32 s8, 0x07060302
    v_mov_b32 v121, 0
    v_and_b32 v122, s44, v48
    v_pk_max_u16 v121, v121, v122
    v_and_b32 v122, s44, v49
    v_pk_max_u16 v121, v121, v122
    v_and_b32 v122, s44, v50
    v_pk_max_u16 v121, v121, v122
    v_and_b32 v122, s44, v51
    v_pk_max_u16 v121, v121, v122
    v_and_b32 v122, s44, v52
    v_pk_max_u16 v121, v121, v122
    v_and_b32 v122, s44, v53
    v_pk_max_u16 v121, v121, v122
    v_and_b32 v122, s44, v54
    v_pk_max_u16 v121, v121, v122
    v_and_b32 v122, s44, v55
    v_pk_max_u16 v121, v121, v122
    v_and_b32 v122, s44, v56
    v_pk_max_u16 v121, v121, v122
    v_and_b32 v122, s44, v57
    v_pk_max_u16 v121, v121, v122
    v_and_b32 v122, s44, v58
    v_pk_max_u16 v121, v121, v122
    v_and_b32 v122, s44, v59
    v_pk_max_u16 v121, v121, v122
    v_and_b32 v122, s44, v60
    v_pk_max_u16 v121, v121, v122
    v_and_b32 v122, s44, v61
    v_pk_max_u16 v121, v121, v122
    v_and_b32 v122, s44, v62
    v_pk_max_u16 v121, v121, v122
    v_and_b32 v122, s44, v63
    v_pk_max_u16 v121, v121, v122
    v_and_b32 v122, s44, v64
    v_pk_max_u16 v121, v121, v122
    v_and_b32 v122, s44, v65
    v_pk_max_u16 v121, v121, v122
    v_and_b32 v122, s44, v66
    v_pk_max_u16 v121, v121, v122
    v_and_b32 v122, s44, v67
    v_pk_max_u16 v121, v121, v122
    v_and_b32 v122, s44, v68
    v_pk_max_u16 v121, v121, v122
    v_and_b32 v122, s44, v69
    v_pk_max_u16 v121, v121, v122
    v_and_b32 v122, s44, v70
    v_pk_max_u16 v121, v121, v122
    v_and_b32 v122, s44, v71
    v_pk_max_u16 v121, v121, v122
    v_and_b32 v122, s44, v72
    v_pk_max_u16 v121, v121, v122
    v_and_b32 v122, s44, v73
    v_pk_max_u16 v121, v121, v122
    v_and_b32 v122, s44, v74
    v_pk_max_u16 v121, v121, v122
    v_and_b32 v122, s44, v75
    v_pk_max_u16 v121, v121, v122
    v_and_b32 v122, s44, v76
    v_pk_max_u16 v121, v121, v122
    v_and_b32 v122, s44, v77
    v_pk_max_u16 v121, v121, v122
    v_and_b32 v122, s44, v78
    v_pk_max_u16 v121, v121, v122
    v_and_b32 v122, s44, v79
    v_pk_max_u16 v121, v121, v122
    s_barrier
    ds_write_b32 v3, v121 offset:39424
    s_waitcnt lgkmcnt(0)
    s_barrier
    ds_read_b128 v[112:115], v127 offset:39424
    s_waitcnt lgkmcnt(0)
    v_pk_max_u16 v121, v121, v112
    v_pk_max_u16 v121, v121, v113
    v_pk_max_u16 v121, v121, v114
    v_pk_max_u16 v121, v121, v115
    s_barrier
    v_pk_max_u16 v121, v121, v121 op_sel:[0,1] op_sel_hi:[1,0]
    s_nop 1
    v_max_u32_dpp v121, v121, v121 row_ror:8 row_mask:0xf bank_mask:0xf
    s_nop 1
    v_max_u32_dpp v121, v121, v121 row_ror:4 row_mask:0xf bank_mask:0xf
    s_nop 1
    v_max_u32_dpp v121, v121, v121 row_ror:2 row_mask:0xf bank_mask:0xf
    s_nop 1
    v_max_u32_dpp v121, v121, v121 row_ror:1 row_mask:0xf bank_mask:0xf
    s_nop 1
    v_max_u32_dpp v121, v121, v121 row_bcast:15 row_mask:0xa bank_mask:0xf
    s_nop 1
    v_max_u32_dpp v121, v121, v121 row_bcast:31 row_mask:0xc bank_mask:0xf
    s_nop 0
    v_readlane_b32 s6, v121, 63
    s_nop 0
    s_bfe_u32 s6, s6, 0x80007
    s_max_u32 s6, s6, 87
    s_sub_u32 s47, 127, s6
    s_sub_u32 s7, 0, s47
    v_lshlrev_b32 v121, 16, v48
    v_and_b32 v122, s46, v48
    v_ldexp_f32 v121, v121, s47
    v_ldexp_f32 v122, v122, s47
    v_perm_b32 v48, v122, v121, s8
    v_lshlrev_b32 v121, 16, v49
    v_and_b32 v122, s46, v49
    v_ldexp_f32 v121, v121, s47
    v_ldexp_f32 v122, v122, s47
    v_perm_b32 v49, v122, v121, s8
    v_lshlrev_b32 v121, 16, v50
    v_and_b32 v122, s46, v50
    v_ldexp_f32 v121, v121, s47
    v_ldexp_f32 v122, v122, s47
    v_perm_b32 v50, v122, v121, s8
    v_lshlrev_b32 v121, 16, v51
    v_and_b32 v122, s46, v51
    v_ldexp_f32 v121, v121, s47
    v_ldexp_f32 v122, v122, s47
    v_perm_b32 v51, v122, v121, s8
    v_lshlrev_b32 v121, 16, v52
    v_and_b32 v122, s46, v52
    v_ldexp_f32 v121, v121, s47
    v_ldexp_f32 v122, v122, s47
    v_perm_b32 v52, v122, v121, s8
    v_lshlrev_b32 v121, 16, v53
    v_and_b32 v122, s46, v53
    v_ldexp_f32 v121, v121, s47
    v_ldexp_f32 v122, v122, s47
    v_perm_b32 v53, v122, v121, s8
    v_lshlrev_b32 v121, 16, v54
    v_and_b32 v122, s46, v54
    v_ldexp_f32 v121, v121, s47
    v_ldexp_f32 v122, v122, s47
    v_perm_b32 v54, v122, v121, s8
    v_lshlrev_b32 v121, 16, v55
    v_and_b32 v122, s46, v55
    v_ldexp_f32 v121, v121, s47
    v_ldexp_f32 v122, v122, s47
    v_perm_b32 v55, v122, v121, s8
    v_lshlrev_b32 v121, 16, v56
    v_and_b32 v122, s46, v56
    v_ldexp_f32 v121, v121, s47
    v_ldexp_f32 v122, v122, s47
    v_perm_b32 v56, v122, v121, s8
    v_lshlrev_b32 v121, 16, v57
    v_and_b32 v122, s46, v57
    v_ldexp_f32 v121, v121, s47
    v_ldexp_f32 v122, v122, s47
    v_perm_b32 v57, v122, v121, s8
    v_lshlrev_b32 v121, 16, v58
    v_and_b32 v122, s46, v58
    v_ldexp_f32 v121, v121, s47
    v_ldexp_f32 v122, v122, s47
    v_perm_b32 v58, v122, v121, s8
    v_lshlrev_b32 v121, 16, v59
    v_and_b32 v122, s46, v59
    v_ldexp_f32 v121, v121, s47
    v_ldexp_f32 v122, v122, s47
    v_perm_b32 v59, v122, v121, s8
    v_lshlrev_b32 v121, 16, v60
    v_and_b32 v122, s46, v60
    v_ldexp_f32 v121, v121, s47
    v_ldexp_f32 v122, v122, s47
    v_perm_b32 v60, v122, v121, s8
    v_lshlrev_b32 v121, 16, v61
    v_and_b32 v122, s46, v61
    v_ldexp_f32 v121, v121, s47
    v_ldexp_f32 v122, v122, s47
    v_perm_b32 v61, v122, v121, s8
    v_lshlrev_b32 v121, 16, v62
    v_and_b32 v122, s46, v62
    v_ldexp_f32 v121, v121, s47
    v_ldexp_f32 v122, v122, s47
    v_perm_b32 v62, v122, v121, s8
    v_lshlrev_b32 v121, 16, v63
    v_and_b32 v122, s46, v63
    v_ldexp_f32 v121, v121, s47
    v_ldexp_f32 v122, v122, s47
    v_perm_b32 v63, v122, v121, s8
    v_lshlrev_b32 v121, 16, v64
    v_and_b32 v122, s46, v64
    v_ldexp_f32 v121, v121, s47
    v_ldexp_f32 v122, v122, s47
    v_perm_b32 v64, v122, v121, s8
    v_lshlrev_b32 v121, 16, v65
    v_and_b32 v122, s46, v65
    v_ldexp_f32 v121, v121, s47
    v_ldexp_f32 v122, v122, s47
    v_perm_b32 v65, v122, v121, s8
    v_lshlrev_b32 v121, 16, v66
    v_and_b32 v122, s46, v66
    v_ldexp_f32 v121, v121, s47
    v_ldexp_f32 v122, v122, s47
    v_perm_b32 v66, v122, v121, s8
    v_lshlrev_b32 v121, 16, v67
    v_and_b32 v122, s46, v67
    v_ldexp_f32 v121, v121, s47
    v_ldexp_f32 v122, v122, s47
    v_perm_b32 v67, v122, v121, s8
    v_lshlrev_b32 v121, 16, v68
    v_and_b32 v122, s46, v68
    v_ldexp_f32 v121, v121, s47
    v_ldexp_f32 v122, v122, s47
    v_perm_b32 v68, v122, v121, s8
    v_lshlrev_b32 v121, 16, v69
    v_and_b32 v122, s46, v69
    v_ldexp_f32 v121, v121, s47
    v_ldexp_f32 v122, v122, s47
    v_perm_b32 v69, v122, v121, s8
    v_lshlrev_b32 v121, 16, v70
    v_and_b32 v122, s46, v70
    v_ldexp_f32 v121, v121, s47
    v_ldexp_f32 v122, v122, s47
    v_perm_b32 v70, v122, v121, s8
    v_lshlrev_b32 v121, 16, v71
    v_and_b32 v122, s46, v71
    v_ldexp_f32 v121, v121, s47
    v_ldexp_f32 v122, v122, s47
    v_perm_b32 v71, v122, v121, s8
    v_lshlrev_b32 v121, 16, v72
    v_and_b32 v122, s46, v72
    v_ldexp_f32 v121, v121, s47
    v_ldexp_f32 v122, v122, s47
    v_perm_b32 v72, v122, v121, s8
    v_lshlrev_b32 v121, 16, v73
    v_and_b32 v122, s46, v73
    v_ldexp_f32 v121, v121, s47
    v_ldexp_f32 v122, v122, s47
    v_perm_b32 v73, v122, v121, s8
    v_lshlrev_b32 v121, 16, v74
    v_and_b32 v122, s46, v74
    v_ldexp_f32 v121, v121, s47
    v_ldexp_f32 v122, v122, s47
    v_perm_b32 v74, v122, v121, s8
    v_lshlrev_b32 v121, 16, v75
    v_and_b32 v122, s46, v75
    v_ldexp_f32 v121, v121, s47
    v_ldexp_f32 v122, v122, s47
    v_perm_b32 v75, v122, v121, s8
    v_lshlrev_b32 v121, 16, v76
    v_and_b32 v122, s46, v76
    v_ldexp_f32 v121, v121, s47
    v_ldexp_f32 v122, v122, s47
    v_perm_b32 v76, v122, v121, s8
    v_lshlrev_b32 v121, 16, v77
    v_and_b32 v122, s46, v77
    v_ldexp_f32 v121, v121, s47
    v_ldexp_f32 v122, v122, s47
    v_perm_b32 v77, v122, v121, s8
    v_lshlrev_b32 v121, 16, v78
    v_and_b32 v122, s46, v78
    v_ldexp_f32 v121, v121, s47
    v_ldexp_f32 v122, v122, s47
    v_perm_b32 v78, v122, v121, s8
    v_lshlrev_b32 v121, 16, v79
    v_and_b32 v122, s46, v79
    v_ldexp_f32 v121, v121, s47
    v_ldexp_f32 v122, v122, s47
    v_perm_b32 v79, v122, v121, s8
    v_lshlrev_b32 v121, 16, v220
    v_and_b32 v122, s46, v220
    v_ldexp_f32 v121, v121, s7
    v_ldexp_f32 v122, v122, s7
    v_perm_b32 v220, v122, v121, s8
    v_lshlrev_b32 v121, 16, v221
    v_and_b32 v122, s46, v221
    v_ldexp_f32 v121, v121, s7
    v_ldexp_f32 v122, v122, s7
    v_perm_b32 v221, v122, v121, s8
    v_lshlrev_b32 v121, 16, v222
    v_and_b32 v122, s46, v222
    v_ldexp_f32 v121, v121, s7
    v_ldexp_f32 v122, v122, s7
    v_perm_b32 v222, v122, v121, s8
    v_lshlrev_b32 v121, 16, v223
    v_and_b32 v122, s46, v223
    v_ldexp_f32 v121, v121, s7
    v_ldexp_f32 v122, v122, s7
    v_perm_b32 v223, v122, v121, s8
    s_add_u32 s6, s47, 10
    v_cmp_lt_u32 vcc, 31, v1
    v_mov_b32 v121, s6
    v_mov_b32 v122, s7
    v_cndmask_b32 v9, v121, v122, vcc
    s_mov_b32 s52, 0
    s_mov_b32 s53, 0
    s_nop 7
    s_branch L_wconv
L_efix:
    s_waitcnt vmcnt(0) lgkmcnt(0)
    s_nop 15
    s_mul_i32 s6, s4, 104
    v_mul_u32_u24 v121, 28, v4
    v_min_u32 v122, 76, v121
    v_add_u32 v121, s6, v121
    v_add_u32 v122, s6, v122
    global_load_dwordx4 v[204:207], v121, s[16:17]
    global_load_dwordx3 v[208:210], v122, s[16:17] offset:16
    s_waitcnt vmcnt(1)
    v_lshl_add_u32 v204, v204, 8, v14
    v_lshl_add_u32 v205, v205, 8, v14
    v_lshl_add_u32 v206, v206, 8, v14
    v_lshl_add_u32 v207, v207, 8, v14
    s_waitcnt vmcnt(0)
    v_lshl_add_u32 v208, v208, 8, v14
    v_lshl_add_u32 v209, v209, 8, v14
    v_lshl_add_u32 v210, v210, 8, v14
    buffer_load_dwordx4 v[144:147], v204, s[56:59], 0 offen
    buffer_load_dwordx4 v[148:151], v205, s[56:59], 0 offen
    buffer_load_dwordx4 v[152:155], v206, s[56:59], 0 offen
    buffer_load_dwordx4 v[156:159], v207, s[56:59], 0 offen
    buffer_load_dwordx4 v[160:163], v208, s[56:59], 0 offen
    buffer_load_dwordx4 v[164:167], v209, s[56:59], 0 offen
    buffer_load_dwordx4 v[168:171], v210, s[56:59], 0 offen
    s_waitcnt vmcnt(0)
    s_mov_b32 s8, 0x07060302
    v_mov_b32 v121, 0
    v_and_b32 v122, s44, v144
    v_pk_max_u16 v121, v121, v122
    v_and_b32 v122, s44, v145
    v_pk_max_u16 v121, v121, v122
    v_and_b32 v122, s44, v146
    v_pk_max_u16 v121, v121, v122
    v_and_b32 v122, s44, v147
    v_pk_max_u16 v121, v121, v122
    v_and_b32 v122, s44, v148
    v_pk_max_u16 v121, v121, v122
    v_and_b32 v122, s44, v149
    v_pk_max_u16 v121, v121, v122
    v_and_b32 v122, s44, v150
    v_pk_max_u16 v121, v121, v122
    v_and_b32 v122, s44, v151
    v_pk_max_u16 v121, v121, v122
    v_and_b32 v122, s44, v152
    v_pk_max_u16 v121, v121, v122
    v_and_b32 v122, s44, v153
    v_pk_max_u16 v121, v121, v122
    v_and_b32 v122, s44, v154
    v_pk_max_u16 v121, v121, v122
    v_and_b32 v122, s44, v155
    v_pk_max_u16 v121, v121, v122
    v_and_b32 v122, s44, v156
    v_pk_max_u16 v121, v121, v122
    v_and_b32 v122, s44, v157
    v_pk_max_u16 v121, v121, v122
    v_and_b32 v122, s44, v158
    v_pk_max_u16 v121, v121, v122
    v_and_b32 v122, s44, v159
    v_pk_max_u16 v121, v121, v122
    v_and_b32 v122, s44, v160
    v_pk_max_u16 v121, v121, v122
    v_and_b32 v122, s44, v161
    v_pk_max_u16 v121, v121, v122
    v_and_b32 v122, s44, v162
    v_pk_max_u16 v121, v121, v122
    v_and_b32 v122, s44, v163
    v_pk_max_u16 v121, v121, v122
    v_and_b32 v122, s44, v164
    v_pk_max_u16 v121, v121, v122
    v_and_b32 v122, s44, v165
    v_pk_max_u16 v121, v121, v122
    v_and_b32 v122, s44, v166
    v_pk_max_u16 v121, v121, v122
    v_and_b32 v122, s44, v167
    v_pk_max_u16 v121, v121, v122
    v_and_b32 v122, s44, v168
    v_pk_max_u16 v121, v121, v122
    v_and_b32 v122, s44, v169
    v_pk_max_u16 v121, v121, v122
    v_and_b32 v122, s44, v170
    v_pk_max_u16 v121, v121, v122
    v_and_b32 v122, s44, v171
    v_pk_max_u16 v121, v121, v122
    v_pk_max_u16 v121, v121, v121 op_sel:[0,1] op_sel_hi:[1,0]
    s_nop 1
    v_max_u32_dpp v121, v121, v121 row_ror:8 row_mask:0xf bank_mask:0xf
    s_nop 1
    v_max_u32_dpp v121, v121, v121 row_ror:4 row_mask:0xf bank_mask:0xf
    s_nop 1
    v_max_u32_dpp v121, v121, v121 row_ror:2 row_mask:0xf bank_mask:0xf
    s_nop 1
    v_max_u32_dpp v121, v121, v121 row_ror:1 row_mask:0xf bank_mask:0xf
    s_nop 1
    v_max_u32_dpp v121, v121, v121 row_bcast:15 row_mask:0xa bank_mask:0xf
    s_nop 1
    v_max_u32_dpp v121, v121, v121 row_bcast:31 row_mask:0xc bank_mask:0xf
    s_nop 0
    v_readlane_b32 s6, v121, 63
    s_nop 0
    s_bfe_u32 s6, s6, 0x80007
    s_max_u32 s6, s6, 104
    s_min_u32 s6, s6, 190
    s_sub_u32 s6, 129, s6
    v_lshlrev_b32 v121, 16, v144
    v_and_b32 v122, s46, v144
    v_ldexp_f32 v121, v121, s6
    v_ldexp_f32 v122, v122, s6
    v_perm_b32 v144, v122, v121, s8
    v_lshlrev_b32 v121, 16, v145
    v_and_b32 v122, s46, v145
    v_ldexp_f32 v121, v121, s6
    v_ldexp_f32 v122, v122, s6
    v_perm_b32 v145, v122, v121, s8
    v_lshlrev_b32 v121, 16, v146
    v_and_b32 v122, s46, v146
    v_ldexp_f32 v121, v121, s6
    v_ldexp_f32 v122, v122, s6
    v_perm_b32 v146, v122, v121, s8
    v_lshlrev_b32 v121, 16, v147
    v_and_b32 v122, s46, v147
    v_ldexp_f32 v121, v121, s6
    v_ldexp_f32 v122, v122, s6
    v_perm_b32 v147, v122, v121, s8
    v_lshlrev_b32 v121, 16, v148
    v_and_b32 v122, s46, v148
    v_ldexp_f32 v121, v121, s6
    v_ldexp_f32 v122, v122, s6
    v_perm_b32 v148, v122, v121, s8
    v_lshlrev_b32 v121, 16, v149
    v_and_b32 v122, s46, v149
    v_ldexp_f32 v121, v121, s6
    v_ldexp_f32 v122, v122, s6
    v_perm_b32 v149, v122, v121, s8
    v_lshlrev_b32 v121, 16, v150
    v_and_b32 v122, s46, v150
    v_ldexp_f32 v121, v121, s6
    v_ldexp_f32 v122, v122, s6
    v_perm_b32 v150, v122, v121, s8
    v_lshlrev_b32 v121, 16, v151
    v_and_b32 v122, s46, v151
    v_ldexp_f32 v121, v121, s6
    v_ldexp_f32 v122, v122, s6
    v_perm_b32 v151, v122, v121, s8
    v_lshlrev_b32 v121, 16, v152
    v_and_b32 v122, s46, v152
    v_ldexp_f32 v121, v121, s6
    v_ldexp_f32 v122, v122, s6
    v_perm_b32 v152, v122, v121, s8
    v_lshlrev_b32 v121, 16, v153
    v_and_b32 v122, s46, v153
    v_ldexp_f32 v121, v121, s6
    v_ldexp_f32 v122, v122, s6
    v_perm_b32 v153, v122, v121, s8
    v_lshlrev_b32 v121, 16, v154
    v_and_b32 v122, s46, v154
    v_ldexp_f32 v121, v121, s6
    v_ldexp_f32 v122, v122, s6
    v_perm_b32 v154, v122, v121, s8
    v_lshlrev_b32 v121, 16, v155
    v_and_b32 v122, s46, v155
    v_ldexp_f32 v121, v121, s6
    v_ldexp_f32 v122, v122, s6
    v_perm_b32 v155, v122, v121, s8
    v_lshlrev_b32 v121, 16, v156
    v_and_b32 v122, s46, v156
    v_ldexp_f32 v121, v121, s6
    v_ldexp_f32 v122, v122, s6
    v_perm_b32 v156, v122, v121, s8
    v_lshlrev_b32 v121, 16, v157
    v_and_b32 v122, s46, v157
    v_ldexp_f32 v121, v121, s6
    v_ldexp_f32 v122, v122, s6
    v_perm_b32 v157, v122, v121, s8
    v_lshlrev_b32 v121, 16, v158
    v_and_b32 v122, s46, v158
    v_ldexp_f32 v121, v121, s6
    v_ldexp_f32 v122, v122, s6
    v_perm_b32 v158, v122, v121, s8
    v_lshlrev_b32 v121, 16, v159
    v_and_b32 v122, s46, v159
    v_ldexp_f32 v121, v121, s6
    v_ldexp_f32 v122, v122, s6
    v_perm_b32 v159, v122, v121, s8
    v_lshlrev_b32 v121, 16, v160
    v_and_b32 v122, s46, v160
    v_ldexp_f32 v121, v121, s6
    v_ldexp_f32 v122, v122, s6
    v_perm_b32 v160, v122, v121, s8
    v_lshlrev_b32 v121, 16, v161
    v_and_b32 v122, s46, v161
    v_ldexp_f32 v121, v121, s6
    v_ldexp_f32 v122, v122, s6
    v_perm_b32 v161, v122, v121, s8
    v_lshlrev_b32 v121, 16, v162
    v_and_b32 v122, s46, v162
    v_ldexp_f32 v121, v121, s6
    v_ldexp_f32 v122, v122, s6
    v_perm_b32 v162, v122, v121, s8
    v_lshlrev_b32 v121, 16, v163
    v_and_b32 v122, s46, v163
    v_ldexp_f32 v121, v121, s6
    v_ldexp_f32 v122, v122, s6
    v_perm_b32 v163, v122, v121, s8
    v_lshlrev_b32 v121, 16, v164
    v_and_b32 v122, s46, v164
    v_ldexp_f32 v121, v121, s6
    v_ldexp_f32 v122, v122, s6
    v_perm_b32 v164, v122, v121, s8
    v_lshlrev_b32 v121, 16, v165
    v_and_b32 v122, s46, v165
    v_ldexp_f32 v121, v121, s6
    v_ldexp_f32 v122, v122, s6
    v_perm_b32 v165, v122, v121, s8
    v_lshlrev_b32 v121, 16, v166
    v_and_b32 v122, s46, v166
    v_ldexp_f32 v121, v121, s6
    v_ldexp_f32 v122, v122, s6
    v_perm_b32 v166, v122, v121, s8
    v_lshlrev_b32 v121, 16, v167
    v_and_b32 v122, s46, v167
    v_ldexp_f32 v121, v121, s6
    v_ldexp_f32 v122, v122, s6
    v_perm_b32 v167, v122, v121, s8
    v_lshlrev_b32 v121, 16, v168
    v_and_b32 v122, s46, v168
    v_ldexp_f32 v121, v121, s6
    v_ldexp_f32 v122, v122, s6
    v_perm_b32 v168, v122, v121, s8
    v_lshlrev_b32 v121, 16, v169
    v_and_b32 v122, s46, v169
    v_ldexp_f32 v121, v121, s6
    v_ldexp_f32 v122, v122, s6
    v_perm_b32 v169, v122, v121, s8
    v_lshlrev_b32 v121, 16, v170
    v_and_b32 v122, s46, v170
    v_ldexp_f32 v121, v121, s6
    v_ldexp_f32 v122, v122, s6
    v_perm_b32 v170, v122, v121, s8
    v_lshlrev_b32 v121, 16, v171
    v_and_b32 v122, s46, v171
    v_ldexp_f32 v121, v121, s6
    v_ldexp_f32 v122, v122, s6
    v_perm_b32 v171, v122, v121, s8
    s_lshl_b32 s6, s6, 1
    v_ldexp_f32 v16, v16, s6
    v_ldexp_f32 v17, v17, s6
    v_ldexp_f32 v18, v18, s6
    v_ldexp_f32 v19, v19, s6
    v_ldexp_f32 v20, v20, s6
    v_ldexp_f32 v21, v21, s6
    v_ldexp_f32 v22, v22, s6
    v_ldexp_f32 v23, v23, s6
    v_ldexp_f32 v24, v24, s6
    v_ldexp_f32 v25, v25, s6
    v_ldexp_f32 v26, v26, s6
    v_ldexp_f32 v27, v27, s6
    v_ldexp_f32 v28, v28, s6
    v_ldexp_f32 v29, v29, s6
    v_ldexp_f32 v30, v30, s6
    v_ldexp_f32 v31, v31, s6
    v_ldexp_f32 v32, v32, s6
    v_ldexp_f32 v33, v33, s6
    v_ldexp_f32 v34, v34, s6
    v_ldexp_f32 v35, v35, s6
    v_ldexp_f32 v36, v36, s6
    v_ldexp_f32 v37, v37, s6
    v_ldexp_f32 v38, v38, s6
    v_ldexp_f32 v39, v39, s6
    v_ldexp_f32 v40, v40, s6
    v_ldexp_f32 v41, v41, s6
    v_ldexp_f32 v42, v42, s6
    v_ldexp_f32 v43, v43, s6
    v_ldexp_f32 v44, v44, s6
    v_ldexp_f32 v45, v45, s6
    v_ldexp_f32 v46, v46, s6
    v_ldexp_f32 v47, v47, s6
    s_add_u32 s7, s5, -28096
    v_add_u32 v0, s7, v15
    ds_write_b128 v0, v[16:19] offset:37888
    ds_write_b128 v0, v[20:23] offset:37952
    ds_write_b128 v0, v[24:27] offset:38016
    ds_write_b128 v0, v[28:31] offset:38080
    ds_write_b128 v0, v[32:35] offset:38144
    ds_write_b128 v0, v[36:39] offset:38208
    ds_write_b128 v0, v[40:43] offset:38272
    ds_write_b128 v0, v[44:47] offset:38336
    s_waitcnt lgkmcnt(0)
    s_add_u32 s54, s54, s6
    s_lshl_b32 s6, s6, 23
    s_sub_u32 s55, s55, s6
    s_mov_b32 s50, 0x7fc00000
    s_mov_b32 s51, 0
    s_mov_b32 s52, 0
    s_mov_b32 s53, 0
    s_nop 7
    s_branch L_econv
L_tailmax:
    s_nop 3
    v_mov_b32 v176, s14
    v_max_f32 v248, s14, v196
    s_nop 1
    v_max_f32_dpp v248, v248, v248 row_ror:8 row_mask:0xf bank_mask:0xf
    s_nop 1
    v_max_f32_dpp v248, v248, v248 row_ror:4 row_mask:0xf bank_mask:0xf
    s_nop 1
    v_max_f32_dpp v248, v248, v248 row_ror:2 row_mask:0xf bank_mask:0xf
    s_nop 1
    v_max_f32_dpp v248, v248, v248 row_ror:1 row_mask:0xf bank_mask:0xf
    s_nop 1
    v_max_f32_dpp v248, v248, v248 row_bcast:15 row_mask:0xa bank_mask:0xf
    s_nop 1
    v_max_f32_dpp v248, v248, v248 row_bcast:31 row_mask:0xc bank_mask:0xf
    s_nop 0
    v_readlane_b32 s13, v248, 63
    s_nop 1
    v_subrev_f32 v196, s13, v196
    v_subrev_f32 v176, s13, v176
    v_mul_f32 v196, s55, v196
    v_mul_f32 v176, s55, v176
    v_exp_f32 v196, v196
    v_exp_f32 v176, v176
    v_mul_f32 v199, v196, v231
    v_fma_f32 v249, v249, v176, v196
    v_fma_f32 v250, v250, v176, v199
    s_nop 3
    s_branch L_tailsum
s_endpgm
.p2align 7
.type L_tab,@object
L_tab:
.long 0x98000000, 0xa0000, 0x0, 0x0
.long 0x98020010, 0xa0004, 0x8, 0x1200010
.long 0x98040020, 0xa0008, 0x10, 0x2400020
.long 0x98060030, 0xa000c, 0x18, 0x3600030
.long 0x98080040, 0xa0010, 0x120, 0x4800040
.long 0x980a0050, 0xa0014, 0x128, 0x5a00050
.long 0x980c0060, 0xa0018, 0x130, 0x6c00060
.long 0x980e0070, 0xa001c, 0x138, 0x7e00070
.long 0x98100080, 0xa0020, 0x240, 0x9000080
.long 0x98120090, 0xa0024, 0x248, 0xa200090
.long 0x981400a0, 0xa0028, 0x250, 0xb4000a0
.long 0x981600b0, 0xa002c, 0x258, 0xc6000b0
.long 0x981800c0, 0xa0030, 0x360, 0xd8000c0
.long 0x981a00d0, 0xa0034, 0x368, 0xea000d0
.long 0x981c00e0, 0xa0038, 0x370, 0xfc000e0
.long 0x981e00f0, 0xa003c, 0x378, 0x10e000f0
.long 0x98200120, 0xa0040, 0x100980, 0x100120
.long 0x98220130, 0xa0044, 0x100988, 0x1300130
.long 0x98240140, 0xa0048, 0x100990, 0x2500140
.long 0x98260150, 0xa004c, 0x100998, 0x3700150
.long 0x98280160, 0xa0050, 0x100aa0, 0x4900160
.long 0x982a0170, 0xa0054, 0x100aa8, 0x5b00170
.long 0x982c0180, 0xa0058, 0x100ab0, 0x6d00180
.long 0x982e0190, 0xa005c, 0x100ab8, 0x7f00190
.long 0x983001a0, 0xa0060, 0x100bc0, 0x91001a0
.long 0x983201b0, 0xa0064, 0x100bc8, 0xa3001b0
.long 0x983401c0, 0xa0068, 0x100bd0, 0xb5001c0
.long 0x983601d0, 0xa006c, 0x100bd8, 0xc7001d0
.long 0x983801e0, 0xa0070, 0x100ce0, 0xd9001e0
.long 0x983a01f0, 0xa0074, 0x100ce8, 0xeb001f0
.long 0x983c0200, 0xa0078, 0x100cf0, 0xfd00200
.long 0x983e0210, 0xa007c, 0x100cf8, 0x10f00210
.long 0x98400240, 0x200, 0x201280, 0x200240
.long 0x98420250, 0x204, 0x201288, 0x1400250
.long 0x98440260, 0x208, 0x201290, 0x2600260
.long 0x98460270, 0x20c, 0x201298, 0x3800270
.long 0x98480280, 0x210, 0x2013a0, 0x4a00280
.long 0x984a0290, 0x214, 0x2013a8, 0x5c00290
.long 0x984c02a0, 0x218, 0x2013b0, 0x6e002a0
.long 0x984e02b0, 0x21c, 0x2013b8, 0x80002b0
.long 0x985002c0, 0x220, 0x2014c0, 0x92002c0
.long 0x985202d0, 0x224, 0x2014c8, 0xa4002d0
.long 0x985402e0, 0x228, 0x2014d0, 0xb6002e0
.long 0x985602f0, 0x22c, 0x2014d8, 0xc8002f0
.long 0x98580300, 0x230, 0x2015e0, 0xda00300
.long 0x985a0310, 0x234, 0x2015e8, 0xec00310
.long 0x985c0320, 0x238, 0x2015f0, 0xfe00320
.long 0x985e0330, 0x23c, 0x2015f8, 0x11000330
.long 0x98600360, 0x240, 0x301c00, 0x300360
.long 0x98620370, 0x244, 0x301c08, 0x1500370
.long 0x98640380, 0x248, 0x301c10, 0x2700380
.long 0x98660390, 0x24c, 0x301c18, 0x3900390
.long 0x986803a0, 0x250, 0x301d20, 0x4b003a0
.long 0x986a03b0, 0x254, 0x301d28, 0x5d003b0
.long 0x986c03c0, 0x258, 0x301d30, 0x6f003c0
.long 0x986e03d0, 0x25c, 0x301d38, 0x81003d0
.long 0x987003e0, 0x260, 0x301e40, 0x93003e0
.long 0x987203f0, 0x264, 0x301e48, 0xa5003f0
.long 0x98740400, 0x268, 0x301e50, 0xb700400
.long 0x98760410, 0x26c, 0x301e58, 0xc900410
.long 0x98780420, 0x270, 0x301f60, 0xdb00420
.long 0x987a0430, 0x274, 0x301f68, 0xed00430
.long 0x987c0440, 0x278, 0x301f70, 0xff00440
.long 0x987e0450, 0x27c, 0x301f78, 0x11100450
.long 0x120, 0x98000000, 0x0, 0x0
.long 0x240, 0x98400120, 0x0, 0x0
.long 0x360, 0x98800240, 0x0, 0x0
.long 0x480, 0x98c00360, 0x0, 0x0
.long 0x5a0, 0x99000480, 0x0, 0x0
.long 0x6c0, 0x994005a0, 0x0, 0x0
.long 0x7e0, 0x998006c0, 0x0, 0x0
.long 0x900, 0x99c007e0, 0x0, 0x0
.long 0xa20, 0x98100900, 0x0, 0x0
.long 0xb40, 0x98500a20, 0x0, 0x0
.long 0xc60, 0x98900a20, 0x0, 0x0
.long 0xd80, 0x98d00a20, 0x0, 0x0
.long 0xea0, 0x99100a20, 0x0, 0x0
.long 0xfc0, 0x99500a20, 0x0, 0x0
.long 0x10e0, 0x99900a20, 0x0, 0x0
.long 0x0, 0x99d00a20, 0x0, 0x0
.long 0x100130, 0x98080010, 0x0, 0x0
.long 0x100250, 0x98480130, 0x0, 0x0
.long 0x100370, 0x98880250, 0x0, 0x0
.long 0x100490, 0x98c80370, 0x0, 0x0
.long 0x1005b0, 0x99080490, 0x0, 0x0
.long 0x1006d0, 0x994805b0, 0x0, 0x0
.long 0x1007f0, 0x998806d0, 0x0, 0x0
.long 0x100910, 0x99c807f0, 0x0, 0x0
.long 0x100a30, 0x98180910, 0x0, 0x0
.long 0x100b50, 0x98580a30, 0x0, 0x0
.long 0x100c70, 0x98980a30, 0x0, 0x0
.long 0x100d90, 0x98d80a30, 0x0, 0x0
.long 0x100eb0, 0x99180a30, 0x0, 0x0
.long 0x100fd0, 0x99580a30, 0x0, 0x0
.long 0x1010f0, 0x99980a30, 0x0, 0x0
.long 0x100010, 0x99d80a30, 0x0, 0x0
.long 0x200140, 0x98040020, 0x0, 0x0
.long 0x200260, 0x98440140, 0x0, 0x0
.long 0x200380, 0x98840260, 0x0, 0x0
.long 0x2004a0, 0x98c40380, 0x0, 0x0
.long 0x2005c0, 0x990404a0, 0x0, 0x0
.long 0x2006e0, 0x994405c0, 0x0, 0x0
.long 0x200800, 0x998406e0, 0x0, 0x0
.long 0x200920, 0x99c40800, 0x0, 0x0
.long 0x200a40, 0x98140920, 0x0, 0x0
.long 0x200b60, 0x98540a40, 0x0, 0x0
.long 0x200c80, 0x98940a40, 0x0, 0x0
.long 0x200da0, 0x98d40a40, 0x0, 0x0
.long 0x200ec0, 0x99140a40, 0x0, 0x0
.long 0x200fe0, 0x99540a40, 0x0, 0x0
.long 0x201100, 0x99940a40, 0x0, 0x0
.long 0x200020, 0x99d40a40, 0x0, 0x0
.long 0x300150, 0x980c0030, 0x0, 0x0
.long 0x300270, 0x984c0150, 0x0, 0x0
.long 0x300390, 0x988c0270, 0x0, 0x0
.long 0x3004b0, 0x98cc0390, 0x0, 0x0
.long 0x3005d0, 0x990c04b0, 0x0, 0x0
.long 0x3006f0, 0x994c05d0, 0x0, 0x0
.long 0x300810, 0x998c06f0, 0x0, 0x0
.long 0x300930, 0x99cc0810, 0x0, 0x0
.long 0x300a50, 0x981c0930, 0x0, 0x0
.long 0x300b70, 0x985c0a50, 0x0, 0x0
.long 0x300c90, 0x989c0a50, 0x0, 0x0
.long 0x300db0, 0x98dc0a50, 0x0, 0x0
.long 0x300ed0, 0x991c0a50, 0x0, 0x0
.long 0x300ff0, 0x995c0a50, 0x0, 0x0
.long 0x301110, 0x999c0a50, 0x0, 0x0
.long 0x300030, 0x99dc0a50, 0x0, 0x0
.long 0x2f40, 0x1203180, 0x6c026d0, 0x9002910
.long 0x1202f44, 0x2403184, 0x7e02764, 0xa2029a4
.long 0x2402f48, 0x3603188, 0x90027f8, 0x2a38
.long 0x3602f4c, 0x480318c, 0xa20288c, 0x1202acc
.long 0x4802f50, 0x5a03190, 0x2920, 0x3602b60
.long 0x5a02f54, 0x6c03194, 0x12029b4, 0x4802bf4
.long 0x6c02f58, 0x7e03198, 0x2402a48, 0x5a02c88
.long 0x7e02f5c, 0x900319c, 0x3602adc, 0x6c02d1c
.long 0x9002f60, 0xa2031a0, 0x4802b70, 0x7e02db0
.long 0xa202f64, 0x31a4, 0x5a02c04, 0x9002e44
.long 0x2f68, 0x24031a8, 0x6c02c98, 0xa202ed8
.long 0x1202f6c, 0x36031ac, 0x7e02d2c, 0x266c
.long 0x2402f70, 0x48031b0, 0x9002dc0, 0x1202700
.long 0x3602f74, 0x5a031b4, 0xa202e54, 0x2402794
.long 0x4802f78, 0x6c031b8, 0x2ee8, 0x4802828
.long 0x5a02f7c, 0x7e031bc, 0x120267c, 0x5a028bc
.long 0x102fd0, 0x1303210, 0x6d02760, 0x91029a0
.long 0x1302fd4, 0x2503214, 0x7f027f4, 0xa302a34
.long 0x2502fd8, 0x3703218, 0x9102888, 0x102ac8
.long 0x3702fdc, 0x490321c, 0xa30291c, 0x1302b5c
.long 0x4902fe0, 0x5b03220, 0x1029b0, 0x3702bf0
.long 0x5b02fe4, 0x6d03224, 0x1302a44, 0x4902c84
.long 0x6d02fe8, 0x7f03228, 0x2502ad8, 0x5b02d18
.long 0x7f02fec, 0x910322c, 0x3702b6c, 0x6d02dac
.long 0x9102ff0, 0xa303230, 0x4902c00, 0x7f02e40
.long 0xa302ff4, 0x103234, 0x5b02c94, 0x9102ed4
.long 0x102ff8, 0x2503238, 0x6d02d28, 0xa302668
.long 0x1302ffc, 0x370323c, 0x7f02dbc, 0x1026fc
.long 0x2503000, 0x4903240, 0x9102e50, 0x1302790
.long 0x3703004, 0x5b03244, 0xa302ee4, 0x2502824
.long 0x4903008, 0x6d03248, 0x102678, 0x49028b8
.long 0x5b0300c, 0x7f0324c, 0x130270c, 0x5b0294c
.long 0x203060, 0x14032a0, 0x6e027f0, 0x9202a30
.long 0x1403064, 0x26032a4, 0x8002884, 0xa402ac4
.long 0x2603068, 0x38032a8, 0x9202918, 0x202b58
.long 0x380306c, 0x4a032ac, 0xa4029ac, 0x1402bec
.long 0x4a03070, 0x5c032b0, 0x202a40, 0x3802c80
.long 0x5c03074, 0x6e032b4, 0x1402ad4, 0x4a02d14
.long 0x6e03078, 0x80032b8, 0x2602b68, 0x5c02da8
.long 0x800307c, 0x92032bc, 0x3802bfc, 0x6e02e3c
.long 0x9203080, 0xa4032c0, 0x4a02c90, 0x8002ed0
.long 0xa403084, 0x2032c4, 0x5c02d24, 0x9202664
.long 0x203088, 0x26032c8, 0x6e02db8, 0xa4026f8
.long 0x140308c, 0x38032cc, 0x8002e4c, 0x20278c
.long 0x2603090, 0x4a032d0, 0x9202ee0, 0x1402820
.long 0x3803094, 0x5c032d4, 0xa402674, 0x26028b4
.long 0x4a03098, 0x6e032d8, 0x202708, 0x4a02948
.long 0x5c0309c, 0x80032dc, 0x140279c, 0x5c029dc
.long 0x3030f0, 0x1503330, 0x6f02880, 0x9302ac0
.long 0x15030f4, 0x2703334, 0x8102914, 0xa502b54
.long 0x27030f8, 0x3903338, 0x93029a8, 0x302be8
.long 0x39030fc, 0x4b0333c, 0xa502a3c, 0x1502c7c
.long 0x4b03100, 0x5d03340, 0x302ad0, 0x3902d10
.long 0x5d03104, 0x6f03344, 0x1502b64, 0x4b02da4
.long 0x6f03108, 0x8103348, 0x2702bf8, 0x5d02e38
.long 0x810310c, 0x930334c, 0x3902c8c, 0x6f02ecc
.long 0x9303110, 0xa503350, 0x4b02d20, 0x8102660
.long 0xa503114, 0x303354, 0x5d02db4, 0x93026f4
.long 0x303118, 0x2703358, 0x6f02e48, 0xa502788
.long 0x150311c, 0x390335c, 0x8102edc, 0x30281c
.long 0x2703120, 0x4b03360, 0x9302670, 0x15028b0
.long 0x3903124, 0x5d03364, 0xa502704, 0x2702944
.long 0x4b03128, 0x6f03368, 0x302798, 0x4b029d8
.long 0x5d0312c, 0x810336c, 0x150282c, 0x5d02a6c
.long 0x24033c0, 0x6c03010, 0x2640, 0x0
.long 0x36033c4, 0x7e030a4, 0x426d0, 0x0
.long 0x48033c8, 0x9003138, 0x82760, 0x0
.long 0x5a033cc, 0xa2031cc, 0xc27f0, 0x0
.long 0x6c033d0, 0x3260, 0x102880, 0x0
.long 0x7e033d4, 0x12032f4, 0x142910, 0x0
.long 0x90033d8, 0x2403388, 0x1829a0, 0x0
.long 0xa2033dc, 0x360341c, 0x1c2a30, 0x0
.long 0x33e0, 0x5a034b0, 0x202ac0, 0x0
.long 0x12033e4, 0x6c02fa4, 0x242b50, 0x0
.long 0x24033e8, 0x7e030a0, 0x282be0, 0x0
.long 0x36033ec, 0x9003134, 0x2c2c70, 0x0
.long 0x48033f0, 0xa2031c8, 0x302d00, 0x0
.long 0x5a033f4, 0x325c, 0x342d90, 0x0
.long 0x6c033f8, 0x12032f0, 0x382e20, 0x0
.long 0x7e033fc, 0x2403384, 0x3c2eb0, 0x0
.long 0x25033c0, 0x6d03418, 0x402650, 0x0
.long 0x37033c4, 0x7f034ac, 0x4426e0, 0x0
.long 0x49033c8, 0x9102fa0, 0x482770, 0x0
.long 0x5b033cc, 0xa303034, 0x4c2800, 0x0
.long 0x6d033d0, 0x103130, 0x502890, 0x0
.long 0x7f033d4, 0x13031c4, 0x542920, 0x0
.long 0x91033d8, 0x2503258, 0x5829b0, 0x0
.long 0xa3033dc, 0x37032ec, 0x5c2a40, 0x0
.long 0x1033e0, 0x5b03380, 0x602ad0, 0x0
.long 0x13033e4, 0x6d03414, 0x642b60, 0x0
.long 0x25033e8, 0x7f034a8, 0x682bf0, 0x0
.long 0x37033ec, 0x9102f9c, 0x6c2c80, 0x0
.long 0x49033f0, 0xa303030, 0x702d10, 0x0
.long 0x5b033f4, 0x1030c4, 0x742da0, 0x0
.long 0x6d033f8, 0x13031c0, 0x782e30, 0x0
.long 0x7f033fc, 0x2503254, 0x7c2ec0, 0x0
.long 0x2603450, 0x6e032e8, 0x802660, 0x0
.long 0x3803454, 0x800337c, 0x8426f0, 0x0
.long 0x4a03458, 0x9203410, 0x882780, 0x0
.long 0x5c0345c, 0xa4034a4, 0x8c2810, 0x0
.long 0x6e03460, 0x202f98, 0x9028a0, 0x0
.long 0x8003464, 0x140302c, 0x942930, 0x0
.long 0x9203468, 0x26030c0, 0x9829c0, 0x0
.long 0xa40346c, 0x3803154, 0x9c2a50, 0x0
.long 0x203470, 0x5c03250, 0xa02ae0, 0x0
.long 0x1403474, 0x6e032e4, 0xa42b70, 0x0
.long 0x2603478, 0x8003378, 0xa82c00, 0x0
.long 0x380347c, 0x920340c, 0xac2c90, 0x0
.long 0x4a03480, 0xa4034a0, 0xb02d20, 0x0
.long 0x5c03484, 0x202f94, 0xb42db0, 0x0
.long 0x6e03488, 0x1403028, 0xb82e40, 0x0
.long 0x800348c, 0x26030bc, 0xbc2ed0, 0x0
.long 0x2703450, 0x6f03150, 0xc02670, 0x0
.long 0x3903454, 0x81031e4, 0xc42700, 0x0
.long 0x4b03458, 0x93032e0, 0xc82790, 0x0
.long 0x5d0345c, 0xa503374, 0xcc2820, 0x0
.long 0x6f03460, 0x303408, 0xd028b0, 0x0
.long 0x8103464, 0x150349c, 0xd42940, 0x0
.long 0x9303468, 0x2702f90, 0xd829d0, 0x0
.long 0xa50346c, 0x3903024, 0xdc2a60, 0x0
.long 0x303470, 0x5d030b8, 0xe02af0, 0x0
.long 0x1503474, 0x6f0314c, 0xe42b80, 0x0
.long 0x2703478, 0x81031e0, 0xe82c10, 0x0
.long 0x390347c, 0x9303274, 0xec2ca0, 0x0
.long 0x4b03480, 0xa503370, 0xf02d30, 0x0
.long 0x5d03484, 0x303404, 0xf42dc0, 0x0
.long 0x6f03488, 0x1503498, 0xf82e50, 0x0
.long 0x810348c, 0x2702f8c, 0xfc2ee0, 0x0
L_ctab:
.long 0xffffffff, 0xffffff, 0xffff, 0xffff, 0xffffffff, 0x1fff, 0x11111111, 0x11111111, 0x7fff7fff, 0x80008000, 0xffff0000, 0x0, 0x2800000, 0x280, 0x43800000, 0x41000000, 0x40004000, 0x1, 0xa, 0x3a38aa3b
.size L_tab, .-L_tab
.section .rodata,"a"
.p2align 6
.amdhsa_kernel standalone__factorization_afm__recsys_kernel
  .amdhsa_next_free_vgpr 384
  .amdhsa_next_free_sgpr 102
  .amdhsa_accum_offset 256
  .amdhsa_group_segment_fixed_size 0
  .amdhsa_kernarg_size 88
  .amdhsa_user_sgpr_count 2
  .amdhsa_user_sgpr_kernarg_segment_ptr 1
  .amdhsa_system_sgpr_workgroup_id_x 1
.end_amdhsa_kernel
```

```asm
; @launch grid=(256,1,1) block=(256,1,1) lds=116992
.amdgcn_target "amdgcn-amd-amdhsa--gfx950"
.text
.globl standalone__factorization_afm__recsys_kernel
.p2align 12
.fill 832, 4, 0xbf800000
.p2align 8
.type standalone__factorization_afm__recsys_kernel,@function
standalone__factorization_afm__recsys_kernel:
    s_cmp_ge_u32 s2, 256
    s_cbranch_scc1 L_end
    s_load_dwordx16 s[16:31], s[0:1], 0
    s_load_dwordx2 s[32:33], s[0:1], 64
    s_getpc_b64 s[96:97]
L_pc:
    v_and_b32 v1, 63, v0
    v_lshlrev_b32 v120, 4, v1
    v_add_u32 v120, L_tab-L_pc, v120
    global_load_dwordx4 v[128:131], v120, s[96:97]
    s_bfe_u32 s7, s2, 0x20003
    s_lshl_b32 s7, s7, 13
    v_lshl_add_u32 v200, v0, 5, s7
    v_lshrrev_b32 v2, 6, v0
    v_min_u32 v200, L_end-L_pc, v200
    v_readfirstlane_b32 s3, v2
    global_load_dword v251, v200, s[96:97]
    global_load_dwordx2 v[132:133], v120, s[96:97] offset:1024
    global_load_dwordx4 v[232:235], v120, s[96:97] offset:2048
    global_load_dwordx3 v[236:238], v120, s[96:97] offset:3072
    v_bfe_u32 v4, v0, 4, 2
    s_and_b32 s4, s2, 7
    s_lshr_b32 s6, s2, 3
    s_lshl_b32 s4, s4, 5
    s_add_u32 s4, s4, s6
    s_lshl2_add_u32 s4, s4, s3
    s_mul_i32 s6, s4, 104
    s_add_u32 s7, s6, 76
    v_lshlrev_b32 v123, 4, v0
    v_and_b32 v14, 0xf0, v123
    v_mad_u32_u24 v121, v4, 28, s6
    v_and_b32 v126, 31, v0
    v_lshlrev_b32 v125, 6, v2
    v_min_u32 v122, s7, v121
    v_lshl_or_b32 v126, v126, 1, v125
    v_lshlrev_b32 v125, 2, v1
    v_add_u32 v112, 4096, v123
    v_add_u32 v113, 12288, v123
    v_add_u32 v114, 20480, v123
    v_add_u32 v115, 28672, v123
    s_waitcnt lgkmcnt(0)
    global_load_dwordx4 v[204:207], v121, s[16:17]
    global_load_dwordx3 v[208:210], v122, s[16:17] offset:16
    s_barrier
    global_load_dwordx4 v[48:51], v112, s[24:25] offset:-4096
    global_load_dwordx4 v[52:55], v112, s[24:25] offset:0
    global_load_dwordx4 v[56:59], v113, s[24:25] offset:-4096
    global_load_dwordx4 v[60:63], v113, s[24:25] offset:0
    global_load_dwordx4 v[64:67], v114, s[24:25] offset:-4096
    global_load_dwordx4 v[68:71], v114, s[24:25] offset:0
    global_load_dwordx4 v[72:75], v115, s[24:25] offset:-4096
    global_load_dwordx4 v[76:79], v115, s[24:25] offset:0
    global_load_dwordx4 v[220:223], v14, s[28:29]
    global_load_ushort v13, v126, s[28:29]
    global_load_ushort v12, v126, s[26:27]
    global_load_dword v252, v125, s[30:31]
    s_add_u32 s94, s96, L_ctab-L_pc
    s_addc_u32 s95, s97, 0
    s_load_dwordx16 s[36:51], s[94:95], 0
    s_load_dwordx4 s[52:55], s[94:95], 64
    s_mov_b32 s56, s18
    s_mov_b32 s57, s19
    s_mov_b32 s58, 25600000
    s_mov_b32 s59, 0x00020000
    s_mul_i32 s5, s3, 19008
    s_lshr_b32 s7, s3, 1
    s_mul_i32 s6, s3, 1152
    s_lshl_b32 s7, s7, 7
    s_add_u32 s6, s6, s7
    s_lshl_b32 s8, s3, 7
    s_add_u32 s5, s5, 40960
    v_lshlrev_b32 v127, 4, v1
    v_lshl_add_u32 v3, v2, 2, v127
    s_mov_b64 exec, 0
    s_cmp_eq_u32 s3, 0
    s_cbranch_scc1 L_pad0
    s_cmp_eq_u32 s3, 1
    s_cbranch_scc1 L_pad1
    s_cmp_eq_u32 s3, 2
    s_cbranch_scc1 L_pad2
    s_branch L_pad3
L_hopret:
    s_mov_b64 exec, -1
    s_waitcnt vmcnt(18)
    v_add_u32_sdwa v5, v128, s6 dst_sel:DWORD dst_unused:UNUSED_PAD src0_sel:WORD_0 src1_sel:DWORD
    s_waitcnt vmcnt(13)
    v_lshl_add_u32 v204, v204, 8, v14
    v_lshl_add_u32 v205, v205, 8, v14
    v_lshl_add_u32 v206, v206, 8, v14
    v_lshl_add_u32 v207, v207, 8, v14
    buffer_load_dwordx4 v[144:147], v204, s[56:59], 0 offen
    buffer_load_dwordx4 v[148:151], v205, s[56:59], 0 offen
    buffer_load_dwordx4 v[152:155], v206, s[56:59], 0 offen
    buffer_load_dwordx4 v[156:159], v207, s[56:59], 0 offen
    s_waitcnt vmcnt(16)
    v_lshl_add_u32 v208, v208, 8, v14
    v_lshl_add_u32 v209, v209, 8, v14
    v_lshl_add_u32 v210, v210, 8, v14
    v_add_u32_sdwa v7, v128, s8 dst_sel:DWORD dst_unused:UNUSED_PAD src0_sel:WORD_1 src1_sel:DWORD
    v_add_u32_sdwa v8, v129, s8 dst_sel:DWORD dst_unused:UNUSED_PAD src0_sel:WORD_0 src1_sel:DWORD
    v_lshrrev_b32 v9, 16, v129
    v_and_b32 v6, 0xffff, v130
    v_lshrrev_b32 v15, 16, v130
    v_lshrrev_b32 v0, 16, v130
    v_add_u32_sdwa v203, v131, s5 dst_sel:DWORD dst_unused:UNUSED_PAD src0_sel:WORD_0 src1_sel:DWORD
    v_add_u32_sdwa v246, v131, s5 dst_sel:DWORD dst_unused:UNUSED_PAD src0_sel:WORD_1 src1_sel:DWORD
    v_add_u32_sdwa v201, v132, s5 dst_sel:DWORD dst_unused:UNUSED_PAD src0_sel:WORD_0 src1_sel:DWORD
    v_add_u32_sdwa v245, v132, s5 dst_sel:DWORD dst_unused:UNUSED_PAD src0_sel:WORD_1 src1_sel:DWORD
    v_add_u32_sdwa v202, v133, s5 dst_sel:DWORD dst_unused:UNUSED_PAD src0_sel:WORD_0 src1_sel:DWORD
    v_lshrrev_b32 v10, 16, v133
    s_mov_b32 s13, 0xffff0000
    s_mov_b32 s90, 0x11111111
    s_mov_b32 s91, 0x11111111
L_wconv:
    s_waitcnt vmcnt(15)
    v_lshlrev_b32 v96, 16, v48
    v_and_b32 v97, s13, v48
    v_lshlrev_b32 v98, 16, v49
    v_and_b32 v99, s13, v49
    v_lshlrev_b32 v100, 16, v50
    v_and_b32 v101, s13, v50
    v_lshlrev_b32 v102, 16, v51
    v_and_b32 v103, s13, v51
    v_cvt_pkrtz_f16_f32 v16, v96, v97
    v_cvt_pkrtz_f16_f32 v17, v98, v99
    v_cvt_pkrtz_f16_f32 v18, v100, v101
    v_cvt_pkrtz_f16_f32 v19, v102, v103
    ds_write_b128 v5, v[16:19] offset:0
    v_or_b32 v248, v16, v17
    v_or3_b32 v248, v248, v18, v19
    s_waitcnt vmcnt(14)
    v_lshlrev_b32 v104, 16, v52
    v_and_b32 v105, s13, v52
    v_lshlrev_b32 v106, 16, v53
    v_and_b32 v107, s13, v53
    v_lshlrev_b32 v108, 16, v54
    v_and_b32 v109, s13, v54
    v_lshlrev_b32 v110, 16, v55
    v_and_b32 v111, s13, v55
    v_cvt_pkrtz_f16_f32 v20, v104, v105
    v_cvt_pkrtz_f16_f32 v21, v106, v107
    v_cvt_pkrtz_f16_f32 v22, v108, v109
    v_cvt_pkrtz_f16_f32 v23, v110, v111
    ds_write_b128 v5, v[20:23] offset:4736
    v_or3_b32 v248, v248, v20, v21
    v_or3_b32 v248, v248, v22, v23
    s_waitcnt vmcnt(13)
    v_lshlrev_b32 v96, 16, v56
    v_and_b32 v97, s13, v56
    v_lshlrev_b32 v98, 16, v57
    v_and_b32 v99, s13, v57
    v_lshlrev_b32 v100, 16, v58
    v_and_b32 v101, s13, v58
    v_lshlrev_b32 v102, 16, v59
    v_and_b32 v103, s13, v59
    v_cvt_pkrtz_f16_f32 v24, v96, v97
    v_cvt_pkrtz_f16_f32 v25, v98, v99
    v_cvt_pkrtz_f16_f32 v26, v100, v101
    v_cvt_pkrtz_f16_f32 v27, v102, v103
    ds_write_b128 v5, v[24:27] offset:9472
    v_or3_b32 v248, v248, v24, v25
    v_or3_b32 v248, v248, v26, v27
    s_waitcnt vmcnt(12)
    v_lshlrev_b32 v104, 16, v60
    v_and_b32 v105, s13, v60
    v_lshlrev_b32 v106, 16, v61
    v_and_b32 v107, s13, v61
    v_lshlrev_b32 v108, 16, v62
    v_and_b32 v109, s13, v62
    v_lshlrev_b32 v110, 16, v63
    v_and_b32 v111, s13, v63
    v_cvt_pkrtz_f16_f32 v28, v104, v105
    v_cvt_pkrtz_f16_f32 v29, v106, v107
    v_cvt_pkrtz_f16_f32 v30, v108, v109
    v_cvt_pkrtz_f16_f32 v31, v110, v111
    ds_write_b128 v5, v[28:31] offset:14208
    v_or3_b32 v248, v248, v28, v29
    v_or3_b32 v248, v248, v30, v31
    s_waitcnt vmcnt(11)
    v_lshlrev_b32 v96, 16, v64
    v_and_b32 v97, s13, v64
    v_lshlrev_b32 v98, 16, v65
    v_and_b32 v99, s13, v65
    v_lshlrev_b32 v100, 16, v66
    v_and_b32 v101, s13, v66
    v_lshlrev_b32 v102, 16, v67
    v_and_b32 v103, s13, v67
    v_cvt_pkrtz_f16_f32 v32, v96, v97
    v_cvt_pkrtz_f16_f32 v33, v98, v99
    v_cvt_pkrtz_f16_f32 v34, v100, v101
    v_cvt_pkrtz_f16_f32 v35, v102, v103
    ds_write_b128 v5, v[32:35] offset:18944
    v_or3_b32 v248, v248, v32, v33
    s_waitcnt vmcnt(7)
    v_dot2_f32_bf16 v112, v48, v220, 0
    v_or3_b32 v248, v248, v34, v35
    v_dot2_f32_bf16 v113, v52, v220, 0
    v_dot2_f32_bf16 v112, v49, v221, v112
    v_dot2_f32_bf16 v113, v53, v221, v113
    v_dot2_f32_bf16 v112, v50, v222, v112
    v_dot2_f32_bf16 v113, v54, v222, v113
    v_dot2_f32_bf16 v112, v51, v223, v112
    v_dot2_f32_bf16 v113, v55, v223, v113
    v_dot2_f32_bf16 v114, v56, v220, 0
    v_dot2_f32_bf16 v115, v60, v220, 0
    v_lshlrev_b32 v104, 16, v68
    v_and_b32 v105, s13, v68
    v_lshlrev_b32 v106, 16, v69
    v_and_b32 v107, s13, v69
    v_lshlrev_b32 v108, 16, v70
    v_and_b32 v109, s13, v70
    v_lshlrev_b32 v110, 16, v71
    v_and_b32 v111, s13, v71
    v_cvt_pkrtz_f16_f32 v36, v104, v105
    v_cvt_pkrtz_f16_f32 v37, v106, v107
    v_cvt_pkrtz_f16_f32 v38, v108, v109
    v_cvt_pkrtz_f16_f32 v39, v110, v111
    ds_write_b128 v5, v[36:39] offset:23680
    v_or3_b32 v248, v248, v36, v37
    v_dot2_f32_bf16 v114, v57, v221, v114
    v_or3_b32 v248, v248, v38, v39
    v_dot2_f32_bf16 v115, v61, v221, v115
    v_dot2_f32_bf16 v114, v58, v222, v114
    v_dot2_f32_bf16 v115, v62, v222, v115
    v_dot2_f32_bf16 v114, v59, v223, v114
    v_dot2_f32_bf16 v115, v63, v223, v115
    v_add_f32_dpp v112, v112, v112 row_ror:8 row_mask:0xf bank_mask:0x3
    v_dot2_f32_bf16 v116, v64, v220, 0
    v_dot2_f32_bf16 v117, v68, v220, 0
    v_dot2_f32_bf16 v116, v65, v221, v116
    v_lshlrev_b32 v96, 16, v72
    v_and_b32 v97, s13, v72
    v_lshlrev_b32 v98, 16, v73
    v_and_b32 v99, s13, v73
    v_lshlrev_b32 v100, 16, v74
    v_and_b32 v101, s13, v74
    v_lshlrev_b32 v102, 16, v75
    v_and_b32 v103, s13, v75
    v_cvt_pkrtz_f16_f32 v40, v96, v97
    v_cvt_pkrtz_f16_f32 v41, v98, v99
    v_cvt_pkrtz_f16_f32 v42, v100, v101
    v_cvt_pkrtz_f16_f32 v43, v102, v103
    ds_write_b128 v5, v[40:43] offset:28416
    v_or3_b32 v248, v248, v40, v41
    v_dot2_f32_bf16 v117, v69, v221, v117
    v_or3_b32 v248, v248, v42, v43
    v_add_f32_dpp v112, v113, v113 row_ror:8 row_mask:0xf bank_mask:0xc
    v_add_f32_dpp v114, v114, v114 row_ror:8 row_mask:0xf bank_mask:0x3
    v_dot2_f32_bf16 v116, v66, v222, v116
    v_dot2_f32_bf16 v117, v70, v222, v117
    v_dot2_f32_bf16 v116, v67, v223, v116
    v_dot2_f32_bf16 v117, v71, v223, v117
    v_add_f32_dpp v114, v115, v115 row_ror:8 row_mask:0xf bank_mask:0xc
    v_add_f32_dpp v112, v112, v112 row_half_mirror row_mask:0xf bank_mask:0x5
    v_dot2_f32_bf16 v118, v72, v220, 0
    v_lshlrev_b32 v104, 16, v76
    v_and_b32 v105, s13, v76
    v_lshlrev_b32 v106, 16, v77
    v_and_b32 v107, s13, v77
    v_lshlrev_b32 v108, 16, v78
    v_and_b32 v109, s13, v78
    v_lshlrev_b32 v110, 16, v79
    v_and_b32 v111, s13, v79
    v_cvt_pkrtz_f16_f32 v44, v104, v105
    v_cvt_pkrtz_f16_f32 v45, v106, v107
    v_cvt_pkrtz_f16_f32 v46, v108, v109
    v_cvt_pkrtz_f16_f32 v47, v110, v111
    ds_write_b128 v5, v[44:47] offset:33152
    v_or3_b32 v248, v248, v44, v45
    v_dot2_f32_bf16 v119, v76, v220, 0
    v_or3_b32 v248, v248, v46, v47
    v_dot2_f32_bf16 v118, v73, v221, v118
    v_dot2_f32_bf16 v119, v77, v221, v119
    v_add_f32_dpp v112, v114, v114 row_half_mirror row_mask:0xf bank_mask:0xa
    v_add_f32_dpp v116, v116, v116 row_ror:8 row_mask:0xf bank_mask:0x3
    v_dot2_f32_bf16 v118, v74, v222, v118
    v_dot2_f32_bf16 v119, v78, v222, v119
    v_dot2_f32_bf16 v118, v75, v223, v118
    v_dot2_f32_bf16 v119, v79, v223, v119
    v_add_f32_dpp v116, v117, v117 row_ror:8 row_mask:0xf bank_mask:0xc
    v_add_f32_dpp v112, v112, v112 quad_perm:[1,0,3,2] row_mask:0xf bank_mask:0xf
    v_cmp_lt_u32 vcc, 31, v1
    v_add_f32_dpp v118, v118, v118 row_ror:8 row_mask:0xf bank_mask:0x3
    v_add_f32_dpp v116, v116, v116 row_half_mirror row_mask:0xf bank_mask:0x5
    s_waitcnt vmcnt(5)
    v_cndmask_b32 v120, v12, v13, vcc
    v_add_f32_dpp v118, v119, v119 row_ror:8 row_mask:0xf bank_mask:0xc
    v_add_f32_dpp v112, v112, v112 quad_perm:[2,3,0,1] row_mask:0xf bank_mask:0xf
    v_lshlrev_b32 v120, 16, v120
    v_add_f32_dpp v116, v118, v118 row_half_mirror row_mask:0xf bank_mask:0xa
    v_ldexp_f32 v120, v120, v9
    ds_write_b32 v3, v248 offset:39424
    v_add_f32_dpp v116, v116, v116 quad_perm:[1,0,3,2] row_mask:0xf bank_mask:0xf
    ds_write_b32 v8, v120 offset:37888
    s_nop 0
    v_add_f32_dpp v113, v116, v116 quad_perm:[2,3,0,1] row_mask:0xf bank_mask:0xf
    s_mov_b64 exec, s[90:91]
    ds_write_b64 v7, v[112:113]
    s_mov_b64 exec, -1
    s_waitcnt lgkmcnt(0)
    s_barrier
    ds_read_b128 v[112:115], v127 offset:39424
    ds_read_b64_tr_b16 a[0:1], v6 offset:0
    ds_read_b64_tr_b16 a[2:3], v6 offset:1152
    ds_read_b64_tr_b16 a[4:5], v6 offset:9472
    ds_read_b64_tr_b16 a[6:7], v6 offset:10624
    ds_read_b64_tr_b16 a[8:9], v6 offset:18944
    ds_read_b64_tr_b16 a[10:11], v6 offset:20096
    ds_read_b64_tr_b16 a[12:13], v6 offset:28416
    ds_read_b64_tr_b16 a[14:15], v6 offset:29568
    ds_read_b64_tr_b16 a[16:17], v6 offset:32
    ds_read_b64_tr_b16 a[18:19], v6 offset:1184
    ds_read_b64_tr_b16 a[20:21], v6 offset:9504
    ds_read_b64_tr_b16 a[22:23], v6 offset:10656
    ds_read_b64_tr_b16 a[24:25], v6 offset:18976
    ds_read_b64_tr_b16 a[26:27], v6 offset:20128
    ds_read_b64_tr_b16 a[28:29], v6 offset:28448
    ds_read_b64_tr_b16 a[30:31], v6 offset:29600
    s_waitcnt lgkmcnt(15)
    v_or3_b32 v112, v112, v113, v114
    v_or_b32 v112, v112, v115
    v_and_b32 v121, s52, v112
    v_and_b32 v122, 0x20002000, v112
    v_cmp_ne_u32 vcc, 0, v121
    v_cmp_ge_u32 s[92:93], v122, s53
    s_cbranch_vccnz L_wfix
    s_cmp_eq_u64 s[92:93], 0
    s_cbranch_scc1 L_wfix
    buffer_load_dwordx4 v[160:163], v208, s[56:59], 0 offen
    buffer_load_dwordx4 v[164:167], v209, s[56:59], 0 offen
    buffer_load_dwordx4 v[168:171], v210, s[56:59], 0 offen
L_econv:
    s_waitcnt vmcnt(6)
    v_lshl_add_u32 v96, v144, 16, s48
    v_add_u32_sdwa v97, v144, s49 dst_sel:WORD_1 dst_unused:UNUSED_PAD src0_sel:WORD_1 src1_sel:DWORD
    v_lshl_add_u32 v98, v145, 16, s48
    v_add_u32_sdwa v99, v145, s49 dst_sel:WORD_1 dst_unused:UNUSED_PAD src0_sel:WORD_1 src1_sel:DWORD
    v_lshl_add_u32 v100, v146, 16, s48
    v_add_u32_sdwa v101, v146, s49 dst_sel:WORD_1 dst_unused:UNUSED_PAD src0_sel:WORD_1 src1_sel:DWORD
    v_lshl_add_u32 v102, v147, 16, s48
    v_add_u32_sdwa v103, v147, s49 dst_sel:WORD_1 dst_unused:UNUSED_PAD src0_sel:WORD_1 src1_sel:DWORD
    v_cvt_pkrtz_f16_f32 v172, v96, v97
    v_max_f32 v248, |v96|, |v97|
    v_cvt_pkrtz_f16_f32 v173, v98, v99
    v_max_f32 v249, |v98|, |v99|
    v_cvt_pkrtz_f16_f32 v174, v100, v101
    v_max3_f32 v248, v248, |v100|, |v101|
    v_cvt_pkrtz_f16_f32 v175, v102, v103
    v_max3_f32 v249, v249, |v102|, |v103|
    ds_write_b128 v203, v[172:175] offset:0
    ds_read_b128 v[16:19], v0 offset:37888
    ds_read_b128 v[20:23], v0 offset:37952
    ds_read_b128 v[24:27], v0 offset:38016
    s_waitcnt vmcnt(5)
    v_lshl_add_u32 v104, v148, 16, s48
    v_add_u32_sdwa v105, v148, s49 dst_sel:WORD_1 dst_unused:UNUSED_PAD src0_sel:WORD_1 src1_sel:DWORD
    v_lshl_add_u32 v106, v149, 16, s48
    v_add_u32_sdwa v107, v149, s49 dst_sel:WORD_1 dst_unused:UNUSED_PAD src0_sel:WORD_1 src1_sel:DWORD
    v_lshl_add_u32 v108, v150, 16, s48
    v_add_u32_sdwa v109, v150, s49 dst_sel:WORD_1 dst_unused:UNUSED_PAD src0_sel:WORD_1 src1_sel:DWORD
    v_lshl_add_u32 v110, v151, 16, s48
    v_add_u32_sdwa v111, v151, s49 dst_sel:WORD_1 dst_unused:UNUSED_PAD src0_sel:WORD_1 src1_sel:DWORD
    v_cvt_pkrtz_f16_f32 v176, v104, v105
    v_max3_f32 v248, v248, |v104|, |v105|
    v_cvt_pkrtz_f16_f32 v177, v106, v107
    v_max3_f32 v249, v249, |v106|, |v107|
    v_cvt_pkrtz_f16_f32 v178, v108, v109
    v_max3_f32 v248, v248, |v108|, |v109|
    v_cvt_pkrtz_f16_f32 v179, v110, v111
    v_max3_f32 v249, v249, |v110|, |v111|
    ds_write_b128 v203, v[176:179] offset:1152
    s_waitcnt vmcnt(4)
    v_lshl_add_u32 v96, v152, 16, s48
    v_add_u32_sdwa v97, v152, s49 dst_sel:WORD_1 dst_unused:UNUSED_PAD src0_sel:WORD_1 src1_sel:DWORD
    v_lshl_add_u32 v98, v153, 16, s48
    v_add_u32_sdwa v99, v153, s49 dst_sel:WORD_1 dst_unused:UNUSED_PAD src0_sel:WORD_1 src1_sel:DWORD
    v_lshl_add_u32 v100, v154, 16, s48
    v_add_u32_sdwa v101, v154, s49 dst_sel:WORD_1 dst_unused:UNUSED_PAD src0_sel:WORD_1 src1_sel:DWORD
    v_lshl_add_u32 v102, v155, 16, s48
    v_add_u32_sdwa v103, v155, s49 dst_sel:WORD_1 dst_unused:UNUSED_PAD src0_sel:WORD_1 src1_sel:DWORD
    v_cvt_pkrtz_f16_f32 v180, v96, v97
    v_cvt_pkrtz_f16_f32 v181, v98, v99
    v_cvt_pkrtz_f16_f32 v182, v100, v101
    v_cvt_pkrtz_f16_f32 v183, v102, v103
    ds_write_b128 v203, v[180:183] offset:2304
    s_waitcnt vmcnt(3)
    v_lshl_add_u32 v104, v156, 16, s48
    v_add_u32_sdwa v105, v156, s49 dst_sel:WORD_1 dst_unused:UNUSED_PAD src0_sel:WORD_1 src1_sel:DWORD
    v_lshl_add_u32 v106, v157, 16, s48
    v_add_u32_sdwa v107, v157, s49 dst_sel:WORD_1 dst_unused:UNUSED_PAD src0_sel:WORD_1 src1_sel:DWORD
    v_lshl_add_u32 v108, v158, 16, s48
    v_add_u32_sdwa v109, v158, s49 dst_sel:WORD_1 dst_unused:UNUSED_PAD src0_sel:WORD_1 src1_sel:DWORD
    v_lshl_add_u32 v110, v159, 16, s48
    v_add_u32_sdwa v111, v159, s49 dst_sel:WORD_1 dst_unused:UNUSED_PAD src0_sel:WORD_1 src1_sel:DWORD
    v_cvt_pkrtz_f16_f32 v184, v104, v105
    v_cvt_pkrtz_f16_f32 v185, v106, v107
    v_cvt_pkrtz_f16_f32 v186, v108, v109
    v_cvt_pkrtz_f16_f32 v187, v110, v111
    ds_write_b128 v203, v[184:187] offset:3456
    ds_read_b128 v[80:83], v246 offset:0
    ds_read_b128 v[128:131], v201 offset:0
    ds_read_b128 v[84:87], v246 offset:64
    ds_read_b128 v[132:135], v201 offset:64
    ds_read_b128 v[88:91], v246 offset:128
    ds_read_b128 v[136:139], v201 offset:128
    ds_read_b128 v[92:95], v246 offset:192
    ds_read_b128 v[140:143], v201 offset:192
    ds_read_b64_tr_b16 a[32:33], v6 offset:64
    ds_read_b64_tr_b16 a[34:35], v6 offset:1216
    ds_read_b64_tr_b16 a[36:37], v6 offset:9536
    ds_read_b64_tr_b16 a[38:39], v6 offset:10688
    ds_read_b64_tr_b16 a[40:41], v6 offset:19008
    ds_read_b64_tr_b16 a[42:43], v6 offset:20160
    ds_read_b64_tr_b16 a[44:45], v6 offset:28480
    ds_read_b64_tr_b16 a[46:47], v6 offset:29632
    v_max3_f32 v248, v248, |v96|, |v97|
    v_max3_f32 v249, v249, |v98|, |v99|
    v_max3_f32 v248, v248, |v100|, |v101|
    v_max3_f32 v249, v249, |v102|, |v103|
    v_max3_f32 v248, v248, |v104|, |v105|
    v_max3_f32 v249, v249, |v106|, |v107|
    v_max3_f32 v248, v248, |v108|, |v109|
    v_max3_f32 v249, v249, |v110|, |v111|
    s_waitcnt lgkmcnt(14)
    v_pk_mul_f16 v128, v128, v80
    v_pk_mul_f16 v129, v129, v81
    v_pk_mul_f16 v130, v130, v82
    v_pk_mul_f16 v131, v131, v83
    s_nop 1
    v_mfma_f32_16x16x32_f16 v[96:99], a[0:3], v[128:131], v[16:19]
    ds_read_b128 v[28:31], v0 offset:38080
    ds_read_b64_tr_b16 a[60:61], v6 offset:28512
    s_waitcnt lgkmcnt(14)
    v_pk_mul_f16 v132, v132, v84
    v_pk_mul_f16 v133, v133, v85
    v_mfma_f32_16x16x32_f16 v[100:103], a[16:19], v[128:131], v[20:23]
    ds_read_b64_tr_b16 a[62:63], v6 offset:29664
    ds_read_b64_tr_b16 a[56:57], v6 offset:19040
    v_pk_mul_f16 v134, v134, v86
    v_pk_mul_f16 v135, v135, v87
    s_waitcnt lgkmcnt(10)
    v_mfma_f32_16x16x32_f16 v[104:107], a[32:35], v[128:131], v[24:27]
    ds_read_b64_tr_b16 a[58:59], v6 offset:20192
    ds_read_b64_tr_b16 a[52:53], v6 offset:9568
    v_pk_mul_f16 v136, v136, v88
    v_pk_mul_f16 v137, v137, v89
    v_mfma_f32_16x16x32_f16 v[96:99], a[4:7], v[132:135], v[96:99]
    ds_read_b64_tr_b16 a[54:55], v6 offset:10720
    ds_read_b64_tr_b16 a[48:49], v6 offset:96
    v_pk_mul_f16 v138, v138, v90
    v_pk_mul_f16 v139, v139, v91
    v_mfma_f32_16x16x32_f16 v[100:103], a[20:23], v[132:135], v[100:103]
    ds_read_b64_tr_b16 a[50:51], v6 offset:1248
    ds_read_b128 v[48:51], v15 offset:38400
    v_pk_mul_f16 v140, v140, v92
    v_pk_mul_f16 v141, v141, v93
    s_waitcnt lgkmcnt(14)
    v_mfma_f32_16x16x32_f16 v[104:107], a[36:39], v[132:135], v[104:107]
    ds_read_b128 v[52:55], v15 offset:38464
    ds_read_b128 v[56:59], v15 offset:38528
    v_pk_mul_f16 v142, v142, v94
    v_pk_mul_f16 v143, v143, v95
    v_mov_b32_dpp v247, v246 row_ror:14 row_mask:0xf bank_mask:0xf
    ds_read_b128 v[156:159], v247 offset:192
    ds_read_b128 v[152:155], v247 offset:128
    ds_read_b128 v[148:151], v247 offset:64
    ds_read_b128 v[144:147], v247 offset:0
    v_mfma_f32_16x16x32_f16 v[96:99], a[8:11], v[136:139], v[96:99]
    ds_read_b128 v[32:35], v0 offset:38144
    ds_read_b64_tr_b16 a[76:77], v6 offset:28544
    ds_read2_b32 v[192:193], v10 offset0:0 offset1:8
    v_mov_b32 v251, 0xff800000
    v_mfma_f32_16x16x32_f16 v[100:103], a[24:27], v[136:139], v[100:103]
    ds_read_b64_tr_b16 a[78:79], v6 offset:29696
    ds_read_b64_tr_b16 a[72:73], v6 offset:19072
    s_waitcnt lgkmcnt(15)
    v_mfma_f32_16x16x32_f16 v[104:107], a[40:43], v[136:139], v[104:107]
    ds_read_b64_tr_b16 a[74:75], v6 offset:20224
    ds_read_b64_tr_b16 a[68:69], v6 offset:9600
    v_mfma_f32_16x16x32_f16 v[96:99], a[12:15], v[140:143], v[96:99]
    ds_read_b64_tr_b16 a[70:71], v6 offset:10752
    ds_read_b64_tr_b16 a[64:65], v6 offset:128
    ds_read_b64_tr_b16 a[66:67], v6 offset:1280
    v_mfma_f32_16x16x32_f16 v[100:103], a[28:31], v[140:143], v[100:103]
    ds_read_b128 v[60:63], v15 offset:38592
    ds_read_b128 v[36:39], v0 offset:38208
    v_mfma_f32_16x16x32_f16 v[104:107], a[44:47], v[140:143], v[104:107]
    ds_read_b64_tr_b16 a[92:93], v6 offset:28576
    ds_read_b64_tr_b16 a[94:95], v6 offset:29728
    s_waitcnt lgkmcnt(15)
    v_mfma_f32_16x16x32_f16 v[108:111], a[48:51], v[128:131], v[28:31]
    ds_read_b64_tr_b16 a[88:89], v6 offset:19104
    ds_read_b64_tr_b16 a[90:91], v6 offset:20256
    v_mul_f32 v184, |v96|, v48
    v_fma_f32 v184, |v97|, v49, v184
    v_mfma_f32_16x16x32_f16 v[108:111], a[52:55], v[132:135], v[108:111]
    ds_read_b64_tr_b16 a[84:85], v6 offset:9632
    ds_read_b64_tr_b16 a[86:87], v6 offset:10784
    ds_read_b64_tr_b16 a[80:81], v6 offset:160
    ds_read_b64_tr_b16 a[82:83], v6 offset:1312
    v_fma_f32 v184, |v98|, v50, v184
    v_fma_f32 v184, |v99|, v51, v184
    v_mfma_f32_16x16x32_f16 v[108:111], a[56:59], v[136:139], v[108:111]
    ds_read_b128 v[64:67], v15 offset:38656
    ds_read_b128 v[40:43], v0 offset:38272
    s_waitcnt lgkmcnt(15)
    v_pk_mul_f16 v144, v144, v80
    v_fma_f32 v184, |v100|, v52, v184
    v_mfma_f32_16x16x32_f16 v[108:111], a[60:63], v[140:143], v[108:111]
    ds_read_b64_tr_b16 a[108:109], v6 offset:28608
    ds_read_b64_tr_b16 a[110:111], v6 offset:29760
    v_and_b32 v253, s44, v252
    v_fma_f32 v184, |v101|, v53, v184
    s_waitcnt lgkmcnt(14)
    v_mfma_f32_16x16x32_f16 v[112:115], a[64:67], v[128:131], v[32:35]
    ds_read_b64_tr_b16 a[104:105], v6 offset:19136
    ds_read_b64_tr_b16 a[106:107], v6 offset:20288
    v_pk_mul_f16 v145, v145, v81
    v_fma_f32 v184, |v102|, v54, v184
    v_mfma_f32_16x16x32_f16 v[112:115], a[68:71], v[132:135], v[112:115]
    ds_read_b64_tr_b16 a[100:101], v6 offset:9664
    ds_read_b64_tr_b16 a[102:103], v6 offset:10816
    ds_read_b64_tr_b16 a[96:97], v6 offset:192
    ds_read_b64_tr_b16 a[98:99], v6 offset:1344
    v_pk_mul_f16 v146, v146, v82
    v_fma_f32 v184, |v103|, v55, v184
    v_mfma_f32_16x16x32_f16 v[112:115], a[72:75], v[136:139], v[112:115]
    ds_read_b128 v[68:71], v15 offset:38720
    ds_read_b128 v[44:47], v0 offset:38336
    v_pk_mul_f16 v147, v147, v83
    v_fma_f32 v184, |v104|, v56, v184
    v_mfma_f32_16x16x32_f16 v[112:115], a[76:79], v[140:143], v[112:115]
    ds_read_b64_tr_b16 a[124:125], v6 offset:28640
    ds_read_b64_tr_b16 a[126:127], v6 offset:29792
    v_pk_mul_f16 v148, v148, v84
    v_fma_f32 v184, |v105|, v57, v184
    s_waitcnt lgkmcnt(14)
    v_mfma_f32_16x16x32_f16 v[116:119], a[80:83], v[128:131], v[36:39]
    ds_read_b64_tr_b16 a[120:121], v6 offset:19168
    ds_read_b64_tr_b16 a[122:123], v6 offset:20320
    v_pk_mul_f16 v149, v149, v85
    v_fma_f32 v184, |v106|, v58, v184
    v_mfma_f32_16x16x32_f16 v[116:119], a[84:87], v[132:135], v[116:119]
    ds_read_b64_tr_b16 a[116:117], v6 offset:9696
    ds_read_b64_tr_b16 a[118:119], v6 offset:10848
    ds_read_b64_tr_b16 a[112:113], v6 offset:224
    ds_read_b64_tr_b16 a[114:115], v6 offset:1376
    v_pk_mul_f16 v150, v150, v86
    v_fma_f32 v184, |v107|, v59, v184
    v_mfma_f32_16x16x32_f16 v[116:119], a[88:91], v[136:139], v[116:119]
    ds_read_b128 v[72:75], v15 offset:38784
    ds_read_b128 v[76:79], v15 offset:38848
    v_pk_mul_f16 v151, v151, v87
    v_fma_f32 v184, |v108|, v60, v184
    v_mfma_f32_16x16x32_f16 v[116:119], a[92:95], v[140:143], v[116:119]
    v_pk_mul_f16 v152, v152, v88
    v_fma_f32 v184, |v109|, v61, v184
    s_waitcnt lgkmcnt(12)
    v_mfma_f32_16x16x32_f16 v[120:123], a[96:99], v[128:131], v[40:43]
    v_pk_mul_f16 v153, v153, v89
    v_fma_f32 v184, |v110|, v62, v184
    v_mfma_f32_16x16x32_f16 v[120:123], a[100:103], v[132:135], v[120:123]
    v_pk_mul_f16 v154, v154, v90
    v_fma_f32 v184, |v111|, v63, v184
    v_mfma_f32_16x16x32_f16 v[120:123], a[104:107], v[136:139], v[120:123]
    v_pk_mul_f16 v155, v155, v91
    v_fma_f32 v184, |v112|, v64, v184
    v_mfma_f32_16x16x32_f16 v[120:123], a[108:111], v[140:143], v[120:123]
    v_pk_mul_f16 v156, v156, v92
    v_fma_f32 v184, |v113|, v65, v184
    s_waitcnt lgkmcnt(2)
    v_mfma_f32_16x16x32_f16 v[124:127], a[112:115], v[128:131], v[44:47]
    v_pk_mul_f16 v157, v157, v93
    v_fma_f32 v184, |v114|, v66, v184
    v_mfma_f32_16x16x32_f16 v[124:127], a[116:119], v[132:135], v[124:127]
    v_pk_mul_f16 v158, v158, v94
    v_fma_f32 v184, |v115|, v67, v184
    v_mfma_f32_16x16x32_f16 v[124:127], a[120:123], v[136:139], v[124:127]
    v_pk_mul_f16 v159, v159, v95
    v_fma_f32 v184, |v116|, v68, v184
    v_mfma_f32_16x16x32_f16 v[124:127], a[124:127], v[140:143], v[124:127]
    v_mov_b32_dpp v247, v246 row_ror:13 row_mask:0xf bank_mask:0xf
    v_fma_f32 v184, |v117|, v69, v184
    v_mfma_f32_16x16x32_f16 v[96:99], a[0:3], v[144:147], v[16:19]
    ds_read_b128 v[140:143], v247 offset:192
    v_fma_f32 v184, |v118|, v70, v184
    v_mfma_f32_16x16x32_f16 v[96:99], a[4:7], v[148:151], v[96:99]
    ds_read_b128 v[136:139], v247 offset:128
    v_fma_f32 v184, |v119|, v71, v184
    v_mfma_f32_16x16x32_f16 v[96:99], a[8:11], v[152:155], v[96:99]
L_pad0:
    s_cbranch_execz L_hopret
    ds_read_b128 v[132:135], v247 offset:64
    s_waitcnt lgkmcnt(4)
    v_fma_f32 v184, |v120|, v72, v184
    v_mfma_f32_16x16x32_f16 v[96:99], a[12:15], v[156:159], v[96:99]
    ds_read_b128 v[128:131], v247 offset:0
    v_fma_f32 v184, |v121|, v73, v184
    v_mfma_f32_16x16x32_f16 v[100:103], a[16:19], v[144:147], v[20:23]
    v_pk_max_u16 v254, v253, v253 op_sel:[0,1] op_sel_hi:[1,0]
    v_fma_f32 v184, |v122|, v74, v184
    v_mfma_f32_16x16x32_f16 v[100:103], a[20:23], v[148:151], v[100:103]
    v_max_f32 v255, |v192|, |v193|
    v_fma_f32 v184, |v123|, v75, v184
    v_mfma_f32_16x16x32_f16 v[100:103], a[24:27], v[152:155], v[100:103]
    v_max_u32_dpp v254, v254, v254 row_ror:8 row_mask:0xf bank_mask:0xf
    s_waitcnt lgkmcnt(4)
    v_fma_f32 v184, |v124|, v76, v184
    v_mfma_f32_16x16x32_f16 v[100:103], a[28:31], v[156:159], v[100:103]
    v_max_u32_dpp v255, v255, v255 row_ror:8 row_mask:0xf bank_mask:0xf
    v_fma_f32 v184, |v125|, v77, v184
    v_mfma_f32_16x16x32_f16 v[104:107], a[32:35], v[144:147], v[24:27]
    s_waitcnt vmcnt(2)
    v_lshl_add_u32 v220, v160, 16, s48
    v_fma_f32 v184, |v126|, v78, v184
    v_mfma_f32_16x16x32_f16 v[104:107], a[36:39], v[148:151], v[104:107]
    v_add_u32_sdwa v221, v160, s49 dst_sel:WORD_1 dst_unused:UNUSED_PAD src0_sel:WORD_1 src1_sel:DWORD
    v_fma_f32 v184, |v127|, v79, v184
    v_mfma_f32_16x16x32_f16 v[104:107], a[40:43], v[152:155], v[104:107]
    v_lshl_add_u32 v222, v161, 16, s48
    v_mul_f32 v185, |v96|, v48
    v_mfma_f32_16x16x32_f16 v[104:107], a[44:47], v[156:159], v[104:107]
    v_add_u32_sdwa v223, v161, s49 dst_sel:WORD_1 dst_unused:UNUSED_PAD src0_sel:WORD_1 src1_sel:DWORD
    v_fma_f32 v185, |v97|, v49, v185
    v_mfma_f32_16x16x32_f16 v[108:111], a[48:51], v[144:147], v[28:31]
    v_lshl_add_u32 v224, v162, 16, s48
    v_fma_f32 v185, |v98|, v50, v185
    v_mfma_f32_16x16x32_f16 v[108:111], a[52:55], v[148:151], v[108:111]
    v_add_u32_sdwa v225, v162, s49 dst_sel:WORD_1 dst_unused:UNUSED_PAD src0_sel:WORD_1 src1_sel:DWORD
    v_fma_f32 v185, |v99|, v51, v185
    v_mfma_f32_16x16x32_f16 v[108:111], a[56:59], v[152:155], v[108:111]
    v_lshl_add_u32 v226, v163, 16, s48
    v_fma_f32 v185, |v100|, v52, v185
    v_mfma_f32_16x16x32_f16 v[108:111], a[60:63], v[156:159], v[108:111]
    s_waitcnt lgkmcnt(0)
    v_pk_mul_f16 v128, v128, v80
    v_fma_f32 v185, |v101|, v53, v185
    v_mfma_f32_16x16x32_f16 v[112:115], a[64:67], v[144:147], v[32:35]
    v_pk_mul_f16 v129, v129, v81
    v_fma_f32 v185, |v102|, v54, v185
    v_mfma_f32_16x16x32_f16 v[112:115], a[68:71], v[148:151], v[112:115]
    v_pk_mul_f16 v130, v130, v82
    v_fma_f32 v185, |v103|, v55, v185
    v_mfma_f32_16x16x32_f16 v[112:115], a[72:75], v[152:155], v[112:115]
    v_pk_mul_f16 v131, v131, v83
    v_fma_f32 v185, |v104|, v56, v185
    v_mfma_f32_16x16x32_f16 v[112:115], a[76:79], v[156:159], v[112:115]
    v_pk_mul_f16 v132, v132, v84
    v_fma_f32 v185, |v105|, v57, v185
    v_mfma_f32_16x16x32_f16 v[116:119], a[80:83], v[144:147], v[36:39]
    v_pk_mul_f16 v133, v133, v85
    v_fma_f32 v185, |v106|, v58, v185
    v_mfma_f32_16x16x32_f16 v[116:119], a[84:87], v[148:151], v[116:119]
    v_pk_mul_f16 v134, v134, v86
    v_fma_f32 v185, |v107|, v59, v185
    v_mfma_f32_16x16x32_f16 v[116:119], a[88:91], v[152:155], v[116:119]
    v_pk_mul_f16 v135, v135, v87
    v_fma_f32 v185, |v108|, v60, v185
    v_mfma_f32_16x16x32_f16 v[116:119], a[92:95], v[156:159], v[116:119]
    v_pk_mul_f16 v136, v136, v88
    v_fma_f32 v185, |v109|, v61, v185
    v_mfma_f32_16x16x32_f16 v[120:123], a[96:99], v[144:147], v[40:43]
    v_pk_mul_f16 v137, v137, v89
    v_fma_f32 v185, |v110|, v62, v185
    v_mfma_f32_16x16x32_f16 v[120:123], a[100:103], v[148:151], v[120:123]
    v_pk_mul_f16 v138, v138, v90
    v_fma_f32 v185, |v111|, v63, v185
    v_mfma_f32_16x16x32_f16 v[120:123], a[104:107], v[152:155], v[120:123]
    v_pk_mul_f16 v139, v139, v91
    v_fma_f32 v185, |v112|, v64, v185
    v_mfma_f32_16x16x32_f16 v[120:123], a[108:111], v[156:159], v[120:123]
    v_pk_mul_f16 v140, v140, v92
    v_fma_f32 v185, |v113|, v65, v185
    v_mfma_f32_16x16x32_f16 v[124:127], a[112:115], v[144:147], v[44:47]
    v_pk_mul_f16 v141, v141, v93
    v_fma_f32 v185, |v114|, v66, v185
    v_mfma_f32_16x16x32_f16 v[124:127], a[116:119], v[148:151], v[124:127]
    v_pk_mul_f16 v142, v142, v94
    v_fma_f32 v185, |v115|, v67, v185
    v_mfma_f32_16x16x32_f16 v[124:127], a[120:123], v[152:155], v[124:127]
    v_pk_mul_f16 v143, v143, v95
    v_fma_f32 v185, |v116|, v68, v185
    v_mfma_f32_16x16x32_f16 v[124:127], a[124:127], v[156:159], v[124:127]
    v_mov_b32_dpp v247, v246 row_ror:12 row_mask:0xf bank_mask:0xf
    v_fma_f32 v185, |v117|, v69, v185
    v_mfma_f32_16x16x32_f16 v[96:99], a[0:3], v[128:131], v[16:19]
    ds_read_b128 v[156:159], v247 offset:192
    v_fma_f32 v185, |v118|, v70, v185
    v_mfma_f32_16x16x32_f16 v[96:99], a[4:7], v[132:135], v[96:99]
    ds_read_b128 v[152:155], v247 offset:128
    v_fma_f32 v185, |v119|, v71, v185
    v_mfma_f32_16x16x32_f16 v[96:99], a[8:11], v[136:139], v[96:99]
    ds_read_b128 v[148:151], v247 offset:64
    v_fma_f32 v185, |v120|, v72, v185
    v_mfma_f32_16x16x32_f16 v[96:99], a[12:15], v[140:143], v[96:99]
    ds_read_b128 v[144:147], v247 offset:0
    v_fma_f32 v185, |v121|, v73, v185
    v_mfma_f32_16x16x32_f16 v[100:103], a[16:19], v[128:131], v[20:23]
    v_add_u32_sdwa v227, v163, s49 dst_sel:WORD_1 dst_unused:UNUSED_PAD src0_sel:WORD_1 src1_sel:DWORD
    v_fma_f32 v185, |v122|, v74, v185
    v_mfma_f32_16x16x32_f16 v[100:103], a[20:23], v[132:135], v[100:103]
    v_cvt_pkrtz_f16_f32 v204, v220, v221
    v_fma_f32 v185, |v123|, v75, v185
    v_mfma_f32_16x16x32_f16 v[100:103], a[24:27], v[136:139], v[100:103]
    v_max3_f32 v248, v248, |v220|, |v221|
    v_fma_f32 v185, |v124|, v76, v185
    v_mfma_f32_16x16x32_f16 v[100:103], a[28:31], v[140:143], v[100:103]
    v_cvt_pkrtz_f16_f32 v205, v222, v223
    v_fma_f32 v185, |v125|, v77, v185
    v_mfma_f32_16x16x32_f16 v[104:107], a[32:35], v[128:131], v[24:27]
    v_max3_f32 v249, v249, |v222|, |v223|
    v_fma_f32 v185, |v126|, v78, v185
    v_mfma_f32_16x16x32_f16 v[104:107], a[36:39], v[132:135], v[104:107]
    v_cvt_pkrtz_f16_f32 v206, v224, v225
    v_fma_f32 v185, |v127|, v79, v185
    v_mfma_f32_16x16x32_f16 v[104:107], a[40:43], v[136:139], v[104:107]
    v_max3_f32 v248, v248, |v224|, |v225|
    v_mul_f32 v186, |v96|, v48
    v_mfma_f32_16x16x32_f16 v[104:107], a[44:47], v[140:143], v[104:107]
    v_cvt_pkrtz_f16_f32 v207, v226, v227
    v_fma_f32 v186, |v97|, v49, v186
    v_mfma_f32_16x16x32_f16 v[108:111], a[48:51], v[128:131], v[28:31]
    v_max3_f32 v249, v249, |v226|, |v227|
    v_fma_f32 v186, |v98|, v50, v186
    v_mfma_f32_16x16x32_f16 v[108:111], a[52:55], v[132:135], v[108:111]
    ds_write_b128 v203, v[204:207] offset:4608
    v_mfma_f32_16x16x32_f16 v[108:111], a[56:59], v[136:139], v[108:111]
    s_waitcnt vmcnt(1)
    v_lshl_add_u32 v220, v164, 16, s48
    v_fma_f32 v186, |v99|, v51, v186
    v_mfma_f32_16x16x32_f16 v[108:111], a[60:63], v[140:143], v[108:111]
    s_waitcnt lgkmcnt(1)
    v_pk_mul_f16 v144, v144, v80
    v_fma_f32 v186, |v100|, v52, v186
    v_mfma_f32_16x16x32_f16 v[112:115], a[64:67], v[128:131], v[32:35]
    v_pk_mul_f16 v145, v145, v81
    v_fma_f32 v186, |v101|, v53, v186
    v_mfma_f32_16x16x32_f16 v[112:115], a[68:71], v[132:135], v[112:115]
    v_pk_mul_f16 v146, v146, v82
    v_fma_f32 v186, |v102|, v54, v186
    v_mfma_f32_16x16x32_f16 v[112:115], a[72:75], v[136:139], v[112:115]
    v_pk_mul_f16 v147, v147, v83
    v_fma_f32 v186, |v103|, v55, v186
    v_mfma_f32_16x16x32_f16 v[112:115], a[76:79], v[140:143], v[112:115]
    v_pk_mul_f16 v148, v148, v84
    v_fma_f32 v186, |v104|, v56, v186
    v_mfma_f32_16x16x32_f16 v[116:119], a[80:83], v[128:131], v[36:39]
    v_pk_mul_f16 v149, v149, v85
    v_fma_f32 v186, |v105|, v57, v186
    v_mfma_f32_16x16x32_f16 v[116:119], a[84:87], v[132:135], v[116:119]
    v_pk_mul_f16 v150, v150, v86
    v_fma_f32 v186, |v106|, v58, v186
    v_mfma_f32_16x16x32_f16 v[116:119], a[88:91], v[136:139], v[116:119]
    v_pk_mul_f16 v151, v151, v87
    v_fma_f32 v186, |v107|, v59, v186
    v_mfma_f32_16x16x32_f16 v[116:119], a[92:95], v[140:143], v[116:119]
    v_pk_mul_f16 v152, v152, v88
    v_fma_f32 v186, |v108|, v60, v186
    v_mfma_f32_16x16x32_f16 v[120:123], a[96:99], v[128:131], v[40:43]
    v_pk_mul_f16 v153, v153, v89
    v_fma_f32 v186, |v109|, v61, v186
    v_mfma_f32_16x16x32_f16 v[120:123], a[100:103], v[132:135], v[120:123]
    v_pk_mul_f16 v154, v154, v90
    v_fma_f32 v186, |v110|, v62, v186
    v_mfma_f32_16x16x32_f16 v[120:123], a[104:107], v[136:139], v[120:123]
    v_pk_mul_f16 v155, v155, v91
    v_fma_f32 v186, |v111|, v63, v186
    v_mfma_f32_16x16x32_f16 v[120:123], a[108:111], v[140:143], v[120:123]
    v_pk_mul_f16 v156, v156, v92
    v_fma_f32 v186, |v112|, v64, v186
    v_mfma_f32_16x16x32_f16 v[124:127], a[112:115], v[128:131], v[44:47]
    v_pk_mul_f16 v157, v157, v93
    v_fma_f32 v186, |v113|, v65, v186
    v_mfma_f32_16x16x32_f16 v[124:127], a[116:119], v[132:135], v[124:127]
    v_pk_mul_f16 v158, v158, v94
    v_fma_f32 v186, |v114|, v66, v186
    v_mfma_f32_16x16x32_f16 v[124:127], a[120:123], v[136:139], v[124:127]
    v_pk_mul_f16 v159, v159, v95
    v_fma_f32 v186, |v115|, v67, v186
    v_mfma_f32_16x16x32_f16 v[124:127], a[124:127], v[140:143], v[124:127]
    v_mov_b32_dpp v247, v246 row_ror:11 row_mask:0xf bank_mask:0xf
    v_fma_f32 v186, |v116|, v68, v186
    v_mfma_f32_16x16x32_f16 v[96:99], a[0:3], v[144:147], v[16:19]
    ds_read_b128 v[140:143], v247 offset:192
    v_fma_f32 v186, |v117|, v69, v186
    v_mfma_f32_16x16x32_f16 v[96:99], a[4:7], v[148:151], v[96:99]
    ds_read_b128 v[136:139], v247 offset:128
    v_fma_f32 v186, |v118|, v70, v186
    v_mfma_f32_16x16x32_f16 v[96:99], a[8:11], v[152:155], v[96:99]
    ds_read_b128 v[132:135], v247 offset:64
    v_fma_f32 v186, |v119|, v71, v186
    v_mfma_f32_16x16x32_f16 v[96:99], a[12:15], v[156:159], v[96:99]
    ds_read_b128 v[128:131], v247 offset:0
    v_fma_f32 v186, |v120|, v72, v186
    v_mfma_f32_16x16x32_f16 v[100:103], a[16:19], v[144:147], v[20:23]
    v_add_u32_sdwa v221, v164, s49 dst_sel:WORD_1 dst_unused:UNUSED_PAD src0_sel:WORD_1 src1_sel:DWORD
    v_fma_f32 v186, |v121|, v73, v186
    v_mfma_f32_16x16x32_f16 v[100:103], a[20:23], v[148:151], v[100:103]
    v_lshl_add_u32 v222, v165, 16, s48
    v_fma_f32 v186, |v122|, v74, v186
    v_mfma_f32_16x16x32_f16 v[100:103], a[24:27], v[152:155], v[100:103]
    v_add_u32_sdwa v223, v165, s49 dst_sel:WORD_1 dst_unused:UNUSED_PAD src0_sel:WORD_1 src1_sel:DWORD
    v_fma_f32 v186, |v123|, v75, v186
    v_mfma_f32_16x16x32_f16 v[100:103], a[28:31], v[156:159], v[100:103]
    v_lshl_add_u32 v224, v166, 16, s48
    v_fma_f32 v186, |v124|, v76, v186
    v_mfma_f32_16x16x32_f16 v[104:107], a[32:35], v[144:147], v[24:27]
    v_add_u32_sdwa v225, v166, s49 dst_sel:WORD_1 dst_unused:UNUSED_PAD src0_sel:WORD_1 src1_sel:DWORD
    v_fma_f32 v186, |v125|, v77, v186
    v_mfma_f32_16x16x32_f16 v[104:107], a[36:39], v[148:151], v[104:107]
    v_lshl_add_u32 v226, v167, 16, s48
    v_fma_f32 v186, |v126|, v78, v186
    v_mfma_f32_16x16x32_f16 v[104:107], a[40:43], v[152:155], v[104:107]
    v_add_u32_sdwa v227, v167, s49 dst_sel:WORD_1 dst_unused:UNUSED_PAD src0_sel:WORD_1 src1_sel:DWORD
    v_fma_f32 v186, |v127|, v79, v186
    v_mfma_f32_16x16x32_f16 v[104:107], a[44:47], v[156:159], v[104:107]
    v_cvt_pkrtz_f16_f32 v208, v220, v221
    v_mul_f32 v187, |v96|, v48
    v_mfma_f32_16x16x32_f16 v[108:111], a[48:51], v[144:147], v[28:31]
    v_max3_f32 v248, v248, |v220|, |v221|
    v_fma_f32 v187, |v97|, v49, v187
    v_mfma_f32_16x16x32_f16 v[108:111], a[52:55], v[148:151], v[108:111]
    v_cvt_pkrtz_f16_f32 v209, v222, v223
    v_fma_f32 v187, |v98|, v50, v187
    v_mfma_f32_16x16x32_f16 v[108:111], a[56:59], v[152:155], v[108:111]
    v_max3_f32 v249, v249, |v222|, |v223|
    v_fma_f32 v187, |v99|, v51, v187
    v_mfma_f32_16x16x32_f16 v[108:111], a[60:63], v[156:159], v[108:111]
    s_waitcnt lgkmcnt(0)
    v_pk_mul_f16 v128, v128, v80
    v_fma_f32 v187, |v100|, v52, v187
    v_mfma_f32_16x16x32_f16 v[112:115], a[64:67], v[144:147], v[32:35]
    v_pk_mul_f16 v129, v129, v81
    v_fma_f32 v187, |v101|, v53, v187
    v_mfma_f32_16x16x32_f16 v[112:115], a[68:71], v[148:151], v[112:115]
    v_pk_mul_f16 v130, v130, v82
    v_fma_f32 v187, |v102|, v54, v187
    v_mfma_f32_16x16x32_f16 v[112:115], a[72:75], v[152:155], v[112:115]
    v_pk_mul_f16 v131, v131, v83
    v_fma_f32 v187, |v103|, v55, v187
    v_mfma_f32_16x16x32_f16 v[112:115], a[76:79], v[156:159], v[112:115]
    v_pk_mul_f16 v132, v132, v84
    v_fma_f32 v187, |v104|, v56, v187
    v_mfma_f32_16x16x32_f16 v[116:119], a[80:83], v[144:147], v[36:39]
    v_pk_mul_f16 v133, v133, v85
    v_fma_f32 v187, |v105|, v57, v187
    v_mfma_f32_16x16x32_f16 v[116:119], a[84:87], v[148:151], v[116:119]
    v_pk_mul_f16 v134, v134, v86
    v_fma_f32 v187, |v106|, v58, v187
    v_mfma_f32_16x16x32_f16 v[116:119], a[88:91], v[152:155], v[116:119]
    v_pk_mul_f16 v135, v135, v87
    v_fma_f32 v187, |v107|, v59, v187
    v_mfma_f32_16x16x32_f16 v[116:119], a[92:95], v[156:159], v[116:119]
    v_pk_mul_f16 v136, v136, v88
    v_fma_f32 v187, |v108|, v60, v187
    v_mfma_f32_16x16x32_f16 v[120:123], a[96:99], v[144:147], v[40:43]
    v_pk_mul_f16 v137, v137, v89
    v_fma_f32 v187, |v109|, v61, v187
    v_mfma_f32_16x16x32_f16 v[120:123], a[100:103], v[148:151], v[120:123]
    v_pk_mul_f16 v138, v138, v90
    v_fma_f32 v187, |v110|, v62, v187
    v_mfma_f32_16x16x32_f16 v[120:123], a[104:107], v[152:155], v[120:123]
    v_pk_mul_f16 v139, v139, v91
    v_fma_f32 v187, |v111|, v63, v187
    v_mfma_f32_16x16x32_f16 v[120:123], a[108:111], v[156:159], v[120:123]
    v_pk_mul_f16 v140, v140, v92
    v_fma_f32 v187, |v112|, v64, v187
    v_mfma_f32_16x16x32_f16 v[124:127], a[112:115], v[144:147], v[44:47]
    v_pk_mul_f16 v141, v141, v93
    v_fma_f32 v187, |v113|, v65, v187
    v_mfma_f32_16x16x32_f16 v[124:127], a[116:119], v[148:151], v[124:127]
    v_pk_mul_f16 v142, v142, v94
    v_fma_f32 v187, |v114|, v66, v187
    v_mfma_f32_16x16x32_f16 v[124:127], a[120:123], v[152:155], v[124:127]
    v_pk_mul_f16 v143, v143, v95
    v_fma_f32 v187, |v115|, v67, v187
    v_mfma_f32_16x16x32_f16 v[124:127], a[124:127], v[156:159], v[124:127]
    v_mov_b32_dpp v247, v246 row_ror:10 row_mask:0xf bank_mask:0xf
    v_fma_f32 v187, |v116|, v68, v187
    v_mfma_f32_16x16x32_f16 v[96:99], a[0:3], v[128:131], v[16:19]
    ds_read_b128 v[156:159], v247 offset:192
    v_fma_f32 v187, |v117|, v69, v187
    v_mfma_f32_16x16x32_f16 v[96:99], a[4:7], v[132:135], v[96:99]
    ds_read_b128 v[152:155], v247 offset:128
    v_fma_f32 v187, |v118|, v70, v187
    v_mfma_f32_16x16x32_f16 v[96:99], a[8:11], v[136:139], v[96:99]
    ds_read_b128 v[148:151], v247 offset:64
    v_fma_f32 v187, |v119|, v71, v187
    v_mfma_f32_16x16x32_f16 v[96:99], a[12:15], v[140:143], v[96:99]
    ds_read_b128 v[144:147], v247 offset:0
    v_fma_f32 v187, |v120|, v72, v187
    v_mfma_f32_16x16x32_f16 v[100:103], a[16:19], v[128:131], v[20:23]
    v_cvt_pkrtz_f16_f32 v210, v224, v225
    v_fma_f32 v187, |v121|, v73, v187
    v_mfma_f32_16x16x32_f16 v[100:103], a[20:23], v[132:135], v[100:103]
    v_max3_f32 v248, v248, |v224|, |v225|
    v_fma_f32 v187, |v122|, v74, v187
    v_mfma_f32_16x16x32_f16 v[100:103], a[24:27], v[136:139], v[100:103]
    v_cvt_pkrtz_f16_f32 v211, v226, v227
    v_fma_f32 v187, |v123|, v75, v187
    v_mfma_f32_16x16x32_f16 v[100:103], a[28:31], v[140:143], v[100:103]
    v_max3_f32 v249, v249, |v226|, |v227|
    v_fma_f32 v187, |v124|, v76, v187
    v_mfma_f32_16x16x32_f16 v[104:107], a[32:35], v[128:131], v[24:27]
    ds_write_b128 v203, v[208:211] offset:5472
    v_mfma_f32_16x16x32_f16 v[104:107], a[36:39], v[132:135], v[104:107]
    s_waitcnt vmcnt(0)
    v_lshl_add_u32 v220, v168, 16, s48
    v_fma_f32 v187, |v125|, v77, v187
    v_mfma_f32_16x16x32_f16 v[104:107], a[40:43], v[136:139], v[104:107]
    v_add_u32_sdwa v221, v168, s49 dst_sel:WORD_1 dst_unused:UNUSED_PAD src0_sel:WORD_1 src1_sel:DWORD
    v_fma_f32 v187, |v126|, v78, v187
    v_mfma_f32_16x16x32_f16 v[104:107], a[44:47], v[140:143], v[104:107]
    v_lshl_add_u32 v222, v169, 16, s48
    v_fma_f32 v187, |v127|, v79, v187
    v_mfma_f32_16x16x32_f16 v[108:111], a[48:51], v[128:131], v[28:31]
    v_add_u32_sdwa v223, v169, s49 dst_sel:WORD_1 dst_unused:UNUSED_PAD src0_sel:WORD_1 src1_sel:DWORD
    v_mul_f32 v188, |v96|, v48
    v_mfma_f32_16x16x32_f16 v[108:111], a[52:55], v[132:135], v[108:111]
    v_lshl_add_u32 v224, v170, 16, s48
    v_fma_f32 v188, |v97|, v49, v188
    v_mfma_f32_16x16x32_f16 v[108:111], a[56:59], v[136:139], v[108:111]
    v_add_u32_sdwa v225, v170, s49 dst_sel:WORD_1 dst_unused:UNUSED_PAD src0_sel:WORD_1 src1_sel:DWORD
    v_fma_f32 v188, |v98|, v50, v188
    v_mfma_f32_16x16x32_f16 v[108:111], a[60:63], v[140:143], v[108:111]
    s_waitcnt lgkmcnt(1)
    v_pk_mul_f16 v144, v144, v80
    v_fma_f32 v188, |v99|, v51, v188
    v_mfma_f32_16x16x32_f16 v[112:115], a[64:67], v[128:131], v[32:35]
    v_pk_mul_f16 v145, v145, v81
    v_fma_f32 v188, |v100|, v52, v188
    v_mfma_f32_16x16x32_f16 v[112:115], a[68:71], v[132:135], v[112:115]
    v_pk_mul_f16 v146, v146, v82
    v_fma_f32 v188, |v101|, v53, v188
    v_mfma_f32_16x16x32_f16 v[112:115], a[72:75], v[136:139], v[112:115]
    v_pk_mul_f16 v147, v147, v83
    v_fma_f32 v188, |v102|, v54, v188
    v_mfma_f32_16x16x32_f16 v[112:115], a[76:79], v[140:143], v[112:115]
    v_pk_mul_f16 v148, v148, v84
    v_fma_f32 v188, |v103|, v55, v188
    v_mfma_f32_16x16x32_f16 v[116:119], a[80:83], v[128:131], v[36:39]
    v_pk_mul_f16 v149, v149, v85
    v_fma_f32 v188, |v104|, v56, v188
    v_mfma_f32_16x16x32_f16 v[116:119], a[84:87], v[132:135], v[116:119]
    v_pk_mul_f16 v150, v150, v86
    v_fma_f32 v188, |v105|, v57, v188
    v_mfma_f32_16x16x32_f16 v[116:119], a[88:91], v[136:139], v[116:119]
    v_pk_mul_f16 v151, v151, v87
    v_fma_f32 v188, |v106|, v58, v188
    v_mfma_f32_16x16x32_f16 v[116:119], a[92:95], v[140:143], v[116:119]
    v_pk_mul_f16 v152, v152, v88
    v_fma_f32 v188, |v107|, v59, v188
    v_mfma_f32_16x16x32_f16 v[120:123], a[96:99], v[128:131], v[40:43]
    v_pk_mul_f16 v153, v153, v89
    v_fma_f32 v188, |v108|, v60, v188
    v_mfma_f32_16x16x32_f16 v[120:123], a[100:103], v[132:135], v[120:123]
    v_pk_mul_f16 v154, v154, v90
    v_fma_f32 v188, |v109|, v61, v188
    v_mfma_f32_16x16x32_f16 v[120:123], a[104:107], v[136:139], v[120:123]
    v_pk_mul_f16 v155, v155, v91
    v_fma_f32 v188, |v110|, v62, v188
    v_mfma_f32_16x16x32_f16 v[120:123], a[108:111], v[140:143], v[120:123]
    v_pk_mul_f16 v156, v156, v92
    v_fma_f32 v188, |v111|, v63, v188
    v_mfma_f32_16x16x32_f16 v[124:127], a[112:115], v[128:131], v[44:47]
    v_pk_mul_f16 v157, v157, v93
    v_fma_f32 v188, |v112|, v64, v188
    v_mfma_f32_16x16x32_f16 v[124:127], a[116:119], v[132:135], v[124:127]
    v_pk_mul_f16 v158, v158, v94
    v_fma_f32 v188, |v113|, v65, v188
    v_mfma_f32_16x16x32_f16 v[124:127], a[120:123], v[136:139], v[124:127]
    v_pk_mul_f16 v159, v159, v95
    v_fma_f32 v188, |v114|, v66, v188
    v_mfma_f32_16x16x32_f16 v[124:127], a[124:127], v[140:143], v[124:127]
    v_mov_b32_dpp v247, v246 row_ror:9 row_mask:0xf bank_mask:0xf
    v_fma_f32 v188, |v115|, v67, v188
    v_mfma_f32_16x16x32_f16 v[96:99], a[0:3], v[144:147], v[16:19]
    ds_read_b128 v[140:143], v247 offset:192
    v_fma_f32 v188, |v116|, v68, v188
    v_mfma_f32_16x16x32_f16 v[96:99], a[4:7], v[148:151], v[96:99]
    ds_read_b128 v[136:139], v247 offset:128
    v_fma_f32 v188, |v117|, v69, v188
    v_mfma_f32_16x16x32_f16 v[96:99], a[8:11], v[152:155], v[96:99]
    ds_read_b128 v[132:135], v247 offset:64
    v_fma_f32 v188, |v118|, v70, v188
    v_mfma_f32_16x16x32_f16 v[96:99], a[12:15], v[156:159], v[96:99]
    ds_read_b128 v[128:131], v247 offset:0
    v_fma_f32 v188, |v119|, v71, v188
    v_mfma_f32_16x16x32_f16 v[100:103], a[16:19], v[144:147], v[20:23]
    v_lshl_add_u32 v226, v171, 16, s48
    v_fma_f32 v188, |v120|, v72, v188
    v_mfma_f32_16x16x32_f16 v[100:103], a[20:23], v[148:151], v[100:103]
    v_add_u32_sdwa v227, v171, s49 dst_sel:WORD_1 dst_unused:UNUSED_PAD src0_sel:WORD_1 src1_sel:DWORD
    v_fma_f32 v188, |v121|, v73, v188
    v_mfma_f32_16x16x32_f16 v[100:103], a[24:27], v[152:155], v[100:103]
    v_cvt_pkrtz_f16_f32 v212, v220, v221
    v_fma_f32 v188, |v122|, v74, v188
    v_mfma_f32_16x16x32_f16 v[100:103], a[28:31], v[156:159], v[100:103]
    v_max3_f32 v248, v248, |v220|, |v221|
    v_fma_f32 v188, |v123|, v75, v188
    v_mfma_f32_16x16x32_f16 v[104:107], a[32:35], v[144:147], v[24:27]
    v_cvt_pkrtz_f16_f32 v213, v222, v223
    v_fma_f32 v188, |v124|, v76, v188
    v_mfma_f32_16x16x32_f16 v[104:107], a[36:39], v[148:151], v[104:107]
    v_max3_f32 v249, v249, |v222|, |v223|
    v_fma_f32 v188, |v125|, v77, v188
    v_mfma_f32_16x16x32_f16 v[104:107], a[40:43], v[152:155], v[104:107]
    v_cvt_pkrtz_f16_f32 v214, v224, v225
    v_fma_f32 v188, |v126|, v78, v188
    v_mfma_f32_16x16x32_f16 v[104:107], a[44:47], v[156:159], v[104:107]
    v_max3_f32 v248, v248, |v224|, |v225|
    v_fma_f32 v188, |v127|, v79, v188
    v_mfma_f32_16x16x32_f16 v[108:111], a[48:51], v[144:147], v[28:31]
    v_cvt_pkrtz_f16_f32 v215, v226, v227
    v_mul_f32 v189, |v96|, v48
    v_mfma_f32_16x16x32_f16 v[108:111], a[52:55], v[148:151], v[108:111]
    v_max3_f32 v249, v249, |v226|, |v227|
    v_fma_f32 v189, |v97|, v49, v189
    v_mfma_f32_16x16x32_f16 v[108:111], a[56:59], v[152:155], v[108:111]
    ds_write_b128 v203, v[212:215] offset:6336
    v_mfma_f32_16x16x32_f16 v[108:111], a[60:63], v[156:159], v[108:111]
    s_waitcnt lgkmcnt(1)
    v_pk_mul_f16 v128, v128, v80
    v_fma_f32 v189, |v98|, v50, v189
    v_mfma_f32_16x16x32_f16 v[112:115], a[64:67], v[144:147], v[32:35]
    v_pk_mul_f16 v129, v129, v81
    v_fma_f32 v189, |v99|, v51, v189
    v_mfma_f32_16x16x32_f16 v[112:115], a[68:71], v[148:151], v[112:115]
    v_pk_mul_f16 v130, v130, v82
    v_fma_f32 v189, |v100|, v52, v189
    v_mfma_f32_16x16x32_f16 v[112:115], a[72:75], v[152:155], v[112:115]
    v_pk_mul_f16 v131, v131, v83
    v_fma_f32 v189, |v101|, v53, v189
    v_mfma_f32_16x16x32_f16 v[112:115], a[76:79], v[156:159], v[112:115]
    v_pk_mul_f16 v132, v132, v84
    v_fma_f32 v189, |v102|, v54, v189
    v_mfma_f32_16x16x32_f16 v[116:119], a[80:83], v[144:147], v[36:39]
    v_pk_mul_f16 v133, v133, v85
    v_fma_f32 v189, |v103|, v55, v189
    v_mfma_f32_16x16x32_f16 v[116:119], a[84:87], v[148:151], v[116:119]
    v_pk_mul_f16 v134, v134, v86
    v_fma_f32 v189, |v104|, v56, v189
    v_mfma_f32_16x16x32_f16 v[116:119], a[88:91], v[152:155], v[116:119]
    v_pk_mul_f16 v135, v135, v87
    v_fma_f32 v189, |v105|, v57, v189
    v_mfma_f32_16x16x32_f16 v[116:119], a[92:95], v[156:159], v[116:119]
    v_pk_mul_f16 v136, v136, v88
    v_fma_f32 v189, |v106|, v58, v189
    v_mfma_f32_16x16x32_f16 v[120:123], a[96:99], v[144:147], v[40:43]
    v_pk_mul_f16 v137, v137, v89
    v_fma_f32 v189, |v107|, v59, v189
    v_mfma_f32_16x16x32_f16 v[120:123], a[100:103], v[148:151], v[120:123]
    v_pk_mul_f16 v138, v138, v90
    v_fma_f32 v189, |v108|, v60, v189
    v_mfma_f32_16x16x32_f16 v[120:123], a[104:107], v[152:155], v[120:123]
    v_pk_mul_f16 v139, v139, v91
    v_fma_f32 v189, |v109|, v61, v189
    v_mfma_f32_16x16x32_f16 v[120:123], a[108:111], v[156:159], v[120:123]
    v_pk_mul_f16 v140, v140, v92
    v_fma_f32 v189, |v110|, v62, v189
    v_mfma_f32_16x16x32_f16 v[124:127], a[112:115], v[144:147], v[44:47]
    v_pk_mul_f16 v141, v141, v93
    v_fma_f32 v189, |v111|, v63, v189
    v_mfma_f32_16x16x32_f16 v[124:127], a[116:119], v[148:151], v[124:127]
    v_pk_mul_f16 v142, v142, v94
    v_fma_f32 v189, |v112|, v64, v189
    v_mfma_f32_16x16x32_f16 v[124:127], a[120:123], v[152:155], v[124:127]
    v_pk_mul_f16 v143, v143, v95
    v_fma_f32 v189, |v113|, v65, v189
    v_mfma_f32_16x16x32_f16 v[124:127], a[124:127], v[156:159], v[124:127]
    v_mov_b32_dpp v247, v246 row_ror:8 row_mask:0xf bank_mask:0xf
    v_fma_f32 v189, |v114|, v66, v189
    v_mfma_f32_16x16x32_f16 v[96:99], a[0:3], v[128:131], v[16:19]
    ds_read_b128 v[156:159], v247 offset:192
    v_fma_f32 v189, |v115|, v67, v189
    v_mfma_f32_16x16x32_f16 v[96:99], a[4:7], v[132:135], v[96:99]
    ds_read_b128 v[152:155], v247 offset:128
    v_fma_f32 v189, |v116|, v68, v189
    v_mfma_f32_16x16x32_f16 v[96:99], a[8:11], v[136:139], v[96:99]
    ds_read_b128 v[148:151], v247 offset:64
    v_fma_f32 v189, |v117|, v69, v189
    v_mfma_f32_16x16x32_f16 v[96:99], a[12:15], v[140:143], v[96:99]
    ds_read_b128 v[144:147], v247 offset:0
    v_fma_f32 v189, |v118|, v70, v189
    v_mfma_f32_16x16x32_f16 v[100:103], a[16:19], v[128:131], v[20:23]
    v_max_f32 v248, v248, v249
    v_fma_f32 v189, |v119|, v71, v189
    v_mfma_f32_16x16x32_f16 v[100:103], a[20:23], v[132:135], v[100:103]
    v_cmp_le_f32 vcc, s50, v248
    v_fma_f32 v189, |v120|, v72, v189
    v_mfma_f32_16x16x32_f16 v[100:103], a[24:27], v[136:139], v[100:103]
    v_cmp_nlt_f32 s[92:93], v248, s51
    v_fma_f32 v189, |v121|, v73, v189
    v_mfma_f32_16x16x32_f16 v[100:103], a[28:31], v[140:143], v[100:103]
    s_cbranch_vccnz L_efix
    v_mfma_f32_16x16x32_f16 v[104:107], a[32:35], v[128:131], v[24:27]
    s_cmp_eq_u64 s[92:93], 0
    s_cbranch_scc1 L_efix
    v_mfma_f32_16x16x32_f16 v[104:107], a[36:39], v[132:135], v[104:107]
    ds_read_b128 v[204:207], v202 offset:4608
    v_fma_f32 v189, |v122|, v74, v189
    v_mfma_f32_16x16x32_f16 v[104:107], a[40:43], v[136:139], v[104:107]
    ds_read_b128 v[208:211], v202 offset:4672
    v_fma_f32 v189, |v123|, v75, v189
    v_mfma_f32_16x16x32_f16 v[104:107], a[44:47], v[140:143], v[104:107]
    ds_read_b128 v[212:215], v202 offset:4736
    v_fma_f32 v189, |v124|, v76, v189
    v_mfma_f32_16x16x32_f16 v[108:111], a[48:51], v[128:131], v[28:31]
    ds_read_b128 v[216:219], v202 offset:4800
    v_fma_f32 v189, |v125|, v77, v189
    v_mfma_f32_16x16x32_f16 v[108:111], a[52:55], v[132:135], v[108:111]
L_pad1:
    s_cbranch_execz L_hopret
    v_add_u32_sdwa v11, v238, s5 dst_sel:DWORD dst_unused:UNUSED_PAD src0_sel:WORD_1 src1_sel:DWORD
    v_fma_f32 v189, |v126|, v78, v189
    v_mfma_f32_16x16x32_f16 v[108:111], a[56:59], v[136:139], v[108:111]
    v_add_u32_sdwa v238, v238, s5 dst_sel:DWORD dst_unused:UNUSED_PAD src0_sel:WORD_0 src1_sel:DWORD
    v_fma_f32 v189, |v127|, v79, v189
    v_mfma_f32_16x16x32_f16 v[108:111], a[60:63], v[140:143], v[108:111]
    s_waitcnt lgkmcnt(4)
    v_pk_mul_f16 v144, v144, v80
    v_mul_f32 v190, |v96|, v48
    v_mfma_f32_16x16x32_f16 v[112:115], a[64:67], v[128:131], v[32:35]
    v_pk_mul_f16 v145, v145, v81
    v_fma_f32 v190, |v97|, v49, v190
    v_mfma_f32_16x16x32_f16 v[112:115], a[68:71], v[132:135], v[112:115]
    v_pk_mul_f16 v146, v146, v82
    v_fma_f32 v190, |v98|, v50, v190
    v_mfma_f32_16x16x32_f16 v[112:115], a[72:75], v[136:139], v[112:115]
    v_pk_mul_f16 v147, v147, v83
    v_fma_f32 v190, |v99|, v51, v190
    v_mfma_f32_16x16x32_f16 v[112:115], a[76:79], v[140:143], v[112:115]
    v_pk_mul_f16 v148, v148, v84
    v_fma_f32 v190, |v100|, v52, v190
    v_mfma_f32_16x16x32_f16 v[116:119], a[80:83], v[128:131], v[36:39]
    v_pk_mul_f16 v149, v149, v85
    v_fma_f32 v190, |v101|, v53, v190
    v_mfma_f32_16x16x32_f16 v[116:119], a[84:87], v[132:135], v[116:119]
    v_pk_mul_f16 v150, v150, v86
    v_fma_f32 v190, |v102|, v54, v190
    v_mfma_f32_16x16x32_f16 v[116:119], a[88:91], v[136:139], v[116:119]
    v_pk_mul_f16 v151, v151, v87
    v_fma_f32 v190, |v103|, v55, v190
    v_mfma_f32_16x16x32_f16 v[116:119], a[92:95], v[140:143], v[116:119]
    v_pk_mul_f16 v152, v152, v88
    v_fma_f32 v190, |v104|, v56, v190
    v_mfma_f32_16x16x32_f16 v[120:123], a[96:99], v[128:131], v[40:43]
    v_pk_mul_f16 v153, v153, v89
    v_fma_f32 v190, |v105|, v57, v190
    v_mfma_f32_16x16x32_f16 v[120:123], a[100:103], v[132:135], v[120:123]
    v_pk_mul_f16 v154, v154, v90
    v_fma_f32 v190, |v106|, v58, v190
    v_mfma_f32_16x16x32_f16 v[120:123], a[104:107], v[136:139], v[120:123]
    v_pk_mul_f16 v155, v155, v91
    v_fma_f32 v190, |v107|, v59, v190
    v_mfma_f32_16x16x32_f16 v[120:123], a[108:111], v[140:143], v[120:123]
    v_pk_mul_f16 v156, v156, v92
    v_fma_f32 v190, |v108|, v60, v190
    v_mfma_f32_16x16x32_f16 v[124:127], a[112:115], v[128:131], v[44:47]
    v_pk_mul_f16 v157, v157, v93
    v_fma_f32 v190, |v109|, v61, v190
    v_mfma_f32_16x16x32_f16 v[124:127], a[116:119], v[132:135], v[124:127]
    v_pk_mul_f16 v158, v158, v94
    v_fma_f32 v190, |v110|, v62, v190
    v_mfma_f32_16x16x32_f16 v[124:127], a[120:123], v[136:139], v[124:127]
    v_pk_mul_f16 v159, v159, v95
    v_fma_f32 v190, |v111|, v63, v190
    v_mfma_f32_16x16x32_f16 v[124:127], a[124:127], v[140:143], v[124:127]
    v_max_u32_dpp v254, v254, v254 row_ror:4 row_mask:0xf bank_mask:0xf
    v_fma_f32 v190, |v112|, v64, v190
    v_mfma_f32_16x16x32_f16 v[96:99], a[0:3], v[144:147], v[16:19]
    ds_read_b128 v[140:143], v245 offset:4800
    v_fma_f32 v190, |v113|, v65, v190
    v_mfma_f32_16x16x32_f16 v[96:99], a[4:7], v[148:151], v[96:99]
    ds_read_b128 v[136:139], v245 offset:4736
    v_fma_f32 v190, |v114|, v66, v190
    v_mfma_f32_16x16x32_f16 v[96:99], a[8:11], v[152:155], v[96:99]
    ds_read_b128 v[132:135], v245 offset:4672
    v_fma_f32 v190, |v115|, v67, v190
    v_mfma_f32_16x16x32_f16 v[96:99], a[12:15], v[156:159], v[96:99]
    ds_read_b128 v[128:131], v245 offset:4608
    v_fma_f32 v190, |v116|, v68, v190
    v_mfma_f32_16x16x32_f16 v[100:103], a[16:19], v[144:147], v[20:23]
    v_max_u32_dpp v255, v255, v255 row_ror:4 row_mask:0xf bank_mask:0xf
    v_fma_f32 v190, |v117|, v69, v190
    v_mfma_f32_16x16x32_f16 v[100:103], a[20:23], v[148:151], v[100:103]
    v_max_u32_dpp v254, v254, v254 row_ror:2 row_mask:0xf bank_mask:0xf
    v_fma_f32 v190, |v118|, v70, v190
    v_mfma_f32_16x16x32_f16 v[100:103], a[24:27], v[152:155], v[100:103]
    v_max_u32_dpp v255, v255, v255 row_ror:2 row_mask:0xf bank_mask:0xf
    v_fma_f32 v190, |v119|, v71, v190
    v_mfma_f32_16x16x32_f16 v[100:103], a[28:31], v[156:159], v[100:103]
    v_max_u32_dpp v254, v254, v254 row_ror:1 row_mask:0xf bank_mask:0xf
    v_fma_f32 v190, |v120|, v72, v190
    v_mfma_f32_16x16x32_f16 v[104:107], a[32:35], v[144:147], v[24:27]
    v_max_u32_dpp v255, v255, v255 row_ror:1 row_mask:0xf bank_mask:0xf
    v_fma_f32 v190, |v121|, v73, v190
    v_mfma_f32_16x16x32_f16 v[104:107], a[36:39], v[148:151], v[104:107]
    v_max_u32_dpp v254, v254, v254 row_bcast:15 row_mask:0xa bank_mask:0xf
    v_fma_f32 v190, |v122|, v74, v190
    v_mfma_f32_16x16x32_f16 v[104:107], a[40:43], v[152:155], v[104:107]
    v_max_u32_dpp v255, v255, v255 row_bcast:15 row_mask:0xa bank_mask:0xf
    v_fma_f32 v190, |v123|, v75, v190
    v_mfma_f32_16x16x32_f16 v[104:107], a[44:47], v[156:159], v[104:107]
    v_max_u32_dpp v254, v254, v254 row_bcast:31 row_mask:0xc bank_mask:0xf
    v_fma_f32 v190, |v124|, v76, v190
    v_mfma_f32_16x16x32_f16 v[108:111], a[48:51], v[144:147], v[28:31]
    v_max_u32_dpp v255, v255, v255 row_bcast:31 row_mask:0xc bank_mask:0xf
    v_fma_f32 v190, |v125|, v77, v190
    v_mfma_f32_16x16x32_f16 v[108:111], a[52:55], v[148:151], v[108:111]
    v_readlane_b32 s34, v254, 63
    v_fma_f32 v190, |v126|, v78, v190
    v_mfma_f32_16x16x32_f16 v[108:111], a[56:59], v[152:155], v[108:111]
    v_readlane_b32 s35, v255, 63
    s_bfe_u32 s34, s34, 0x80007
    v_fma_f32 v190, |v127|, v79, v190
    v_mfma_f32_16x16x32_f16 v[108:111], a[60:63], v[156:159], v[108:111]
    s_waitcnt lgkmcnt(0)
    v_pk_mul_f16 v128, v128, v80
    s_max_u32 s34, s34, 60
    v_mul_f32 v191, |v96|, v48
    v_mfma_f32_16x16x32_f16 v[112:115], a[64:67], v[144:147], v[32:35]
    v_pk_mul_f16 v129, v129, v81
    s_sub_u32 s11, s34, 134
    v_fma_f32 v191, |v97|, v49, v191
    v_mfma_f32_16x16x32_f16 v[112:115], a[68:71], v[148:151], v[112:115]
    v_pk_mul_f16 v130, v130, v82
    s_sub_u32 s11, s11, s54
    v_fma_f32 v191, |v98|, v50, v191
    v_mfma_f32_16x16x32_f16 v[112:115], a[72:75], v[152:155], v[112:115]
    v_pk_mul_f16 v131, v131, v83
    s_sub_u32 s34, s34, 22
    v_fma_f32 v191, |v99|, v51, v191
    v_mfma_f32_16x16x32_f16 v[112:115], a[76:79], v[156:159], v[112:115]
    v_pk_mul_f16 v132, v132, v84
    s_mul_i32 s10, s34, 0x800080
    v_fma_f32 v191, |v100|, v52, v191
    v_mfma_f32_16x16x32_f16 v[116:119], a[80:83], v[144:147], v[36:39]
    v_pk_mul_f16 v133, v133, v85
    s_lshr_b32 s35, s35, 23
    v_fma_f32 v191, |v101|, v53, v191
    v_mfma_f32_16x16x32_f16 v[116:119], a[84:87], v[148:151], v[116:119]
    v_pk_mul_f16 v134, v134, v86
    s_max_u32 s35, s35, 60
    v_fma_f32 v191, |v102|, v54, v191
    v_mfma_f32_16x16x32_f16 v[116:119], a[88:91], v[152:155], v[116:119]
    v_pk_mul_f16 v135, v135, v87
    s_sub_u32 s34, 134, s35
    v_fma_f32 v191, |v103|, v55, v191
    v_mfma_f32_16x16x32_f16 v[116:119], a[92:95], v[156:159], v[116:119]
    v_pk_mul_f16 v136, v136, v88
    s_sub_u32 s35, s35, 7
    v_fma_f32 v191, |v104|, v56, v191
    v_mfma_f32_16x16x32_f16 v[120:123], a[96:99], v[144:147], v[40:43]
    v_pk_mul_f16 v137, v137, v89
    s_lshl_b32 s12, s35, 23
    v_fma_f32 v191, |v105|, v57, v191
    v_mfma_f32_16x16x32_f16 v[120:123], a[100:103], v[148:151], v[120:123]
    v_pk_mul_f16 v138, v138, v90
    v_fma_f32 v191, |v106|, v58, v191
    v_mfma_f32_16x16x32_f16 v[120:123], a[104:107], v[152:155], v[120:123]
    v_pk_mul_f16 v139, v139, v91
    v_fma_f32 v191, |v107|, v59, v191
    v_mfma_f32_16x16x32_f16 v[120:123], a[108:111], v[156:159], v[120:123]
    v_pk_mul_f16 v140, v140, v92
    v_fma_f32 v191, |v108|, v60, v191
    v_mfma_f32_16x16x32_f16 v[124:127], a[112:115], v[144:147], v[44:47]
    v_pk_mul_f16 v141, v141, v93
    v_fma_f32 v191, |v109|, v61, v191
    v_mfma_f32_16x16x32_f16 v[124:127], a[116:119], v[148:151], v[124:127]
    v_pk_mul_f16 v142, v142, v94
    v_fma_f32 v191, |v110|, v62, v191
    v_mfma_f32_16x16x32_f16 v[124:127], a[120:123], v[152:155], v[124:127]
    v_pk_mul_f16 v143, v143, v95
    v_fma_f32 v191, |v111|, v63, v191
    v_mfma_f32_16x16x32_f16 v[124:127], a[124:127], v[156:159], v[124:127]
    v_and_b32 v254, s45, v252
    v_fma_f32 v191, |v112|, v64, v191
    v_mfma_f32_16x16x32_f16 v[96:99], a[0:3], v[128:131], v[16:19]
    ds_read_b128 v[156:159], v245 offset:5088
    v_fma_f32 v191, |v113|, v65, v191
    v_mfma_f32_16x16x32_f16 v[96:99], a[4:7], v[132:135], v[96:99]
    ds_read_b128 v[152:155], v245 offset:5024
    v_fma_f32 v191, |v114|, v66, v191
    v_mfma_f32_16x16x32_f16 v[96:99], a[8:11], v[136:139], v[96:99]
    ds_read_b128 v[148:151], v245 offset:4960
    v_fma_f32 v191, |v115|, v67, v191
    v_mfma_f32_16x16x32_f16 v[96:99], a[12:15], v[140:143], v[96:99]
    ds_read_b128 v[144:147], v245 offset:4896
    v_fma_f32 v191, |v116|, v68, v191
    v_mfma_f32_16x16x32_f16 v[100:103], a[16:19], v[128:131], v[20:23]
    v_ldexp_f32 v192, v192, s34
    v_fma_f32 v191, |v117|, v69, v191
    v_mfma_f32_16x16x32_f16 v[100:103], a[20:23], v[132:135], v[100:103]
    v_ldexp_f32 v193, v193, s34
    v_fma_f32 v191, |v118|, v70, v191
    v_mfma_f32_16x16x32_f16 v[100:103], a[24:27], v[136:139], v[100:103]
    v_pk_sub_u16 v253, v253, s10 clamp
    v_fma_f32 v191, |v119|, v71, v191
    v_mfma_f32_16x16x32_f16 v[100:103], a[28:31], v[140:143], v[100:103]
    v_cvt_pk_f16_f32 v192, v192, v193
    v_fma_f32 v191, |v120|, v72, v191
    v_mfma_f32_16x16x32_f16 v[104:107], a[32:35], v[128:131], v[24:27]
    v_lshl_or_b32 v253, v253, 3, v254
    v_fma_f32 v191, |v121|, v73, v191
    v_mfma_f32_16x16x32_f16 v[104:107], a[36:39], v[132:135], v[104:107]
    ds_write_b32 v11, v192 offset:9216
    v_mfma_f32_16x16x32_f16 v[104:107], a[40:43], v[136:139], v[104:107]
    ds_write_b32 v11, v253 offset:9504
    v_fma_f32 v191, |v122|, v74, v191
    v_mfma_f32_16x16x32_f16 v[104:107], a[44:47], v[140:143], v[104:107]
    ds_read_b128 v[172:175], v245 offset:9408
    v_fma_f32 v191, |v123|, v75, v191
    v_mfma_f32_16x16x32_f16 v[108:111], a[48:51], v[128:131], v[28:31]
    ds_read_b128 v[168:171], v245 offset:9344
    v_fma_f32 v191, |v124|, v76, v191
    v_mfma_f32_16x16x32_f16 v[108:111], a[52:55], v[132:135], v[108:111]
    ds_read_b128 v[164:167], v245 offset:9280
    v_fma_f32 v191, |v125|, v77, v191
    v_mfma_f32_16x16x32_f16 v[108:111], a[56:59], v[136:139], v[108:111]
    ds_read_b128 v[160:163], v245 offset:9216
    v_fma_f32 v191, |v126|, v78, v191
    v_mfma_f32_16x16x32_f16 v[108:111], a[60:63], v[140:143], v[108:111]
    s_waitcnt lgkmcnt(6)
    v_pk_mul_f16 v144, v144, v80
    v_fma_f32 v191, |v127|, v79, v191
    v_mfma_f32_16x16x32_f16 v[112:115], a[64:67], v[128:131], v[32:35]
    v_pk_mul_f16 v145, v145, v81
    v_mul_f32 v176, |v96|, v48
    v_mfma_f32_16x16x32_f16 v[112:115], a[68:71], v[132:135], v[112:115]
    v_pk_mul_f16 v146, v146, v82
    v_fma_f32 v176, |v97|, v49, v176
    v_mfma_f32_16x16x32_f16 v[112:115], a[72:75], v[136:139], v[112:115]
    v_pk_mul_f16 v147, v147, v83
    v_fma_f32 v176, |v98|, v50, v176
    v_mfma_f32_16x16x32_f16 v[112:115], a[76:79], v[140:143], v[112:115]
    v_pk_mul_f16 v148, v148, v84
    v_fma_f32 v176, |v99|, v51, v176
    v_mfma_f32_16x16x32_f16 v[116:119], a[80:83], v[128:131], v[36:39]
    v_pk_mul_f16 v149, v149, v85
    v_fma_f32 v176, |v100|, v52, v176
    v_mfma_f32_16x16x32_f16 v[116:119], a[84:87], v[132:135], v[116:119]
    v_pk_mul_f16 v150, v150, v86
    v_fma_f32 v176, |v101|, v53, v176
    v_mfma_f32_16x16x32_f16 v[116:119], a[88:91], v[136:139], v[116:119]
    v_pk_mul_f16 v151, v151, v87
    v_fma_f32 v176, |v102|, v54, v176
    v_mfma_f32_16x16x32_f16 v[116:119], a[92:95], v[140:143], v[116:119]
    v_pk_mul_f16 v152, v152, v88
    v_fma_f32 v176, |v103|, v55, v176
    v_mfma_f32_16x16x32_f16 v[120:123], a[96:99], v[128:131], v[40:43]
    v_pk_mul_f16 v153, v153, v89
    v_fma_f32 v176, |v104|, v56, v176
    v_mfma_f32_16x16x32_f16 v[120:123], a[100:103], v[132:135], v[120:123]
    v_pk_mul_f16 v154, v154, v90
    v_fma_f32 v176, |v105|, v57, v176
    v_mfma_f32_16x16x32_f16 v[120:123], a[104:107], v[136:139], v[120:123]
    v_pk_mul_f16 v155, v155, v91
    v_fma_f32 v176, |v106|, v58, v176
    v_mfma_f32_16x16x32_f16 v[120:123], a[108:111], v[140:143], v[120:123]
    v_pk_mul_f16 v156, v156, v92
    v_fma_f32 v176, |v107|, v59, v176
    v_mfma_f32_16x16x32_f16 v[124:127], a[112:115], v[128:131], v[44:47]
    v_pk_mul_f16 v157, v157, v93
    v_fma_f32 v176, |v108|, v60, v176
    v_mfma_f32_16x16x32_f16 v[124:127], a[116:119], v[132:135], v[124:127]
    v_pk_mul_f16 v158, v158, v94
    v_fma_f32 v176, |v109|, v61, v176
    v_mfma_f32_16x16x32_f16 v[124:127], a[120:123], v[136:139], v[124:127]
    v_pk_mul_f16 v159, v159, v95
    v_fma_f32 v176, |v110|, v62, v176
    v_mfma_f32_16x16x32_f16 v[124:127], a[124:127], v[140:143], v[124:127]
    s_waitcnt lgkmcnt(0)
    v_pk_mul_f16 v160, v160, v80
    v_fma_f32 v176, |v111|, v63, v176
    v_mfma_f32_16x16x32_f16 v[96:99], a[0:3], v[144:147], v[16:19]
    ds_read_b128 v[140:143], v245 offset:5376
    v_fma_f32 v176, |v112|, v64, v176
    v_mfma_f32_16x16x32_f16 v[96:99], a[4:7], v[148:151], v[96:99]
    ds_read_b128 v[136:139], v245 offset:5312
    v_fma_f32 v176, |v113|, v65, v176
    v_mfma_f32_16x16x32_f16 v[96:99], a[8:11], v[152:155], v[96:99]
    ds_read_b128 v[132:135], v245 offset:5248
    v_fma_f32 v176, |v114|, v66, v176
    v_mfma_f32_16x16x32_f16 v[96:99], a[12:15], v[156:159], v[96:99]
    ds_read_b128 v[128:131], v245 offset:5184
    v_fma_f32 v176, |v115|, v67, v176
    v_mfma_f32_16x16x32_f16 v[100:103], a[16:19], v[144:147], v[20:23]
    v_pk_mul_f16 v161, v161, v81
    v_fma_f32 v176, |v116|, v68, v176
    v_mfma_f32_16x16x32_f16 v[100:103], a[20:23], v[148:151], v[100:103]
    v_pk_mul_f16 v162, v162, v82
    v_fma_f32 v176, |v117|, v69, v176
    v_mfma_f32_16x16x32_f16 v[100:103], a[24:27], v[152:155], v[100:103]
    v_pk_mul_f16 v163, v163, v83
    v_fma_f32 v176, |v118|, v70, v176
    v_mfma_f32_16x16x32_f16 v[100:103], a[28:31], v[156:159], v[100:103]
    v_pk_mul_f16 v164, v164, v84
    v_fma_f32 v176, |v119|, v71, v176
    v_mfma_f32_16x16x32_f16 v[104:107], a[32:35], v[144:147], v[24:27]
    v_pk_mul_f16 v165, v165, v85
    v_fma_f32 v176, |v120|, v72, v176
    v_mfma_f32_16x16x32_f16 v[104:107], a[36:39], v[148:151], v[104:107]
    v_pk_mul_f16 v166, v166, v86
    v_fma_f32 v176, |v121|, v73, v176
    v_mfma_f32_16x16x32_f16 v[104:107], a[40:43], v[152:155], v[104:107]
    v_pk_mul_f16 v167, v167, v87
    v_fma_f32 v176, |v122|, v74, v176
    v_mfma_f32_16x16x32_f16 v[104:107], a[44:47], v[156:159], v[104:107]
    v_pk_mul_f16 v168, v168, v88
    v_fma_f32 v176, |v123|, v75, v176
    v_mfma_f32_16x16x32_f16 v[108:111], a[48:51], v[144:147], v[28:31]
    v_pk_mul_f16 v169, v169, v89
    v_fma_f32 v176, |v124|, v76, v176
    v_mfma_f32_16x16x32_f16 v[108:111], a[52:55], v[148:151], v[108:111]
    v_pk_mul_f16 v170, v170, v90
    v_fma_f32 v176, |v125|, v77, v176
    v_mfma_f32_16x16x32_f16 v[108:111], a[56:59], v[152:155], v[108:111]
    v_pk_mul_f16 v171, v171, v91
    v_fma_f32 v176, |v126|, v78, v176
    v_mfma_f32_16x16x32_f16 v[108:111], a[60:63], v[156:159], v[108:111]
    s_waitcnt lgkmcnt(0)
    v_pk_mul_f16 v128, v128, v80
    v_fma_f32 v176, |v127|, v79, v176
    v_mfma_f32_16x16x32_f16 v[112:115], a[64:67], v[144:147], v[32:35]
    v_pk_mul_f16 v129, v129, v81
    v_mul_f32 v177, |v96|, v48
    v_mfma_f32_16x16x32_f16 v[112:115], a[68:71], v[148:151], v[112:115]
    v_pk_mul_f16 v130, v130, v82
    v_fma_f32 v177, |v97|, v49, v177
    v_mfma_f32_16x16x32_f16 v[112:115], a[72:75], v[152:155], v[112:115]
    v_pk_mul_f16 v131, v131, v83
    v_fma_f32 v177, |v98|, v50, v177
    v_mfma_f32_16x16x32_f16 v[112:115], a[76:79], v[156:159], v[112:115]
    v_pk_mul_f16 v132, v132, v84
    v_fma_f32 v177, |v99|, v51, v177
    v_mfma_f32_16x16x32_f16 v[116:119], a[80:83], v[144:147], v[36:39]
    v_pk_mul_f16 v133, v133, v85
    v_fma_f32 v177, |v100|, v52, v177
    v_mfma_f32_16x16x32_f16 v[116:119], a[84:87], v[148:151], v[116:119]
    v_pk_mul_f16 v134, v134, v86
    v_fma_f32 v177, |v101|, v53, v177
    v_mfma_f32_16x16x32_f16 v[116:119], a[88:91], v[152:155], v[116:119]
    v_pk_mul_f16 v135, v135, v87
    v_fma_f32 v177, |v102|, v54, v177
    v_mfma_f32_16x16x32_f16 v[116:119], a[92:95], v[156:159], v[116:119]
    v_pk_mul_f16 v136, v136, v88
    v_fma_f32 v177, |v103|, v55, v177
    v_mfma_f32_16x16x32_f16 v[120:123], a[96:99], v[144:147], v[40:43]
    v_pk_mul_f16 v137, v137, v89
    v_fma_f32 v177, |v104|, v56, v177
    v_mfma_f32_16x16x32_f16 v[120:123], a[100:103], v[148:151], v[120:123]
    v_pk_mul_f16 v138, v138, v90
    v_fma_f32 v177, |v105|, v57, v177
    v_mfma_f32_16x16x32_f16 v[120:123], a[104:107], v[152:155], v[120:123]
    v_pk_mul_f16 v139, v139, v91
    v_fma_f32 v177, |v106|, v58, v177
    v_mfma_f32_16x16x32_f16 v[120:123], a[108:111], v[156:159], v[120:123]
    v_pk_mul_f16 v140, v140, v92
    v_fma_f32 v177, |v107|, v59, v177
    v_mfma_f32_16x16x32_f16 v[124:127], a[112:115], v[144:147], v[44:47]
    v_pk_mul_f16 v141, v141, v93
    v_fma_f32 v177, |v108|, v60, v177
    v_mfma_f32_16x16x32_f16 v[124:127], a[116:119], v[148:151], v[124:127]
    v_pk_mul_f16 v142, v142, v94
    v_fma_f32 v177, |v109|, v61, v177
    v_mfma_f32_16x16x32_f16 v[124:127], a[120:123], v[152:155], v[124:127]
    v_pk_mul_f16 v143, v143, v95
    v_fma_f32 v177, |v110|, v62, v177
    v_mfma_f32_16x16x32_f16 v[124:127], a[124:127], v[156:159], v[124:127]
    v_pk_mul_f16 v172, v172, v92
    v_fma_f32 v177, |v111|, v63, v177
    v_mfma_f32_16x16x32_f16 v[96:99], a[0:3], v[128:131], v[16:19]
    ds_read_b128 v[156:159], v245 offset:5664
    v_fma_f32 v177, |v112|, v64, v177
    v_mfma_f32_16x16x32_f16 v[96:99], a[4:7], v[132:135], v[96:99]
    ds_read_b128 v[152:155], v245 offset:5600
    v_fma_f32 v177, |v113|, v65, v177
    v_mfma_f32_16x16x32_f16 v[96:99], a[8:11], v[136:139], v[96:99]
    ds_read_b128 v[148:151], v245 offset:5536
    v_fma_f32 v177, |v114|, v66, v177
    v_mfma_f32_16x16x32_f16 v[96:99], a[12:15], v[140:143], v[96:99]
    ds_read_b128 v[144:147], v245 offset:5472
    v_fma_f32 v177, |v115|, v67, v177
    v_mfma_f32_16x16x32_f16 v[100:103], a[16:19], v[128:131], v[20:23]
    v_pk_mul_f16 v173, v173, v93
    v_fma_f32 v177, |v116|, v68, v177
    v_mfma_f32_16x16x32_f16 v[100:103], a[20:23], v[132:135], v[100:103]
    v_pk_mul_f16 v174, v174, v94
    v_fma_f32 v177, |v117|, v69, v177
    v_mfma_f32_16x16x32_f16 v[100:103], a[24:27], v[136:139], v[100:103]
    v_pk_mul_f16 v175, v175, v95
    v_fma_f32 v177, |v118|, v70, v177
    v_mfma_f32_16x16x32_f16 v[100:103], a[28:31], v[140:143], v[100:103]
    v_add_u32_sdwa v239, v232, s5 dst_sel:DWORD dst_unused:UNUSED_PAD src0_sel:WORD_1 src1_sel:DWORD
    v_fma_f32 v177, |v119|, v71, v177
    v_mfma_f32_16x16x32_f16 v[220:223], v[160:163], v[80:83], 0
    v_add_u32_sdwa v232, v232, s5 dst_sel:DWORD dst_unused:UNUSED_PAD src0_sel:WORD_0 src1_sel:DWORD
    v_fma_f32 v177, |v120|, v72, v177
    v_mfma_f32_16x16x32_f16 v[220:223], v[164:167], v[84:87], v[220:223]
    v_add_u32_sdwa v240, v233, s5 dst_sel:DWORD dst_unused:UNUSED_PAD src0_sel:WORD_1 src1_sel:DWORD
    v_fma_f32 v177, |v121|, v73, v177
    v_mfma_f32_16x16x32_f16 v[220:223], v[168:171], v[88:91], v[220:223]
    v_add_u32_sdwa v233, v233, s5 dst_sel:DWORD dst_unused:UNUSED_PAD src0_sel:WORD_0 src1_sel:DWORD
    v_fma_f32 v177, |v122|, v74, v177
    v_mfma_f32_16x16x32_f16 v[220:223], v[172:175], v[92:95], v[220:223]
    v_add_u32_sdwa v241, v234, s5 dst_sel:DWORD dst_unused:UNUSED_PAD src0_sel:WORD_1 src1_sel:DWORD
    v_fma_f32 v177, |v123|, v75, v177
    v_mfma_f32_16x16x32_f16 v[224:227], v[160:163], v[204:207], 0
    s_waitcnt lgkmcnt(0)
    v_pk_mul_f16 v144, v144, v80
    v_fma_f32 v177, |v124|, v76, v177
    v_mfma_f32_16x16x32_f16 v[224:227], v[164:167], v[208:211], v[224:227]
    v_pk_mul_f16 v145, v145, v81
    v_fma_f32 v177, |v125|, v77, v177
    v_mfma_f32_16x16x32_f16 v[224:227], v[168:171], v[212:215], v[224:227]
    v_pk_mul_f16 v146, v146, v82
    v_fma_f32 v177, |v126|, v78, v177
    v_mfma_f32_16x16x32_f16 v[224:227], v[172:175], v[216:219], v[224:227]
    ds_read_b128 v[172:175], v245 offset:9696
    v_fma_f32 v177, |v127|, v79, v177
    v_mfma_f32_16x16x32_f16 v[104:107], a[32:35], v[128:131], v[24:27]
    ds_read_b128 v[168:171], v245 offset:9632
    v_mul_f32 v178, |v96|, v48
    v_mfma_f32_16x16x32_f16 v[104:107], a[36:39], v[132:135], v[104:107]
    ds_read_b128 v[164:167], v245 offset:9568
    v_fma_f32 v178, |v97|, v49, v178
    v_mfma_f32_16x16x32_f16 v[104:107], a[40:43], v[136:139], v[104:107]
    ds_write_b128 v238, v[220:223] offset:0
    v_mfma_f32_16x16x32_f16 v[104:107], a[44:47], v[140:143], v[104:107]
    ds_write_b128 v238, v[224:227] offset:2304
    v_mfma_f32_16x16x32_f16 v[108:111], a[48:51], v[128:131], v[28:31]
    ds_read_b128 v[160:163], v245 offset:9504
    v_fma_f32 v178, |v98|, v50, v178
    v_mfma_f32_16x16x32_f16 v[108:111], a[52:55], v[132:135], v[108:111]
    v_pk_mul_f16 v147, v147, v83
    v_fma_f32 v178, |v99|, v51, v178
    v_mfma_f32_16x16x32_f16 v[108:111], a[56:59], v[136:139], v[108:111]
    v_pk_mul_f16 v148, v148, v84
    v_fma_f32 v178, |v100|, v52, v178
    v_mfma_f32_16x16x32_f16 v[108:111], a[60:63], v[140:143], v[108:111]
    v_pk_mul_f16 v149, v149, v85
    v_fma_f32 v178, |v101|, v53, v178
    v_mfma_f32_16x16x32_f16 v[112:115], a[64:67], v[128:131], v[32:35]
    v_pk_mul_f16 v150, v150, v86
    v_fma_f32 v178, |v102|, v54, v178
    v_mfma_f32_16x16x32_f16 v[112:115], a[68:71], v[132:135], v[112:115]
    v_pk_mul_f16 v151, v151, v87
    v_fma_f32 v178, |v103|, v55, v178
    v_mfma_f32_16x16x32_f16 v[112:115], a[72:75], v[136:139], v[112:115]
    v_pk_mul_f16 v152, v152, v88
    v_fma_f32 v178, |v104|, v56, v178
    v_mfma_f32_16x16x32_f16 v[112:115], a[76:79], v[140:143], v[112:115]
    v_pk_mul_f16 v153, v153, v89
    v_fma_f32 v178, |v105|, v57, v178
    v_mfma_f32_16x16x32_f16 v[116:119], a[80:83], v[128:131], v[36:39]
    v_pk_mul_f16 v154, v154, v90
    v_fma_f32 v178, |v106|, v58, v178
    v_mfma_f32_16x16x32_f16 v[116:119], a[84:87], v[132:135], v[116:119]
    s_waitcnt lgkmcnt(0)
    v_pk_mul_f16 v160, v160, v80
    v_fma_f32 v178, |v107|, v59, v178
    v_mfma_f32_16x16x32_f16 v[116:119], a[88:91], v[136:139], v[116:119]
    v_pk_mul_f16 v161, v161, v81
    v_fma_f32 v178, |v108|, v60, v178
    v_mfma_f32_16x16x32_f16 v[116:119], a[92:95], v[140:143], v[116:119]
    v_pk_mul_f16 v162, v162, v82
    v_fma_f32 v178, |v109|, v61, v178
    v_mfma_f32_16x16x32_f16 v[120:123], a[96:99], v[128:131], v[40:43]
    v_pk_mul_f16 v163, v163, v83
    v_fma_f32 v178, |v110|, v62, v178
    v_mfma_f32_16x16x32_f16 v[120:123], a[100:103], v[132:135], v[120:123]
    v_pk_mul_f16 v164, v164, v84
    v_fma_f32 v178, |v111|, v63, v178
    v_mfma_f32_16x16x32_f16 v[120:123], a[104:107], v[136:139], v[120:123]
    v_pk_mul_f16 v155, v155, v91
    v_fma_f32 v178, |v112|, v64, v178
    v_mfma_f32_16x16x32_f16 v[120:123], a[108:111], v[140:143], v[120:123]
    v_pk_mul_f16 v156, v156, v92
    v_fma_f32 v178, |v113|, v65, v178
    v_mfma_f32_16x16x32_f16 v[124:127], a[112:115], v[128:131], v[44:47]
    v_pk_mul_f16 v157, v157, v93
    v_fma_f32 v178, |v114|, v66, v178
    v_mfma_f32_16x16x32_f16 v[124:127], a[116:119], v[132:135], v[124:127]
    v_pk_mul_f16 v158, v158, v94
    v_fma_f32 v178, |v115|, v67, v178
    v_mfma_f32_16x16x32_f16 v[124:127], a[120:123], v[136:139], v[124:127]
    v_pk_mul_f16 v159, v159, v95
    v_fma_f32 v178, |v116|, v68, v178
    v_mfma_f32_16x16x32_f16 v[124:127], a[124:127], v[140:143], v[124:127]
    v_pk_mul_f16 v165, v165, v85
    v_fma_f32 v178, |v117|, v69, v178
    v_mfma_f32_16x16x32_f16 v[96:99], a[0:3], v[144:147], v[16:19]
    ds_read_b128 v[140:143], v245 offset:5952
    v_fma_f32 v178, |v118|, v70, v178
    v_mfma_f32_16x16x32_f16 v[96:99], a[4:7], v[148:151], v[96:99]
    ds_read_b128 v[136:139], v245 offset:5888
    v_fma_f32 v178, |v119|, v71, v178
    v_mfma_f32_16x16x32_f16 v[96:99], a[8:11], v[152:155], v[96:99]
    ds_read_b128 v[132:135], v245 offset:5824
    v_fma_f32 v178, |v120|, v72, v178
    v_mfma_f32_16x16x32_f16 v[96:99], a[12:15], v[156:159], v[96:99]
    ds_read_b128 v[128:131], v245 offset:5760
    v_fma_f32 v178, |v121|, v73, v178
    v_mfma_f32_16x16x32_f16 v[100:103], a[16:19], v[144:147], v[20:23]
    v_pk_mul_f16 v166, v166, v86
    v_fma_f32 v178, |v122|, v74, v178
    v_mfma_f32_16x16x32_f16 v[100:103], a[20:23], v[148:151], v[100:103]
    v_pk_mul_f16 v167, v167, v87
    v_fma_f32 v178, |v123|, v75, v178
    v_mfma_f32_16x16x32_f16 v[100:103], a[24:27], v[152:155], v[100:103]
    v_pk_mul_f16 v168, v168, v88
    v_fma_f32 v178, |v124|, v76, v178
    v_mfma_f32_16x16x32_f16 v[100:103], a[28:31], v[156:159], v[100:103]
    v_pk_mul_f16 v169, v169, v89
    v_fma_f32 v178, |v125|, v77, v178
    v_mfma_f32_16x16x32_f16 v[104:107], a[32:35], v[144:147], v[24:27]
    v_pk_mul_f16 v170, v170, v90
    v_fma_f32 v178, |v126|, v78, v178
    v_mfma_f32_16x16x32_f16 v[104:107], a[36:39], v[148:151], v[104:107]
    v_pk_mul_f16 v171, v171, v91
    v_fma_f32 v178, |v127|, v79, v178
    v_mfma_f32_16x16x32_f16 v[104:107], a[40:43], v[152:155], v[104:107]
    v_pk_mul_f16 v172, v172, v92
    v_mul_f32 v179, |v96|, v48
    v_mfma_f32_16x16x32_f16 v[104:107], a[44:47], v[156:159], v[104:107]
    v_pk_mul_f16 v173, v173, v93
    v_fma_f32 v179, |v97|, v49, v179
    v_mfma_f32_16x16x32_f16 v[108:111], a[48:51], v[144:147], v[28:31]
    v_pk_mul_f16 v174, v174, v94
    v_fma_f32 v179, |v98|, v50, v179
    v_mfma_f32_16x16x32_f16 v[108:111], a[52:55], v[148:151], v[108:111]
L_pad2:
    s_cbranch_execz L_hopret
    v_pk_mul_f16 v175, v175, v95
    v_fma_f32 v179, |v99|, v51, v179
    v_mfma_f32_16x16x32_f16 v[108:111], a[56:59], v[152:155], v[108:111]
    s_waitcnt lgkmcnt(0)
    v_pk_mul_f16 v128, v128, v80
    v_fma_f32 v179, |v100|, v52, v179
    v_mfma_f32_16x16x32_f16 v[108:111], a[60:63], v[156:159], v[108:111]
    v_pk_mul_f16 v129, v129, v81
    v_fma_f32 v179, |v101|, v53, v179
    v_mfma_f32_16x16x32_f16 v[220:223], v[160:163], v[80:83], 0
    v_pk_mul_f16 v130, v130, v82
    v_fma_f32 v179, |v102|, v54, v179
    v_mfma_f32_16x16x32_f16 v[220:223], v[164:167], v[84:87], v[220:223]
    v_pk_mul_f16 v131, v131, v83
    v_fma_f32 v179, |v103|, v55, v179
    v_mfma_f32_16x16x32_f16 v[220:223], v[168:171], v[88:91], v[220:223]
    v_pk_mul_f16 v132, v132, v84
    v_fma_f32 v179, |v104|, v56, v179
    v_mfma_f32_16x16x32_f16 v[220:223], v[172:175], v[92:95], v[220:223]
    v_pk_mul_f16 v133, v133, v85
    v_fma_f32 v179, |v105|, v57, v179
    v_mfma_f32_16x16x32_f16 v[224:227], v[160:163], v[204:207], 0
    v_pk_mul_f16 v134, v134, v86
    v_fma_f32 v179, |v106|, v58, v179
    v_mfma_f32_16x16x32_f16 v[224:227], v[164:167], v[208:211], v[224:227]
    v_pk_mul_f16 v135, v135, v87
    v_fma_f32 v179, |v107|, v59, v179
    v_mfma_f32_16x16x32_f16 v[224:227], v[168:171], v[212:215], v[224:227]
    v_pk_mul_f16 v136, v136, v88
    v_pk_mul_f16 v137, v137, v89
    v_mfma_f32_16x16x32_f16 v[224:227], v[172:175], v[216:219], v[224:227]
    ds_read_b128 v[172:175], v245 offset:9408
    ds_read_b128 v[168:171], v245 offset:9344
    v_mfma_f32_16x16x32_f16 v[112:115], a[64:67], v[144:147], v[32:35]
    ds_read_b128 v[164:167], v245 offset:9280
    ds_read_b128 v[160:163], v245 offset:9216
    v_mfma_f32_16x16x32_f16 v[112:115], a[68:71], v[148:151], v[112:115]
    v_pk_mul_f16 v138, v138, v90
    v_pk_mul_f16 v139, v139, v91
    v_mfma_f32_16x16x32_f16 v[112:115], a[72:75], v[152:155], v[112:115]
    ds_write_b128 v238, v[220:223] offset:4608
    v_mfma_f32_16x16x32_f16 v[112:115], a[76:79], v[156:159], v[112:115]
    ds_write_b128 v238, v[224:227] offset:6912
    v_mfma_f32_16x16x32_f16 v[116:119], a[80:83], v[144:147], v[36:39]
    v_pk_mul_f16 v140, v140, v92
    v_fma_f32 v179, |v108|, v60, v179
    v_mfma_f32_16x16x32_f16 v[116:119], a[84:87], v[148:151], v[116:119]
    v_pk_mul_f16 v141, v141, v93
    v_fma_f32 v179, |v109|, v61, v179
    v_mfma_f32_16x16x32_f16 v[116:119], a[88:91], v[152:155], v[116:119]
    v_pk_mul_f16 v142, v142, v94
    v_fma_f32 v179, |v110|, v62, v179
    v_mfma_f32_16x16x32_f16 v[116:119], a[92:95], v[156:159], v[116:119]
    v_pk_mul_f16 v143, v143, v95
    v_fma_f32 v179, |v111|, v63, v179
    v_mfma_f32_16x16x32_f16 v[120:123], a[96:99], v[144:147], v[40:43]
    v_add_u32_sdwa v234, v234, s5 dst_sel:DWORD dst_unused:UNUSED_PAD src0_sel:WORD_0 src1_sel:DWORD
    v_fma_f32 v179, |v112|, v64, v179
    v_mfma_f32_16x16x32_f16 v[120:123], a[100:103], v[148:151], v[120:123]
    s_waitcnt lgkmcnt(2)
    v_pk_mul_f16 v160, v160, v204
    v_fma_f32 v179, |v113|, v65, v179
    v_mfma_f32_16x16x32_f16 v[120:123], a[104:107], v[152:155], v[120:123]
    v_pk_mul_f16 v161, v161, v205
    v_fma_f32 v179, |v114|, v66, v179
    v_mfma_f32_16x16x32_f16 v[120:123], a[108:111], v[156:159], v[120:123]
    v_pk_mul_f16 v162, v162, v206
    v_fma_f32 v179, |v115|, v67, v179
    v_mfma_f32_16x16x32_f16 v[124:127], a[112:115], v[144:147], v[44:47]
    v_pk_mul_f16 v163, v163, v207
    v_fma_f32 v179, |v116|, v68, v179
    v_mfma_f32_16x16x32_f16 v[124:127], a[116:119], v[148:151], v[124:127]
    v_pk_mul_f16 v164, v164, v208
    v_fma_f32 v179, |v117|, v69, v179
    v_mfma_f32_16x16x32_f16 v[124:127], a[120:123], v[152:155], v[124:127]
    v_pk_mul_f16 v165, v165, v209
    v_fma_f32 v179, |v118|, v70, v179
    v_mfma_f32_16x16x32_f16 v[124:127], a[124:127], v[156:159], v[124:127]
    v_pk_mul_f16 v166, v166, v210
    v_fma_f32 v179, |v119|, v71, v179
    v_mfma_f32_16x16x32_f16 v[96:99], a[0:3], v[128:131], v[16:19]
    ds_read_b128 v[156:159], v245 offset:6240
    v_fma_f32 v179, |v120|, v72, v179
    v_mfma_f32_16x16x32_f16 v[96:99], a[4:7], v[132:135], v[96:99]
    ds_read_b128 v[152:155], v245 offset:6176
    v_fma_f32 v179, |v121|, v73, v179
    v_mfma_f32_16x16x32_f16 v[96:99], a[8:11], v[136:139], v[96:99]
    ds_read_b128 v[148:151], v245 offset:6112
    v_fma_f32 v179, |v122|, v74, v179
    v_mfma_f32_16x16x32_f16 v[96:99], a[12:15], v[140:143], v[96:99]
    ds_read_b128 v[144:147], v245 offset:6048
    v_fma_f32 v179, |v123|, v75, v179
    v_mfma_f32_16x16x32_f16 v[100:103], a[16:19], v[128:131], v[20:23]
    v_pk_mul_f16 v167, v167, v211
    v_fma_f32 v179, |v124|, v76, v179
    v_mfma_f32_16x16x32_f16 v[100:103], a[20:23], v[132:135], v[100:103]
    v_pk_mul_f16 v168, v168, v212
    v_fma_f32 v179, |v125|, v77, v179
    v_mfma_f32_16x16x32_f16 v[100:103], a[24:27], v[136:139], v[100:103]
    v_pk_mul_f16 v169, v169, v213
    v_fma_f32 v179, |v126|, v78, v179
    v_mfma_f32_16x16x32_f16 v[100:103], a[28:31], v[140:143], v[100:103]
    v_pk_mul_f16 v170, v170, v214
    v_fma_f32 v179, |v127|, v79, v179
    v_mfma_f32_16x16x32_f16 v[104:107], a[32:35], v[128:131], v[24:27]
    v_pk_mul_f16 v171, v171, v215
    v_mul_f32 v180, |v96|, v48
    v_mfma_f32_16x16x32_f16 v[104:107], a[36:39], v[132:135], v[104:107]
    v_pk_mul_f16 v172, v172, v216
    v_fma_f32 v180, |v97|, v49, v180
    v_mfma_f32_16x16x32_f16 v[104:107], a[40:43], v[136:139], v[104:107]
    v_pk_mul_f16 v173, v173, v217
    v_fma_f32 v180, |v98|, v50, v180
    v_mfma_f32_16x16x32_f16 v[104:107], a[44:47], v[140:143], v[104:107]
    v_pk_mul_f16 v174, v174, v218
    v_fma_f32 v180, |v99|, v51, v180
    v_mfma_f32_16x16x32_f16 v[108:111], a[48:51], v[128:131], v[28:31]
    v_pk_mul_f16 v175, v175, v219
    v_fma_f32 v180, |v100|, v52, v180
    v_mfma_f32_16x16x32_f16 v[108:111], a[52:55], v[132:135], v[108:111]
    s_waitcnt lgkmcnt(0)
    v_pk_mul_f16 v144, v144, v80
    v_fma_f32 v180, |v101|, v53, v180
    v_mfma_f32_16x16x32_f16 v[108:111], a[56:59], v[136:139], v[108:111]
    v_pk_mul_f16 v145, v145, v81
    v_fma_f32 v180, |v102|, v54, v180
    v_mfma_f32_16x16x32_f16 v[108:111], a[60:63], v[140:143], v[108:111]
    v_pk_mul_f16 v146, v146, v82
    v_fma_f32 v180, |v103|, v55, v180
    v_mfma_f32_16x16x32_f16 v[228:231], v[160:163], v[204:207], 0
    v_pk_mul_f16 v147, v147, v83
    v_fma_f32 v180, |v104|, v56, v180
    v_mfma_f32_16x16x32_f16 v[228:231], v[164:167], v[208:211], v[228:231]
    v_pk_mul_f16 v148, v148, v84
    v_fma_f32 v180, |v105|, v57, v180
    v_mfma_f32_16x16x32_f16 v[228:231], v[168:171], v[212:215], v[228:231]
    v_pk_mul_f16 v149, v149, v85
    v_fma_f32 v180, |v106|, v58, v180
    v_mfma_f32_16x16x32_f16 v[228:231], v[172:175], v[216:219], v[228:231]
    ds_read_b128 v[172:175], v245 offset:9696
    v_fma_f32 v180, |v107|, v59, v180
    v_mfma_f32_16x16x32_f16 v[112:115], a[64:67], v[128:131], v[32:35]
    ds_read_b128 v[168:171], v245 offset:9632
    ds_read_b128 v[164:167], v245 offset:9568
    v_mfma_f32_16x16x32_f16 v[112:115], a[68:71], v[132:135], v[112:115]
    ds_read_b128 v[160:163], v245 offset:9504
    v_pk_mul_f16 v150, v150, v86
    v_mfma_f32_16x16x32_f16 v[112:115], a[72:75], v[136:139], v[112:115]
    ds_write_b128 v238, v[228:231] offset:2368
    v_mfma_f32_16x16x32_f16 v[112:115], a[76:79], v[140:143], v[112:115]
    v_pk_mul_f16 v151, v151, v87
    v_fma_f32 v180, |v108|, v60, v180
    v_mfma_f32_16x16x32_f16 v[116:119], a[80:83], v[128:131], v[36:39]
    v_pk_mul_f16 v152, v152, v88
    v_fma_f32 v180, |v109|, v61, v180
    v_mfma_f32_16x16x32_f16 v[116:119], a[84:87], v[132:135], v[116:119]
    v_pk_mul_f16 v153, v153, v89
    v_fma_f32 v180, |v110|, v62, v180
    v_mfma_f32_16x16x32_f16 v[116:119], a[88:91], v[136:139], v[116:119]
    v_pk_mul_f16 v154, v154, v90
    v_fma_f32 v180, |v111|, v63, v180
    v_mfma_f32_16x16x32_f16 v[116:119], a[92:95], v[140:143], v[116:119]
    v_pk_mul_f16 v155, v155, v91
    v_fma_f32 v180, |v112|, v64, v180
    v_mfma_f32_16x16x32_f16 v[120:123], a[96:99], v[128:131], v[40:43]
    v_pk_mul_f16 v156, v156, v92
    v_fma_f32 v180, |v113|, v65, v180
    v_mfma_f32_16x16x32_f16 v[120:123], a[100:103], v[132:135], v[120:123]
    v_pk_mul_f16 v157, v157, v93
    v_fma_f32 v180, |v114|, v66, v180
    v_mfma_f32_16x16x32_f16 v[120:123], a[104:107], v[136:139], v[120:123]
    s_waitcnt lgkmcnt(1)
    v_pk_mul_f16 v160, v160, v204
    v_fma_f32 v180, |v115|, v67, v180
    v_mfma_f32_16x16x32_f16 v[120:123], a[108:111], v[140:143], v[120:123]
    v_pk_mul_f16 v161, v161, v205
    v_fma_f32 v180, |v116|, v68, v180
    v_mfma_f32_16x16x32_f16 v[124:127], a[112:115], v[128:131], v[44:47]
    v_pk_mul_f16 v162, v162, v206
    v_fma_f32 v180, |v117|, v69, v180
    v_mfma_f32_16x16x32_f16 v[124:127], a[116:119], v[132:135], v[124:127]
    v_pk_mul_f16 v158, v158, v94
    v_fma_f32 v180, |v118|, v70, v180
    v_mfma_f32_16x16x32_f16 v[124:127], a[120:123], v[136:139], v[124:127]
    v_pk_mul_f16 v159, v159, v95
    v_fma_f32 v180, |v119|, v71, v180
    v_mfma_f32_16x16x32_f16 v[124:127], a[124:127], v[140:143], v[124:127]
    v_pk_mul_f16 v163, v163, v207
    v_fma_f32 v180, |v120|, v72, v180
    v_mfma_f32_16x16x32_f16 v[96:99], a[0:3], v[144:147], v[16:19]
    ds_read_b128 v[140:143], v245 offset:6528
    v_fma_f32 v180, |v121|, v73, v180
    v_mfma_f32_16x16x32_f16 v[96:99], a[4:7], v[148:151], v[96:99]
    ds_read_b128 v[136:139], v245 offset:6464
    v_fma_f32 v180, |v122|, v74, v180
    v_mfma_f32_16x16x32_f16 v[96:99], a[8:11], v[152:155], v[96:99]
    ds_read_b128 v[132:135], v245 offset:6400
    v_fma_f32 v180, |v123|, v75, v180
    v_mfma_f32_16x16x32_f16 v[96:99], a[12:15], v[156:159], v[96:99]
    ds_read_b128 v[128:131], v245 offset:6336
    v_fma_f32 v180, |v124|, v76, v180
    v_mfma_f32_16x16x32_f16 v[100:103], a[16:19], v[144:147], v[20:23]
    v_pk_mul_f16 v164, v164, v208
    v_fma_f32 v180, |v125|, v77, v180
    v_mfma_f32_16x16x32_f16 v[100:103], a[20:23], v[148:151], v[100:103]
    v_pk_mul_f16 v165, v165, v209
    v_fma_f32 v180, |v126|, v78, v180
    v_mfma_f32_16x16x32_f16 v[100:103], a[24:27], v[152:155], v[100:103]
    v_pk_mul_f16 v166, v166, v210
    v_fma_f32 v180, |v127|, v79, v180
    v_mfma_f32_16x16x32_f16 v[100:103], a[28:31], v[156:159], v[100:103]
    v_pk_mul_f16 v167, v167, v211
    v_mul_f32 v181, |v96|, v48
    v_mfma_f32_16x16x32_f16 v[104:107], a[32:35], v[144:147], v[24:27]
    v_pk_mul_f16 v168, v168, v212
    v_fma_f32 v181, |v97|, v49, v181
    v_mfma_f32_16x16x32_f16 v[104:107], a[36:39], v[148:151], v[104:107]
    v_pk_mul_f16 v169, v169, v213
    v_fma_f32 v181, |v98|, v50, v181
    v_mfma_f32_16x16x32_f16 v[104:107], a[40:43], v[152:155], v[104:107]
    v_pk_mul_f16 v170, v170, v214
    v_fma_f32 v181, |v99|, v51, v181
    v_mfma_f32_16x16x32_f16 v[104:107], a[44:47], v[156:159], v[104:107]
    v_pk_mul_f16 v171, v171, v215
    v_fma_f32 v181, |v100|, v52, v181
    v_mfma_f32_16x16x32_f16 v[108:111], a[48:51], v[144:147], v[28:31]
    v_pk_mul_f16 v172, v172, v216
    v_fma_f32 v181, |v101|, v53, v181
    v_mfma_f32_16x16x32_f16 v[108:111], a[52:55], v[148:151], v[108:111]
    v_pk_mul_f16 v173, v173, v217
    v_fma_f32 v181, |v102|, v54, v181
    v_mfma_f32_16x16x32_f16 v[108:111], a[56:59], v[152:155], v[108:111]
    v_pk_mul_f16 v174, v174, v218
    v_fma_f32 v181, |v103|, v55, v181
    v_mfma_f32_16x16x32_f16 v[108:111], a[60:63], v[156:159], v[108:111]
    s_waitcnt lgkmcnt(0)
    v_pk_mul_f16 v128, v128, v80
    v_fma_f32 v181, |v104|, v56, v181
    v_mfma_f32_16x16x32_f16 v[112:115], a[64:67], v[144:147], v[32:35]
    v_pk_mul_f16 v129, v129, v81
    v_fma_f32 v181, |v105|, v57, v181
    v_mfma_f32_16x16x32_f16 v[112:115], a[68:71], v[148:151], v[112:115]
    v_pk_mul_f16 v130, v130, v82
    v_fma_f32 v181, |v106|, v58, v181
    v_mfma_f32_16x16x32_f16 v[112:115], a[72:75], v[152:155], v[112:115]
    v_pk_mul_f16 v131, v131, v83
    v_fma_f32 v181, |v107|, v59, v181
    v_mfma_f32_16x16x32_f16 v[112:115], a[76:79], v[156:159], v[112:115]
    v_pk_mul_f16 v132, v132, v84
    v_fma_f32 v181, |v108|, v60, v181
    v_mfma_f32_16x16x32_f16 v[116:119], a[80:83], v[144:147], v[36:39]
    v_pk_mul_f16 v133, v133, v85
    v_fma_f32 v181, |v109|, v61, v181
    v_mfma_f32_16x16x32_f16 v[116:119], a[84:87], v[148:151], v[116:119]
    v_pk_mul_f16 v134, v134, v86
    v_fma_f32 v181, |v110|, v62, v181
    v_mfma_f32_16x16x32_f16 v[116:119], a[88:91], v[152:155], v[116:119]
    v_pk_mul_f16 v135, v135, v87
    v_fma_f32 v181, |v111|, v63, v181
    v_mfma_f32_16x16x32_f16 v[116:119], a[92:95], v[156:159], v[116:119]
    v_pk_mul_f16 v136, v136, v88
    v_fma_f32 v181, |v112|, v64, v181
    v_mfma_f32_16x16x32_f16 v[120:123], a[96:99], v[144:147], v[40:43]
    v_pk_mul_f16 v137, v137, v89
    v_fma_f32 v181, |v113|, v65, v181
    v_mfma_f32_16x16x32_f16 v[120:123], a[100:103], v[148:151], v[120:123]
    v_pk_mul_f16 v138, v138, v90
    v_fma_f32 v181, |v114|, v66, v181
    v_mfma_f32_16x16x32_f16 v[120:123], a[104:107], v[152:155], v[120:123]
    v_pk_mul_f16 v139, v139, v91
    v_fma_f32 v181, |v115|, v67, v181
    v_mfma_f32_16x16x32_f16 v[120:123], a[108:111], v[156:159], v[120:123]
    v_pk_mul_f16 v140, v140, v92
    v_fma_f32 v181, |v116|, v68, v181
    v_mfma_f32_16x16x32_f16 v[124:127], a[112:115], v[144:147], v[44:47]
    v_pk_mul_f16 v141, v141, v93
    v_fma_f32 v181, |v117|, v69, v181
    v_mfma_f32_16x16x32_f16 v[124:127], a[116:119], v[148:151], v[124:127]
    v_pk_mul_f16 v142, v142, v94
    v_fma_f32 v181, |v118|, v70, v181
    v_mfma_f32_16x16x32_f16 v[124:127], a[120:123], v[152:155], v[124:127]
    v_pk_mul_f16 v143, v143, v95
    v_fma_f32 v181, |v119|, v71, v181
    v_mfma_f32_16x16x32_f16 v[124:127], a[124:127], v[156:159], v[124:127]
    v_pk_mul_f16 v175, v175, v219
    v_fma_f32 v181, |v120|, v72, v181
    v_mfma_f32_16x16x32_f16 v[96:99], a[0:3], v[128:131], v[16:19]
    ds_read_b128 v[156:159], v245 offset:6816
    v_fma_f32 v181, |v121|, v73, v181
    v_mfma_f32_16x16x32_f16 v[96:99], a[4:7], v[132:135], v[96:99]
    ds_read_b128 v[152:155], v245 offset:6752
    v_fma_f32 v181, |v122|, v74, v181
    v_mfma_f32_16x16x32_f16 v[96:99], a[8:11], v[136:139], v[96:99]
    ds_read_b128 v[148:151], v245 offset:6688
    v_fma_f32 v181, |v123|, v75, v181
    v_mfma_f32_16x16x32_f16 v[96:99], a[12:15], v[140:143], v[96:99]
    ds_read_b128 v[144:147], v245 offset:6624
    v_fma_f32 v181, |v124|, v76, v181
    v_mfma_f32_16x16x32_f16 v[228:231], v[160:163], v[204:207], 0
    v_add_u32_sdwa v242, v235, s5 dst_sel:DWORD dst_unused:UNUSED_PAD src0_sel:WORD_1 src1_sel:DWORD
    v_fma_f32 v181, |v125|, v77, v181
    v_mfma_f32_16x16x32_f16 v[228:231], v[164:167], v[208:211], v[228:231]
    v_add_u32_sdwa v235, v235, s5 dst_sel:DWORD dst_unused:UNUSED_PAD src0_sel:WORD_0 src1_sel:DWORD
    v_fma_f32 v181, |v126|, v78, v181
    v_mfma_f32_16x16x32_f16 v[228:231], v[168:171], v[212:215], v[228:231]
    v_add_u32_sdwa v243, v236, s5 dst_sel:DWORD dst_unused:UNUSED_PAD src0_sel:WORD_1 src1_sel:DWORD
    v_fma_f32 v181, |v127|, v79, v181
    v_mfma_f32_16x16x32_f16 v[228:231], v[172:175], v[216:219], v[228:231]
    v_add_u32_sdwa v236, v236, s5 dst_sel:DWORD dst_unused:UNUSED_PAD src0_sel:WORD_0 src1_sel:DWORD
    v_add_u32_sdwa v244, v237, s5 dst_sel:DWORD dst_unused:UNUSED_PAD src0_sel:WORD_1 src1_sel:DWORD
    v_mfma_f32_16x16x32_f16 v[100:103], a[16:19], v[128:131], v[20:23]
    v_add_u32_sdwa v237, v237, s5 dst_sel:DWORD dst_unused:UNUSED_PAD src0_sel:WORD_0 src1_sel:DWORD
    v_mfma_f32_16x16x32_f16 v[100:103], a[20:23], v[132:135], v[100:103]
    v_permlane32_swap_b32 v184, v186
    v_mfma_f32_16x16x32_f16 v[100:103], a[24:27], v[136:139], v[100:103]
    v_permlane32_swap_b32 v185, v187
    v_mfma_f32_16x16x32_f16 v[100:103], a[28:31], v[140:143], v[100:103]
    ds_write_b128 v238, v[228:231] offset:6976
    v_mfma_f32_16x16x32_f16 v[104:107], a[32:35], v[128:131], v[24:27]
    ds_read2st64_b32 v[230:231], v237 offset0:0 offset1:18
    v_mul_f32 v182, |v96|, v48
    v_mfma_f32_16x16x32_f16 v[104:107], a[36:39], v[132:135], v[104:107]
    ds_read2st64_b32 v[228:229], v236 offset0:0 offset1:18
    v_fma_f32 v182, |v97|, v49, v182
    v_mfma_f32_16x16x32_f16 v[104:107], a[40:43], v[136:139], v[104:107]
    ds_read2st64_b32 v[222:223], v233 offset0:0 offset1:18
    v_fma_f32 v182, |v98|, v50, v182
    v_mfma_f32_16x16x32_f16 v[104:107], a[44:47], v[140:143], v[104:107]
    ds_read2st64_b32 v[220:221], v232 offset0:0 offset1:18
    v_fma_f32 v182, |v99|, v51, v182
    v_mfma_f32_16x16x32_f16 v[108:111], a[48:51], v[128:131], v[28:31]
    ds_read2st64_b32 v[226:227], v235 offset0:0 offset1:18
    v_fma_f32 v182, |v100|, v52, v182
    v_mfma_f32_16x16x32_f16 v[108:111], a[52:55], v[132:135], v[108:111]
    ds_read2st64_b32 v[224:225], v234 offset0:0 offset1:18
    v_fma_f32 v182, |v101|, v53, v182
    v_mfma_f32_16x16x32_f16 v[108:111], a[56:59], v[136:139], v[108:111]
    s_waitcnt lgkmcnt(7)
    v_pk_mul_f16 v144, v144, v80
    v_fma_f32 v182, |v102|, v54, v182
    v_mfma_f32_16x16x32_f16 v[108:111], a[60:63], v[140:143], v[108:111]
    v_pk_mul_f16 v145, v145, v81
    v_fma_f32 v182, |v103|, v55, v182
    v_mfma_f32_16x16x32_f16 v[112:115], a[64:67], v[128:131], v[32:35]
    v_pk_mul_f16 v146, v146, v82
    v_fma_f32 v182, |v104|, v56, v182
    v_mfma_f32_16x16x32_f16 v[112:115], a[68:71], v[132:135], v[112:115]
    v_pk_mul_f16 v147, v147, v83
    v_fma_f32 v182, |v105|, v57, v182
    v_mfma_f32_16x16x32_f16 v[112:115], a[72:75], v[136:139], v[112:115]
    v_pk_mul_f16 v148, v148, v84
    v_fma_f32 v182, |v106|, v58, v182
    v_mfma_f32_16x16x32_f16 v[112:115], a[76:79], v[140:143], v[112:115]
    v_pk_mul_f16 v149, v149, v85
    v_fma_f32 v182, |v107|, v59, v182
    v_mfma_f32_16x16x32_f16 v[116:119], a[80:83], v[128:131], v[36:39]
    v_pk_mul_f16 v150, v150, v86
    v_fma_f32 v182, |v108|, v60, v182
    v_mfma_f32_16x16x32_f16 v[116:119], a[84:87], v[132:135], v[116:119]
    v_pk_mul_f16 v151, v151, v87
    v_fma_f32 v182, |v109|, v61, v182
    v_mfma_f32_16x16x32_f16 v[116:119], a[88:91], v[136:139], v[116:119]
    v_pk_mul_f16 v152, v152, v88
    v_fma_f32 v182, |v110|, v62, v182
    v_mfma_f32_16x16x32_f16 v[116:119], a[92:95], v[140:143], v[116:119]
    v_pk_mul_f16 v153, v153, v89
    v_fma_f32 v182, |v111|, v63, v182
    v_mfma_f32_16x16x32_f16 v[120:123], a[96:99], v[128:131], v[40:43]
    v_pk_mul_f16 v154, v154, v90
    v_fma_f32 v182, |v112|, v64, v182
    v_mfma_f32_16x16x32_f16 v[120:123], a[100:103], v[132:135], v[120:123]
    v_pk_mul_f16 v155, v155, v91
    v_fma_f32 v182, |v113|, v65, v182
    v_mfma_f32_16x16x32_f16 v[120:123], a[104:107], v[136:139], v[120:123]
    v_pk_mul_f16 v156, v156, v92
    v_fma_f32 v182, |v114|, v66, v182
    v_mfma_f32_16x16x32_f16 v[120:123], a[108:111], v[140:143], v[120:123]
    v_pk_mul_f16 v157, v157, v93
    v_fma_f32 v182, |v115|, v67, v182
    v_mfma_f32_16x16x32_f16 v[124:127], a[112:115], v[128:131], v[44:47]
    v_pk_mul_f16 v158, v158, v94
    v_fma_f32 v182, |v116|, v68, v182
    v_mfma_f32_16x16x32_f16 v[124:127], a[116:119], v[132:135], v[124:127]
    v_pk_mul_f16 v159, v159, v95
    v_fma_f32 v182, |v117|, v69, v182
    v_mfma_f32_16x16x32_f16 v[124:127], a[120:123], v[136:139], v[124:127]
    v_add_f32 v184, v184, v186
    v_fma_f32 v182, |v118|, v70, v182
    v_mfma_f32_16x16x32_f16 v[124:127], a[124:127], v[140:143], v[124:127]
    v_add_f32 v185, v185, v187
    v_fma_f32 v182, |v119|, v71, v182
    v_mfma_f32_16x16x32_f16 v[96:99], a[0:3], v[144:147], v[16:19]
    ds_read_b128 v[140:143], v245 offset:7104
    v_fma_f32 v182, |v120|, v72, v182
    v_mfma_f32_16x16x32_f16 v[96:99], a[4:7], v[148:151], v[96:99]
    ds_read_b128 v[136:139], v245 offset:7040
    v_fma_f32 v182, |v121|, v73, v182
    v_mfma_f32_16x16x32_f16 v[96:99], a[8:11], v[152:155], v[96:99]
    ds_read_b128 v[132:135], v245 offset:6976
    v_fma_f32 v182, |v122|, v74, v182
    v_mfma_f32_16x16x32_f16 v[96:99], a[12:15], v[156:159], v[96:99]
    ds_read_b128 v[128:131], v245 offset:6912
    v_fma_f32 v182, |v123|, v75, v182
    v_mfma_f32_16x16x32_f16 v[100:103], a[16:19], v[144:147], v[20:23]
    v_permlane16_swap_b32 v184, v185
    v_mfma_f32_16x16x32_f16 v[100:103], a[20:23], v[148:151], v[100:103]
    v_add_f32 v184, v184, v185
    v_fma_f32 v182, |v124|, v76, v182
    v_mfma_f32_16x16x32_f16 v[100:103], a[24:27], v[152:155], v[100:103]
    s_waitcnt lgkmcnt(4)
    v_fma_f32 v184, v224, s12, v184
    v_fma_f32 v182, |v125|, v77, v182
    v_mfma_f32_16x16x32_f16 v[100:103], a[28:31], v[156:159], v[100:103]
    v_permlane32_swap_b32 v188, v190
    v_mfma_f32_16x16x32_f16 v[104:107], a[32:35], v[144:147], v[24:27]
    v_permlane32_swap_b32 v189, v191
    v_mfma_f32_16x16x32_f16 v[104:107], a[36:39], v[148:151], v[104:107]
    v_add_f32 v188, v188, v190
    v_fma_f32 v182, |v126|, v78, v182
    v_mfma_f32_16x16x32_f16 v[104:107], a[40:43], v[152:155], v[104:107]
    v_add_f32 v189, v189, v191
    v_fma_f32 v182, |v127|, v79, v182
    v_mfma_f32_16x16x32_f16 v[104:107], a[44:47], v[156:159], v[104:107]
    v_permlane16_swap_b32 v188, v189
    v_mfma_f32_16x16x32_f16 v[108:111], a[48:51], v[144:147], v[28:31]
    s_waitcnt lgkmcnt(0)
    v_pk_mul_f16 v128, v128, v80
    v_mul_f32 v183, |v96|, v48
    v_mfma_f32_16x16x32_f16 v[108:111], a[52:55], v[148:151], v[108:111]
    v_pk_mul_f16 v129, v129, v81
    v_fma_f32 v183, |v97|, v49, v183
    v_mfma_f32_16x16x32_f16 v[108:111], a[56:59], v[152:155], v[108:111]
    v_pk_mul_f16 v130, v130, v82
    v_fma_f32 v183, |v98|, v50, v183
    v_mfma_f32_16x16x32_f16 v[108:111], a[60:63], v[156:159], v[108:111]
    v_pk_mul_f16 v131, v131, v83
    v_fma_f32 v183, |v99|, v51, v183
    v_mfma_f32_16x16x32_f16 v[112:115], a[64:67], v[144:147], v[32:35]
    v_pk_mul_f16 v132, v132, v84
    v_fma_f32 v183, |v100|, v52, v183
    v_mfma_f32_16x16x32_f16 v[112:115], a[68:71], v[148:151], v[112:115]
    v_pk_mul_f16 v133, v133, v85
    v_fma_f32 v183, |v101|, v53, v183
    v_mfma_f32_16x16x32_f16 v[112:115], a[72:75], v[152:155], v[112:115]
    v_pk_mul_f16 v134, v134, v86
    v_fma_f32 v183, |v102|, v54, v183
    v_mfma_f32_16x16x32_f16 v[112:115], a[76:79], v[156:159], v[112:115]
    v_pk_mul_f16 v135, v135, v87
    v_fma_f32 v183, |v103|, v55, v183
    v_mfma_f32_16x16x32_f16 v[116:119], a[80:83], v[144:147], v[36:39]
    v_pk_mul_f16 v136, v136, v88
    v_fma_f32 v183, |v104|, v56, v183
    v_mfma_f32_16x16x32_f16 v[116:119], a[84:87], v[148:151], v[116:119]
    v_pk_mul_f16 v137, v137, v89
    v_fma_f32 v183, |v105|, v57, v183
    v_mfma_f32_16x16x32_f16 v[116:119], a[88:91], v[152:155], v[116:119]
    v_pk_mul_f16 v138, v138, v90
    v_fma_f32 v183, |v106|, v58, v183
    v_mfma_f32_16x16x32_f16 v[116:119], a[92:95], v[156:159], v[116:119]
    v_pk_mul_f16 v139, v139, v91
    v_fma_f32 v183, |v107|, v59, v183
    v_mfma_f32_16x16x32_f16 v[120:123], a[96:99], v[144:147], v[40:43]
    v_pk_mul_f16 v140, v140, v92
    v_fma_f32 v183, |v108|, v60, v183
    v_mfma_f32_16x16x32_f16 v[120:123], a[100:103], v[148:151], v[120:123]
    v_pk_mul_f16 v141, v141, v93
    v_fma_f32 v183, |v109|, v61, v183
    v_mfma_f32_16x16x32_f16 v[120:123], a[104:107], v[152:155], v[120:123]
    v_pk_mul_f16 v142, v142, v94
    v_fma_f32 v183, |v110|, v62, v183
    v_mfma_f32_16x16x32_f16 v[120:123], a[108:111], v[156:159], v[120:123]
    v_pk_mul_f16 v143, v143, v95
    v_fma_f32 v183, |v111|, v63, v183
    v_mfma_f32_16x16x32_f16 v[124:127], a[112:115], v[144:147], v[44:47]
    v_add_f32 v188, v188, v189
    v_fma_f32 v183, |v112|, v64, v183
    v_mfma_f32_16x16x32_f16 v[124:127], a[116:119], v[148:151], v[124:127]
    v_fma_f32 v188, v226, s12, v188
    v_fma_f32 v183, |v113|, v65, v183
    v_mfma_f32_16x16x32_f16 v[124:127], a[120:123], v[152:155], v[124:127]
    v_cndmask_b32 v188, v251, v188, s[36:37]
    v_fma_f32 v183, |v114|, v66, v183
    v_mfma_f32_16x16x32_f16 v[124:127], a[124:127], v[156:159], v[124:127]
    v_permlane32_swap_b32 v176, v178
    v_mfma_f32_16x16x32_f16 v[96:99], a[0:3], v[128:131], v[16:19]
    ds_read_b128 v[156:159], v245 offset:7392
    v_fma_f32 v183, |v115|, v67, v183
    v_mfma_f32_16x16x32_f16 v[96:99], a[4:7], v[132:135], v[96:99]
    ds_read_b128 v[152:155], v245 offset:7328
    v_fma_f32 v183, |v116|, v68, v183
    v_mfma_f32_16x16x32_f16 v[96:99], a[8:11], v[136:139], v[96:99]
    ds_read_b128 v[148:151], v245 offset:7264
    v_fma_f32 v183, |v117|, v69, v183
    v_mfma_f32_16x16x32_f16 v[96:99], a[12:15], v[140:143], v[96:99]
    ds_read_b128 v[144:147], v245 offset:7200
    v_fma_f32 v183, |v118|, v70, v183
    v_mfma_f32_16x16x32_f16 v[100:103], a[16:19], v[128:131], v[20:23]
    v_permlane32_swap_b32 v177, v179
    v_mfma_f32_16x16x32_f16 v[100:103], a[20:23], v[132:135], v[100:103]
    v_add_f32 v176, v176, v178
    v_fma_f32 v183, |v119|, v71, v183
    v_mfma_f32_16x16x32_f16 v[100:103], a[24:27], v[136:139], v[100:103]
    v_add_f32 v177, v177, v179
    v_fma_f32 v183, |v120|, v72, v183
    v_mfma_f32_16x16x32_f16 v[100:103], a[28:31], v[140:143], v[100:103]
    v_permlane16_swap_b32 v176, v177
    v_mfma_f32_16x16x32_f16 v[104:107], a[32:35], v[128:131], v[24:27]
    v_add_f32 v176, v176, v177
    v_fma_f32 v183, |v121|, v73, v183
    v_mfma_f32_16x16x32_f16 v[104:107], a[36:39], v[132:135], v[104:107]
    v_fma_f32 v176, v220, s12, v176
    v_fma_f32 v183, |v122|, v74, v183
    v_mfma_f32_16x16x32_f16 v[104:107], a[40:43], v[136:139], v[104:107]
    v_max3_f32 v248, v184, v188, v176
    v_fma_f32 v183, |v123|, v75, v183
    v_mfma_f32_16x16x32_f16 v[104:107], a[44:47], v[140:143], v[104:107]
    v_fma_f32 v183, |v124|, v76, v183
    v_fma_f32 v183, |v125|, v77, v183
    v_mfma_f32_16x16x32_f16 v[108:111], a[48:51], v[128:131], v[28:31]
    s_waitcnt lgkmcnt(0)
    v_pk_mul_f16 v144, v144, v80
    v_fma_f32 v183, |v126|, v78, v183
    v_mfma_f32_16x16x32_f16 v[108:111], a[52:55], v[132:135], v[108:111]
    v_pk_mul_f16 v145, v145, v81
    v_fma_f32 v183, |v127|, v79, v183
    v_mfma_f32_16x16x32_f16 v[108:111], a[56:59], v[136:139], v[108:111]
L_pad3:
    s_cbranch_execz L_hopret
    v_pk_mul_f16 v146, v146, v82
    v_mul_f32 v192, |v96|, v48
    v_mfma_f32_16x16x32_f16 v[108:111], a[60:63], v[140:143], v[108:111]
    v_pk_mul_f16 v147, v147, v83
    v_fma_f32 v192, |v97|, v49, v192
    v_mfma_f32_16x16x32_f16 v[112:115], a[64:67], v[128:131], v[32:35]
    v_pk_mul_f16 v148, v148, v84
    v_fma_f32 v192, |v98|, v50, v192
    v_mfma_f32_16x16x32_f16 v[112:115], a[68:71], v[132:135], v[112:115]
    v_pk_mul_f16 v149, v149, v85
    v_fma_f32 v192, |v99|, v51, v192
    v_mfma_f32_16x16x32_f16 v[112:115], a[72:75], v[136:139], v[112:115]
    v_pk_mul_f16 v150, v150, v86
    v_fma_f32 v192, |v100|, v52, v192
    v_mfma_f32_16x16x32_f16 v[112:115], a[76:79], v[140:143], v[112:115]
    v_pk_mul_f16 v151, v151, v87
    v_fma_f32 v192, |v101|, v53, v192
    v_mfma_f32_16x16x32_f16 v[116:119], a[80:83], v[128:131], v[36:39]
    v_pk_mul_f16 v152, v152, v88
    v_fma_f32 v192, |v102|, v54, v192
    v_mfma_f32_16x16x32_f16 v[116:119], a[84:87], v[132:135], v[116:119]
    v_pk_mul_f16 v153, v153, v89
    v_fma_f32 v192, |v103|, v55, v192
    v_mfma_f32_16x16x32_f16 v[116:119], a[88:91], v[136:139], v[116:119]
    v_pk_mul_f16 v154, v154, v90
    v_fma_f32 v192, |v104|, v56, v192
    v_mfma_f32_16x16x32_f16 v[116:119], a[92:95], v[140:143], v[116:119]
    v_pk_mul_f16 v155, v155, v91
    v_fma_f32 v192, |v105|, v57, v192
    v_mfma_f32_16x16x32_f16 v[120:123], a[96:99], v[128:131], v[40:43]
    v_pk_mul_f16 v156, v156, v92
    v_fma_f32 v192, |v106|, v58, v192
    v_mfma_f32_16x16x32_f16 v[120:123], a[100:103], v[132:135], v[120:123]
    v_pk_mul_f16 v157, v157, v93
    v_fma_f32 v192, |v107|, v59, v192
    v_mfma_f32_16x16x32_f16 v[120:123], a[104:107], v[136:139], v[120:123]
    v_pk_mul_f16 v158, v158, v94
    v_fma_f32 v192, |v108|, v60, v192
    v_mfma_f32_16x16x32_f16 v[120:123], a[108:111], v[140:143], v[120:123]
    v_pk_mul_f16 v159, v159, v95
    v_fma_f32 v192, |v109|, v61, v192
    v_mfma_f32_16x16x32_f16 v[124:127], a[112:115], v[128:131], v[44:47]
    ds_read_b128 v[216:219], v239 offset:4800
    v_fma_f32 v192, |v110|, v62, v192
    v_mfma_f32_16x16x32_f16 v[124:127], a[116:119], v[132:135], v[124:127]
    ds_read_b128 v[212:215], v239 offset:4736
    v_fma_f32 v192, |v111|, v63, v192
    v_mfma_f32_16x16x32_f16 v[124:127], a[120:123], v[136:139], v[124:127]
    ds_read_b128 v[208:211], v239 offset:4672
    v_fma_f32 v192, |v112|, v64, v192
    v_mfma_f32_16x16x32_f16 v[124:127], a[124:127], v[140:143], v[124:127]
    ds_read_b128 v[204:207], v239 offset:4608
    v_fma_f32 v192, |v113|, v65, v192
    v_mfma_f32_16x16x32_f16 v[96:99], a[0:3], v[144:147], v[16:19]
    ds_read_b128 v[140:143], v240 offset:4800
    v_fma_f32 v192, |v114|, v66, v192
    v_mfma_f32_16x16x32_f16 v[96:99], a[4:7], v[148:151], v[96:99]
    ds_read_b128 v[136:139], v240 offset:4736
    v_fma_f32 v192, |v115|, v67, v192
    v_mfma_f32_16x16x32_f16 v[96:99], a[8:11], v[152:155], v[96:99]
    ds_read_b128 v[132:135], v240 offset:4672
    v_fma_f32 v192, |v116|, v68, v192
    v_mfma_f32_16x16x32_f16 v[96:99], a[12:15], v[156:159], v[96:99]
    ds_read_b128 v[128:131], v240 offset:4608
    v_fma_f32 v192, |v117|, v69, v192
    v_mfma_f32_16x16x32_f16 v[100:103], a[16:19], v[144:147], v[20:23]
    v_permlane32_swap_b32 v180, v182
    v_mfma_f32_16x16x32_f16 v[100:103], a[20:23], v[148:151], v[100:103]
    v_permlane32_swap_b32 v181, v183
    v_mfma_f32_16x16x32_f16 v[100:103], a[24:27], v[152:155], v[100:103]
    v_add_f32 v180, v180, v182
    v_fma_f32 v192, |v118|, v70, v192
    v_mfma_f32_16x16x32_f16 v[100:103], a[28:31], v[156:159], v[100:103]
    v_add_f32 v181, v181, v183
    v_fma_f32 v192, |v119|, v71, v192
    v_mfma_f32_16x16x32_f16 v[104:107], a[32:35], v[144:147], v[24:27]
    v_permlane16_swap_b32 v180, v181
    v_fma_f32 v192, |v120|, v72, v192
    v_mfma_f32_16x16x32_f16 v[104:107], a[36:39], v[148:151], v[104:107]
    v_add_f32 v180, v180, v181
    v_fma_f32 v192, |v121|, v73, v192
    v_mfma_f32_16x16x32_f16 v[104:107], a[40:43], v[152:155], v[104:107]
    v_fma_f32 v180, v222, s12, v180
    v_fma_f32 v192, |v122|, v74, v192
    v_mfma_f32_16x16x32_f16 v[104:107], a[44:47], v[156:159], v[104:107]
    v_fma_f32 v192, |v123|, v75, v192
    v_fma_f32 v192, |v124|, v76, v192
    v_mfma_f32_16x16x32_f16 v[108:111], a[48:51], v[144:147], v[28:31]
    s_waitcnt lgkmcnt(0)
    v_pk_mul_f16 v128, v128, v204
    v_fma_f32 v192, |v125|, v77, v192
    v_mfma_f32_16x16x32_f16 v[108:111], a[52:55], v[148:151], v[108:111]
    v_pk_mul_f16 v129, v129, v205
    v_fma_f32 v192, |v126|, v78, v192
    v_mfma_f32_16x16x32_f16 v[108:111], a[56:59], v[152:155], v[108:111]
    v_pk_mul_f16 v130, v130, v206
    v_fma_f32 v192, |v127|, v79, v192
    v_mfma_f32_16x16x32_f16 v[108:111], a[60:63], v[156:159], v[108:111]
    v_pk_mul_f16 v131, v131, v207
    v_mul_f32 v194, |v96|, v48
    v_mfma_f32_16x16x32_f16 v[112:115], a[64:67], v[144:147], v[32:35]
    v_pk_mul_f16 v132, v132, v208
    v_fma_f32 v194, |v97|, v49, v194
    v_mfma_f32_16x16x32_f16 v[112:115], a[68:71], v[148:151], v[112:115]
    v_pk_mul_f16 v133, v133, v209
    v_fma_f32 v194, |v98|, v50, v194
    v_mfma_f32_16x16x32_f16 v[112:115], a[72:75], v[152:155], v[112:115]
    v_pk_mul_f16 v134, v134, v210
    v_fma_f32 v194, |v99|, v51, v194
    v_mfma_f32_16x16x32_f16 v[112:115], a[76:79], v[156:159], v[112:115]
    v_pk_mul_f16 v135, v135, v211
    v_fma_f32 v194, |v100|, v52, v194
    v_mfma_f32_16x16x32_f16 v[116:119], a[80:83], v[144:147], v[36:39]
    v_pk_mul_f16 v136, v136, v212
    v_fma_f32 v194, |v101|, v53, v194
    v_mfma_f32_16x16x32_f16 v[116:119], a[84:87], v[148:151], v[116:119]
    v_pk_mul_f16 v137, v137, v213
    v_fma_f32 v194, |v102|, v54, v194
    v_mfma_f32_16x16x32_f16 v[116:119], a[88:91], v[152:155], v[116:119]
    v_pk_mul_f16 v138, v138, v214
    v_fma_f32 v194, |v103|, v55, v194
    v_mfma_f32_16x16x32_f16 v[116:119], a[92:95], v[156:159], v[116:119]
    v_pk_mul_f16 v139, v139, v215
    v_fma_f32 v194, |v104|, v56, v194
    v_mfma_f32_16x16x32_f16 v[120:123], a[96:99], v[144:147], v[40:43]
    v_pk_mul_f16 v140, v140, v216
    v_fma_f32 v194, |v105|, v57, v194
    v_mfma_f32_16x16x32_f16 v[120:123], a[100:103], v[148:151], v[120:123]
    v_pk_mul_f16 v141, v141, v217
    v_fma_f32 v194, |v106|, v58, v194
    v_mfma_f32_16x16x32_f16 v[120:123], a[104:107], v[152:155], v[120:123]
    v_pk_mul_f16 v142, v142, v218
    v_fma_f32 v194, |v107|, v59, v194
    v_mfma_f32_16x16x32_f16 v[120:123], a[108:111], v[156:159], v[120:123]
    v_pk_mul_f16 v143, v143, v219
    v_fma_f32 v194, |v108|, v60, v194
    v_mfma_f32_16x16x32_f16 v[124:127], a[112:115], v[144:147], v[44:47]
    ds_read_b128 v[216:219], v243 offset:4800
    v_fma_f32 v194, |v109|, v61, v194
    v_mfma_f32_16x16x32_f16 v[124:127], a[116:119], v[148:151], v[124:127]
    ds_read_b128 v[212:215], v243 offset:4736
    v_fma_f32 v194, |v110|, v62, v194
    v_mfma_f32_16x16x32_f16 v[124:127], a[120:123], v[152:155], v[124:127]
    ds_read_b128 v[208:211], v243 offset:4672
    v_fma_f32 v194, |v111|, v63, v194
    v_mfma_f32_16x16x32_f16 v[124:127], a[124:127], v[156:159], v[124:127]
    ds_read_b128 v[204:207], v243 offset:4608
    v_fma_f32 v194, |v112|, v64, v194
    v_mfma_f32_16x16x32_f16 v[96:99], a[0:3], v[128:131], v[16:19]
    ds_read_b128 v[156:159], v244 offset:4800
    v_fma_f32 v194, |v113|, v65, v194
    v_mfma_f32_16x16x32_f16 v[96:99], a[4:7], v[132:135], v[96:99]
    ds_read_b128 v[152:155], v244 offset:4736
    v_fma_f32 v194, |v114|, v66, v194
    v_mfma_f32_16x16x32_f16 v[96:99], a[8:11], v[136:139], v[96:99]
    ds_read_b128 v[148:151], v244 offset:4672
    v_fma_f32 v194, |v115|, v67, v194
    v_mfma_f32_16x16x32_f16 v[96:99], a[12:15], v[140:143], v[96:99]
    ds_read_b128 v[144:147], v244 offset:4608
    v_fma_f32 v194, |v116|, v68, v194
    v_mfma_f32_16x16x32_f16 v[100:103], a[16:19], v[128:131], v[20:23]
    v_fma_f32 v194, |v117|, v69, v194
    v_fma_f32 v194, |v118|, v70, v194
    v_mfma_f32_16x16x32_f16 v[100:103], a[20:23], v[132:135], v[100:103]
    v_fma_f32 v194, |v119|, v71, v194
    v_fma_f32 v194, |v120|, v72, v194
    v_mfma_f32_16x16x32_f16 v[100:103], a[24:27], v[136:139], v[100:103]
    v_fma_f32 v194, |v121|, v73, v194
    v_fma_f32 v194, |v122|, v74, v194
    v_mfma_f32_16x16x32_f16 v[100:103], a[28:31], v[140:143], v[100:103]
    v_fma_f32 v194, |v123|, v75, v194
    v_fma_f32 v194, |v124|, v76, v194
    v_mfma_f32_16x16x32_f16 v[104:107], a[32:35], v[128:131], v[24:27]
    v_fma_f32 v194, |v125|, v77, v194
    v_fma_f32 v194, |v126|, v78, v194
    v_mfma_f32_16x16x32_f16 v[104:107], a[36:39], v[132:135], v[104:107]
    v_fma_f32 v194, |v127|, v79, v194
    v_mul_f32 v196, |v96|, v48
    v_mfma_f32_16x16x32_f16 v[104:107], a[40:43], v[136:139], v[104:107]
    v_permlane32_swap_b32 v192, v194
    v_mfma_f32_16x16x32_f16 v[104:107], a[44:47], v[140:143], v[104:107]
    v_add_f32 v192, v192, v194
    v_fma_f32 v196, |v97|, v49, v196
    v_mfma_f32_16x16x32_f16 v[108:111], a[48:51], v[128:131], v[28:31]
    s_waitcnt lgkmcnt(0)
    v_pk_mul_f16 v144, v144, v204
    v_fma_f32 v196, |v98|, v50, v196
    v_mfma_f32_16x16x32_f16 v[108:111], a[52:55], v[132:135], v[108:111]
    v_pk_mul_f16 v145, v145, v205
    v_fma_f32 v196, |v99|, v51, v196
    v_mfma_f32_16x16x32_f16 v[108:111], a[56:59], v[136:139], v[108:111]
    v_pk_mul_f16 v146, v146, v206
    v_fma_f32 v196, |v100|, v52, v196
    v_mfma_f32_16x16x32_f16 v[108:111], a[60:63], v[140:143], v[108:111]
    v_pk_mul_f16 v147, v147, v207
    v_fma_f32 v196, |v101|, v53, v196
    v_mfma_f32_16x16x32_f16 v[112:115], a[64:67], v[128:131], v[32:35]
    v_pk_mul_f16 v148, v148, v208
    v_fma_f32 v196, |v102|, v54, v196
    v_mfma_f32_16x16x32_f16 v[112:115], a[68:71], v[132:135], v[112:115]
    v_pk_mul_f16 v149, v149, v209
    v_fma_f32 v196, |v103|, v55, v196
    v_mfma_f32_16x16x32_f16 v[112:115], a[72:75], v[136:139], v[112:115]
    v_pk_mul_f16 v150, v150, v210
    v_fma_f32 v196, |v104|, v56, v196
    v_mfma_f32_16x16x32_f16 v[112:115], a[76:79], v[140:143], v[112:115]
    v_pk_mul_f16 v151, v151, v211
    v_fma_f32 v196, |v105|, v57, v196
    v_mfma_f32_16x16x32_f16 v[116:119], a[80:83], v[128:131], v[36:39]
    v_pk_mul_f16 v152, v152, v212
    v_fma_f32 v196, |v106|, v58, v196
    v_mfma_f32_16x16x32_f16 v[116:119], a[84:87], v[132:135], v[116:119]
    v_pk_mul_f16 v153, v153, v213
    v_fma_f32 v196, |v107|, v59, v196
    v_mfma_f32_16x16x32_f16 v[116:119], a[88:91], v[136:139], v[116:119]
    v_pk_mul_f16 v154, v154, v214
    v_fma_f32 v196, |v108|, v60, v196
    v_mfma_f32_16x16x32_f16 v[116:119], a[92:95], v[140:143], v[116:119]
    v_pk_mul_f16 v155, v155, v215
    v_fma_f32 v196, |v109|, v61, v196
    v_mfma_f32_16x16x32_f16 v[120:123], a[96:99], v[128:131], v[40:43]
    v_pk_mul_f16 v156, v156, v216
    v_fma_f32 v196, |v110|, v62, v196
    v_mfma_f32_16x16x32_f16 v[120:123], a[100:103], v[132:135], v[120:123]
    v_pk_mul_f16 v157, v157, v217
    v_fma_f32 v196, |v111|, v63, v196
    v_mfma_f32_16x16x32_f16 v[120:123], a[104:107], v[136:139], v[120:123]
    v_pk_mul_f16 v158, v158, v218
    v_fma_f32 v196, |v112|, v64, v196
    v_mfma_f32_16x16x32_f16 v[120:123], a[108:111], v[140:143], v[120:123]
    v_pk_mul_f16 v159, v159, v219
    v_fma_f32 v196, |v113|, v65, v196
    v_mfma_f32_16x16x32_f16 v[124:127], a[112:115], v[128:131], v[44:47]
    ds_read_b128 v[216:219], v241 offset:4800
    v_fma_f32 v196, |v114|, v66, v196
    v_mfma_f32_16x16x32_f16 v[124:127], a[116:119], v[132:135], v[124:127]
    ds_read_b128 v[212:215], v241 offset:4736
    v_fma_f32 v196, |v115|, v67, v196
    v_mfma_f32_16x16x32_f16 v[124:127], a[120:123], v[136:139], v[124:127]
    ds_read_b128 v[208:211], v241 offset:4672
    v_fma_f32 v196, |v116|, v68, v196
    v_mfma_f32_16x16x32_f16 v[124:127], a[124:127], v[140:143], v[124:127]
    ds_read_b128 v[204:207], v241 offset:4608
    v_fma_f32 v196, |v117|, v69, v196
    v_mfma_f32_16x16x32_f16 v[96:99], a[0:3], v[144:147], v[16:19]
    ds_read_b128 v[140:143], v242 offset:4800
    v_fma_f32 v196, |v118|, v70, v196
    v_mfma_f32_16x16x32_f16 v[96:99], a[4:7], v[148:151], v[96:99]
    ds_read_b128 v[136:139], v242 offset:4736
    v_fma_f32 v196, |v119|, v71, v196
    v_mfma_f32_16x16x32_f16 v[96:99], a[8:11], v[152:155], v[96:99]
    ds_read_b128 v[132:135], v242 offset:4672
    v_fma_f32 v196, |v120|, v72, v196
    v_mfma_f32_16x16x32_f16 v[96:99], a[12:15], v[156:159], v[96:99]
    ds_read_b128 v[128:131], v242 offset:4608
    v_fma_f32 v196, |v121|, v73, v196
    v_mfma_f32_16x16x32_f16 v[100:103], a[16:19], v[144:147], v[20:23]
    v_mov_b32 v193, v192
    v_fma_f32 v196, |v122|, v74, v196
    v_mfma_f32_16x16x32_f16 v[100:103], a[20:23], v[148:151], v[100:103]
    v_permlane16_swap_b32 v192, v193
    v_mfma_f32_16x16x32_f16 v[100:103], a[24:27], v[152:155], v[100:103]
    v_add_f32 v192, v192, v193
    v_fma_f32 v196, |v123|, v75, v196
    v_mfma_f32_16x16x32_f16 v[100:103], a[28:31], v[156:159], v[100:103]
    v_fma_f32 v192, v228, s12, v192
    v_fma_f32 v196, |v124|, v76, v196
    v_mfma_f32_16x16x32_f16 v[104:107], a[32:35], v[144:147], v[24:27]
    v_cndmask_b32 v192, v251, v192, s[38:39]
    v_fma_f32 v196, |v125|, v77, v196
    v_mfma_f32_16x16x32_f16 v[104:107], a[36:39], v[148:151], v[104:107]
    v_max3_f32 v248, v248, v180, v192
    v_fma_f32 v196, |v126|, v78, v196
    v_mfma_f32_16x16x32_f16 v[104:107], a[40:43], v[152:155], v[104:107]
    v_max_f32_dpp v248, v248, v248 row_ror:8 row_mask:0xf bank_mask:0xf
    v_fma_f32 v196, |v127|, v79, v196
    v_mfma_f32_16x16x32_f16 v[104:107], a[44:47], v[156:159], v[104:107]
    v_max_f32_dpp v248, v248, v248 row_ror:4 row_mask:0xf bank_mask:0xf
    v_mul_f32 v198, |v96|, v48
    v_mfma_f32_16x16x32_f16 v[108:111], a[48:51], v[144:147], v[28:31]
    s_waitcnt lgkmcnt(0)
    v_pk_mul_f16 v128, v128, v204
    v_fma_f32 v198, |v97|, v49, v198
    v_mfma_f32_16x16x32_f16 v[108:111], a[52:55], v[148:151], v[108:111]
    v_pk_mul_f16 v129, v129, v205
    v_fma_f32 v198, |v98|, v50, v198
    v_mfma_f32_16x16x32_f16 v[108:111], a[56:59], v[152:155], v[108:111]
    v_pk_mul_f16 v130, v130, v206
    v_fma_f32 v198, |v99|, v51, v198
    v_mfma_f32_16x16x32_f16 v[108:111], a[60:63], v[156:159], v[108:111]
    v_pk_mul_f16 v131, v131, v207
    v_fma_f32 v198, |v100|, v52, v198
    v_mfma_f32_16x16x32_f16 v[112:115], a[64:67], v[144:147], v[32:35]
    v_pk_mul_f16 v132, v132, v208
    v_fma_f32 v198, |v101|, v53, v198
    v_mfma_f32_16x16x32_f16 v[112:115], a[68:71], v[148:151], v[112:115]
    v_pk_mul_f16 v133, v133, v209
    v_fma_f32 v198, |v102|, v54, v198
    v_mfma_f32_16x16x32_f16 v[112:115], a[72:75], v[152:155], v[112:115]
    v_pk_mul_f16 v134, v134, v210
    v_fma_f32 v198, |v103|, v55, v198
    v_mfma_f32_16x16x32_f16 v[112:115], a[76:79], v[156:159], v[112:115]
    v_pk_mul_f16 v135, v135, v211
    v_fma_f32 v198, |v104|, v56, v198
    v_mfma_f32_16x16x32_f16 v[116:119], a[80:83], v[144:147], v[36:39]
    v_pk_mul_f16 v136, v136, v212
    v_fma_f32 v198, |v105|, v57, v198
    v_mfma_f32_16x16x32_f16 v[116:119], a[84:87], v[148:151], v[116:119]
    v_pk_mul_f16 v137, v137, v213
    v_fma_f32 v198, |v106|, v58, v198
    v_mfma_f32_16x16x32_f16 v[116:119], a[88:91], v[152:155], v[116:119]
    v_pk_mul_f16 v138, v138, v214
    v_fma_f32 v198, |v107|, v59, v198
    v_mfma_f32_16x16x32_f16 v[116:119], a[92:95], v[156:159], v[116:119]
    v_pk_mul_f16 v139, v139, v215
    v_fma_f32 v198, |v108|, v60, v198
    v_mfma_f32_16x16x32_f16 v[120:123], a[96:99], v[144:147], v[40:43]
    v_pk_mul_f16 v140, v140, v216
    v_fma_f32 v198, |v109|, v61, v198
    v_mfma_f32_16x16x32_f16 v[120:123], a[100:103], v[148:151], v[120:123]
    v_pk_mul_f16 v141, v141, v217
    v_fma_f32 v198, |v110|, v62, v198
    v_mfma_f32_16x16x32_f16 v[120:123], a[104:107], v[152:155], v[120:123]
    v_pk_mul_f16 v142, v142, v218
    v_fma_f32 v198, |v111|, v63, v198
    v_mfma_f32_16x16x32_f16 v[120:123], a[108:111], v[156:159], v[120:123]
    v_pk_mul_f16 v143, v143, v219
    v_fma_f32 v198, |v112|, v64, v198
    v_mfma_f32_16x16x32_f16 v[124:127], a[112:115], v[144:147], v[44:47]
    v_max_f32_dpp v248, v248, v248 row_ror:2 row_mask:0xf bank_mask:0xf
    v_fma_f32 v198, |v113|, v65, v198
    v_mfma_f32_16x16x32_f16 v[124:127], a[116:119], v[148:151], v[124:127]
    v_max_f32_dpp v248, v248, v248 row_ror:1 row_mask:0xf bank_mask:0xf
    v_fma_f32 v198, |v114|, v66, v198
    v_mfma_f32_16x16x32_f16 v[124:127], a[120:123], v[152:155], v[124:127]
    v_max_f32_dpp v248, v248, v248 row_bcast:15 row_mask:0xa bank_mask:0xf
    v_fma_f32 v198, |v115|, v67, v198
    v_mfma_f32_16x16x32_f16 v[124:127], a[124:127], v[156:159], v[124:127]
    v_max_f32_dpp v248, v248, v248 row_bcast:31 row_mask:0xc bank_mask:0xf
    v_fma_f32 v198, |v116|, v68, v198
    v_mfma_f32_16x16x32_f16 v[96:99], a[0:3], v[128:131], v[16:19]
    v_readlane_b32 s14, v248, 63
    v_fma_f32 v198, |v117|, v69, v198
    v_mfma_f32_16x16x32_f16 v[96:99], a[4:7], v[132:135], v[96:99]
    v_subrev_f32 v184, s14, v184
    v_fma_f32 v198, |v118|, v70, v198
    v_mfma_f32_16x16x32_f16 v[96:99], a[8:11], v[136:139], v[96:99]
    v_subrev_f32 v188, s14, v188
    v_fma_f32 v198, |v119|, v71, v198
    v_mfma_f32_16x16x32_f16 v[96:99], a[12:15], v[140:143], v[96:99]
    v_subrev_f32 v176, s14, v176
    v_fma_f32 v198, |v120|, v72, v198
    v_mfma_f32_16x16x32_f16 v[100:103], a[16:19], v[128:131], v[20:23]
    v_subrev_f32 v180, s14, v180
    v_fma_f32 v198, |v121|, v73, v198
    v_mfma_f32_16x16x32_f16 v[100:103], a[20:23], v[132:135], v[100:103]
    v_subrev_f32 v192, s14, v192
    v_fma_f32 v198, |v122|, v74, v198
    v_mfma_f32_16x16x32_f16 v[100:103], a[24:27], v[136:139], v[100:103]
    v_mul_f32 v184, s55, v184
    v_fma_f32 v198, |v123|, v75, v198
    v_mfma_f32_16x16x32_f16 v[100:103], a[28:31], v[140:143], v[100:103]
    v_mul_f32 v188, s55, v188
    v_fma_f32 v198, |v124|, v76, v198
    v_mfma_f32_16x16x32_f16 v[104:107], a[32:35], v[128:131], v[24:27]
    v_mul_f32 v176, s55, v176
    v_fma_f32 v198, |v125|, v77, v198
    v_mfma_f32_16x16x32_f16 v[104:107], a[36:39], v[132:135], v[104:107]
    v_mul_f32 v180, s55, v180
    v_fma_f32 v198, |v126|, v78, v198
    v_mfma_f32_16x16x32_f16 v[104:107], a[40:43], v[136:139], v[104:107]
    v_mul_f32 v192, s55, v192
    v_fma_f32 v198, |v127|, v79, v198
    v_mfma_f32_16x16x32_f16 v[104:107], a[44:47], v[140:143], v[104:107]
    v_exp_f32 v184, v184
    v_mfma_f32_16x16x32_f16 v[108:111], a[48:51], v[128:131], v[28:31]
    v_exp_f32 v188, v188
    v_mfma_f32_16x16x32_f16 v[108:111], a[52:55], v[132:135], v[108:111]
    v_exp_f32 v176, v176
    v_mfma_f32_16x16x32_f16 v[108:111], a[56:59], v[136:139], v[108:111]
    v_exp_f32 v180, v180
    v_mfma_f32_16x16x32_f16 v[108:111], a[60:63], v[140:143], v[108:111]
    v_exp_f32 v192, v192
    v_mfma_f32_16x16x32_f16 v[112:115], a[64:67], v[128:131], v[32:35]
    v_add_f32 v249, v184, v188
    v_mul_f32 v197, |v96|, v48
    v_mfma_f32_16x16x32_f16 v[112:115], a[68:71], v[132:135], v[112:115]
    v_mul_f32 v250, v184, v225
    v_mul_f32 v200, |v97|, v49
    v_mfma_f32_16x16x32_f16 v[112:115], a[72:75], v[136:139], v[112:115]
    v_fmac_f32 v250, v188, v227
    v_fma_f32 v197, |v98|, v50, v197
    v_mfma_f32_16x16x32_f16 v[112:115], a[76:79], v[140:143], v[112:115]
    v_add_f32 v249, v249, v176
    v_fma_f32 v200, |v99|, v51, v200
    v_mfma_f32_16x16x32_f16 v[116:119], a[80:83], v[128:131], v[36:39]
    v_fmac_f32 v250, v176, v221
    v_fma_f32 v197, |v100|, v52, v197
    v_mfma_f32_16x16x32_f16 v[116:119], a[84:87], v[132:135], v[116:119]
    v_add_f32 v249, v249, v180
    v_fma_f32 v200, |v101|, v53, v200
    v_mfma_f32_16x16x32_f16 v[116:119], a[88:91], v[136:139], v[116:119]
    v_fmac_f32 v250, v180, v223
    v_fma_f32 v197, |v102|, v54, v197
    v_mfma_f32_16x16x32_f16 v[116:119], a[92:95], v[140:143], v[116:119]
    v_add_f32 v249, v249, v192
    v_fma_f32 v200, |v103|, v55, v200
    v_mfma_f32_16x16x32_f16 v[120:123], a[96:99], v[128:131], v[40:43]
    v_fmac_f32 v250, v192, v229
    s_lshl_b32 s6, s4, 1
    v_fma_f32 v197, |v104|, v56, v197
    v_mfma_f32_16x16x32_f16 v[120:123], a[100:103], v[132:135], v[120:123]
    v_mov_b32 v2, s6
    v_fma_f32 v200, |v105|, v57, v200
    v_mfma_f32_16x16x32_f16 v[120:123], a[104:107], v[136:139], v[120:123]
    v_permlane32_swap_b32 v196, v198
    v_mfma_f32_16x16x32_f16 v[120:123], a[108:111], v[140:143], v[120:123]
    v_add_f32 v196, v196, v198
    v_fma_f32 v197, |v106|, v58, v197
    v_mfma_f32_16x16x32_f16 v[124:127], a[112:115], v[128:131], v[44:47]
    v_fma_f32 v200, |v107|, v59, v200
    v_fma_f32 v197, |v108|, v60, v197
    v_mfma_f32_16x16x32_f16 v[124:127], a[116:119], v[132:135], v[124:127]
    v_fma_f32 v200, |v109|, v61, v200
    v_fma_f32 v197, |v110|, v62, v197
    v_mfma_f32_16x16x32_f16 v[124:127], a[120:123], v[136:139], v[124:127]
    v_fma_f32 v200, |v111|, v63, v200
    v_fma_f32 v197, |v112|, v64, v197
    v_mfma_f32_16x16x32_f16 v[124:127], a[124:127], v[140:143], v[124:127]
    v_fma_f32 v200, |v113|, v65, v200
    v_fma_f32 v197, |v114|, v66, v197
    v_fma_f32 v200, |v115|, v67, v200
    v_fma_f32 v197, |v116|, v68, v197
    v_fma_f32 v200, |v117|, v69, v200
    v_fma_f32 v197, |v118|, v70, v197
    v_fma_f32 v200, |v119|, v71, v200
    v_fma_f32 v197, |v120|, v72, v197
    v_fma_f32 v200, |v121|, v73, v200
    v_fma_f32 v197, |v122|, v74, v197
    v_fma_f32 v200, |v123|, v75, v200
    v_fma_f32 v197, |v124|, v76, v197
    v_fma_f32 v200, |v125|, v77, v200
    v_fma_f32 v197, |v126|, v78, v197
    v_fma_f32 v200, |v127|, v79, v200
    v_add_f32 v197, v197, v200
    s_nop 1
    v_permlane32_swap_b32 v197, v199
    v_add_f32 v197, v197, v199
    s_nop 1
    v_permlane16_swap_b32 v196, v197
    v_fma_f32 v196, v230, s12, v196
    v_add_f32 v196, v196, v197
    v_cndmask_b32 v196, v251, v196, s[40:41]
    v_subrev_f32 v197, s14, v196
    v_mul_f32 v197, s55, v197
    v_cmp_lt_f32 vcc, 4.0, v197
    v_exp_f32 v197, v197
    s_cbranch_vccnz L_tailmax
    v_add_f32 v249, v249, v197
    v_fmac_f32 v250, v197, v231
L_tailsum:
    s_nop 0
    v_add_f32_dpp v249, v249, v249 row_ror:8 row_mask:0xf bank_mask:0xf
    v_add_f32_dpp v250, v250, v250 row_ror:8 row_mask:0xf bank_mask:0xf
    s_nop 0
    v_add_f32_dpp v249, v249, v249 row_ror:4 row_mask:0xf bank_mask:0xf
    v_add_f32_dpp v250, v250, v250 row_ror:4 row_mask:0xf bank_mask:0xf
    s_nop 0
    v_add_f32_dpp v249, v249, v249 row_ror:2 row_mask:0xf bank_mask:0xf
    v_add_f32_dpp v250, v250, v250 row_ror:2 row_mask:0xf bank_mask:0xf
    s_nop 0
    v_add_f32_dpp v249, v249, v249 row_ror:1 row_mask:0xf bank_mask:0xf
    v_add_f32_dpp v250, v250, v250 row_ror:1 row_mask:0xf bank_mask:0xf
    s_nop 0
    v_add_f32_dpp v249, v249, v249 row_bcast:15 row_mask:0xa bank_mask:0xf
    v_add_f32_dpp v250, v250, v250 row_bcast:15 row_mask:0xa bank_mask:0xf
    s_nop 0
    v_add_f32_dpp v249, v249, v249 row_bcast:31 row_mask:0xc bank_mask:0xf
    v_add_f32_dpp v250, v250, v250 row_bcast:31 row_mask:0xc bank_mask:0xf
    v_rcp_f32 v249, v249
    v_ldexp_f32 v250, v250, s11
    s_mov_b32 exec_lo, 0
    s_mov_b32 exec_hi, 0x80000000
    v_mul_f32 v250, v250, v249
    v_cvt_pk_bf16_f32 v250, v250, v250
    global_store_short v2, v250, s[32:33]
L_end:
    s_endpgm
L_wfix:
    s_waitcnt lgkmcnt(0)
    s_nop 7
    s_mov_b32 s8, 0x07060302
    v_mov_b32 v121, 0
    v_and_b32 v122, s44, v48
    v_pk_max_u16 v121, v121, v122
    v_and_b32 v122, s44, v49
    v_pk_max_u16 v121, v121, v122
    v_and_b32 v122, s44, v50
    v_pk_max_u16 v121, v121, v122
    v_and_b32 v122, s44, v51
    v_pk_max_u16 v121, v121, v122
    v_and_b32 v122, s44, v52
    v_pk_max_u16 v121, v121, v122
    v_and_b32 v122, s44, v53
    v_pk_max_u16 v121, v121, v122
    v_and_b32 v122, s44, v54
    v_pk_max_u16 v121, v121, v122
    v_and_b32 v122, s44, v55
    v_pk_max_u16 v121, v121, v122
    v_and_b32 v122, s44, v56
    v_pk_max_u16 v121, v121, v122
    v_and_b32 v122, s44, v57
    v_pk_max_u16 v121, v121, v122
    v_and_b32 v122, s44, v58
    v_pk_max_u16 v121, v121, v122
    v_and_b32 v122, s44, v59
    v_pk_max_u16 v121, v121, v122
    v_and_b32 v122, s44, v60
    v_pk_max_u16 v121, v121, v122
    v_and_b32 v122, s44, v61
    v_pk_max_u16 v121, v121, v122
    v_and_b32 v122, s44, v62
    v_pk_max_u16 v121, v121, v122
    v_and_b32 v122, s44, v63
    v_pk_max_u16 v121, v121, v122
    v_and_b32 v122, s44, v64
    v_pk_max_u16 v121, v121, v122
    v_and_b32 v122, s44, v65
    v_pk_max_u16 v121, v121, v122
    v_and_b32 v122, s44, v66
    v_pk_max_u16 v121, v121, v122
    v_and_b32 v122, s44, v67
    v_pk_max_u16 v121, v121, v122
    v_and_b32 v122, s44, v68
    v_pk_max_u16 v121, v121, v122
    v_and_b32 v122, s44, v69
    v_pk_max_u16 v121, v121, v122
    v_and_b32 v122, s44, v70
    v_pk_max_u16 v121, v121, v122
    v_and_b32 v122, s44, v71
    v_pk_max_u16 v121, v121, v122
    v_and_b32 v122, s44, v72
    v_pk_max_u16 v121, v121, v122
    v_and_b32 v122, s44, v73
    v_pk_max_u16 v121, v121, v122
    v_and_b32 v122, s44, v74
    v_pk_max_u16 v121, v121, v122
    v_and_b32 v122, s44, v75
    v_pk_max_u16 v121, v121, v122
    v_and_b32 v122, s44, v76
    v_pk_max_u16 v121, v121, v122
    v_and_b32 v122, s44, v77
    v_pk_max_u16 v121, v121, v122
    v_and_b32 v122, s44, v78
    v_pk_max_u16 v121, v121, v122
    v_and_b32 v122, s44, v79
    v_pk_max_u16 v121, v121, v122
    s_barrier
    ds_write_b32 v3, v121 offset:39424
    s_waitcnt lgkmcnt(0)
    s_barrier
    ds_read_b128 v[112:115], v127 offset:39424
    s_waitcnt lgkmcnt(0)
    v_pk_max_u16 v121, v121, v112
    v_pk_max_u16 v121, v121, v113
    v_pk_max_u16 v121, v121, v114
    v_pk_max_u16 v121, v121, v115
    s_barrier
    v_pk_max_u16 v121, v121, v121 op_sel:[0,1] op_sel_hi:[1,0]
    s_nop 1
    v_max_u32_dpp v121, v121, v121 row_ror:8 row_mask:0xf bank_mask:0xf
    s_nop 1
    v_max_u32_dpp v121, v121, v121 row_ror:4 row_mask:0xf bank_mask:0xf
    s_nop 1
    v_max_u32_dpp v121, v121, v121 row_ror:2 row_mask:0xf bank_mask:0xf
    s_nop 1
    v_max_u32_dpp v121, v121, v121 row_ror:1 row_mask:0xf bank_mask:0xf
    s_nop 1
    v_max_u32_dpp v121, v121, v121 row_bcast:15 row_mask:0xa bank_mask:0xf
    s_nop 1
    v_max_u32_dpp v121, v121, v121 row_bcast:31 row_mask:0xc bank_mask:0xf
    s_nop 0
    v_readlane_b32 s6, v121, 63
    s_nop 0
    s_bfe_u32 s6, s6, 0x80007
    s_max_u32 s6, s6, 87
    s_sub_u32 s47, 127, s6
    s_sub_u32 s7, 0, s47
    v_lshlrev_b32 v121, 16, v48
    v_and_b32 v122, s46, v48
    v_ldexp_f32 v121, v121, s47
    v_ldexp_f32 v122, v122, s47
    v_perm_b32 v48, v122, v121, s8
    v_lshlrev_b32 v121, 16, v49
    v_and_b32 v122, s46, v49
    v_ldexp_f32 v121, v121, s47
    v_ldexp_f32 v122, v122, s47
    v_perm_b32 v49, v122, v121, s8
    v_lshlrev_b32 v121, 16, v50
    v_and_b32 v122, s46, v50
    v_ldexp_f32 v121, v121, s47
    v_ldexp_f32 v122, v122, s47
    v_perm_b32 v50, v122, v121, s8
    v_lshlrev_b32 v121, 16, v51
    v_and_b32 v122, s46, v51
    v_ldexp_f32 v121, v121, s47
    v_ldexp_f32 v122, v122, s47
    v_perm_b32 v51, v122, v121, s8
    v_lshlrev_b32 v121, 16, v52
    v_and_b32 v122, s46, v52
    v_ldexp_f32 v121, v121, s47
    v_ldexp_f32 v122, v122, s47
    v_perm_b32 v52, v122, v121, s8
    v_lshlrev_b32 v121, 16, v53
    v_and_b32 v122, s46, v53
    v_ldexp_f32 v121, v121, s47
    v_ldexp_f32 v122, v122, s47
    v_perm_b32 v53, v122, v121, s8
    v_lshlrev_b32 v121, 16, v54
    v_and_b32 v122, s46, v54
    v_ldexp_f32 v121, v121, s47
    v_ldexp_f32 v122, v122, s47
    v_perm_b32 v54, v122, v121, s8
    v_lshlrev_b32 v121, 16, v55
    v_and_b32 v122, s46, v55
    v_ldexp_f32 v121, v121, s47
    v_ldexp_f32 v122, v122, s47
    v_perm_b32 v55, v122, v121, s8
    v_lshlrev_b32 v121, 16, v56
    v_and_b32 v122, s46, v56
    v_ldexp_f32 v121, v121, s47
    v_ldexp_f32 v122, v122, s47
    v_perm_b32 v56, v122, v121, s8
    v_lshlrev_b32 v121, 16, v57
    v_and_b32 v122, s46, v57
    v_ldexp_f32 v121, v121, s47
    v_ldexp_f32 v122, v122, s47
    v_perm_b32 v57, v122, v121, s8
    v_lshlrev_b32 v121, 16, v58
    v_and_b32 v122, s46, v58
    v_ldexp_f32 v121, v121, s47
    v_ldexp_f32 v122, v122, s47
    v_perm_b32 v58, v122, v121, s8
    v_lshlrev_b32 v121, 16, v59
    v_and_b32 v122, s46, v59
    v_ldexp_f32 v121, v121, s47
    v_ldexp_f32 v122, v122, s47
    v_perm_b32 v59, v122, v121, s8
    v_lshlrev_b32 v121, 16, v60
    v_and_b32 v122, s46, v60
    v_ldexp_f32 v121, v121, s47
    v_ldexp_f32 v122, v122, s47
    v_perm_b32 v60, v122, v121, s8
    v_lshlrev_b32 v121, 16, v61
    v_and_b32 v122, s46, v61
    v_ldexp_f32 v121, v121, s47
    v_ldexp_f32 v122, v122, s47
    v_perm_b32 v61, v122, v121, s8
    v_lshlrev_b32 v121, 16, v62
    v_and_b32 v122, s46, v62
    v_ldexp_f32 v121, v121, s47
    v_ldexp_f32 v122, v122, s47
    v_perm_b32 v62, v122, v121, s8
    v_lshlrev_b32 v121, 16, v63
    v_and_b32 v122, s46, v63
    v_ldexp_f32 v121, v121, s47
    v_ldexp_f32 v122, v122, s47
    v_perm_b32 v63, v122, v121, s8
    v_lshlrev_b32 v121, 16, v64
    v_and_b32 v122, s46, v64
    v_ldexp_f32 v121, v121, s47
    v_ldexp_f32 v122, v122, s47
    v_perm_b32 v64, v122, v121, s8
    v_lshlrev_b32 v121, 16, v65
    v_and_b32 v122, s46, v65
    v_ldexp_f32 v121, v121, s47
    v_ldexp_f32 v122, v122, s47
    v_perm_b32 v65, v122, v121, s8
    v_lshlrev_b32 v121, 16, v66
    v_and_b32 v122, s46, v66
    v_ldexp_f32 v121, v121, s47
    v_ldexp_f32 v122, v122, s47
    v_perm_b32 v66, v122, v121, s8
    v_lshlrev_b32 v121, 16, v67
    v_and_b32 v122, s46, v67
    v_ldexp_f32 v121, v121, s47
    v_ldexp_f32 v122, v122, s47
    v_perm_b32 v67, v122, v121, s8
    v_lshlrev_b32 v121, 16, v68
    v_and_b32 v122, s46, v68
    v_ldexp_f32 v121, v121, s47
    v_ldexp_f32 v122, v122, s47
    v_perm_b32 v68, v122, v121, s8
    v_lshlrev_b32 v121, 16, v69
    v_and_b32 v122, s46, v69
    v_ldexp_f32 v121, v121, s47
    v_ldexp_f32 v122, v122, s47
    v_perm_b32 v69, v122, v121, s8
    v_lshlrev_b32 v121, 16, v70
    v_and_b32 v122, s46, v70
    v_ldexp_f32 v121, v121, s47
    v_ldexp_f32 v122, v122, s47
    v_perm_b32 v70, v122, v121, s8
    v_lshlrev_b32 v121, 16, v71
    v_and_b32 v122, s46, v71
    v_ldexp_f32 v121, v121, s47
    v_ldexp_f32 v122, v122, s47
    v_perm_b32 v71, v122, v121, s8
    v_lshlrev_b32 v121, 16, v72
    v_and_b32 v122, s46, v72
    v_ldexp_f32 v121, v121, s47
    v_ldexp_f32 v122, v122, s47
    v_perm_b32 v72, v122, v121, s8
    v_lshlrev_b32 v121, 16, v73
    v_and_b32 v122, s46, v73
    v_ldexp_f32 v121, v121, s47
    v_ldexp_f32 v122, v122, s47
    v_perm_b32 v73, v122, v121, s8
    v_lshlrev_b32 v121, 16, v74
    v_and_b32 v122, s46, v74
    v_ldexp_f32 v121, v121, s47
    v_ldexp_f32 v122, v122, s47
    v_perm_b32 v74, v122, v121, s8
    v_lshlrev_b32 v121, 16, v75
    v_and_b32 v122, s46, v75
    v_ldexp_f32 v121, v121, s47
    v_ldexp_f32 v122, v122, s47
    v_perm_b32 v75, v122, v121, s8
    v_lshlrev_b32 v121, 16, v76
    v_and_b32 v122, s46, v76
    v_ldexp_f32 v121, v121, s47
    v_ldexp_f32 v122, v122, s47
    v_perm_b32 v76, v122, v121, s8
    v_lshlrev_b32 v121, 16, v77
    v_and_b32 v122, s46, v77
    v_ldexp_f32 v121, v121, s47
    v_ldexp_f32 v122, v122, s47
    v_perm_b32 v77, v122, v121, s8
    v_lshlrev_b32 v121, 16, v78
    v_and_b32 v122, s46, v78
    v_ldexp_f32 v121, v121, s47
    v_ldexp_f32 v122, v122, s47
    v_perm_b32 v78, v122, v121, s8
    v_lshlrev_b32 v121, 16, v79
    v_and_b32 v122, s46, v79
    v_ldexp_f32 v121, v121, s47
    v_ldexp_f32 v122, v122, s47
    v_perm_b32 v79, v122, v121, s8
    v_lshlrev_b32 v121, 16, v220
    v_and_b32 v122, s46, v220
    v_ldexp_f32 v121, v121, s7
    v_ldexp_f32 v122, v122, s7
    v_perm_b32 v220, v122, v121, s8
    v_lshlrev_b32 v121, 16, v221
    v_and_b32 v122, s46, v221
    v_ldexp_f32 v121, v121, s7
    v_ldexp_f32 v122, v122, s7
    v_perm_b32 v221, v122, v121, s8
    v_lshlrev_b32 v121, 16, v222
    v_and_b32 v122, s46, v222
    v_ldexp_f32 v121, v121, s7
    v_ldexp_f32 v122, v122, s7
    v_perm_b32 v222, v122, v121, s8
    v_lshlrev_b32 v121, 16, v223
    v_and_b32 v122, s46, v223
    v_ldexp_f32 v121, v121, s7
    v_ldexp_f32 v122, v122, s7
    v_perm_b32 v223, v122, v121, s8
    s_add_u32 s6, s47, 10
    v_cmp_lt_u32 vcc, 31, v1
    v_mov_b32 v121, s6
    v_mov_b32 v122, s7
    v_cndmask_b32 v9, v121, v122, vcc
    s_mov_b32 s52, 0
    s_mov_b32 s53, 0
    s_nop 7
    s_branch L_wconv
L_efix:
    s_waitcnt vmcnt(0) lgkmcnt(0)
    s_nop 15
    s_mul_i32 s6, s4, 104
    v_mul_u32_u24 v121, 28, v4
    v_min_u32 v122, 76, v121
    v_add_u32 v121, s6, v121
    v_add_u32 v122, s6, v122
    global_load_dwordx4 v[204:207], v121, s[16:17]
    global_load_dwordx3 v[208:210], v122, s[16:17] offset:16
    s_waitcnt vmcnt(1)
    v_lshl_add_u32 v204, v204, 8, v14
    v_lshl_add_u32 v205, v205, 8, v14
    v_lshl_add_u32 v206, v206, 8, v14
    v_lshl_add_u32 v207, v207, 8, v14
    s_waitcnt vmcnt(0)
    v_lshl_add_u32 v208, v208, 8, v14
    v_lshl_add_u32 v209, v209, 8, v14
    v_lshl_add_u32 v210, v210, 8, v14
    buffer_load_dwordx4 v[144:147], v204, s[56:59], 0 offen
    buffer_load_dwordx4 v[148:151], v205, s[56:59], 0 offen
    buffer_load_dwordx4 v[152:155], v206, s[56:59], 0 offen
    buffer_load_dwordx4 v[156:159], v207, s[56:59], 0 offen
    buffer_load_dwordx4 v[160:163], v208, s[56:59], 0 offen
    buffer_load_dwordx4 v[164:167], v209, s[56:59], 0 offen
    buffer_load_dwordx4 v[168:171], v210, s[56:59], 0 offen
    s_waitcnt vmcnt(0)
    s_mov_b32 s8, 0x07060302
    v_mov_b32 v121, 0
    v_and_b32 v122, s44, v144
    v_pk_max_u16 v121, v121, v122
    v_and_b32 v122, s44, v145
    v_pk_max_u16 v121, v121, v122
    v_and_b32 v122, s44, v146
    v_pk_max_u16 v121, v121, v122
    v_and_b32 v122, s44, v147
    v_pk_max_u16 v121, v121, v122
    v_and_b32 v122, s44, v148
    v_pk_max_u16 v121, v121, v122
    v_and_b32 v122, s44, v149
    v_pk_max_u16 v121, v121, v122
    v_and_b32 v122, s44, v150
    v_pk_max_u16 v121, v121, v122
    v_and_b32 v122, s44, v151
    v_pk_max_u16 v121, v121, v122
    v_and_b32 v122, s44, v152
    v_pk_max_u16 v121, v121, v122
    v_and_b32 v122, s44, v153
    v_pk_max_u16 v121, v121, v122
    v_and_b32 v122, s44, v154
    v_pk_max_u16 v121, v121, v122
    v_and_b32 v122, s44, v155
    v_pk_max_u16 v121, v121, v122
    v_and_b32 v122, s44, v156
    v_pk_max_u16 v121, v121, v122
    v_and_b32 v122, s44, v157
    v_pk_max_u16 v121, v121, v122
    v_and_b32 v122, s44, v158
    v_pk_max_u16 v121, v121, v122
    v_and_b32 v122, s44, v159
    v_pk_max_u16 v121, v121, v122
    v_and_b32 v122, s44, v160
    v_pk_max_u16 v121, v121, v122
    v_and_b32 v122, s44, v161
    v_pk_max_u16 v121, v121, v122
    v_and_b32 v122, s44, v162
    v_pk_max_u16 v121, v121, v122
    v_and_b32 v122, s44, v163
    v_pk_max_u16 v121, v121, v122
    v_and_b32 v122, s44, v164
    v_pk_max_u16 v121, v121, v122
    v_and_b32 v122, s44, v165
    v_pk_max_u16 v121, v121, v122
    v_and_b32 v122, s44, v166
    v_pk_max_u16 v121, v121, v122
    v_and_b32 v122, s44, v167
    v_pk_max_u16 v121, v121, v122
    v_and_b32 v122, s44, v168
    v_pk_max_u16 v121, v121, v122
    v_and_b32 v122, s44, v169
    v_pk_max_u16 v121, v121, v122
    v_and_b32 v122, s44, v170
    v_pk_max_u16 v121, v121, v122
    v_and_b32 v122, s44, v171
    v_pk_max_u16 v121, v121, v122
    v_pk_max_u16 v121, v121, v121 op_sel:[0,1] op_sel_hi:[1,0]
    s_nop 1
    v_max_u32_dpp v121, v121, v121 row_ror:8 row_mask:0xf bank_mask:0xf
    s_nop 1
    v_max_u32_dpp v121, v121, v121 row_ror:4 row_mask:0xf bank_mask:0xf
    s_nop 1
    v_max_u32_dpp v121, v121, v121 row_ror:2 row_mask:0xf bank_mask:0xf
    s_nop 1
    v_max_u32_dpp v121, v121, v121 row_ror:1 row_mask:0xf bank_mask:0xf
    s_nop 1
    v_max_u32_dpp v121, v121, v121 row_bcast:15 row_mask:0xa bank_mask:0xf
    s_nop 1
    v_max_u32_dpp v121, v121, v121 row_bcast:31 row_mask:0xc bank_mask:0xf
    s_nop 0
    v_readlane_b32 s6, v121, 63
    s_nop 0
    s_bfe_u32 s6, s6, 0x80007
    s_max_u32 s6, s6, 104
    s_min_u32 s6, s6, 190
    s_sub_u32 s6, 129, s6
    v_lshlrev_b32 v121, 16, v144
    v_and_b32 v122, s46, v144
    v_ldexp_f32 v121, v121, s6
    v_ldexp_f32 v122, v122, s6
    v_perm_b32 v144, v122, v121, s8
    v_lshlrev_b32 v121, 16, v145
    v_and_b32 v122, s46, v145
    v_ldexp_f32 v121, v121, s6
    v_ldexp_f32 v122, v122, s6
    v_perm_b32 v145, v122, v121, s8
    v_lshlrev_b32 v121, 16, v146
    v_and_b32 v122, s46, v146
    v_ldexp_f32 v121, v121, s6
    v_ldexp_f32 v122, v122, s6
    v_perm_b32 v146, v122, v121, s8
    v_lshlrev_b32 v121, 16, v147
    v_and_b32 v122, s46, v147
    v_ldexp_f32 v121, v121, s6
    v_ldexp_f32 v122, v122, s6
    v_perm_b32 v147, v122, v121, s8
    v_lshlrev_b32 v121, 16, v148
    v_and_b32 v122, s46, v148
    v_ldexp_f32 v121, v121, s6
    v_ldexp_f32 v122, v122, s6
    v_perm_b32 v148, v122, v121, s8
    v_lshlrev_b32 v121, 16, v149
    v_and_b32 v122, s46, v149
    v_ldexp_f32 v121, v121, s6
    v_ldexp_f32 v122, v122, s6
    v_perm_b32 v149, v122, v121, s8
    v_lshlrev_b32 v121, 16, v150
    v_and_b32 v122, s46, v150
    v_ldexp_f32 v121, v121, s6
    v_ldexp_f32 v122, v122, s6
    v_perm_b32 v150, v122, v121, s8
    v_lshlrev_b32 v121, 16, v151
    v_and_b32 v122, s46, v151
    v_ldexp_f32 v121, v121, s6
    v_ldexp_f32 v122, v122, s6
    v_perm_b32 v151, v122, v121, s8
    v_lshlrev_b32 v121, 16, v152
    v_and_b32 v122, s46, v152
    v_ldexp_f32 v121, v121, s6
    v_ldexp_f32 v122, v122, s6
    v_perm_b32 v152, v122, v121, s8
    v_lshlrev_b32 v121, 16, v153
    v_and_b32 v122, s46, v153
    v_ldexp_f32 v121, v121, s6
    v_ldexp_f32 v122, v122, s6
    v_perm_b32 v153, v122, v121, s8
    v_lshlrev_b32 v121, 16, v154
    v_and_b32 v122, s46, v154
    v_ldexp_f32 v121, v121, s6
    v_ldexp_f32 v122, v122, s6
    v_perm_b32 v154, v122, v121, s8
    v_lshlrev_b32 v121, 16, v155
    v_and_b32 v122, s46, v155
    v_ldexp_f32 v121, v121, s6
    v_ldexp_f32 v122, v122, s6
    v_perm_b32 v155, v122, v121, s8
    v_lshlrev_b32 v121, 16, v156
    v_and_b32 v122, s46, v156
    v_ldexp_f32 v121, v121, s6
    v_ldexp_f32 v122, v122, s6
    v_perm_b32 v156, v122, v121, s8
    v_lshlrev_b32 v121, 16, v157
    v_and_b32 v122, s46, v157
    v_ldexp_f32 v121, v121, s6
    v_ldexp_f32 v122, v122, s6
    v_perm_b32 v157, v122, v121, s8
    v_lshlrev_b32 v121, 16, v158
    v_and_b32 v122, s46, v158
    v_ldexp_f32 v121, v121, s6
    v_ldexp_f32 v122, v122, s6
    v_perm_b32 v158, v122, v121, s8
    v_lshlrev_b32 v121, 16, v159
    v_and_b32 v122, s46, v159
    v_ldexp_f32 v121, v121, s6
    v_ldexp_f32 v122, v122, s6
    v_perm_b32 v159, v122, v121, s8
    v_lshlrev_b32 v121, 16, v160
    v_and_b32 v122, s46, v160
    v_ldexp_f32 v121, v121, s6
    v_ldexp_f32 v122, v122, s6
    v_perm_b32 v160, v122, v121, s8
    v_lshlrev_b32 v121, 16, v161
    v_and_b32 v122, s46, v161
    v_ldexp_f32 v121, v121, s6
    v_ldexp_f32 v122, v122, s6
    v_perm_b32 v161, v122, v121, s8
    v_lshlrev_b32 v121, 16, v162
    v_and_b32 v122, s46, v162
    v_ldexp_f32 v121, v121, s6
    v_ldexp_f32 v122, v122, s6
    v_perm_b32 v162, v122, v121, s8
    v_lshlrev_b32 v121, 16, v163
    v_and_b32 v122, s46, v163
    v_ldexp_f32 v121, v121, s6
    v_ldexp_f32 v122, v122, s6
    v_perm_b32 v163, v122, v121, s8
    v_lshlrev_b32 v121, 16, v164
    v_and_b32 v122, s46, v164
    v_ldexp_f32 v121, v121, s6
    v_ldexp_f32 v122, v122, s6
    v_perm_b32 v164, v122, v121, s8
    v_lshlrev_b32 v121, 16, v165
    v_and_b32 v122, s46, v165
    v_ldexp_f32 v121, v121, s6
    v_ldexp_f32 v122, v122, s6
    v_perm_b32 v165, v122, v121, s8
    v_lshlrev_b32 v121, 16, v166
    v_and_b32 v122, s46, v166
    v_ldexp_f32 v121, v121, s6
    v_ldexp_f32 v122, v122, s6
    v_perm_b32 v166, v122, v121, s8
    v_lshlrev_b32 v121, 16, v167
    v_and_b32 v122, s46, v167
    v_ldexp_f32 v121, v121, s6
    v_ldexp_f32 v122, v122, s6
    v_perm_b32 v167, v122, v121, s8
    v_lshlrev_b32 v121, 16, v168
    v_and_b32 v122, s46, v168
    v_ldexp_f32 v121, v121, s6
    v_ldexp_f32 v122, v122, s6
    v_perm_b32 v168, v122, v121, s8
    v_lshlrev_b32 v121, 16, v169
    v_and_b32 v122, s46, v169
    v_ldexp_f32 v121, v121, s6
    v_ldexp_f32 v122, v122, s6
    v_perm_b32 v169, v122, v121, s8
    v_lshlrev_b32 v121, 16, v170
    v_and_b32 v122, s46, v170
    v_ldexp_f32 v121, v121, s6
    v_ldexp_f32 v122, v122, s6
    v_perm_b32 v170, v122, v121, s8
    v_lshlrev_b32 v121, 16, v171
    v_and_b32 v122, s46, v171
    v_ldexp_f32 v121, v121, s6
    v_ldexp_f32 v122, v122, s6
    v_perm_b32 v171, v122, v121, s8
    s_lshl_b32 s6, s6, 1
    v_ldexp_f32 v16, v16, s6
    v_ldexp_f32 v17, v17, s6
    v_ldexp_f32 v18, v18, s6
    v_ldexp_f32 v19, v19, s6
    v_ldexp_f32 v20, v20, s6
    v_ldexp_f32 v21, v21, s6
    v_ldexp_f32 v22, v22, s6
    v_ldexp_f32 v23, v23, s6
    v_ldexp_f32 v24, v24, s6
    v_ldexp_f32 v25, v25, s6
    v_ldexp_f32 v26, v26, s6
    v_ldexp_f32 v27, v27, s6
    v_ldexp_f32 v28, v28, s6
    v_ldexp_f32 v29, v29, s6
    v_ldexp_f32 v30, v30, s6
    v_ldexp_f32 v31, v31, s6
    v_ldexp_f32 v32, v32, s6
    v_ldexp_f32 v33, v33, s6
    v_ldexp_f32 v34, v34, s6
    v_ldexp_f32 v35, v35, s6
    v_ldexp_f32 v36, v36, s6
    v_ldexp_f32 v37, v37, s6
    v_ldexp_f32 v38, v38, s6
    v_ldexp_f32 v39, v39, s6
    v_ldexp_f32 v40, v40, s6
    v_ldexp_f32 v41, v41, s6
    v_ldexp_f32 v42, v42, s6
    v_ldexp_f32 v43, v43, s6
    v_ldexp_f32 v44, v44, s6
    v_ldexp_f32 v45, v45, s6
    v_ldexp_f32 v46, v46, s6
    v_ldexp_f32 v47, v47, s6
    s_add_u32 s7, s5, -28096
    v_add_u32 v0, s7, v15
    ds_write_b128 v0, v[16:19] offset:37888
    ds_write_b128 v0, v[20:23] offset:37952
    ds_write_b128 v0, v[24:27] offset:38016
    ds_write_b128 v0, v[28:31] offset:38080
    ds_write_b128 v0, v[32:35] offset:38144
    ds_write_b128 v0, v[36:39] offset:38208
    ds_write_b128 v0, v[40:43] offset:38272
    ds_write_b128 v0, v[44:47] offset:38336
    s_waitcnt lgkmcnt(0)
    s_add_u32 s54, s54, s6
    s_lshl_b32 s6, s6, 23
    s_sub_u32 s55, s55, s6
    s_mov_b32 s50, 0x7fc00000
    s_mov_b32 s51, 0
    s_mov_b32 s52, 0
    s_mov_b32 s53, 0
    s_nop 7
    s_branch L_econv
L_tailmax:
    s_nop 3
    v_mov_b32 v176, s14
    v_max_f32 v248, s14, v196
    s_nop 1
    v_max_f32_dpp v248, v248, v248 row_ror:8 row_mask:0xf bank_mask:0xf
    s_nop 1
    v_max_f32_dpp v248, v248, v248 row_ror:4 row_mask:0xf bank_mask:0xf
    s_nop 1
    v_max_f32_dpp v248, v248, v248 row_ror:2 row_mask:0xf bank_mask:0xf
    s_nop 1
    v_max_f32_dpp v248, v248, v248 row_ror:1 row_mask:0xf bank_mask:0xf
    s_nop 1
    v_max_f32_dpp v248, v248, v248 row_bcast:15 row_mask:0xa bank_mask:0xf
    s_nop 1
    v_max_f32_dpp v248, v248, v248 row_bcast:31 row_mask:0xc bank_mask:0xf
    s_nop 0
    v_readlane_b32 s13, v248, 63
    s_nop 1
    v_subrev_f32 v196, s13, v196
    v_subrev_f32 v176, s13, v176
    v_mul_f32 v196, s55, v196
    v_mul_f32 v176, s55, v176
    v_exp_f32 v196, v196
    v_exp_f32 v176, v176
    v_mul_f32 v199, v196, v231
    v_fma_f32 v249, v249, v176, v196
    v_fma_f32 v250, v250, v176, v199
    s_nop 3
    s_branch L_tailsum
s_endpgm
.p2align 7
.type L_tab,@object
L_tab:
.long 0x98000000, 0xa0000, 0x0, 0x0
.long 0x98020010, 0xa0004, 0x8, 0x1200010
.long 0x98040020, 0xa0008, 0x10, 0x2400020
.long 0x98060030, 0xa000c, 0x18, 0x3600030
.long 0x98080040, 0xa0010, 0x120, 0x4800040
.long 0x980a0050, 0xa0014, 0x128, 0x5a00050
.long 0x980c0060, 0xa0018, 0x130, 0x6c00060
.long 0x980e0070, 0xa001c, 0x138, 0x7e00070
.long 0x98100080, 0xa0020, 0x240, 0x9000080
.long 0x98120090, 0xa0024, 0x248, 0xa200090
.long 0x981400a0, 0xa0028, 0x250, 0xb4000a0
.long 0x981600b0, 0xa002c, 0x258, 0xc6000b0
.long 0x981800c0, 0xa0030, 0x360, 0xd8000c0
.long 0x981a00d0, 0xa0034, 0x368, 0xea000d0
.long 0x981c00e0, 0xa0038, 0x370, 0xfc000e0
.long 0x981e00f0, 0xa003c, 0x378, 0x10e000f0
.long 0x98200120, 0xa0040, 0x100980, 0x100120
.long 0x98220130, 0xa0044, 0x100988, 0x1300130
.long 0x98240140, 0xa0048, 0x100990, 0x2500140
.long 0x98260150, 0xa004c, 0x100998, 0x3700150
.long 0x98280160, 0xa0050, 0x100aa0, 0x4900160
.long 0x982a0170, 0xa0054, 0x100aa8, 0x5b00170
.long 0x982c0180, 0xa0058, 0x100ab0, 0x6d00180
.long 0x982e0190, 0xa005c, 0x100ab8, 0x7f00190
.long 0x983001a0, 0xa0060, 0x100bc0, 0x91001a0
.long 0x983201b0, 0xa0064, 0x100bc8, 0xa3001b0
.long 0x983401c0, 0xa0068, 0x100bd0, 0xb5001c0
.long 0x983601d0, 0xa006c, 0x100bd8, 0xc7001d0
.long 0x983801e0, 0xa0070, 0x100ce0, 0xd9001e0
.long 0x983a01f0, 0xa0074, 0x100ce8, 0xeb001f0
.long 0x983c0200, 0xa0078, 0x100cf0, 0xfd00200
.long 0x983e0210, 0xa007c, 0x100cf8, 0x10f00210
.long 0x98400240, 0x200, 0x201280, 0x200240
.long 0x98420250, 0x204, 0x201288, 0x1400250
.long 0x98440260, 0x208, 0x201290, 0x2600260
.long 0x98460270, 0x20c, 0x201298, 0x3800270
.long 0x98480280, 0x210, 0x2013a0, 0x4a00280
.long 0x984a0290, 0x214, 0x2013a8, 0x5c00290
.long 0x984c02a0, 0x218, 0x2013b0, 0x6e002a0
.long 0x984e02b0, 0x21c, 0x2013b8, 0x80002b0
.long 0x985002c0, 0x220, 0x2014c0, 0x92002c0
.long 0x985202d0, 0x224, 0x2014c8, 0xa4002d0
.long 0x985402e0, 0x228, 0x2014d0, 0xb6002e0
.long 0x985602f0, 0x22c, 0x2014d8, 0xc8002f0
.long 0x98580300, 0x230, 0x2015e0, 0xda00300
.long 0x985a0310, 0x234, 0x2015e8, 0xec00310
.long 0x985c0320, 0x238, 0x2015f0, 0xfe00320
.long 0x985e0330, 0x23c, 0x2015f8, 0x11000330
.long 0x98600360, 0x240, 0x301c00, 0x300360
.long 0x98620370, 0x244, 0x301c08, 0x1500370
.long 0x98640380, 0x248, 0x301c10, 0x2700380
.long 0x98660390, 0x24c, 0x301c18, 0x3900390
.long 0x986803a0, 0x250, 0x301d20, 0x4b003a0
.long 0x986a03b0, 0x254, 0x301d28, 0x5d003b0
.long 0x986c03c0, 0x258, 0x301d30, 0x6f003c0
.long 0x986e03d0, 0x25c, 0x301d38, 0x81003d0
.long 0x987003e0, 0x260, 0x301e40, 0x93003e0
.long 0x987203f0, 0x264, 0x301e48, 0xa5003f0
.long 0x98740400, 0x268, 0x301e50, 0xb700400
.long 0x98760410, 0x26c, 0x301e58, 0xc900410
.long 0x98780420, 0x270, 0x301f60, 0xdb00420
.long 0x987a0430, 0x274, 0x301f68, 0xed00430
.long 0x987c0440, 0x278, 0x301f70, 0xff00440
.long 0x987e0450, 0x27c, 0x301f78, 0x11100450
.long 0x120, 0x98000000, 0x0, 0x0
.long 0x240, 0x98400120, 0x0, 0x0
.long 0x360, 0x98800240, 0x0, 0x0
.long 0x480, 0x98c00360, 0x0, 0x0
.long 0x5a0, 0x99000480, 0x0, 0x0
.long 0x6c0, 0x994005a0, 0x0, 0x0
.long 0x7e0, 0x998006c0, 0x0, 0x0
.long 0x900, 0x99c007e0, 0x0, 0x0
.long 0xa20, 0x98100900, 0x0, 0x0
.long 0xb40, 0x98500a20, 0x0, 0x0
.long 0xc60, 0x98900a20, 0x0, 0x0
.long 0xd80, 0x98d00a20, 0x0, 0x0
.long 0xea0, 0x99100a20, 0x0, 0x0
.long 0xfc0, 0x99500a20, 0x0, 0x0
.long 0x10e0, 0x99900a20, 0x0, 0x0
.long 0x0, 0x99d00a20, 0x0, 0x0
.long 0x100130, 0x98080010, 0x0, 0x0
.long 0x100250, 0x98480130, 0x0, 0x0
.long 0x100370, 0x98880250, 0x0, 0x0
.long 0x100490, 0x98c80370, 0x0, 0x0
.long 0x1005b0, 0x99080490, 0x0, 0x0
.long 0x1006d0, 0x994805b0, 0x0, 0x0
.long 0x1007f0, 0x998806d0, 0x0, 0x0
.long 0x100910, 0x99c807f0, 0x0, 0x0
.long 0x100a30, 0x98180910, 0x0, 0x0
.long 0x100b50, 0x98580a30, 0x0, 0x0
.long 0x100c70, 0x98980a30, 0x0, 0x0
.long 0x100d90, 0x98d80a30, 0x0, 0x0
.long 0x100eb0, 0x99180a30, 0x0, 0x0
.long 0x100fd0, 0x99580a30, 0x0, 0x0
.long 0x1010f0, 0x99980a30, 0x0, 0x0
.long 0x100010, 0x99d80a30, 0x0, 0x0
.long 0x200140, 0x98040020, 0x0, 0x0
.long 0x200260, 0x98440140, 0x0, 0x0
.long 0x200380, 0x98840260, 0x0, 0x0
.long 0x2004a0, 0x98c40380, 0x0, 0x0
.long 0x2005c0, 0x990404a0, 0x0, 0x0
.long 0x2006e0, 0x994405c0, 0x0, 0x0
.long 0x200800, 0x998406e0, 0x0, 0x0
.long 0x200920, 0x99c40800, 0x0, 0x0
.long 0x200a40, 0x98140920, 0x0, 0x0
.long 0x200b60, 0x98540a40, 0x0, 0x0
.long 0x200c80, 0x98940a40, 0x0, 0x0
.long 0x200da0, 0x98d40a40, 0x0, 0x0
.long 0x200ec0, 0x99140a40, 0x0, 0x0
.long 0x200fe0, 0x99540a40, 0x0, 0x0
.long 0x201100, 0x99940a40, 0x0, 0x0
.long 0x200020, 0x99d40a40, 0x0, 0x0
.long 0x300150, 0x980c0030, 0x0, 0x0
.long 0x300270, 0x984c0150, 0x0, 0x0
.long 0x300390, 0x988c0270, 0x0, 0x0
.long 0x3004b0, 0x98cc0390, 0x0, 0x0
.long 0x3005d0, 0x990c04b0, 0x0, 0x0
.long 0x3006f0, 0x994c05d0, 0x0, 0x0
.long 0x300810, 0x998c06f0, 0x0, 0x0
.long 0x300930, 0x99cc0810, 0x0, 0x0
.long 0x300a50, 0x981c0930, 0x0, 0x0
.long 0x300b70, 0x985c0a50, 0x0, 0x0
.long 0x300c90, 0x989c0a50, 0x0, 0x0
.long 0x300db0, 0x98dc0a50, 0x0, 0x0
.long 0x300ed0, 0x991c0a50, 0x0, 0x0
.long 0x300ff0, 0x995c0a50, 0x0, 0x0
.long 0x301110, 0x999c0a50, 0x0, 0x0
.long 0x300030, 0x99dc0a50, 0x0, 0x0
.long 0x2f40, 0x1203180, 0x6c026d0, 0x9002910
.long 0x1202f44, 0x2403184, 0x7e02764, 0xa2029a4
.long 0x2402f48, 0x3603188, 0x90027f8, 0x2a38
.long 0x3602f4c, 0x480318c, 0xa20288c, 0x1202acc
.long 0x4802f50, 0x5a03190, 0x2920, 0x3602b60
.long 0x5a02f54, 0x6c03194, 0x12029b4, 0x4802bf4
.long 0x6c02f58, 0x7e03198, 0x2402a48, 0x5a02c88
.long 0x7e02f5c, 0x900319c, 0x3602adc, 0x6c02d1c
.long 0x9002f60, 0xa2031a0, 0x4802b70, 0x7e02db0
.long 0xa202f64, 0x31a4, 0x5a02c04, 0x9002e44
.long 0x2f68, 0x24031a8, 0x6c02c98, 0xa202ed8
.long 0x1202f6c, 0x36031ac, 0x7e02d2c, 0x266c
.long 0x2402f70, 0x48031b0, 0x9002dc0, 0x1202700
.long 0x3602f74, 0x5a031b4, 0xa202e54, 0x2402794
.long 0x4802f78, 0x6c031b8, 0x2ee8, 0x4802828
.long 0x5a02f7c, 0x7e031bc, 0x120267c, 0x5a028bc
.long 0x102fd0, 0x1303210, 0x6d02760, 0x91029a0
.long 0x1302fd4, 0x2503214, 0x7f027f4, 0xa302a34
.long 0x2502fd8, 0x3703218, 0x9102888, 0x102ac8
.long 0x3702fdc, 0x490321c, 0xa30291c, 0x1302b5c
.long 0x4902fe0, 0x5b03220, 0x1029b0, 0x3702bf0
.long 0x5b02fe4, 0x6d03224, 0x1302a44, 0x4902c84
.long 0x6d02fe8, 0x7f03228, 0x2502ad8, 0x5b02d18
.long 0x7f02fec, 0x910322c, 0x3702b6c, 0x6d02dac
.long 0x9102ff0, 0xa303230, 0x4902c00, 0x7f02e40
.long 0xa302ff4, 0x103234, 0x5b02c94, 0x9102ed4
.long 0x102ff8, 0x2503238, 0x6d02d28, 0xa302668
.long 0x1302ffc, 0x370323c, 0x7f02dbc, 0x1026fc
.long 0x2503000, 0x4903240, 0x9102e50, 0x1302790
.long 0x3703004, 0x5b03244, 0xa302ee4, 0x2502824
.long 0x4903008, 0x6d03248, 0x102678, 0x49028b8
.long 0x5b0300c, 0x7f0324c, 0x130270c, 0x5b0294c
.long 0x203060, 0x14032a0, 0x6e027f0, 0x9202a30
.long 0x1403064, 0x26032a4, 0x8002884, 0xa402ac4
.long 0x2603068, 0x38032a8, 0x9202918, 0x202b58
.long 0x380306c, 0x4a032ac, 0xa4029ac, 0x1402bec
.long 0x4a03070, 0x5c032b0, 0x202a40, 0x3802c80
.long 0x5c03074, 0x6e032b4, 0x1402ad4, 0x4a02d14
.long 0x6e03078, 0x80032b8, 0x2602b68, 0x5c02da8
.long 0x800307c, 0x92032bc, 0x3802bfc, 0x6e02e3c
.long 0x9203080, 0xa4032c0, 0x4a02c90, 0x8002ed0
.long 0xa403084, 0x2032c4, 0x5c02d24, 0x9202664
.long 0x203088, 0x26032c8, 0x6e02db8, 0xa4026f8
.long 0x140308c, 0x38032cc, 0x8002e4c, 0x20278c
.long 0x2603090, 0x4a032d0, 0x9202ee0, 0x1402820
.long 0x3803094, 0x5c032d4, 0xa402674, 0x26028b4
.long 0x4a03098, 0x6e032d8, 0x202708, 0x4a02948
.long 0x5c0309c, 0x80032dc, 0x140279c, 0x5c029dc
.long 0x3030f0, 0x1503330, 0x6f02880, 0x9302ac0
.long 0x15030f4, 0x2703334, 0x8102914, 0xa502b54
.long 0x27030f8, 0x3903338, 0x93029a8, 0x302be8
.long 0x39030fc, 0x4b0333c, 0xa502a3c, 0x1502c7c
.long 0x4b03100, 0x5d03340, 0x302ad0, 0x3902d10
.long 0x5d03104, 0x6f03344, 0x1502b64, 0x4b02da4
.long 0x6f03108, 0x8103348, 0x2702bf8, 0x5d02e38
.long 0x810310c, 0x930334c, 0x3902c8c, 0x6f02ecc
.long 0x9303110, 0xa503350, 0x4b02d20, 0x8102660
.long 0xa503114, 0x303354, 0x5d02db4, 0x93026f4
.long 0x303118, 0x2703358, 0x6f02e48, 0xa502788
.long 0x150311c, 0x390335c, 0x8102edc, 0x30281c
.long 0x2703120, 0x4b03360, 0x9302670, 0x15028b0
.long 0x3903124, 0x5d03364, 0xa502704, 0x2702944
.long 0x4b03128, 0x6f03368, 0x302798, 0x4b029d8
.long 0x5d0312c, 0x810336c, 0x150282c, 0x5d02a6c
.long 0x24033c0, 0x6c03010, 0x2640, 0x0
.long 0x36033c4, 0x7e030a4, 0x426d0, 0x0
.long 0x48033c8, 0x9003138, 0x82760, 0x0
.long 0x5a033cc, 0xa2031cc, 0xc27f0, 0x0
.long 0x6c033d0, 0x3260, 0x102880, 0x0
.long 0x7e033d4, 0x12032f4, 0x142910, 0x0
.long 0x90033d8, 0x2403388, 0x1829a0, 0x0
.long 0xa2033dc, 0x360341c, 0x1c2a30, 0x0
.long 0x33e0, 0x5a034b0, 0x202ac0, 0x0
.long 0x12033e4, 0x6c02fa4, 0x242b50, 0x0
.long 0x24033e8, 0x7e030a0, 0x282be0, 0x0
.long 0x36033ec, 0x9003134, 0x2c2c70, 0x0
.long 0x48033f0, 0xa2031c8, 0x302d00, 0x0
.long 0x5a033f4, 0x325c, 0x342d90, 0x0
.long 0x6c033f8, 0x12032f0, 0x382e20, 0x0
.long 0x7e033fc, 0x2403384, 0x3c2eb0, 0x0
.long 0x25033c0, 0x6d03418, 0x402650, 0x0
.long 0x37033c4, 0x7f034ac, 0x4426e0, 0x0
.long 0x49033c8, 0x9102fa0, 0x482770, 0x0
.long 0x5b033cc, 0xa303034, 0x4c2800, 0x0
.long 0x6d033d0, 0x103130, 0x502890, 0x0
.long 0x7f033d4, 0x13031c4, 0x542920, 0x0
.long 0x91033d8, 0x2503258, 0x5829b0, 0x0
.long 0xa3033dc, 0x37032ec, 0x5c2a40, 0x0
.long 0x1033e0, 0x5b03380, 0x602ad0, 0x0
.long 0x13033e4, 0x6d03414, 0x642b60, 0x0
.long 0x25033e8, 0x7f034a8, 0x682bf0, 0x0
.long 0x37033ec, 0x9102f9c, 0x6c2c80, 0x0
.long 0x49033f0, 0xa303030, 0x702d10, 0x0
.long 0x5b033f4, 0x1030c4, 0x742da0, 0x0
.long 0x6d033f8, 0x13031c0, 0x782e30, 0x0
.long 0x7f033fc, 0x2503254, 0x7c2ec0, 0x0
.long 0x2603450, 0x6e032e8, 0x802660, 0x0
.long 0x3803454, 0x800337c, 0x8426f0, 0x0
.long 0x4a03458, 0x9203410, 0x882780, 0x0
.long 0x5c0345c, 0xa4034a4, 0x8c2810, 0x0
.long 0x6e03460, 0x202f98, 0x9028a0, 0x0
.long 0x8003464, 0x140302c, 0x942930, 0x0
.long 0x9203468, 0x26030c0, 0x9829c0, 0x0
.long 0xa40346c, 0x3803154, 0x9c2a50, 0x0
.long 0x203470, 0x5c03250, 0xa02ae0, 0x0
.long 0x1403474, 0x6e032e4, 0xa42b70, 0x0
.long 0x2603478, 0x8003378, 0xa82c00, 0x0
.long 0x380347c, 0x920340c, 0xac2c90, 0x0
.long 0x4a03480, 0xa4034a0, 0xb02d20, 0x0
.long 0x5c03484, 0x202f94, 0xb42db0, 0x0
.long 0x6e03488, 0x1403028, 0xb82e40, 0x0
.long 0x800348c, 0x26030bc, 0xbc2ed0, 0x0
.long 0x2703450, 0x6f03150, 0xc02670, 0x0
.long 0x3903454, 0x81031e4, 0xc42700, 0x0
.long 0x4b03458, 0x93032e0, 0xc82790, 0x0
.long 0x5d0345c, 0xa503374, 0xcc2820, 0x0
.long 0x6f03460, 0x303408, 0xd028b0, 0x0
.long 0x8103464, 0x150349c, 0xd42940, 0x0
.long 0x9303468, 0x2702f90, 0xd829d0, 0x0
.long 0xa50346c, 0x3903024, 0xdc2a60, 0x0
.long 0x303470, 0x5d030b8, 0xe02af0, 0x0
.long 0x1503474, 0x6f0314c, 0xe42b80, 0x0
.long 0x2703478, 0x81031e0, 0xe82c10, 0x0
.long 0x390347c, 0x9303274, 0xec2ca0, 0x0
.long 0x4b03480, 0xa503370, 0xf02d30, 0x0
.long 0x5d03484, 0x303404, 0xf42dc0, 0x0
.long 0x6f03488, 0x1503498, 0xf82e50, 0x0
.long 0x810348c, 0x2702f8c, 0xfc2ee0, 0x0
L_ctab:
.long 0xffffffff, 0xffffff, 0xffff, 0xffff, 0xffffffff, 0x1fff, 0x11111111, 0x11111111, 0x7fff7fff, 0x80008000, 0xffff0000, 0x0, 0x2800000, 0x280, 0x43800000, 0x41000000, 0x40004000, 0x1, 0xa, 0x3a38aa3b
.size L_tab, .-L_tab
.section .rodata,"a"
.p2align 6
.amdhsa_kernel standalone__factorization_afm__recsys_kernel
  .amdhsa_next_free_vgpr 384
  .amdhsa_next_free_sgpr 102
  .amdhsa_accum_offset 256
  .amdhsa_group_segment_fixed_size 0
  .amdhsa_kernarg_size 88
  .amdhsa_user_sgpr_count 2
  .amdhsa_user_sgpr_kernarg_segment_ptr 1
  .amdhsa_system_sgpr_workgroup_id_x 1
.end_amdhsa_kernel
```

```asm
; @launch grid=(256,1,1) block=(256,1,1) lds=116992
.amdgcn_target "amdgcn-amd-amdhsa--gfx950"
.text
.globl standalone__factorization_afm__recsys_kernel
.p2align 12
.fill 832, 4, 0xbf800000
.p2align 8
.type standalone__factorization_afm__recsys_kernel,@function
standalone__factorization_afm__recsys_kernel:
    s_load_dwordx16 s[16:31], s[0:1], 0
    s_cmp_ge_u32 s2, 256
    s_cbranch_scc1 L_end
    s_getpc_b64 s[96:97]
L_pc:
    v_and_b32 v1, 63, v0
    v_lshlrev_b32 v120, 4, v1
    v_add_u32 v120, L_tab-L_pc, v120
    global_load_dwordx4 v[128:131], v120, s[96:97]
    s_bfe_u32 s7, s2, 0x20003
    s_lshl_b32 s7, s7, 13
    v_lshl_add_u32 v200, v0, 5, s7
    v_lshrrev_b32 v2, 6, v0
    v_min_u32 v200, L_end-L_pc, v200
    v_readfirstlane_b32 s3, v2
    global_load_dword v251, v200, s[96:97]
    global_load_dwordx2 v[132:133], v120, s[96:97] offset:1024
    global_load_dwordx4 v[232:235], v120, s[96:97] offset:2048
    global_load_dwordx3 v[236:238], v120, s[96:97] offset:3072
    v_bfe_u32 v4, v0, 4, 2
    s_and_b32 s4, s2, 7
    s_lshr_b32 s6, s2, 3
    s_lshl_b32 s4, s4, 5
    s_add_u32 s4, s4, s6
    s_lshl2_add_u32 s4, s4, s3
    s_mul_i32 s6, s4, 104
    s_add_u32 s7, s6, 76
    v_lshlrev_b32 v123, 4, v0
    v_and_b32 v14, 0xf0, v123
    v_mad_u32_u24 v121, v4, 28, s6
    v_and_b32 v126, 31, v0
    v_lshlrev_b32 v125, 6, v2
    v_min_u32 v122, s7, v121
    v_lshl_or_b32 v126, v126, 1, v125
    v_lshlrev_b32 v125, 2, v1
    v_add_u32 v112, 4096, v123
    v_add_u32 v113, 12288, v123
    v_add_u32 v114, 20480, v123
    v_add_u32 v115, 28672, v123
    s_waitcnt lgkmcnt(0)
    global_load_dwordx4 v[204:207], v121, s[16:17]
    global_load_dwordx3 v[208:210], v122, s[16:17] offset:16
    s_barrier
    global_load_dwordx4 v[48:51], v112, s[24:25] offset:-4096
    global_load_dwordx4 v[52:55], v112, s[24:25] offset:0
    global_load_dwordx4 v[56:59], v113, s[24:25] offset:-4096
    global_load_dwordx4 v[60:63], v113, s[24:25] offset:0
    global_load_dwordx4 v[64:67], v114, s[24:25] offset:-4096
    global_load_dwordx4 v[68:71], v114, s[24:25] offset:0
    global_load_dwordx4 v[72:75], v115, s[24:25] offset:-4096
    global_load_dwordx4 v[76:79], v115, s[24:25] offset:0
    global_load_dwordx4 v[220:223], v14, s[28:29]
    global_load_ushort v13, v126, s[28:29]
    global_load_ushort v12, v126, s[26:27]
    global_load_dword v252, v125, s[30:31]
    s_load_dwordx2 s[32:33], s[0:1], 64
    s_add_u32 s94, s96, L_ctab-L_pc
    s_addc_u32 s95, s97, 0
    s_load_dwordx16 s[36:51], s[94:95], 0
    s_load_dwordx4 s[52:55], s[94:95], 64
    s_mov_b32 s56, s18
    s_mov_b32 s57, s19
    s_mov_b32 s58, 25600000
    s_mov_b32 s59, 0x00020000
    s_mul_i32 s5, s3, 19008
    s_lshr_b32 s7, s3, 1
    s_mul_i32 s6, s3, 1152
    s_lshl_b32 s7, s7, 7
    s_add_u32 s6, s6, s7
    s_lshl_b32 s8, s3, 7
    s_add_u32 s5, s5, 40960
    v_lshlrev_b32 v127, 4, v1
    v_lshl_add_u32 v3, v2, 2, v127
    s_mov_b64 exec, 0
    s_cmp_eq_u32 s3, 0
    s_cbranch_scc1 L_pad0
    s_cmp_eq_u32 s3, 1
    s_cbranch_scc1 L_pad1
    s_cmp_eq_u32 s3, 2
    s_cbranch_scc1 L_pad2
    s_branch L_pad3
L_hopret:
    s_mov_b64 exec, -1
    s_waitcnt vmcnt(18)
    v_add_u32_sdwa v5, v128, s6 dst_sel:DWORD dst_unused:UNUSED_PAD src0_sel:WORD_0 src1_sel:DWORD
    s_waitcnt vmcnt(13)
    v_lshl_add_u32 v204, v204, 8, v14
    v_lshl_add_u32 v205, v205, 8, v14
    v_lshl_add_u32 v206, v206, 8, v14
    v_lshl_add_u32 v207, v207, 8, v14
    buffer_load_dwordx4 v[144:147], v204, s[56:59], 0 offen
    buffer_load_dwordx4 v[148:151], v205, s[56:59], 0 offen
    buffer_load_dwordx4 v[152:155], v206, s[56:59], 0 offen
    buffer_load_dwordx4 v[156:159], v207, s[56:59], 0 offen
    s_waitcnt vmcnt(16)
    v_lshl_add_u32 v208, v208, 8, v14
    v_lshl_add_u32 v209, v209, 8, v14
    v_lshl_add_u32 v210, v210, 8, v14
    v_add_u32_sdwa v7, v128, s8 dst_sel:DWORD dst_unused:UNUSED_PAD src0_sel:WORD_1 src1_sel:DWORD
    v_add_u32_sdwa v8, v129, s8 dst_sel:DWORD dst_unused:UNUSED_PAD src0_sel:WORD_0 src1_sel:DWORD
    v_lshrrev_b32 v9, 16, v129
    v_and_b32 v6, 0xffff, v130
    v_lshrrev_b32 v15, 16, v130
    v_lshrrev_b32 v0, 16, v130
    v_add_u32_sdwa v203, v131, s5 dst_sel:DWORD dst_unused:UNUSED_PAD src0_sel:WORD_0 src1_sel:DWORD
    v_add_u32_sdwa v246, v131, s5 dst_sel:DWORD dst_unused:UNUSED_PAD src0_sel:WORD_1 src1_sel:DWORD
    v_add_u32_sdwa v201, v132, s5 dst_sel:DWORD dst_unused:UNUSED_PAD src0_sel:WORD_0 src1_sel:DWORD
    v_add_u32_sdwa v245, v132, s5 dst_sel:DWORD dst_unused:UNUSED_PAD src0_sel:WORD_1 src1_sel:DWORD
    v_add_u32_sdwa v202, v133, s5 dst_sel:DWORD dst_unused:UNUSED_PAD src0_sel:WORD_0 src1_sel:DWORD
    v_lshrrev_b32 v10, 16, v133
    s_mov_b32 s13, 0xffff0000
    s_mov_b32 s90, 0x11111111
    s_mov_b32 s91, 0x11111111
L_wconv:
    s_waitcnt vmcnt(15)
    v_lshlrev_b32 v96, 16, v48
    v_and_b32 v97, s13, v48
    v_lshlrev_b32 v98, 16, v49
    v_and_b32 v99, s13, v49
    v_lshlrev_b32 v100, 16, v50
    v_and_b32 v101, s13, v50
    v_lshlrev_b32 v102, 16, v51
    v_and_b32 v103, s13, v51
    v_cvt_pkrtz_f16_f32 v16, v96, v97
    v_cvt_pkrtz_f16_f32 v17, v98, v99
    v_cvt_pkrtz_f16_f32 v18, v100, v101
    v_cvt_pkrtz_f16_f32 v19, v102, v103
    ds_write_b128 v5, v[16:19] offset:0
    v_or_b32 v248, v16, v17
    v_or3_b32 v248, v248, v18, v19
    s_waitcnt vmcnt(14)
    v_lshlrev_b32 v104, 16, v52
    v_and_b32 v105, s13, v52
    v_lshlrev_b32 v106, 16, v53
    v_and_b32 v107, s13, v53
    v_lshlrev_b32 v108, 16, v54
    v_and_b32 v109, s13, v54
    v_lshlrev_b32 v110, 16, v55
    v_and_b32 v111, s13, v55
    v_cvt_pkrtz_f16_f32 v20, v104, v105
    v_cvt_pkrtz_f16_f32 v21, v106, v107
    v_cvt_pkrtz_f16_f32 v22, v108, v109
    v_cvt_pkrtz_f16_f32 v23, v110, v111
    ds_write_b128 v5, v[20:23] offset:4736
    v_or3_b32 v248, v248, v20, v21
    v_or3_b32 v248, v248, v22, v23
    s_waitcnt vmcnt(13)
    v_lshlrev_b32 v96, 16, v56
    v_and_b32 v97, s13, v56
    v_lshlrev_b32 v98, 16, v57
    v_and_b32 v99, s13, v57
    v_lshlrev_b32 v100, 16, v58
    v_and_b32 v101, s13, v58
    v_lshlrev_b32 v102, 16, v59
    v_and_b32 v103, s13, v59
    v_cvt_pkrtz_f16_f32 v24, v96, v97
    v_cvt_pkrtz_f16_f32 v25, v98, v99
    v_cvt_pkrtz_f16_f32 v26, v100, v101
    v_cvt_pkrtz_f16_f32 v27, v102, v103
    ds_write_b128 v5, v[24:27] offset:9472
    v_or3_b32 v248, v248, v24, v25
    v_or3_b32 v248, v248, v26, v27
    s_waitcnt vmcnt(12)
    v_lshlrev_b32 v104, 16, v60
    v_and_b32 v105, s13, v60
    v_lshlrev_b32 v106, 16, v61
    v_and_b32 v107, s13, v61
    v_lshlrev_b32 v108, 16, v62
    v_and_b32 v109, s13, v62
    v_lshlrev_b32 v110, 16, v63
    v_and_b32 v111, s13, v63
    v_cvt_pkrtz_f16_f32 v28, v104, v105
    v_cvt_pkrtz_f16_f32 v29, v106, v107
    v_cvt_pkrtz_f16_f32 v30, v108, v109
    v_cvt_pkrtz_f16_f32 v31, v110, v111
    ds_write_b128 v5, v[28:31] offset:14208
    v_or3_b32 v248, v248, v28, v29
    v_or3_b32 v248, v248, v30, v31
    s_waitcnt vmcnt(11)
    v_lshlrev_b32 v96, 16, v64
    v_and_b32 v97, s13, v64
    v_lshlrev_b32 v98, 16, v65
    v_and_b32 v99, s13, v65
    v_lshlrev_b32 v100, 16, v66
    v_and_b32 v101, s13, v66
    v_lshlrev_b32 v102, 16, v67
    v_and_b32 v103, s13, v67
    v_cvt_pkrtz_f16_f32 v32, v96, v97
    v_cvt_pkrtz_f16_f32 v33, v98, v99
    v_cvt_pkrtz_f16_f32 v34, v100, v101
    v_cvt_pkrtz_f16_f32 v35, v102, v103
    ds_write_b128 v5, v[32:35] offset:18944
    v_or3_b32 v248, v248, v32, v33
    s_waitcnt vmcnt(7)
    v_dot2_f32_bf16 v112, v48, v220, 0
    v_or3_b32 v248, v248, v34, v35
    v_dot2_f32_bf16 v113, v52, v220, 0
    v_dot2_f32_bf16 v112, v49, v221, v112
    v_dot2_f32_bf16 v113, v53, v221, v113
    v_dot2_f32_bf16 v112, v50, v222, v112
    v_dot2_f32_bf16 v113, v54, v222, v113
    v_dot2_f32_bf16 v112, v51, v223, v112
    v_dot2_f32_bf16 v113, v55, v223, v113
    v_dot2_f32_bf16 v114, v56, v220, 0
    v_dot2_f32_bf16 v115, v60, v220, 0
    v_lshlrev_b32 v104, 16, v68
    v_and_b32 v105, s13, v68
    v_lshlrev_b32 v106, 16, v69
    v_and_b32 v107, s13, v69
    v_lshlrev_b32 v108, 16, v70
    v_and_b32 v109, s13, v70
    v_lshlrev_b32 v110, 16, v71
    v_and_b32 v111, s13, v71
    v_cvt_pkrtz_f16_f32 v36, v104, v105
    v_cvt_pkrtz_f16_f32 v37, v106, v107
    v_cvt_pkrtz_f16_f32 v38, v108, v109
    v_cvt_pkrtz_f16_f32 v39, v110, v111
    ds_write_b128 v5, v[36:39] offset:23680
    v_or3_b32 v248, v248, v36, v37
    v_dot2_f32_bf16 v114, v57, v221, v114
    v_or3_b32 v248, v248, v38, v39
    v_dot2_f32_bf16 v115, v61, v221, v115
    v_dot2_f32_bf16 v114, v58, v222, v114
    v_dot2_f32_bf16 v115, v62, v222, v115
    v_dot2_f32_bf16 v114, v59, v223, v114
    v_dot2_f32_bf16 v115, v63, v223, v115
    v_add_f32_dpp v112, v112, v112 row_ror:8 row_mask:0xf bank_mask:0x3
    v_dot2_f32_bf16 v116, v64, v220, 0
    v_dot2_f32_bf16 v117, v68, v220, 0
    v_dot2_f32_bf16 v116, v65, v221, v116
    v_lshlrev_b32 v96, 16, v72
    v_and_b32 v97, s13, v72
    v_lshlrev_b32 v98, 16, v73
    v_and_b32 v99, s13, v73
    v_lshlrev_b32 v100, 16, v74
    v_and_b32 v101, s13, v74
    v_lshlrev_b32 v102, 16, v75
    v_and_b32 v103, s13, v75
    v_cvt_pkrtz_f16_f32 v40, v96, v97
    v_cvt_pkrtz_f16_f32 v41, v98, v99
    v_cvt_pkrtz_f16_f32 v42, v100, v101
    v_cvt_pkrtz_f16_f32 v43, v102, v103
    ds_write_b128 v5, v[40:43] offset:28416
    v_or3_b32 v248, v248, v40, v41
    v_dot2_f32_bf16 v117, v69, v221, v117
    v_or3_b32 v248, v248, v42, v43
    v_add_f32_dpp v112, v113, v113 row_ror:8 row_mask:0xf bank_mask:0xc
    v_add_f32_dpp v114, v114, v114 row_ror:8 row_mask:0xf bank_mask:0x3
    v_dot2_f32_bf16 v116, v66, v222, v116
    v_dot2_f32_bf16 v117, v70, v222, v117
    v_dot2_f32_bf16 v116, v67, v223, v116
    v_dot2_f32_bf16 v117, v71, v223, v117
    v_add_f32_dpp v114, v115, v115 row_ror:8 row_mask:0xf bank_mask:0xc
    v_add_f32_dpp v112, v112, v112 row_half_mirror row_mask:0xf bank_mask:0x5
    v_dot2_f32_bf16 v118, v72, v220, 0
    v_lshlrev_b32 v104, 16, v76
    v_and_b32 v105, s13, v76
    v_lshlrev_b32 v106, 16, v77
    v_and_b32 v107, s13, v77
    v_lshlrev_b32 v108, 16, v78
    v_and_b32 v109, s13, v78
    v_lshlrev_b32 v110, 16, v79
    v_and_b32 v111, s13, v79
    v_cvt_pkrtz_f16_f32 v44, v104, v105
    v_cvt_pkrtz_f16_f32 v45, v106, v107
    v_cvt_pkrtz_f16_f32 v46, v108, v109
    v_cvt_pkrtz_f16_f32 v47, v110, v111
    ds_write_b128 v5, v[44:47] offset:33152
    v_or3_b32 v248, v248, v44, v45
    v_dot2_f32_bf16 v119, v76, v220, 0
    v_or3_b32 v248, v248, v46, v47
    v_dot2_f32_bf16 v118, v73, v221, v118
    v_dot2_f32_bf16 v119, v77, v221, v119
    v_add_f32_dpp v112, v114, v114 row_half_mirror row_mask:0xf bank_mask:0xa
    v_add_f32_dpp v116, v116, v116 row_ror:8 row_mask:0xf bank_mask:0x3
    v_dot2_f32_bf16 v118, v74, v222, v118
    v_dot2_f32_bf16 v119, v78, v222, v119
    v_dot2_f32_bf16 v118, v75, v223, v118
    v_dot2_f32_bf16 v119, v79, v223, v119
    v_add_f32_dpp v116, v117, v117 row_ror:8 row_mask:0xf bank_mask:0xc
    v_add_f32_dpp v112, v112, v112 quad_perm:[1,0,3,2] row_mask:0xf bank_mask:0xf
    v_cmp_lt_u32 vcc, 31, v1
    v_add_f32_dpp v118, v118, v118 row_ror:8 row_mask:0xf bank_mask:0x3
    v_add_f32_dpp v116, v116, v116 row_half_mirror row_mask:0xf bank_mask:0x5
    s_waitcnt vmcnt(5)
    v_cndmask_b32 v120, v12, v13, vcc
    v_add_f32_dpp v118, v119, v119 row_ror:8 row_mask:0xf bank_mask:0xc
    v_add_f32_dpp v112, v112, v112 quad_perm:[2,3,0,1] row_mask:0xf bank_mask:0xf
    v_lshlrev_b32 v120, 16, v120
    v_add_f32_dpp v116, v118, v118 row_half_mirror row_mask:0xf bank_mask:0xa
    v_ldexp_f32 v120, v120, v9
    ds_write_b32 v3, v248 offset:39424
    v_add_f32_dpp v116, v116, v116 quad_perm:[1,0,3,2] row_mask:0xf bank_mask:0xf
    ds_write_b32 v8, v120 offset:37888
    s_nop 0
    v_add_f32_dpp v113, v116, v116 quad_perm:[2,3,0,1] row_mask:0xf bank_mask:0xf
    s_mov_b64 exec, s[90:91]
    ds_write_b64 v7, v[112:113]
    s_mov_b64 exec, -1
    s_waitcnt lgkmcnt(0)
    s_barrier
    ds_read_b128 v[112:115], v127 offset:39424
    ds_read_b64_tr_b16 a[0:1], v6 offset:0
    ds_read_b64_tr_b16 a[2:3], v6 offset:1152
    ds_read_b64_tr_b16 a[4:5], v6 offset:9472
    ds_read_b64_tr_b16 a[6:7], v6 offset:10624
    ds_read_b64_tr_b16 a[8:9], v6 offset:18944
    ds_read_b64_tr_b16 a[10:11], v6 offset:20096
    ds_read_b64_tr_b16 a[12:13], v6 offset:28416
    ds_read_b64_tr_b16 a[14:15], v6 offset:29568
    ds_read_b64_tr_b16 a[16:17], v6 offset:32
    ds_read_b64_tr_b16 a[18:19], v6 offset:1184
    ds_read_b64_tr_b16 a[20:21], v6 offset:9504
    ds_read_b64_tr_b16 a[22:23], v6 offset:10656
    ds_read_b64_tr_b16 a[24:25], v6 offset:18976
    ds_read_b64_tr_b16 a[26:27], v6 offset:20128
    ds_read_b64_tr_b16 a[28:29], v6 offset:28448
    ds_read_b64_tr_b16 a[30:31], v6 offset:29600
    s_waitcnt lgkmcnt(15)
    v_or3_b32 v112, v112, v113, v114
    v_or_b32 v112, v112, v115
    v_and_b32 v121, s52, v112
    v_and_b32 v122, 0x20002000, v112
    v_cmp_ne_u32 vcc, 0, v121
    v_cmp_ge_u32 s[92:93], v122, s53
    s_cbranch_vccnz L_wfix
    s_cmp_eq_u64 s[92:93], 0
    s_cbranch_scc1 L_wfix
    buffer_load_dwordx4 v[160:163], v208, s[56:59], 0 offen
    buffer_load_dwordx4 v[164:167], v209, s[56:59], 0 offen
    buffer_load_dwordx4 v[168:171], v210, s[56:59], 0 offen
L_econv:
    s_waitcnt vmcnt(6)
    v_lshl_add_u32 v96, v144, 16, s48
    v_add_u32_sdwa v97, v144, s49 dst_sel:WORD_1 dst_unused:UNUSED_PAD src0_sel:WORD_1 src1_sel:DWORD
    v_lshl_add_u32 v98, v145, 16, s48
    v_add_u32_sdwa v99, v145, s49 dst_sel:WORD_1 dst_unused:UNUSED_PAD src0_sel:WORD_1 src1_sel:DWORD
    v_lshl_add_u32 v100, v146, 16, s48
    v_add_u32_sdwa v101, v146, s49 dst_sel:WORD_1 dst_unused:UNUSED_PAD src0_sel:WORD_1 src1_sel:DWORD
    v_lshl_add_u32 v102, v147, 16, s48
    v_add_u32_sdwa v103, v147, s49 dst_sel:WORD_1 dst_unused:UNUSED_PAD src0_sel:WORD_1 src1_sel:DWORD
    v_cvt_pkrtz_f16_f32 v172, v96, v97
    v_max_f32 v248, |v96|, |v97|
    v_cvt_pkrtz_f16_f32 v173, v98, v99
    v_max_f32 v249, |v98|, |v99|
    v_cvt_pkrtz_f16_f32 v174, v100, v101
    v_max3_f32 v248, v248, |v100|, |v101|
    v_cvt_pkrtz_f16_f32 v175, v102, v103
    v_max3_f32 v249, v249, |v102|, |v103|
    ds_write_b128 v203, v[172:175] offset:0
    ds_read_b128 v[16:19], v0 offset:37888
    ds_read_b128 v[20:23], v0 offset:37952
    ds_read_b128 v[24:27], v0 offset:38016
    s_waitcnt vmcnt(5)
    v_lshl_add_u32 v104, v148, 16, s48
    v_add_u32_sdwa v105, v148, s49 dst_sel:WORD_1 dst_unused:UNUSED_PAD src0_sel:WORD_1 src1_sel:DWORD
    v_lshl_add_u32 v106, v149, 16, s48
    v_add_u32_sdwa v107, v149, s49 dst_sel:WORD_1 dst_unused:UNUSED_PAD src0_sel:WORD_1 src1_sel:DWORD
    v_lshl_add_u32 v108, v150, 16, s48
    v_add_u32_sdwa v109, v150, s49 dst_sel:WORD_1 dst_unused:UNUSED_PAD src0_sel:WORD_1 src1_sel:DWORD
    v_lshl_add_u32 v110, v151, 16, s48
    v_add_u32_sdwa v111, v151, s49 dst_sel:WORD_1 dst_unused:UNUSED_PAD src0_sel:WORD_1 src1_sel:DWORD
    v_cvt_pkrtz_f16_f32 v176, v104, v105
    v_max3_f32 v248, v248, |v104|, |v105|
    v_cvt_pkrtz_f16_f32 v177, v106, v107
    v_max3_f32 v249, v249, |v106|, |v107|
    v_cvt_pkrtz_f16_f32 v178, v108, v109
    v_max3_f32 v248, v248, |v108|, |v109|
    v_cvt_pkrtz_f16_f32 v179, v110, v111
    v_max3_f32 v249, v249, |v110|, |v111|
    ds_write_b128 v203, v[176:179] offset:1152
    s_waitcnt vmcnt(4)
    v_lshl_add_u32 v96, v152, 16, s48
    v_add_u32_sdwa v97, v152, s49 dst_sel:WORD_1 dst_unused:UNUSED_PAD src0_sel:WORD_1 src1_sel:DWORD
    v_lshl_add_u32 v98, v153, 16, s48
    v_add_u32_sdwa v99, v153, s49 dst_sel:WORD_1 dst_unused:UNUSED_PAD src0_sel:WORD_1 src1_sel:DWORD
    v_lshl_add_u32 v100, v154, 16, s48
    v_add_u32_sdwa v101, v154, s49 dst_sel:WORD_1 dst_unused:UNUSED_PAD src0_sel:WORD_1 src1_sel:DWORD
    v_lshl_add_u32 v102, v155, 16, s48
    v_add_u32_sdwa v103, v155, s49 dst_sel:WORD_1 dst_unused:UNUSED_PAD src0_sel:WORD_1 src1_sel:DWORD
    v_cvt_pkrtz_f16_f32 v180, v96, v97
    v_cvt_pkrtz_f16_f32 v181, v98, v99
    v_cvt_pkrtz_f16_f32 v182, v100, v101
    v_cvt_pkrtz_f16_f32 v183, v102, v103
    ds_write_b128 v203, v[180:183] offset:2304
    s_waitcnt vmcnt(3)
    v_lshl_add_u32 v104, v156, 16, s48
    v_add_u32_sdwa v105, v156, s49 dst_sel:WORD_1 dst_unused:UNUSED_PAD src0_sel:WORD_1 src1_sel:DWORD
    v_lshl_add_u32 v106, v157, 16, s48
    v_add_u32_sdwa v107, v157, s49 dst_sel:WORD_1 dst_unused:UNUSED_PAD src0_sel:WORD_1 src1_sel:DWORD
    v_lshl_add_u32 v108, v158, 16, s48
    v_add_u32_sdwa v109, v158, s49 dst_sel:WORD_1 dst_unused:UNUSED_PAD src0_sel:WORD_1 src1_sel:DWORD
    v_lshl_add_u32 v110, v159, 16, s48
    v_add_u32_sdwa v111, v159, s49 dst_sel:WORD_1 dst_unused:UNUSED_PAD src0_sel:WORD_1 src1_sel:DWORD
    v_cvt_pkrtz_f16_f32 v184, v104, v105
    v_cvt_pkrtz_f16_f32 v185, v106, v107
    v_cvt_pkrtz_f16_f32 v186, v108, v109
    v_cvt_pkrtz_f16_f32 v187, v110, v111
    ds_write_b128 v203, v[184:187] offset:3456
    ds_read_b128 v[80:83], v246 offset:0
    ds_read_b128 v[128:131], v201 offset:0
    ds_read_b128 v[84:87], v246 offset:64
    ds_read_b128 v[132:135], v201 offset:64
    ds_read_b128 v[88:91], v246 offset:128
    ds_read_b128 v[136:139], v201 offset:128
    ds_read_b128 v[92:95], v246 offset:192
    ds_read_b128 v[140:143], v201 offset:192
    ds_read_b64_tr_b16 a[32:33], v6 offset:64
    ds_read_b64_tr_b16 a[34:35], v6 offset:1216
    ds_read_b64_tr_b16 a[36:37], v6 offset:9536
    ds_read_b64_tr_b16 a[38:39], v6 offset:10688
    ds_read_b64_tr_b16 a[40:41], v6 offset:19008
    ds_read_b64_tr_b16 a[42:43], v6 offset:20160
    ds_read_b64_tr_b16 a[44:45], v6 offset:28480
    ds_read_b64_tr_b16 a[46:47], v6 offset:29632
    v_max3_f32 v248, v248, |v96|, |v97|
    v_max3_f32 v249, v249, |v98|, |v99|
    v_max3_f32 v248, v248, |v100|, |v101|
    v_max3_f32 v249, v249, |v102|, |v103|
    v_max3_f32 v248, v248, |v104|, |v105|
    v_max3_f32 v249, v249, |v106|, |v107|
    v_max3_f32 v248, v248, |v108|, |v109|
    v_max3_f32 v249, v249, |v110|, |v111|
    s_waitcnt lgkmcnt(14)
    v_pk_mul_f16 v128, v128, v80
    v_pk_mul_f16 v129, v129, v81
    v_pk_mul_f16 v130, v130, v82
    v_pk_mul_f16 v131, v131, v83
    s_nop 1
    v_mfma_f32_16x16x32_f16 v[96:99], a[0:3], v[128:131], v[16:19]
    ds_read_b128 v[28:31], v0 offset:38080
    ds_read_b64_tr_b16 a[48:49], v6 offset:96
    s_waitcnt lgkmcnt(14)
    v_pk_mul_f16 v132, v132, v84
    v_pk_mul_f16 v133, v133, v85
    v_mfma_f32_16x16x32_f16 v[100:103], a[16:19], v[128:131], v[20:23]
    ds_read_b64_tr_b16 a[50:51], v6 offset:1248
    ds_read_b64_tr_b16 a[52:53], v6 offset:9568
    v_pk_mul_f16 v134, v134, v86
    v_pk_mul_f16 v135, v135, v87
    s_waitcnt lgkmcnt(10)
    v_mfma_f32_16x16x32_f16 v[104:107], a[32:35], v[128:131], v[24:27]
    ds_read_b64_tr_b16 a[54:55], v6 offset:10720
    ds_read_b64_tr_b16 a[56:57], v6 offset:19040
    v_pk_mul_f16 v136, v136, v88
    v_pk_mul_f16 v137, v137, v89
    v_mfma_f32_16x16x32_f16 v[96:99], a[4:7], v[132:135], v[96:99]
    ds_read_b64_tr_b16 a[58:59], v6 offset:20192
    ds_read_b64_tr_b16 a[60:61], v6 offset:28512
    v_pk_mul_f16 v138, v138, v90
    v_pk_mul_f16 v139, v139, v91
    v_mfma_f32_16x16x32_f16 v[100:103], a[20:23], v[132:135], v[100:103]
    ds_read_b64_tr_b16 a[62:63], v6 offset:29664
    ds_read_b128 v[48:51], v15 offset:38400
    v_pk_mul_f16 v140, v140, v92
    v_pk_mul_f16 v141, v141, v93
    s_waitcnt lgkmcnt(14)
    v_mfma_f32_16x16x32_f16 v[104:107], a[36:39], v[132:135], v[104:107]
    ds_read_b128 v[52:55], v15 offset:38464
    ds_read_b128 v[56:59], v15 offset:38528
    v_pk_mul_f16 v142, v142, v94
    v_pk_mul_f16 v143, v143, v95
    v_mov_b32_dpp v247, v246 row_ror:14 row_mask:0xf bank_mask:0xf
    ds_read_b128 v[156:159], v247 offset:192
    ds_read_b128 v[152:155], v247 offset:128
    ds_read_b128 v[148:151], v247 offset:64
    ds_read_b128 v[144:147], v247 offset:0
    v_mfma_f32_16x16x32_f16 v[96:99], a[8:11], v[136:139], v[96:99]
    ds_read_b128 v[32:35], v0 offset:38144
    ds_read_b64_tr_b16 a[76:77], v6 offset:28544
    ds_read2_b32 v[192:193], v10 offset0:0 offset1:8
    v_mov_b32 v251, 0xff800000
    v_mfma_f32_16x16x32_f16 v[100:103], a[24:27], v[136:139], v[100:103]
    ds_read_b64_tr_b16 a[78:79], v6 offset:29696
    ds_read_b64_tr_b16 a[72:73], v6 offset:19072
    s_waitcnt lgkmcnt(15)
    v_mfma_f32_16x16x32_f16 v[104:107], a[40:43], v[136:139], v[104:107]
    ds_read_b64_tr_b16 a[74:75], v6 offset:20224
    ds_read_b64_tr_b16 a[68:69], v6 offset:9600
    v_mfma_f32_16x16x32_f16 v[96:99], a[12:15], v[140:143], v[96:99]
    ds_read_b64_tr_b16 a[70:71], v6 offset:10752
    ds_read_b64_tr_b16 a[64:65], v6 offset:128
    ds_read_b64_tr_b16 a[66:67], v6 offset:1280
    v_mfma_f32_16x16x32_f16 v[100:103], a[28:31], v[140:143], v[100:103]
    ds_read_b128 v[60:63], v15 offset:38592
    ds_read_b128 v[36:39], v0 offset:38208
    v_mfma_f32_16x16x32_f16 v[104:107], a[44:47], v[140:143], v[104:107]
    ds_read_b64_tr_b16 a[80:81], v6 offset:160
    ds_read_b64_tr_b16 a[82:83], v6 offset:1312
    s_waitcnt lgkmcnt(15)
    v_mfma_f32_16x16x32_f16 v[108:111], a[60:63], v[140:143], v[28:31]
    ds_read_b64_tr_b16 a[84:85], v6 offset:9632
    ds_read_b64_tr_b16 a[86:87], v6 offset:10784
    v_mul_f32 v184, |v96|, v48
    v_fma_f32 v184, |v97|, v49, v184
    v_mfma_f32_16x16x32_f16 v[108:111], a[56:59], v[136:139], v[108:111]
    ds_read_b64_tr_b16 a[88:89], v6 offset:19104
    ds_read_b64_tr_b16 a[90:91], v6 offset:20256
    ds_read_b64_tr_b16 a[92:93], v6 offset:28576
    ds_read_b64_tr_b16 a[94:95], v6 offset:29728
    v_fma_f32 v184, |v98|, v50, v184
    v_fma_f32 v184, |v99|, v51, v184
    v_mfma_f32_16x16x32_f16 v[108:111], a[52:55], v[132:135], v[108:111]
    ds_read_b128 v[64:67], v15 offset:38656
    ds_read_b128 v[40:43], v0 offset:38272
    s_waitcnt lgkmcnt(15)
    v_pk_mul_f16 v144, v144, v80
    v_fma_f32 v184, |v100|, v52, v184
    v_mfma_f32_16x16x32_f16 v[108:111], a[48:51], v[128:131], v[108:111]
    ds_read_b64_tr_b16 a[108:109], v6 offset:28608
    ds_read_b64_tr_b16 a[110:111], v6 offset:29760
    v_and_b32 v253, s44, v252
    v_fma_f32 v184, |v101|, v53, v184
    s_waitcnt lgkmcnt(14)
    v_mfma_f32_16x16x32_f16 v[112:115], a[64:67], v[128:131], v[32:35]
    ds_read_b64_tr_b16 a[104:105], v6 offset:19136
    ds_read_b64_tr_b16 a[106:107], v6 offset:20288
    v_pk_mul_f16 v145, v145, v81
    v_fma_f32 v184, |v102|, v54, v184
    v_mfma_f32_16x16x32_f16 v[112:115], a[68:71], v[132:135], v[112:115]
    ds_read_b64_tr_b16 a[100:101], v6 offset:9664
    ds_read_b64_tr_b16 a[102:103], v6 offset:10816
    ds_read_b64_tr_b16 a[96:97], v6 offset:192
    ds_read_b64_tr_b16 a[98:99], v6 offset:1344
    v_pk_mul_f16 v146, v146, v82
    v_fma_f32 v184, |v103|, v55, v184
    v_mfma_f32_16x16x32_f16 v[112:115], a[72:75], v[136:139], v[112:115]
    ds_read_b128 v[68:71], v15 offset:38720
    ds_read_b128 v[44:47], v0 offset:38336
    v_pk_mul_f16 v147, v147, v83
    v_fma_f32 v184, |v104|, v56, v184
    v_mfma_f32_16x16x32_f16 v[112:115], a[76:79], v[140:143], v[112:115]
    ds_read_b64_tr_b16 a[112:113], v6 offset:224
    ds_read_b64_tr_b16 a[114:115], v6 offset:1376
    v_pk_mul_f16 v148, v148, v84
    v_fma_f32 v184, |v105|, v57, v184
    s_waitcnt lgkmcnt(14)
    v_mfma_f32_16x16x32_f16 v[116:119], a[92:95], v[140:143], v[36:39]
    ds_read_b64_tr_b16 a[116:117], v6 offset:9696
    ds_read_b64_tr_b16 a[118:119], v6 offset:10848
    v_pk_mul_f16 v149, v149, v85
    v_fma_f32 v184, |v106|, v58, v184
    v_mfma_f32_16x16x32_f16 v[116:119], a[88:91], v[136:139], v[116:119]
    ds_read_b64_tr_b16 a[120:121], v6 offset:19168
    ds_read_b64_tr_b16 a[122:123], v6 offset:20320
    ds_read_b64_tr_b16 a[124:125], v6 offset:28640
    ds_read_b64_tr_b16 a[126:127], v6 offset:29792
    v_pk_mul_f16 v150, v150, v86
    v_fma_f32 v184, |v107|, v59, v184
    v_mfma_f32_16x16x32_f16 v[116:119], a[84:87], v[132:135], v[116:119]
    ds_read_b128 v[72:75], v15 offset:38784
    ds_read_b128 v[76:79], v15 offset:38848
    v_pk_mul_f16 v151, v151, v87
    v_fma_f32 v184, |v108|, v60, v184
    v_mfma_f32_16x16x32_f16 v[116:119], a[80:83], v[128:131], v[116:119]
    v_pk_mul_f16 v152, v152, v88
    v_fma_f32 v184, |v109|, v61, v184
    s_waitcnt lgkmcnt(12)
    v_mfma_f32_16x16x32_f16 v[120:123], a[96:99], v[128:131], v[40:43]
    v_pk_mul_f16 v153, v153, v89
    v_fma_f32 v184, |v110|, v62, v184
    v_mfma_f32_16x16x32_f16 v[120:123], a[100:103], v[132:135], v[120:123]
    v_pk_mul_f16 v154, v154, v90
    v_fma_f32 v184, |v111|, v63, v184
    v_mfma_f32_16x16x32_f16 v[120:123], a[104:107], v[136:139], v[120:123]
    v_pk_mul_f16 v155, v155, v91
    v_fma_f32 v184, |v112|, v64, v184
    v_mfma_f32_16x16x32_f16 v[120:123], a[108:111], v[140:143], v[120:123]
    v_pk_mul_f16 v156, v156, v92
    v_fma_f32 v184, |v113|, v65, v184
    s_waitcnt lgkmcnt(2)
    v_mfma_f32_16x16x32_f16 v[124:127], a[124:127], v[140:143], v[44:47]
    v_pk_mul_f16 v157, v157, v93
    v_fma_f32 v184, |v114|, v66, v184
    v_mfma_f32_16x16x32_f16 v[124:127], a[120:123], v[136:139], v[124:127]
    v_pk_mul_f16 v158, v158, v94
    v_fma_f32 v184, |v115|, v67, v184
    v_mfma_f32_16x16x32_f16 v[124:127], a[116:119], v[132:135], v[124:127]
    v_pk_mul_f16 v159, v159, v95
    v_fma_f32 v184, |v116|, v68, v184
    v_mfma_f32_16x16x32_f16 v[124:127], a[112:115], v[128:131], v[124:127]
    v_mov_b32_dpp v247, v246 row_ror:13 row_mask:0xf bank_mask:0xf
    v_fma_f32 v184, |v117|, v69, v184
    v_mfma_f32_16x16x32_f16 v[96:99], a[112:115], v[144:147], v[44:47]
    ds_read_b128 v[140:143], v247 offset:192
    v_fma_f32 v184, |v118|, v70, v184
    v_mfma_f32_16x16x32_f16 v[96:99], a[116:119], v[148:151], v[96:99]
    ds_read_b128 v[136:139], v247 offset:128
    v_fma_f32 v184, |v119|, v71, v184
    v_mfma_f32_16x16x32_f16 v[96:99], a[120:123], v[152:155], v[96:99]
L_pad0:
    s_cbranch_execz L_hopret
    ds_read_b128 v[132:135], v247 offset:64
    s_waitcnt lgkmcnt(4)
    v_fma_f32 v184, |v120|, v72, v184
    v_mfma_f32_16x16x32_f16 v[96:99], a[124:127], v[156:159], v[96:99]
    ds_read_b128 v[128:131], v247 offset:0
    v_fma_f32 v184, |v121|, v73, v184
    v_mfma_f32_16x16x32_f16 v[100:103], a[108:111], v[156:159], v[40:43]
    v_pk_max_u16 v254, v253, v253 op_sel:[0,1] op_sel_hi:[1,0]
    v_fma_f32 v184, |v122|, v74, v184
    v_mfma_f32_16x16x32_f16 v[100:103], a[104:107], v[152:155], v[100:103]
    v_max_f32 v255, |v192|, |v193|
    v_fma_f32 v184, |v123|, v75, v184
    v_mfma_f32_16x16x32_f16 v[100:103], a[100:103], v[148:151], v[100:103]
    v_max_u32_dpp v254, v254, v254 row_ror:8 row_mask:0xf bank_mask:0xf
    s_waitcnt lgkmcnt(4)
    v_fma_f32 v184, |v124|, v76, v184
    v_mfma_f32_16x16x32_f16 v[100:103], a[96:99], v[144:147], v[100:103]
    v_max_u32_dpp v255, v255, v255 row_ror:8 row_mask:0xf bank_mask:0xf
    v_fma_f32 v184, |v125|, v77, v184
    v_mfma_f32_16x16x32_f16 v[104:107], a[80:83], v[144:147], v[36:39]
    s_waitcnt vmcnt(2)
    v_lshl_add_u32 v220, v160, 16, s48
    v_fma_f32 v184, |v126|, v78, v184
    v_mfma_f32_16x16x32_f16 v[104:107], a[84:87], v[148:151], v[104:107]
    v_add_u32_sdwa v221, v160, s49 dst_sel:WORD_1 dst_unused:UNUSED_PAD src0_sel:WORD_1 src1_sel:DWORD
    v_fma_f32 v184, |v127|, v79, v184
    v_mfma_f32_16x16x32_f16 v[104:107], a[88:91], v[152:155], v[104:107]
    v_lshl_add_u32 v222, v161, 16, s48
    v_mul_f32 v185, |v96|, v76
    v_mfma_f32_16x16x32_f16 v[104:107], a[92:95], v[156:159], v[104:107]
    v_add_u32_sdwa v223, v161, s49 dst_sel:WORD_1 dst_unused:UNUSED_PAD src0_sel:WORD_1 src1_sel:DWORD
    v_fma_f32 v185, |v97|, v77, v185
    v_mfma_f32_16x16x32_f16 v[108:111], a[76:79], v[156:159], v[32:35]
    v_lshl_add_u32 v224, v162, 16, s48
    v_fma_f32 v185, |v98|, v78, v185
    v_mfma_f32_16x16x32_f16 v[108:111], a[72:75], v[152:155], v[108:111]
    v_add_u32_sdwa v225, v162, s49 dst_sel:WORD_1 dst_unused:UNUSED_PAD src0_sel:WORD_1 src1_sel:DWORD
    v_fma_f32 v185, |v99|, v79, v185
    v_mfma_f32_16x16x32_f16 v[108:111], a[68:71], v[148:151], v[108:111]
    v_lshl_add_u32 v226, v163, 16, s48
    v_fma_f32 v185, |v100|, v72, v185
    v_mfma_f32_16x16x32_f16 v[108:111], a[64:67], v[144:147], v[108:111]
    s_waitcnt lgkmcnt(0)
    v_pk_mul_f16 v128, v128, v80
    v_fma_f32 v185, |v101|, v73, v185
    v_mfma_f32_16x16x32_f16 v[112:115], a[48:51], v[144:147], v[28:31]
    v_pk_mul_f16 v129, v129, v81
    v_fma_f32 v185, |v102|, v74, v185
    v_mfma_f32_16x16x32_f16 v[112:115], a[52:55], v[148:151], v[112:115]
    v_pk_mul_f16 v130, v130, v82
    v_fma_f32 v185, |v103|, v75, v185
    v_mfma_f32_16x16x32_f16 v[112:115], a[56:59], v[152:155], v[112:115]
    v_pk_mul_f16 v131, v131, v83
    v_fma_f32 v185, |v104|, v68, v185
    v_mfma_f32_16x16x32_f16 v[112:115], a[60:63], v[156:159], v[112:115]
    v_pk_mul_f16 v132, v132, v84
    v_fma_f32 v185, |v105|, v69, v185
    v_mfma_f32_16x16x32_f16 v[116:119], a[44:47], v[156:159], v[24:27]
    v_pk_mul_f16 v133, v133, v85
    v_fma_f32 v185, |v106|, v70, v185
    v_mfma_f32_16x16x32_f16 v[116:119], a[40:43], v[152:155], v[116:119]
    v_pk_mul_f16 v134, v134, v86
    v_fma_f32 v185, |v107|, v71, v185
    v_mfma_f32_16x16x32_f16 v[116:119], a[36:39], v[148:151], v[116:119]
    v_pk_mul_f16 v135, v135, v87
    v_fma_f32 v185, |v108|, v64, v185
    v_mfma_f32_16x16x32_f16 v[116:119], a[32:35], v[144:147], v[116:119]
    v_pk_mul_f16 v136, v136, v88
    v_fma_f32 v185, |v109|, v65, v185
    v_mfma_f32_16x16x32_f16 v[120:123], a[16:19], v[144:147], v[20:23]
    v_pk_mul_f16 v137, v137, v89
    v_fma_f32 v185, |v110|, v66, v185
    v_mfma_f32_16x16x32_f16 v[120:123], a[20:23], v[148:151], v[120:123]
    v_pk_mul_f16 v138, v138, v90
    v_fma_f32 v185, |v111|, v67, v185
    v_mfma_f32_16x16x32_f16 v[120:123], a[24:27], v[152:155], v[120:123]
    v_pk_mul_f16 v139, v139, v91
    v_fma_f32 v185, |v112|, v60, v185
    v_mfma_f32_16x16x32_f16 v[120:123], a[28:31], v[156:159], v[120:123]
    v_pk_mul_f16 v140, v140, v92
    v_fma_f32 v185, |v113|, v61, v185
    v_mfma_f32_16x16x32_f16 v[124:127], a[12:15], v[156:159], v[16:19]
    v_pk_mul_f16 v141, v141, v93
    v_fma_f32 v185, |v114|, v62, v185
    v_mfma_f32_16x16x32_f16 v[124:127], a[8:11], v[152:155], v[124:127]
    v_pk_mul_f16 v142, v142, v94
    v_fma_f32 v185, |v115|, v63, v185
    v_mfma_f32_16x16x32_f16 v[124:127], a[4:7], v[148:151], v[124:127]
    v_pk_mul_f16 v143, v143, v95
    v_fma_f32 v185, |v116|, v56, v185
    v_mfma_f32_16x16x32_f16 v[124:127], a[0:3], v[144:147], v[124:127]
    v_mov_b32_dpp v247, v246 row_ror:12 row_mask:0xf bank_mask:0xf
    v_fma_f32 v185, |v117|, v57, v185
    v_mfma_f32_16x16x32_f16 v[96:99], a[0:3], v[128:131], v[16:19]
    ds_read_b128 v[156:159], v247 offset:192
    v_fma_f32 v185, |v118|, v58, v185
    v_mfma_f32_16x16x32_f16 v[96:99], a[4:7], v[132:135], v[96:99]
    ds_read_b128 v[152:155], v247 offset:128
    v_fma_f32 v185, |v119|, v59, v185
    v_mfma_f32_16x16x32_f16 v[96:99], a[8:11], v[136:139], v[96:99]
    ds_read_b128 v[148:151], v247 offset:64
    v_fma_f32 v185, |v120|, v52, v185
    v_mfma_f32_16x16x32_f16 v[96:99], a[12:15], v[140:143], v[96:99]
    ds_read_b128 v[144:147], v247 offset:0
    v_fma_f32 v185, |v121|, v53, v185
    v_mfma_f32_16x16x32_f16 v[100:103], a[28:31], v[140:143], v[20:23]
    v_add_u32_sdwa v227, v163, s49 dst_sel:WORD_1 dst_unused:UNUSED_PAD src0_sel:WORD_1 src1_sel:DWORD
    v_fma_f32 v185, |v122|, v54, v185
    v_mfma_f32_16x16x32_f16 v[100:103], a[24:27], v[136:139], v[100:103]
    v_cvt_pkrtz_f16_f32 v204, v220, v221
    v_fma_f32 v185, |v123|, v55, v185
    v_mfma_f32_16x16x32_f16 v[100:103], a[20:23], v[132:135], v[100:103]
    v_max3_f32 v248, v248, |v220|, |v221|
    v_fma_f32 v185, |v124|, v48, v185
    v_mfma_f32_16x16x32_f16 v[100:103], a[16:19], v[128:131], v[100:103]
    v_cvt_pkrtz_f16_f32 v205, v222, v223
    v_fma_f32 v185, |v125|, v49, v185
    v_mfma_f32_16x16x32_f16 v[104:107], a[32:35], v[128:131], v[24:27]
    v_max3_f32 v249, v249, |v222|, |v223|
    v_fma_f32 v185, |v126|, v50, v185
    v_mfma_f32_16x16x32_f16 v[104:107], a[36:39], v[132:135], v[104:107]
    v_cvt_pkrtz_f16_f32 v206, v224, v225
    v_fma_f32 v185, |v127|, v51, v185
    v_mfma_f32_16x16x32_f16 v[104:107], a[40:43], v[136:139], v[104:107]
    v_max3_f32 v248, v248, |v224|, |v225|
    v_mul_f32 v186, |v96|, v48
    v_mfma_f32_16x16x32_f16 v[104:107], a[44:47], v[140:143], v[104:107]
    v_cvt_pkrtz_f16_f32 v207, v226, v227
    v_fma_f32 v186, |v97|, v49, v186
    v_mfma_f32_16x16x32_f16 v[108:111], a[60:63], v[140:143], v[28:31]
    v_max3_f32 v249, v249, |v226|, |v227|
    v_fma_f32 v186, |v98|, v50, v186
    v_mfma_f32_16x16x32_f16 v[108:111], a[56:59], v[136:139], v[108:111]
    ds_write_b128 v203, v[204:207] offset:4608
    v_mfma_f32_16x16x32_f16 v[108:111], a[52:55], v[132:135], v[108:111]
    s_waitcnt vmcnt(1)
    v_lshl_add_u32 v220, v164, 16, s48
    v_fma_f32 v186, |v99|, v51, v186
    v_mfma_f32_16x16x32_f16 v[108:111], a[48:51], v[128:131], v[108:111]
    s_waitcnt lgkmcnt(1)
    v_pk_mul_f16 v144, v144, v80
    v_fma_f32 v186, |v100|, v52, v186
    v_mfma_f32_16x16x32_f16 v[112:115], a[64:67], v[128:131], v[32:35]
    v_pk_mul_f16 v145, v145, v81
    v_fma_f32 v186, |v101|, v53, v186
    v_mfma_f32_16x16x32_f16 v[112:115], a[68:71], v[132:135], v[112:115]
    v_pk_mul_f16 v146, v146, v82
    v_fma_f32 v186, |v102|, v54, v186
    v_mfma_f32_16x16x32_f16 v[112:115], a[72:75], v[136:139], v[112:115]
    v_pk_mul_f16 v147, v147, v83
    v_fma_f32 v186, |v103|, v55, v186
    v_mfma_f32_16x16x32_f16 v[112:115], a[76:79], v[140:143], v[112:115]
    v_pk_mul_f16 v148, v148, v84
    v_fma_f32 v186, |v104|, v56, v186
    v_mfma_f32_16x16x32_f16 v[116:119], a[92:95], v[140:143], v[36:39]
    v_pk_mul_f16 v149, v149, v85
    v_fma_f32 v186, |v105|, v57, v186
    v_mfma_f32_16x16x32_f16 v[116:119], a[88:91], v[136:139], v[116:119]
    v_pk_mul_f16 v150, v150, v86
    v_fma_f32 v186, |v106|, v58, v186
    v_mfma_f32_16x16x32_f16 v[116:119], a[84:87], v[132:135], v[116:119]
    v_pk_mul_f16 v151, v151, v87
    v_fma_f32 v186, |v107|, v59, v186
    v_mfma_f32_16x16x32_f16 v[116:119], a[80:83], v[128:131], v[116:119]
    v_pk_mul_f16 v152, v152, v88
    v_fma_f32 v186, |v108|, v60, v186
    v_mfma_f32_16x16x32_f16 v[120:123], a[96:99], v[128:131], v[40:43]
    v_pk_mul_f16 v153, v153, v89
    v_fma_f32 v186, |v109|, v61, v186
    v_mfma_f32_16x16x32_f16 v[120:123], a[100:103], v[132:135], v[120:123]
    v_pk_mul_f16 v154, v154, v90
    v_fma_f32 v186, |v110|, v62, v186
    v_mfma_f32_16x16x32_f16 v[120:123], a[104:107], v[136:139], v[120:123]
    v_pk_mul_f16 v155, v155, v91
    v_fma_f32 v186, |v111|, v63, v186
    v_mfma_f32_16x16x32_f16 v[120:123], a[108:111], v[140:143], v[120:123]
    v_pk_mul_f16 v156, v156, v92
    v_fma_f32 v186, |v112|, v64, v186
    v_mfma_f32_16x16x32_f16 v[124:127], a[124:127], v[140:143], v[44:47]
    v_pk_mul_f16 v157, v157, v93
    v_fma_f32 v186, |v113|, v65, v186
    v_mfma_f32_16x16x32_f16 v[124:127], a[120:123], v[136:139], v[124:127]
    v_pk_mul_f16 v158, v158, v94
    v_fma_f32 v186, |v114|, v66, v186
    v_mfma_f32_16x16x32_f16 v[124:127], a[116:119], v[132:135], v[124:127]
    v_pk_mul_f16 v159, v159, v95
    v_fma_f32 v186, |v115|, v67, v186
    v_mfma_f32_16x16x32_f16 v[124:127], a[112:115], v[128:131], v[124:127]
    v_mov_b32_dpp v247, v246 row_ror:11 row_mask:0xf bank_mask:0xf
    v_fma_f32 v186, |v116|, v68, v186
    v_mfma_f32_16x16x32_f16 v[96:99], a[112:115], v[144:147], v[44:47]
    ds_read_b128 v[140:143], v247 offset:192
    v_fma_f32 v186, |v117|, v69, v186
    v_mfma_f32_16x16x32_f16 v[96:99], a[116:119], v[148:151], v[96:99]
    ds_read_b128 v[136:139], v247 offset:128
    v_fma_f32 v186, |v118|, v70, v186
    v_mfma_f32_16x16x32_f16 v[96:99], a[120:123], v[152:155], v[96:99]
    ds_read_b128 v[132:135], v247 offset:64
    v_fma_f32 v186, |v119|, v71, v186
    v_mfma_f32_16x16x32_f16 v[96:99], a[124:127], v[156:159], v[96:99]
    ds_read_b128 v[128:131], v247 offset:0
    v_fma_f32 v186, |v120|, v72, v186
    v_mfma_f32_16x16x32_f16 v[100:103], a[108:111], v[156:159], v[40:43]
    v_add_u32_sdwa v221, v164, s49 dst_sel:WORD_1 dst_unused:UNUSED_PAD src0_sel:WORD_1 src1_sel:DWORD
    v_fma_f32 v186, |v121|, v73, v186
    v_mfma_f32_16x16x32_f16 v[100:103], a[104:107], v[152:155], v[100:103]
    v_lshl_add_u32 v222, v165, 16, s48
    v_fma_f32 v186, |v122|, v74, v186
    v_mfma_f32_16x16x32_f16 v[100:103], a[100:103], v[148:151], v[100:103]
    v_add_u32_sdwa v223, v165, s49 dst_sel:WORD_1 dst_unused:UNUSED_PAD src0_sel:WORD_1 src1_sel:DWORD
    v_fma_f32 v186, |v123|, v75, v186
    v_mfma_f32_16x16x32_f16 v[100:103], a[96:99], v[144:147], v[100:103]
    v_lshl_add_u32 v224, v166, 16, s48
    v_fma_f32 v186, |v124|, v76, v186
    v_mfma_f32_16x16x32_f16 v[104:107], a[80:83], v[144:147], v[36:39]
    v_add_u32_sdwa v225, v166, s49 dst_sel:WORD_1 dst_unused:UNUSED_PAD src0_sel:WORD_1 src1_sel:DWORD
    v_fma_f32 v186, |v125|, v77, v186
    v_mfma_f32_16x16x32_f16 v[104:107], a[84:87], v[148:151], v[104:107]
    v_lshl_add_u32 v226, v167, 16, s48
    v_fma_f32 v186, |v126|, v78, v186
    v_mfma_f32_16x16x32_f16 v[104:107], a[88:91], v[152:155], v[104:107]
    v_add_u32_sdwa v227, v167, s49 dst_sel:WORD_1 dst_unused:UNUSED_PAD src0_sel:WORD_1 src1_sel:DWORD
    v_fma_f32 v186, |v127|, v79, v186
    v_mfma_f32_16x16x32_f16 v[104:107], a[92:95], v[156:159], v[104:107]
    v_cvt_pkrtz_f16_f32 v208, v220, v221
    v_mul_f32 v187, |v96|, v76
    v_mfma_f32_16x16x32_f16 v[108:111], a[76:79], v[156:159], v[32:35]
    v_max3_f32 v248, v248, |v220|, |v221|
    v_fma_f32 v187, |v97|, v77, v187
    v_mfma_f32_16x16x32_f16 v[108:111], a[72:75], v[152:155], v[108:111]
    v_cvt_pkrtz_f16_f32 v209, v222, v223
    v_fma_f32 v187, |v98|, v78, v187
    v_mfma_f32_16x16x32_f16 v[108:111], a[68:71], v[148:151], v[108:111]
    v_max3_f32 v249, v249, |v222|, |v223|
    v_fma_f32 v187, |v99|, v79, v187
    v_mfma_f32_16x16x32_f16 v[108:111], a[64:67], v[144:147], v[108:111]
    s_waitcnt lgkmcnt(0)
    v_pk_mul_f16 v128, v128, v80
    v_fma_f32 v187, |v100|, v72, v187
    v_mfma_f32_16x16x32_f16 v[112:115], a[48:51], v[144:147], v[28:31]
    v_pk_mul_f16 v129, v129, v81
    v_fma_f32 v187, |v101|, v73, v187
    v_mfma_f32_16x16x32_f16 v[112:115], a[52:55], v[148:151], v[112:115]
    v_pk_mul_f16 v130, v130, v82
    v_fma_f32 v187, |v102|, v74, v187
    v_mfma_f32_16x16x32_f16 v[112:115], a[56:59], v[152:155], v[112:115]
    v_pk_mul_f16 v131, v131, v83
    v_fma_f32 v187, |v103|, v75, v187
    v_mfma_f32_16x16x32_f16 v[112:115], a[60:63], v[156:159], v[112:115]
    v_pk_mul_f16 v132, v132, v84
    v_fma_f32 v187, |v104|, v68, v187
    v_mfma_f32_16x16x32_f16 v[116:119], a[44:47], v[156:159], v[24:27]
    v_pk_mul_f16 v133, v133, v85
    v_fma_f32 v187, |v105|, v69, v187
    v_mfma_f32_16x16x32_f16 v[116:119], a[40:43], v[152:155], v[116:119]
    v_pk_mul_f16 v134, v134, v86
    v_fma_f32 v187, |v106|, v70, v187
    v_mfma_f32_16x16x32_f16 v[116:119], a[36:39], v[148:151], v[116:119]
    v_pk_mul_f16 v135, v135, v87
    v_fma_f32 v187, |v107|, v71, v187
    v_mfma_f32_16x16x32_f16 v[116:119], a[32:35], v[144:147], v[116:119]
    v_pk_mul_f16 v136, v136, v88
    v_fma_f32 v187, |v108|, v64, v187
    v_mfma_f32_16x16x32_f16 v[120:123], a[16:19], v[144:147], v[20:23]
    v_pk_mul_f16 v137, v137, v89
    v_fma_f32 v187, |v109|, v65, v187
    v_mfma_f32_16x16x32_f16 v[120:123], a[20:23], v[148:151], v[120:123]
    v_pk_mul_f16 v138, v138, v90
    v_fma_f32 v187, |v110|, v66, v187
    v_mfma_f32_16x16x32_f16 v[120:123], a[24:27], v[152:155], v[120:123]
    v_pk_mul_f16 v139, v139, v91
    v_fma_f32 v187, |v111|, v67, v187
    v_mfma_f32_16x16x32_f16 v[120:123], a[28:31], v[156:159], v[120:123]
    v_pk_mul_f16 v140, v140, v92
    v_fma_f32 v187, |v112|, v60, v187
    v_mfma_f32_16x16x32_f16 v[124:127], a[12:15], v[156:159], v[16:19]
    v_pk_mul_f16 v141, v141, v93
    v_fma_f32 v187, |v113|, v61, v187
    v_mfma_f32_16x16x32_f16 v[124:127], a[8:11], v[152:155], v[124:127]
    v_pk_mul_f16 v142, v142, v94
    v_fma_f32 v187, |v114|, v62, v187
    v_mfma_f32_16x16x32_f16 v[124:127], a[4:7], v[148:151], v[124:127]
    v_pk_mul_f16 v143, v143, v95
    v_fma_f32 v187, |v115|, v63, v187
    v_mfma_f32_16x16x32_f16 v[124:127], a[0:3], v[144:147], v[124:127]
    v_mov_b32_dpp v247, v246 row_ror:10 row_mask:0xf bank_mask:0xf
    v_fma_f32 v187, |v116|, v56, v187
    v_mfma_f32_16x16x32_f16 v[96:99], a[0:3], v[128:131], v[16:19]
    ds_read_b128 v[156:159], v247 offset:192
    v_fma_f32 v187, |v117|, v57, v187
    v_mfma_f32_16x16x32_f16 v[96:99], a[4:7], v[132:135], v[96:99]
    ds_read_b128 v[152:155], v247 offset:128
    v_fma_f32 v187, |v118|, v58, v187
    v_mfma_f32_16x16x32_f16 v[96:99], a[8:11], v[136:139], v[96:99]
    ds_read_b128 v[148:151], v247 offset:64
    v_fma_f32 v187, |v119|, v59, v187
    v_mfma_f32_16x16x32_f16 v[96:99], a[12:15], v[140:143], v[96:99]
    ds_read_b128 v[144:147], v247 offset:0
    v_fma_f32 v187, |v120|, v52, v187
    v_mfma_f32_16x16x32_f16 v[100:103], a[28:31], v[140:143], v[20:23]
    v_cvt_pkrtz_f16_f32 v210, v224, v225
    v_fma_f32 v187, |v121|, v53, v187
    v_mfma_f32_16x16x32_f16 v[100:103], a[24:27], v[136:139], v[100:103]
    v_max3_f32 v248, v248, |v224|, |v225|
    v_fma_f32 v187, |v122|, v54, v187
    v_mfma_f32_16x16x32_f16 v[100:103], a[20:23], v[132:135], v[100:103]
    v_cvt_pkrtz_f16_f32 v211, v226, v227
    v_fma_f32 v187, |v123|, v55, v187
    v_mfma_f32_16x16x32_f16 v[100:103], a[16:19], v[128:131], v[100:103]
    v_max3_f32 v249, v249, |v226|, |v227|
    v_fma_f32 v187, |v124|, v48, v187
    v_mfma_f32_16x16x32_f16 v[104:107], a[32:35], v[128:131], v[24:27]
    ds_write_b128 v203, v[208:211] offset:5472
    v_mfma_f32_16x16x32_f16 v[104:107], a[36:39], v[132:135], v[104:107]
    s_waitcnt vmcnt(0)
    v_lshl_add_u32 v220, v168, 16, s48
    v_fma_f32 v187, |v125|, v49, v187
    v_mfma_f32_16x16x32_f16 v[104:107], a[40:43], v[136:139], v[104:107]
    v_add_u32_sdwa v221, v168, s49 dst_sel:WORD_1 dst_unused:UNUSED_PAD src0_sel:WORD_1 src1_sel:DWORD
    v_fma_f32 v187, |v126|, v50, v187
    v_mfma_f32_16x16x32_f16 v[104:107], a[44:47], v[140:143], v[104:107]
    v_lshl_add_u32 v222, v169, 16, s48
    v_fma_f32 v187, |v127|, v51, v187
    v_mfma_f32_16x16x32_f16 v[108:111], a[60:63], v[140:143], v[28:31]
    v_add_u32_sdwa v223, v169, s49 dst_sel:WORD_1 dst_unused:UNUSED_PAD src0_sel:WORD_1 src1_sel:DWORD
    v_mul_f32 v188, |v96|, v48
    v_mfma_f32_16x16x32_f16 v[108:111], a[56:59], v[136:139], v[108:111]
    v_lshl_add_u32 v224, v170, 16, s48
    v_fma_f32 v188, |v97|, v49, v188
    v_mfma_f32_16x16x32_f16 v[108:111], a[52:55], v[132:135], v[108:111]
    v_add_u32_sdwa v225, v170, s49 dst_sel:WORD_1 dst_unused:UNUSED_PAD src0_sel:WORD_1 src1_sel:DWORD
    v_fma_f32 v188, |v98|, v50, v188
    v_mfma_f32_16x16x32_f16 v[108:111], a[48:51], v[128:131], v[108:111]
    s_waitcnt lgkmcnt(1)
    v_pk_mul_f16 v144, v144, v80
    v_fma_f32 v188, |v99|, v51, v188
    v_mfma_f32_16x16x32_f16 v[112:115], a[64:67], v[128:131], v[32:35]
    v_pk_mul_f16 v145, v145, v81
    v_fma_f32 v188, |v100|, v52, v188
    v_mfma_f32_16x16x32_f16 v[112:115], a[68:71], v[132:135], v[112:115]
    v_pk_mul_f16 v146, v146, v82
    v_fma_f32 v188, |v101|, v53, v188
    v_mfma_f32_16x16x32_f16 v[112:115], a[72:75], v[136:139], v[112:115]
    v_pk_mul_f16 v147, v147, v83
    v_fma_f32 v188, |v102|, v54, v188
    v_mfma_f32_16x16x32_f16 v[112:115], a[76:79], v[140:143], v[112:115]
    v_pk_mul_f16 v148, v148, v84
    v_fma_f32 v188, |v103|, v55, v188
    v_mfma_f32_16x16x32_f16 v[116:119], a[92:95], v[140:143], v[36:39]
    v_pk_mul_f16 v149, v149, v85
    v_fma_f32 v188, |v104|, v56, v188
    v_mfma_f32_16x16x32_f16 v[116:119], a[88:91], v[136:139], v[116:119]
    v_pk_mul_f16 v150, v150, v86
    v_fma_f32 v188, |v105|, v57, v188
    v_mfma_f32_16x16x32_f16 v[116:119], a[84:87], v[132:135], v[116:119]
    v_pk_mul_f16 v151, v151, v87
    v_fma_f32 v188, |v106|, v58, v188
    v_mfma_f32_16x16x32_f16 v[116:119], a[80:83], v[128:131], v[116:119]
    v_pk_mul_f16 v152, v152, v88
    v_fma_f32 v188, |v107|, v59, v188
    v_mfma_f32_16x16x32_f16 v[120:123], a[96:99], v[128:131], v[40:43]
    v_pk_mul_f16 v153, v153, v89
    v_fma_f32 v188, |v108|, v60, v188
    v_mfma_f32_16x16x32_f16 v[120:123], a[100:103], v[132:135], v[120:123]
    v_pk_mul_f16 v154, v154, v90
    v_fma_f32 v188, |v109|, v61, v188
    v_mfma_f32_16x16x32_f16 v[120:123], a[104:107], v[136:139], v[120:123]
    v_pk_mul_f16 v155, v155, v91
    v_fma_f32 v188, |v110|, v62, v188
    v_mfma_f32_16x16x32_f16 v[120:123], a[108:111], v[140:143], v[120:123]
    v_pk_mul_f16 v156, v156, v92
    v_fma_f32 v188, |v111|, v63, v188
    v_mfma_f32_16x16x32_f16 v[124:127], a[124:127], v[140:143], v[44:47]
    v_pk_mul_f16 v157, v157, v93
    v_fma_f32 v188, |v112|, v64, v188
    v_mfma_f32_16x16x32_f16 v[124:127], a[120:123], v[136:139], v[124:127]
    v_pk_mul_f16 v158, v158, v94
    v_fma_f32 v188, |v113|, v65, v188
    v_mfma_f32_16x16x32_f16 v[124:127], a[116:119], v[132:135], v[124:127]
    v_pk_mul_f16 v159, v159, v95
    v_fma_f32 v188, |v114|, v66, v188
    v_mfma_f32_16x16x32_f16 v[124:127], a[112:115], v[128:131], v[124:127]
    v_mov_b32_dpp v247, v246 row_ror:9 row_mask:0xf bank_mask:0xf
    v_fma_f32 v188, |v115|, v67, v188
    v_mfma_f32_16x16x32_f16 v[96:99], a[112:115], v[144:147], v[44:47]
    ds_read_b128 v[140:143], v247 offset:192
    v_fma_f32 v188, |v116|, v68, v188
    v_mfma_f32_16x16x32_f16 v[96:99], a[116:119], v[148:151], v[96:99]
    ds_read_b128 v[136:139], v247 offset:128
    v_fma_f32 v188, |v117|, v69, v188
    v_mfma_f32_16x16x32_f16 v[96:99], a[120:123], v[152:155], v[96:99]
    ds_read_b128 v[132:135], v247 offset:64
    v_fma_f32 v188, |v118|, v70, v188
    v_mfma_f32_16x16x32_f16 v[96:99], a[124:127], v[156:159], v[96:99]
    ds_read_b128 v[128:131], v247 offset:0
    v_fma_f32 v188, |v119|, v71, v188
    v_mfma_f32_16x16x32_f16 v[100:103], a[108:111], v[156:159], v[40:43]
    v_lshl_add_u32 v226, v171, 16, s48
    v_fma_f32 v188, |v120|, v72, v188
    v_mfma_f32_16x16x32_f16 v[100:103], a[104:107], v[152:155], v[100:103]
    v_add_u32_sdwa v227, v171, s49 dst_sel:WORD_1 dst_unused:UNUSED_PAD src0_sel:WORD_1 src1_sel:DWORD
    v_fma_f32 v188, |v121|, v73, v188
    v_mfma_f32_16x16x32_f16 v[100:103], a[100:103], v[148:151], v[100:103]
    v_cvt_pkrtz_f16_f32 v212, v220, v221
    v_fma_f32 v188, |v122|, v74, v188
    v_mfma_f32_16x16x32_f16 v[100:103], a[96:99], v[144:147], v[100:103]
    v_max3_f32 v248, v248, |v220|, |v221|
    v_fma_f32 v188, |v123|, v75, v188
    v_mfma_f32_16x16x32_f16 v[104:107], a[80:83], v[144:147], v[36:39]
    v_cvt_pkrtz_f16_f32 v213, v222, v223
    v_fma_f32 v188, |v124|, v76, v188
    v_mfma_f32_16x16x32_f16 v[104:107], a[84:87], v[148:151], v[104:107]
    v_max3_f32 v249, v249, |v222|, |v223|
    v_fma_f32 v188, |v125|, v77, v188
    v_mfma_f32_16x16x32_f16 v[104:107], a[88:91], v[152:155], v[104:107]
    v_cvt_pkrtz_f16_f32 v214, v224, v225
    v_fma_f32 v188, |v126|, v78, v188
    v_mfma_f32_16x16x32_f16 v[104:107], a[92:95], v[156:159], v[104:107]
    v_max3_f32 v248, v248, |v224|, |v225|
    v_fma_f32 v188, |v127|, v79, v188
    v_mfma_f32_16x16x32_f16 v[108:111], a[76:79], v[156:159], v[32:35]
    v_cvt_pkrtz_f16_f32 v215, v226, v227
    v_mul_f32 v189, |v96|, v76
    v_mfma_f32_16x16x32_f16 v[108:111], a[72:75], v[152:155], v[108:111]
    v_max3_f32 v249, v249, |v226|, |v227|
    v_fma_f32 v189, |v97|, v77, v189
    v_mfma_f32_16x16x32_f16 v[108:111], a[68:71], v[148:151], v[108:111]
    ds_write_b128 v203, v[212:215] offset:6336
    v_mfma_f32_16x16x32_f16 v[108:111], a[64:67], v[144:147], v[108:111]
    s_waitcnt lgkmcnt(1)
    v_pk_mul_f16 v128, v128, v80
    v_fma_f32 v189, |v98|, v78, v189
    v_mfma_f32_16x16x32_f16 v[112:115], a[48:51], v[144:147], v[28:31]
    v_pk_mul_f16 v129, v129, v81
    v_fma_f32 v189, |v99|, v79, v189
    v_mfma_f32_16x16x32_f16 v[112:115], a[52:55], v[148:151], v[112:115]
    v_pk_mul_f16 v130, v130, v82
    v_fma_f32 v189, |v100|, v72, v189
    v_mfma_f32_16x16x32_f16 v[112:115], a[56:59], v[152:155], v[112:115]
    v_pk_mul_f16 v131, v131, v83
    v_fma_f32 v189, |v101|, v73, v189
    v_mfma_f32_16x16x32_f16 v[112:115], a[60:63], v[156:159], v[112:115]
    v_pk_mul_f16 v132, v132, v84
    v_fma_f32 v189, |v102|, v74, v189
    v_mfma_f32_16x16x32_f16 v[116:119], a[44:47], v[156:159], v[24:27]
    v_pk_mul_f16 v133, v133, v85
    v_fma_f32 v189, |v103|, v75, v189
    v_mfma_f32_16x16x32_f16 v[116:119], a[40:43], v[152:155], v[116:119]
    v_pk_mul_f16 v134, v134, v86
    v_fma_f32 v189, |v104|, v68, v189
    v_mfma_f32_16x16x32_f16 v[116:119], a[36:39], v[148:151], v[116:119]
    v_pk_mul_f16 v135, v135, v87
    v_fma_f32 v189, |v105|, v69, v189
    v_mfma_f32_16x16x32_f16 v[116:119], a[32:35], v[144:147], v[116:119]
    v_pk_mul_f16 v136, v136, v88
    v_fma_f32 v189, |v106|, v70, v189
    v_mfma_f32_16x16x32_f16 v[120:123], a[16:19], v[144:147], v[20:23]
    v_pk_mul_f16 v137, v137, v89
    v_fma_f32 v189, |v107|, v71, v189
    v_mfma_f32_16x16x32_f16 v[120:123], a[20:23], v[148:151], v[120:123]
    v_pk_mul_f16 v138, v138, v90
    v_fma_f32 v189, |v108|, v64, v189
    v_mfma_f32_16x16x32_f16 v[120:123], a[24:27], v[152:155], v[120:123]
    v_pk_mul_f16 v139, v139, v91
    v_fma_f32 v189, |v109|, v65, v189
    v_mfma_f32_16x16x32_f16 v[120:123], a[28:31], v[156:159], v[120:123]
    v_pk_mul_f16 v140, v140, v92
    v_fma_f32 v189, |v110|, v66, v189
    v_mfma_f32_16x16x32_f16 v[124:127], a[12:15], v[156:159], v[16:19]
    v_pk_mul_f16 v141, v141, v93
    v_fma_f32 v189, |v111|, v67, v189
    v_mfma_f32_16x16x32_f16 v[124:127], a[8:11], v[152:155], v[124:127]
    v_pk_mul_f16 v142, v142, v94
    v_fma_f32 v189, |v112|, v60, v189
    v_mfma_f32_16x16x32_f16 v[124:127], a[4:7], v[148:151], v[124:127]
    v_pk_mul_f16 v143, v143, v95
    v_fma_f32 v189, |v113|, v61, v189
    v_mfma_f32_16x16x32_f16 v[124:127], a[0:3], v[144:147], v[124:127]
    v_mov_b32_dpp v247, v246 row_ror:8 row_mask:0xf bank_mask:0xf
    v_fma_f32 v189, |v114|, v62, v189
    v_mfma_f32_16x16x32_f16 v[96:99], a[0:3], v[128:131], v[16:19]
    ds_read_b128 v[156:159], v247 offset:192
    v_fma_f32 v189, |v115|, v63, v189
    v_mfma_f32_16x16x32_f16 v[96:99], a[4:7], v[132:135], v[96:99]
    ds_read_b128 v[152:155], v247 offset:128
    v_fma_f32 v189, |v116|, v56, v189
    v_mfma_f32_16x16x32_f16 v[96:99], a[8:11], v[136:139], v[96:99]
    ds_read_b128 v[148:151], v247 offset:64
    v_fma_f32 v189, |v117|, v57, v189
    v_mfma_f32_16x16x32_f16 v[96:99], a[12:15], v[140:143], v[96:99]
    ds_read_b128 v[144:147], v247 offset:0
    v_fma_f32 v189, |v118|, v58, v189
    v_mfma_f32_16x16x32_f16 v[100:103], a[28:31], v[140:143], v[20:23]
    v_max_f32 v248, v248, v249
    v_fma_f32 v189, |v119|, v59, v189
    v_mfma_f32_16x16x32_f16 v[100:103], a[24:27], v[136:139], v[100:103]
    v_cmp_le_f32 vcc, s50, v248
    v_fma_f32 v189, |v120|, v52, v189
    v_mfma_f32_16x16x32_f16 v[100:103], a[20:23], v[132:135], v[100:103]
    v_cmp_nlt_f32 s[92:93], v248, s51
    v_fma_f32 v189, |v121|, v53, v189
    v_mfma_f32_16x16x32_f16 v[100:103], a[16:19], v[128:131], v[100:103]
    s_cbranch_vccnz L_efix
    v_mfma_f32_16x16x32_f16 v[104:107], a[32:35], v[128:131], v[24:27]
    s_cmp_eq_u64 s[92:93], 0
    s_cbranch_scc1 L_efix
    v_mfma_f32_16x16x32_f16 v[104:107], a[36:39], v[132:135], v[104:107]
    ds_read_b128 v[204:207], v202 offset:4608
    v_fma_f32 v189, |v122|, v54, v189
    v_mfma_f32_16x16x32_f16 v[104:107], a[40:43], v[136:139], v[104:107]
    ds_read_b128 v[208:211], v202 offset:4672
    v_fma_f32 v189, |v123|, v55, v189
    v_mfma_f32_16x16x32_f16 v[104:107], a[44:47], v[140:143], v[104:107]
    ds_read_b128 v[212:215], v202 offset:4736
    v_fma_f32 v189, |v124|, v48, v189
    v_mfma_f32_16x16x32_f16 v[108:111], a[60:63], v[140:143], v[28:31]
    ds_read_b128 v[216:219], v202 offset:4800
    v_fma_f32 v189, |v125|, v49, v189
    v_mfma_f32_16x16x32_f16 v[108:111], a[56:59], v[136:139], v[108:111]
L_pad1:
    s_cbranch_execz L_hopret
    v_add_u32_sdwa v11, v238, s5 dst_sel:DWORD dst_unused:UNUSED_PAD src0_sel:WORD_1 src1_sel:DWORD
    v_fma_f32 v189, |v126|, v50, v189
    v_mfma_f32_16x16x32_f16 v[108:111], a[52:55], v[132:135], v[108:111]
    v_add_u32_sdwa v238, v238, s5 dst_sel:DWORD dst_unused:UNUSED_PAD src0_sel:WORD_0 src1_sel:DWORD
    v_fma_f32 v189, |v127|, v51, v189
    v_mfma_f32_16x16x32_f16 v[108:111], a[48:51], v[128:131], v[108:111]
    s_waitcnt lgkmcnt(4)
    v_pk_mul_f16 v144, v144, v80
    v_mul_f32 v190, |v96|, v48
    v_mfma_f32_16x16x32_f16 v[112:115], a[64:67], v[128:131], v[32:35]
    v_pk_mul_f16 v145, v145, v81
    v_fma_f32 v190, |v97|, v49, v190
    v_mfma_f32_16x16x32_f16 v[112:115], a[68:71], v[132:135], v[112:115]
    v_pk_mul_f16 v146, v146, v82
    v_fma_f32 v190, |v98|, v50, v190
    v_mfma_f32_16x16x32_f16 v[112:115], a[72:75], v[136:139], v[112:115]
    v_pk_mul_f16 v147, v147, v83
    v_fma_f32 v190, |v99|, v51, v190
    v_mfma_f32_16x16x32_f16 v[112:115], a[76:79], v[140:143], v[112:115]
    v_pk_mul_f16 v148, v148, v84
    v_fma_f32 v190, |v100|, v52, v190
    v_mfma_f32_16x16x32_f16 v[116:119], a[92:95], v[140:143], v[36:39]
    v_pk_mul_f16 v149, v149, v85
    v_fma_f32 v190, |v101|, v53, v190
    v_mfma_f32_16x16x32_f16 v[116:119], a[88:91], v[136:139], v[116:119]
    v_pk_mul_f16 v150, v150, v86
    v_fma_f32 v190, |v102|, v54, v190
    v_mfma_f32_16x16x32_f16 v[116:119], a[84:87], v[132:135], v[116:119]
    v_pk_mul_f16 v151, v151, v87
    v_fma_f32 v190, |v103|, v55, v190
    v_mfma_f32_16x16x32_f16 v[116:119], a[80:83], v[128:131], v[116:119]
    v_pk_mul_f16 v152, v152, v88
    v_fma_f32 v190, |v104|, v56, v190
    v_mfma_f32_16x16x32_f16 v[120:123], a[96:99], v[128:131], v[40:43]
    v_pk_mul_f16 v153, v153, v89
    v_fma_f32 v190, |v105|, v57, v190
    v_mfma_f32_16x16x32_f16 v[120:123], a[100:103], v[132:135], v[120:123]
    v_pk_mul_f16 v154, v154, v90
    v_fma_f32 v190, |v106|, v58, v190
    v_mfma_f32_16x16x32_f16 v[120:123], a[104:107], v[136:139], v[120:123]
    v_pk_mul_f16 v155, v155, v91
    v_fma_f32 v190, |v107|, v59, v190
    v_mfma_f32_16x16x32_f16 v[120:123], a[108:111], v[140:143], v[120:123]
    v_pk_mul_f16 v156, v156, v92
    v_fma_f32 v190, |v108|, v60, v190
    v_mfma_f32_16x16x32_f16 v[124:127], a[124:127], v[140:143], v[44:47]
    v_pk_mul_f16 v157, v157, v93
    v_fma_f32 v190, |v109|, v61, v190
    v_mfma_f32_16x16x32_f16 v[124:127], a[120:123], v[136:139], v[124:127]
    v_pk_mul_f16 v158, v158, v94
    v_fma_f32 v190, |v110|, v62, v190
    v_mfma_f32_16x16x32_f16 v[124:127], a[116:119], v[132:135], v[124:127]
    v_pk_mul_f16 v159, v159, v95
    v_fma_f32 v190, |v111|, v63, v190
    v_mfma_f32_16x16x32_f16 v[124:127], a[112:115], v[128:131], v[124:127]
    v_max_u32_dpp v254, v254, v254 row_ror:4 row_mask:0xf bank_mask:0xf
    v_fma_f32 v190, |v112|, v64, v190
    v_mfma_f32_16x16x32_f16 v[96:99], a[112:115], v[144:147], v[44:47]
    ds_read_b128 v[140:143], v245 offset:4800
    v_fma_f32 v190, |v113|, v65, v190
    v_mfma_f32_16x16x32_f16 v[96:99], a[116:119], v[148:151], v[96:99]
    ds_read_b128 v[136:139], v245 offset:4736
    v_fma_f32 v190, |v114|, v66, v190
    v_mfma_f32_16x16x32_f16 v[96:99], a[120:123], v[152:155], v[96:99]
    ds_read_b128 v[132:135], v245 offset:4672
    v_fma_f32 v190, |v115|, v67, v190
    v_mfma_f32_16x16x32_f16 v[96:99], a[124:127], v[156:159], v[96:99]
    ds_read_b128 v[128:131], v245 offset:4608
    v_fma_f32 v190, |v116|, v68, v190
    v_mfma_f32_16x16x32_f16 v[100:103], a[108:111], v[156:159], v[40:43]
    v_max_u32_dpp v255, v255, v255 row_ror:4 row_mask:0xf bank_mask:0xf
    v_fma_f32 v190, |v117|, v69, v190
    v_mfma_f32_16x16x32_f16 v[100:103], a[104:107], v[152:155], v[100:103]
    v_max_u32_dpp v254, v254, v254 row_ror:2 row_mask:0xf bank_mask:0xf
    v_fma_f32 v190, |v118|, v70, v190
    v_mfma_f32_16x16x32_f16 v[100:103], a[100:103], v[148:151], v[100:103]
    v_max_u32_dpp v255, v255, v255 row_ror:2 row_mask:0xf bank_mask:0xf
    v_fma_f32 v190, |v119|, v71, v190
    v_mfma_f32_16x16x32_f16 v[100:103], a[96:99], v[144:147], v[100:103]
    v_max_u32_dpp v254, v254, v254 row_ror:1 row_mask:0xf bank_mask:0xf
    v_fma_f32 v190, |v120|, v72, v190
    v_mfma_f32_16x16x32_f16 v[104:107], a[80:83], v[144:147], v[36:39]
    v_max_u32_dpp v255, v255, v255 row_ror:1 row_mask:0xf bank_mask:0xf
    v_fma_f32 v190, |v121|, v73, v190
    v_mfma_f32_16x16x32_f16 v[104:107], a[84:87], v[148:151], v[104:107]
    v_max_u32_dpp v254, v254, v254 row_bcast:15 row_mask:0xa bank_mask:0xf
    v_fma_f32 v190, |v122|, v74, v190
    v_mfma_f32_16x16x32_f16 v[104:107], a[88:91], v[152:155], v[104:107]
    v_max_u32_dpp v255, v255, v255 row_bcast:15 row_mask:0xa bank_mask:0xf
    v_fma_f32 v190, |v123|, v75, v190
    v_mfma_f32_16x16x32_f16 v[104:107], a[92:95], v[156:159], v[104:107]
    v_max_u32_dpp v254, v254, v254 row_bcast:31 row_mask:0xc bank_mask:0xf
    v_fma_f32 v190, |v124|, v76, v190
    v_mfma_f32_16x16x32_f16 v[108:111], a[76:79], v[156:159], v[32:35]
    v_max_u32_dpp v255, v255, v255 row_bcast:31 row_mask:0xc bank_mask:0xf
    v_fma_f32 v190, |v125|, v77, v190
    v_mfma_f32_16x16x32_f16 v[108:111], a[72:75], v[152:155], v[108:111]
    v_readlane_b32 s34, v254, 63
    v_fma_f32 v190, |v126|, v78, v190
    v_mfma_f32_16x16x32_f16 v[108:111], a[68:71], v[148:151], v[108:111]
    v_readlane_b32 s35, v255, 63
    s_bfe_u32 s34, s34, 0x80007
    v_fma_f32 v190, |v127|, v79, v190
    v_mfma_f32_16x16x32_f16 v[108:111], a[64:67], v[144:147], v[108:111]
    s_waitcnt lgkmcnt(0)
    v_pk_mul_f16 v128, v128, v80
    s_max_u32 s34, s34, 60
    v_mul_f32 v191, |v96|, v76
    v_mfma_f32_16x16x32_f16 v[112:115], a[48:51], v[144:147], v[28:31]
    v_pk_mul_f16 v129, v129, v81
    s_sub_u32 s11, s34, 134
    v_fma_f32 v191, |v97|, v77, v191
    v_mfma_f32_16x16x32_f16 v[112:115], a[52:55], v[148:151], v[112:115]
    v_pk_mul_f16 v130, v130, v82
    s_sub_u32 s11, s11, s54
    v_fma_f32 v191, |v98|, v78, v191
    v_mfma_f32_16x16x32_f16 v[112:115], a[56:59], v[152:155], v[112:115]
    v_pk_mul_f16 v131, v131, v83
    s_sub_u32 s34, s34, 22
    v_fma_f32 v191, |v99|, v79, v191
    v_mfma_f32_16x16x32_f16 v[112:115], a[60:63], v[156:159], v[112:115]
    v_pk_mul_f16 v132, v132, v84
    s_mul_i32 s10, s34, 0x800080
    v_fma_f32 v191, |v100|, v72, v191
    v_mfma_f32_16x16x32_f16 v[116:119], a[44:47], v[156:159], v[24:27]
    v_pk_mul_f16 v133, v133, v85
    s_lshr_b32 s35, s35, 23
    v_fma_f32 v191, |v101|, v73, v191
    v_mfma_f32_16x16x32_f16 v[116:119], a[40:43], v[152:155], v[116:119]
    v_pk_mul_f16 v134, v134, v86
    s_max_u32 s35, s35, 60
    v_fma_f32 v191, |v102|, v74, v191
    v_mfma_f32_16x16x32_f16 v[116:119], a[36:39], v[148:151], v[116:119]
    v_pk_mul_f16 v135, v135, v87
    s_sub_u32 s34, 134, s35
    v_fma_f32 v191, |v103|, v75, v191
    v_mfma_f32_16x16x32_f16 v[116:119], a[32:35], v[144:147], v[116:119]
    v_pk_mul_f16 v136, v136, v88
    s_sub_u32 s35, s35, 7
    v_fma_f32 v191, |v104|, v68, v191
    v_mfma_f32_16x16x32_f16 v[120:123], a[16:19], v[144:147], v[20:23]
    v_pk_mul_f16 v137, v137, v89
    s_lshl_b32 s12, s35, 23
    v_fma_f32 v191, |v105|, v69, v191
    v_mfma_f32_16x16x32_f16 v[120:123], a[20:23], v[148:151], v[120:123]
    v_pk_mul_f16 v138, v138, v90
    v_fma_f32 v191, |v106|, v70, v191
    v_mfma_f32_16x16x32_f16 v[120:123], a[24:27], v[152:155], v[120:123]
    v_pk_mul_f16 v139, v139, v91
    v_fma_f32 v191, |v107|, v71, v191
    v_mfma_f32_16x16x32_f16 v[120:123], a[28:31], v[156:159], v[120:123]
    v_pk_mul_f16 v140, v140, v92
    v_fma_f32 v191, |v108|, v64, v191
    v_mfma_f32_16x16x32_f16 v[124:127], a[12:15], v[156:159], v[16:19]
    v_pk_mul_f16 v141, v141, v93
    v_fma_f32 v191, |v109|, v65, v191
    v_mfma_f32_16x16x32_f16 v[124:127], a[8:11], v[152:155], v[124:127]
    v_pk_mul_f16 v142, v142, v94
    v_fma_f32 v191, |v110|, v66, v191
    v_mfma_f32_16x16x32_f16 v[124:127], a[4:7], v[148:151], v[124:127]
    v_pk_mul_f16 v143, v143, v95
    v_fma_f32 v191, |v111|, v67, v191
    v_mfma_f32_16x16x32_f16 v[124:127], a[0:3], v[144:147], v[124:127]
    v_and_b32 v254, s45, v252
    v_fma_f32 v191, |v112|, v60, v191
    v_mfma_f32_16x16x32_f16 v[96:99], a[0:3], v[128:131], v[16:19]
    ds_read_b128 v[156:159], v245 offset:5088
    v_fma_f32 v191, |v113|, v61, v191
    v_mfma_f32_16x16x32_f16 v[96:99], a[4:7], v[132:135], v[96:99]
    ds_read_b128 v[152:155], v245 offset:5024
    v_fma_f32 v191, |v114|, v62, v191
    v_mfma_f32_16x16x32_f16 v[96:99], a[8:11], v[136:139], v[96:99]
    ds_read_b128 v[148:151], v245 offset:4960
    v_fma_f32 v191, |v115|, v63, v191
    v_mfma_f32_16x16x32_f16 v[96:99], a[12:15], v[140:143], v[96:99]
    ds_read_b128 v[144:147], v245 offset:4896
    v_fma_f32 v191, |v116|, v56, v191
    v_mfma_f32_16x16x32_f16 v[100:103], a[28:31], v[140:143], v[20:23]
    v_ldexp_f32 v192, v192, s34
    v_fma_f32 v191, |v117|, v57, v191
    v_mfma_f32_16x16x32_f16 v[100:103], a[24:27], v[136:139], v[100:103]
    v_ldexp_f32 v193, v193, s34
    v_fma_f32 v191, |v118|, v58, v191
    v_mfma_f32_16x16x32_f16 v[100:103], a[20:23], v[132:135], v[100:103]
    v_pk_sub_u16 v253, v253, s10 clamp
    v_fma_f32 v191, |v119|, v59, v191
    v_mfma_f32_16x16x32_f16 v[100:103], a[16:19], v[128:131], v[100:103]
    v_cvt_pk_f16_f32 v192, v192, v193
    v_fma_f32 v191, |v120|, v52, v191
    v_mfma_f32_16x16x32_f16 v[104:107], a[32:35], v[128:131], v[24:27]
    v_lshl_or_b32 v253, v253, 3, v254
    v_fma_f32 v191, |v121|, v53, v191
    v_mfma_f32_16x16x32_f16 v[104:107], a[36:39], v[132:135], v[104:107]
    ds_write_b32 v11, v192 offset:9216
    v_mfma_f32_16x16x32_f16 v[104:107], a[40:43], v[136:139], v[104:107]
    ds_write_b32 v11, v253 offset:9504
    v_fma_f32 v191, |v122|, v54, v191
    v_mfma_f32_16x16x32_f16 v[104:107], a[44:47], v[140:143], v[104:107]
    ds_read_b128 v[172:175], v245 offset:9408
    v_fma_f32 v191, |v123|, v55, v191
    v_mfma_f32_16x16x32_f16 v[108:111], a[60:63], v[140:143], v[28:31]
    ds_read_b128 v[168:171], v245 offset:9344
    v_fma_f32 v191, |v124|, v48, v191
    v_mfma_f32_16x16x32_f16 v[108:111], a[56:59], v[136:139], v[108:111]
    ds_read_b128 v[164:167], v245 offset:9280
    v_fma_f32 v191, |v125|, v49, v191
    v_mfma_f32_16x16x32_f16 v[108:111], a[52:55], v[132:135], v[108:111]
    ds_read_b128 v[160:163], v245 offset:9216
    v_fma_f32 v191, |v126|, v50, v191
    v_mfma_f32_16x16x32_f16 v[108:111], a[48:51], v[128:131], v[108:111]
    s_waitcnt lgkmcnt(6)
    v_pk_mul_f16 v144, v144, v80
    v_fma_f32 v191, |v127|, v51, v191
    v_mfma_f32_16x16x32_f16 v[112:115], a[64:67], v[128:131], v[32:35]
    v_pk_mul_f16 v145, v145, v81
    v_mul_f32 v176, |v96|, v48
    v_mfma_f32_16x16x32_f16 v[112:115], a[68:71], v[132:135], v[112:115]
    v_pk_mul_f16 v146, v146, v82
    v_fma_f32 v176, |v97|, v49, v176
    v_mfma_f32_16x16x32_f16 v[112:115], a[72:75], v[136:139], v[112:115]
    v_pk_mul_f16 v147, v147, v83
    v_fma_f32 v176, |v98|, v50, v176
    v_mfma_f32_16x16x32_f16 v[112:115], a[76:79], v[140:143], v[112:115]
    v_pk_mul_f16 v148, v148, v84
    v_fma_f32 v176, |v99|, v51, v176
    v_mfma_f32_16x16x32_f16 v[116:119], a[92:95], v[140:143], v[36:39]
    v_pk_mul_f16 v149, v149, v85
    v_fma_f32 v176, |v100|, v52, v176
    v_mfma_f32_16x16x32_f16 v[116:119], a[88:91], v[136:139], v[116:119]
    v_pk_mul_f16 v150, v150, v86
    v_fma_f32 v176, |v101|, v53, v176
    v_mfma_f32_16x16x32_f16 v[116:119], a[84:87], v[132:135], v[116:119]
    v_pk_mul_f16 v151, v151, v87
    v_fma_f32 v176, |v102|, v54, v176
    v_mfma_f32_16x16x32_f16 v[116:119], a[80:83], v[128:131], v[116:119]
    v_pk_mul_f16 v152, v152, v88
    v_fma_f32 v176, |v103|, v55, v176
    v_mfma_f32_16x16x32_f16 v[120:123], a[96:99], v[128:131], v[40:43]
    v_pk_mul_f16 v153, v153, v89
    v_fma_f32 v176, |v104|, v56, v176
    v_mfma_f32_16x16x32_f16 v[120:123], a[100:103], v[132:135], v[120:123]
    v_pk_mul_f16 v154, v154, v90
    v_fma_f32 v176, |v105|, v57, v176
    v_mfma_f32_16x16x32_f16 v[120:123], a[104:107], v[136:139], v[120:123]
    v_pk_mul_f16 v155, v155, v91
    v_fma_f32 v176, |v106|, v58, v176
    v_mfma_f32_16x16x32_f16 v[120:123], a[108:111], v[140:143], v[120:123]
    v_pk_mul_f16 v156, v156, v92
    v_fma_f32 v176, |v107|, v59, v176
    v_mfma_f32_16x16x32_f16 v[124:127], a[124:127], v[140:143], v[44:47]
    v_pk_mul_f16 v157, v157, v93
    v_fma_f32 v176, |v108|, v60, v176
    v_mfma_f32_16x16x32_f16 v[124:127], a[120:123], v[136:139], v[124:127]
    v_pk_mul_f16 v158, v158, v94
    v_fma_f32 v176, |v109|, v61, v176
    v_mfma_f32_16x16x32_f16 v[124:127], a[116:119], v[132:135], v[124:127]
    v_pk_mul_f16 v159, v159, v95
    v_fma_f32 v176, |v110|, v62, v176
    v_mfma_f32_16x16x32_f16 v[124:127], a[112:115], v[128:131], v[124:127]
    s_waitcnt lgkmcnt(0)
    v_pk_mul_f16 v160, v160, v80
    v_fma_f32 v176, |v111|, v63, v176
    v_mfma_f32_16x16x32_f16 v[96:99], a[112:115], v[144:147], v[44:47]
    ds_read_b128 v[140:143], v245 offset:5376
    v_fma_f32 v176, |v112|, v64, v176
    v_mfma_f32_16x16x32_f16 v[96:99], a[116:119], v[148:151], v[96:99]
    ds_read_b128 v[136:139], v245 offset:5312
    v_fma_f32 v176, |v113|, v65, v176
    v_mfma_f32_16x16x32_f16 v[96:99], a[120:123], v[152:155], v[96:99]
    ds_read_b128 v[132:135], v245 offset:5248
    v_fma_f32 v176, |v114|, v66, v176
    v_mfma_f32_16x16x32_f16 v[96:99], a[124:127], v[156:159], v[96:99]
    ds_read_b128 v[128:131], v245 offset:5184
    v_fma_f32 v176, |v115|, v67, v176
    v_mfma_f32_16x16x32_f16 v[100:103], a[108:111], v[156:159], v[40:43]
    v_pk_mul_f16 v161, v161, v81
    v_fma_f32 v176, |v116|, v68, v176
    v_mfma_f32_16x16x32_f16 v[100:103], a[104:107], v[152:155], v[100:103]
    v_pk_mul_f16 v162, v162, v82
    v_fma_f32 v176, |v117|, v69, v176
    v_mfma_f32_16x16x32_f16 v[100:103], a[100:103], v[148:151], v[100:103]
    v_pk_mul_f16 v163, v163, v83
    v_fma_f32 v176, |v118|, v70, v176
    v_mfma_f32_16x16x32_f16 v[100:103], a[96:99], v[144:147], v[100:103]
    v_pk_mul_f16 v164, v164, v84
    v_fma_f32 v176, |v119|, v71, v176
    v_mfma_f32_16x16x32_f16 v[104:107], a[80:83], v[144:147], v[36:39]
    v_pk_mul_f16 v165, v165, v85
    v_fma_f32 v176, |v120|, v72, v176
    v_mfma_f32_16x16x32_f16 v[104:107], a[84:87], v[148:151], v[104:107]
    v_pk_mul_f16 v166, v166, v86
    v_fma_f32 v176, |v121|, v73, v176
    v_mfma_f32_16x16x32_f16 v[104:107], a[88:91], v[152:155], v[104:107]
    v_pk_mul_f16 v167, v167, v87
    v_fma_f32 v176, |v122|, v74, v176
    v_mfma_f32_16x16x32_f16 v[104:107], a[92:95], v[156:159], v[104:107]
    v_pk_mul_f16 v168, v168, v88
    v_fma_f32 v176, |v123|, v75, v176
    v_mfma_f32_16x16x32_f16 v[108:111], a[76:79], v[156:159], v[32:35]
    v_pk_mul_f16 v169, v169, v89
    v_fma_f32 v176, |v124|, v76, v176
    v_mfma_f32_16x16x32_f16 v[108:111], a[72:75], v[152:155], v[108:111]
    v_pk_mul_f16 v170, v170, v90
    v_fma_f32 v176, |v125|, v77, v176
    v_mfma_f32_16x16x32_f16 v[108:111], a[68:71], v[148:151], v[108:111]
    v_pk_mul_f16 v171, v171, v91
    v_fma_f32 v176, |v126|, v78, v176
    v_mfma_f32_16x16x32_f16 v[108:111], a[64:67], v[144:147], v[108:111]
    s_waitcnt lgkmcnt(0)
    v_pk_mul_f16 v128, v128, v80
    v_fma_f32 v176, |v127|, v79, v176
    v_mfma_f32_16x16x32_f16 v[112:115], a[48:51], v[144:147], v[28:31]
    v_pk_mul_f16 v129, v129, v81
    v_mul_f32 v177, |v96|, v76
    v_mfma_f32_16x16x32_f16 v[112:115], a[52:55], v[148:151], v[112:115]
    v_pk_mul_f16 v130, v130, v82
    v_fma_f32 v177, |v97|, v77, v177
    v_mfma_f32_16x16x32_f16 v[112:115], a[56:59], v[152:155], v[112:115]
    v_pk_mul_f16 v131, v131, v83
    v_fma_f32 v177, |v98|, v78, v177
    v_mfma_f32_16x16x32_f16 v[112:115], a[60:63], v[156:159], v[112:115]
    v_pk_mul_f16 v132, v132, v84
    v_fma_f32 v177, |v99|, v79, v177
    v_mfma_f32_16x16x32_f16 v[116:119], a[44:47], v[156:159], v[24:27]
    v_pk_mul_f16 v133, v133, v85
    v_fma_f32 v177, |v100|, v72, v177
    v_mfma_f32_16x16x32_f16 v[116:119], a[40:43], v[152:155], v[116:119]
    v_pk_mul_f16 v134, v134, v86
    v_fma_f32 v177, |v101|, v73, v177
    v_mfma_f32_16x16x32_f16 v[116:119], a[36:39], v[148:151], v[116:119]
    v_pk_mul_f16 v135, v135, v87
    v_fma_f32 v177, |v102|, v74, v177
    v_mfma_f32_16x16x32_f16 v[116:119], a[32:35], v[144:147], v[116:119]
    v_pk_mul_f16 v136, v136, v88
    v_fma_f32 v177, |v103|, v75, v177
    v_mfma_f32_16x16x32_f16 v[120:123], a[16:19], v[144:147], v[20:23]
    v_pk_mul_f16 v137, v137, v89
    v_fma_f32 v177, |v104|, v68, v177
    v_mfma_f32_16x16x32_f16 v[120:123], a[20:23], v[148:151], v[120:123]
    v_pk_mul_f16 v138, v138, v90
    v_fma_f32 v177, |v105|, v69, v177
    v_mfma_f32_16x16x32_f16 v[120:123], a[24:27], v[152:155], v[120:123]
    v_pk_mul_f16 v139, v139, v91
    v_fma_f32 v177, |v106|, v70, v177
    v_mfma_f32_16x16x32_f16 v[120:123], a[28:31], v[156:159], v[120:123]
    v_pk_mul_f16 v140, v140, v92
    v_fma_f32 v177, |v107|, v71, v177
    v_mfma_f32_16x16x32_f16 v[124:127], a[12:15], v[156:159], v[16:19]
    v_pk_mul_f16 v141, v141, v93
    v_fma_f32 v177, |v108|, v64, v177
    v_mfma_f32_16x16x32_f16 v[124:127], a[8:11], v[152:155], v[124:127]
    v_pk_mul_f16 v142, v142, v94
    v_fma_f32 v177, |v109|, v65, v177
    v_mfma_f32_16x16x32_f16 v[124:127], a[4:7], v[148:151], v[124:127]
    v_pk_mul_f16 v143, v143, v95
    v_fma_f32 v177, |v110|, v66, v177
    v_mfma_f32_16x16x32_f16 v[124:127], a[0:3], v[144:147], v[124:127]
    v_pk_mul_f16 v172, v172, v92
    v_fma_f32 v177, |v111|, v67, v177
    v_mfma_f32_16x16x32_f16 v[96:99], a[0:3], v[128:131], v[16:19]
    ds_read_b128 v[156:159], v245 offset:5664
    v_fma_f32 v177, |v112|, v60, v177
    v_mfma_f32_16x16x32_f16 v[96:99], a[4:7], v[132:135], v[96:99]
    ds_read_b128 v[152:155], v245 offset:5600
    v_fma_f32 v177, |v113|, v61, v177
    v_mfma_f32_16x16x32_f16 v[96:99], a[8:11], v[136:139], v[96:99]
    ds_read_b128 v[148:151], v245 offset:5536
    v_fma_f32 v177, |v114|, v62, v177
    v_mfma_f32_16x16x32_f16 v[96:99], a[12:15], v[140:143], v[96:99]
    ds_read_b128 v[144:147], v245 offset:5472
    v_fma_f32 v177, |v115|, v63, v177
    v_mfma_f32_16x16x32_f16 v[100:103], a[28:31], v[140:143], v[20:23]
    v_pk_mul_f16 v173, v173, v93
    v_fma_f32 v177, |v116|, v56, v177
    v_mfma_f32_16x16x32_f16 v[100:103], a[24:27], v[136:139], v[100:103]
    v_pk_mul_f16 v174, v174, v94
    v_fma_f32 v177, |v117|, v57, v177
    v_mfma_f32_16x16x32_f16 v[100:103], a[20:23], v[132:135], v[100:103]
    v_pk_mul_f16 v175, v175, v95
    v_fma_f32 v177, |v118|, v58, v177
    v_mfma_f32_16x16x32_f16 v[100:103], a[16:19], v[128:131], v[100:103]
    v_add_u32_sdwa v239, v232, s5 dst_sel:DWORD dst_unused:UNUSED_PAD src0_sel:WORD_1 src1_sel:DWORD
    v_fma_f32 v177, |v119|, v59, v177
    v_mfma_f32_16x16x32_f16 v[220:223], v[160:163], v[80:83], 0
    v_add_u32_sdwa v232, v232, s5 dst_sel:DWORD dst_unused:UNUSED_PAD src0_sel:WORD_0 src1_sel:DWORD
    v_fma_f32 v177, |v120|, v52, v177
    v_mfma_f32_16x16x32_f16 v[220:223], v[164:167], v[84:87], v[220:223]
    v_add_u32_sdwa v240, v233, s5 dst_sel:DWORD dst_unused:UNUSED_PAD src0_sel:WORD_1 src1_sel:DWORD
    v_fma_f32 v177, |v121|, v53, v177
    v_mfma_f32_16x16x32_f16 v[220:223], v[168:171], v[88:91], v[220:223]
    v_add_u32_sdwa v233, v233, s5 dst_sel:DWORD dst_unused:UNUSED_PAD src0_sel:WORD_0 src1_sel:DWORD
    v_fma_f32 v177, |v122|, v54, v177
    v_mfma_f32_16x16x32_f16 v[220:223], v[172:175], v[92:95], v[220:223]
    v_add_u32_sdwa v241, v234, s5 dst_sel:DWORD dst_unused:UNUSED_PAD src0_sel:WORD_1 src1_sel:DWORD
    v_fma_f32 v177, |v123|, v55, v177
    v_mfma_f32_16x16x32_f16 v[224:227], v[172:175], v[216:219], 0
    s_waitcnt lgkmcnt(0)
    v_pk_mul_f16 v144, v144, v80
    v_fma_f32 v177, |v124|, v48, v177
    v_mfma_f32_16x16x32_f16 v[224:227], v[168:171], v[212:215], v[224:227]
    v_pk_mul_f16 v145, v145, v81
    v_fma_f32 v177, |v125|, v49, v177
    v_mfma_f32_16x16x32_f16 v[224:227], v[164:167], v[208:211], v[224:227]
    v_pk_mul_f16 v146, v146, v82
    v_fma_f32 v177, |v126|, v50, v177
    v_mfma_f32_16x16x32_f16 v[224:227], v[160:163], v[204:207], v[224:227]
    ds_read_b128 v[172:175], v245 offset:9696
    v_fma_f32 v177, |v127|, v51, v177
    v_mfma_f32_16x16x32_f16 v[104:107], a[32:35], v[128:131], v[24:27]
    ds_read_b128 v[168:171], v245 offset:9632
    v_mul_f32 v178, |v96|, v48
    v_mfma_f32_16x16x32_f16 v[104:107], a[36:39], v[132:135], v[104:107]
    ds_read_b128 v[164:167], v245 offset:9568
    v_fma_f32 v178, |v97|, v49, v178
    v_mfma_f32_16x16x32_f16 v[104:107], a[40:43], v[136:139], v[104:107]
    ds_write_b128 v238, v[220:223] offset:0
    v_mfma_f32_16x16x32_f16 v[104:107], a[44:47], v[140:143], v[104:107]
    ds_write_b128 v238, v[224:227] offset:2304
    v_mfma_f32_16x16x32_f16 v[108:111], a[60:63], v[140:143], v[28:31]
    ds_read_b128 v[160:163], v245 offset:9504
    v_fma_f32 v178, |v98|, v50, v178
    v_mfma_f32_16x16x32_f16 v[108:111], a[56:59], v[136:139], v[108:111]
    v_pk_mul_f16 v147, v147, v83
    v_fma_f32 v178, |v99|, v51, v178
    v_mfma_f32_16x16x32_f16 v[108:111], a[52:55], v[132:135], v[108:111]
    v_pk_mul_f16 v148, v148, v84
    v_fma_f32 v178, |v100|, v52, v178
    v_mfma_f32_16x16x32_f16 v[108:111], a[48:51], v[128:131], v[108:111]
    v_pk_mul_f16 v149, v149, v85
    v_fma_f32 v178, |v101|, v53, v178
    v_mfma_f32_16x16x32_f16 v[112:115], a[64:67], v[128:131], v[32:35]
    v_pk_mul_f16 v150, v150, v86
    v_fma_f32 v178, |v102|, v54, v178
    v_mfma_f32_16x16x32_f16 v[112:115], a[68:71], v[132:135], v[112:115]
    v_pk_mul_f16 v151, v151, v87
    v_fma_f32 v178, |v103|, v55, v178
    v_mfma_f32_16x16x32_f16 v[112:115], a[72:75], v[136:139], v[112:115]
    v_pk_mul_f16 v152, v152, v88
    v_fma_f32 v178, |v104|, v56, v178
    v_mfma_f32_16x16x32_f16 v[112:115], a[76:79], v[140:143], v[112:115]
    v_pk_mul_f16 v153, v153, v89
    v_fma_f32 v178, |v105|, v57, v178
    v_mfma_f32_16x16x32_f16 v[116:119], a[92:95], v[140:143], v[36:39]
    v_pk_mul_f16 v154, v154, v90
    v_fma_f32 v178, |v106|, v58, v178
    v_mfma_f32_16x16x32_f16 v[116:119], a[88:91], v[136:139], v[116:119]
    s_waitcnt lgkmcnt(0)
    v_pk_mul_f16 v160, v160, v80
    v_fma_f32 v178, |v107|, v59, v178
    v_mfma_f32_16x16x32_f16 v[116:119], a[84:87], v[132:135], v[116:119]
    v_pk_mul_f16 v161, v161, v81
    v_fma_f32 v178, |v108|, v60, v178
    v_mfma_f32_16x16x32_f16 v[116:119], a[80:83], v[128:131], v[116:119]
    v_pk_mul_f16 v162, v162, v82
    v_fma_f32 v178, |v109|, v61, v178
    v_mfma_f32_16x16x32_f16 v[120:123], a[96:99], v[128:131], v[40:43]
    v_pk_mul_f16 v163, v163, v83
    v_fma_f32 v178, |v110|, v62, v178
    v_mfma_f32_16x16x32_f16 v[120:123], a[100:103], v[132:135], v[120:123]
    v_pk_mul_f16 v164, v164, v84
    v_fma_f32 v178, |v111|, v63, v178
    v_mfma_f32_16x16x32_f16 v[120:123], a[104:107], v[136:139], v[120:123]
    v_pk_mul_f16 v155, v155, v91
    v_fma_f32 v178, |v112|, v64, v178
    v_mfma_f32_16x16x32_f16 v[120:123], a[108:111], v[140:143], v[120:123]
    v_pk_mul_f16 v156, v156, v92
    v_fma_f32 v178, |v113|, v65, v178
    v_mfma_f32_16x16x32_f16 v[124:127], a[124:127], v[140:143], v[44:47]
    v_pk_mul_f16 v157, v157, v93
    v_fma_f32 v178, |v114|, v66, v178
    v_mfma_f32_16x16x32_f16 v[124:127], a[120:123], v[136:139], v[124:127]
    v_pk_mul_f16 v158, v158, v94
    v_fma_f32 v178, |v115|, v67, v178
    v_mfma_f32_16x16x32_f16 v[124:127], a[116:119], v[132:135], v[124:127]
    v_pk_mul_f16 v159, v159, v95
    v_fma_f32 v178, |v116|, v68, v178
    v_mfma_f32_16x16x32_f16 v[124:127], a[112:115], v[128:131], v[124:127]
    v_pk_mul_f16 v165, v165, v85
    v_fma_f32 v178, |v117|, v69, v178
    v_mfma_f32_16x16x32_f16 v[96:99], a[112:115], v[144:147], v[44:47]
    ds_read_b128 v[140:143], v245 offset:5952
    v_fma_f32 v178, |v118|, v70, v178
    v_mfma_f32_16x16x32_f16 v[96:99], a[116:119], v[148:151], v[96:99]
    ds_read_b128 v[136:139], v245 offset:5888
    v_fma_f32 v178, |v119|, v71, v178
    v_mfma_f32_16x16x32_f16 v[96:99], a[120:123], v[152:155], v[96:99]
    ds_read_b128 v[132:135], v245 offset:5824
    v_fma_f32 v178, |v120|, v72, v178
    v_mfma_f32_16x16x32_f16 v[96:99], a[124:127], v[156:159], v[96:99]
    ds_read_b128 v[128:131], v245 offset:5760
    v_fma_f32 v178, |v121|, v73, v178
    v_mfma_f32_16x16x32_f16 v[100:103], a[108:111], v[156:159], v[40:43]
    v_pk_mul_f16 v166, v166, v86
    v_fma_f32 v178, |v122|, v74, v178
    v_mfma_f32_16x16x32_f16 v[100:103], a[104:107], v[152:155], v[100:103]
    v_pk_mul_f16 v167, v167, v87
    v_fma_f32 v178, |v123|, v75, v178
    v_mfma_f32_16x16x32_f16 v[100:103], a[100:103], v[148:151], v[100:103]
    v_pk_mul_f16 v168, v168, v88
    v_fma_f32 v178, |v124|, v76, v178
    v_mfma_f32_16x16x32_f16 v[100:103], a[96:99], v[144:147], v[100:103]
    v_pk_mul_f16 v169, v169, v89
    v_fma_f32 v178, |v125|, v77, v178
    v_mfma_f32_16x16x32_f16 v[104:107], a[80:83], v[144:147], v[36:39]
    v_pk_mul_f16 v170, v170, v90
    v_fma_f32 v178, |v126|, v78, v178
    v_mfma_f32_16x16x32_f16 v[104:107], a[84:87], v[148:151], v[104:107]
    v_pk_mul_f16 v171, v171, v91
    v_fma_f32 v178, |v127|, v79, v178
    v_mfma_f32_16x16x32_f16 v[104:107], a[88:91], v[152:155], v[104:107]
    v_pk_mul_f16 v172, v172, v92
    v_mul_f32 v179, |v96|, v76
    v_mfma_f32_16x16x32_f16 v[104:107], a[92:95], v[156:159], v[104:107]
    v_pk_mul_f16 v173, v173, v93
    v_fma_f32 v179, |v97|, v77, v179
    v_mfma_f32_16x16x32_f16 v[108:111], a[76:79], v[156:159], v[32:35]
    v_pk_mul_f16 v174, v174, v94
    v_fma_f32 v179, |v98|, v78, v179
    v_mfma_f32_16x16x32_f16 v[108:111], a[72:75], v[152:155], v[108:111]
L_pad2:
    s_cbranch_execz L_hopret
    v_pk_mul_f16 v175, v175, v95
    v_fma_f32 v179, |v99|, v79, v179
    v_mfma_f32_16x16x32_f16 v[108:111], a[68:71], v[148:151], v[108:111]
    s_waitcnt lgkmcnt(0)
    v_pk_mul_f16 v128, v128, v80
    v_fma_f32 v179, |v100|, v72, v179
    v_mfma_f32_16x16x32_f16 v[108:111], a[64:67], v[144:147], v[108:111]
    v_pk_mul_f16 v129, v129, v81
    v_fma_f32 v179, |v101|, v73, v179
    v_mfma_f32_16x16x32_f16 v[220:223], v[160:163], v[80:83], 0
    v_pk_mul_f16 v130, v130, v82
    v_fma_f32 v179, |v102|, v74, v179
    v_mfma_f32_16x16x32_f16 v[220:223], v[164:167], v[84:87], v[220:223]
    v_pk_mul_f16 v131, v131, v83
    v_fma_f32 v179, |v103|, v75, v179
    v_mfma_f32_16x16x32_f16 v[220:223], v[168:171], v[88:91], v[220:223]
    v_pk_mul_f16 v132, v132, v84
    v_fma_f32 v179, |v104|, v68, v179
    v_mfma_f32_16x16x32_f16 v[220:223], v[172:175], v[92:95], v[220:223]
    v_pk_mul_f16 v133, v133, v85
    v_fma_f32 v179, |v105|, v69, v179
    v_mfma_f32_16x16x32_f16 v[224:227], v[172:175], v[216:219], 0
    v_pk_mul_f16 v134, v134, v86
    v_fma_f32 v179, |v106|, v70, v179
    v_mfma_f32_16x16x32_f16 v[224:227], v[168:171], v[212:215], v[224:227]
    v_pk_mul_f16 v135, v135, v87
    v_fma_f32 v179, |v107|, v71, v179
    v_mfma_f32_16x16x32_f16 v[224:227], v[164:167], v[208:211], v[224:227]
    v_pk_mul_f16 v136, v136, v88
    v_pk_mul_f16 v137, v137, v89
    v_mfma_f32_16x16x32_f16 v[224:227], v[160:163], v[204:207], v[224:227]
    ds_read_b128 v[172:175], v245 offset:9408
    ds_read_b128 v[168:171], v245 offset:9344
    v_mfma_f32_16x16x32_f16 v[112:115], a[48:51], v[144:147], v[28:31]
    ds_read_b128 v[164:167], v245 offset:9280
    ds_read_b128 v[160:163], v245 offset:9216
    v_mfma_f32_16x16x32_f16 v[112:115], a[52:55], v[148:151], v[112:115]
    v_pk_mul_f16 v138, v138, v90
    v_pk_mul_f16 v139, v139, v91
    v_mfma_f32_16x16x32_f16 v[112:115], a[56:59], v[152:155], v[112:115]
    ds_write_b128 v238, v[220:223] offset:4608
    v_mfma_f32_16x16x32_f16 v[112:115], a[60:63], v[156:159], v[112:115]
    ds_write_b128 v238, v[224:227] offset:6912
    v_mfma_f32_16x16x32_f16 v[116:119], a[44:47], v[156:159], v[24:27]
    v_pk_mul_f16 v140, v140, v92
    v_fma_f32 v179, |v108|, v64, v179
    v_mfma_f32_16x16x32_f16 v[116:119], a[40:43], v[152:155], v[116:119]
    v_pk_mul_f16 v141, v141, v93
    v_fma_f32 v179, |v109|, v65, v179
    v_mfma_f32_16x16x32_f16 v[116:119], a[36:39], v[148:151], v[116:119]
    v_pk_mul_f16 v142, v142, v94
    v_fma_f32 v179, |v110|, v66, v179
    v_mfma_f32_16x16x32_f16 v[116:119], a[32:35], v[144:147], v[116:119]
    v_pk_mul_f16 v143, v143, v95
    v_fma_f32 v179, |v111|, v67, v179
    v_mfma_f32_16x16x32_f16 v[120:123], a[16:19], v[144:147], v[20:23]
    v_add_u32_sdwa v234, v234, s5 dst_sel:DWORD dst_unused:UNUSED_PAD src0_sel:WORD_0 src1_sel:DWORD
    v_fma_f32 v179, |v112|, v60, v179
    v_mfma_f32_16x16x32_f16 v[120:123], a[20:23], v[148:151], v[120:123]
    s_waitcnt lgkmcnt(2)
    v_pk_mul_f16 v160, v160, v204
    v_fma_f32 v179, |v113|, v61, v179
    v_mfma_f32_16x16x32_f16 v[120:123], a[24:27], v[152:155], v[120:123]
    v_pk_mul_f16 v161, v161, v205
    v_fma_f32 v179, |v114|, v62, v179
    v_mfma_f32_16x16x32_f16 v[120:123], a[28:31], v[156:159], v[120:123]
    v_pk_mul_f16 v162, v162, v206
    v_fma_f32 v179, |v115|, v63, v179
    v_mfma_f32_16x16x32_f16 v[124:127], a[12:15], v[156:159], v[16:19]
    v_pk_mul_f16 v163, v163, v207
    v_fma_f32 v179, |v116|, v56, v179
    v_mfma_f32_16x16x32_f16 v[124:127], a[8:11], v[152:155], v[124:127]
    v_pk_mul_f16 v164, v164, v208
    v_fma_f32 v179, |v117|, v57, v179
    v_mfma_f32_16x16x32_f16 v[124:127], a[4:7], v[148:151], v[124:127]
    v_pk_mul_f16 v165, v165, v209
    v_fma_f32 v179, |v118|, v58, v179
    v_mfma_f32_16x16x32_f16 v[124:127], a[0:3], v[144:147], v[124:127]
    v_pk_mul_f16 v166, v166, v210
    v_fma_f32 v179, |v119|, v59, v179
    v_mfma_f32_16x16x32_f16 v[96:99], a[0:3], v[128:131], v[16:19]
    ds_read_b128 v[156:159], v245 offset:6240
    v_fma_f32 v179, |v120|, v52, v179
    v_mfma_f32_16x16x32_f16 v[96:99], a[4:7], v[132:135], v[96:99]
    ds_read_b128 v[152:155], v245 offset:6176
    v_fma_f32 v179, |v121|, v53, v179
    v_mfma_f32_16x16x32_f16 v[96:99], a[8:11], v[136:139], v[96:99]
    ds_read_b128 v[148:151], v245 offset:6112
    v_fma_f32 v179, |v122|, v54, v179
    v_mfma_f32_16x16x32_f16 v[96:99], a[12:15], v[140:143], v[96:99]
    ds_read_b128 v[144:147], v245 offset:6048
    v_fma_f32 v179, |v123|, v55, v179
    v_mfma_f32_16x16x32_f16 v[100:103], a[28:31], v[140:143], v[20:23]
    v_pk_mul_f16 v167, v167, v211
    v_fma_f32 v179, |v124|, v48, v179
    v_mfma_f32_16x16x32_f16 v[100:103], a[24:27], v[136:139], v[100:103]
    v_pk_mul_f16 v168, v168, v212
    v_fma_f32 v179, |v125|, v49, v179
    v_mfma_f32_16x16x32_f16 v[100:103], a[20:23], v[132:135], v[100:103]
    v_pk_mul_f16 v169, v169, v213
    v_fma_f32 v179, |v126|, v50, v179
    v_mfma_f32_16x16x32_f16 v[100:103], a[16:19], v[128:131], v[100:103]
    v_pk_mul_f16 v170, v170, v214
    v_fma_f32 v179, |v127|, v51, v179
    v_mfma_f32_16x16x32_f16 v[104:107], a[32:35], v[128:131], v[24:27]
    v_pk_mul_f16 v171, v171, v215
    v_mul_f32 v180, |v96|, v48
    v_mfma_f32_16x16x32_f16 v[104:107], a[36:39], v[132:135], v[104:107]
    v_pk_mul_f16 v172, v172, v216
    v_fma_f32 v180, |v97|, v49, v180
    v_mfma_f32_16x16x32_f16 v[104:107], a[40:43], v[136:139], v[104:107]
    v_pk_mul_f16 v173, v173, v217
    v_fma_f32 v180, |v98|, v50, v180
    v_mfma_f32_16x16x32_f16 v[104:107], a[44:47], v[140:143], v[104:107]
    v_pk_mul_f16 v174, v174, v218
    v_fma_f32 v180, |v99|, v51, v180
    v_mfma_f32_16x16x32_f16 v[108:111], a[60:63], v[140:143], v[28:31]
    v_pk_mul_f16 v175, v175, v219
    v_fma_f32 v180, |v100|, v52, v180
    v_mfma_f32_16x16x32_f16 v[108:111], a[56:59], v[136:139], v[108:111]
    s_waitcnt lgkmcnt(0)
    v_pk_mul_f16 v144, v144, v80
    v_fma_f32 v180, |v101|, v53, v180
    v_mfma_f32_16x16x32_f16 v[108:111], a[52:55], v[132:135], v[108:111]
    v_pk_mul_f16 v145, v145, v81
    v_fma_f32 v180, |v102|, v54, v180
    v_mfma_f32_16x16x32_f16 v[108:111], a[48:51], v[128:131], v[108:111]
    v_pk_mul_f16 v146, v146, v82
    v_fma_f32 v180, |v103|, v55, v180
    v_mfma_f32_16x16x32_f16 v[228:231], v[160:163], v[204:207], 0
    v_pk_mul_f16 v147, v147, v83
    v_fma_f32 v180, |v104|, v56, v180
    v_mfma_f32_16x16x32_f16 v[228:231], v[164:167], v[208:211], v[228:231]
    v_pk_mul_f16 v148, v148, v84
    v_fma_f32 v180, |v105|, v57, v180
    v_mfma_f32_16x16x32_f16 v[228:231], v[168:171], v[212:215], v[228:231]
    v_pk_mul_f16 v149, v149, v85
    v_fma_f32 v180, |v106|, v58, v180
    v_mfma_f32_16x16x32_f16 v[228:231], v[172:175], v[216:219], v[228:231]
    ds_read_b128 v[172:175], v245 offset:9696
    v_fma_f32 v180, |v107|, v59, v180
    v_mfma_f32_16x16x32_f16 v[112:115], a[64:67], v[128:131], v[32:35]
    ds_read_b128 v[168:171], v245 offset:9632
    ds_read_b128 v[164:167], v245 offset:9568
    v_mfma_f32_16x16x32_f16 v[112:115], a[68:71], v[132:135], v[112:115]
    ds_read_b128 v[160:163], v245 offset:9504
    v_pk_mul_f16 v150, v150, v86
    v_mfma_f32_16x16x32_f16 v[112:115], a[72:75], v[136:139], v[112:115]
    ds_write_b128 v238, v[228:231] offset:2368
    v_mfma_f32_16x16x32_f16 v[112:115], a[76:79], v[140:143], v[112:115]
    v_pk_mul_f16 v151, v151, v87
    v_fma_f32 v180, |v108|, v60, v180
    v_mfma_f32_16x16x32_f16 v[116:119], a[92:95], v[140:143], v[36:39]
    v_pk_mul_f16 v152, v152, v88
    v_fma_f32 v180, |v109|, v61, v180
    v_mfma_f32_16x16x32_f16 v[116:119], a[88:91], v[136:139], v[116:119]
    v_pk_mul_f16 v153, v153, v89
    v_fma_f32 v180, |v110|, v62, v180
    v_mfma_f32_16x16x32_f16 v[116:119], a[84:87], v[132:135], v[116:119]
    v_pk_mul_f16 v154, v154, v90
    v_fma_f32 v180, |v111|, v63, v180
    v_mfma_f32_16x16x32_f16 v[116:119], a[80:83], v[128:131], v[116:119]
    v_pk_mul_f16 v155, v155, v91
    v_fma_f32 v180, |v112|, v64, v180
    v_mfma_f32_16x16x32_f16 v[120:123], a[96:99], v[128:131], v[40:43]
    v_pk_mul_f16 v156, v156, v92
    v_fma_f32 v180, |v113|, v65, v180
    v_mfma_f32_16x16x32_f16 v[120:123], a[100:103], v[132:135], v[120:123]
    v_pk_mul_f16 v157, v157, v93
    v_fma_f32 v180, |v114|, v66, v180
    v_mfma_f32_16x16x32_f16 v[120:123], a[104:107], v[136:139], v[120:123]
    s_waitcnt lgkmcnt(1)
    v_pk_mul_f16 v160, v160, v204
    v_fma_f32 v180, |v115|, v67, v180
    v_mfma_f32_16x16x32_f16 v[120:123], a[108:111], v[140:143], v[120:123]
    v_pk_mul_f16 v161, v161, v205
    v_fma_f32 v180, |v116|, v68, v180
    v_mfma_f32_16x16x32_f16 v[124:127], a[124:127], v[140:143], v[44:47]
    v_pk_mul_f16 v162, v162, v206
    v_fma_f32 v180, |v117|, v69, v180
    v_mfma_f32_16x16x32_f16 v[124:127], a[120:123], v[136:139], v[124:127]
    v_pk_mul_f16 v158, v158, v94
    v_fma_f32 v180, |v118|, v70, v180
    v_mfma_f32_16x16x32_f16 v[124:127], a[116:119], v[132:135], v[124:127]
    v_pk_mul_f16 v159, v159, v95
    v_fma_f32 v180, |v119|, v71, v180
    v_mfma_f32_16x16x32_f16 v[124:127], a[112:115], v[128:131], v[124:127]
    v_pk_mul_f16 v163, v163, v207
    v_fma_f32 v180, |v120|, v72, v180
    v_mfma_f32_16x16x32_f16 v[96:99], a[112:115], v[144:147], v[44:47]
    ds_read_b128 v[140:143], v245 offset:6528
    v_fma_f32 v180, |v121|, v73, v180
    v_mfma_f32_16x16x32_f16 v[96:99], a[116:119], v[148:151], v[96:99]
    ds_read_b128 v[136:139], v245 offset:6464
    v_fma_f32 v180, |v122|, v74, v180
    v_mfma_f32_16x16x32_f16 v[96:99], a[120:123], v[152:155], v[96:99]
    ds_read_b128 v[132:135], v245 offset:6400
    v_fma_f32 v180, |v123|, v75, v180
    v_mfma_f32_16x16x32_f16 v[96:99], a[124:127], v[156:159], v[96:99]
    ds_read_b128 v[128:131], v245 offset:6336
    v_fma_f32 v180, |v124|, v76, v180
    v_mfma_f32_16x16x32_f16 v[100:103], a[108:111], v[156:159], v[40:43]
    v_pk_mul_f16 v164, v164, v208
    v_fma_f32 v180, |v125|, v77, v180
    v_mfma_f32_16x16x32_f16 v[100:103], a[104:107], v[152:155], v[100:103]
    v_pk_mul_f16 v165, v165, v209
    v_fma_f32 v180, |v126|, v78, v180
    v_mfma_f32_16x16x32_f16 v[100:103], a[100:103], v[148:151], v[100:103]
    v_pk_mul_f16 v166, v166, v210
    v_fma_f32 v180, |v127|, v79, v180
    v_mfma_f32_16x16x32_f16 v[100:103], a[96:99], v[144:147], v[100:103]
    v_pk_mul_f16 v167, v167, v211
    v_mul_f32 v181, |v96|, v76
    v_mfma_f32_16x16x32_f16 v[104:107], a[80:83], v[144:147], v[36:39]
    v_pk_mul_f16 v168, v168, v212
    v_fma_f32 v181, |v97|, v77, v181
    v_mfma_f32_16x16x32_f16 v[104:107], a[84:87], v[148:151], v[104:107]
    v_pk_mul_f16 v169, v169, v213
    v_fma_f32 v181, |v98|, v78, v181
    v_mfma_f32_16x16x32_f16 v[104:107], a[88:91], v[152:155], v[104:107]
    v_pk_mul_f16 v170, v170, v214
    v_fma_f32 v181, |v99|, v79, v181
    v_mfma_f32_16x16x32_f16 v[104:107], a[92:95], v[156:159], v[104:107]
    v_pk_mul_f16 v171, v171, v215
    v_fma_f32 v181, |v100|, v72, v181
    v_mfma_f32_16x16x32_f16 v[108:111], a[76:79], v[156:159], v[32:35]
    v_pk_mul_f16 v172, v172, v216
    v_fma_f32 v181, |v101|, v73, v181
    v_mfma_f32_16x16x32_f16 v[108:111], a[72:75], v[152:155], v[108:111]
    v_pk_mul_f16 v173, v173, v217
    v_fma_f32 v181, |v102|, v74, v181
    v_mfma_f32_16x16x32_f16 v[108:111], a[68:71], v[148:151], v[108:111]
    v_pk_mul_f16 v174, v174, v218
    v_fma_f32 v181, |v103|, v75, v181
    v_mfma_f32_16x16x32_f16 v[108:111], a[64:67], v[144:147], v[108:111]
    s_waitcnt lgkmcnt(0)
    v_pk_mul_f16 v128, v128, v80
    v_fma_f32 v181, |v104|, v68, v181
    v_mfma_f32_16x16x32_f16 v[112:115], a[48:51], v[144:147], v[28:31]
    v_pk_mul_f16 v129, v129, v81
    v_fma_f32 v181, |v105|, v69, v181
    v_mfma_f32_16x16x32_f16 v[112:115], a[52:55], v[148:151], v[112:115]
    v_pk_mul_f16 v130, v130, v82
    v_fma_f32 v181, |v106|, v70, v181
    v_mfma_f32_16x16x32_f16 v[112:115], a[56:59], v[152:155], v[112:115]
    v_pk_mul_f16 v131, v131, v83
    v_fma_f32 v181, |v107|, v71, v181
    v_mfma_f32_16x16x32_f16 v[112:115], a[60:63], v[156:159], v[112:115]
    v_pk_mul_f16 v132, v132, v84
    v_fma_f32 v181, |v108|, v64, v181
    v_mfma_f32_16x16x32_f16 v[116:119], a[44:47], v[156:159], v[24:27]
    v_pk_mul_f16 v133, v133, v85
    v_fma_f32 v181, |v109|, v65, v181
    v_mfma_f32_16x16x32_f16 v[116:119], a[40:43], v[152:155], v[116:119]
    v_pk_mul_f16 v134, v134, v86
    v_fma_f32 v181, |v110|, v66, v181
    v_mfma_f32_16x16x32_f16 v[116:119], a[36:39], v[148:151], v[116:119]
    v_pk_mul_f16 v135, v135, v87
    v_fma_f32 v181, |v111|, v67, v181
    v_mfma_f32_16x16x32_f16 v[116:119], a[32:35], v[144:147], v[116:119]
    v_pk_mul_f16 v136, v136, v88
    v_fma_f32 v181, |v112|, v60, v181
    v_mfma_f32_16x16x32_f16 v[120:123], a[16:19], v[144:147], v[20:23]
    v_pk_mul_f16 v137, v137, v89
    v_fma_f32 v181, |v113|, v61, v181
    v_mfma_f32_16x16x32_f16 v[120:123], a[20:23], v[148:151], v[120:123]
    v_pk_mul_f16 v138, v138, v90
    v_fma_f32 v181, |v114|, v62, v181
    v_mfma_f32_16x16x32_f16 v[120:123], a[24:27], v[152:155], v[120:123]
    v_pk_mul_f16 v139, v139, v91
    v_fma_f32 v181, |v115|, v63, v181
    v_mfma_f32_16x16x32_f16 v[120:123], a[28:31], v[156:159], v[120:123]
    v_pk_mul_f16 v140, v140, v92
    v_fma_f32 v181, |v116|, v56, v181
    v_mfma_f32_16x16x32_f16 v[124:127], a[12:15], v[156:159], v[16:19]
    v_pk_mul_f16 v141, v141, v93
    v_fma_f32 v181, |v117|, v57, v181
    v_mfma_f32_16x16x32_f16 v[124:127], a[8:11], v[152:155], v[124:127]
    v_pk_mul_f16 v142, v142, v94
    v_fma_f32 v181, |v118|, v58, v181
    v_mfma_f32_16x16x32_f16 v[124:127], a[4:7], v[148:151], v[124:127]
    v_pk_mul_f16 v143, v143, v95
    v_fma_f32 v181, |v119|, v59, v181
    v_mfma_f32_16x16x32_f16 v[124:127], a[0:3], v[144:147], v[124:127]
    v_pk_mul_f16 v175, v175, v219
    v_fma_f32 v181, |v120|, v52, v181
    v_mfma_f32_16x16x32_f16 v[96:99], a[0:3], v[128:131], v[16:19]
    ds_read_b128 v[156:159], v245 offset:6816
    v_fma_f32 v181, |v121|, v53, v181
    v_mfma_f32_16x16x32_f16 v[96:99], a[4:7], v[132:135], v[96:99]
    ds_read_b128 v[152:155], v245 offset:6752
    v_fma_f32 v181, |v122|, v54, v181
    v_mfma_f32_16x16x32_f16 v[96:99], a[8:11], v[136:139], v[96:99]
    ds_read_b128 v[148:151], v245 offset:6688
    v_fma_f32 v181, |v123|, v55, v181
    v_mfma_f32_16x16x32_f16 v[96:99], a[12:15], v[140:143], v[96:99]
    ds_read_b128 v[144:147], v245 offset:6624
    v_fma_f32 v181, |v124|, v48, v181
    v_mfma_f32_16x16x32_f16 v[228:231], v[160:163], v[204:207], 0
    v_add_u32_sdwa v242, v235, s5 dst_sel:DWORD dst_unused:UNUSED_PAD src0_sel:WORD_1 src1_sel:DWORD
    v_fma_f32 v181, |v125|, v49, v181
    v_mfma_f32_16x16x32_f16 v[228:231], v[164:167], v[208:211], v[228:231]
    v_add_u32_sdwa v235, v235, s5 dst_sel:DWORD dst_unused:UNUSED_PAD src0_sel:WORD_0 src1_sel:DWORD
    v_fma_f32 v181, |v126|, v50, v181
    v_mfma_f32_16x16x32_f16 v[228:231], v[168:171], v[212:215], v[228:231]
    v_add_u32_sdwa v243, v236, s5 dst_sel:DWORD dst_unused:UNUSED_PAD src0_sel:WORD_1 src1_sel:DWORD
    v_fma_f32 v181, |v127|, v51, v181
    v_mfma_f32_16x16x32_f16 v[228:231], v[172:175], v[216:219], v[228:231]
    v_add_u32_sdwa v236, v236, s5 dst_sel:DWORD dst_unused:UNUSED_PAD src0_sel:WORD_0 src1_sel:DWORD
    v_add_u32_sdwa v244, v237, s5 dst_sel:DWORD dst_unused:UNUSED_PAD src0_sel:WORD_1 src1_sel:DWORD
    v_mfma_f32_16x16x32_f16 v[100:103], a[28:31], v[140:143], v[20:23]
    v_add_u32_sdwa v237, v237, s5 dst_sel:DWORD dst_unused:UNUSED_PAD src0_sel:WORD_0 src1_sel:DWORD
    v_mfma_f32_16x16x32_f16 v[100:103], a[24:27], v[136:139], v[100:103]
    v_permlane32_swap_b32 v184, v186
    v_mfma_f32_16x16x32_f16 v[100:103], a[20:23], v[132:135], v[100:103]
    v_permlane32_swap_b32 v185, v187
    v_mfma_f32_16x16x32_f16 v[100:103], a[16:19], v[128:131], v[100:103]
    ds_write_b128 v238, v[228:231] offset:6976
    v_mfma_f32_16x16x32_f16 v[104:107], a[32:35], v[128:131], v[24:27]
    ds_read2st64_b32 v[230:231], v237 offset0:0 offset1:18
    v_mul_f32 v182, |v96|, v48
    v_mfma_f32_16x16x32_f16 v[104:107], a[36:39], v[132:135], v[104:107]
    ds_read2st64_b32 v[228:229], v236 offset0:0 offset1:18
    v_fma_f32 v182, |v97|, v49, v182
    v_mfma_f32_16x16x32_f16 v[104:107], a[40:43], v[136:139], v[104:107]
    ds_read2st64_b32 v[222:223], v233 offset0:0 offset1:18
    v_fma_f32 v182, |v98|, v50, v182
    v_mfma_f32_16x16x32_f16 v[104:107], a[44:47], v[140:143], v[104:107]
    ds_read2st64_b32 v[220:221], v232 offset0:0 offset1:18
    v_fma_f32 v182, |v99|, v51, v182
    v_mfma_f32_16x16x32_f16 v[108:111], a[60:63], v[140:143], v[28:31]
    ds_read2st64_b32 v[226:227], v235 offset0:0 offset1:18
    v_fma_f32 v182, |v100|, v52, v182
    v_mfma_f32_16x16x32_f16 v[108:111], a[56:59], v[136:139], v[108:111]
    ds_read2st64_b32 v[224:225], v234 offset0:0 offset1:18
    v_fma_f32 v182, |v101|, v53, v182
    v_mfma_f32_16x16x32_f16 v[108:111], a[52:55], v[132:135], v[108:111]
    s_waitcnt lgkmcnt(7)
    v_pk_mul_f16 v144, v144, v80
    v_fma_f32 v182, |v102|, v54, v182
    v_mfma_f32_16x16x32_f16 v[108:111], a[48:51], v[128:131], v[108:111]
    v_pk_mul_f16 v145, v145, v81
    v_fma_f32 v182, |v103|, v55, v182
    v_mfma_f32_16x16x32_f16 v[112:115], a[64:67], v[128:131], v[32:35]
    v_pk_mul_f16 v146, v146, v82
    v_fma_f32 v182, |v104|, v56, v182
    v_mfma_f32_16x16x32_f16 v[112:115], a[68:71], v[132:135], v[112:115]
    v_pk_mul_f16 v147, v147, v83
    v_fma_f32 v182, |v105|, v57, v182
    v_mfma_f32_16x16x32_f16 v[112:115], a[72:75], v[136:139], v[112:115]
    v_pk_mul_f16 v148, v148, v84
    v_fma_f32 v182, |v106|, v58, v182
    v_mfma_f32_16x16x32_f16 v[112:115], a[76:79], v[140:143], v[112:115]
    v_pk_mul_f16 v149, v149, v85
    v_fma_f32 v182, |v107|, v59, v182
    v_mfma_f32_16x16x32_f16 v[116:119], a[92:95], v[140:143], v[36:39]
    v_pk_mul_f16 v150, v150, v86
    v_fma_f32 v182, |v108|, v60, v182
    v_mfma_f32_16x16x32_f16 v[116:119], a[88:91], v[136:139], v[116:119]
    v_pk_mul_f16 v151, v151, v87
    v_fma_f32 v182, |v109|, v61, v182
    v_mfma_f32_16x16x32_f16 v[116:119], a[84:87], v[132:135], v[116:119]
    v_pk_mul_f16 v152, v152, v88
    v_fma_f32 v182, |v110|, v62, v182
    v_mfma_f32_16x16x32_f16 v[116:119], a[80:83], v[128:131], v[116:119]
    v_pk_mul_f16 v153, v153, v89
    v_fma_f32 v182, |v111|, v63, v182
    v_mfma_f32_16x16x32_f16 v[120:123], a[96:99], v[128:131], v[40:43]
    v_pk_mul_f16 v154, v154, v90
    v_fma_f32 v182, |v112|, v64, v182
    v_mfma_f32_16x16x32_f16 v[120:123], a[100:103], v[132:135], v[120:123]
    v_pk_mul_f16 v155, v155, v91
    v_fma_f32 v182, |v113|, v65, v182
    v_mfma_f32_16x16x32_f16 v[120:123], a[104:107], v[136:139], v[120:123]
    v_pk_mul_f16 v156, v156, v92
    v_fma_f32 v182, |v114|, v66, v182
    v_mfma_f32_16x16x32_f16 v[120:123], a[108:111], v[140:143], v[120:123]
    v_pk_mul_f16 v157, v157, v93
    v_fma_f32 v182, |v115|, v67, v182
    v_mfma_f32_16x16x32_f16 v[124:127], a[124:127], v[140:143], v[44:47]
    v_pk_mul_f16 v158, v158, v94
    v_fma_f32 v182, |v116|, v68, v182
    v_mfma_f32_16x16x32_f16 v[124:127], a[120:123], v[136:139], v[124:127]
    v_pk_mul_f16 v159, v159, v95
    v_fma_f32 v182, |v117|, v69, v182
    v_mfma_f32_16x16x32_f16 v[124:127], a[116:119], v[132:135], v[124:127]
    v_add_f32 v184, v184, v186
    v_fma_f32 v182, |v118|, v70, v182
    v_mfma_f32_16x16x32_f16 v[124:127], a[112:115], v[128:131], v[124:127]
    v_add_f32 v185, v185, v187
    v_fma_f32 v182, |v119|, v71, v182
    v_mfma_f32_16x16x32_f16 v[96:99], a[112:115], v[144:147], v[44:47]
    ds_read_b128 v[140:143], v245 offset:7104
    v_fma_f32 v182, |v120|, v72, v182
    v_mfma_f32_16x16x32_f16 v[96:99], a[116:119], v[148:151], v[96:99]
    ds_read_b128 v[136:139], v245 offset:7040
    v_fma_f32 v182, |v121|, v73, v182
    v_mfma_f32_16x16x32_f16 v[96:99], a[120:123], v[152:155], v[96:99]
    ds_read_b128 v[132:135], v245 offset:6976
    v_fma_f32 v182, |v122|, v74, v182
    v_mfma_f32_16x16x32_f16 v[96:99], a[124:127], v[156:159], v[96:99]
    ds_read_b128 v[128:131], v245 offset:6912
    v_fma_f32 v182, |v123|, v75, v182
    v_mfma_f32_16x16x32_f16 v[100:103], a[108:111], v[156:159], v[40:43]
    v_permlane16_swap_b32 v184, v185
    v_mfma_f32_16x16x32_f16 v[100:103], a[104:107], v[152:155], v[100:103]
    v_add_f32 v184, v184, v185
    v_fma_f32 v182, |v124|, v76, v182
    v_mfma_f32_16x16x32_f16 v[100:103], a[100:103], v[148:151], v[100:103]
    s_waitcnt lgkmcnt(4)
    v_fma_f32 v184, v224, s12, v184
    v_fma_f32 v182, |v125|, v77, v182
    v_mfma_f32_16x16x32_f16 v[100:103], a[96:99], v[144:147], v[100:103]
    v_permlane32_swap_b32 v188, v190
    v_mfma_f32_16x16x32_f16 v[104:107], a[80:83], v[144:147], v[36:39]
    v_permlane32_swap_b32 v189, v191
    v_mfma_f32_16x16x32_f16 v[104:107], a[84:87], v[148:151], v[104:107]
    v_add_f32 v188, v188, v190
    v_fma_f32 v182, |v126|, v78, v182
    v_mfma_f32_16x16x32_f16 v[104:107], a[88:91], v[152:155], v[104:107]
    v_add_f32 v189, v189, v191
    v_fma_f32 v182, |v127|, v79, v182
    v_mfma_f32_16x16x32_f16 v[104:107], a[92:95], v[156:159], v[104:107]
    v_permlane16_swap_b32 v188, v189
    v_mfma_f32_16x16x32_f16 v[108:111], a[76:79], v[156:159], v[32:35]
    s_waitcnt lgkmcnt(0)
    v_pk_mul_f16 v128, v128, v80
    v_mul_f32 v183, |v96|, v76
    v_mfma_f32_16x16x32_f16 v[108:111], a[72:75], v[152:155], v[108:111]
    v_pk_mul_f16 v129, v129, v81
    v_fma_f32 v183, |v97|, v77, v183
    v_mfma_f32_16x16x32_f16 v[108:111], a[68:71], v[148:151], v[108:111]
    v_pk_mul_f16 v130, v130, v82
    v_fma_f32 v183, |v98|, v78, v183
    v_mfma_f32_16x16x32_f16 v[108:111], a[64:67], v[144:147], v[108:111]
    v_pk_mul_f16 v131, v131, v83
    v_fma_f32 v183, |v99|, v79, v183
    v_mfma_f32_16x16x32_f16 v[112:115], a[48:51], v[144:147], v[28:31]
    v_pk_mul_f16 v132, v132, v84
    v_fma_f32 v183, |v100|, v72, v183
    v_mfma_f32_16x16x32_f16 v[112:115], a[52:55], v[148:151], v[112:115]
    v_pk_mul_f16 v133, v133, v85
    v_fma_f32 v183, |v101|, v73, v183
    v_mfma_f32_16x16x32_f16 v[112:115], a[56:59], v[152:155], v[112:115]
    v_pk_mul_f16 v134, v134, v86
    v_fma_f32 v183, |v102|, v74, v183
    v_mfma_f32_16x16x32_f16 v[112:115], a[60:63], v[156:159], v[112:115]
    v_pk_mul_f16 v135, v135, v87
    v_fma_f32 v183, |v103|, v75, v183
    v_mfma_f32_16x16x32_f16 v[116:119], a[44:47], v[156:159], v[24:27]
    v_pk_mul_f16 v136, v136, v88
    v_fma_f32 v183, |v104|, v68, v183
    v_mfma_f32_16x16x32_f16 v[116:119], a[40:43], v[152:155], v[116:119]
    v_pk_mul_f16 v137, v137, v89
    v_fma_f32 v183, |v105|, v69, v183
    v_mfma_f32_16x16x32_f16 v[116:119], a[36:39], v[148:151], v[116:119]
    v_pk_mul_f16 v138, v138, v90
    v_fma_f32 v183, |v106|, v70, v183
    v_mfma_f32_16x16x32_f16 v[116:119], a[32:35], v[144:147], v[116:119]
    v_pk_mul_f16 v139, v139, v91
    v_fma_f32 v183, |v107|, v71, v183
    v_mfma_f32_16x16x32_f16 v[120:123], a[16:19], v[144:147], v[20:23]
    v_pk_mul_f16 v140, v140, v92
    v_fma_f32 v183, |v108|, v64, v183
    v_mfma_f32_16x16x32_f16 v[120:123], a[20:23], v[148:151], v[120:123]
    v_pk_mul_f16 v141, v141, v93
    v_fma_f32 v183, |v109|, v65, v183
    v_mfma_f32_16x16x32_f16 v[120:123], a[24:27], v[152:155], v[120:123]
    v_pk_mul_f16 v142, v142, v94
    v_fma_f32 v183, |v110|, v66, v183
    v_mfma_f32_16x16x32_f16 v[120:123], a[28:31], v[156:159], v[120:123]
    v_pk_mul_f16 v143, v143, v95
    v_fma_f32 v183, |v111|, v67, v183
    v_mfma_f32_16x16x32_f16 v[124:127], a[12:15], v[156:159], v[16:19]
    v_add_f32 v188, v188, v189
    v_fma_f32 v183, |v112|, v60, v183
    v_mfma_f32_16x16x32_f16 v[124:127], a[8:11], v[152:155], v[124:127]
    v_fma_f32 v188, v226, s12, v188
    v_fma_f32 v183, |v113|, v61, v183
    v_mfma_f32_16x16x32_f16 v[124:127], a[4:7], v[148:151], v[124:127]
    v_cndmask_b32 v188, v251, v188, s[36:37]
    v_fma_f32 v183, |v114|, v62, v183
    v_mfma_f32_16x16x32_f16 v[124:127], a[0:3], v[144:147], v[124:127]
    v_permlane32_swap_b32 v176, v178
    v_mfma_f32_16x16x32_f16 v[96:99], a[0:3], v[128:131], v[16:19]
    ds_read_b128 v[156:159], v245 offset:7392
    v_fma_f32 v183, |v115|, v63, v183
    v_mfma_f32_16x16x32_f16 v[96:99], a[4:7], v[132:135], v[96:99]
    ds_read_b128 v[152:155], v245 offset:7328
    v_fma_f32 v183, |v116|, v56, v183
    v_mfma_f32_16x16x32_f16 v[96:99], a[8:11], v[136:139], v[96:99]
    ds_read_b128 v[148:151], v245 offset:7264
    v_fma_f32 v183, |v117|, v57, v183
    v_mfma_f32_16x16x32_f16 v[96:99], a[12:15], v[140:143], v[96:99]
    ds_read_b128 v[144:147], v245 offset:7200
    v_fma_f32 v183, |v118|, v58, v183
    v_mfma_f32_16x16x32_f16 v[100:103], a[28:31], v[140:143], v[20:23]
    v_permlane32_swap_b32 v177, v179
    v_mfma_f32_16x16x32_f16 v[100:103], a[24:27], v[136:139], v[100:103]
    v_add_f32 v176, v176, v178
    v_fma_f32 v183, |v119|, v59, v183
    v_mfma_f32_16x16x32_f16 v[100:103], a[20:23], v[132:135], v[100:103]
    v_add_f32 v177, v177, v179
    v_fma_f32 v183, |v120|, v52, v183
    v_mfma_f32_16x16x32_f16 v[100:103], a[16:19], v[128:131], v[100:103]
    v_permlane16_swap_b32 v176, v177
    v_mfma_f32_16x16x32_f16 v[104:107], a[32:35], v[128:131], v[24:27]
    v_add_f32 v176, v176, v177
    v_fma_f32 v183, |v121|, v53, v183
    v_mfma_f32_16x16x32_f16 v[104:107], a[36:39], v[132:135], v[104:107]
    v_fma_f32 v176, v220, s12, v176
    v_fma_f32 v183, |v122|, v54, v183
    v_mfma_f32_16x16x32_f16 v[104:107], a[40:43], v[136:139], v[104:107]
    v_max3_f32 v248, v184, v188, v176
    v_fma_f32 v183, |v123|, v55, v183
    v_mfma_f32_16x16x32_f16 v[104:107], a[44:47], v[140:143], v[104:107]
    v_fma_f32 v183, |v124|, v48, v183
    v_fma_f32 v183, |v125|, v49, v183
    v_mfma_f32_16x16x32_f16 v[108:111], a[60:63], v[140:143], v[28:31]
    s_waitcnt lgkmcnt(0)
    v_pk_mul_f16 v144, v144, v80
    v_fma_f32 v183, |v126|, v50, v183
    v_mfma_f32_16x16x32_f16 v[108:111], a[56:59], v[136:139], v[108:111]
    v_pk_mul_f16 v145, v145, v81
    v_fma_f32 v183, |v127|, v51, v183
    v_mfma_f32_16x16x32_f16 v[108:111], a[52:55], v[132:135], v[108:111]
L_pad3:
    s_cbranch_execz L_hopret
    v_pk_mul_f16 v146, v146, v82
    v_mul_f32 v192, |v96|, v48
    v_mfma_f32_16x16x32_f16 v[108:111], a[48:51], v[128:131], v[108:111]
    v_pk_mul_f16 v147, v147, v83
    v_fma_f32 v192, |v97|, v49, v192
    v_mfma_f32_16x16x32_f16 v[112:115], a[64:67], v[128:131], v[32:35]
    v_pk_mul_f16 v148, v148, v84
    v_fma_f32 v192, |v98|, v50, v192
    v_mfma_f32_16x16x32_f16 v[112:115], a[68:71], v[132:135], v[112:115]
    v_pk_mul_f16 v149, v149, v85
    v_fma_f32 v192, |v99|, v51, v192
    v_mfma_f32_16x16x32_f16 v[112:115], a[72:75], v[136:139], v[112:115]
    v_pk_mul_f16 v150, v150, v86
    v_fma_f32 v192, |v100|, v52, v192
    v_mfma_f32_16x16x32_f16 v[112:115], a[76:79], v[140:143], v[112:115]
    v_pk_mul_f16 v151, v151, v87
    v_fma_f32 v192, |v101|, v53, v192
    v_mfma_f32_16x16x32_f16 v[116:119], a[92:95], v[140:143], v[36:39]
    v_pk_mul_f16 v152, v152, v88
    v_fma_f32 v192, |v102|, v54, v192
    v_mfma_f32_16x16x32_f16 v[116:119], a[88:91], v[136:139], v[116:119]
    v_pk_mul_f16 v153, v153, v89
    v_fma_f32 v192, |v103|, v55, v192
    v_mfma_f32_16x16x32_f16 v[116:119], a[84:87], v[132:135], v[116:119]
    v_pk_mul_f16 v154, v154, v90
    v_fma_f32 v192, |v104|, v56, v192
    v_mfma_f32_16x16x32_f16 v[116:119], a[80:83], v[128:131], v[116:119]
    v_pk_mul_f16 v155, v155, v91
    v_fma_f32 v192, |v105|, v57, v192
    v_mfma_f32_16x16x32_f16 v[120:123], a[96:99], v[128:131], v[40:43]
    v_pk_mul_f16 v156, v156, v92
    v_fma_f32 v192, |v106|, v58, v192
    v_mfma_f32_16x16x32_f16 v[120:123], a[100:103], v[132:135], v[120:123]
    v_pk_mul_f16 v157, v157, v93
    v_fma_f32 v192, |v107|, v59, v192
    v_mfma_f32_16x16x32_f16 v[120:123], a[104:107], v[136:139], v[120:123]
    v_pk_mul_f16 v158, v158, v94
    v_fma_f32 v192, |v108|, v60, v192
    v_mfma_f32_16x16x32_f16 v[120:123], a[108:111], v[140:143], v[120:123]
    v_pk_mul_f16 v159, v159, v95
    v_fma_f32 v192, |v109|, v61, v192
    v_mfma_f32_16x16x32_f16 v[124:127], a[124:127], v[140:143], v[44:47]
    ds_read_b128 v[216:219], v239 offset:4800
    v_fma_f32 v192, |v110|, v62, v192
    v_mfma_f32_16x16x32_f16 v[124:127], a[120:123], v[136:139], v[124:127]
    ds_read_b128 v[212:215], v239 offset:4736
    v_fma_f32 v192, |v111|, v63, v192
    v_mfma_f32_16x16x32_f16 v[124:127], a[116:119], v[132:135], v[124:127]
    ds_read_b128 v[208:211], v239 offset:4672
    v_fma_f32 v192, |v112|, v64, v192
    v_mfma_f32_16x16x32_f16 v[124:127], a[112:115], v[128:131], v[124:127]
    ds_read_b128 v[204:207], v239 offset:4608
    v_fma_f32 v192, |v113|, v65, v192
    v_mfma_f32_16x16x32_f16 v[96:99], a[112:115], v[144:147], v[44:47]
    ds_read_b128 v[140:143], v240 offset:4800
    v_fma_f32 v192, |v114|, v66, v192
    v_mfma_f32_16x16x32_f16 v[96:99], a[116:119], v[148:151], v[96:99]
    ds_read_b128 v[136:139], v240 offset:4736
    v_fma_f32 v192, |v115|, v67, v192
    v_mfma_f32_16x16x32_f16 v[96:99], a[120:123], v[152:155], v[96:99]
    ds_read_b128 v[132:135], v240 offset:4672
    v_fma_f32 v192, |v116|, v68, v192
    v_mfma_f32_16x16x32_f16 v[96:99], a[124:127], v[156:159], v[96:99]
    ds_read_b128 v[128:131], v240 offset:4608
    v_fma_f32 v192, |v117|, v69, v192
    v_mfma_f32_16x16x32_f16 v[100:103], a[108:111], v[156:159], v[40:43]
    v_permlane32_swap_b32 v180, v182
    v_mfma_f32_16x16x32_f16 v[100:103], a[104:107], v[152:155], v[100:103]
    v_permlane32_swap_b32 v181, v183
    v_mfma_f32_16x16x32_f16 v[100:103], a[100:103], v[148:151], v[100:103]
    v_add_f32 v180, v180, v182
    v_fma_f32 v192, |v118|, v70, v192
    v_mfma_f32_16x16x32_f16 v[100:103], a[96:99], v[144:147], v[100:103]
    v_add_f32 v181, v181, v183
    v_fma_f32 v192, |v119|, v71, v192
    v_mfma_f32_16x16x32_f16 v[104:107], a[80:83], v[144:147], v[36:39]
    v_permlane16_swap_b32 v180, v181
    v_fma_f32 v192, |v120|, v72, v192
    v_mfma_f32_16x16x32_f16 v[104:107], a[84:87], v[148:151], v[104:107]
    v_add_f32 v180, v180, v181
    v_fma_f32 v192, |v121|, v73, v192
    v_mfma_f32_16x16x32_f16 v[104:107], a[88:91], v[152:155], v[104:107]
    v_fma_f32 v180, v222, s12, v180
    v_fma_f32 v192, |v122|, v74, v192
    v_mfma_f32_16x16x32_f16 v[104:107], a[92:95], v[156:159], v[104:107]
    v_fma_f32 v192, |v123|, v75, v192
    v_fma_f32 v192, |v124|, v76, v192
    v_mfma_f32_16x16x32_f16 v[108:111], a[76:79], v[156:159], v[32:35]
    s_waitcnt lgkmcnt(0)
    v_pk_mul_f16 v128, v128, v204
    v_fma_f32 v192, |v125|, v77, v192
    v_mfma_f32_16x16x32_f16 v[108:111], a[72:75], v[152:155], v[108:111]
    v_pk_mul_f16 v129, v129, v205
    v_fma_f32 v192, |v126|, v78, v192
    v_mfma_f32_16x16x32_f16 v[108:111], a[68:71], v[148:151], v[108:111]
    v_pk_mul_f16 v130, v130, v206
    v_fma_f32 v192, |v127|, v79, v192
    v_mfma_f32_16x16x32_f16 v[108:111], a[64:67], v[144:147], v[108:111]
    v_pk_mul_f16 v131, v131, v207
    v_mul_f32 v194, |v96|, v76
    v_mfma_f32_16x16x32_f16 v[112:115], a[48:51], v[144:147], v[28:31]
    v_pk_mul_f16 v132, v132, v208
    v_fma_f32 v194, |v97|, v77, v194
    v_mfma_f32_16x16x32_f16 v[112:115], a[52:55], v[148:151], v[112:115]
    v_pk_mul_f16 v133, v133, v209
    v_fma_f32 v194, |v98|, v78, v194
    v_mfma_f32_16x16x32_f16 v[112:115], a[56:59], v[152:155], v[112:115]
    v_pk_mul_f16 v134, v134, v210
    v_fma_f32 v194, |v99|, v79, v194
    v_mfma_f32_16x16x32_f16 v[112:115], a[60:63], v[156:159], v[112:115]
    v_pk_mul_f16 v135, v135, v211
    v_fma_f32 v194, |v100|, v72, v194
    v_mfma_f32_16x16x32_f16 v[116:119], a[44:47], v[156:159], v[24:27]
    v_pk_mul_f16 v136, v136, v212
    v_fma_f32 v194, |v101|, v73, v194
    v_mfma_f32_16x16x32_f16 v[116:119], a[40:43], v[152:155], v[116:119]
    v_pk_mul_f16 v137, v137, v213
    v_fma_f32 v194, |v102|, v74, v194
    v_mfma_f32_16x16x32_f16 v[116:119], a[36:39], v[148:151], v[116:119]
    v_pk_mul_f16 v138, v138, v214
    v_fma_f32 v194, |v103|, v75, v194
    v_mfma_f32_16x16x32_f16 v[116:119], a[32:35], v[144:147], v[116:119]
    v_pk_mul_f16 v139, v139, v215
    v_fma_f32 v194, |v104|, v68, v194
    v_mfma_f32_16x16x32_f16 v[120:123], a[16:19], v[144:147], v[20:23]
    v_pk_mul_f16 v140, v140, v216
    v_fma_f32 v194, |v105|, v69, v194
    v_mfma_f32_16x16x32_f16 v[120:123], a[20:23], v[148:151], v[120:123]
    v_pk_mul_f16 v141, v141, v217
    v_fma_f32 v194, |v106|, v70, v194
    v_mfma_f32_16x16x32_f16 v[120:123], a[24:27], v[152:155], v[120:123]
    v_pk_mul_f16 v142, v142, v218
    v_fma_f32 v194, |v107|, v71, v194
    v_mfma_f32_16x16x32_f16 v[120:123], a[28:31], v[156:159], v[120:123]
    v_pk_mul_f16 v143, v143, v219
    v_fma_f32 v194, |v108|, v64, v194
    v_mfma_f32_16x16x32_f16 v[124:127], a[12:15], v[156:159], v[16:19]
    ds_read_b128 v[216:219], v243 offset:4800
    v_fma_f32 v194, |v109|, v65, v194
    v_mfma_f32_16x16x32_f16 v[124:127], a[8:11], v[152:155], v[124:127]
    ds_read_b128 v[212:215], v243 offset:4736
    v_fma_f32 v194, |v110|, v66, v194
    v_mfma_f32_16x16x32_f16 v[124:127], a[4:7], v[148:151], v[124:127]
    ds_read_b128 v[208:211], v243 offset:4672
    v_fma_f32 v194, |v111|, v67, v194
    v_mfma_f32_16x16x32_f16 v[124:127], a[0:3], v[144:147], v[124:127]
    ds_read_b128 v[204:207], v243 offset:4608
    v_fma_f32 v194, |v112|, v60, v194
    v_mfma_f32_16x16x32_f16 v[96:99], a[0:3], v[128:131], v[16:19]
    ds_read_b128 v[156:159], v244 offset:4800
    v_fma_f32 v194, |v113|, v61, v194
    v_mfma_f32_16x16x32_f16 v[96:99], a[4:7], v[132:135], v[96:99]
    ds_read_b128 v[152:155], v244 offset:4736
    v_fma_f32 v194, |v114|, v62, v194
    v_mfma_f32_16x16x32_f16 v[96:99], a[8:11], v[136:139], v[96:99]
    ds_read_b128 v[148:151], v244 offset:4672
    v_fma_f32 v194, |v115|, v63, v194
    v_mfma_f32_16x16x32_f16 v[96:99], a[12:15], v[140:143], v[96:99]
    ds_read_b128 v[144:147], v244 offset:4608
    v_fma_f32 v194, |v116|, v56, v194
    v_mfma_f32_16x16x32_f16 v[100:103], a[28:31], v[140:143], v[20:23]
    v_fma_f32 v194, |v117|, v57, v194
    v_fma_f32 v194, |v118|, v58, v194
    v_mfma_f32_16x16x32_f16 v[100:103], a[24:27], v[136:139], v[100:103]
    v_fma_f32 v194, |v119|, v59, v194
    v_fma_f32 v194, |v120|, v52, v194
    v_mfma_f32_16x16x32_f16 v[100:103], a[20:23], v[132:135], v[100:103]
    v_fma_f32 v194, |v121|, v53, v194
    v_fma_f32 v194, |v122|, v54, v194
    v_mfma_f32_16x16x32_f16 v[100:103], a[16:19], v[128:131], v[100:103]
    v_fma_f32 v194, |v123|, v55, v194
    v_fma_f32 v194, |v124|, v48, v194
    v_mfma_f32_16x16x32_f16 v[104:107], a[32:35], v[128:131], v[24:27]
    v_fma_f32 v194, |v125|, v49, v194
    v_fma_f32 v194, |v126|, v50, v194
    v_mfma_f32_16x16x32_f16 v[104:107], a[36:39], v[132:135], v[104:107]
    v_fma_f32 v194, |v127|, v51, v194
    v_mul_f32 v196, |v96|, v48
    v_mfma_f32_16x16x32_f16 v[104:107], a[40:43], v[136:139], v[104:107]
    v_permlane32_swap_b32 v192, v194
    v_mfma_f32_16x16x32_f16 v[104:107], a[44:47], v[140:143], v[104:107]
    v_add_f32 v192, v192, v194
    v_fma_f32 v196, |v97|, v49, v196
    v_mfma_f32_16x16x32_f16 v[108:111], a[60:63], v[140:143], v[28:31]
    s_waitcnt lgkmcnt(0)
    v_pk_mul_f16 v144, v144, v204
    v_fma_f32 v196, |v98|, v50, v196
    v_mfma_f32_16x16x32_f16 v[108:111], a[56:59], v[136:139], v[108:111]
    v_pk_mul_f16 v145, v145, v205
    v_fma_f32 v196, |v99|, v51, v196
    v_mfma_f32_16x16x32_f16 v[108:111], a[52:55], v[132:135], v[108:111]
    v_pk_mul_f16 v146, v146, v206
    v_fma_f32 v196, |v100|, v52, v196
    v_mfma_f32_16x16x32_f16 v[108:111], a[48:51], v[128:131], v[108:111]
    v_pk_mul_f16 v147, v147, v207
    v_fma_f32 v196, |v101|, v53, v196
    v_mfma_f32_16x16x32_f16 v[112:115], a[64:67], v[128:131], v[32:35]
    v_pk_mul_f16 v148, v148, v208
    v_fma_f32 v196, |v102|, v54, v196
    v_mfma_f32_16x16x32_f16 v[112:115], a[68:71], v[132:135], v[112:115]
    v_pk_mul_f16 v149, v149, v209
    v_fma_f32 v196, |v103|, v55, v196
    v_mfma_f32_16x16x32_f16 v[112:115], a[72:75], v[136:139], v[112:115]
    v_pk_mul_f16 v150, v150, v210
    v_fma_f32 v196, |v104|, v56, v196
    v_mfma_f32_16x16x32_f16 v[112:115], a[76:79], v[140:143], v[112:115]
    v_pk_mul_f16 v151, v151, v211
    v_fma_f32 v196, |v105|, v57, v196
    v_mfma_f32_16x16x32_f16 v[116:119], a[92:95], v[140:143], v[36:39]
    v_pk_mul_f16 v152, v152, v212
    v_fma_f32 v196, |v106|, v58, v196
    v_mfma_f32_16x16x32_f16 v[116:119], a[88:91], v[136:139], v[116:119]
    v_pk_mul_f16 v153, v153, v213
    v_fma_f32 v196, |v107|, v59, v196
    v_mfma_f32_16x16x32_f16 v[116:119], a[84:87], v[132:135], v[116:119]
    v_pk_mul_f16 v154, v154, v214
    v_fma_f32 v196, |v108|, v60, v196
    v_mfma_f32_16x16x32_f16 v[116:119], a[80:83], v[128:131], v[116:119]
    v_pk_mul_f16 v155, v155, v215
    v_fma_f32 v196, |v109|, v61, v196
    v_mfma_f32_16x16x32_f16 v[120:123], a[96:99], v[128:131], v[40:43]
    v_pk_mul_f16 v156, v156, v216
    v_fma_f32 v196, |v110|, v62, v196
    v_mfma_f32_16x16x32_f16 v[120:123], a[100:103], v[132:135], v[120:123]
    v_pk_mul_f16 v157, v157, v217
    v_fma_f32 v196, |v111|, v63, v196
    v_mfma_f32_16x16x32_f16 v[120:123], a[104:107], v[136:139], v[120:123]
    v_pk_mul_f16 v158, v158, v218
    v_fma_f32 v196, |v112|, v64, v196
    v_mfma_f32_16x16x32_f16 v[120:123], a[108:111], v[140:143], v[120:123]
    v_pk_mul_f16 v159, v159, v219
    v_fma_f32 v196, |v113|, v65, v196
    v_mfma_f32_16x16x32_f16 v[124:127], a[124:127], v[140:143], v[44:47]
    ds_read_b128 v[216:219], v241 offset:4800
    v_fma_f32 v196, |v114|, v66, v196
    v_mfma_f32_16x16x32_f16 v[124:127], a[120:123], v[136:139], v[124:127]
    ds_read_b128 v[212:215], v241 offset:4736
    v_fma_f32 v196, |v115|, v67, v196
    v_mfma_f32_16x16x32_f16 v[124:127], a[116:119], v[132:135], v[124:127]
    ds_read_b128 v[208:211], v241 offset:4672
    v_fma_f32 v196, |v116|, v68, v196
    v_mfma_f32_16x16x32_f16 v[124:127], a[112:115], v[128:131], v[124:127]
    ds_read_b128 v[204:207], v241 offset:4608
    v_fma_f32 v196, |v117|, v69, v196
    v_mfma_f32_16x16x32_f16 v[96:99], a[112:115], v[144:147], v[44:47]
    ds_read_b128 v[140:143], v242 offset:4800
    v_fma_f32 v196, |v118|, v70, v196
    v_mfma_f32_16x16x32_f16 v[96:99], a[116:119], v[148:151], v[96:99]
    ds_read_b128 v[136:139], v242 offset:4736
    v_fma_f32 v196, |v119|, v71, v196
    v_mfma_f32_16x16x32_f16 v[96:99], a[120:123], v[152:155], v[96:99]
    ds_read_b128 v[132:135], v242 offset:4672
    v_fma_f32 v196, |v120|, v72, v196
    v_mfma_f32_16x16x32_f16 v[96:99], a[124:127], v[156:159], v[96:99]
    ds_read_b128 v[128:131], v242 offset:4608
    v_fma_f32 v196, |v121|, v73, v196
    v_mfma_f32_16x16x32_f16 v[100:103], a[108:111], v[156:159], v[40:43]
    v_mov_b32 v193, v192
    v_fma_f32 v196, |v122|, v74, v196
    v_mfma_f32_16x16x32_f16 v[100:103], a[104:107], v[152:155], v[100:103]
    v_permlane16_swap_b32 v192, v193
    v_mfma_f32_16x16x32_f16 v[100:103], a[100:103], v[148:151], v[100:103]
    v_add_f32 v192, v192, v193
    v_fma_f32 v196, |v123|, v75, v196
    v_mfma_f32_16x16x32_f16 v[100:103], a[96:99], v[144:147], v[100:103]
    v_fma_f32 v192, v228, s12, v192
    v_fma_f32 v196, |v124|, v76, v196
    v_mfma_f32_16x16x32_f16 v[104:107], a[80:83], v[144:147], v[36:39]
    v_cndmask_b32 v192, v251, v192, s[38:39]
    v_fma_f32 v196, |v125|, v77, v196
    v_mfma_f32_16x16x32_f16 v[104:107], a[84:87], v[148:151], v[104:107]
    v_max3_f32 v248, v248, v180, v192
    v_fma_f32 v196, |v126|, v78, v196
    v_mfma_f32_16x16x32_f16 v[104:107], a[88:91], v[152:155], v[104:107]
    v_max_f32_dpp v248, v248, v248 row_ror:8 row_mask:0xf bank_mask:0xf
    v_fma_f32 v196, |v127|, v79, v196
    v_mfma_f32_16x16x32_f16 v[104:107], a[92:95], v[156:159], v[104:107]
    v_max_f32_dpp v248, v248, v248 row_ror:4 row_mask:0xf bank_mask:0xf
    v_mul_f32 v198, |v96|, v76
    v_mfma_f32_16x16x32_f16 v[108:111], a[76:79], v[156:159], v[32:35]
    s_waitcnt lgkmcnt(0)
    v_pk_mul_f16 v128, v128, v204
    v_fma_f32 v198, |v97|, v77, v198
    v_mfma_f32_16x16x32_f16 v[108:111], a[72:75], v[152:155], v[108:111]
    v_pk_mul_f16 v129, v129, v205
    v_fma_f32 v198, |v98|, v78, v198
    v_mfma_f32_16x16x32_f16 v[108:111], a[68:71], v[148:151], v[108:111]
    v_pk_mul_f16 v130, v130, v206
    v_fma_f32 v198, |v99|, v79, v198
    v_mfma_f32_16x16x32_f16 v[108:111], a[64:67], v[144:147], v[108:111]
    v_pk_mul_f16 v131, v131, v207
    v_fma_f32 v198, |v100|, v72, v198
    v_mfma_f32_16x16x32_f16 v[112:115], a[48:51], v[144:147], v[28:31]
    v_pk_mul_f16 v132, v132, v208
    v_fma_f32 v198, |v101|, v73, v198
    v_mfma_f32_16x16x32_f16 v[112:115], a[52:55], v[148:151], v[112:115]
    v_pk_mul_f16 v133, v133, v209
    v_fma_f32 v198, |v102|, v74, v198
    v_mfma_f32_16x16x32_f16 v[112:115], a[56:59], v[152:155], v[112:115]
    v_pk_mul_f16 v134, v134, v210
    v_fma_f32 v198, |v103|, v75, v198
    v_mfma_f32_16x16x32_f16 v[112:115], a[60:63], v[156:159], v[112:115]
    v_pk_mul_f16 v135, v135, v211
    v_fma_f32 v198, |v104|, v68, v198
    v_mfma_f32_16x16x32_f16 v[116:119], a[44:47], v[156:159], v[24:27]
    v_pk_mul_f16 v136, v136, v212
    v_fma_f32 v198, |v105|, v69, v198
    v_mfma_f32_16x16x32_f16 v[116:119], a[40:43], v[152:155], v[116:119]
    v_pk_mul_f16 v137, v137, v213
    v_fma_f32 v198, |v106|, v70, v198
    v_mfma_f32_16x16x32_f16 v[116:119], a[36:39], v[148:151], v[116:119]
    v_pk_mul_f16 v138, v138, v214
    v_fma_f32 v198, |v107|, v71, v198
    v_mfma_f32_16x16x32_f16 v[116:119], a[32:35], v[144:147], v[116:119]
    v_pk_mul_f16 v139, v139, v215
    v_fma_f32 v198, |v108|, v64, v198
    v_mfma_f32_16x16x32_f16 v[120:123], a[16:19], v[144:147], v[20:23]
    v_pk_mul_f16 v140, v140, v216
    v_fma_f32 v198, |v109|, v65, v198
    v_mfma_f32_16x16x32_f16 v[120:123], a[20:23], v[148:151], v[120:123]
    v_pk_mul_f16 v141, v141, v217
    v_fma_f32 v198, |v110|, v66, v198
    v_mfma_f32_16x16x32_f16 v[120:123], a[24:27], v[152:155], v[120:123]
    v_pk_mul_f16 v142, v142, v218
    v_fma_f32 v198, |v111|, v67, v198
    v_mfma_f32_16x16x32_f16 v[120:123], a[28:31], v[156:159], v[120:123]
    v_pk_mul_f16 v143, v143, v219
    v_fma_f32 v198, |v112|, v60, v198
    v_mfma_f32_16x16x32_f16 v[124:127], a[12:15], v[156:159], v[16:19]
    v_max_f32_dpp v248, v248, v248 row_ror:2 row_mask:0xf bank_mask:0xf
    v_fma_f32 v198, |v113|, v61, v198
    v_mfma_f32_16x16x32_f16 v[124:127], a[8:11], v[152:155], v[124:127]
    v_max_f32_dpp v248, v248, v248 row_ror:1 row_mask:0xf bank_mask:0xf
    v_fma_f32 v198, |v114|, v62, v198
    v_mfma_f32_16x16x32_f16 v[124:127], a[4:7], v[148:151], v[124:127]
    v_max_f32_dpp v248, v248, v248 row_bcast:15 row_mask:0xa bank_mask:0xf
    v_fma_f32 v198, |v115|, v63, v198
    v_mfma_f32_16x16x32_f16 v[124:127], a[0:3], v[144:147], v[124:127]
    v_max_f32_dpp v248, v248, v248 row_bcast:31 row_mask:0xc bank_mask:0xf
    v_fma_f32 v198, |v116|, v56, v198
    v_mfma_f32_16x16x32_f16 v[96:99], a[0:3], v[128:131], v[16:19]
    v_readlane_b32 s14, v248, 63
    v_fma_f32 v198, |v117|, v57, v198
    v_mfma_f32_16x16x32_f16 v[96:99], a[4:7], v[132:135], v[96:99]
    v_subrev_f32 v184, s14, v184
    v_fma_f32 v198, |v118|, v58, v198
    v_mfma_f32_16x16x32_f16 v[96:99], a[8:11], v[136:139], v[96:99]
    v_subrev_f32 v188, s14, v188
    v_fma_f32 v198, |v119|, v59, v198
    v_mfma_f32_16x16x32_f16 v[96:99], a[12:15], v[140:143], v[96:99]
    v_subrev_f32 v176, s14, v176
    v_fma_f32 v198, |v120|, v52, v198
    v_mfma_f32_16x16x32_f16 v[100:103], a[28:31], v[140:143], v[20:23]
    v_subrev_f32 v180, s14, v180
    v_fma_f32 v198, |v121|, v53, v198
    v_mfma_f32_16x16x32_f16 v[100:103], a[24:27], v[136:139], v[100:103]
    v_subrev_f32 v192, s14, v192
    v_fma_f32 v198, |v122|, v54, v198
    v_mfma_f32_16x16x32_f16 v[100:103], a[20:23], v[132:135], v[100:103]
    v_mul_f32 v184, s55, v184
    v_fma_f32 v198, |v123|, v55, v198
    v_mfma_f32_16x16x32_f16 v[100:103], a[16:19], v[128:131], v[100:103]
    v_mul_f32 v188, s55, v188
    v_fma_f32 v198, |v124|, v48, v198
    v_mfma_f32_16x16x32_f16 v[104:107], a[32:35], v[128:131], v[24:27]
    v_mul_f32 v176, s55, v176
    v_fma_f32 v198, |v125|, v49, v198
    v_mfma_f32_16x16x32_f16 v[104:107], a[36:39], v[132:135], v[104:107]
    v_mul_f32 v180, s55, v180
    v_fma_f32 v198, |v126|, v50, v198
    v_mfma_f32_16x16x32_f16 v[104:107], a[40:43], v[136:139], v[104:107]
    v_mul_f32 v192, s55, v192
    v_fma_f32 v198, |v127|, v51, v198
    v_mfma_f32_16x16x32_f16 v[104:107], a[44:47], v[140:143], v[104:107]
    v_exp_f32 v184, v184
    v_mfma_f32_16x16x32_f16 v[108:111], a[60:63], v[140:143], v[28:31]
    v_exp_f32 v188, v188
    v_mfma_f32_16x16x32_f16 v[108:111], a[56:59], v[136:139], v[108:111]
    v_exp_f32 v176, v176
    v_mfma_f32_16x16x32_f16 v[108:111], a[52:55], v[132:135], v[108:111]
    v_exp_f32 v180, v180
    v_mfma_f32_16x16x32_f16 v[108:111], a[48:51], v[128:131], v[108:111]
    v_exp_f32 v192, v192
    v_mfma_f32_16x16x32_f16 v[112:115], a[64:67], v[128:131], v[32:35]
    v_add_f32 v249, v184, v188
    v_mul_f32 v197, |v96|, v48
    v_mfma_f32_16x16x32_f16 v[112:115], a[68:71], v[132:135], v[112:115]
    v_mul_f32 v250, v184, v225
    v_mul_f32 v200, |v97|, v49
    v_mfma_f32_16x16x32_f16 v[112:115], a[72:75], v[136:139], v[112:115]
    v_fmac_f32 v250, v188, v227
    v_fma_f32 v197, |v98|, v50, v197
    v_mfma_f32_16x16x32_f16 v[112:115], a[76:79], v[140:143], v[112:115]
    v_add_f32 v249, v249, v176
    v_fma_f32 v200, |v99|, v51, v200
    v_mfma_f32_16x16x32_f16 v[116:119], a[92:95], v[140:143], v[36:39]
    v_fmac_f32 v250, v176, v221
    v_fma_f32 v197, |v100|, v52, v197
    v_mfma_f32_16x16x32_f16 v[116:119], a[88:91], v[136:139], v[116:119]
    v_add_f32 v249, v249, v180
    v_fma_f32 v200, |v101|, v53, v200
    v_mfma_f32_16x16x32_f16 v[116:119], a[84:87], v[132:135], v[116:119]
    v_fmac_f32 v250, v180, v223
    v_fma_f32 v197, |v102|, v54, v197
    v_mfma_f32_16x16x32_f16 v[116:119], a[80:83], v[128:131], v[116:119]
    v_add_f32 v249, v249, v192
    v_fma_f32 v200, |v103|, v55, v200
    v_mfma_f32_16x16x32_f16 v[120:123], a[96:99], v[128:131], v[40:43]
    v_fmac_f32 v250, v192, v229
    s_lshl_b32 s6, s4, 1
    v_fma_f32 v197, |v104|, v56, v197
    v_mfma_f32_16x16x32_f16 v[120:123], a[100:103], v[132:135], v[120:123]
    v_mov_b32 v2, s6
    v_fma_f32 v200, |v105|, v57, v200
    v_mfma_f32_16x16x32_f16 v[120:123], a[104:107], v[136:139], v[120:123]
    v_permlane32_swap_b32 v196, v198
    v_mfma_f32_16x16x32_f16 v[120:123], a[108:111], v[140:143], v[120:123]
    v_add_f32 v196, v196, v198
    v_fma_f32 v197, |v106|, v58, v197
    v_mfma_f32_16x16x32_f16 v[124:127], a[124:127], v[140:143], v[44:47]
    v_fma_f32 v200, |v107|, v59, v200
    v_fma_f32 v197, |v108|, v60, v197
    v_mfma_f32_16x16x32_f16 v[124:127], a[120:123], v[136:139], v[124:127]
    v_fma_f32 v200, |v109|, v61, v200
    v_fma_f32 v197, |v110|, v62, v197
    v_mfma_f32_16x16x32_f16 v[124:127], a[116:119], v[132:135], v[124:127]
    v_fma_f32 v200, |v111|, v63, v200
    v_fma_f32 v197, |v112|, v64, v197
    v_mfma_f32_16x16x32_f16 v[124:127], a[112:115], v[128:131], v[124:127]
    v_fma_f32 v200, |v113|, v65, v200
    v_fma_f32 v197, |v114|, v66, v197
    v_fma_f32 v200, |v115|, v67, v200
    v_fma_f32 v197, |v116|, v68, v197
    v_fma_f32 v200, |v117|, v69, v200
    v_fma_f32 v197, |v118|, v70, v197
    v_fma_f32 v200, |v119|, v71, v200
    v_fma_f32 v197, |v120|, v72, v197
    v_fma_f32 v200, |v121|, v73, v200
    v_fma_f32 v197, |v122|, v74, v197
    v_fma_f32 v200, |v123|, v75, v200
    v_fma_f32 v197, |v124|, v76, v197
    v_fma_f32 v200, |v125|, v77, v200
    v_fma_f32 v197, |v126|, v78, v197
    v_fma_f32 v200, |v127|, v79, v200
    v_add_f32 v197, v197, v200
    s_nop 1
    v_permlane32_swap_b32 v197, v199
    v_add_f32 v197, v197, v199
    s_nop 1
    v_permlane16_swap_b32 v196, v197
    v_fma_f32 v196, v230, s12, v196
    v_add_f32 v196, v196, v197
    v_cndmask_b32 v196, v251, v196, s[40:41]
    v_subrev_f32 v197, s14, v196
    v_mul_f32 v197, s55, v197
    v_cmp_lt_f32 vcc, 4.0, v197
    v_exp_f32 v197, v197
    s_cbranch_vccnz L_tailmax
    v_add_f32 v249, v249, v197
    v_fmac_f32 v250, v197, v231
L_tailsum:
    s_nop 0
    v_add_f32_dpp v249, v249, v249 row_ror:8 row_mask:0xf bank_mask:0xf
    v_add_f32_dpp v250, v250, v250 row_ror:8 row_mask:0xf bank_mask:0xf
    s_nop 0
    v_add_f32_dpp v249, v249, v249 row_ror:4 row_mask:0xf bank_mask:0xf
    v_add_f32_dpp v250, v250, v250 row_ror:4 row_mask:0xf bank_mask:0xf
    s_nop 0
    v_add_f32_dpp v249, v249, v249 row_ror:2 row_mask:0xf bank_mask:0xf
    v_add_f32_dpp v250, v250, v250 row_ror:2 row_mask:0xf bank_mask:0xf
    s_nop 0
    v_add_f32_dpp v249, v249, v249 row_ror:1 row_mask:0xf bank_mask:0xf
    v_add_f32_dpp v250, v250, v250 row_ror:1 row_mask:0xf bank_mask:0xf
    s_nop 0
    v_add_f32_dpp v249, v249, v249 row_bcast:15 row_mask:0xa bank_mask:0xf
    v_add_f32_dpp v250, v250, v250 row_bcast:15 row_mask:0xa bank_mask:0xf
    s_nop 0
    v_add_f32_dpp v249, v249, v249 row_bcast:31 row_mask:0xc bank_mask:0xf
    v_add_f32_dpp v250, v250, v250 row_bcast:31 row_mask:0xc bank_mask:0xf
    v_rcp_f32 v249, v249
    v_ldexp_f32 v250, v250, s11
    s_mov_b32 exec_lo, 0
    s_mov_b32 exec_hi, 0x80000000
    v_mul_f32 v250, v250, v249
    v_cvt_pk_bf16_f32 v250, v250, v250
    global_store_short v2, v250, s[32:33]
L_end:
    s_endpgm
L_wfix:
    s_waitcnt lgkmcnt(0)
    s_nop 7
    s_mov_b32 s8, 0x07060302
    v_mov_b32 v121, 0
    v_and_b32 v122, s44, v48
    v_pk_max_u16 v121, v121, v122
    v_and_b32 v122, s44, v49
    v_pk_max_u16 v121, v121, v122
    v_and_b32 v122, s44, v50
    v_pk_max_u16 v121, v121, v122
    v_and_b32 v122, s44, v51
    v_pk_max_u16 v121, v121, v122
    v_and_b32 v122, s44, v52
    v_pk_max_u16 v121, v121, v122
    v_and_b32 v122, s44, v53
    v_pk_max_u16 v121, v121, v122
    v_and_b32 v122, s44, v54
    v_pk_max_u16 v121, v121, v122
    v_and_b32 v122, s44, v55
    v_pk_max_u16 v121, v121, v122
    v_and_b32 v122, s44, v56
    v_pk_max_u16 v121, v121, v122
    v_and_b32 v122, s44, v57
    v_pk_max_u16 v121, v121, v122
    v_and_b32 v122, s44, v58
    v_pk_max_u16 v121, v121, v122
    v_and_b32 v122, s44, v59
    v_pk_max_u16 v121, v121, v122
    v_and_b32 v122, s44, v60
    v_pk_max_u16 v121, v121, v122
    v_and_b32 v122, s44, v61
    v_pk_max_u16 v121, v121, v122
    v_and_b32 v122, s44, v62
    v_pk_max_u16 v121, v121, v122
    v_and_b32 v122, s44, v63
    v_pk_max_u16 v121, v121, v122
    v_and_b32 v122, s44, v64
    v_pk_max_u16 v121, v121, v122
    v_and_b32 v122, s44, v65
    v_pk_max_u16 v121, v121, v122
    v_and_b32 v122, s44, v66
    v_pk_max_u16 v121, v121, v122
    v_and_b32 v122, s44, v67
    v_pk_max_u16 v121, v121, v122
    v_and_b32 v122, s44, v68
    v_pk_max_u16 v121, v121, v122
    v_and_b32 v122, s44, v69
    v_pk_max_u16 v121, v121, v122
    v_and_b32 v122, s44, v70
    v_pk_max_u16 v121, v121, v122
    v_and_b32 v122, s44, v71
    v_pk_max_u16 v121, v121, v122
    v_and_b32 v122, s44, v72
    v_pk_max_u16 v121, v121, v122
    v_and_b32 v122, s44, v73
    v_pk_max_u16 v121, v121, v122
    v_and_b32 v122, s44, v74
    v_pk_max_u16 v121, v121, v122
    v_and_b32 v122, s44, v75
    v_pk_max_u16 v121, v121, v122
    v_and_b32 v122, s44, v76
    v_pk_max_u16 v121, v121, v122
    v_and_b32 v122, s44, v77
    v_pk_max_u16 v121, v121, v122
    v_and_b32 v122, s44, v78
    v_pk_max_u16 v121, v121, v122
    v_and_b32 v122, s44, v79
    v_pk_max_u16 v121, v121, v122
    s_barrier
    ds_write_b32 v3, v121 offset:39424
    s_waitcnt lgkmcnt(0)
    s_barrier
    ds_read_b128 v[112:115], v127 offset:39424
    s_waitcnt lgkmcnt(0)
    v_pk_max_u16 v121, v121, v112
    v_pk_max_u16 v121, v121, v113
    v_pk_max_u16 v121, v121, v114
    v_pk_max_u16 v121, v121, v115
    s_barrier
    v_pk_max_u16 v121, v121, v121 op_sel:[0,1] op_sel_hi:[1,0]
    s_nop 1
    v_max_u32_dpp v121, v121, v121 row_ror:8 row_mask:0xf bank_mask:0xf
    s_nop 1
    v_max_u32_dpp v121, v121, v121 row_ror:4 row_mask:0xf bank_mask:0xf
    s_nop 1
    v_max_u32_dpp v121, v121, v121 row_ror:2 row_mask:0xf bank_mask:0xf
    s_nop 1
    v_max_u32_dpp v121, v121, v121 row_ror:1 row_mask:0xf bank_mask:0xf
    s_nop 1
    v_max_u32_dpp v121, v121, v121 row_bcast:15 row_mask:0xa bank_mask:0xf
    s_nop 1
    v_max_u32_dpp v121, v121, v121 row_bcast:31 row_mask:0xc bank_mask:0xf
    s_nop 0
    v_readlane_b32 s6, v121, 63
    s_nop 0
    s_bfe_u32 s6, s6, 0x80007
    s_max_u32 s6, s6, 87
    s_sub_u32 s47, 127, s6
    s_sub_u32 s7, 0, s47
    v_lshlrev_b32 v121, 16, v48
    v_and_b32 v122, s46, v48
    v_ldexp_f32 v121, v121, s47
    v_ldexp_f32 v122, v122, s47
    v_perm_b32 v48, v122, v121, s8
    v_lshlrev_b32 v121, 16, v49
    v_and_b32 v122, s46, v49
    v_ldexp_f32 v121, v121, s47
    v_ldexp_f32 v122, v122, s47
    v_perm_b32 v49, v122, v121, s8
    v_lshlrev_b32 v121, 16, v50
    v_and_b32 v122, s46, v50
    v_ldexp_f32 v121, v121, s47
    v_ldexp_f32 v122, v122, s47
    v_perm_b32 v50, v122, v121, s8
    v_lshlrev_b32 v121, 16, v51
    v_and_b32 v122, s46, v51
    v_ldexp_f32 v121, v121, s47
    v_ldexp_f32 v122, v122, s47
    v_perm_b32 v51, v122, v121, s8
    v_lshlrev_b32 v121, 16, v52
    v_and_b32 v122, s46, v52
    v_ldexp_f32 v121, v121, s47
    v_ldexp_f32 v122, v122, s47
    v_perm_b32 v52, v122, v121, s8
    v_lshlrev_b32 v121, 16, v53
    v_and_b32 v122, s46, v53
    v_ldexp_f32 v121, v121, s47
    v_ldexp_f32 v122, v122, s47
    v_perm_b32 v53, v122, v121, s8
    v_lshlrev_b32 v121, 16, v54
    v_and_b32 v122, s46, v54
    v_ldexp_f32 v121, v121, s47
    v_ldexp_f32 v122, v122, s47
    v_perm_b32 v54, v122, v121, s8
    v_lshlrev_b32 v121, 16, v55
    v_and_b32 v122, s46, v55
    v_ldexp_f32 v121, v121, s47
    v_ldexp_f32 v122, v122, s47
    v_perm_b32 v55, v122, v121, s8
    v_lshlrev_b32 v121, 16, v56
    v_and_b32 v122, s46, v56
    v_ldexp_f32 v121, v121, s47
    v_ldexp_f32 v122, v122, s47
    v_perm_b32 v56, v122, v121, s8
    v_lshlrev_b32 v121, 16, v57
    v_and_b32 v122, s46, v57
    v_ldexp_f32 v121, v121, s47
    v_ldexp_f32 v122, v122, s47
    v_perm_b32 v57, v122, v121, s8
    v_lshlrev_b32 v121, 16, v58
    v_and_b32 v122, s46, v58
    v_ldexp_f32 v121, v121, s47
    v_ldexp_f32 v122, v122, s47
    v_perm_b32 v58, v122, v121, s8
    v_lshlrev_b32 v121, 16, v59
    v_and_b32 v122, s46, v59
    v_ldexp_f32 v121, v121, s47
    v_ldexp_f32 v122, v122, s47
    v_perm_b32 v59, v122, v121, s8
    v_lshlrev_b32 v121, 16, v60
    v_and_b32 v122, s46, v60
    v_ldexp_f32 v121, v121, s47
    v_ldexp_f32 v122, v122, s47
    v_perm_b32 v60, v122, v121, s8
    v_lshlrev_b32 v121, 16, v61
    v_and_b32 v122, s46, v61
    v_ldexp_f32 v121, v121, s47
    v_ldexp_f32 v122, v122, s47
    v_perm_b32 v61, v122, v121, s8
    v_lshlrev_b32 v121, 16, v62
    v_and_b32 v122, s46, v62
    v_ldexp_f32 v121, v121, s47
    v_ldexp_f32 v122, v122, s47
    v_perm_b32 v62, v122, v121, s8
    v_lshlrev_b32 v121, 16, v63
    v_and_b32 v122, s46, v63
    v_ldexp_f32 v121, v121, s47
    v_ldexp_f32 v122, v122, s47
    v_perm_b32 v63, v122, v121, s8
    v_lshlrev_b32 v121, 16, v64
    v_and_b32 v122, s46, v64
    v_ldexp_f32 v121, v121, s47
    v_ldexp_f32 v122, v122, s47
    v_perm_b32 v64, v122, v121, s8
    v_lshlrev_b32 v121, 16, v65
    v_and_b32 v122, s46, v65
    v_ldexp_f32 v121, v121, s47
    v_ldexp_f32 v122, v122, s47
    v_perm_b32 v65, v122, v121, s8
    v_lshlrev_b32 v121, 16, v66
    v_and_b32 v122, s46, v66
    v_ldexp_f32 v121, v121, s47
    v_ldexp_f32 v122, v122, s47
    v_perm_b32 v66, v122, v121, s8
    v_lshlrev_b32 v121, 16, v67
    v_and_b32 v122, s46, v67
    v_ldexp_f32 v121, v121, s47
    v_ldexp_f32 v122, v122, s47
    v_perm_b32 v67, v122, v121, s8
    v_lshlrev_b32 v121, 16, v68
    v_and_b32 v122, s46, v68
    v_ldexp_f32 v121, v121, s47
    v_ldexp_f32 v122, v122, s47
    v_perm_b32 v68, v122, v121, s8
    v_lshlrev_b32 v121, 16, v69
    v_and_b32 v122, s46, v69
    v_ldexp_f32 v121, v121, s47
    v_ldexp_f32 v122, v122, s47
    v_perm_b32 v69, v122, v121, s8
    v_lshlrev_b32 v121, 16, v70
    v_and_b32 v122, s46, v70
    v_ldexp_f32 v121, v121, s47
    v_ldexp_f32 v122, v122, s47
    v_perm_b32 v70, v122, v121, s8
    v_lshlrev_b32 v121, 16, v71
    v_and_b32 v122, s46, v71
    v_ldexp_f32 v121, v121, s47
    v_ldexp_f32 v122, v122, s47
    v_perm_b32 v71, v122, v121, s8
    v_lshlrev_b32 v121, 16, v72
    v_and_b32 v122, s46, v72
    v_ldexp_f32 v121, v121, s47
    v_ldexp_f32 v122, v122, s47
    v_perm_b32 v72, v122, v121, s8
    v_lshlrev_b32 v121, 16, v73
    v_and_b32 v122, s46, v73
    v_ldexp_f32 v121, v121, s47
    v_ldexp_f32 v122, v122, s47
    v_perm_b32 v73, v122, v121, s8
    v_lshlrev_b32 v121, 16, v74
    v_and_b32 v122, s46, v74
    v_ldexp_f32 v121, v121, s47
    v_ldexp_f32 v122, v122, s47
    v_perm_b32 v74, v122, v121, s8
    v_lshlrev_b32 v121, 16, v75
    v_and_b32 v122, s46, v75
    v_ldexp_f32 v121, v121, s47
    v_ldexp_f32 v122, v122, s47
    v_perm_b32 v75, v122, v121, s8
    v_lshlrev_b32 v121, 16, v76
    v_and_b32 v122, s46, v76
    v_ldexp_f32 v121, v121, s47
    v_ldexp_f32 v122, v122, s47
    v_perm_b32 v76, v122, v121, s8
    v_lshlrev_b32 v121, 16, v77
    v_and_b32 v122, s46, v77
    v_ldexp_f32 v121, v121, s47
    v_ldexp_f32 v122, v122, s47
    v_perm_b32 v77, v122, v121, s8
    v_lshlrev_b32 v121, 16, v78
    v_and_b32 v122, s46, v78
    v_ldexp_f32 v121, v121, s47
    v_ldexp_f32 v122, v122, s47
    v_perm_b32 v78, v122, v121, s8
    v_lshlrev_b32 v121, 16, v79
    v_and_b32 v122, s46, v79
    v_ldexp_f32 v121, v121, s47
    v_ldexp_f32 v122, v122, s47
    v_perm_b32 v79, v122, v121, s8
    v_lshlrev_b32 v121, 16, v220
    v_and_b32 v122, s46, v220
    v_ldexp_f32 v121, v121, s7
    v_ldexp_f32 v122, v122, s7
    v_perm_b32 v220, v122, v121, s8
    v_lshlrev_b32 v121, 16, v221
    v_and_b32 v122, s46, v221
    v_ldexp_f32 v121, v121, s7
    v_ldexp_f32 v122, v122, s7
    v_perm_b32 v221, v122, v121, s8
    v_lshlrev_b32 v121, 16, v222
    v_and_b32 v122, s46, v222
    v_ldexp_f32 v121, v121, s7
    v_ldexp_f32 v122, v122, s7
    v_perm_b32 v222, v122, v121, s8
    v_lshlrev_b32 v121, 16, v223
    v_and_b32 v122, s46, v223
    v_ldexp_f32 v121, v121, s7
    v_ldexp_f32 v122, v122, s7
    v_perm_b32 v223, v122, v121, s8
    s_add_u32 s6, s47, 10
    v_cmp_lt_u32 vcc, 31, v1
    v_mov_b32 v121, s6
    v_mov_b32 v122, s7
    v_cndmask_b32 v9, v121, v122, vcc
    s_mov_b32 s52, 0
    s_mov_b32 s53, 0
    s_nop 7
    s_branch L_wconv
L_efix:
    s_waitcnt vmcnt(0) lgkmcnt(0)
    s_nop 15
    s_mul_i32 s6, s4, 104
    v_mul_u32_u24 v121, 28, v4
    v_min_u32 v122, 76, v121
    v_add_u32 v121, s6, v121
    v_add_u32 v122, s6, v122
    global_load_dwordx4 v[204:207], v121, s[16:17]
    global_load_dwordx3 v[208:210], v122, s[16:17] offset:16
    s_waitcnt vmcnt(1)
    v_lshl_add_u32 v204, v204, 8, v14
    v_lshl_add_u32 v205, v205, 8, v14
    v_lshl_add_u32 v206, v206, 8, v14
    v_lshl_add_u32 v207, v207, 8, v14
    s_waitcnt vmcnt(0)
    v_lshl_add_u32 v208, v208, 8, v14
    v_lshl_add_u32 v209, v209, 8, v14
    v_lshl_add_u32 v210, v210, 8, v14
    buffer_load_dwordx4 v[144:147], v204, s[56:59], 0 offen
    buffer_load_dwordx4 v[148:151], v205, s[56:59], 0 offen
    buffer_load_dwordx4 v[152:155], v206, s[56:59], 0 offen
    buffer_load_dwordx4 v[156:159], v207, s[56:59], 0 offen
    buffer_load_dwordx4 v[160:163], v208, s[56:59], 0 offen
    buffer_load_dwordx4 v[164:167], v209, s[56:59], 0 offen
    buffer_load_dwordx4 v[168:171], v210, s[56:59], 0 offen
    s_waitcnt vmcnt(0)
    s_mov_b32 s8, 0x07060302
    v_mov_b32 v121, 0
    v_and_b32 v122, s44, v144
    v_pk_max_u16 v121, v121, v122
    v_and_b32 v122, s44, v145
    v_pk_max_u16 v121, v121, v122
    v_and_b32 v122, s44, v146
    v_pk_max_u16 v121, v121, v122
    v_and_b32 v122, s44, v147
    v_pk_max_u16 v121, v121, v122
    v_and_b32 v122, s44, v148
    v_pk_max_u16 v121, v121, v122
    v_and_b32 v122, s44, v149
    v_pk_max_u16 v121, v121, v122
    v_and_b32 v122, s44, v150
    v_pk_max_u16 v121, v121, v122
    v_and_b32 v122, s44, v151
    v_pk_max_u16 v121, v121, v122
    v_and_b32 v122, s44, v152
    v_pk_max_u16 v121, v121, v122
    v_and_b32 v122, s44, v153
    v_pk_max_u16 v121, v121, v122
    v_and_b32 v122, s44, v154
    v_pk_max_u16 v121, v121, v122
    v_and_b32 v122, s44, v155
    v_pk_max_u16 v121, v121, v122
    v_and_b32 v122, s44, v156
    v_pk_max_u16 v121, v121, v122
    v_and_b32 v122, s44, v157
    v_pk_max_u16 v121, v121, v122
    v_and_b32 v122, s44, v158
    v_pk_max_u16 v121, v121, v122
    v_and_b32 v122, s44, v159
    v_pk_max_u16 v121, v121, v122
    v_and_b32 v122, s44, v160
    v_pk_max_u16 v121, v121, v122
    v_and_b32 v122, s44, v161
    v_pk_max_u16 v121, v121, v122
    v_and_b32 v122, s44, v162
    v_pk_max_u16 v121, v121, v122
    v_and_b32 v122, s44, v163
    v_pk_max_u16 v121, v121, v122
    v_and_b32 v122, s44, v164
    v_pk_max_u16 v121, v121, v122
    v_and_b32 v122, s44, v165
    v_pk_max_u16 v121, v121, v122
    v_and_b32 v122, s44, v166
    v_pk_max_u16 v121, v121, v122
    v_and_b32 v122, s44, v167
    v_pk_max_u16 v121, v121, v122
    v_and_b32 v122, s44, v168
    v_pk_max_u16 v121, v121, v122
    v_and_b32 v122, s44, v169
    v_pk_max_u16 v121, v121, v122
    v_and_b32 v122, s44, v170
    v_pk_max_u16 v121, v121, v122
    v_and_b32 v122, s44, v171
    v_pk_max_u16 v121, v121, v122
    v_pk_max_u16 v121, v121, v121 op_sel:[0,1] op_sel_hi:[1,0]
    s_nop 1
    v_max_u32_dpp v121, v121, v121 row_ror:8 row_mask:0xf bank_mask:0xf
    s_nop 1
    v_max_u32_dpp v121, v121, v121 row_ror:4 row_mask:0xf bank_mask:0xf
    s_nop 1
    v_max_u32_dpp v121, v121, v121 row_ror:2 row_mask:0xf bank_mask:0xf
    s_nop 1
    v_max_u32_dpp v121, v121, v121 row_ror:1 row_mask:0xf bank_mask:0xf
    s_nop 1
    v_max_u32_dpp v121, v121, v121 row_bcast:15 row_mask:0xa bank_mask:0xf
    s_nop 1
    v_max_u32_dpp v121, v121, v121 row_bcast:31 row_mask:0xc bank_mask:0xf
    s_nop 0
    v_readlane_b32 s6, v121, 63
    s_nop 0
    s_bfe_u32 s6, s6, 0x80007
    s_max_u32 s6, s6, 104
    s_min_u32 s6, s6, 190
    s_sub_u32 s6, 129, s6
    v_lshlrev_b32 v121, 16, v144
    v_and_b32 v122, s46, v144
    v_ldexp_f32 v121, v121, s6
    v_ldexp_f32 v122, v122, s6
    v_perm_b32 v144, v122, v121, s8
    v_lshlrev_b32 v121, 16, v145
    v_and_b32 v122, s46, v145
    v_ldexp_f32 v121, v121, s6
    v_ldexp_f32 v122, v122, s6
    v_perm_b32 v145, v122, v121, s8
    v_lshlrev_b32 v121, 16, v146
    v_and_b32 v122, s46, v146
    v_ldexp_f32 v121, v121, s6
    v_ldexp_f32 v122, v122, s6
    v_perm_b32 v146, v122, v121, s8
    v_lshlrev_b32 v121, 16, v147
    v_and_b32 v122, s46, v147
    v_ldexp_f32 v121, v121, s6
    v_ldexp_f32 v122, v122, s6
    v_perm_b32 v147, v122, v121, s8
    v_lshlrev_b32 v121, 16, v148
    v_and_b32 v122, s46, v148
    v_ldexp_f32 v121, v121, s6
    v_ldexp_f32 v122, v122, s6
    v_perm_b32 v148, v122, v121, s8
    v_lshlrev_b32 v121, 16, v149
    v_and_b32 v122, s46, v149
    v_ldexp_f32 v121, v121, s6
    v_ldexp_f32 v122, v122, s6
    v_perm_b32 v149, v122, v121, s8
    v_lshlrev_b32 v121, 16, v150
    v_and_b32 v122, s46, v150
    v_ldexp_f32 v121, v121, s6
    v_ldexp_f32 v122, v122, s6
    v_perm_b32 v150, v122, v121, s8
    v_lshlrev_b32 v121, 16, v151
    v_and_b32 v122, s46, v151
    v_ldexp_f32 v121, v121, s6
    v_ldexp_f32 v122, v122, s6
    v_perm_b32 v151, v122, v121, s8
    v_lshlrev_b32 v121, 16, v152
    v_and_b32 v122, s46, v152
    v_ldexp_f32 v121, v121, s6
    v_ldexp_f32 v122, v122, s6
    v_perm_b32 v152, v122, v121, s8
    v_lshlrev_b32 v121, 16, v153
    v_and_b32 v122, s46, v153
    v_ldexp_f32 v121, v121, s6
    v_ldexp_f32 v122, v122, s6
    v_perm_b32 v153, v122, v121, s8
    v_lshlrev_b32 v121, 16, v154
    v_and_b32 v122, s46, v154
    v_ldexp_f32 v121, v121, s6
    v_ldexp_f32 v122, v122, s6
    v_perm_b32 v154, v122, v121, s8
    v_lshlrev_b32 v121, 16, v155
    v_and_b32 v122, s46, v155
    v_ldexp_f32 v121, v121, s6
    v_ldexp_f32 v122, v122, s6
    v_perm_b32 v155, v122, v121, s8
    v_lshlrev_b32 v121, 16, v156
    v_and_b32 v122, s46, v156
    v_ldexp_f32 v121, v121, s6
    v_ldexp_f32 v122, v122, s6
    v_perm_b32 v156, v122, v121, s8
    v_lshlrev_b32 v121, 16, v157
    v_and_b32 v122, s46, v157
    v_ldexp_f32 v121, v121, s6
    v_ldexp_f32 v122, v122, s6
    v_perm_b32 v157, v122, v121, s8
    v_lshlrev_b32 v121, 16, v158
    v_and_b32 v122, s46, v158
    v_ldexp_f32 v121, v121, s6
    v_ldexp_f32 v122, v122, s6
    v_perm_b32 v158, v122, v121, s8
    v_lshlrev_b32 v121, 16, v159
    v_and_b32 v122, s46, v159
    v_ldexp_f32 v121, v121, s6
    v_ldexp_f32 v122, v122, s6
    v_perm_b32 v159, v122, v121, s8
    v_lshlrev_b32 v121, 16, v160
    v_and_b32 v122, s46, v160
    v_ldexp_f32 v121, v121, s6
    v_ldexp_f32 v122, v122, s6
    v_perm_b32 v160, v122, v121, s8
    v_lshlrev_b32 v121, 16, v161
    v_and_b32 v122, s46, v161
    v_ldexp_f32 v121, v121, s6
    v_ldexp_f32 v122, v122, s6
    v_perm_b32 v161, v122, v121, s8
    v_lshlrev_b32 v121, 16, v162
    v_and_b32 v122, s46, v162
    v_ldexp_f32 v121, v121, s6
    v_ldexp_f32 v122, v122, s6
    v_perm_b32 v162, v122, v121, s8
    v_lshlrev_b32 v121, 16, v163
    v_and_b32 v122, s46, v163
    v_ldexp_f32 v121, v121, s6
    v_ldexp_f32 v122, v122, s6
    v_perm_b32 v163, v122, v121, s8
    v_lshlrev_b32 v121, 16, v164
    v_and_b32 v122, s46, v164
    v_ldexp_f32 v121, v121, s6
    v_ldexp_f32 v122, v122, s6
    v_perm_b32 v164, v122, v121, s8
    v_lshlrev_b32 v121, 16, v165
    v_and_b32 v122, s46, v165
    v_ldexp_f32 v121, v121, s6
    v_ldexp_f32 v122, v122, s6
    v_perm_b32 v165, v122, v121, s8
    v_lshlrev_b32 v121, 16, v166
    v_and_b32 v122, s46, v166
    v_ldexp_f32 v121, v121, s6
    v_ldexp_f32 v122, v122, s6
    v_perm_b32 v166, v122, v121, s8
    v_lshlrev_b32 v121, 16, v167
    v_and_b32 v122, s46, v167
    v_ldexp_f32 v121, v121, s6
    v_ldexp_f32 v122, v122, s6
    v_perm_b32 v167, v122, v121, s8
    v_lshlrev_b32 v121, 16, v168
    v_and_b32 v122, s46, v168
    v_ldexp_f32 v121, v121, s6
    v_ldexp_f32 v122, v122, s6
    v_perm_b32 v168, v122, v121, s8
    v_lshlrev_b32 v121, 16, v169
    v_and_b32 v122, s46, v169
    v_ldexp_f32 v121, v121, s6
    v_ldexp_f32 v122, v122, s6
    v_perm_b32 v169, v122, v121, s8
    v_lshlrev_b32 v121, 16, v170
    v_and_b32 v122, s46, v170
    v_ldexp_f32 v121, v121, s6
    v_ldexp_f32 v122, v122, s6
    v_perm_b32 v170, v122, v121, s8
    v_lshlrev_b32 v121, 16, v171
    v_and_b32 v122, s46, v171
    v_ldexp_f32 v121, v121, s6
    v_ldexp_f32 v122, v122, s6
    v_perm_b32 v171, v122, v121, s8
    s_lshl_b32 s6, s6, 1
    v_ldexp_f32 v16, v16, s6
    v_ldexp_f32 v17, v17, s6
    v_ldexp_f32 v18, v18, s6
    v_ldexp_f32 v19, v19, s6
    v_ldexp_f32 v20, v20, s6
    v_ldexp_f32 v21, v21, s6
    v_ldexp_f32 v22, v22, s6
    v_ldexp_f32 v23, v23, s6
    v_ldexp_f32 v24, v24, s6
    v_ldexp_f32 v25, v25, s6
    v_ldexp_f32 v26, v26, s6
    v_ldexp_f32 v27, v27, s6
    v_ldexp_f32 v28, v28, s6
    v_ldexp_f32 v29, v29, s6
    v_ldexp_f32 v30, v30, s6
    v_ldexp_f32 v31, v31, s6
    v_ldexp_f32 v32, v32, s6
    v_ldexp_f32 v33, v33, s6
    v_ldexp_f32 v34, v34, s6
    v_ldexp_f32 v35, v35, s6
    v_ldexp_f32 v36, v36, s6
    v_ldexp_f32 v37, v37, s6
    v_ldexp_f32 v38, v38, s6
    v_ldexp_f32 v39, v39, s6
    v_ldexp_f32 v40, v40, s6
    v_ldexp_f32 v41, v41, s6
    v_ldexp_f32 v42, v42, s6
    v_ldexp_f32 v43, v43, s6
    v_ldexp_f32 v44, v44, s6
    v_ldexp_f32 v45, v45, s6
    v_ldexp_f32 v46, v46, s6
    v_ldexp_f32 v47, v47, s6
    s_add_u32 s7, s5, -28096
    v_add_u32 v0, s7, v15
    ds_write_b128 v0, v[16:19] offset:37888
    ds_write_b128 v0, v[20:23] offset:37952
    ds_write_b128 v0, v[24:27] offset:38016
    ds_write_b128 v0, v[28:31] offset:38080
    ds_write_b128 v0, v[32:35] offset:38144
    ds_write_b128 v0, v[36:39] offset:38208
    ds_write_b128 v0, v[40:43] offset:38272
    ds_write_b128 v0, v[44:47] offset:38336
    s_waitcnt lgkmcnt(0)
    s_add_u32 s54, s54, s6
    s_lshl_b32 s6, s6, 23
    s_sub_u32 s55, s55, s6
    s_mov_b32 s50, 0x7fc00000
    s_mov_b32 s51, 0
    s_mov_b32 s52, 0
    s_mov_b32 s53, 0
    s_nop 7
    s_branch L_econv
L_tailmax:
    s_nop 3
    v_mov_b32 v176, s14
    v_max_f32 v248, s14, v196
    s_nop 1
    v_max_f32_dpp v248, v248, v248 row_ror:8 row_mask:0xf bank_mask:0xf
    s_nop 1
    v_max_f32_dpp v248, v248, v248 row_ror:4 row_mask:0xf bank_mask:0xf
    s_nop 1
    v_max_f32_dpp v248, v248, v248 row_ror:2 row_mask:0xf bank_mask:0xf
    s_nop 1
    v_max_f32_dpp v248, v248, v248 row_ror:1 row_mask:0xf bank_mask:0xf
    s_nop 1
    v_max_f32_dpp v248, v248, v248 row_bcast:15 row_mask:0xa bank_mask:0xf
    s_nop 1
    v_max_f32_dpp v248, v248, v248 row_bcast:31 row_mask:0xc bank_mask:0xf
    s_nop 0
    v_readlane_b32 s13, v248, 63
    s_nop 1
    v_subrev_f32 v196, s13, v196
    v_subrev_f32 v176, s13, v176
    v_mul_f32 v196, s55, v196
    v_mul_f32 v176, s55, v176
    v_exp_f32 v196, v196
    v_exp_f32 v176, v176
    v_mul_f32 v199, v196, v231
    v_fma_f32 v249, v249, v176, v196
    v_fma_f32 v250, v250, v176, v199
    s_nop 3
    s_branch L_tailsum
s_endpgm
.p2align 7
.type L_tab,@object
L_tab:
.long 0x98000000, 0xa0000, 0x0, 0x0
.long 0x98020010, 0xa0004, 0x8, 0x1200010
.long 0x98040020, 0xa0008, 0x10, 0x2400020
.long 0x98060030, 0xa000c, 0x18, 0x3600030
.long 0x98080040, 0xa0010, 0x120, 0x4800040
.long 0x980a0050, 0xa0014, 0x128, 0x5a00050
.long 0x980c0060, 0xa0018, 0x130, 0x6c00060
.long 0x980e0070, 0xa001c, 0x138, 0x7e00070
.long 0x98100080, 0xa0020, 0x240, 0x9000080
.long 0x98120090, 0xa0024, 0x248, 0xa200090
.long 0x981400a0, 0xa0028, 0x250, 0xb4000a0
.long 0x981600b0, 0xa002c, 0x258, 0xc6000b0
.long 0x981800c0, 0xa0030, 0x360, 0xd8000c0
.long 0x981a00d0, 0xa0034, 0x368, 0xea000d0
.long 0x981c00e0, 0xa0038, 0x370, 0xfc000e0
.long 0x981e00f0, 0xa003c, 0x378, 0x10e000f0
.long 0x98200120, 0xa0040, 0x100980, 0x100120
.long 0x98220130, 0xa0044, 0x100988, 0x1300130
.long 0x98240140, 0xa0048, 0x100990, 0x2500140
.long 0x98260150, 0xa004c, 0x100998, 0x3700150
.long 0x98280160, 0xa0050, 0x100aa0, 0x4900160
.long 0x982a0170, 0xa0054, 0x100aa8, 0x5b00170
.long 0x982c0180, 0xa0058, 0x100ab0, 0x6d00180
.long 0x982e0190, 0xa005c, 0x100ab8, 0x7f00190
.long 0x983001a0, 0xa0060, 0x100bc0, 0x91001a0
.long 0x983201b0, 0xa0064, 0x100bc8, 0xa3001b0
.long 0x983401c0, 0xa0068, 0x100bd0, 0xb5001c0
.long 0x983601d0, 0xa006c, 0x100bd8, 0xc7001d0
.long 0x983801e0, 0xa0070, 0x100ce0, 0xd9001e0
.long 0x983a01f0, 0xa0074, 0x100ce8, 0xeb001f0
.long 0x983c0200, 0xa0078, 0x100cf0, 0xfd00200
.long 0x983e0210, 0xa007c, 0x100cf8, 0x10f00210
.long 0x98400240, 0x200, 0x201280, 0x200240
.long 0x98420250, 0x204, 0x201288, 0x1400250
.long 0x98440260, 0x208, 0x201290, 0x2600260
.long 0x98460270, 0x20c, 0x201298, 0x3800270
.long 0x98480280, 0x210, 0x2013a0, 0x4a00280
.long 0x984a0290, 0x214, 0x2013a8, 0x5c00290
.long 0x984c02a0, 0x218, 0x2013b0, 0x6e002a0
.long 0x984e02b0, 0x21c, 0x2013b8, 0x80002b0
.long 0x985002c0, 0x220, 0x2014c0, 0x92002c0
.long 0x985202d0, 0x224, 0x2014c8, 0xa4002d0
.long 0x985402e0, 0x228, 0x2014d0, 0xb6002e0
.long 0x985602f0, 0x22c, 0x2014d8, 0xc8002f0
.long 0x98580300, 0x230, 0x2015e0, 0xda00300
.long 0x985a0310, 0x234, 0x2015e8, 0xec00310
.long 0x985c0320, 0x238, 0x2015f0, 0xfe00320
.long 0x985e0330, 0x23c, 0x2015f8, 0x11000330
.long 0x98600360, 0x240, 0x301c00, 0x300360
.long 0x98620370, 0x244, 0x301c08, 0x1500370
.long 0x98640380, 0x248, 0x301c10, 0x2700380
.long 0x98660390, 0x24c, 0x301c18, 0x3900390
.long 0x986803a0, 0x250, 0x301d20, 0x4b003a0
.long 0x986a03b0, 0x254, 0x301d28, 0x5d003b0
.long 0x986c03c0, 0x258, 0x301d30, 0x6f003c0
.long 0x986e03d0, 0x25c, 0x301d38, 0x81003d0
.long 0x987003e0, 0x260, 0x301e40, 0x93003e0
.long 0x987203f0, 0x264, 0x301e48, 0xa5003f0
.long 0x98740400, 0x268, 0x301e50, 0xb700400
.long 0x98760410, 0x26c, 0x301e58, 0xc900410
.long 0x98780420, 0x270, 0x301f60, 0xdb00420
.long 0x987a0430, 0x274, 0x301f68, 0xed00430
.long 0x987c0440, 0x278, 0x301f70, 0xff00440
.long 0x987e0450, 0x27c, 0x301f78, 0x11100450
.long 0x120, 0x98000000, 0x0, 0x0
.long 0x240, 0x98400120, 0x0, 0x0
.long 0x360, 0x98800240, 0x0, 0x0
.long 0x480, 0x98c00360, 0x0, 0x0
.long 0x5a0, 0x99000480, 0x0, 0x0
.long 0x6c0, 0x994005a0, 0x0, 0x0
.long 0x7e0, 0x998006c0, 0x0, 0x0
.long 0x900, 0x99c007e0, 0x0, 0x0
.long 0xa20, 0x98100900, 0x0, 0x0
.long 0xb40, 0x98500a20, 0x0, 0x0
.long 0xc60, 0x98900a20, 0x0, 0x0
.long 0xd80, 0x98d00a20, 0x0, 0x0
.long 0xea0, 0x99100a20, 0x0, 0x0
.long 0xfc0, 0x99500a20, 0x0, 0x0
.long 0x10e0, 0x99900a20, 0x0, 0x0
.long 0x0, 0x99d00a20, 0x0, 0x0
.long 0x100130, 0x98080010, 0x0, 0x0
.long 0x100250, 0x98480130, 0x0, 0x0
.long 0x100370, 0x98880250, 0x0, 0x0
.long 0x100490, 0x98c80370, 0x0, 0x0
.long 0x1005b0, 0x99080490, 0x0, 0x0
.long 0x1006d0, 0x994805b0, 0x0, 0x0
.long 0x1007f0, 0x998806d0, 0x0, 0x0
.long 0x100910, 0x99c807f0, 0x0, 0x0
.long 0x100a30, 0x98180910, 0x0, 0x0
.long 0x100b50, 0x98580a30, 0x0, 0x0
.long 0x100c70, 0x98980a30, 0x0, 0x0
.long 0x100d90, 0x98d80a30, 0x0, 0x0
.long 0x100eb0, 0x99180a30, 0x0, 0x0
.long 0x100fd0, 0x99580a30, 0x0, 0x0
.long 0x1010f0, 0x99980a30, 0x0, 0x0
.long 0x100010, 0x99d80a30, 0x0, 0x0
.long 0x200140, 0x98040020, 0x0, 0x0
.long 0x200260, 0x98440140, 0x0, 0x0
.long 0x200380, 0x98840260, 0x0, 0x0
.long 0x2004a0, 0x98c40380, 0x0, 0x0
.long 0x2005c0, 0x990404a0, 0x0, 0x0
.long 0x2006e0, 0x994405c0, 0x0, 0x0
.long 0x200800, 0x998406e0, 0x0, 0x0
.long 0x200920, 0x99c40800, 0x0, 0x0
.long 0x200a40, 0x98140920, 0x0, 0x0
.long 0x200b60, 0x98540a40, 0x0, 0x0
.long 0x200c80, 0x98940a40, 0x0, 0x0
.long 0x200da0, 0x98d40a40, 0x0, 0x0
.long 0x200ec0, 0x99140a40, 0x0, 0x0
.long 0x200fe0, 0x99540a40, 0x0, 0x0
.long 0x201100, 0x99940a40, 0x0, 0x0
.long 0x200020, 0x99d40a40, 0x0, 0x0
.long 0x300150, 0x980c0030, 0x0, 0x0
.long 0x300270, 0x984c0150, 0x0, 0x0
.long 0x300390, 0x988c0270, 0x0, 0x0
.long 0x3004b0, 0x98cc0390, 0x0, 0x0
.long 0x3005d0, 0x990c04b0, 0x0, 0x0
.long 0x3006f0, 0x994c05d0, 0x0, 0x0
.long 0x300810, 0x998c06f0, 0x0, 0x0
.long 0x300930, 0x99cc0810, 0x0, 0x0
.long 0x300a50, 0x981c0930, 0x0, 0x0
.long 0x300b70, 0x985c0a50, 0x0, 0x0
.long 0x300c90, 0x989c0a50, 0x0, 0x0
.long 0x300db0, 0x98dc0a50, 0x0, 0x0
.long 0x300ed0, 0x991c0a50, 0x0, 0x0
.long 0x300ff0, 0x995c0a50, 0x0, 0x0
.long 0x301110, 0x999c0a50, 0x0, 0x0
.long 0x300030, 0x99dc0a50, 0x0, 0x0
.long 0x2f40, 0x1203180, 0x6c026d0, 0x9002910
.long 0x1202f44, 0x2403184, 0x7e02764, 0xa2029a4
.long 0x2402f48, 0x3603188, 0x90027f8, 0x2a38
.long 0x3602f4c, 0x480318c, 0xa20288c, 0x1202acc
.long 0x4802f50, 0x5a03190, 0x2920, 0x3602b60
.long 0x5a02f54, 0x6c03194, 0x12029b4, 0x4802bf4
.long 0x6c02f58, 0x7e03198, 0x2402a48, 0x5a02c88
.long 0x7e02f5c, 0x900319c, 0x3602adc, 0x6c02d1c
.long 0x9002f60, 0xa2031a0, 0x4802b70, 0x7e02db0
.long 0xa202f64, 0x31a4, 0x5a02c04, 0x9002e44
.long 0x2f68, 0x24031a8, 0x6c02c98, 0xa202ed8
.long 0x1202f6c, 0x36031ac, 0x7e02d2c, 0x266c
.long 0x2402f70, 0x48031b0, 0x9002dc0, 0x1202700
.long 0x3602f74, 0x5a031b4, 0xa202e54, 0x2402794
.long 0x4802f78, 0x6c031b8, 0x2ee8, 0x4802828
.long 0x5a02f7c, 0x7e031bc, 0x120267c, 0x5a028bc
.long 0x102fd0, 0x1303210, 0x6d02760, 0x91029a0
.long 0x1302fd4, 0x2503214, 0x7f027f4, 0xa302a34
.long 0x2502fd8, 0x3703218, 0x9102888, 0x102ac8
.long 0x3702fdc, 0x490321c, 0xa30291c, 0x1302b5c
.long 0x4902fe0, 0x5b03220, 0x1029b0, 0x3702bf0
.long 0x5b02fe4, 0x6d03224, 0x1302a44, 0x4902c84
.long 0x6d02fe8, 0x7f03228, 0x2502ad8, 0x5b02d18
.long 0x7f02fec, 0x910322c, 0x3702b6c, 0x6d02dac
.long 0x9102ff0, 0xa303230, 0x4902c00, 0x7f02e40
.long 0xa302ff4, 0x103234, 0x5b02c94, 0x9102ed4
.long 0x102ff8, 0x2503238, 0x6d02d28, 0xa302668
.long 0x1302ffc, 0x370323c, 0x7f02dbc, 0x1026fc
.long 0x2503000, 0x4903240, 0x9102e50, 0x1302790
.long 0x3703004, 0x5b03244, 0xa302ee4, 0x2502824
.long 0x4903008, 0x6d03248, 0x102678, 0x49028b8
.long 0x5b0300c, 0x7f0324c, 0x130270c, 0x5b0294c
.long 0x203060, 0x14032a0, 0x6e027f0, 0x9202a30
.long 0x1403064, 0x26032a4, 0x8002884, 0xa402ac4
.long 0x2603068, 0x38032a8, 0x9202918, 0x202b58
.long 0x380306c, 0x4a032ac, 0xa4029ac, 0x1402bec
.long 0x4a03070, 0x5c032b0, 0x202a40, 0x3802c80
.long 0x5c03074, 0x6e032b4, 0x1402ad4, 0x4a02d14
.long 0x6e03078, 0x80032b8, 0x2602b68, 0x5c02da8
.long 0x800307c, 0x92032bc, 0x3802bfc, 0x6e02e3c
.long 0x9203080, 0xa4032c0, 0x4a02c90, 0x8002ed0
.long 0xa403084, 0x2032c4, 0x5c02d24, 0x9202664
.long 0x203088, 0x26032c8, 0x6e02db8, 0xa4026f8
.long 0x140308c, 0x38032cc, 0x8002e4c, 0x20278c
.long 0x2603090, 0x4a032d0, 0x9202ee0, 0x1402820
.long 0x3803094, 0x5c032d4, 0xa402674, 0x26028b4
.long 0x4a03098, 0x6e032d8, 0x202708, 0x4a02948
.long 0x5c0309c, 0x80032dc, 0x140279c, 0x5c029dc
.long 0x3030f0, 0x1503330, 0x6f02880, 0x9302ac0
.long 0x15030f4, 0x2703334, 0x8102914, 0xa502b54
.long 0x27030f8, 0x3903338, 0x93029a8, 0x302be8
.long 0x39030fc, 0x4b0333c, 0xa502a3c, 0x1502c7c
.long 0x4b03100, 0x5d03340, 0x302ad0, 0x3902d10
.long 0x5d03104, 0x6f03344, 0x1502b64, 0x4b02da4
.long 0x6f03108, 0x8103348, 0x2702bf8, 0x5d02e38
.long 0x810310c, 0x930334c, 0x3902c8c, 0x6f02ecc
.long 0x9303110, 0xa503350, 0x4b02d20, 0x8102660
.long 0xa503114, 0x303354, 0x5d02db4, 0x93026f4
.long 0x303118, 0x2703358, 0x6f02e48, 0xa502788
.long 0x150311c, 0x390335c, 0x8102edc, 0x30281c
.long 0x2703120, 0x4b03360, 0x9302670, 0x15028b0
.long 0x3903124, 0x5d03364, 0xa502704, 0x2702944
.long 0x4b03128, 0x6f03368, 0x302798, 0x4b029d8
.long 0x5d0312c, 0x810336c, 0x150282c, 0x5d02a6c
.long 0x24033c0, 0x6c03010, 0x2640, 0x0
.long 0x36033c4, 0x7e030a4, 0x426d0, 0x0
.long 0x48033c8, 0x9003138, 0x82760, 0x0
.long 0x5a033cc, 0xa2031cc, 0xc27f0, 0x0
.long 0x6c033d0, 0x3260, 0x102880, 0x0
.long 0x7e033d4, 0x12032f4, 0x142910, 0x0
.long 0x90033d8, 0x2403388, 0x1829a0, 0x0
.long 0xa2033dc, 0x360341c, 0x1c2a30, 0x0
.long 0x33e0, 0x5a034b0, 0x202ac0, 0x0
.long 0x12033e4, 0x6c02fa4, 0x242b50, 0x0
.long 0x24033e8, 0x7e030a0, 0x282be0, 0x0
.long 0x36033ec, 0x9003134, 0x2c2c70, 0x0
.long 0x48033f0, 0xa2031c8, 0x302d00, 0x0
.long 0x5a033f4, 0x325c, 0x342d90, 0x0
.long 0x6c033f8, 0x12032f0, 0x382e20, 0x0
.long 0x7e033fc, 0x2403384, 0x3c2eb0, 0x0
.long 0x25033c0, 0x6d03418, 0x402650, 0x0
.long 0x37033c4, 0x7f034ac, 0x4426e0, 0x0
.long 0x49033c8, 0x9102fa0, 0x482770, 0x0
.long 0x5b033cc, 0xa303034, 0x4c2800, 0x0
.long 0x6d033d0, 0x103130, 0x502890, 0x0
.long 0x7f033d4, 0x13031c4, 0x542920, 0x0
.long 0x91033d8, 0x2503258, 0x5829b0, 0x0
.long 0xa3033dc, 0x37032ec, 0x5c2a40, 0x0
.long 0x1033e0, 0x5b03380, 0x602ad0, 0x0
.long 0x13033e4, 0x6d03414, 0x642b60, 0x0
.long 0x25033e8, 0x7f034a8, 0x682bf0, 0x0
.long 0x37033ec, 0x9102f9c, 0x6c2c80, 0x0
.long 0x49033f0, 0xa303030, 0x702d10, 0x0
.long 0x5b033f4, 0x1030c4, 0x742da0, 0x0
.long 0x6d033f8, 0x13031c0, 0x782e30, 0x0
.long 0x7f033fc, 0x2503254, 0x7c2ec0, 0x0
.long 0x2603450, 0x6e032e8, 0x802660, 0x0
.long 0x3803454, 0x800337c, 0x8426f0, 0x0
.long 0x4a03458, 0x9203410, 0x882780, 0x0
.long 0x5c0345c, 0xa4034a4, 0x8c2810, 0x0
.long 0x6e03460, 0x202f98, 0x9028a0, 0x0
.long 0x8003464, 0x140302c, 0x942930, 0x0
.long 0x9203468, 0x26030c0, 0x9829c0, 0x0
.long 0xa40346c, 0x3803154, 0x9c2a50, 0x0
.long 0x203470, 0x5c03250, 0xa02ae0, 0x0
.long 0x1403474, 0x6e032e4, 0xa42b70, 0x0
.long 0x2603478, 0x8003378, 0xa82c00, 0x0
.long 0x380347c, 0x920340c, 0xac2c90, 0x0
.long 0x4a03480, 0xa4034a0, 0xb02d20, 0x0
.long 0x5c03484, 0x202f94, 0xb42db0, 0x0
.long 0x6e03488, 0x1403028, 0xb82e40, 0x0
.long 0x800348c, 0x26030bc, 0xbc2ed0, 0x0
.long 0x2703450, 0x6f03150, 0xc02670, 0x0
.long 0x3903454, 0x81031e4, 0xc42700, 0x0
.long 0x4b03458, 0x93032e0, 0xc82790, 0x0
.long 0x5d0345c, 0xa503374, 0xcc2820, 0x0
.long 0x6f03460, 0x303408, 0xd028b0, 0x0
.long 0x8103464, 0x150349c, 0xd42940, 0x0
.long 0x9303468, 0x2702f90, 0xd829d0, 0x0
.long 0xa50346c, 0x3903024, 0xdc2a60, 0x0
.long 0x303470, 0x5d030b8, 0xe02af0, 0x0
.long 0x1503474, 0x6f0314c, 0xe42b80, 0x0
.long 0x2703478, 0x81031e0, 0xe82c10, 0x0
.long 0x390347c, 0x9303274, 0xec2ca0, 0x0
.long 0x4b03480, 0xa503370, 0xf02d30, 0x0
.long 0x5d03484, 0x303404, 0xf42dc0, 0x0
.long 0x6f03488, 0x1503498, 0xf82e50, 0x0
.long 0x810348c, 0x2702f8c, 0xfc2ee0, 0x0
L_ctab:
.long 0xffffffff, 0xffffff, 0xffff, 0xffff, 0xffffffff, 0x1fff, 0x11111111, 0x11111111, 0x7fff7fff, 0x80008000, 0xffff0000, 0x0, 0x2800000, 0x280, 0x43800000, 0x41000000, 0x40004000, 0x1, 0xa, 0x3a38aa3b
.size L_tab, .-L_tab
.section .rodata,"a"
.p2align 6
.amdhsa_kernel standalone__factorization_afm__recsys_kernel
  .amdhsa_next_free_vgpr 384
  .amdhsa_next_free_sgpr 102
  .amdhsa_accum_offset 256
  .amdhsa_group_segment_fixed_size 0
  .amdhsa_kernarg_size 88
  .amdhsa_user_sgpr_count 2
  .amdhsa_user_sgpr_kernarg_segment_ptr 1
  .amdhsa_system_sgpr_workgroup_id_x 1
.end_amdhsa_kernel
```

```asm
; @launch grid=(256,1,1) block=(256,1,1) lds=116992
.amdgcn_target "amdgcn-amd-amdhsa--gfx950"
.text
.globl standalone__factorization_afm__recsys_kernel
.p2align 12
.fill 832, 4, 0xbf800000
.p2align 8
.type standalone__factorization_afm__recsys_kernel,@function
standalone__factorization_afm__recsys_kernel:
    s_load_dwordx16 s[16:31], s[0:1], 0
    s_cmp_ge_u32 s2, 256
    s_cbranch_scc1 L_end
    s_getpc_b64 s[96:97]
L_pc:
    v_and_b32 v1, 63, v0
    v_lshlrev_b32 v244, 4, v1
    v_add_u32 v244, L_tab-L_pc, v244
    global_load_dwordx4 v[128:131], v244, s[96:97]
    s_bfe_u32 s7, s2, 0x20003
    s_lshl_b32 s7, s7, 13
    v_lshl_add_u32 v200, v0, 5, s7
    v_lshrrev_b32 v2, 6, v0
    v_min_u32 v200, L_end-L_pc, v200
    v_readfirstlane_b32 s3, v2
    global_load_dword v251, v200, s[96:97]
    global_load_dwordx2 v[132:133], v244, s[96:97] offset:1024
    v_bfe_u32 v4, v0, 4, 2
    s_and_b32 s4, s2, 7
    s_lshr_b32 s6, s2, 3
    s_lshl_b32 s4, s4, 5
    s_add_u32 s4, s4, s6
    s_lshl2_add_u32 s4, s4, s3
    s_mul_i32 s6, s4, 104
    s_add_u32 s7, s6, 76
    v_lshlrev_b32 v123, 4, v0
    v_and_b32 v14, 0xf0, v123
    v_mad_u32_u24 v121, v4, 28, s6
    v_and_b32 v126, 31, v0
    v_lshlrev_b32 v125, 6, v2
    v_min_u32 v122, s7, v121
    v_lshl_or_b32 v126, v126, 1, v125
    v_lshlrev_b32 v125, 2, v1
    v_add_u32 v112, 4096, v123
    v_add_u32 v113, 12288, v123
    v_add_u32 v114, 20480, v123
    v_add_u32 v115, 28672, v123
    s_waitcnt lgkmcnt(0)
    global_load_dwordx4 v[204:207], v121, s[16:17]
    global_load_dwordx3 v[208:210], v122, s[16:17] offset:16
    s_barrier
    global_load_dwordx4 v[48:51], v112, s[24:25] offset:-4096
    global_load_dwordx4 v[52:55], v112, s[24:25] offset:0
    global_load_dwordx4 v[56:59], v113, s[24:25] offset:-4096
    global_load_dwordx4 v[60:63], v113, s[24:25] offset:0
    global_load_dwordx4 v[64:67], v114, s[24:25] offset:-4096
    global_load_dwordx4 v[68:71], v114, s[24:25] offset:0
    global_load_dwordx4 v[72:75], v115, s[24:25] offset:-4096
    global_load_dwordx4 v[76:79], v115, s[24:25] offset:0
    global_load_dwordx4 v[220:223], v14, s[28:29]
    global_load_ushort v13, v126, s[28:29]
    global_load_ushort v12, v126, s[26:27]
    global_load_dword v252, v125, s[30:31]
    s_load_dwordx2 s[32:33], s[0:1], 64
    s_add_u32 s94, s96, L_ctab-L_pc
    s_addc_u32 s95, s97, 0
    s_load_dwordx16 s[36:51], s[94:95], 0
    s_load_dwordx4 s[52:55], s[94:95], 64
    s_mov_b32 s56, s18
    s_mov_b32 s57, s19
    s_mov_b32 s58, 25600000
    s_mov_b32 s59, 0x00020000
    s_mul_i32 s5, s3, 19008
    s_lshr_b32 s7, s3, 1
    s_mul_i32 s6, s3, 1152
    s_lshl_b32 s7, s7, 7
    s_add_u32 s6, s6, s7
    s_lshl_b32 s8, s3, 7
    s_add_u32 s5, s5, 40960
    v_lshlrev_b32 v127, 4, v1
    v_lshl_add_u32 v3, v2, 2, v127
    s_mov_b64 exec, 0
    s_cmp_eq_u32 s3, 0
    s_cbranch_scc1 L_pad0
    s_cmp_eq_u32 s3, 1
    s_cbranch_scc1 L_pad1
    s_cmp_eq_u32 s3, 2
    s_cbranch_scc1 L_pad2
    s_branch L_pad3
L_hopret:
    s_mov_b64 exec, -1
    s_waitcnt vmcnt(16)
    v_add_u32_sdwa v5, v128, s6 dst_sel:DWORD dst_unused:UNUSED_PAD src0_sel:WORD_0 src1_sel:DWORD
    s_waitcnt vmcnt(13)
    v_lshl_add_u32 v204, v204, 8, v14
    v_lshl_add_u32 v205, v205, 8, v14
    v_lshl_add_u32 v206, v206, 8, v14
    v_lshl_add_u32 v207, v207, 8, v14
    buffer_load_dwordx4 v[144:147], v204, s[56:59], 0 offen
    buffer_load_dwordx4 v[148:151], v205, s[56:59], 0 offen
    buffer_load_dwordx4 v[152:155], v206, s[56:59], 0 offen
    buffer_load_dwordx4 v[156:159], v207, s[56:59], 0 offen
    s_waitcnt vmcnt(16)
    v_lshl_add_u32 v208, v208, 8, v14
    v_lshl_add_u32 v209, v209, 8, v14
    v_lshl_add_u32 v210, v210, 8, v14
    v_add_u32_sdwa v7, v128, s8 dst_sel:DWORD dst_unused:UNUSED_PAD src0_sel:WORD_1 src1_sel:DWORD
    v_add_u32_sdwa v8, v129, s8 dst_sel:DWORD dst_unused:UNUSED_PAD src0_sel:WORD_0 src1_sel:DWORD
    v_lshrrev_b32 v9, 16, v129
    v_and_b32 v6, 0xffff, v130
    v_lshrrev_b32 v15, 16, v130
    v_lshrrev_b32 v0, 16, v130
    v_add_u32_sdwa v203, v131, s5 dst_sel:DWORD dst_unused:UNUSED_PAD src0_sel:WORD_0 src1_sel:DWORD
    v_add_u32_sdwa v246, v131, s5 dst_sel:DWORD dst_unused:UNUSED_PAD src0_sel:WORD_1 src1_sel:DWORD
    v_add_u32_sdwa v201, v132, s5 dst_sel:DWORD dst_unused:UNUSED_PAD src0_sel:WORD_0 src1_sel:DWORD
    v_add_u32_sdwa v245, v132, s5 dst_sel:DWORD dst_unused:UNUSED_PAD src0_sel:WORD_1 src1_sel:DWORD
    v_add_u32_sdwa v202, v133, s5 dst_sel:DWORD dst_unused:UNUSED_PAD src0_sel:WORD_0 src1_sel:DWORD
    v_lshrrev_b32 v10, 16, v133
    s_mov_b32 s13, 0xffff0000
    s_mov_b32 s90, 0x11111111
    s_mov_b32 s91, 0x11111111
L_wconv:
    s_waitcnt vmcnt(15)
    v_lshlrev_b32 v96, 16, v48
    v_and_b32 v97, s13, v48
    v_lshlrev_b32 v98, 16, v49
    v_and_b32 v99, s13, v49
    v_lshlrev_b32 v100, 16, v50
    v_and_b32 v101, s13, v50
    v_lshlrev_b32 v102, 16, v51
    v_and_b32 v103, s13, v51
    v_cvt_pkrtz_f16_f32 v16, v96, v97
    v_cvt_pkrtz_f16_f32 v17, v98, v99
    v_cvt_pkrtz_f16_f32 v18, v100, v101
    v_cvt_pkrtz_f16_f32 v19, v102, v103
    ds_write_b128 v5, v[16:19] offset:0
    v_or_b32 v248, v16, v17
    v_or3_b32 v248, v248, v18, v19
    s_waitcnt vmcnt(14)
    v_lshlrev_b32 v104, 16, v52
    v_and_b32 v105, s13, v52
    v_lshlrev_b32 v106, 16, v53
    v_and_b32 v107, s13, v53
    v_lshlrev_b32 v108, 16, v54
    v_and_b32 v109, s13, v54
    v_lshlrev_b32 v110, 16, v55
    v_and_b32 v111, s13, v55
    v_cvt_pkrtz_f16_f32 v20, v104, v105
    v_cvt_pkrtz_f16_f32 v21, v106, v107
    v_cvt_pkrtz_f16_f32 v22, v108, v109
    v_cvt_pkrtz_f16_f32 v23, v110, v111
    ds_write_b128 v5, v[20:23] offset:4736
    v_or3_b32 v248, v248, v20, v21
    v_or3_b32 v248, v248, v22, v23
    s_waitcnt vmcnt(13)
    v_lshlrev_b32 v96, 16, v56
    v_and_b32 v97, s13, v56
    v_lshlrev_b32 v98, 16, v57
    v_and_b32 v99, s13, v57
    v_lshlrev_b32 v100, 16, v58
    v_and_b32 v101, s13, v58
    v_lshlrev_b32 v102, 16, v59
    v_and_b32 v103, s13, v59
    v_cvt_pkrtz_f16_f32 v24, v96, v97
    v_cvt_pkrtz_f16_f32 v25, v98, v99
    v_cvt_pkrtz_f16_f32 v26, v100, v101
    v_cvt_pkrtz_f16_f32 v27, v102, v103
    ds_write_b128 v5, v[24:27] offset:9472
    v_or3_b32 v248, v248, v24, v25
    v_or3_b32 v248, v248, v26, v27
    s_waitcnt vmcnt(12)
    v_lshlrev_b32 v104, 16, v60
    v_and_b32 v105, s13, v60
    v_lshlrev_b32 v106, 16, v61
    v_and_b32 v107, s13, v61
    v_lshlrev_b32 v108, 16, v62
    v_and_b32 v109, s13, v62
    v_lshlrev_b32 v110, 16, v63
    v_and_b32 v111, s13, v63
    v_cvt_pkrtz_f16_f32 v28, v104, v105
    v_cvt_pkrtz_f16_f32 v29, v106, v107
    v_cvt_pkrtz_f16_f32 v30, v108, v109
    v_cvt_pkrtz_f16_f32 v31, v110, v111
    ds_write_b128 v5, v[28:31] offset:14208
    v_or3_b32 v248, v248, v28, v29
    v_or3_b32 v248, v248, v30, v31
    s_waitcnt vmcnt(11)
    v_lshlrev_b32 v96, 16, v64
    v_and_b32 v97, s13, v64
    v_lshlrev_b32 v98, 16, v65
    v_and_b32 v99, s13, v65
    v_lshlrev_b32 v100, 16, v66
    v_and_b32 v101, s13, v66
    v_lshlrev_b32 v102, 16, v67
    v_and_b32 v103, s13, v67
    v_cvt_pkrtz_f16_f32 v32, v96, v97
    v_cvt_pkrtz_f16_f32 v33, v98, v99
    v_cvt_pkrtz_f16_f32 v34, v100, v101
    v_cvt_pkrtz_f16_f32 v35, v102, v103
    ds_write_b128 v5, v[32:35] offset:18944
    v_or3_b32 v248, v248, v32, v33
    s_waitcnt vmcnt(7)
    v_dot2_f32_bf16 v112, v48, v220, 0
    v_or3_b32 v248, v248, v34, v35
    v_dot2_f32_bf16 v113, v52, v220, 0
    v_dot2_f32_bf16 v112, v49, v221, v112
    v_dot2_f32_bf16 v113, v53, v221, v113
    v_dot2_f32_bf16 v112, v50, v222, v112
    v_dot2_f32_bf16 v113, v54, v222, v113
    v_dot2_f32_bf16 v112, v51, v223, v112
    v_dot2_f32_bf16 v113, v55, v223, v113
    v_dot2_f32_bf16 v114, v56, v220, 0
    v_dot2_f32_bf16 v115, v60, v220, 0
    v_lshlrev_b32 v104, 16, v68
    v_and_b32 v105, s13, v68
    v_lshlrev_b32 v106, 16, v69
    v_and_b32 v107, s13, v69
    v_lshlrev_b32 v108, 16, v70
    v_and_b32 v109, s13, v70
    v_lshlrev_b32 v110, 16, v71
    v_and_b32 v111, s13, v71
    v_cvt_pkrtz_f16_f32 v36, v104, v105
    v_cvt_pkrtz_f16_f32 v37, v106, v107
    v_cvt_pkrtz_f16_f32 v38, v108, v109
    v_cvt_pkrtz_f16_f32 v39, v110, v111
    ds_write_b128 v5, v[36:39] offset:23680
    v_or3_b32 v248, v248, v36, v37
    v_dot2_f32_bf16 v114, v57, v221, v114
    v_or3_b32 v248, v248, v38, v39
    v_dot2_f32_bf16 v115, v61, v221, v115
    v_dot2_f32_bf16 v114, v58, v222, v114
    v_dot2_f32_bf16 v115, v62, v222, v115
    v_dot2_f32_bf16 v114, v59, v223, v114
    v_dot2_f32_bf16 v115, v63, v223, v115
    v_add_f32_dpp v112, v112, v112 row_ror:8 row_mask:0xf bank_mask:0x3
    v_dot2_f32_bf16 v116, v64, v220, 0
    v_dot2_f32_bf16 v117, v68, v220, 0
    v_dot2_f32_bf16 v116, v65, v221, v116
    v_lshlrev_b32 v96, 16, v72
    v_and_b32 v97, s13, v72
    v_lshlrev_b32 v98, 16, v73
    v_and_b32 v99, s13, v73
    v_lshlrev_b32 v100, 16, v74
    v_and_b32 v101, s13, v74
    v_lshlrev_b32 v102, 16, v75
    v_and_b32 v103, s13, v75
    v_cvt_pkrtz_f16_f32 v40, v96, v97
    v_cvt_pkrtz_f16_f32 v41, v98, v99
    v_cvt_pkrtz_f16_f32 v42, v100, v101
    v_cvt_pkrtz_f16_f32 v43, v102, v103
    ds_write_b128 v5, v[40:43] offset:28416
    v_or3_b32 v248, v248, v40, v41
    v_dot2_f32_bf16 v117, v69, v221, v117
    v_or3_b32 v248, v248, v42, v43
    v_add_f32_dpp v112, v113, v113 row_ror:8 row_mask:0xf bank_mask:0xc
    v_add_f32_dpp v114, v114, v114 row_ror:8 row_mask:0xf bank_mask:0x3
    v_dot2_f32_bf16 v116, v66, v222, v116
    v_dot2_f32_bf16 v117, v70, v222, v117
    v_dot2_f32_bf16 v116, v67, v223, v116
    v_dot2_f32_bf16 v117, v71, v223, v117
    v_add_f32_dpp v114, v115, v115 row_ror:8 row_mask:0xf bank_mask:0xc
    v_add_f32_dpp v112, v112, v112 row_half_mirror row_mask:0xf bank_mask:0x5
    v_dot2_f32_bf16 v118, v72, v220, 0
    v_lshlrev_b32 v104, 16, v76
    v_and_b32 v105, s13, v76
    v_lshlrev_b32 v106, 16, v77
    v_and_b32 v107, s13, v77
    v_lshlrev_b32 v108, 16, v78
    v_and_b32 v109, s13, v78
    v_lshlrev_b32 v110, 16, v79
    v_and_b32 v111, s13, v79
    v_cvt_pkrtz_f16_f32 v44, v104, v105
    v_cvt_pkrtz_f16_f32 v45, v106, v107
    v_cvt_pkrtz_f16_f32 v46, v108, v109
    v_cvt_pkrtz_f16_f32 v47, v110, v111
    ds_write_b128 v5, v[44:47] offset:33152
    v_or3_b32 v248, v248, v44, v45
    v_dot2_f32_bf16 v119, v76, v220, 0
    v_or3_b32 v248, v248, v46, v47
    v_dot2_f32_bf16 v118, v73, v221, v118
    v_dot2_f32_bf16 v119, v77, v221, v119
    v_add_f32_dpp v112, v114, v114 row_half_mirror row_mask:0xf bank_mask:0xa
    v_add_f32_dpp v116, v116, v116 row_ror:8 row_mask:0xf bank_mask:0x3
    v_dot2_f32_bf16 v118, v74, v222, v118
    v_dot2_f32_bf16 v119, v78, v222, v119
    v_dot2_f32_bf16 v118, v75, v223, v118
    v_dot2_f32_bf16 v119, v79, v223, v119
    v_add_f32_dpp v116, v117, v117 row_ror:8 row_mask:0xf bank_mask:0xc
    v_add_f32_dpp v112, v112, v112 quad_perm:[1,0,3,2] row_mask:0xf bank_mask:0xf
    v_cmp_lt_u32 vcc, 31, v1
    v_add_f32_dpp v118, v118, v118 row_ror:8 row_mask:0xf bank_mask:0x3
    v_add_f32_dpp v116, v116, v116 row_half_mirror row_mask:0xf bank_mask:0x5
    s_waitcnt vmcnt(5)
    v_cndmask_b32 v120, v12, v13, vcc
    v_add_f32_dpp v118, v119, v119 row_ror:8 row_mask:0xf bank_mask:0xc
    v_add_f32_dpp v112, v112, v112 quad_perm:[2,3,0,1] row_mask:0xf bank_mask:0xf
    v_lshlrev_b32 v120, 16, v120
    v_add_f32_dpp v116, v118, v118 row_half_mirror row_mask:0xf bank_mask:0xa
    v_ldexp_f32 v120, v120, v9
    ds_write_b32 v3, v248 offset:39424
    v_add_f32_dpp v116, v116, v116 quad_perm:[1,0,3,2] row_mask:0xf bank_mask:0xf
    ds_write_b32 v8, v120 offset:37888
    s_nop 0
    v_add_f32_dpp v113, v116, v116 quad_perm:[2,3,0,1] row_mask:0xf bank_mask:0xf
    s_mov_b64 exec, s[90:91]
    ds_write_b64 v7, v[112:113]
    s_mov_b64 exec, -1
    s_waitcnt lgkmcnt(0)
    s_barrier
    ds_read_b128 v[112:115], v127 offset:39424
    ds_read_b64_tr_b16 a[0:1], v6 offset:0
    ds_read_b64_tr_b16 a[2:3], v6 offset:1152
    ds_read_b64_tr_b16 a[4:5], v6 offset:9472
    ds_read_b64_tr_b16 a[6:7], v6 offset:10624
    ds_read_b64_tr_b16 a[8:9], v6 offset:18944
    ds_read_b64_tr_b16 a[10:11], v6 offset:20096
    ds_read_b64_tr_b16 a[12:13], v6 offset:28416
    ds_read_b64_tr_b16 a[14:15], v6 offset:29568
    ds_read_b64_tr_b16 a[16:17], v6 offset:32
    ds_read_b64_tr_b16 a[18:19], v6 offset:1184
    ds_read_b64_tr_b16 a[20:21], v6 offset:9504
    ds_read_b64_tr_b16 a[22:23], v6 offset:10656
    ds_read_b64_tr_b16 a[24:25], v6 offset:18976
    ds_read_b64_tr_b16 a[26:27], v6 offset:20128
    ds_read_b64_tr_b16 a[28:29], v6 offset:28448
    ds_read_b64_tr_b16 a[30:31], v6 offset:29600
    ds_read_b64_tr_b16 a[32:33], v6 offset:64
    ds_read_b64_tr_b16 a[34:35], v6 offset:1216
    ds_read_b64_tr_b16 a[36:37], v6 offset:9536
    ds_read_b64_tr_b16 a[38:39], v6 offset:10688
    ds_read_b64_tr_b16 a[40:41], v6 offset:19008
    ds_read_b64_tr_b16 a[42:43], v6 offset:20160
    ds_read_b64_tr_b16 a[44:45], v6 offset:28480
    ds_read_b64_tr_b16 a[46:47], v6 offset:29632
    ds_read_b64_tr_b16 a[48:49], v6 offset:96
    ds_read_b64_tr_b16 a[50:51], v6 offset:1248
    ds_read_b64_tr_b16 a[52:53], v6 offset:9568
    ds_read_b64_tr_b16 a[54:55], v6 offset:10720
    ds_read_b64_tr_b16 a[56:57], v6 offset:19040
    ds_read_b64_tr_b16 a[58:59], v6 offset:20192
    ds_read_b64_tr_b16 a[60:61], v6 offset:28512
    ds_read_b64_tr_b16 a[62:63], v6 offset:29664
    s_waitcnt lgkmcnt(15)
    v_or3_b32 v112, v112, v113, v114
    v_or_b32 v112, v112, v115
    v_and_b32 v121, s52, v112
    v_and_b32 v122, 0x20002000, v112
    v_cmp_ne_u32 vcc, 0, v121
    v_cmp_ge_u32 s[92:93], v122, s53
    s_cbranch_vccnz L_wfix
    s_cmp_eq_u64 s[92:93], 0
    s_cbranch_scc1 L_wfix
    buffer_load_dwordx4 v[160:163], v208, s[56:59], 0 offen
    buffer_load_dwordx4 v[164:167], v209, s[56:59], 0 offen
    buffer_load_dwordx4 v[168:171], v210, s[56:59], 0 offen
    global_load_dwordx4 v[232:235], v244, s[96:97] offset:2048
    global_load_dwordx3 v[236:238], v244, s[96:97] offset:3072
L_econv:
    s_waitcnt vmcnt(8)
    v_lshl_add_u32 v96, v144, 16, s48
    v_add_u32_sdwa v97, v144, s49 dst_sel:WORD_1 dst_unused:UNUSED_PAD src0_sel:WORD_1 src1_sel:DWORD
    v_lshl_add_u32 v98, v145, 16, s48
    v_add_u32_sdwa v99, v145, s49 dst_sel:WORD_1 dst_unused:UNUSED_PAD src0_sel:WORD_1 src1_sel:DWORD
    v_lshl_add_u32 v100, v146, 16, s48
    v_add_u32_sdwa v101, v146, s49 dst_sel:WORD_1 dst_unused:UNUSED_PAD src0_sel:WORD_1 src1_sel:DWORD
    v_lshl_add_u32 v102, v147, 16, s48
    v_add_u32_sdwa v103, v147, s49 dst_sel:WORD_1 dst_unused:UNUSED_PAD src0_sel:WORD_1 src1_sel:DWORD
    v_cvt_pkrtz_f16_f32 v172, v96, v97
    v_max_f32 v248, |v96|, |v97|
    v_cvt_pkrtz_f16_f32 v173, v98, v99
    v_max_f32 v249, |v98|, |v99|
    v_cvt_pkrtz_f16_f32 v174, v100, v101
    v_max3_f32 v248, v248, |v100|, |v101|
    v_cvt_pkrtz_f16_f32 v175, v102, v103
    v_max3_f32 v249, v249, |v102|, |v103|
    ds_write_b128 v203, v[172:175] offset:0
    ds_read_b128 v[16:19], v0 offset:37888
    ds_read_b128 v[20:23], v0 offset:37952
    ds_read_b128 v[24:27], v0 offset:38016
    ds_read_b128 v[28:31], v0 offset:38080
    ds_read_b128 v[32:35], v0 offset:38144
    s_waitcnt vmcnt(7)
    v_lshl_add_u32 v104, v148, 16, s48
    v_add_u32_sdwa v105, v148, s49 dst_sel:WORD_1 dst_unused:UNUSED_PAD src0_sel:WORD_1 src1_sel:DWORD
    v_lshl_add_u32 v106, v149, 16, s48
    v_add_u32_sdwa v107, v149, s49 dst_sel:WORD_1 dst_unused:UNUSED_PAD src0_sel:WORD_1 src1_sel:DWORD
    v_lshl_add_u32 v108, v150, 16, s48
    v_add_u32_sdwa v109, v150, s49 dst_sel:WORD_1 dst_unused:UNUSED_PAD src0_sel:WORD_1 src1_sel:DWORD
    v_lshl_add_u32 v110, v151, 16, s48
    v_add_u32_sdwa v111, v151, s49 dst_sel:WORD_1 dst_unused:UNUSED_PAD src0_sel:WORD_1 src1_sel:DWORD
    v_cvt_pkrtz_f16_f32 v176, v104, v105
    v_max3_f32 v248, v248, |v104|, |v105|
    v_cvt_pkrtz_f16_f32 v177, v106, v107
    v_max3_f32 v249, v249, |v106|, |v107|
    v_cvt_pkrtz_f16_f32 v178, v108, v109
    v_max3_f32 v248, v248, |v108|, |v109|
    v_cvt_pkrtz_f16_f32 v179, v110, v111
    v_max3_f32 v249, v249, |v110|, |v111|
    ds_write_b128 v203, v[176:179] offset:1152
    s_waitcnt vmcnt(6)
    v_lshl_add_u32 v96, v152, 16, s48
    v_add_u32_sdwa v97, v152, s49 dst_sel:WORD_1 dst_unused:UNUSED_PAD src0_sel:WORD_1 src1_sel:DWORD
    v_lshl_add_u32 v98, v153, 16, s48
    v_add_u32_sdwa v99, v153, s49 dst_sel:WORD_1 dst_unused:UNUSED_PAD src0_sel:WORD_1 src1_sel:DWORD
    v_lshl_add_u32 v100, v154, 16, s48
    v_add_u32_sdwa v101, v154, s49 dst_sel:WORD_1 dst_unused:UNUSED_PAD src0_sel:WORD_1 src1_sel:DWORD
    v_lshl_add_u32 v102, v155, 16, s48
    v_add_u32_sdwa v103, v155, s49 dst_sel:WORD_1 dst_unused:UNUSED_PAD src0_sel:WORD_1 src1_sel:DWORD
    v_cvt_pkrtz_f16_f32 v180, v96, v97
    v_cvt_pkrtz_f16_f32 v181, v98, v99
    v_cvt_pkrtz_f16_f32 v182, v100, v101
    v_cvt_pkrtz_f16_f32 v183, v102, v103
    ds_write_b128 v203, v[180:183] offset:2304
    s_waitcnt vmcnt(5)
    v_lshl_add_u32 v104, v156, 16, s48
    v_add_u32_sdwa v105, v156, s49 dst_sel:WORD_1 dst_unused:UNUSED_PAD src0_sel:WORD_1 src1_sel:DWORD
    v_lshl_add_u32 v106, v157, 16, s48
    v_add_u32_sdwa v107, v157, s49 dst_sel:WORD_1 dst_unused:UNUSED_PAD src0_sel:WORD_1 src1_sel:DWORD
    v_lshl_add_u32 v108, v158, 16, s48
    v_add_u32_sdwa v109, v158, s49 dst_sel:WORD_1 dst_unused:UNUSED_PAD src0_sel:WORD_1 src1_sel:DWORD
    v_lshl_add_u32 v110, v159, 16, s48
    v_add_u32_sdwa v111, v159, s49 dst_sel:WORD_1 dst_unused:UNUSED_PAD src0_sel:WORD_1 src1_sel:DWORD
    v_cvt_pkrtz_f16_f32 v184, v104, v105
    v_cvt_pkrtz_f16_f32 v185, v106, v107
    v_cvt_pkrtz_f16_f32 v186, v108, v109
    v_cvt_pkrtz_f16_f32 v187, v110, v111
    ds_write_b128 v203, v[184:187] offset:3456
    ds_read_b128 v[80:83], v246 offset:0
    ds_read_b128 v[128:131], v201 offset:0
    ds_read_b128 v[84:87], v246 offset:64
    ds_read_b128 v[132:135], v201 offset:64
    ds_read_b128 v[88:91], v246 offset:128
    ds_read_b128 v[136:139], v201 offset:128
    ds_read_b128 v[92:95], v246 offset:192
    ds_read_b128 v[140:143], v201 offset:192
    ds_read_b64_tr_b16 a[64:65], v6 offset:128
    ds_read_b64_tr_b16 a[66:67], v6 offset:1280
    ds_read_b64_tr_b16 a[68:69], v6 offset:9600
    ds_read_b64_tr_b16 a[70:71], v6 offset:10752
    ds_read_b64_tr_b16 a[72:73], v6 offset:19072
    ds_read_b64_tr_b16 a[74:75], v6 offset:20224
    ds_read_b64_tr_b16 a[76:77], v6 offset:28544
    ds_read_b64_tr_b16 a[78:79], v6 offset:29696
    v_max3_f32 v248, v248, |v96|, |v97|
    v_max3_f32 v249, v249, |v98|, |v99|
    v_max3_f32 v248, v248, |v100|, |v101|
    v_max3_f32 v249, v249, |v102|, |v103|
    v_max3_f32 v248, v248, |v104|, |v105|
    v_max3_f32 v249, v249, |v106|, |v107|
    v_max3_f32 v248, v248, |v108|, |v109|
    v_max3_f32 v249, v249, |v110|, |v111|
    s_waitcnt lgkmcnt(14)
    v_pk_mul_f16 v128, v128, v80
    v_pk_mul_f16 v129, v129, v81
    v_pk_mul_f16 v130, v130, v82
    v_pk_mul_f16 v131, v131, v83
    s_nop 1
    v_mfma_f32_16x16x32_f16 v[96:99], a[0:3], v[128:131], v[16:19]
    ds_read_b128 v[48:51], v15 offset:38400
    ds_read_b128 v[52:55], v15 offset:38464
    s_waitcnt lgkmcnt(14)
    v_pk_mul_f16 v132, v132, v84
    v_pk_mul_f16 v133, v133, v85
    v_mfma_f32_16x16x32_f16 v[100:103], a[16:19], v[128:131], v[20:23]
    ds_read_b128 v[56:59], v15 offset:38528
    ds_read_b128 v[60:63], v15 offset:38592
    v_pk_mul_f16 v134, v134, v86
    v_pk_mul_f16 v135, v135, v87
    v_mfma_f32_16x16x32_f16 v[104:107], a[32:35], v[128:131], v[24:27]
    ds_read_b128 v[36:39], v0 offset:38208
    ds_read_b64_tr_b16 a[80:81], v6 offset:160
    s_waitcnt lgkmcnt(15)
    v_pk_mul_f16 v136, v136, v88
    v_pk_mul_f16 v137, v137, v89
    v_mfma_f32_16x16x32_f16 v[96:99], a[4:7], v[132:135], v[96:99]
    ds_read_b64_tr_b16 a[82:83], v6 offset:1312
    ds_read_b64_tr_b16 a[84:85], v6 offset:9632
    v_pk_mul_f16 v138, v138, v90
    v_pk_mul_f16 v139, v139, v91
    v_mfma_f32_16x16x32_f16 v[100:103], a[20:23], v[132:135], v[100:103]
    ds_read_b64_tr_b16 a[86:87], v6 offset:10784
    ds_read_b64_tr_b16 a[88:89], v6 offset:19104
    s_waitcnt lgkmcnt(15)
    v_pk_mul_f16 v140, v140, v92
    v_pk_mul_f16 v141, v141, v93
    v_mfma_f32_16x16x32_f16 v[104:107], a[36:39], v[132:135], v[104:107]
    ds_read_b64_tr_b16 a[90:91], v6 offset:20256
    ds_read_b64_tr_b16 a[92:93], v6 offset:28576
    v_pk_mul_f16 v142, v142, v94
    v_pk_mul_f16 v143, v143, v95
    v_mov_b32_dpp v247, v246 row_ror:14 row_mask:0xf bank_mask:0xf
    ds_read_b128 v[156:159], v247 offset:192
    ds_read_b128 v[152:155], v247 offset:128
    ds_read_b128 v[148:151], v247 offset:64
    ds_read_b128 v[144:147], v247 offset:0
    v_mfma_f32_16x16x32_f16 v[96:99], a[8:11], v[136:139], v[96:99]
    ds_read_b64_tr_b16 a[94:95], v6 offset:29728
    ds_read_b128 v[64:67], v15 offset:38656
    ds_read2_b32 v[192:193], v10 offset0:0 offset1:8
    v_mov_b32 v251, 0xff800000
    v_mfma_f32_16x16x32_f16 v[100:103], a[24:27], v[136:139], v[100:103]
    ds_read_b128 v[40:43], v0 offset:38272
    ds_read_b64_tr_b16 a[108:109], v6 offset:28608
    v_mfma_f32_16x16x32_f16 v[104:107], a[40:43], v[136:139], v[104:107]
    ds_read_b64_tr_b16 a[110:111], v6 offset:29760
    ds_read_b64_tr_b16 a[104:105], v6 offset:19136
    v_mfma_f32_16x16x32_f16 v[96:99], a[12:15], v[140:143], v[96:99]
    ds_read_b64_tr_b16 a[106:107], v6 offset:20288
    ds_read_b64_tr_b16 a[100:101], v6 offset:9664
    v_mfma_f32_16x16x32_f16 v[100:103], a[28:31], v[140:143], v[100:103]
    ds_read_b64_tr_b16 a[102:103], v6 offset:10816
    ds_read_b64_tr_b16 a[96:97], v6 offset:192
    v_mfma_f32_16x16x32_f16 v[104:107], a[44:47], v[140:143], v[104:107]
    ds_read_b64_tr_b16 a[98:99], v6 offset:1344
    ds_read_b128 v[68:71], v15 offset:38720
    v_mfma_f32_16x16x32_f16 v[108:111], a[60:63], v[140:143], v[28:31]
    ds_read_b128 v[44:47], v0 offset:38336
    ds_read_b64_tr_b16 a[112:113], v6 offset:224
    s_waitcnt lgkmcnt(15)
    v_mul_f32 v184, |v96|, v48
    v_fma_f32 v184, |v97|, v49, v184
    v_mfma_f32_16x16x32_f16 v[108:111], a[56:59], v[136:139], v[108:111]
    ds_read_b64_tr_b16 a[114:115], v6 offset:1376
    ds_read_b64_tr_b16 a[116:117], v6 offset:9696
    v_fma_f32 v184, |v98|, v50, v184
    v_fma_f32 v184, |v99|, v51, v184
    v_mfma_f32_16x16x32_f16 v[108:111], a[52:55], v[132:135], v[108:111]
    ds_read_b64_tr_b16 a[118:119], v6 offset:10848
    ds_read_b64_tr_b16 a[120:121], v6 offset:19168
    v_pk_mul_f16 v144, v144, v80
    v_fma_f32 v184, |v100|, v52, v184
    v_mfma_f32_16x16x32_f16 v[108:111], a[48:51], v[128:131], v[108:111]
    ds_read_b64_tr_b16 a[122:123], v6 offset:20320
    ds_read_b64_tr_b16 a[124:125], v6 offset:28640
    v_and_b32 v253, s44, v252
    v_fma_f32 v184, |v101|, v53, v184
    v_mfma_f32_16x16x32_f16 v[112:115], a[64:67], v[128:131], v[32:35]
    ds_read_b64_tr_b16 a[126:127], v6 offset:29792
    ds_read_b128 v[72:75], v15 offset:38784
    v_pk_mul_f16 v145, v145, v81
    v_fma_f32 v184, |v102|, v54, v184
    v_mfma_f32_16x16x32_f16 v[112:115], a[68:71], v[132:135], v[112:115]
    ds_read_b128 v[76:79], v15 offset:38848
    v_pk_mul_f16 v146, v146, v82
    v_fma_f32 v184, |v103|, v55, v184
    v_mfma_f32_16x16x32_f16 v[112:115], a[72:75], v[136:139], v[112:115]
    v_pk_mul_f16 v147, v147, v83
    v_fma_f32 v184, |v104|, v56, v184
    v_mfma_f32_16x16x32_f16 v[112:115], a[76:79], v[140:143], v[112:115]
    v_pk_mul_f16 v148, v148, v84
    v_fma_f32 v184, |v105|, v57, v184
    s_waitcnt lgkmcnt(15)
    v_mfma_f32_16x16x32_f16 v[116:119], a[92:95], v[140:143], v[36:39]
    v_pk_mul_f16 v149, v149, v85
    v_fma_f32 v184, |v106|, v58, v184
    v_mfma_f32_16x16x32_f16 v[116:119], a[88:91], v[136:139], v[116:119]
    v_pk_mul_f16 v150, v150, v86
    v_fma_f32 v184, |v107|, v59, v184
    v_mfma_f32_16x16x32_f16 v[116:119], a[84:87], v[132:135], v[116:119]
    v_pk_mul_f16 v151, v151, v87
    v_fma_f32 v184, |v108|, v60, v184
    v_mfma_f32_16x16x32_f16 v[116:119], a[80:83], v[128:131], v[116:119]
    v_pk_mul_f16 v152, v152, v88
    v_fma_f32 v184, |v109|, v61, v184
    s_waitcnt lgkmcnt(12)
    v_mfma_f32_16x16x32_f16 v[120:123], a[96:99], v[128:131], v[40:43]
    v_pk_mul_f16 v153, v153, v89
    v_fma_f32 v184, |v110|, v62, v184
    v_mfma_f32_16x16x32_f16 v[120:123], a[100:103], v[132:135], v[120:123]
    v_pk_mul_f16 v154, v154, v90
    v_fma_f32 v184, |v111|, v63, v184
    v_mfma_f32_16x16x32_f16 v[120:123], a[104:107], v[136:139], v[120:123]
    v_pk_mul_f16 v155, v155, v91
    v_fma_f32 v184, |v112|, v64, v184
    v_mfma_f32_16x16x32_f16 v[120:123], a[108:111], v[140:143], v[120:123]
    v_pk_mul_f16 v156, v156, v92
    v_fma_f32 v184, |v113|, v65, v184
    s_waitcnt lgkmcnt(2)
    v_mfma_f32_16x16x32_f16 v[124:127], a[124:127], v[140:143], v[44:47]
    v_pk_mul_f16 v157, v157, v93
    v_fma_f32 v184, |v114|, v66, v184
    v_mfma_f32_16x16x32_f16 v[124:127], a[120:123], v[136:139], v[124:127]
    v_pk_mul_f16 v158, v158, v94
    v_fma_f32 v184, |v115|, v67, v184
    v_mfma_f32_16x16x32_f16 v[124:127], a[116:119], v[132:135], v[124:127]
    v_pk_mul_f16 v159, v159, v95
    v_fma_f32 v184, |v116|, v68, v184
    v_mfma_f32_16x16x32_f16 v[124:127], a[112:115], v[128:131], v[124:127]
    v_mov_b32_dpp v247, v246 row_ror:13 row_mask:0xf bank_mask:0xf
    v_fma_f32 v184, |v117|, v69, v184
    v_mfma_f32_16x16x32_f16 v[96:99], a[112:115], v[144:147], v[44:47]
    ds_read_b128 v[140:143], v247 offset:192
    v_fma_f32 v184, |v118|, v70, v184
    v_mfma_f32_16x16x32_f16 v[96:99], a[116:119], v[148:151], v[96:99]
    ds_read_b128 v[136:139], v247 offset:128
    v_fma_f32 v184, |v119|, v71, v184
    v_mfma_f32_16x16x32_f16 v[96:99], a[120:123], v[152:155], v[96:99]
    ds_read_b128 v[132:135], v247 offset:64
    s_waitcnt lgkmcnt(4)
    v_fma_f32 v184, |v120|, v72, v184
    v_mfma_f32_16x16x32_f16 v[96:99], a[124:127], v[156:159], v[96:99]
L_pad0:
    s_cbranch_execz L_hopret
    ds_read_b128 v[128:131], v247 offset:0
    v_fma_f32 v184, |v121|, v73, v184
    v_mfma_f32_16x16x32_f16 v[100:103], a[108:111], v[156:159], v[40:43]
    v_pk_max_u16 v254, v253, v253 op_sel:[0,1] op_sel_hi:[1,0]
    v_fma_f32 v184, |v122|, v74, v184
    v_mfma_f32_16x16x32_f16 v[100:103], a[104:107], v[152:155], v[100:103]
    v_max_f32 v255, |v192|, |v193|
    v_fma_f32 v184, |v123|, v75, v184
    v_mfma_f32_16x16x32_f16 v[100:103], a[100:103], v[148:151], v[100:103]
    v_max_u32_dpp v254, v254, v254 row_ror:8 row_mask:0xf bank_mask:0xf
    s_waitcnt lgkmcnt(4)
    v_fma_f32 v184, |v124|, v76, v184
    v_mfma_f32_16x16x32_f16 v[100:103], a[96:99], v[144:147], v[100:103]
    v_max_u32_dpp v255, v255, v255 row_ror:8 row_mask:0xf bank_mask:0xf
    v_fma_f32 v184, |v125|, v77, v184
    v_mfma_f32_16x16x32_f16 v[104:107], a[80:83], v[144:147], v[36:39]
    s_waitcnt vmcnt(4)
    v_lshl_add_u32 v220, v160, 16, s48
    v_fma_f32 v184, |v126|, v78, v184
    v_mfma_f32_16x16x32_f16 v[104:107], a[84:87], v[148:151], v[104:107]
    v_add_u32_sdwa v221, v160, s49 dst_sel:WORD_1 dst_unused:UNUSED_PAD src0_sel:WORD_1 src1_sel:DWORD
    v_fma_f32 v184, |v127|, v79, v184
    v_mfma_f32_16x16x32_f16 v[104:107], a[88:91], v[152:155], v[104:107]
    v_lshl_add_u32 v222, v161, 16, s48
    v_mul_f32 v185, |v96|, v76
    v_mfma_f32_16x16x32_f16 v[104:107], a[92:95], v[156:159], v[104:107]
    v_add_u32_sdwa v223, v161, s49 dst_sel:WORD_1 dst_unused:UNUSED_PAD src0_sel:WORD_1 src1_sel:DWORD
    v_fma_f32 v185, |v97|, v77, v185
    v_mfma_f32_16x16x32_f16 v[108:111], a[76:79], v[156:159], v[32:35]
    v_lshl_add_u32 v224, v162, 16, s48
    v_fma_f32 v185, |v98|, v78, v185
    v_mfma_f32_16x16x32_f16 v[108:111], a[72:75], v[152:155], v[108:111]
    v_add_u32_sdwa v225, v162, s49 dst_sel:WORD_1 dst_unused:UNUSED_PAD src0_sel:WORD_1 src1_sel:DWORD
    v_fma_f32 v185, |v99|, v79, v185
    v_mfma_f32_16x16x32_f16 v[108:111], a[68:71], v[148:151], v[108:111]
    v_lshl_add_u32 v226, v163, 16, s48
    v_fma_f32 v185, |v100|, v72, v185
    v_mfma_f32_16x16x32_f16 v[108:111], a[64:67], v[144:147], v[108:111]
    s_waitcnt lgkmcnt(0)
    v_pk_mul_f16 v128, v128, v80
    v_fma_f32 v185, |v101|, v73, v185
    v_mfma_f32_16x16x32_f16 v[112:115], a[48:51], v[144:147], v[28:31]
    v_pk_mul_f16 v129, v129, v81
    v_fma_f32 v185, |v102|, v74, v185
    v_mfma_f32_16x16x32_f16 v[112:115], a[52:55], v[148:151], v[112:115]
    v_pk_mul_f16 v130, v130, v82
    v_fma_f32 v185, |v103|, v75, v185
    v_mfma_f32_16x16x32_f16 v[112:115], a[56:59], v[152:155], v[112:115]
    v_pk_mul_f16 v131, v131, v83
    v_fma_f32 v185, |v104|, v68, v185
    v_mfma_f32_16x16x32_f16 v[112:115], a[60:63], v[156:159], v[112:115]
    v_pk_mul_f16 v132, v132, v84
    v_fma_f32 v185, |v105|, v69, v185
    v_mfma_f32_16x16x32_f16 v[116:119], a[44:47], v[156:159], v[24:27]
    v_pk_mul_f16 v133, v133, v85
    v_fma_f32 v185, |v106|, v70, v185
    v_mfma_f32_16x16x32_f16 v[116:119], a[40:43], v[152:155], v[116:119]
    v_pk_mul_f16 v134, v134, v86
    v_fma_f32 v185, |v107|, v71, v185
    v_mfma_f32_16x16x32_f16 v[116:119], a[36:39], v[148:151], v[116:119]
    v_pk_mul_f16 v135, v135, v87
    v_fma_f32 v185, |v108|, v64, v185
    v_mfma_f32_16x16x32_f16 v[116:119], a[32:35], v[144:147], v[116:119]
    v_pk_mul_f16 v136, v136, v88
    v_fma_f32 v185, |v109|, v65, v185
    v_mfma_f32_16x16x32_f16 v[120:123], a[16:19], v[144:147], v[20:23]
    v_pk_mul_f16 v137, v137, v89
    v_fma_f32 v185, |v110|, v66, v185
    v_mfma_f32_16x16x32_f16 v[120:123], a[20:23], v[148:151], v[120:123]
    v_pk_mul_f16 v138, v138, v90
    v_fma_f32 v185, |v111|, v67, v185
    v_mfma_f32_16x16x32_f16 v[120:123], a[24:27], v[152:155], v[120:123]
    v_pk_mul_f16 v139, v139, v91
    v_fma_f32 v185, |v112|, v60, v185
    v_mfma_f32_16x16x32_f16 v[120:123], a[28:31], v[156:159], v[120:123]
    v_pk_mul_f16 v140, v140, v92
    v_fma_f32 v185, |v113|, v61, v185
    v_mfma_f32_16x16x32_f16 v[124:127], a[12:15], v[156:159], v[16:19]
    v_pk_mul_f16 v141, v141, v93
    v_fma_f32 v185, |v114|, v62, v185
    v_mfma_f32_16x16x32_f16 v[124:127], a[8:11], v[152:155], v[124:127]
    v_pk_mul_f16 v142, v142, v94
    v_fma_f32 v185, |v115|, v63, v185
    v_mfma_f32_16x16x32_f16 v[124:127], a[4:7], v[148:151], v[124:127]
    v_pk_mul_f16 v143, v143, v95
    v_fma_f32 v185, |v116|, v56, v185
    v_mfma_f32_16x16x32_f16 v[124:127], a[0:3], v[144:147], v[124:127]
    v_mov_b32_dpp v247, v246 row_ror:12 row_mask:0xf bank_mask:0xf
    v_fma_f32 v185, |v117|, v57, v185
    v_mfma_f32_16x16x32_f16 v[96:99], a[0:3], v[128:131], v[16:19]
    ds_read_b128 v[156:159], v247 offset:192
    v_fma_f32 v185, |v118|, v58, v185
    v_mfma_f32_16x16x32_f16 v[96:99], a[4:7], v[132:135], v[96:99]
    ds_read_b128 v[152:155], v247 offset:128
    v_fma_f32 v185, |v119|, v59, v185
    v_mfma_f32_16x16x32_f16 v[96:99], a[8:11], v[136:139], v[96:99]
    ds_read_b128 v[148:151], v247 offset:64
    v_fma_f32 v185, |v120|, v52, v185
    v_mfma_f32_16x16x32_f16 v[96:99], a[12:15], v[140:143], v[96:99]
    ds_read_b128 v[144:147], v247 offset:0
    v_fma_f32 v185, |v121|, v53, v185
    v_mfma_f32_16x16x32_f16 v[100:103], a[28:31], v[140:143], v[20:23]
    v_add_u32_sdwa v227, v163, s49 dst_sel:WORD_1 dst_unused:UNUSED_PAD src0_sel:WORD_1 src1_sel:DWORD
    v_fma_f32 v185, |v122|, v54, v185
    v_mfma_f32_16x16x32_f16 v[100:103], a[24:27], v[136:139], v[100:103]
    v_cvt_pkrtz_f16_f32 v204, v220, v221
    v_fma_f32 v185, |v123|, v55, v185
    v_mfma_f32_16x16x32_f16 v[100:103], a[20:23], v[132:135], v[100:103]
    v_max3_f32 v248, v248, |v220|, |v221|
    v_fma_f32 v185, |v124|, v48, v185
    v_mfma_f32_16x16x32_f16 v[100:103], a[16:19], v[128:131], v[100:103]
    v_cvt_pkrtz_f16_f32 v205, v222, v223
    v_fma_f32 v185, |v125|, v49, v185
    v_mfma_f32_16x16x32_f16 v[104:107], a[32:35], v[128:131], v[24:27]
    v_max3_f32 v249, v249, |v222|, |v223|
    v_fma_f32 v185, |v126|, v50, v185
    v_mfma_f32_16x16x32_f16 v[104:107], a[36:39], v[132:135], v[104:107]
    v_cvt_pkrtz_f16_f32 v206, v224, v225
    v_fma_f32 v185, |v127|, v51, v185
    v_mfma_f32_16x16x32_f16 v[104:107], a[40:43], v[136:139], v[104:107]
    v_max3_f32 v248, v248, |v224|, |v225|
    v_mul_f32 v186, |v96|, v48
    v_mfma_f32_16x16x32_f16 v[104:107], a[44:47], v[140:143], v[104:107]
    v_cvt_pkrtz_f16_f32 v207, v226, v227
    v_fma_f32 v186, |v97|, v49, v186
    v_mfma_f32_16x16x32_f16 v[108:111], a[60:63], v[140:143], v[28:31]
    v_max3_f32 v249, v249, |v226|, |v227|
    v_fma_f32 v186, |v98|, v50, v186
    v_mfma_f32_16x16x32_f16 v[108:111], a[56:59], v[136:139], v[108:111]
    ds_write_b128 v203, v[204:207] offset:4608
    v_mfma_f32_16x16x32_f16 v[108:111], a[52:55], v[132:135], v[108:111]
    s_waitcnt vmcnt(3)
    v_lshl_add_u32 v220, v164, 16, s48
    v_fma_f32 v186, |v99|, v51, v186
    v_mfma_f32_16x16x32_f16 v[108:111], a[48:51], v[128:131], v[108:111]
    s_waitcnt lgkmcnt(1)
    v_pk_mul_f16 v144, v144, v80
    v_fma_f32 v186, |v100|, v52, v186
    v_mfma_f32_16x16x32_f16 v[112:115], a[64:67], v[128:131], v[32:35]
    v_pk_mul_f16 v145, v145, v81
    v_fma_f32 v186, |v101|, v53, v186
    v_mfma_f32_16x16x32_f16 v[112:115], a[68:71], v[132:135], v[112:115]
    v_pk_mul_f16 v146, v146, v82
    v_fma_f32 v186, |v102|, v54, v186
    v_mfma_f32_16x16x32_f16 v[112:115], a[72:75], v[136:139], v[112:115]
    v_pk_mul_f16 v147, v147, v83
    v_fma_f32 v186, |v103|, v55, v186
    v_mfma_f32_16x16x32_f16 v[112:115], a[76:79], v[140:143], v[112:115]
    v_pk_mul_f16 v148, v148, v84
    v_fma_f32 v186, |v104|, v56, v186
    v_mfma_f32_16x16x32_f16 v[116:119], a[92:95], v[140:143], v[36:39]
    v_pk_mul_f16 v149, v149, v85
    v_fma_f32 v186, |v105|, v57, v186
    v_mfma_f32_16x16x32_f16 v[116:119], a[88:91], v[136:139], v[116:119]
    v_pk_mul_f16 v150, v150, v86
    v_fma_f32 v186, |v106|, v58, v186
    v_mfma_f32_16x16x32_f16 v[116:119], a[84:87], v[132:135], v[116:119]
    v_pk_mul_f16 v151, v151, v87
    v_fma_f32 v186, |v107|, v59, v186
    v_mfma_f32_16x16x32_f16 v[116:119], a[80:83], v[128:131], v[116:119]
    v_pk_mul_f16 v152, v152, v88
    v_fma_f32 v186, |v108|, v60, v186
    v_mfma_f32_16x16x32_f16 v[120:123], a[96:99], v[128:131], v[40:43]
    v_pk_mul_f16 v153, v153, v89
    v_fma_f32 v186, |v109|, v61, v186
    v_mfma_f32_16x16x32_f16 v[120:123], a[100:103], v[132:135], v[120:123]
    v_pk_mul_f16 v154, v154, v90
    v_fma_f32 v186, |v110|, v62, v186
    v_mfma_f32_16x16x32_f16 v[120:123], a[104:107], v[136:139], v[120:123]
    v_pk_mul_f16 v155, v155, v91
    v_fma_f32 v186, |v111|, v63, v186
    v_mfma_f32_16x16x32_f16 v[120:123], a[108:111], v[140:143], v[120:123]
    v_pk_mul_f16 v156, v156, v92
    v_fma_f32 v186, |v112|, v64, v186
    v_mfma_f32_16x16x32_f16 v[124:127], a[124:127], v[140:143], v[44:47]
    v_pk_mul_f16 v157, v157, v93
    v_fma_f32 v186, |v113|, v65, v186
    v_mfma_f32_16x16x32_f16 v[124:127], a[120:123], v[136:139], v[124:127]
    v_pk_mul_f16 v158, v158, v94
    v_fma_f32 v186, |v114|, v66, v186
    v_mfma_f32_16x16x32_f16 v[124:127], a[116:119], v[132:135], v[124:127]
    v_pk_mul_f16 v159, v159, v95
    v_fma_f32 v186, |v115|, v67, v186
    v_mfma_f32_16x16x32_f16 v[124:127], a[112:115], v[128:131], v[124:127]
    v_mov_b32_dpp v247, v246 row_ror:11 row_mask:0xf bank_mask:0xf
    v_fma_f32 v186, |v116|, v68, v186
    v_mfma_f32_16x16x32_f16 v[96:99], a[112:115], v[144:147], v[44:47]
    ds_read_b128 v[140:143], v247 offset:192
    v_fma_f32 v186, |v117|, v69, v186
    v_mfma_f32_16x16x32_f16 v[96:99], a[116:119], v[148:151], v[96:99]
    ds_read_b128 v[136:139], v247 offset:128
    v_fma_f32 v186, |v118|, v70, v186
    v_mfma_f32_16x16x32_f16 v[96:99], a[120:123], v[152:155], v[96:99]
    ds_read_b128 v[132:135], v247 offset:64
    v_fma_f32 v186, |v119|, v71, v186
    v_mfma_f32_16x16x32_f16 v[96:99], a[124:127], v[156:159], v[96:99]
    ds_read_b128 v[128:131], v247 offset:0
    v_fma_f32 v186, |v120|, v72, v186
    v_mfma_f32_16x16x32_f16 v[100:103], a[108:111], v[156:159], v[40:43]
    v_add_u32_sdwa v221, v164, s49 dst_sel:WORD_1 dst_unused:UNUSED_PAD src0_sel:WORD_1 src1_sel:DWORD
    v_fma_f32 v186, |v121|, v73, v186
    v_mfma_f32_16x16x32_f16 v[100:103], a[104:107], v[152:155], v[100:103]
    v_lshl_add_u32 v222, v165, 16, s48
    v_fma_f32 v186, |v122|, v74, v186
    v_mfma_f32_16x16x32_f16 v[100:103], a[100:103], v[148:151], v[100:103]
    v_add_u32_sdwa v223, v165, s49 dst_sel:WORD_1 dst_unused:UNUSED_PAD src0_sel:WORD_1 src1_sel:DWORD
    v_fma_f32 v186, |v123|, v75, v186
    v_mfma_f32_16x16x32_f16 v[100:103], a[96:99], v[144:147], v[100:103]
    v_lshl_add_u32 v224, v166, 16, s48
    v_fma_f32 v186, |v124|, v76, v186
    v_mfma_f32_16x16x32_f16 v[104:107], a[80:83], v[144:147], v[36:39]
    v_add_u32_sdwa v225, v166, s49 dst_sel:WORD_1 dst_unused:UNUSED_PAD src0_sel:WORD_1 src1_sel:DWORD
    v_fma_f32 v186, |v125|, v77, v186
    v_mfma_f32_16x16x32_f16 v[104:107], a[84:87], v[148:151], v[104:107]
    v_lshl_add_u32 v226, v167, 16, s48
    v_fma_f32 v186, |v126|, v78, v186
    v_mfma_f32_16x16x32_f16 v[104:107], a[88:91], v[152:155], v[104:107]
    v_add_u32_sdwa v227, v167, s49 dst_sel:WORD_1 dst_unused:UNUSED_PAD src0_sel:WORD_1 src1_sel:DWORD
    v_fma_f32 v186, |v127|, v79, v186
    v_mfma_f32_16x16x32_f16 v[104:107], a[92:95], v[156:159], v[104:107]
    v_cvt_pkrtz_f16_f32 v208, v220, v221
    v_mul_f32 v187, |v96|, v76
    v_mfma_f32_16x16x32_f16 v[108:111], a[76:79], v[156:159], v[32:35]
    v_max3_f32 v248, v248, |v220|, |v221|
    v_fma_f32 v187, |v97|, v77, v187
    v_mfma_f32_16x16x32_f16 v[108:111], a[72:75], v[152:155], v[108:111]
    v_cvt_pkrtz_f16_f32 v209, v222, v223
    v_fma_f32 v187, |v98|, v78, v187
    v_mfma_f32_16x16x32_f16 v[108:111], a[68:71], v[148:151], v[108:111]
    v_max3_f32 v249, v249, |v222|, |v223|
    v_fma_f32 v187, |v99|, v79, v187
    v_mfma_f32_16x16x32_f16 v[108:111], a[64:67], v[144:147], v[108:111]
    s_waitcnt lgkmcnt(0)
    v_pk_mul_f16 v128, v128, v80
    v_fma_f32 v187, |v100|, v72, v187
    v_mfma_f32_16x16x32_f16 v[112:115], a[48:51], v[144:147], v[28:31]
    v_pk_mul_f16 v129, v129, v81
    v_fma_f32 v187, |v101|, v73, v187
    v_mfma_f32_16x16x32_f16 v[112:115], a[52:55], v[148:151], v[112:115]
    v_pk_mul_f16 v130, v130, v82
    v_fma_f32 v187, |v102|, v74, v187
    v_mfma_f32_16x16x32_f16 v[112:115], a[56:59], v[152:155], v[112:115]
    v_pk_mul_f16 v131, v131, v83
    v_fma_f32 v187, |v103|, v75, v187
    v_mfma_f32_16x16x32_f16 v[112:115], a[60:63], v[156:159], v[112:115]
    v_pk_mul_f16 v132, v132, v84
    v_fma_f32 v187, |v104|, v68, v187
    v_mfma_f32_16x16x32_f16 v[116:119], a[44:47], v[156:159], v[24:27]
    v_pk_mul_f16 v133, v133, v85
    v_fma_f32 v187, |v105|, v69, v187
    v_mfma_f32_16x16x32_f16 v[116:119], a[40:43], v[152:155], v[116:119]
    v_pk_mul_f16 v134, v134, v86
    v_fma_f32 v187, |v106|, v70, v187
    v_mfma_f32_16x16x32_f16 v[116:119], a[36:39], v[148:151], v[116:119]
    v_pk_mul_f16 v135, v135, v87
    v_fma_f32 v187, |v107|, v71, v187
    v_mfma_f32_16x16x32_f16 v[116:119], a[32:35], v[144:147], v[116:119]
    v_pk_mul_f16 v136, v136, v88
    v_fma_f32 v187, |v108|, v64, v187
    v_mfma_f32_16x16x32_f16 v[120:123], a[16:19], v[144:147], v[20:23]
    v_pk_mul_f16 v137, v137, v89
    v_fma_f32 v187, |v109|, v65, v187
    v_mfma_f32_16x16x32_f16 v[120:123], a[20:23], v[148:151], v[120:123]
    v_pk_mul_f16 v138, v138, v90
    v_fma_f32 v187, |v110|, v66, v187
    v_mfma_f32_16x16x32_f16 v[120:123], a[24:27], v[152:155], v[120:123]
    v_pk_mul_f16 v139, v139, v91
    v_fma_f32 v187, |v111|, v67, v187
    v_mfma_f32_16x16x32_f16 v[120:123], a[28:31], v[156:159], v[120:123]
    v_pk_mul_f16 v140, v140, v92
    v_fma_f32 v187, |v112|, v60, v187
    v_mfma_f32_16x16x32_f16 v[124:127], a[12:15], v[156:159], v[16:19]
    v_pk_mul_f16 v141, v141, v93
    v_fma_f32 v187, |v113|, v61, v187
    v_mfma_f32_16x16x32_f16 v[124:127], a[8:11], v[152:155], v[124:127]
    v_pk_mul_f16 v142, v142, v94
    v_fma_f32 v187, |v114|, v62, v187
    v_mfma_f32_16x16x32_f16 v[124:127], a[4:7], v[148:151], v[124:127]
    v_pk_mul_f16 v143, v143, v95
    v_fma_f32 v187, |v115|, v63, v187
    v_mfma_f32_16x16x32_f16 v[124:127], a[0:3], v[144:147], v[124:127]
    v_mov_b32_dpp v247, v246 row_ror:10 row_mask:0xf bank_mask:0xf
    v_fma_f32 v187, |v116|, v56, v187
    v_mfma_f32_16x16x32_f16 v[96:99], a[0:3], v[128:131], v[16:19]
    ds_read_b128 v[156:159], v247 offset:192
    v_fma_f32 v187, |v117|, v57, v187
    v_mfma_f32_16x16x32_f16 v[96:99], a[4:7], v[132:135], v[96:99]
    ds_read_b128 v[152:155], v247 offset:128
    v_fma_f32 v187, |v118|, v58, v187
    v_mfma_f32_16x16x32_f16 v[96:99], a[8:11], v[136:139], v[96:99]
    ds_read_b128 v[148:151], v247 offset:64
    v_fma_f32 v187, |v119|, v59, v187
    v_mfma_f32_16x16x32_f16 v[96:99], a[12:15], v[140:143], v[96:99]
    ds_read_b128 v[144:147], v247 offset:0
    v_fma_f32 v187, |v120|, v52, v187
    v_mfma_f32_16x16x32_f16 v[100:103], a[28:31], v[140:143], v[20:23]
    v_cvt_pkrtz_f16_f32 v210, v224, v225
    v_fma_f32 v187, |v121|, v53, v187
    v_mfma_f32_16x16x32_f16 v[100:103], a[24:27], v[136:139], v[100:103]
    v_max3_f32 v248, v248, |v224|, |v225|
    v_fma_f32 v187, |v122|, v54, v187
    v_mfma_f32_16x16x32_f16 v[100:103], a[20:23], v[132:135], v[100:103]
    v_cvt_pkrtz_f16_f32 v211, v226, v227
    v_fma_f32 v187, |v123|, v55, v187
    v_mfma_f32_16x16x32_f16 v[100:103], a[16:19], v[128:131], v[100:103]
    v_max3_f32 v249, v249, |v226|, |v227|
    v_fma_f32 v187, |v124|, v48, v187
    v_mfma_f32_16x16x32_f16 v[104:107], a[32:35], v[128:131], v[24:27]
    ds_write_b128 v203, v[208:211] offset:5472
    v_mfma_f32_16x16x32_f16 v[104:107], a[36:39], v[132:135], v[104:107]
    s_waitcnt vmcnt(2)
    v_lshl_add_u32 v220, v168, 16, s48
    v_fma_f32 v187, |v125|, v49, v187
    v_mfma_f32_16x16x32_f16 v[104:107], a[40:43], v[136:139], v[104:107]
    v_add_u32_sdwa v221, v168, s49 dst_sel:WORD_1 dst_unused:UNUSED_PAD src0_sel:WORD_1 src1_sel:DWORD
    v_fma_f32 v187, |v126|, v50, v187
    v_mfma_f32_16x16x32_f16 v[104:107], a[44:47], v[140:143], v[104:107]
    v_lshl_add_u32 v222, v169, 16, s48
    v_fma_f32 v187, |v127|, v51, v187
    v_mfma_f32_16x16x32_f16 v[108:111], a[60:63], v[140:143], v[28:31]
    v_add_u32_sdwa v223, v169, s49 dst_sel:WORD_1 dst_unused:UNUSED_PAD src0_sel:WORD_1 src1_sel:DWORD
    v_mul_f32 v188, |v96|, v48
    v_mfma_f32_16x16x32_f16 v[108:111], a[56:59], v[136:139], v[108:111]
    v_lshl_add_u32 v224, v170, 16, s48
    v_fma_f32 v188, |v97|, v49, v188
    v_mfma_f32_16x16x32_f16 v[108:111], a[52:55], v[132:135], v[108:111]
    v_add_u32_sdwa v225, v170, s49 dst_sel:WORD_1 dst_unused:UNUSED_PAD src0_sel:WORD_1 src1_sel:DWORD
    v_fma_f32 v188, |v98|, v50, v188
    v_mfma_f32_16x16x32_f16 v[108:111], a[48:51], v[128:131], v[108:111]
    s_waitcnt lgkmcnt(1)
    v_pk_mul_f16 v144, v144, v80
    v_fma_f32 v188, |v99|, v51, v188
    v_mfma_f32_16x16x32_f16 v[112:115], a[64:67], v[128:131], v[32:35]
    v_pk_mul_f16 v145, v145, v81
    v_fma_f32 v188, |v100|, v52, v188
    v_mfma_f32_16x16x32_f16 v[112:115], a[68:71], v[132:135], v[112:115]
    v_pk_mul_f16 v146, v146, v82
    v_fma_f32 v188, |v101|, v53, v188
    v_mfma_f32_16x16x32_f16 v[112:115], a[72:75], v[136:139], v[112:115]
    v_pk_mul_f16 v147, v147, v83
    v_fma_f32 v188, |v102|, v54, v188
    v_mfma_f32_16x16x32_f16 v[112:115], a[76:79], v[140:143], v[112:115]
    v_pk_mul_f16 v148, v148, v84
    v_fma_f32 v188, |v103|, v55, v188
    v_mfma_f32_16x16x32_f16 v[116:119], a[92:95], v[140:143], v[36:39]
    v_pk_mul_f16 v149, v149, v85
    v_fma_f32 v188, |v104|, v56, v188
    v_mfma_f32_16x16x32_f16 v[116:119], a[88:91], v[136:139], v[116:119]
    v_pk_mul_f16 v150, v150, v86
    v_fma_f32 v188, |v105|, v57, v188
    v_mfma_f32_16x16x32_f16 v[116:119], a[84:87], v[132:135], v[116:119]
    v_pk_mul_f16 v151, v151, v87
    v_fma_f32 v188, |v106|, v58, v188
    v_mfma_f32_16x16x32_f16 v[116:119], a[80:83], v[128:131], v[116:119]
    v_pk_mul_f16 v152, v152, v88
    v_fma_f32 v188, |v107|, v59, v188
    v_mfma_f32_16x16x32_f16 v[120:123], a[96:99], v[128:131], v[40:43]
    v_pk_mul_f16 v153, v153, v89
    v_fma_f32 v188, |v108|, v60, v188
    v_mfma_f32_16x16x32_f16 v[120:123], a[100:103], v[132:135], v[120:123]
    v_pk_mul_f16 v154, v154, v90
    v_fma_f32 v188, |v109|, v61, v188
    v_mfma_f32_16x16x32_f16 v[120:123], a[104:107], v[136:139], v[120:123]
    v_pk_mul_f16 v155, v155, v91
    v_fma_f32 v188, |v110|, v62, v188
    v_mfma_f32_16x16x32_f16 v[120:123], a[108:111], v[140:143], v[120:123]
    v_pk_mul_f16 v156, v156, v92
    v_fma_f32 v188, |v111|, v63, v188
    v_mfma_f32_16x16x32_f16 v[124:127], a[124:127], v[140:143], v[44:47]
    v_pk_mul_f16 v157, v157, v93
    v_fma_f32 v188, |v112|, v64, v188
    v_mfma_f32_16x16x32_f16 v[124:127], a[120:123], v[136:139], v[124:127]
    v_pk_mul_f16 v158, v158, v94
    v_fma_f32 v188, |v113|, v65, v188
    v_mfma_f32_16x16x32_f16 v[124:127], a[116:119], v[132:135], v[124:127]
    v_pk_mul_f16 v159, v159, v95
    v_fma_f32 v188, |v114|, v66, v188
    v_mfma_f32_16x16x32_f16 v[124:127], a[112:115], v[128:131], v[124:127]
    v_mov_b32_dpp v247, v246 row_ror:9 row_mask:0xf bank_mask:0xf
    v_fma_f32 v188, |v115|, v67, v188
    v_mfma_f32_16x16x32_f16 v[96:99], a[112:115], v[144:147], v[44:47]
    ds_read_b128 v[140:143], v247 offset:192
    v_fma_f32 v188, |v116|, v68, v188
    v_mfma_f32_16x16x32_f16 v[96:99], a[116:119], v[148:151], v[96:99]
    ds_read_b128 v[136:139], v247 offset:128
    v_fma_f32 v188, |v117|, v69, v188
    v_mfma_f32_16x16x32_f16 v[96:99], a[120:123], v[152:155], v[96:99]
    ds_read_b128 v[132:135], v247 offset:64
    v_fma_f32 v188, |v118|, v70, v188
    v_mfma_f32_16x16x32_f16 v[96:99], a[124:127], v[156:159], v[96:99]
    ds_read_b128 v[128:131], v247 offset:0
    v_fma_f32 v188, |v119|, v71, v188
    v_mfma_f32_16x16x32_f16 v[100:103], a[108:111], v[156:159], v[40:43]
    v_lshl_add_u32 v226, v171, 16, s48
    v_fma_f32 v188, |v120|, v72, v188
    v_mfma_f32_16x16x32_f16 v[100:103], a[104:107], v[152:155], v[100:103]
    v_add_u32_sdwa v227, v171, s49 dst_sel:WORD_1 dst_unused:UNUSED_PAD src0_sel:WORD_1 src1_sel:DWORD
    v_fma_f32 v188, |v121|, v73, v188
    v_mfma_f32_16x16x32_f16 v[100:103], a[100:103], v[148:151], v[100:103]
    v_cvt_pkrtz_f16_f32 v212, v220, v221
    v_fma_f32 v188, |v122|, v74, v188
    v_mfma_f32_16x16x32_f16 v[100:103], a[96:99], v[144:147], v[100:103]
    v_max3_f32 v248, v248, |v220|, |v221|
    v_fma_f32 v188, |v123|, v75, v188
    v_mfma_f32_16x16x32_f16 v[104:107], a[80:83], v[144:147], v[36:39]
    v_cvt_pkrtz_f16_f32 v213, v222, v223
    v_fma_f32 v188, |v124|, v76, v188
    v_mfma_f32_16x16x32_f16 v[104:107], a[84:87], v[148:151], v[104:107]
    v_max3_f32 v249, v249, |v222|, |v223|
    v_fma_f32 v188, |v125|, v77, v188
    v_mfma_f32_16x16x32_f16 v[104:107], a[88:91], v[152:155], v[104:107]
    v_cvt_pkrtz_f16_f32 v214, v224, v225
    v_fma_f32 v188, |v126|, v78, v188
    v_mfma_f32_16x16x32_f16 v[104:107], a[92:95], v[156:159], v[104:107]
    v_max3_f32 v248, v248, |v224|, |v225|
    v_fma_f32 v188, |v127|, v79, v188
    v_mfma_f32_16x16x32_f16 v[108:111], a[76:79], v[156:159], v[32:35]
    v_cvt_pkrtz_f16_f32 v215, v226, v227
    v_mul_f32 v189, |v96|, v76
    v_mfma_f32_16x16x32_f16 v[108:111], a[72:75], v[152:155], v[108:111]
    v_max3_f32 v249, v249, |v226|, |v227|
    v_fma_f32 v189, |v97|, v77, v189
    v_mfma_f32_16x16x32_f16 v[108:111], a[68:71], v[148:151], v[108:111]
    ds_write_b128 v203, v[212:215] offset:6336
    v_mfma_f32_16x16x32_f16 v[108:111], a[64:67], v[144:147], v[108:111]
    s_waitcnt lgkmcnt(1)
    v_pk_mul_f16 v128, v128, v80
    v_fma_f32 v189, |v98|, v78, v189
    v_mfma_f32_16x16x32_f16 v[112:115], a[48:51], v[144:147], v[28:31]
    v_pk_mul_f16 v129, v129, v81
    v_fma_f32 v189, |v99|, v79, v189
    v_mfma_f32_16x16x32_f16 v[112:115], a[52:55], v[148:151], v[112:115]
    v_pk_mul_f16 v130, v130, v82
    v_fma_f32 v189, |v100|, v72, v189
    v_mfma_f32_16x16x32_f16 v[112:115], a[56:59], v[152:155], v[112:115]
    v_pk_mul_f16 v131, v131, v83
    v_fma_f32 v189, |v101|, v73, v189
    v_mfma_f32_16x16x32_f16 v[112:115], a[60:63], v[156:159], v[112:115]
    v_pk_mul_f16 v132, v132, v84
    v_fma_f32 v189, |v102|, v74, v189
    v_mfma_f32_16x16x32_f16 v[116:119], a[44:47], v[156:159], v[24:27]
    v_pk_mul_f16 v133, v133, v85
    v_fma_f32 v189, |v103|, v75, v189
    v_mfma_f32_16x16x32_f16 v[116:119], a[40:43], v[152:155], v[116:119]
    v_pk_mul_f16 v134, v134, v86
    v_fma_f32 v189, |v104|, v68, v189
    v_mfma_f32_16x16x32_f16 v[116:119], a[36:39], v[148:151], v[116:119]
    v_pk_mul_f16 v135, v135, v87
    v_fma_f32 v189, |v105|, v69, v189
    v_mfma_f32_16x16x32_f16 v[116:119], a[32:35], v[144:147], v[116:119]
    v_pk_mul_f16 v136, v136, v88
    v_fma_f32 v189, |v106|, v70, v189
    v_mfma_f32_16x16x32_f16 v[120:123], a[16:19], v[144:147], v[20:23]
    v_pk_mul_f16 v137, v137, v89
    v_fma_f32 v189, |v107|, v71, v189
    v_mfma_f32_16x16x32_f16 v[120:123], a[20:23], v[148:151], v[120:123]
    v_pk_mul_f16 v138, v138, v90
    v_fma_f32 v189, |v108|, v64, v189
    v_mfma_f32_16x16x32_f16 v[120:123], a[24:27], v[152:155], v[120:123]
    v_pk_mul_f16 v139, v139, v91
    v_fma_f32 v189, |v109|, v65, v189
    v_mfma_f32_16x16x32_f16 v[120:123], a[28:31], v[156:159], v[120:123]
    v_pk_mul_f16 v140, v140, v92
    v_fma_f32 v189, |v110|, v66, v189
    v_mfma_f32_16x16x32_f16 v[124:127], a[12:15], v[156:159], v[16:19]
    v_pk_mul_f16 v141, v141, v93
    v_fma_f32 v189, |v111|, v67, v189
    v_mfma_f32_16x16x32_f16 v[124:127], a[8:11], v[152:155], v[124:127]
    v_pk_mul_f16 v142, v142, v94
    v_fma_f32 v189, |v112|, v60, v189
    v_mfma_f32_16x16x32_f16 v[124:127], a[4:7], v[148:151], v[124:127]
    v_pk_mul_f16 v143, v143, v95
    v_fma_f32 v189, |v113|, v61, v189
    v_mfma_f32_16x16x32_f16 v[124:127], a[0:3], v[144:147], v[124:127]
    v_mov_b32_dpp v247, v246 row_ror:8 row_mask:0xf bank_mask:0xf
    v_fma_f32 v189, |v114|, v62, v189
    v_mfma_f32_16x16x32_f16 v[96:99], a[0:3], v[128:131], v[16:19]
    ds_read_b128 v[156:159], v247 offset:192
    v_fma_f32 v189, |v115|, v63, v189
    v_mfma_f32_16x16x32_f16 v[96:99], a[4:7], v[132:135], v[96:99]
    ds_read_b128 v[152:155], v247 offset:128
    v_fma_f32 v189, |v116|, v56, v189
    v_mfma_f32_16x16x32_f16 v[96:99], a[8:11], v[136:139], v[96:99]
    ds_read_b128 v[148:151], v247 offset:64
    v_fma_f32 v189, |v117|, v57, v189
    v_mfma_f32_16x16x32_f16 v[96:99], a[12:15], v[140:143], v[96:99]
    ds_read_b128 v[144:147], v247 offset:0
    v_fma_f32 v189, |v118|, v58, v189
    v_mfma_f32_16x16x32_f16 v[100:103], a[28:31], v[140:143], v[20:23]
    v_max_f32 v248, v248, v249
    v_fma_f32 v189, |v119|, v59, v189
    v_mfma_f32_16x16x32_f16 v[100:103], a[24:27], v[136:139], v[100:103]
    v_cmp_le_f32 vcc, s50, v248
    v_fma_f32 v189, |v120|, v52, v189
    v_mfma_f32_16x16x32_f16 v[100:103], a[20:23], v[132:135], v[100:103]
    v_cmp_nlt_f32 s[92:93], v248, s51
    v_fma_f32 v189, |v121|, v53, v189
    v_mfma_f32_16x16x32_f16 v[100:103], a[16:19], v[128:131], v[100:103]
    s_cbranch_vccnz L_efix
    v_mfma_f32_16x16x32_f16 v[104:107], a[32:35], v[128:131], v[24:27]
    s_cmp_eq_u64 s[92:93], 0
    s_cbranch_scc1 L_efix
    v_mfma_f32_16x16x32_f16 v[104:107], a[36:39], v[132:135], v[104:107]
    ds_read_b128 v[204:207], v202 offset:4608
    v_fma_f32 v189, |v122|, v54, v189
    v_mfma_f32_16x16x32_f16 v[104:107], a[40:43], v[136:139], v[104:107]
    ds_read_b128 v[208:211], v202 offset:4672
    v_fma_f32 v189, |v123|, v55, v189
    v_mfma_f32_16x16x32_f16 v[104:107], a[44:47], v[140:143], v[104:107]
    ds_read_b128 v[212:215], v202 offset:4736
    v_fma_f32 v189, |v124|, v48, v189
    v_mfma_f32_16x16x32_f16 v[108:111], a[60:63], v[140:143], v[28:31]
    ds_read_b128 v[216:219], v202 offset:4800
    v_fma_f32 v189, |v125|, v49, v189
    v_mfma_f32_16x16x32_f16 v[108:111], a[56:59], v[136:139], v[108:111]
    s_waitcnt vmcnt(0)
    v_add_u32_sdwa v11, v238, s5 dst_sel:DWORD dst_unused:UNUSED_PAD src0_sel:WORD_1 src1_sel:DWORD
    v_fma_f32 v189, |v126|, v50, v189
    v_mfma_f32_16x16x32_f16 v[108:111], a[52:55], v[132:135], v[108:111]
L_pad1:
    s_cbranch_execz L_hopret
    v_add_u32_sdwa v238, v238, s5 dst_sel:DWORD dst_unused:UNUSED_PAD src0_sel:WORD_0 src1_sel:DWORD
    v_fma_f32 v189, |v127|, v51, v189
    v_mfma_f32_16x16x32_f16 v[108:111], a[48:51], v[128:131], v[108:111]
    s_waitcnt lgkmcnt(4)
    v_pk_mul_f16 v144, v144, v80
    v_mul_f32 v190, |v96|, v48
    v_mfma_f32_16x16x32_f16 v[112:115], a[64:67], v[128:131], v[32:35]
    v_pk_mul_f16 v145, v145, v81
    v_fma_f32 v190, |v97|, v49, v190
    v_mfma_f32_16x16x32_f16 v[112:115], a[68:71], v[132:135], v[112:115]
    v_pk_mul_f16 v146, v146, v82
    v_fma_f32 v190, |v98|, v50, v190
    v_mfma_f32_16x16x32_f16 v[112:115], a[72:75], v[136:139], v[112:115]
    v_pk_mul_f16 v147, v147, v83
    v_fma_f32 v190, |v99|, v51, v190
    v_mfma_f32_16x16x32_f16 v[112:115], a[76:79], v[140:143], v[112:115]
    v_pk_mul_f16 v148, v148, v84
    v_fma_f32 v190, |v100|, v52, v190
    v_mfma_f32_16x16x32_f16 v[116:119], a[92:95], v[140:143], v[36:39]
    v_pk_mul_f16 v149, v149, v85
    v_fma_f32 v190, |v101|, v53, v190
    v_mfma_f32_16x16x32_f16 v[116:119], a[88:91], v[136:139], v[116:119]
    v_pk_mul_f16 v150, v150, v86
    v_fma_f32 v190, |v102|, v54, v190
    v_mfma_f32_16x16x32_f16 v[116:119], a[84:87], v[132:135], v[116:119]
    v_pk_mul_f16 v151, v151, v87
    v_fma_f32 v190, |v103|, v55, v190
    v_mfma_f32_16x16x32_f16 v[116:119], a[80:83], v[128:131], v[116:119]
    v_pk_mul_f16 v152, v152, v88
    v_fma_f32 v190, |v104|, v56, v190
    v_mfma_f32_16x16x32_f16 v[120:123], a[96:99], v[128:131], v[40:43]
    v_pk_mul_f16 v153, v153, v89
    v_fma_f32 v190, |v105|, v57, v190
    v_mfma_f32_16x16x32_f16 v[120:123], a[100:103], v[132:135], v[120:123]
    v_pk_mul_f16 v154, v154, v90
    v_fma_f32 v190, |v106|, v58, v190
    v_mfma_f32_16x16x32_f16 v[120:123], a[104:107], v[136:139], v[120:123]
    v_pk_mul_f16 v155, v155, v91
    v_fma_f32 v190, |v107|, v59, v190
    v_mfma_f32_16x16x32_f16 v[120:123], a[108:111], v[140:143], v[120:123]
    v_pk_mul_f16 v156, v156, v92
    v_fma_f32 v190, |v108|, v60, v190
    v_mfma_f32_16x16x32_f16 v[124:127], a[124:127], v[140:143], v[44:47]
    v_pk_mul_f16 v157, v157, v93
    v_fma_f32 v190, |v109|, v61, v190
    v_mfma_f32_16x16x32_f16 v[124:127], a[120:123], v[136:139], v[124:127]
    v_pk_mul_f16 v158, v158, v94
    v_fma_f32 v190, |v110|, v62, v190
    v_mfma_f32_16x16x32_f16 v[124:127], a[116:119], v[132:135], v[124:127]
    v_pk_mul_f16 v159, v159, v95
    v_fma_f32 v190, |v111|, v63, v190
    v_mfma_f32_16x16x32_f16 v[124:127], a[112:115], v[128:131], v[124:127]
    v_max_u32_dpp v254, v254, v254 row_ror:4 row_mask:0xf bank_mask:0xf
    v_fma_f32 v190, |v112|, v64, v190
    v_mfma_f32_16x16x32_f16 v[96:99], a[112:115], v[144:147], v[44:47]
    ds_read_b128 v[140:143], v245 offset:4800
    v_fma_f32 v190, |v113|, v65, v190
    v_mfma_f32_16x16x32_f16 v[96:99], a[116:119], v[148:151], v[96:99]
    ds_read_b128 v[136:139], v245 offset:4736
    v_fma_f32 v190, |v114|, v66, v190
    v_mfma_f32_16x16x32_f16 v[96:99], a[120:123], v[152:155], v[96:99]
    ds_read_b128 v[132:135], v245 offset:4672
    v_fma_f32 v190, |v115|, v67, v190
    v_mfma_f32_16x16x32_f16 v[96:99], a[124:127], v[156:159], v[96:99]
    ds_read_b128 v[128:131], v245 offset:4608
    v_fma_f32 v190, |v116|, v68, v190
    v_mfma_f32_16x16x32_f16 v[100:103], a[108:111], v[156:159], v[40:43]
    v_max_u32_dpp v255, v255, v255 row_ror:4 row_mask:0xf bank_mask:0xf
    v_fma_f32 v190, |v117|, v69, v190
    v_mfma_f32_16x16x32_f16 v[100:103], a[104:107], v[152:155], v[100:103]
    v_max_u32_dpp v254, v254, v254 row_ror:2 row_mask:0xf bank_mask:0xf
    v_fma_f32 v190, |v118|, v70, v190
    v_mfma_f32_16x16x32_f16 v[100:103], a[100:103], v[148:151], v[100:103]
    v_max_u32_dpp v255, v255, v255 row_ror:2 row_mask:0xf bank_mask:0xf
    v_fma_f32 v190, |v119|, v71, v190
    v_mfma_f32_16x16x32_f16 v[100:103], a[96:99], v[144:147], v[100:103]
    v_max_u32_dpp v254, v254, v254 row_ror:1 row_mask:0xf bank_mask:0xf
    v_fma_f32 v190, |v120|, v72, v190
    v_mfma_f32_16x16x32_f16 v[104:107], a[80:83], v[144:147], v[36:39]
    v_max_u32_dpp v255, v255, v255 row_ror:1 row_mask:0xf bank_mask:0xf
    v_fma_f32 v190, |v121|, v73, v190
    v_mfma_f32_16x16x32_f16 v[104:107], a[84:87], v[148:151], v[104:107]
    v_max_u32_dpp v254, v254, v254 row_bcast:15 row_mask:0xa bank_mask:0xf
    v_fma_f32 v190, |v122|, v74, v190
    v_mfma_f32_16x16x32_f16 v[104:107], a[88:91], v[152:155], v[104:107]
    v_max_u32_dpp v255, v255, v255 row_bcast:15 row_mask:0xa bank_mask:0xf
    v_fma_f32 v190, |v123|, v75, v190
    v_mfma_f32_16x16x32_f16 v[104:107], a[92:95], v[156:159], v[104:107]
    v_max_u32_dpp v254, v254, v254 row_bcast:31 row_mask:0xc bank_mask:0xf
    v_fma_f32 v190, |v124|, v76, v190
    v_mfma_f32_16x16x32_f16 v[108:111], a[76:79], v[156:159], v[32:35]
    v_max_u32_dpp v255, v255, v255 row_bcast:31 row_mask:0xc bank_mask:0xf
    v_fma_f32 v190, |v125|, v77, v190
    v_mfma_f32_16x16x32_f16 v[108:111], a[72:75], v[152:155], v[108:111]
    v_readlane_b32 s34, v254, 63
    v_fma_f32 v190, |v126|, v78, v190
    v_mfma_f32_16x16x32_f16 v[108:111], a[68:71], v[148:151], v[108:111]
    v_readlane_b32 s35, v255, 63
    s_bfe_u32 s34, s34, 0x80007
    v_fma_f32 v190, |v127|, v79, v190
    v_mfma_f32_16x16x32_f16 v[108:111], a[64:67], v[144:147], v[108:111]
    s_waitcnt lgkmcnt(0)
    v_pk_mul_f16 v128, v128, v80
    s_max_u32 s34, s34, 60
    v_mul_f32 v191, |v96|, v76
    v_mfma_f32_16x16x32_f16 v[112:115], a[48:51], v[144:147], v[28:31]
    v_pk_mul_f16 v129, v129, v81
    s_sub_u32 s11, s34, 134
    v_fma_f32 v191, |v97|, v77, v191
    v_mfma_f32_16x16x32_f16 v[112:115], a[52:55], v[148:151], v[112:115]
    v_pk_mul_f16 v130, v130, v82
    s_sub_u32 s11, s11, s54
    v_fma_f32 v191, |v98|, v78, v191
    v_mfma_f32_16x16x32_f16 v[112:115], a[56:59], v[152:155], v[112:115]
    v_pk_mul_f16 v131, v131, v83
    s_sub_u32 s34, s34, 22
    v_fma_f32 v191, |v99|, v79, v191
    v_mfma_f32_16x16x32_f16 v[112:115], a[60:63], v[156:159], v[112:115]
    v_pk_mul_f16 v132, v132, v84
    s_mul_i32 s10, s34, 0x800080
    v_fma_f32 v191, |v100|, v72, v191
    v_mfma_f32_16x16x32_f16 v[116:119], a[44:47], v[156:159], v[24:27]
    v_pk_mul_f16 v133, v133, v85
    s_lshr_b32 s35, s35, 23
    v_fma_f32 v191, |v101|, v73, v191
    v_mfma_f32_16x16x32_f16 v[116:119], a[40:43], v[152:155], v[116:119]
    v_pk_mul_f16 v134, v134, v86
    s_max_u32 s35, s35, 60
    v_fma_f32 v191, |v102|, v74, v191
    v_mfma_f32_16x16x32_f16 v[116:119], a[36:39], v[148:151], v[116:119]
    v_pk_mul_f16 v135, v135, v87
    s_sub_u32 s34, 134, s35
    v_fma_f32 v191, |v103|, v75, v191
    v_mfma_f32_16x16x32_f16 v[116:119], a[32:35], v[144:147], v[116:119]
    v_pk_mul_f16 v136, v136, v88
    s_sub_u32 s35, s35, 7
    v_fma_f32 v191, |v104|, v68, v191
    v_mfma_f32_16x16x32_f16 v[120:123], a[16:19], v[144:147], v[20:23]
    v_pk_mul_f16 v137, v137, v89
    s_lshl_b32 s12, s35, 23
    v_fma_f32 v191, |v105|, v69, v191
    v_mfma_f32_16x16x32_f16 v[120:123], a[20:23], v[148:151], v[120:123]
    v_pk_mul_f16 v138, v138, v90
    v_fma_f32 v191, |v106|, v70, v191
    v_mfma_f32_16x16x32_f16 v[120:123], a[24:27], v[152:155], v[120:123]
    v_pk_mul_f16 v139, v139, v91
    v_fma_f32 v191, |v107|, v71, v191
    v_mfma_f32_16x16x32_f16 v[120:123], a[28:31], v[156:159], v[120:123]
    v_pk_mul_f16 v140, v140, v92
    v_fma_f32 v191, |v108|, v64, v191
    v_mfma_f32_16x16x32_f16 v[124:127], a[12:15], v[156:159], v[16:19]
    v_pk_mul_f16 v141, v141, v93
    v_fma_f32 v191, |v109|, v65, v191
    v_mfma_f32_16x16x32_f16 v[124:127], a[8:11], v[152:155], v[124:127]
    v_pk_mul_f16 v142, v142, v94
    v_fma_f32 v191, |v110|, v66, v191
    v_mfma_f32_16x16x32_f16 v[124:127], a[4:7], v[148:151], v[124:127]
    v_pk_mul_f16 v143, v143, v95
    v_fma_f32 v191, |v111|, v67, v191
    v_mfma_f32_16x16x32_f16 v[124:127], a[0:3], v[144:147], v[124:127]
    v_and_b32 v254, s45, v252
    v_fma_f32 v191, |v112|, v60, v191
    v_mfma_f32_16x16x32_f16 v[96:99], a[0:3], v[128:131], v[16:19]
    ds_read_b128 v[156:159], v245 offset:5088
    v_fma_f32 v191, |v113|, v61, v191
    v_mfma_f32_16x16x32_f16 v[96:99], a[4:7], v[132:135], v[96:99]
    ds_read_b128 v[152:155], v245 offset:5024
    v_fma_f32 v191, |v114|, v62, v191
    v_mfma_f32_16x16x32_f16 v[96:99], a[8:11], v[136:139], v[96:99]
    ds_read_b128 v[148:151], v245 offset:4960
    v_fma_f32 v191, |v115|, v63, v191
    v_mfma_f32_16x16x32_f16 v[96:99], a[12:15], v[140:143], v[96:99]
    ds_read_b128 v[144:147], v245 offset:4896
    v_fma_f32 v191, |v116|, v56, v191
    v_mfma_f32_16x16x32_f16 v[100:103], a[28:31], v[140:143], v[20:23]
    v_ldexp_f32 v192, v192, s34
    v_fma_f32 v191, |v117|, v57, v191
    v_mfma_f32_16x16x32_f16 v[100:103], a[24:27], v[136:139], v[100:103]
    v_ldexp_f32 v193, v193, s34
    v_fma_f32 v191, |v118|, v58, v191
    v_mfma_f32_16x16x32_f16 v[100:103], a[20:23], v[132:135], v[100:103]
    v_pk_sub_u16 v253, v253, s10 clamp
    v_fma_f32 v191, |v119|, v59, v191
    v_mfma_f32_16x16x32_f16 v[100:103], a[16:19], v[128:131], v[100:103]
    v_cvt_pk_f16_f32 v192, v192, v193
    v_fma_f32 v191, |v120|, v52, v191
    v_mfma_f32_16x16x32_f16 v[104:107], a[32:35], v[128:131], v[24:27]
    v_lshl_or_b32 v253, v253, 3, v254
    v_fma_f32 v191, |v121|, v53, v191
    v_mfma_f32_16x16x32_f16 v[104:107], a[36:39], v[132:135], v[104:107]
    ds_write_b32 v11, v192 offset:9216
    v_mfma_f32_16x16x32_f16 v[104:107], a[40:43], v[136:139], v[104:107]
    ds_write_b32 v11, v253 offset:9504
    v_fma_f32 v191, |v122|, v54, v191
    v_mfma_f32_16x16x32_f16 v[104:107], a[44:47], v[140:143], v[104:107]
    ds_read_b128 v[172:175], v245 offset:9408
    v_fma_f32 v191, |v123|, v55, v191
    v_mfma_f32_16x16x32_f16 v[108:111], a[60:63], v[140:143], v[28:31]
    ds_read_b128 v[168:171], v245 offset:9344
    v_fma_f32 v191, |v124|, v48, v191
    v_mfma_f32_16x16x32_f16 v[108:111], a[56:59], v[136:139], v[108:111]
    ds_read_b128 v[164:167], v245 offset:9280
    v_fma_f32 v191, |v125|, v49, v191
    v_mfma_f32_16x16x32_f16 v[108:111], a[52:55], v[132:135], v[108:111]
    ds_read_b128 v[160:163], v245 offset:9216
    v_fma_f32 v191, |v126|, v50, v191
    v_mfma_f32_16x16x32_f16 v[108:111], a[48:51], v[128:131], v[108:111]
    s_waitcnt lgkmcnt(6)
    v_pk_mul_f16 v144, v144, v80
    v_fma_f32 v191, |v127|, v51, v191
    v_mfma_f32_16x16x32_f16 v[112:115], a[64:67], v[128:131], v[32:35]
    v_pk_mul_f16 v145, v145, v81
    v_mul_f32 v176, |v96|, v48
    v_mfma_f32_16x16x32_f16 v[112:115], a[68:71], v[132:135], v[112:115]
    v_pk_mul_f16 v146, v146, v82
    v_fma_f32 v176, |v97|, v49, v176
    v_mfma_f32_16x16x32_f16 v[112:115], a[72:75], v[136:139], v[112:115]
    v_pk_mul_f16 v147, v147, v83
    v_fma_f32 v176, |v98|, v50, v176
    v_mfma_f32_16x16x32_f16 v[112:115], a[76:79], v[140:143], v[112:115]
    v_pk_mul_f16 v148, v148, v84
    v_fma_f32 v176, |v99|, v51, v176
    v_mfma_f32_16x16x32_f16 v[116:119], a[92:95], v[140:143], v[36:39]
    v_pk_mul_f16 v149, v149, v85
    v_fma_f32 v176, |v100|, v52, v176
    v_mfma_f32_16x16x32_f16 v[116:119], a[88:91], v[136:139], v[116:119]
    v_pk_mul_f16 v150, v150, v86
    v_fma_f32 v176, |v101|, v53, v176
    v_mfma_f32_16x16x32_f16 v[116:119], a[84:87], v[132:135], v[116:119]
    v_pk_mul_f16 v151, v151, v87
    v_fma_f32 v176, |v102|, v54, v176
    v_mfma_f32_16x16x32_f16 v[116:119], a[80:83], v[128:131], v[116:119]
    v_pk_mul_f16 v152, v152, v88
    v_fma_f32 v176, |v103|, v55, v176
    v_mfma_f32_16x16x32_f16 v[120:123], a[96:99], v[128:131], v[40:43]
    v_pk_mul_f16 v153, v153, v89
    v_fma_f32 v176, |v104|, v56, v176
    v_mfma_f32_16x16x32_f16 v[120:123], a[100:103], v[132:135], v[120:123]
    v_pk_mul_f16 v154, v154, v90
    v_fma_f32 v176, |v105|, v57, v176
    v_mfma_f32_16x16x32_f16 v[120:123], a[104:107], v[136:139], v[120:123]
    v_pk_mul_f16 v155, v155, v91
    v_fma_f32 v176, |v106|, v58, v176
    v_mfma_f32_16x16x32_f16 v[120:123], a[108:111], v[140:143], v[120:123]
    v_pk_mul_f16 v156, v156, v92
    v_fma_f32 v176, |v107|, v59, v176
    v_mfma_f32_16x16x32_f16 v[124:127], a[124:127], v[140:143], v[44:47]
    v_pk_mul_f16 v157, v157, v93
    v_fma_f32 v176, |v108|, v60, v176
    v_mfma_f32_16x16x32_f16 v[124:127], a[120:123], v[136:139], v[124:127]
    v_pk_mul_f16 v158, v158, v94
    v_fma_f32 v176, |v109|, v61, v176
    v_mfma_f32_16x16x32_f16 v[124:127], a[116:119], v[132:135], v[124:127]
    v_pk_mul_f16 v159, v159, v95
    v_fma_f32 v176, |v110|, v62, v176
    v_mfma_f32_16x16x32_f16 v[124:127], a[112:115], v[128:131], v[124:127]
    s_waitcnt lgkmcnt(0)
    v_pk_mul_f16 v160, v160, v80
    v_fma_f32 v176, |v111|, v63, v176
    v_mfma_f32_16x16x32_f16 v[96:99], a[112:115], v[144:147], v[44:47]
    ds_read_b128 v[140:143], v245 offset:5376
    v_fma_f32 v176, |v112|, v64, v176
    v_mfma_f32_16x16x32_f16 v[96:99], a[116:119], v[148:151], v[96:99]
    ds_read_b128 v[136:139], v245 offset:5312
    v_fma_f32 v176, |v113|, v65, v176
    v_mfma_f32_16x16x32_f16 v[96:99], a[120:123], v[152:155], v[96:99]
    ds_read_b128 v[132:135], v245 offset:5248
    v_fma_f32 v176, |v114|, v66, v176
    v_mfma_f32_16x16x32_f16 v[96:99], a[124:127], v[156:159], v[96:99]
    ds_read_b128 v[128:131], v245 offset:5184
    v_fma_f32 v176, |v115|, v67, v176
    v_mfma_f32_16x16x32_f16 v[100:103], a[108:111], v[156:159], v[40:43]
    v_pk_mul_f16 v161, v161, v81
    v_fma_f32 v176, |v116|, v68, v176
    v_mfma_f32_16x16x32_f16 v[100:103], a[104:107], v[152:155], v[100:103]
    v_pk_mul_f16 v162, v162, v82
    v_fma_f32 v176, |v117|, v69, v176
    v_mfma_f32_16x16x32_f16 v[100:103], a[100:103], v[148:151], v[100:103]
    v_pk_mul_f16 v163, v163, v83
    v_fma_f32 v176, |v118|, v70, v176
    v_mfma_f32_16x16x32_f16 v[100:103], a[96:99], v[144:147], v[100:103]
    v_pk_mul_f16 v164, v164, v84
    v_fma_f32 v176, |v119|, v71, v176
    v_mfma_f32_16x16x32_f16 v[104:107], a[80:83], v[144:147], v[36:39]
    v_pk_mul_f16 v165, v165, v85
    v_fma_f32 v176, |v120|, v72, v176
    v_mfma_f32_16x16x32_f16 v[104:107], a[84:87], v[148:151], v[104:107]
    v_pk_mul_f16 v166, v166, v86
    v_fma_f32 v176, |v121|, v73, v176
    v_mfma_f32_16x16x32_f16 v[104:107], a[88:91], v[152:155], v[104:107]
    v_pk_mul_f16 v167, v167, v87
    v_fma_f32 v176, |v122|, v74, v176
    v_mfma_f32_16x16x32_f16 v[104:107], a[92:95], v[156:159], v[104:107]
    v_pk_mul_f16 v168, v168, v88
    v_fma_f32 v176, |v123|, v75, v176
    v_mfma_f32_16x16x32_f16 v[108:111], a[76:79], v[156:159], v[32:35]
    v_pk_mul_f16 v169, v169, v89
    v_fma_f32 v176, |v124|, v76, v176
    v_mfma_f32_16x16x32_f16 v[108:111], a[72:75], v[152:155], v[108:111]
    v_pk_mul_f16 v170, v170, v90
    v_fma_f32 v176, |v125|, v77, v176
    v_mfma_f32_16x16x32_f16 v[108:111], a[68:71], v[148:151], v[108:111]
    v_pk_mul_f16 v171, v171, v91
    v_fma_f32 v176, |v126|, v78, v176
    v_mfma_f32_16x16x32_f16 v[108:111], a[64:67], v[144:147], v[108:111]
    s_waitcnt lgkmcnt(0)
    v_pk_mul_f16 v128, v128, v80
    v_fma_f32 v176, |v127|, v79, v176
    v_mfma_f32_16x16x32_f16 v[112:115], a[48:51], v[144:147], v[28:31]
    v_pk_mul_f16 v129, v129, v81
    v_mul_f32 v177, |v96|, v76
    v_mfma_f32_16x16x32_f16 v[112:115], a[52:55], v[148:151], v[112:115]
    v_pk_mul_f16 v130, v130, v82
    v_fma_f32 v177, |v97|, v77, v177
    v_mfma_f32_16x16x32_f16 v[112:115], a[56:59], v[152:155], v[112:115]
    v_pk_mul_f16 v131, v131, v83
    v_fma_f32 v177, |v98|, v78, v177
    v_mfma_f32_16x16x32_f16 v[112:115], a[60:63], v[156:159], v[112:115]
    v_pk_mul_f16 v132, v132, v84
    v_fma_f32 v177, |v99|, v79, v177
    v_mfma_f32_16x16x32_f16 v[116:119], a[44:47], v[156:159], v[24:27]
    v_pk_mul_f16 v133, v133, v85
    v_fma_f32 v177, |v100|, v72, v177
    v_mfma_f32_16x16x32_f16 v[116:119], a[40:43], v[152:155], v[116:119]
    v_pk_mul_f16 v134, v134, v86
    v_fma_f32 v177, |v101|, v73, v177
    v_mfma_f32_16x16x32_f16 v[116:119], a[36:39], v[148:151], v[116:119]
    v_pk_mul_f16 v135, v135, v87
    v_fma_f32 v177, |v102|, v74, v177
    v_mfma_f32_16x16x32_f16 v[116:119], a[32:35], v[144:147], v[116:119]
    v_pk_mul_f16 v136, v136, v88
    v_fma_f32 v177, |v103|, v75, v177
    v_mfma_f32_16x16x32_f16 v[120:123], a[16:19], v[144:147], v[20:23]
    v_pk_mul_f16 v137, v137, v89
    v_fma_f32 v177, |v104|, v68, v177
    v_mfma_f32_16x16x32_f16 v[120:123], a[20:23], v[148:151], v[120:123]
    v_pk_mul_f16 v138, v138, v90
    v_fma_f32 v177, |v105|, v69, v177
    v_mfma_f32_16x16x32_f16 v[120:123], a[24:27], v[152:155], v[120:123]
    v_pk_mul_f16 v139, v139, v91
    v_fma_f32 v177, |v106|, v70, v177
    v_mfma_f32_16x16x32_f16 v[120:123], a[28:31], v[156:159], v[120:123]
    v_pk_mul_f16 v140, v140, v92
    v_fma_f32 v177, |v107|, v71, v177
    v_mfma_f32_16x16x32_f16 v[124:127], a[12:15], v[156:159], v[16:19]
    v_pk_mul_f16 v141, v141, v93
    v_fma_f32 v177, |v108|, v64, v177
    v_mfma_f32_16x16x32_f16 v[124:127], a[8:11], v[152:155], v[124:127]
    v_pk_mul_f16 v142, v142, v94
    v_fma_f32 v177, |v109|, v65, v177
    v_mfma_f32_16x16x32_f16 v[124:127], a[4:7], v[148:151], v[124:127]
    v_pk_mul_f16 v143, v143, v95
    v_fma_f32 v177, |v110|, v66, v177
    v_mfma_f32_16x16x32_f16 v[124:127], a[0:3], v[144:147], v[124:127]
    v_pk_mul_f16 v172, v172, v92
    v_fma_f32 v177, |v111|, v67, v177
    v_mfma_f32_16x16x32_f16 v[96:99], a[0:3], v[128:131], v[16:19]
    ds_read_b128 v[156:159], v245 offset:5664
    v_fma_f32 v177, |v112|, v60, v177
    v_mfma_f32_16x16x32_f16 v[96:99], a[4:7], v[132:135], v[96:99]
    ds_read_b128 v[152:155], v245 offset:5600
    v_fma_f32 v177, |v113|, v61, v177
    v_mfma_f32_16x16x32_f16 v[96:99], a[8:11], v[136:139], v[96:99]
    ds_read_b128 v[148:151], v245 offset:5536
    v_fma_f32 v177, |v114|, v62, v177
    v_mfma_f32_16x16x32_f16 v[96:99], a[12:15], v[140:143], v[96:99]
    ds_read_b128 v[144:147], v245 offset:5472
    v_fma_f32 v177, |v115|, v63, v177
    v_mfma_f32_16x16x32_f16 v[100:103], a[28:31], v[140:143], v[20:23]
    v_pk_mul_f16 v173, v173, v93
    v_fma_f32 v177, |v116|, v56, v177
    v_mfma_f32_16x16x32_f16 v[100:103], a[24:27], v[136:139], v[100:103]
    v_pk_mul_f16 v174, v174, v94
    v_fma_f32 v177, |v117|, v57, v177
    v_mfma_f32_16x16x32_f16 v[100:103], a[20:23], v[132:135], v[100:103]
    v_pk_mul_f16 v175, v175, v95
    v_fma_f32 v177, |v118|, v58, v177
    v_mfma_f32_16x16x32_f16 v[100:103], a[16:19], v[128:131], v[100:103]
    v_add_u32_sdwa v239, v232, s5 dst_sel:DWORD dst_unused:UNUSED_PAD src0_sel:WORD_1 src1_sel:DWORD
    v_fma_f32 v177, |v119|, v59, v177
    v_mfma_f32_16x16x32_f16 v[220:223], v[160:163], v[80:83], 0
    v_add_u32_sdwa v232, v232, s5 dst_sel:DWORD dst_unused:UNUSED_PAD src0_sel:WORD_0 src1_sel:DWORD
    v_fma_f32 v177, |v120|, v52, v177
    v_mfma_f32_16x16x32_f16 v[220:223], v[164:167], v[84:87], v[220:223]
    v_add_u32_sdwa v240, v233, s5 dst_sel:DWORD dst_unused:UNUSED_PAD src0_sel:WORD_1 src1_sel:DWORD
    v_fma_f32 v177, |v121|, v53, v177
    v_mfma_f32_16x16x32_f16 v[220:223], v[168:171], v[88:91], v[220:223]
    v_add_u32_sdwa v233, v233, s5 dst_sel:DWORD dst_unused:UNUSED_PAD src0_sel:WORD_0 src1_sel:DWORD
    v_fma_f32 v177, |v122|, v54, v177
    v_mfma_f32_16x16x32_f16 v[220:223], v[172:175], v[92:95], v[220:223]
    v_add_u32_sdwa v241, v234, s5 dst_sel:DWORD dst_unused:UNUSED_PAD src0_sel:WORD_1 src1_sel:DWORD
    v_fma_f32 v177, |v123|, v55, v177
    v_mfma_f32_16x16x32_f16 v[224:227], v[172:175], v[216:219], 0
    s_waitcnt lgkmcnt(0)
    v_pk_mul_f16 v144, v144, v80
    v_fma_f32 v177, |v124|, v48, v177
    v_mfma_f32_16x16x32_f16 v[224:227], v[168:171], v[212:215], v[224:227]
    v_pk_mul_f16 v145, v145, v81
    v_fma_f32 v177, |v125|, v49, v177
    v_mfma_f32_16x16x32_f16 v[224:227], v[164:167], v[208:211], v[224:227]
    v_pk_mul_f16 v146, v146, v82
    v_fma_f32 v177, |v126|, v50, v177
    v_mfma_f32_16x16x32_f16 v[224:227], v[160:163], v[204:207], v[224:227]
    ds_read_b128 v[172:175], v245 offset:9696
    v_fma_f32 v177, |v127|, v51, v177
    v_mfma_f32_16x16x32_f16 v[104:107], a[32:35], v[128:131], v[24:27]
    ds_read_b128 v[168:171], v245 offset:9632
    v_mul_f32 v178, |v96|, v48
    v_mfma_f32_16x16x32_f16 v[104:107], a[36:39], v[132:135], v[104:107]
    ds_read_b128 v[164:167], v245 offset:9568
    v_fma_f32 v178, |v97|, v49, v178
    v_mfma_f32_16x16x32_f16 v[104:107], a[40:43], v[136:139], v[104:107]
    ds_write_b128 v238, v[220:223] offset:0
    v_mfma_f32_16x16x32_f16 v[104:107], a[44:47], v[140:143], v[104:107]
    ds_write_b128 v238, v[224:227] offset:2304
    v_mfma_f32_16x16x32_f16 v[108:111], a[60:63], v[140:143], v[28:31]
    ds_read_b128 v[160:163], v245 offset:9504
    v_fma_f32 v178, |v98|, v50, v178
    v_mfma_f32_16x16x32_f16 v[108:111], a[56:59], v[136:139], v[108:111]
    v_pk_mul_f16 v147, v147, v83
    v_fma_f32 v178, |v99|, v51, v178
    v_mfma_f32_16x16x32_f16 v[108:111], a[52:55], v[132:135], v[108:111]
    v_pk_mul_f16 v148, v148, v84
    v_fma_f32 v178, |v100|, v52, v178
    v_mfma_f32_16x16x32_f16 v[108:111], a[48:51], v[128:131], v[108:111]
    v_pk_mul_f16 v149, v149, v85
    v_fma_f32 v178, |v101|, v53, v178
    v_mfma_f32_16x16x32_f16 v[112:115], a[64:67], v[128:131], v[32:35]
    v_pk_mul_f16 v150, v150, v86
    v_fma_f32 v178, |v102|, v54, v178
    v_mfma_f32_16x16x32_f16 v[112:115], a[68:71], v[132:135], v[112:115]
    v_pk_mul_f16 v151, v151, v87
    v_fma_f32 v178, |v103|, v55, v178
    v_mfma_f32_16x16x32_f16 v[112:115], a[72:75], v[136:139], v[112:115]
    v_pk_mul_f16 v152, v152, v88
    v_fma_f32 v178, |v104|, v56, v178
    v_mfma_f32_16x16x32_f16 v[112:115], a[76:79], v[140:143], v[112:115]
    v_pk_mul_f16 v153, v153, v89
    v_fma_f32 v178, |v105|, v57, v178
    v_mfma_f32_16x16x32_f16 v[116:119], a[92:95], v[140:143], v[36:39]
    v_pk_mul_f16 v154, v154, v90
    v_fma_f32 v178, |v106|, v58, v178
    v_mfma_f32_16x16x32_f16 v[116:119], a[88:91], v[136:139], v[116:119]
    s_waitcnt lgkmcnt(0)
    v_pk_mul_f16 v160, v160, v80
    v_fma_f32 v178, |v107|, v59, v178
    v_mfma_f32_16x16x32_f16 v[116:119], a[84:87], v[132:135], v[116:119]
    v_pk_mul_f16 v161, v161, v81
    v_fma_f32 v178, |v108|, v60, v178
    v_mfma_f32_16x16x32_f16 v[116:119], a[80:83], v[128:131], v[116:119]
    v_pk_mul_f16 v162, v162, v82
    v_fma_f32 v178, |v109|, v61, v178
    v_mfma_f32_16x16x32_f16 v[120:123], a[96:99], v[128:131], v[40:43]
    v_pk_mul_f16 v163, v163, v83
    v_fma_f32 v178, |v110|, v62, v178
    v_mfma_f32_16x16x32_f16 v[120:123], a[100:103], v[132:135], v[120:123]
    v_pk_mul_f16 v164, v164, v84
    v_fma_f32 v178, |v111|, v63, v178
    v_mfma_f32_16x16x32_f16 v[120:123], a[104:107], v[136:139], v[120:123]
    v_pk_mul_f16 v155, v155, v91
    v_fma_f32 v178, |v112|, v64, v178
    v_mfma_f32_16x16x32_f16 v[120:123], a[108:111], v[140:143], v[120:123]
    v_pk_mul_f16 v156, v156, v92
    v_fma_f32 v178, |v113|, v65, v178
    v_mfma_f32_16x16x32_f16 v[124:127], a[124:127], v[140:143], v[44:47]
    v_pk_mul_f16 v157, v157, v93
    v_fma_f32 v178, |v114|, v66, v178
    v_mfma_f32_16x16x32_f16 v[124:127], a[120:123], v[136:139], v[124:127]
    v_pk_mul_f16 v158, v158, v94
    v_fma_f32 v178, |v115|, v67, v178
    v_mfma_f32_16x16x32_f16 v[124:127], a[116:119], v[132:135], v[124:127]
    v_pk_mul_f16 v159, v159, v95
    v_fma_f32 v178, |v116|, v68, v178
    v_mfma_f32_16x16x32_f16 v[124:127], a[112:115], v[128:131], v[124:127]
    v_pk_mul_f16 v165, v165, v85
    v_fma_f32 v178, |v117|, v69, v178
    v_mfma_f32_16x16x32_f16 v[96:99], a[112:115], v[144:147], v[44:47]
    ds_read_b128 v[140:143], v245 offset:5952
    v_fma_f32 v178, |v118|, v70, v178
    v_mfma_f32_16x16x32_f16 v[96:99], a[116:119], v[148:151], v[96:99]
    ds_read_b128 v[136:139], v245 offset:5888
    v_fma_f32 v178, |v119|, v71, v178
    v_mfma_f32_16x16x32_f16 v[96:99], a[120:123], v[152:155], v[96:99]
    ds_read_b128 v[132:135], v245 offset:5824
    v_fma_f32 v178, |v120|, v72, v178
    v_mfma_f32_16x16x32_f16 v[96:99], a[124:127], v[156:159], v[96:99]
    ds_read_b128 v[128:131], v245 offset:5760
    v_fma_f32 v178, |v121|, v73, v178
    v_mfma_f32_16x16x32_f16 v[100:103], a[108:111], v[156:159], v[40:43]
    v_pk_mul_f16 v166, v166, v86
    v_fma_f32 v178, |v122|, v74, v178
    v_mfma_f32_16x16x32_f16 v[100:103], a[104:107], v[152:155], v[100:103]
    v_pk_mul_f16 v167, v167, v87
    v_fma_f32 v178, |v123|, v75, v178
    v_mfma_f32_16x16x32_f16 v[100:103], a[100:103], v[148:151], v[100:103]
    v_pk_mul_f16 v168, v168, v88
    v_fma_f32 v178, |v124|, v76, v178
    v_mfma_f32_16x16x32_f16 v[100:103], a[96:99], v[144:147], v[100:103]
    v_pk_mul_f16 v169, v169, v89
    v_fma_f32 v178, |v125|, v77, v178
    v_mfma_f32_16x16x32_f16 v[104:107], a[80:83], v[144:147], v[36:39]
    v_pk_mul_f16 v170, v170, v90
    v_fma_f32 v178, |v126|, v78, v178
    v_mfma_f32_16x16x32_f16 v[104:107], a[84:87], v[148:151], v[104:107]
    v_pk_mul_f16 v171, v171, v91
    v_fma_f32 v178, |v127|, v79, v178
    v_mfma_f32_16x16x32_f16 v[104:107], a[88:91], v[152:155], v[104:107]
    v_pk_mul_f16 v172, v172, v92
    v_mul_f32 v179, |v96|, v76
    v_mfma_f32_16x16x32_f16 v[104:107], a[92:95], v[156:159], v[104:107]
    v_pk_mul_f16 v173, v173, v93
    v_fma_f32 v179, |v97|, v77, v179
    v_mfma_f32_16x16x32_f16 v[108:111], a[76:79], v[156:159], v[32:35]
    v_pk_mul_f16 v174, v174, v94
    v_fma_f32 v179, |v98|, v78, v179
    v_mfma_f32_16x16x32_f16 v[108:111], a[72:75], v[152:155], v[108:111]
    v_pk_mul_f16 v175, v175, v95
    v_fma_f32 v179, |v99|, v79, v179
    v_mfma_f32_16x16x32_f16 v[108:111], a[68:71], v[148:151], v[108:111]
L_pad2:
    s_cbranch_execz L_hopret
    s_waitcnt lgkmcnt(0)
    v_pk_mul_f16 v128, v128, v80
    v_fma_f32 v179, |v100|, v72, v179
    v_mfma_f32_16x16x32_f16 v[108:111], a[64:67], v[144:147], v[108:111]
    v_pk_mul_f16 v129, v129, v81
    v_fma_f32 v179, |v101|, v73, v179
    v_mfma_f32_16x16x32_f16 v[220:223], v[160:163], v[80:83], 0
    v_pk_mul_f16 v130, v130, v82
    v_fma_f32 v179, |v102|, v74, v179
    v_mfma_f32_16x16x32_f16 v[220:223], v[164:167], v[84:87], v[220:223]
    v_pk_mul_f16 v131, v131, v83
    v_fma_f32 v179, |v103|, v75, v179
    v_mfma_f32_16x16x32_f16 v[220:223], v[168:171], v[88:91], v[220:223]
    v_pk_mul_f16 v132, v132, v84
    v_fma_f32 v179, |v104|, v68, v179
    v_mfma_f32_16x16x32_f16 v[220:223], v[172:175], v[92:95], v[220:223]
    v_pk_mul_f16 v133, v133, v85
    v_fma_f32 v179, |v105|, v69, v179
    v_mfma_f32_16x16x32_f16 v[224:227], v[172:175], v[216:219], 0
    v_pk_mul_f16 v134, v134, v86
    v_fma_f32 v179, |v106|, v70, v179
    v_mfma_f32_16x16x32_f16 v[224:227], v[168:171], v[212:215], v[224:227]
    v_pk_mul_f16 v135, v135, v87
    v_fma_f32 v179, |v107|, v71, v179
    v_mfma_f32_16x16x32_f16 v[224:227], v[164:167], v[208:211], v[224:227]
    v_pk_mul_f16 v136, v136, v88
    v_pk_mul_f16 v137, v137, v89
    v_mfma_f32_16x16x32_f16 v[224:227], v[160:163], v[204:207], v[224:227]
    ds_read_b128 v[172:175], v245 offset:9408
    ds_read_b128 v[168:171], v245 offset:9344
    v_mfma_f32_16x16x32_f16 v[112:115], a[48:51], v[144:147], v[28:31]
    ds_read_b128 v[164:167], v245 offset:9280
    ds_read_b128 v[160:163], v245 offset:9216
    v_mfma_f32_16x16x32_f16 v[112:115], a[52:55], v[148:151], v[112:115]
    v_pk_mul_f16 v138, v138, v90
    v_pk_mul_f16 v139, v139, v91
    v_mfma_f32_16x16x32_f16 v[112:115], a[56:59], v[152:155], v[112:115]
    ds_write_b128 v238, v[220:223] offset:4608
    v_mfma_f32_16x16x32_f16 v[112:115], a[60:63], v[156:159], v[112:115]
    ds_write_b128 v238, v[224:227] offset:6912
    v_mfma_f32_16x16x32_f16 v[116:119], a[44:47], v[156:159], v[24:27]
    v_pk_mul_f16 v140, v140, v92
    v_fma_f32 v179, |v108|, v64, v179
    v_mfma_f32_16x16x32_f16 v[116:119], a[40:43], v[152:155], v[116:119]
    v_pk_mul_f16 v141, v141, v93
    v_fma_f32 v179, |v109|, v65, v179
    v_mfma_f32_16x16x32_f16 v[116:119], a[36:39], v[148:151], v[116:119]
    v_pk_mul_f16 v142, v142, v94
    v_fma_f32 v179, |v110|, v66, v179
    v_mfma_f32_16x16x32_f16 v[116:119], a[32:35], v[144:147], v[116:119]
    v_pk_mul_f16 v143, v143, v95
    v_fma_f32 v179, |v111|, v67, v179
    v_mfma_f32_16x16x32_f16 v[120:123], a[16:19], v[144:147], v[20:23]
    v_add_u32_sdwa v234, v234, s5 dst_sel:DWORD dst_unused:UNUSED_PAD src0_sel:WORD_0 src1_sel:DWORD
    v_fma_f32 v179, |v112|, v60, v179
    v_mfma_f32_16x16x32_f16 v[120:123], a[20:23], v[148:151], v[120:123]
    s_waitcnt lgkmcnt(2)
    v_pk_mul_f16 v160, v160, v204
    v_fma_f32 v179, |v113|, v61, v179
    v_mfma_f32_16x16x32_f16 v[120:123], a[24:27], v[152:155], v[120:123]
    v_pk_mul_f16 v161, v161, v205
    v_fma_f32 v179, |v114|, v62, v179
    v_mfma_f32_16x16x32_f16 v[120:123], a[28:31], v[156:159], v[120:123]
    v_pk_mul_f16 v162, v162, v206
    v_fma_f32 v179, |v115|, v63, v179
    v_mfma_f32_16x16x32_f16 v[124:127], a[12:15], v[156:159], v[16:19]
    v_pk_mul_f16 v163, v163, v207
    v_fma_f32 v179, |v116|, v56, v179
    v_mfma_f32_16x16x32_f16 v[124:127], a[8:11], v[152:155], v[124:127]
    v_pk_mul_f16 v164, v164, v208
    v_fma_f32 v179, |v117|, v57, v179
    v_mfma_f32_16x16x32_f16 v[124:127], a[4:7], v[148:151], v[124:127]
    v_pk_mul_f16 v165, v165, v209
    v_fma_f32 v179, |v118|, v58, v179
    v_mfma_f32_16x16x32_f16 v[124:127], a[0:3], v[144:147], v[124:127]
    v_pk_mul_f16 v166, v166, v210
    v_fma_f32 v179, |v119|, v59, v179
    v_mfma_f32_16x16x32_f16 v[96:99], a[0:3], v[128:131], v[16:19]
    ds_read_b128 v[156:159], v245 offset:6240
    v_fma_f32 v179, |v120|, v52, v179
    v_mfma_f32_16x16x32_f16 v[96:99], a[4:7], v[132:135], v[96:99]
    ds_read_b128 v[152:155], v245 offset:6176
    v_fma_f32 v179, |v121|, v53, v179
    v_mfma_f32_16x16x32_f16 v[96:99], a[8:11], v[136:139], v[96:99]
    ds_read_b128 v[148:151], v245 offset:6112
    v_fma_f32 v179, |v122|, v54, v179
    v_mfma_f32_16x16x32_f16 v[96:99], a[12:15], v[140:143], v[96:99]
    ds_read_b128 v[144:147], v245 offset:6048
    v_fma_f32 v179, |v123|, v55, v179
    v_mfma_f32_16x16x32_f16 v[100:103], a[28:31], v[140:143], v[20:23]
    v_pk_mul_f16 v167, v167, v211
    v_fma_f32 v179, |v124|, v48, v179
    v_mfma_f32_16x16x32_f16 v[100:103], a[24:27], v[136:139], v[100:103]
    v_pk_mul_f16 v168, v168, v212
    v_fma_f32 v179, |v125|, v49, v179
    v_mfma_f32_16x16x32_f16 v[100:103], a[20:23], v[132:135], v[100:103]
    v_pk_mul_f16 v169, v169, v213
    v_fma_f32 v179, |v126|, v50, v179
    v_mfma_f32_16x16x32_f16 v[100:103], a[16:19], v[128:131], v[100:103]
    v_pk_mul_f16 v170, v170, v214
    v_fma_f32 v179, |v127|, v51, v179
    v_mfma_f32_16x16x32_f16 v[104:107], a[32:35], v[128:131], v[24:27]
    v_pk_mul_f16 v171, v171, v215
    v_mul_f32 v180, |v96|, v48
    v_mfma_f32_16x16x32_f16 v[104:107], a[36:39], v[132:135], v[104:107]
    v_pk_mul_f16 v172, v172, v216
    v_fma_f32 v180, |v97|, v49, v180
    v_mfma_f32_16x16x32_f16 v[104:107], a[40:43], v[136:139], v[104:107]
    v_pk_mul_f16 v173, v173, v217
    v_fma_f32 v180, |v98|, v50, v180
    v_mfma_f32_16x16x32_f16 v[104:107], a[44:47], v[140:143], v[104:107]
    v_pk_mul_f16 v174, v174, v218
    v_fma_f32 v180, |v99|, v51, v180
    v_mfma_f32_16x16x32_f16 v[108:111], a[60:63], v[140:143], v[28:31]
    v_pk_mul_f16 v175, v175, v219
    v_fma_f32 v180, |v100|, v52, v180
    v_mfma_f32_16x16x32_f16 v[108:111], a[56:59], v[136:139], v[108:111]
    s_waitcnt lgkmcnt(0)
    v_pk_mul_f16 v144, v144, v80
    v_fma_f32 v180, |v101|, v53, v180
    v_mfma_f32_16x16x32_f16 v[108:111], a[52:55], v[132:135], v[108:111]
    v_pk_mul_f16 v145, v145, v81
    v_fma_f32 v180, |v102|, v54, v180
    v_mfma_f32_16x16x32_f16 v[108:111], a[48:51], v[128:131], v[108:111]
    v_pk_mul_f16 v146, v146, v82
    v_fma_f32 v180, |v103|, v55, v180
    v_mfma_f32_16x16x32_f16 v[228:231], v[160:163], v[204:207], 0
    v_pk_mul_f16 v147, v147, v83
    v_fma_f32 v180, |v104|, v56, v180
    v_mfma_f32_16x16x32_f16 v[228:231], v[164:167], v[208:211], v[228:231]
    v_pk_mul_f16 v148, v148, v84
    v_fma_f32 v180, |v105|, v57, v180
    v_mfma_f32_16x16x32_f16 v[228:231], v[168:171], v[212:215], v[228:231]
    v_pk_mul_f16 v149, v149, v85
    v_fma_f32 v180, |v106|, v58, v180
    v_mfma_f32_16x16x32_f16 v[228:231], v[172:175], v[216:219], v[228:231]
    ds_read_b128 v[172:175], v245 offset:9696
    v_fma_f32 v180, |v107|, v59, v180
    v_mfma_f32_16x16x32_f16 v[112:115], a[64:67], v[128:131], v[32:35]
    ds_read_b128 v[168:171], v245 offset:9632
    ds_read_b128 v[164:167], v245 offset:9568
    v_mfma_f32_16x16x32_f16 v[112:115], a[68:71], v[132:135], v[112:115]
    ds_read_b128 v[160:163], v245 offset:9504
    v_pk_mul_f16 v150, v150, v86
    v_mfma_f32_16x16x32_f16 v[112:115], a[72:75], v[136:139], v[112:115]
    ds_write_b128 v238, v[228:231] offset:2368
    v_mfma_f32_16x16x32_f16 v[112:115], a[76:79], v[140:143], v[112:115]
    v_pk_mul_f16 v151, v151, v87
    v_fma_f32 v180, |v108|, v60, v180
    v_mfma_f32_16x16x32_f16 v[116:119], a[92:95], v[140:143], v[36:39]
    v_pk_mul_f16 v152, v152, v88
    v_fma_f32 v180, |v109|, v61, v180
    v_mfma_f32_16x16x32_f16 v[116:119], a[88:91], v[136:139], v[116:119]
    v_pk_mul_f16 v153, v153, v89
    v_fma_f32 v180, |v110|, v62, v180
    v_mfma_f32_16x16x32_f16 v[116:119], a[84:87], v[132:135], v[116:119]
    v_pk_mul_f16 v154, v154, v90
    v_fma_f32 v180, |v111|, v63, v180
    v_mfma_f32_16x16x32_f16 v[116:119], a[80:83], v[128:131], v[116:119]
    v_pk_mul_f16 v155, v155, v91
    v_fma_f32 v180, |v112|, v64, v180
    v_mfma_f32_16x16x32_f16 v[120:123], a[96:99], v[128:131], v[40:43]
    v_pk_mul_f16 v156, v156, v92
    v_fma_f32 v180, |v113|, v65, v180
    v_mfma_f32_16x16x32_f16 v[120:123], a[100:103], v[132:135], v[120:123]
    v_pk_mul_f16 v157, v157, v93
    v_fma_f32 v180, |v114|, v66, v180
    v_mfma_f32_16x16x32_f16 v[120:123], a[104:107], v[136:139], v[120:123]
    s_waitcnt lgkmcnt(1)
    v_pk_mul_f16 v160, v160, v204
    v_fma_f32 v180, |v115|, v67, v180
    v_mfma_f32_16x16x32_f16 v[120:123], a[108:111], v[140:143], v[120:123]
    v_pk_mul_f16 v161, v161, v205
    v_fma_f32 v180, |v116|, v68, v180
    v_mfma_f32_16x16x32_f16 v[124:127], a[124:127], v[140:143], v[44:47]
    v_pk_mul_f16 v162, v162, v206
    v_fma_f32 v180, |v117|, v69, v180
    v_mfma_f32_16x16x32_f16 v[124:127], a[120:123], v[136:139], v[124:127]
    v_pk_mul_f16 v158, v158, v94
    v_fma_f32 v180, |v118|, v70, v180
    v_mfma_f32_16x16x32_f16 v[124:127], a[116:119], v[132:135], v[124:127]
    v_pk_mul_f16 v159, v159, v95
    v_fma_f32 v180, |v119|, v71, v180
    v_mfma_f32_16x16x32_f16 v[124:127], a[112:115], v[128:131], v[124:127]
    v_pk_mul_f16 v163, v163, v207
    v_fma_f32 v180, |v120|, v72, v180
    v_mfma_f32_16x16x32_f16 v[96:99], a[112:115], v[144:147], v[44:47]
    ds_read_b128 v[140:143], v245 offset:6528
    v_fma_f32 v180, |v121|, v73, v180
    v_mfma_f32_16x16x32_f16 v[96:99], a[116:119], v[148:151], v[96:99]
    ds_read_b128 v[136:139], v245 offset:6464
    v_fma_f32 v180, |v122|, v74, v180
    v_mfma_f32_16x16x32_f16 v[96:99], a[120:123], v[152:155], v[96:99]
    ds_read_b128 v[132:135], v245 offset:6400
    v_fma_f32 v180, |v123|, v75, v180
    v_mfma_f32_16x16x32_f16 v[96:99], a[124:127], v[156:159], v[96:99]
    ds_read_b128 v[128:131], v245 offset:6336
    v_fma_f32 v180, |v124|, v76, v180
    v_mfma_f32_16x16x32_f16 v[100:103], a[108:111], v[156:159], v[40:43]
    v_pk_mul_f16 v164, v164, v208
    v_fma_f32 v180, |v125|, v77, v180
    v_mfma_f32_16x16x32_f16 v[100:103], a[104:107], v[152:155], v[100:103]
    v_pk_mul_f16 v165, v165, v209
    v_fma_f32 v180, |v126|, v78, v180
    v_mfma_f32_16x16x32_f16 v[100:103], a[100:103], v[148:151], v[100:103]
    v_pk_mul_f16 v166, v166, v210
    v_fma_f32 v180, |v127|, v79, v180
    v_mfma_f32_16x16x32_f16 v[100:103], a[96:99], v[144:147], v[100:103]
    v_pk_mul_f16 v167, v167, v211
    v_mul_f32 v181, |v96|, v76
    v_mfma_f32_16x16x32_f16 v[104:107], a[80:83], v[144:147], v[36:39]
    v_pk_mul_f16 v168, v168, v212
    v_fma_f32 v181, |v97|, v77, v181
    v_mfma_f32_16x16x32_f16 v[104:107], a[84:87], v[148:151], v[104:107]
    v_pk_mul_f16 v169, v169, v213
    v_fma_f32 v181, |v98|, v78, v181
    v_mfma_f32_16x16x32_f16 v[104:107], a[88:91], v[152:155], v[104:107]
    v_pk_mul_f16 v170, v170, v214
    v_fma_f32 v181, |v99|, v79, v181
    v_mfma_f32_16x16x32_f16 v[104:107], a[92:95], v[156:159], v[104:107]
    v_pk_mul_f16 v171, v171, v215
    v_fma_f32 v181, |v100|, v72, v181
    v_mfma_f32_16x16x32_f16 v[108:111], a[76:79], v[156:159], v[32:35]
    v_pk_mul_f16 v172, v172, v216
    v_fma_f32 v181, |v101|, v73, v181
    v_mfma_f32_16x16x32_f16 v[108:111], a[72:75], v[152:155], v[108:111]
    v_pk_mul_f16 v173, v173, v217
    v_fma_f32 v181, |v102|, v74, v181
    v_mfma_f32_16x16x32_f16 v[108:111], a[68:71], v[148:151], v[108:111]
    v_pk_mul_f16 v174, v174, v218
    v_fma_f32 v181, |v103|, v75, v181
    v_mfma_f32_16x16x32_f16 v[108:111], a[64:67], v[144:147], v[108:111]
    s_waitcnt lgkmcnt(0)
    v_pk_mul_f16 v128, v128, v80
    v_fma_f32 v181, |v104|, v68, v181
    v_mfma_f32_16x16x32_f16 v[112:115], a[48:51], v[144:147], v[28:31]
    v_pk_mul_f16 v129, v129, v81
    v_fma_f32 v181, |v105|, v69, v181
    v_mfma_f32_16x16x32_f16 v[112:115], a[52:55], v[148:151], v[112:115]
    v_pk_mul_f16 v130, v130, v82
    v_fma_f32 v181, |v106|, v70, v181
    v_mfma_f32_16x16x32_f16 v[112:115], a[56:59], v[152:155], v[112:115]
    v_pk_mul_f16 v131, v131, v83
    v_fma_f32 v181, |v107|, v71, v181
    v_mfma_f32_16x16x32_f16 v[112:115], a[60:63], v[156:159], v[112:115]
    v_pk_mul_f16 v132, v132, v84
    v_fma_f32 v181, |v108|, v64, v181
    v_mfma_f32_16x16x32_f16 v[116:119], a[44:47], v[156:159], v[24:27]
    v_pk_mul_f16 v133, v133, v85
    v_fma_f32 v181, |v109|, v65, v181
    v_mfma_f32_16x16x32_f16 v[116:119], a[40:43], v[152:155], v[116:119]
    v_pk_mul_f16 v134, v134, v86
    v_fma_f32 v181, |v110|, v66, v181
    v_mfma_f32_16x16x32_f16 v[116:119], a[36:39], v[148:151], v[116:119]
    v_pk_mul_f16 v135, v135, v87
    v_fma_f32 v181, |v111|, v67, v181
    v_mfma_f32_16x16x32_f16 v[116:119], a[32:35], v[144:147], v[116:119]
    v_pk_mul_f16 v136, v136, v88
    v_fma_f32 v181, |v112|, v60, v181
    v_mfma_f32_16x16x32_f16 v[120:123], a[16:19], v[144:147], v[20:23]
    v_pk_mul_f16 v137, v137, v89
    v_fma_f32 v181, |v113|, v61, v181
    v_mfma_f32_16x16x32_f16 v[120:123], a[20:23], v[148:151], v[120:123]
    v_pk_mul_f16 v138, v138, v90
    v_fma_f32 v181, |v114|, v62, v181
    v_mfma_f32_16x16x32_f16 v[120:123], a[24:27], v[152:155], v[120:123]
    v_pk_mul_f16 v139, v139, v91
    v_fma_f32 v181, |v115|, v63, v181
    v_mfma_f32_16x16x32_f16 v[120:123], a[28:31], v[156:159], v[120:123]
    v_pk_mul_f16 v140, v140, v92
    v_fma_f32 v181, |v116|, v56, v181
    v_mfma_f32_16x16x32_f16 v[124:127], a[12:15], v[156:159], v[16:19]
    v_pk_mul_f16 v141, v141, v93
    v_fma_f32 v181, |v117|, v57, v181
    v_mfma_f32_16x16x32_f16 v[124:127], a[8:11], v[152:155], v[124:127]
    v_pk_mul_f16 v142, v142, v94
    v_fma_f32 v181, |v118|, v58, v181
    v_mfma_f32_16x16x32_f16 v[124:127], a[4:7], v[148:151], v[124:127]
    v_pk_mul_f16 v143, v143, v95
    v_fma_f32 v181, |v119|, v59, v181
    v_mfma_f32_16x16x32_f16 v[124:127], a[0:3], v[144:147], v[124:127]
    v_pk_mul_f16 v175, v175, v219
    v_fma_f32 v181, |v120|, v52, v181
    v_mfma_f32_16x16x32_f16 v[96:99], a[0:3], v[128:131], v[16:19]
    ds_read_b128 v[156:159], v245 offset:6816
    v_fma_f32 v181, |v121|, v53, v181
    v_mfma_f32_16x16x32_f16 v[96:99], a[4:7], v[132:135], v[96:99]
    ds_read_b128 v[152:155], v245 offset:6752
    v_fma_f32 v181, |v122|, v54, v181
    v_mfma_f32_16x16x32_f16 v[96:99], a[8:11], v[136:139], v[96:99]
    ds_read_b128 v[148:151], v245 offset:6688
    v_fma_f32 v181, |v123|, v55, v181
    v_mfma_f32_16x16x32_f16 v[96:99], a[12:15], v[140:143], v[96:99]
    ds_read_b128 v[144:147], v245 offset:6624
    v_fma_f32 v181, |v124|, v48, v181
    v_mfma_f32_16x16x32_f16 v[228:231], v[160:163], v[204:207], 0
    v_add_u32_sdwa v242, v235, s5 dst_sel:DWORD dst_unused:UNUSED_PAD src0_sel:WORD_1 src1_sel:DWORD
    v_fma_f32 v181, |v125|, v49, v181
    v_mfma_f32_16x16x32_f16 v[228:231], v[164:167], v[208:211], v[228:231]
    v_add_u32_sdwa v235, v235, s5 dst_sel:DWORD dst_unused:UNUSED_PAD src0_sel:WORD_0 src1_sel:DWORD
    v_fma_f32 v181, |v126|, v50, v181
    v_mfma_f32_16x16x32_f16 v[228:231], v[168:171], v[212:215], v[228:231]
    v_add_u32_sdwa v243, v236, s5 dst_sel:DWORD dst_unused:UNUSED_PAD src0_sel:WORD_1 src1_sel:DWORD
    v_fma_f32 v181, |v127|, v51, v181
    v_mfma_f32_16x16x32_f16 v[228:231], v[172:175], v[216:219], v[228:231]
    v_add_u32_sdwa v236, v236, s5 dst_sel:DWORD dst_unused:UNUSED_PAD src0_sel:WORD_0 src1_sel:DWORD
    v_add_u32_sdwa v244, v237, s5 dst_sel:DWORD dst_unused:UNUSED_PAD src0_sel:WORD_1 src1_sel:DWORD
    v_mfma_f32_16x16x32_f16 v[100:103], a[28:31], v[140:143], v[20:23]
    v_add_u32_sdwa v237, v237, s5 dst_sel:DWORD dst_unused:UNUSED_PAD src0_sel:WORD_0 src1_sel:DWORD
    v_mfma_f32_16x16x32_f16 v[100:103], a[24:27], v[136:139], v[100:103]
    v_permlane32_swap_b32 v184, v186
    v_mfma_f32_16x16x32_f16 v[100:103], a[20:23], v[132:135], v[100:103]
    v_permlane32_swap_b32 v185, v187
    v_mfma_f32_16x16x32_f16 v[100:103], a[16:19], v[128:131], v[100:103]
    ds_write_b128 v238, v[228:231] offset:6976
    v_mfma_f32_16x16x32_f16 v[104:107], a[32:35], v[128:131], v[24:27]
    ds_read2st64_b32 v[230:231], v237 offset0:0 offset1:18
    v_mul_f32 v182, |v96|, v48
    v_mfma_f32_16x16x32_f16 v[104:107], a[36:39], v[132:135], v[104:107]
    ds_read2st64_b32 v[228:229], v236 offset0:0 offset1:18
    v_fma_f32 v182, |v97|, v49, v182
    v_mfma_f32_16x16x32_f16 v[104:107], a[40:43], v[136:139], v[104:107]
    ds_read2st64_b32 v[222:223], v233 offset0:0 offset1:18
    v_fma_f32 v182, |v98|, v50, v182
    v_mfma_f32_16x16x32_f16 v[104:107], a[44:47], v[140:143], v[104:107]
    ds_read2st64_b32 v[220:221], v232 offset0:0 offset1:18
    v_fma_f32 v182, |v99|, v51, v182
    v_mfma_f32_16x16x32_f16 v[108:111], a[60:63], v[140:143], v[28:31]
    ds_read2st64_b32 v[226:227], v235 offset0:0 offset1:18
    v_fma_f32 v182, |v100|, v52, v182
    v_mfma_f32_16x16x32_f16 v[108:111], a[56:59], v[136:139], v[108:111]
    ds_read2st64_b32 v[224:225], v234 offset0:0 offset1:18
    v_fma_f32 v182, |v101|, v53, v182
    v_mfma_f32_16x16x32_f16 v[108:111], a[52:55], v[132:135], v[108:111]
    s_waitcnt lgkmcnt(7)
    v_pk_mul_f16 v144, v144, v80
    v_fma_f32 v182, |v102|, v54, v182
    v_mfma_f32_16x16x32_f16 v[108:111], a[48:51], v[128:131], v[108:111]
    v_pk_mul_f16 v145, v145, v81
    v_fma_f32 v182, |v103|, v55, v182
    v_mfma_f32_16x16x32_f16 v[112:115], a[64:67], v[128:131], v[32:35]
    v_pk_mul_f16 v146, v146, v82
    v_fma_f32 v182, |v104|, v56, v182
    v_mfma_f32_16x16x32_f16 v[112:115], a[68:71], v[132:135], v[112:115]
    v_pk_mul_f16 v147, v147, v83
    v_fma_f32 v182, |v105|, v57, v182
    v_mfma_f32_16x16x32_f16 v[112:115], a[72:75], v[136:139], v[112:115]
    v_pk_mul_f16 v148, v148, v84
    v_fma_f32 v182, |v106|, v58, v182
    v_mfma_f32_16x16x32_f16 v[112:115], a[76:79], v[140:143], v[112:115]
    v_pk_mul_f16 v149, v149, v85
    v_fma_f32 v182, |v107|, v59, v182
    v_mfma_f32_16x16x32_f16 v[116:119], a[92:95], v[140:143], v[36:39]
    v_pk_mul_f16 v150, v150, v86
    v_fma_f32 v182, |v108|, v60, v182
    v_mfma_f32_16x16x32_f16 v[116:119], a[88:91], v[136:139], v[116:119]
    v_pk_mul_f16 v151, v151, v87
    v_fma_f32 v182, |v109|, v61, v182
    v_mfma_f32_16x16x32_f16 v[116:119], a[84:87], v[132:135], v[116:119]
    v_pk_mul_f16 v152, v152, v88
    v_fma_f32 v182, |v110|, v62, v182
    v_mfma_f32_16x16x32_f16 v[116:119], a[80:83], v[128:131], v[116:119]
    v_pk_mul_f16 v153, v153, v89
    v_fma_f32 v182, |v111|, v63, v182
    v_mfma_f32_16x16x32_f16 v[120:123], a[96:99], v[128:131], v[40:43]
    v_pk_mul_f16 v154, v154, v90
    v_fma_f32 v182, |v112|, v64, v182
    v_mfma_f32_16x16x32_f16 v[120:123], a[100:103], v[132:135], v[120:123]
    v_pk_mul_f16 v155, v155, v91
    v_fma_f32 v182, |v113|, v65, v182
    v_mfma_f32_16x16x32_f16 v[120:123], a[104:107], v[136:139], v[120:123]
    v_pk_mul_f16 v156, v156, v92
    v_fma_f32 v182, |v114|, v66, v182
    v_mfma_f32_16x16x32_f16 v[120:123], a[108:111], v[140:143], v[120:123]
    v_pk_mul_f16 v157, v157, v93
    v_fma_f32 v182, |v115|, v67, v182
    v_mfma_f32_16x16x32_f16 v[124:127], a[124:127], v[140:143], v[44:47]
    v_pk_mul_f16 v158, v158, v94
    v_fma_f32 v182, |v116|, v68, v182
    v_mfma_f32_16x16x32_f16 v[124:127], a[120:123], v[136:139], v[124:127]
    v_pk_mul_f16 v159, v159, v95
    v_fma_f32 v182, |v117|, v69, v182
    v_mfma_f32_16x16x32_f16 v[124:127], a[116:119], v[132:135], v[124:127]
    v_add_f32 v184, v184, v186
    v_fma_f32 v182, |v118|, v70, v182
    v_mfma_f32_16x16x32_f16 v[124:127], a[112:115], v[128:131], v[124:127]
    v_add_f32 v185, v185, v187
    v_fma_f32 v182, |v119|, v71, v182
    v_mfma_f32_16x16x32_f16 v[96:99], a[112:115], v[144:147], v[44:47]
    ds_read_b128 v[140:143], v245 offset:7104
    v_fma_f32 v182, |v120|, v72, v182
    v_mfma_f32_16x16x32_f16 v[96:99], a[116:119], v[148:151], v[96:99]
    ds_read_b128 v[136:139], v245 offset:7040
    v_fma_f32 v182, |v121|, v73, v182
    v_mfma_f32_16x16x32_f16 v[96:99], a[120:123], v[152:155], v[96:99]
    ds_read_b128 v[132:135], v245 offset:6976
    v_fma_f32 v182, |v122|, v74, v182
    v_mfma_f32_16x16x32_f16 v[96:99], a[124:127], v[156:159], v[96:99]
    ds_read_b128 v[128:131], v245 offset:6912
    v_fma_f32 v182, |v123|, v75, v182
    v_mfma_f32_16x16x32_f16 v[100:103], a[108:111], v[156:159], v[40:43]
    v_permlane16_swap_b32 v184, v185
    v_mfma_f32_16x16x32_f16 v[100:103], a[104:107], v[152:155], v[100:103]
    v_add_f32 v184, v184, v185
    v_fma_f32 v182, |v124|, v76, v182
    v_mfma_f32_16x16x32_f16 v[100:103], a[100:103], v[148:151], v[100:103]
    s_waitcnt lgkmcnt(4)
    v_fma_f32 v184, v224, s12, v184
    v_fma_f32 v182, |v125|, v77, v182
    v_mfma_f32_16x16x32_f16 v[100:103], a[96:99], v[144:147], v[100:103]
    v_permlane32_swap_b32 v188, v190
    v_mfma_f32_16x16x32_f16 v[104:107], a[80:83], v[144:147], v[36:39]
    v_permlane32_swap_b32 v189, v191
    v_mfma_f32_16x16x32_f16 v[104:107], a[84:87], v[148:151], v[104:107]
    v_add_f32 v188, v188, v190
    v_fma_f32 v182, |v126|, v78, v182
    v_mfma_f32_16x16x32_f16 v[104:107], a[88:91], v[152:155], v[104:107]
    v_add_f32 v189, v189, v191
    v_fma_f32 v182, |v127|, v79, v182
    v_mfma_f32_16x16x32_f16 v[104:107], a[92:95], v[156:159], v[104:107]
    v_permlane16_swap_b32 v188, v189
    v_mfma_f32_16x16x32_f16 v[108:111], a[76:79], v[156:159], v[32:35]
    s_waitcnt lgkmcnt(0)
    v_pk_mul_f16 v128, v128, v80
    v_mul_f32 v183, |v96|, v76
    v_mfma_f32_16x16x32_f16 v[108:111], a[72:75], v[152:155], v[108:111]
    v_pk_mul_f16 v129, v129, v81
    v_fma_f32 v183, |v97|, v77, v183
    v_mfma_f32_16x16x32_f16 v[108:111], a[68:71], v[148:151], v[108:111]
    v_pk_mul_f16 v130, v130, v82
    v_fma_f32 v183, |v98|, v78, v183
    v_mfma_f32_16x16x32_f16 v[108:111], a[64:67], v[144:147], v[108:111]
    v_pk_mul_f16 v131, v131, v83
    v_fma_f32 v183, |v99|, v79, v183
    v_mfma_f32_16x16x32_f16 v[112:115], a[48:51], v[144:147], v[28:31]
    v_pk_mul_f16 v132, v132, v84
    v_fma_f32 v183, |v100|, v72, v183
    v_mfma_f32_16x16x32_f16 v[112:115], a[52:55], v[148:151], v[112:115]
    v_pk_mul_f16 v133, v133, v85
    v_fma_f32 v183, |v101|, v73, v183
    v_mfma_f32_16x16x32_f16 v[112:115], a[56:59], v[152:155], v[112:115]
    v_pk_mul_f16 v134, v134, v86
    v_fma_f32 v183, |v102|, v74, v183
    v_mfma_f32_16x16x32_f16 v[112:115], a[60:63], v[156:159], v[112:115]
    v_pk_mul_f16 v135, v135, v87
    v_fma_f32 v183, |v103|, v75, v183
    v_mfma_f32_16x16x32_f16 v[116:119], a[44:47], v[156:159], v[24:27]
    v_pk_mul_f16 v136, v136, v88
    v_fma_f32 v183, |v104|, v68, v183
    v_mfma_f32_16x16x32_f16 v[116:119], a[40:43], v[152:155], v[116:119]
    v_pk_mul_f16 v137, v137, v89
    v_fma_f32 v183, |v105|, v69, v183
    v_mfma_f32_16x16x32_f16 v[116:119], a[36:39], v[148:151], v[116:119]
    v_pk_mul_f16 v138, v138, v90
    v_fma_f32 v183, |v106|, v70, v183
    v_mfma_f32_16x16x32_f16 v[116:119], a[32:35], v[144:147], v[116:119]
    v_pk_mul_f16 v139, v139, v91
    v_fma_f32 v183, |v107|, v71, v183
    v_mfma_f32_16x16x32_f16 v[120:123], a[16:19], v[144:147], v[20:23]
    v_pk_mul_f16 v140, v140, v92
    v_fma_f32 v183, |v108|, v64, v183
    v_mfma_f32_16x16x32_f16 v[120:123], a[20:23], v[148:151], v[120:123]
    v_pk_mul_f16 v141, v141, v93
    v_fma_f32 v183, |v109|, v65, v183
    v_mfma_f32_16x16x32_f16 v[120:123], a[24:27], v[152:155], v[120:123]
    v_pk_mul_f16 v142, v142, v94
    v_fma_f32 v183, |v110|, v66, v183
    v_mfma_f32_16x16x32_f16 v[120:123], a[28:31], v[156:159], v[120:123]
    v_pk_mul_f16 v143, v143, v95
    v_fma_f32 v183, |v111|, v67, v183
    v_mfma_f32_16x16x32_f16 v[124:127], a[12:15], v[156:159], v[16:19]
    v_add_f32 v188, v188, v189
    v_fma_f32 v183, |v112|, v60, v183
    v_mfma_f32_16x16x32_f16 v[124:127], a[8:11], v[152:155], v[124:127]
    v_fma_f32 v188, v226, s12, v188
    v_fma_f32 v183, |v113|, v61, v183
    v_mfma_f32_16x16x32_f16 v[124:127], a[4:7], v[148:151], v[124:127]
    v_cndmask_b32 v188, v251, v188, s[36:37]
    v_fma_f32 v183, |v114|, v62, v183
    v_mfma_f32_16x16x32_f16 v[124:127], a[0:3], v[144:147], v[124:127]
    v_permlane32_swap_b32 v176, v178
    v_mfma_f32_16x16x32_f16 v[96:99], a[0:3], v[128:131], v[16:19]
    ds_read_b128 v[156:159], v245 offset:7392
    v_fma_f32 v183, |v115|, v63, v183
    v_mfma_f32_16x16x32_f16 v[96:99], a[4:7], v[132:135], v[96:99]
    ds_read_b128 v[152:155], v245 offset:7328
    v_fma_f32 v183, |v116|, v56, v183
    v_mfma_f32_16x16x32_f16 v[96:99], a[8:11], v[136:139], v[96:99]
    ds_read_b128 v[148:151], v245 offset:7264
    v_fma_f32 v183, |v117|, v57, v183
    v_mfma_f32_16x16x32_f16 v[96:99], a[12:15], v[140:143], v[96:99]
    ds_read_b128 v[144:147], v245 offset:7200
    v_fma_f32 v183, |v118|, v58, v183
    v_mfma_f32_16x16x32_f16 v[100:103], a[28:31], v[140:143], v[20:23]
    v_permlane32_swap_b32 v177, v179
    v_mfma_f32_16x16x32_f16 v[100:103], a[24:27], v[136:139], v[100:103]
    v_add_f32 v176, v176, v178
    v_fma_f32 v183, |v119|, v59, v183
    v_mfma_f32_16x16x32_f16 v[100:103], a[20:23], v[132:135], v[100:103]
    v_add_f32 v177, v177, v179
    v_fma_f32 v183, |v120|, v52, v183
    v_mfma_f32_16x16x32_f16 v[100:103], a[16:19], v[128:131], v[100:103]
    v_permlane16_swap_b32 v176, v177
    v_mfma_f32_16x16x32_f16 v[104:107], a[32:35], v[128:131], v[24:27]
    v_add_f32 v176, v176, v177
    v_fma_f32 v183, |v121|, v53, v183
    v_mfma_f32_16x16x32_f16 v[104:107], a[36:39], v[132:135], v[104:107]
    v_fma_f32 v176, v220, s12, v176
    v_fma_f32 v183, |v122|, v54, v183
    v_mfma_f32_16x16x32_f16 v[104:107], a[40:43], v[136:139], v[104:107]
    v_max3_f32 v248, v184, v188, v176
    v_fma_f32 v183, |v123|, v55, v183
    v_mfma_f32_16x16x32_f16 v[104:107], a[44:47], v[140:143], v[104:107]
    v_fma_f32 v183, |v124|, v48, v183
    v_fma_f32 v183, |v125|, v49, v183
    v_mfma_f32_16x16x32_f16 v[108:111], a[60:63], v[140:143], v[28:31]
    s_waitcnt lgkmcnt(0)
    v_pk_mul_f16 v144, v144, v80
    v_fma_f32 v183, |v126|, v50, v183
    v_mfma_f32_16x16x32_f16 v[108:111], a[56:59], v[136:139], v[108:111]
    v_pk_mul_f16 v145, v145, v81
    v_fma_f32 v183, |v127|, v51, v183
    v_mfma_f32_16x16x32_f16 v[108:111], a[52:55], v[132:135], v[108:111]
L_pad3:
    s_cbranch_execz L_hopret
    v_pk_mul_f16 v146, v146, v82
    v_mul_f32 v192, |v96|, v48
    v_mfma_f32_16x16x32_f16 v[108:111], a[48:51], v[128:131], v[108:111]
    v_pk_mul_f16 v147, v147, v83
    v_fma_f32 v192, |v97|, v49, v192
    v_mfma_f32_16x16x32_f16 v[112:115], a[64:67], v[128:131], v[32:35]
    v_pk_mul_f16 v148, v148, v84
    v_fma_f32 v192, |v98|, v50, v192
    v_mfma_f32_16x16x32_f16 v[112:115], a[68:71], v[132:135], v[112:115]
    v_pk_mul_f16 v149, v149, v85
    v_fma_f32 v192, |v99|, v51, v192
    v_mfma_f32_16x16x32_f16 v[112:115], a[72:75], v[136:139], v[112:115]
    v_pk_mul_f16 v150, v150, v86
    v_fma_f32 v192, |v100|, v52, v192
    v_mfma_f32_16x16x32_f16 v[112:115], a[76:79], v[140:143], v[112:115]
    v_pk_mul_f16 v151, v151, v87
    v_fma_f32 v192, |v101|, v53, v192
    v_mfma_f32_16x16x32_f16 v[116:119], a[92:95], v[140:143], v[36:39]
    v_pk_mul_f16 v152, v152, v88
    v_fma_f32 v192, |v102|, v54, v192
    v_mfma_f32_16x16x32_f16 v[116:119], a[88:91], v[136:139], v[116:119]
    v_pk_mul_f16 v153, v153, v89
    v_fma_f32 v192, |v103|, v55, v192
    v_mfma_f32_16x16x32_f16 v[116:119], a[84:87], v[132:135], v[116:119]
    v_pk_mul_f16 v154, v154, v90
    v_fma_f32 v192, |v104|, v56, v192
    v_mfma_f32_16x16x32_f16 v[116:119], a[80:83], v[128:131], v[116:119]
    v_pk_mul_f16 v155, v155, v91
    v_fma_f32 v192, |v105|, v57, v192
    v_mfma_f32_16x16x32_f16 v[120:123], a[96:99], v[128:131], v[40:43]
    v_pk_mul_f16 v156, v156, v92
    v_fma_f32 v192, |v106|, v58, v192
    v_mfma_f32_16x16x32_f16 v[120:123], a[100:103], v[132:135], v[120:123]
    v_pk_mul_f16 v157, v157, v93
    v_fma_f32 v192, |v107|, v59, v192
    v_mfma_f32_16x16x32_f16 v[120:123], a[104:107], v[136:139], v[120:123]
    v_pk_mul_f16 v158, v158, v94
    v_fma_f32 v192, |v108|, v60, v192
    v_mfma_f32_16x16x32_f16 v[120:123], a[108:111], v[140:143], v[120:123]
    v_pk_mul_f16 v159, v159, v95
    v_fma_f32 v192, |v109|, v61, v192
    v_mfma_f32_16x16x32_f16 v[124:127], a[124:127], v[140:143], v[44:47]
    ds_read_b128 v[216:219], v239 offset:4800
    v_fma_f32 v192, |v110|, v62, v192
    v_mfma_f32_16x16x32_f16 v[124:127], a[120:123], v[136:139], v[124:127]
    ds_read_b128 v[212:215], v239 offset:4736
    v_fma_f32 v192, |v111|, v63, v192
    v_mfma_f32_16x16x32_f16 v[124:127], a[116:119], v[132:135], v[124:127]
    ds_read_b128 v[208:211], v239 offset:4672
    v_fma_f32 v192, |v112|, v64, v192
    v_mfma_f32_16x16x32_f16 v[124:127], a[112:115], v[128:131], v[124:127]
    ds_read_b128 v[204:207], v239 offset:4608
    v_fma_f32 v192, |v113|, v65, v192
    v_mfma_f32_16x16x32_f16 v[96:99], a[112:115], v[144:147], v[44:47]
    ds_read_b128 v[140:143], v240 offset:4800
    v_fma_f32 v192, |v114|, v66, v192
    v_mfma_f32_16x16x32_f16 v[96:99], a[116:119], v[148:151], v[96:99]
    ds_read_b128 v[136:139], v240 offset:4736
    v_fma_f32 v192, |v115|, v67, v192
    v_mfma_f32_16x16x32_f16 v[96:99], a[120:123], v[152:155], v[96:99]
    ds_read_b128 v[132:135], v240 offset:4672
    v_fma_f32 v192, |v116|, v68, v192
    v_mfma_f32_16x16x32_f16 v[96:99], a[124:127], v[156:159], v[96:99]
    ds_read_b128 v[128:131], v240 offset:4608
    v_fma_f32 v192, |v117|, v69, v192
    v_mfma_f32_16x16x32_f16 v[100:103], a[108:111], v[156:159], v[40:43]
    v_permlane32_swap_b32 v180, v182
    v_mfma_f32_16x16x32_f16 v[100:103], a[104:107], v[152:155], v[100:103]
    v_permlane32_swap_b32 v181, v183
    v_mfma_f32_16x16x32_f16 v[100:103], a[100:103], v[148:151], v[100:103]
    v_add_f32 v180, v180, v182
    v_fma_f32 v192, |v118|, v70, v192
    v_mfma_f32_16x16x32_f16 v[100:103], a[96:99], v[144:147], v[100:103]
    v_add_f32 v181, v181, v183
    v_fma_f32 v192, |v119|, v71, v192
    v_mfma_f32_16x16x32_f16 v[104:107], a[80:83], v[144:147], v[36:39]
    v_permlane16_swap_b32 v180, v181
    v_fma_f32 v192, |v120|, v72, v192
    v_mfma_f32_16x16x32_f16 v[104:107], a[84:87], v[148:151], v[104:107]
    v_add_f32 v180, v180, v181
    v_fma_f32 v192, |v121|, v73, v192
    v_mfma_f32_16x16x32_f16 v[104:107], a[88:91], v[152:155], v[104:107]
    v_fma_f32 v180, v222, s12, v180
    v_fma_f32 v192, |v122|, v74, v192
    v_mfma_f32_16x16x32_f16 v[104:107], a[92:95], v[156:159], v[104:107]
    v_fma_f32 v192, |v123|, v75, v192
    v_fma_f32 v192, |v124|, v76, v192
    v_mfma_f32_16x16x32_f16 v[108:111], a[76:79], v[156:159], v[32:35]
    s_waitcnt lgkmcnt(0)
    v_pk_mul_f16 v128, v128, v204
    v_fma_f32 v192, |v125|, v77, v192
    v_mfma_f32_16x16x32_f16 v[108:111], a[72:75], v[152:155], v[108:111]
    v_pk_mul_f16 v129, v129, v205
    v_fma_f32 v192, |v126|, v78, v192
    v_mfma_f32_16x16x32_f16 v[108:111], a[68:71], v[148:151], v[108:111]
    v_pk_mul_f16 v130, v130, v206
    v_fma_f32 v192, |v127|, v79, v192
    v_mfma_f32_16x16x32_f16 v[108:111], a[64:67], v[144:147], v[108:111]
    v_pk_mul_f16 v131, v131, v207
    v_mul_f32 v194, |v96|, v76
    v_mfma_f32_16x16x32_f16 v[112:115], a[48:51], v[144:147], v[28:31]
    v_pk_mul_f16 v132, v132, v208
    v_fma_f32 v194, |v97|, v77, v194
    v_mfma_f32_16x16x32_f16 v[112:115], a[52:55], v[148:151], v[112:115]
    v_pk_mul_f16 v133, v133, v209
    v_fma_f32 v194, |v98|, v78, v194
    v_mfma_f32_16x16x32_f16 v[112:115], a[56:59], v[152:155], v[112:115]
    v_pk_mul_f16 v134, v134, v210
    v_fma_f32 v194, |v99|, v79, v194
    v_mfma_f32_16x16x32_f16 v[112:115], a[60:63], v[156:159], v[112:115]
    v_pk_mul_f16 v135, v135, v211
    v_fma_f32 v194, |v100|, v72, v194
    v_mfma_f32_16x16x32_f16 v[116:119], a[44:47], v[156:159], v[24:27]
    v_pk_mul_f16 v136, v136, v212
    v_fma_f32 v194, |v101|, v73, v194
    v_mfma_f32_16x16x32_f16 v[116:119], a[40:43], v[152:155], v[116:119]
    v_pk_mul_f16 v137, v137, v213
    v_fma_f32 v194, |v102|, v74, v194
    v_mfma_f32_16x16x32_f16 v[116:119], a[36:39], v[148:151], v[116:119]
    v_pk_mul_f16 v138, v138, v214
    v_fma_f32 v194, |v103|, v75, v194
    v_mfma_f32_16x16x32_f16 v[116:119], a[32:35], v[144:147], v[116:119]
    v_pk_mul_f16 v139, v139, v215
    v_fma_f32 v194, |v104|, v68, v194
    v_mfma_f32_16x16x32_f16 v[120:123], a[16:19], v[144:147], v[20:23]
    v_pk_mul_f16 v140, v140, v216
    v_fma_f32 v194, |v105|, v69, v194
    v_mfma_f32_16x16x32_f16 v[120:123], a[20:23], v[148:151], v[120:123]
    v_pk_mul_f16 v141, v141, v217
    v_fma_f32 v194, |v106|, v70, v194
    v_mfma_f32_16x16x32_f16 v[120:123], a[24:27], v[152:155], v[120:123]
    v_pk_mul_f16 v142, v142, v218
    v_fma_f32 v194, |v107|, v71, v194
    v_mfma_f32_16x16x32_f16 v[120:123], a[28:31], v[156:159], v[120:123]
    v_pk_mul_f16 v143, v143, v219
    v_fma_f32 v194, |v108|, v64, v194
    v_mfma_f32_16x16x32_f16 v[124:127], a[12:15], v[156:159], v[16:19]
    ds_read_b128 v[216:219], v243 offset:4800
    v_fma_f32 v194, |v109|, v65, v194
    v_mfma_f32_16x16x32_f16 v[124:127], a[8:11], v[152:155], v[124:127]
    ds_read_b128 v[212:215], v243 offset:4736
    v_fma_f32 v194, |v110|, v66, v194
    v_mfma_f32_16x16x32_f16 v[124:127], a[4:7], v[148:151], v[124:127]
    ds_read_b128 v[208:211], v243 offset:4672
    v_fma_f32 v194, |v111|, v67, v194
    v_mfma_f32_16x16x32_f16 v[124:127], a[0:3], v[144:147], v[124:127]
    ds_read_b128 v[204:207], v243 offset:4608
    v_fma_f32 v194, |v112|, v60, v194
    v_mfma_f32_16x16x32_f16 v[96:99], a[0:3], v[128:131], v[16:19]
    ds_read_b128 v[156:159], v244 offset:4800
    v_fma_f32 v194, |v113|, v61, v194
    v_mfma_f32_16x16x32_f16 v[96:99], a[4:7], v[132:135], v[96:99]
    ds_read_b128 v[152:155], v244 offset:4736
    v_fma_f32 v194, |v114|, v62, v194
    v_mfma_f32_16x16x32_f16 v[96:99], a[8:11], v[136:139], v[96:99]
    ds_read_b128 v[148:151], v244 offset:4672
    v_fma_f32 v194, |v115|, v63, v194
    v_mfma_f32_16x16x32_f16 v[96:99], a[12:15], v[140:143], v[96:99]
    ds_read_b128 v[144:147], v244 offset:4608
    v_fma_f32 v194, |v116|, v56, v194
    v_mfma_f32_16x16x32_f16 v[100:103], a[28:31], v[140:143], v[20:23]
    v_fma_f32 v194, |v117|, v57, v194
    v_fma_f32 v194, |v118|, v58, v194
    v_mfma_f32_16x16x32_f16 v[100:103], a[24:27], v[136:139], v[100:103]
    v_fma_f32 v194, |v119|, v59, v194
    v_fma_f32 v194, |v120|, v52, v194
    v_mfma_f32_16x16x32_f16 v[100:103], a[20:23], v[132:135], v[100:103]
    v_fma_f32 v194, |v121|, v53, v194
    v_fma_f32 v194, |v122|, v54, v194
    v_mfma_f32_16x16x32_f16 v[100:103], a[16:19], v[128:131], v[100:103]
    v_fma_f32 v194, |v123|, v55, v194
    v_fma_f32 v194, |v124|, v48, v194
    v_mfma_f32_16x16x32_f16 v[104:107], a[32:35], v[128:131], v[24:27]
    v_fma_f32 v194, |v125|, v49, v194
    v_fma_f32 v194, |v126|, v50, v194
    v_mfma_f32_16x16x32_f16 v[104:107], a[36:39], v[132:135], v[104:107]
    v_fma_f32 v194, |v127|, v51, v194
    v_mul_f32 v196, |v96|, v48
    v_mfma_f32_16x16x32_f16 v[104:107], a[40:43], v[136:139], v[104:107]
    v_permlane32_swap_b32 v192, v194
    v_mfma_f32_16x16x32_f16 v[104:107], a[44:47], v[140:143], v[104:107]
    v_add_f32 v192, v192, v194
    v_fma_f32 v196, |v97|, v49, v196
    v_mfma_f32_16x16x32_f16 v[108:111], a[60:63], v[140:143], v[28:31]
    s_waitcnt lgkmcnt(0)
    v_pk_mul_f16 v144, v144, v204
    v_fma_f32 v196, |v98|, v50, v196
    v_mfma_f32_16x16x32_f16 v[108:111], a[56:59], v[136:139], v[108:111]
    v_pk_mul_f16 v145, v145, v205
    v_fma_f32 v196, |v99|, v51, v196
    v_mfma_f32_16x16x32_f16 v[108:111], a[52:55], v[132:135], v[108:111]
    v_pk_mul_f16 v146, v146, v206
    v_fma_f32 v196, |v100|, v52, v196
    v_mfma_f32_16x16x32_f16 v[108:111], a[48:51], v[128:131], v[108:111]
    v_pk_mul_f16 v147, v147, v207
    v_fma_f32 v196, |v101|, v53, v196
    v_mfma_f32_16x16x32_f16 v[112:115], a[64:67], v[128:131], v[32:35]
    v_pk_mul_f16 v148, v148, v208
    v_fma_f32 v196, |v102|, v54, v196
    v_mfma_f32_16x16x32_f16 v[112:115], a[68:71], v[132:135], v[112:115]
    v_pk_mul_f16 v149, v149, v209
    v_fma_f32 v196, |v103|, v55, v196
    v_mfma_f32_16x16x32_f16 v[112:115], a[72:75], v[136:139], v[112:115]
    v_pk_mul_f16 v150, v150, v210
    v_fma_f32 v196, |v104|, v56, v196
    v_mfma_f32_16x16x32_f16 v[112:115], a[76:79], v[140:143], v[112:115]
    v_pk_mul_f16 v151, v151, v211
    v_fma_f32 v196, |v105|, v57, v196
    v_mfma_f32_16x16x32_f16 v[116:119], a[92:95], v[140:143], v[36:39]
    v_pk_mul_f16 v152, v152, v212
    v_fma_f32 v196, |v106|, v58, v196
    v_mfma_f32_16x16x32_f16 v[116:119], a[88:91], v[136:139], v[116:119]
    v_pk_mul_f16 v153, v153, v213
    v_fma_f32 v196, |v107|, v59, v196
    v_mfma_f32_16x16x32_f16 v[116:119], a[84:87], v[132:135], v[116:119]
    v_pk_mul_f16 v154, v154, v214
    v_fma_f32 v196, |v108|, v60, v196
    v_mfma_f32_16x16x32_f16 v[116:119], a[80:83], v[128:131], v[116:119]
    v_pk_mul_f16 v155, v155, v215
    v_fma_f32 v196, |v109|, v61, v196
    v_mfma_f32_16x16x32_f16 v[120:123], a[96:99], v[128:131], v[40:43]
    v_pk_mul_f16 v156, v156, v216
    v_fma_f32 v196, |v110|, v62, v196
    v_mfma_f32_16x16x32_f16 v[120:123], a[100:103], v[132:135], v[120:123]
    v_pk_mul_f16 v157, v157, v217
    v_fma_f32 v196, |v111|, v63, v196
    v_mfma_f32_16x16x32_f16 v[120:123], a[104:107], v[136:139], v[120:123]
    v_pk_mul_f16 v158, v158, v218
    v_fma_f32 v196, |v112|, v64, v196
    v_mfma_f32_16x16x32_f16 v[120:123], a[108:111], v[140:143], v[120:123]
    v_pk_mul_f16 v159, v159, v219
    v_fma_f32 v196, |v113|, v65, v196
    v_mfma_f32_16x16x32_f16 v[124:127], a[124:127], v[140:143], v[44:47]
    ds_read_b128 v[216:219], v241 offset:4800
    v_fma_f32 v196, |v114|, v66, v196
    v_mfma_f32_16x16x32_f16 v[124:127], a[120:123], v[136:139], v[124:127]
    ds_read_b128 v[212:215], v241 offset:4736
    v_fma_f32 v196, |v115|, v67, v196
    v_mfma_f32_16x16x32_f16 v[124:127], a[116:119], v[132:135], v[124:127]
    ds_read_b128 v[208:211], v241 offset:4672
    v_fma_f32 v196, |v116|, v68, v196
    v_mfma_f32_16x16x32_f16 v[124:127], a[112:115], v[128:131], v[124:127]
    ds_read_b128 v[204:207], v241 offset:4608
    v_fma_f32 v196, |v117|, v69, v196
    v_mfma_f32_16x16x32_f16 v[96:99], a[112:115], v[144:147], v[44:47]
    ds_read_b128 v[140:143], v242 offset:4800
    v_fma_f32 v196, |v118|, v70, v196
    v_mfma_f32_16x16x32_f16 v[96:99], a[116:119], v[148:151], v[96:99]
    ds_read_b128 v[136:139], v242 offset:4736
    v_fma_f32 v196, |v119|, v71, v196
    v_mfma_f32_16x16x32_f16 v[96:99], a[120:123], v[152:155], v[96:99]
    ds_read_b128 v[132:135], v242 offset:4672
    v_fma_f32 v196, |v120|, v72, v196
    v_mfma_f32_16x16x32_f16 v[96:99], a[124:127], v[156:159], v[96:99]
    ds_read_b128 v[128:131], v242 offset:4608
    v_fma_f32 v196, |v121|, v73, v196
    v_mfma_f32_16x16x32_f16 v[100:103], a[108:111], v[156:159], v[40:43]
    v_mov_b32 v193, v192
    v_fma_f32 v196, |v122|, v74, v196
    v_mfma_f32_16x16x32_f16 v[100:103], a[104:107], v[152:155], v[100:103]
    v_permlane16_swap_b32 v192, v193
    v_mfma_f32_16x16x32_f16 v[100:103], a[100:103], v[148:151], v[100:103]
    v_add_f32 v192, v192, v193
    v_fma_f32 v196, |v123|, v75, v196
    v_mfma_f32_16x16x32_f16 v[100:103], a[96:99], v[144:147], v[100:103]
    v_fma_f32 v192, v228, s12, v192
    v_fma_f32 v196, |v124|, v76, v196
    v_mfma_f32_16x16x32_f16 v[104:107], a[80:83], v[144:147], v[36:39]
    v_cndmask_b32 v192, v251, v192, s[38:39]
    v_fma_f32 v196, |v125|, v77, v196
    v_mfma_f32_16x16x32_f16 v[104:107], a[84:87], v[148:151], v[104:107]
    v_max3_f32 v248, v248, v180, v192
    v_fma_f32 v196, |v126|, v78, v196
    v_mfma_f32_16x16x32_f16 v[104:107], a[88:91], v[152:155], v[104:107]
    v_max_f32_dpp v248, v248, v248 row_ror:8 row_mask:0xf bank_mask:0xf
    v_fma_f32 v196, |v127|, v79, v196
    v_mfma_f32_16x16x32_f16 v[104:107], a[92:95], v[156:159], v[104:107]
    v_max_f32_dpp v248, v248, v248 row_ror:4 row_mask:0xf bank_mask:0xf
    v_mul_f32 v198, |v96|, v76
    v_mfma_f32_16x16x32_f16 v[108:111], a[76:79], v[156:159], v[32:35]
    s_waitcnt lgkmcnt(0)
    v_pk_mul_f16 v128, v128, v204
    v_fma_f32 v198, |v97|, v77, v198
    v_mfma_f32_16x16x32_f16 v[108:111], a[72:75], v[152:155], v[108:111]
    v_pk_mul_f16 v129, v129, v205
    v_fma_f32 v198, |v98|, v78, v198
    v_mfma_f32_16x16x32_f16 v[108:111], a[68:71], v[148:151], v[108:111]
    v_pk_mul_f16 v130, v130, v206
    v_fma_f32 v198, |v99|, v79, v198
    v_mfma_f32_16x16x32_f16 v[108:111], a[64:67], v[144:147], v[108:111]
    v_pk_mul_f16 v131, v131, v207
    v_fma_f32 v198, |v100|, v72, v198
    v_mfma_f32_16x16x32_f16 v[112:115], a[48:51], v[144:147], v[28:31]
    v_pk_mul_f16 v132, v132, v208
    v_fma_f32 v198, |v101|, v73, v198
    v_mfma_f32_16x16x32_f16 v[112:115], a[52:55], v[148:151], v[112:115]
    v_pk_mul_f16 v133, v133, v209
    v_fma_f32 v198, |v102|, v74, v198
    v_mfma_f32_16x16x32_f16 v[112:115], a[56:59], v[152:155], v[112:115]
    v_pk_mul_f16 v134, v134, v210
    v_fma_f32 v198, |v103|, v75, v198
    v_mfma_f32_16x16x32_f16 v[112:115], a[60:63], v[156:159], v[112:115]
    v_pk_mul_f16 v135, v135, v211
    v_fma_f32 v198, |v104|, v68, v198
    v_mfma_f32_16x16x32_f16 v[116:119], a[44:47], v[156:159], v[24:27]
    v_pk_mul_f16 v136, v136, v212
    v_fma_f32 v198, |v105|, v69, v198
    v_mfma_f32_16x16x32_f16 v[116:119], a[40:43], v[152:155], v[116:119]
    v_pk_mul_f16 v137, v137, v213
    v_fma_f32 v198, |v106|, v70, v198
    v_mfma_f32_16x16x32_f16 v[116:119], a[36:39], v[148:151], v[116:119]
    v_pk_mul_f16 v138, v138, v214
    v_fma_f32 v198, |v107|, v71, v198
    v_mfma_f32_16x16x32_f16 v[116:119], a[32:35], v[144:147], v[116:119]
    v_pk_mul_f16 v139, v139, v215
    v_fma_f32 v198, |v108|, v64, v198
    v_mfma_f32_16x16x32_f16 v[120:123], a[16:19], v[144:147], v[20:23]
    v_pk_mul_f16 v140, v140, v216
    v_fma_f32 v198, |v109|, v65, v198
    v_mfma_f32_16x16x32_f16 v[120:123], a[20:23], v[148:151], v[120:123]
    v_pk_mul_f16 v141, v141, v217
    v_fma_f32 v198, |v110|, v66, v198
    v_mfma_f32_16x16x32_f16 v[120:123], a[24:27], v[152:155], v[120:123]
    v_pk_mul_f16 v142, v142, v218
    v_fma_f32 v198, |v111|, v67, v198
    v_mfma_f32_16x16x32_f16 v[120:123], a[28:31], v[156:159], v[120:123]
    v_pk_mul_f16 v143, v143, v219
    v_fma_f32 v198, |v112|, v60, v198
    v_mfma_f32_16x16x32_f16 v[124:127], a[12:15], v[156:159], v[16:19]
    v_max_f32_dpp v248, v248, v248 row_ror:2 row_mask:0xf bank_mask:0xf
    v_fma_f32 v198, |v113|, v61, v198
    v_mfma_f32_16x16x32_f16 v[124:127], a[8:11], v[152:155], v[124:127]
    v_max_f32_dpp v248, v248, v248 row_ror:1 row_mask:0xf bank_mask:0xf
    v_fma_f32 v198, |v114|, v62, v198
    v_mfma_f32_16x16x32_f16 v[124:127], a[4:7], v[148:151], v[124:127]
    v_max_f32_dpp v248, v248, v248 row_bcast:15 row_mask:0xa bank_mask:0xf
    v_fma_f32 v198, |v115|, v63, v198
    v_mfma_f32_16x16x32_f16 v[124:127], a[0:3], v[144:147], v[124:127]
    v_max_f32_dpp v248, v248, v248 row_bcast:31 row_mask:0xc bank_mask:0xf
    v_fma_f32 v198, |v116|, v56, v198
    v_mfma_f32_16x16x32_f16 v[96:99], a[0:3], v[128:131], v[16:19]
    v_readlane_b32 s14, v248, 63
    v_fma_f32 v198, |v117|, v57, v198
    v_mfma_f32_16x16x32_f16 v[96:99], a[4:7], v[132:135], v[96:99]
    v_subrev_f32 v184, s14, v184
    v_fma_f32 v198, |v118|, v58, v198
    v_mfma_f32_16x16x32_f16 v[96:99], a[8:11], v[136:139], v[96:99]
    v_subrev_f32 v188, s14, v188
    v_fma_f32 v198, |v119|, v59, v198
    v_mfma_f32_16x16x32_f16 v[96:99], a[12:15], v[140:143], v[96:99]
    v_subrev_f32 v176, s14, v176
    v_fma_f32 v198, |v120|, v52, v198
    v_mfma_f32_16x16x32_f16 v[100:103], a[28:31], v[140:143], v[20:23]
    v_subrev_f32 v180, s14, v180
    v_fma_f32 v198, |v121|, v53, v198
    v_mfma_f32_16x16x32_f16 v[100:103], a[24:27], v[136:139], v[100:103]
    v_subrev_f32 v192, s14, v192
    v_fma_f32 v198, |v122|, v54, v198
    v_mfma_f32_16x16x32_f16 v[100:103], a[20:23], v[132:135], v[100:103]
    v_mul_f32 v184, s55, v184
    v_fma_f32 v198, |v123|, v55, v198
    v_mfma_f32_16x16x32_f16 v[100:103], a[16:19], v[128:131], v[100:103]
    v_mul_f32 v188, s55, v188
    v_fma_f32 v198, |v124|, v48, v198
    v_mfma_f32_16x16x32_f16 v[104:107], a[32:35], v[128:131], v[24:27]
    v_mul_f32 v176, s55, v176
    v_fma_f32 v198, |v125|, v49, v198
    v_mfma_f32_16x16x32_f16 v[104:107], a[36:39], v[132:135], v[104:107]
    v_mul_f32 v180, s55, v180
    v_fma_f32 v198, |v126|, v50, v198
    v_mfma_f32_16x16x32_f16 v[104:107], a[40:43], v[136:139], v[104:107]
    v_mul_f32 v192, s55, v192
    v_fma_f32 v198, |v127|, v51, v198
    v_mfma_f32_16x16x32_f16 v[104:107], a[44:47], v[140:143], v[104:107]
    v_exp_f32 v184, v184
    v_mfma_f32_16x16x32_f16 v[108:111], a[60:63], v[140:143], v[28:31]
    v_exp_f32 v188, v188
    v_mfma_f32_16x16x32_f16 v[108:111], a[56:59], v[136:139], v[108:111]
    v_exp_f32 v176, v176
    v_mfma_f32_16x16x32_f16 v[108:111], a[52:55], v[132:135], v[108:111]
    v_exp_f32 v180, v180
    v_mfma_f32_16x16x32_f16 v[108:111], a[48:51], v[128:131], v[108:111]
    v_exp_f32 v192, v192
    v_mfma_f32_16x16x32_f16 v[112:115], a[64:67], v[128:131], v[32:35]
    v_add_f32 v249, v184, v188
    v_mul_f32 v197, |v96|, v48
    v_mfma_f32_16x16x32_f16 v[112:115], a[68:71], v[132:135], v[112:115]
    v_mul_f32 v250, v184, v225
    v_mul_f32 v200, |v97|, v49
    v_mfma_f32_16x16x32_f16 v[112:115], a[72:75], v[136:139], v[112:115]
    v_fmac_f32 v250, v188, v227
    v_fma_f32 v197, |v98|, v50, v197
    v_mfma_f32_16x16x32_f16 v[112:115], a[76:79], v[140:143], v[112:115]
    v_add_f32 v249, v249, v176
    v_fma_f32 v200, |v99|, v51, v200
    v_mfma_f32_16x16x32_f16 v[116:119], a[92:95], v[140:143], v[36:39]
    v_fmac_f32 v250, v176, v221
    v_fma_f32 v197, |v100|, v52, v197
    v_mfma_f32_16x16x32_f16 v[116:119], a[88:91], v[136:139], v[116:119]
    v_add_f32 v249, v249, v180
    v_fma_f32 v200, |v101|, v53, v200
    v_mfma_f32_16x16x32_f16 v[116:119], a[84:87], v[132:135], v[116:119]
    v_fmac_f32 v250, v180, v223
    v_fma_f32 v197, |v102|, v54, v197
    v_mfma_f32_16x16x32_f16 v[116:119], a[80:83], v[128:131], v[116:119]
    v_add_f32 v249, v249, v192
    v_fma_f32 v200, |v103|, v55, v200
    v_mfma_f32_16x16x32_f16 v[120:123], a[96:99], v[128:131], v[40:43]
    v_fmac_f32 v250, v192, v229
    s_lshl_b32 s6, s4, 1
    v_fma_f32 v197, |v104|, v56, v197
    v_mfma_f32_16x16x32_f16 v[120:123], a[100:103], v[132:135], v[120:123]
    v_mov_b32 v2, s6
    v_fma_f32 v200, |v105|, v57, v200
    v_mfma_f32_16x16x32_f16 v[120:123], a[104:107], v[136:139], v[120:123]
    v_permlane32_swap_b32 v196, v198
    v_mfma_f32_16x16x32_f16 v[120:123], a[108:111], v[140:143], v[120:123]
    v_add_f32 v196, v196, v198
    v_fma_f32 v197, |v106|, v58, v197
    v_mfma_f32_16x16x32_f16 v[124:127], a[124:127], v[140:143], v[44:47]
    v_fma_f32 v200, |v107|, v59, v200
    v_fma_f32 v197, |v108|, v60, v197
    v_mfma_f32_16x16x32_f16 v[124:127], a[120:123], v[136:139], v[124:127]
    v_fma_f32 v200, |v109|, v61, v200
    v_fma_f32 v197, |v110|, v62, v197
    v_mfma_f32_16x16x32_f16 v[124:127], a[116:119], v[132:135], v[124:127]
    v_fma_f32 v200, |v111|, v63, v200
    v_fma_f32 v197, |v112|, v64, v197
    v_mfma_f32_16x16x32_f16 v[124:127], a[112:115], v[128:131], v[124:127]
    v_fma_f32 v200, |v113|, v65, v200
    v_fma_f32 v197, |v114|, v66, v197
    v_fma_f32 v200, |v115|, v67, v200
    v_fma_f32 v197, |v116|, v68, v197
    v_fma_f32 v200, |v117|, v69, v200
    v_fma_f32 v197, |v118|, v70, v197
    v_fma_f32 v200, |v119|, v71, v200
    v_fma_f32 v197, |v120|, v72, v197
    v_fma_f32 v200, |v121|, v73, v200
    v_fma_f32 v197, |v122|, v74, v197
    v_fma_f32 v200, |v123|, v75, v200
    v_fma_f32 v197, |v124|, v76, v197
    v_fma_f32 v200, |v125|, v77, v200
    v_fma_f32 v197, |v126|, v78, v197
    v_fma_f32 v200, |v127|, v79, v200
    v_add_f32 v197, v197, v200
    s_nop 1
    v_permlane32_swap_b32 v197, v199
    v_add_f32 v197, v197, v199
    s_nop 1
    v_permlane16_swap_b32 v196, v197
    v_fma_f32 v196, v230, s12, v196
    v_add_f32 v196, v196, v197
    v_cndmask_b32 v196, v251, v196, s[40:41]
    v_subrev_f32 v197, s14, v196
    v_mul_f32 v197, s55, v197
    v_cmp_lt_f32 vcc, 4.0, v197
    v_exp_f32 v197, v197
    s_cbranch_vccnz L_tailmax
    v_add_f32 v249, v249, v197
    v_fmac_f32 v250, v197, v231
L_tailsum:
    s_nop 0
    v_add_f32_dpp v249, v249, v249 row_ror:8 row_mask:0xf bank_mask:0xf
    v_add_f32_dpp v250, v250, v250 row_ror:8 row_mask:0xf bank_mask:0xf
    s_nop 0
    v_add_f32_dpp v249, v249, v249 row_ror:4 row_mask:0xf bank_mask:0xf
    v_add_f32_dpp v250, v250, v250 row_ror:4 row_mask:0xf bank_mask:0xf
    s_nop 0
    v_add_f32_dpp v249, v249, v249 row_ror:2 row_mask:0xf bank_mask:0xf
    v_add_f32_dpp v250, v250, v250 row_ror:2 row_mask:0xf bank_mask:0xf
    s_nop 0
    v_add_f32_dpp v249, v249, v249 row_ror:1 row_mask:0xf bank_mask:0xf
    v_add_f32_dpp v250, v250, v250 row_ror:1 row_mask:0xf bank_mask:0xf
    s_nop 0
    v_add_f32_dpp v249, v249, v249 row_bcast:15 row_mask:0xa bank_mask:0xf
    v_add_f32_dpp v250, v250, v250 row_bcast:15 row_mask:0xa bank_mask:0xf
    s_nop 0
    v_add_f32_dpp v249, v249, v249 row_bcast:31 row_mask:0xc bank_mask:0xf
    v_add_f32_dpp v250, v250, v250 row_bcast:31 row_mask:0xc bank_mask:0xf
    v_rcp_f32 v249, v249
    v_ldexp_f32 v250, v250, s11
    s_mov_b32 exec_lo, 0
    s_mov_b32 exec_hi, 0x80000000
    v_mul_f32 v250, v250, v249
    v_cvt_pk_bf16_f32 v250, v250, v250
    global_store_short v2, v250, s[32:33]
L_end:
    s_endpgm
L_wfix:
    s_waitcnt lgkmcnt(0)
    s_nop 7
    s_mov_b32 s8, 0x07060302
    v_mov_b32 v121, 0
    v_and_b32 v122, s44, v48
    v_pk_max_u16 v121, v121, v122
    v_and_b32 v122, s44, v49
    v_pk_max_u16 v121, v121, v122
    v_and_b32 v122, s44, v50
    v_pk_max_u16 v121, v121, v122
    v_and_b32 v122, s44, v51
    v_pk_max_u16 v121, v121, v122
    v_and_b32 v122, s44, v52
    v_pk_max_u16 v121, v121, v122
    v_and_b32 v122, s44, v53
    v_pk_max_u16 v121, v121, v122
    v_and_b32 v122, s44, v54
    v_pk_max_u16 v121, v121, v122
    v_and_b32 v122, s44, v55
    v_pk_max_u16 v121, v121, v122
    v_and_b32 v122, s44, v56
    v_pk_max_u16 v121, v121, v122
    v_and_b32 v122, s44, v57
    v_pk_max_u16 v121, v121, v122
    v_and_b32 v122, s44, v58
    v_pk_max_u16 v121, v121, v122
    v_and_b32 v122, s44, v59
    v_pk_max_u16 v121, v121, v122
    v_and_b32 v122, s44, v60
    v_pk_max_u16 v121, v121, v122
    v_and_b32 v122, s44, v61
    v_pk_max_u16 v121, v121, v122
    v_and_b32 v122, s44, v62
    v_pk_max_u16 v121, v121, v122
    v_and_b32 v122, s44, v63
    v_pk_max_u16 v121, v121, v122
    v_and_b32 v122, s44, v64
    v_pk_max_u16 v121, v121, v122
    v_and_b32 v122, s44, v65
    v_pk_max_u16 v121, v121, v122
    v_and_b32 v122, s44, v66
    v_pk_max_u16 v121, v121, v122
    v_and_b32 v122, s44, v67
    v_pk_max_u16 v121, v121, v122
    v_and_b32 v122, s44, v68
    v_pk_max_u16 v121, v121, v122
    v_and_b32 v122, s44, v69
    v_pk_max_u16 v121, v121, v122
    v_and_b32 v122, s44, v70
    v_pk_max_u16 v121, v121, v122
    v_and_b32 v122, s44, v71
    v_pk_max_u16 v121, v121, v122
    v_and_b32 v122, s44, v72
    v_pk_max_u16 v121, v121, v122
    v_and_b32 v122, s44, v73
    v_pk_max_u16 v121, v121, v122
    v_and_b32 v122, s44, v74
    v_pk_max_u16 v121, v121, v122
    v_and_b32 v122, s44, v75
    v_pk_max_u16 v121, v121, v122
    v_and_b32 v122, s44, v76
    v_pk_max_u16 v121, v121, v122
    v_and_b32 v122, s44, v77
    v_pk_max_u16 v121, v121, v122
    v_and_b32 v122, s44, v78
    v_pk_max_u16 v121, v121, v122
    v_and_b32 v122, s44, v79
    v_pk_max_u16 v121, v121, v122
    s_barrier
    ds_write_b32 v3, v121 offset:39424
    s_waitcnt lgkmcnt(0)
    s_barrier
    ds_read_b128 v[112:115], v127 offset:39424
    s_waitcnt lgkmcnt(0)
    v_pk_max_u16 v121, v121, v112
    v_pk_max_u16 v121, v121, v113
    v_pk_max_u16 v121, v121, v114
    v_pk_max_u16 v121, v121, v115
    s_barrier
    v_pk_max_u16 v121, v121, v121 op_sel:[0,1] op_sel_hi:[1,0]
    s_nop 1
    v_max_u32_dpp v121, v121, v121 row_ror:8 row_mask:0xf bank_mask:0xf
    s_nop 1
    v_max_u32_dpp v121, v121, v121 row_ror:4 row_mask:0xf bank_mask:0xf
    s_nop 1
    v_max_u32_dpp v121, v121, v121 row_ror:2 row_mask:0xf bank_mask:0xf
    s_nop 1
    v_max_u32_dpp v121, v121, v121 row_ror:1 row_mask:0xf bank_mask:0xf
    s_nop 1
    v_max_u32_dpp v121, v121, v121 row_bcast:15 row_mask:0xa bank_mask:0xf
    s_nop 1
    v_max_u32_dpp v121, v121, v121 row_bcast:31 row_mask:0xc bank_mask:0xf
    s_nop 0
    v_readlane_b32 s6, v121, 63
    s_nop 0
    s_bfe_u32 s6, s6, 0x80007
    s_max_u32 s6, s6, 87
    s_sub_u32 s47, 127, s6
    s_sub_u32 s7, 0, s47
    v_lshlrev_b32 v121, 16, v48
    v_and_b32 v122, s46, v48
    v_ldexp_f32 v121, v121, s47
    v_ldexp_f32 v122, v122, s47
    v_perm_b32 v48, v122, v121, s8
    v_lshlrev_b32 v121, 16, v49
    v_and_b32 v122, s46, v49
    v_ldexp_f32 v121, v121, s47
    v_ldexp_f32 v122, v122, s47
    v_perm_b32 v49, v122, v121, s8
    v_lshlrev_b32 v121, 16, v50
    v_and_b32 v122, s46, v50
    v_ldexp_f32 v121, v121, s47
    v_ldexp_f32 v122, v122, s47
    v_perm_b32 v50, v122, v121, s8
    v_lshlrev_b32 v121, 16, v51
    v_and_b32 v122, s46, v51
    v_ldexp_f32 v121, v121, s47
    v_ldexp_f32 v122, v122, s47
    v_perm_b32 v51, v122, v121, s8
    v_lshlrev_b32 v121, 16, v52
    v_and_b32 v122, s46, v52
    v_ldexp_f32 v121, v121, s47
    v_ldexp_f32 v122, v122, s47
    v_perm_b32 v52, v122, v121, s8
    v_lshlrev_b32 v121, 16, v53
    v_and_b32 v122, s46, v53
    v_ldexp_f32 v121, v121, s47
    v_ldexp_f32 v122, v122, s47
    v_perm_b32 v53, v122, v121, s8
    v_lshlrev_b32 v121, 16, v54
    v_and_b32 v122, s46, v54
    v_ldexp_f32 v121, v121, s47
    v_ldexp_f32 v122, v122, s47
    v_perm_b32 v54, v122, v121, s8
    v_lshlrev_b32 v121, 16, v55
    v_and_b32 v122, s46, v55
    v_ldexp_f32 v121, v121, s47
    v_ldexp_f32 v122, v122, s47
    v_perm_b32 v55, v122, v121, s8
    v_lshlrev_b32 v121, 16, v56
    v_and_b32 v122, s46, v56
    v_ldexp_f32 v121, v121, s47
    v_ldexp_f32 v122, v122, s47
    v_perm_b32 v56, v122, v121, s8
    v_lshlrev_b32 v121, 16, v57
    v_and_b32 v122, s46, v57
    v_ldexp_f32 v121, v121, s47
    v_ldexp_f32 v122, v122, s47
    v_perm_b32 v57, v122, v121, s8
    v_lshlrev_b32 v121, 16, v58
    v_and_b32 v122, s46, v58
    v_ldexp_f32 v121, v121, s47
    v_ldexp_f32 v122, v122, s47
    v_perm_b32 v58, v122, v121, s8
    v_lshlrev_b32 v121, 16, v59
    v_and_b32 v122, s46, v59
    v_ldexp_f32 v121, v121, s47
    v_ldexp_f32 v122, v122, s47
    v_perm_b32 v59, v122, v121, s8
    v_lshlrev_b32 v121, 16, v60
    v_and_b32 v122, s46, v60
    v_ldexp_f32 v121, v121, s47
    v_ldexp_f32 v122, v122, s47
    v_perm_b32 v60, v122, v121, s8
    v_lshlrev_b32 v121, 16, v61
    v_and_b32 v122, s46, v61
    v_ldexp_f32 v121, v121, s47
    v_ldexp_f32 v122, v122, s47
    v_perm_b32 v61, v122, v121, s8
    v_lshlrev_b32 v121, 16, v62
    v_and_b32 v122, s46, v62
    v_ldexp_f32 v121, v121, s47
    v_ldexp_f32 v122, v122, s47
    v_perm_b32 v62, v122, v121, s8
    v_lshlrev_b32 v121, 16, v63
    v_and_b32 v122, s46, v63
    v_ldexp_f32 v121, v121, s47
    v_ldexp_f32 v122, v122, s47
    v_perm_b32 v63, v122, v121, s8
    v_lshlrev_b32 v121, 16, v64
    v_and_b32 v122, s46, v64
    v_ldexp_f32 v121, v121, s47
    v_ldexp_f32 v122, v122, s47
    v_perm_b32 v64, v122, v121, s8
    v_lshlrev_b32 v121, 16, v65
    v_and_b32 v122, s46, v65
    v_ldexp_f32 v121, v121, s47
    v_ldexp_f32 v122, v122, s47
    v_perm_b32 v65, v122, v121, s8
    v_lshlrev_b32 v121, 16, v66
    v_and_b32 v122, s46, v66
    v_ldexp_f32 v121, v121, s47
    v_ldexp_f32 v122, v122, s47
    v_perm_b32 v66, v122, v121, s8
    v_lshlrev_b32 v121, 16, v67
    v_and_b32 v122, s46, v67
    v_ldexp_f32 v121, v121, s47
    v_ldexp_f32 v122, v122, s47
    v_perm_b32 v67, v122, v121, s8
    v_lshlrev_b32 v121, 16, v68
    v_and_b32 v122, s46, v68
    v_ldexp_f32 v121, v121, s47
    v_ldexp_f32 v122, v122, s47
    v_perm_b32 v68, v122, v121, s8
    v_lshlrev_b32 v121, 16, v69
    v_and_b32 v122, s46, v69
    v_ldexp_f32 v121, v121, s47
    v_ldexp_f32 v122, v122, s47
    v_perm_b32 v69, v122, v121, s8
    v_lshlrev_b32 v121, 16, v70
    v_and_b32 v122, s46, v70
    v_ldexp_f32 v121, v121, s47
    v_ldexp_f32 v122, v122, s47
    v_perm_b32 v70, v122, v121, s8
    v_lshlrev_b32 v121, 16, v71
    v_and_b32 v122, s46, v71
    v_ldexp_f32 v121, v121, s47
    v_ldexp_f32 v122, v122, s47
    v_perm_b32 v71, v122, v121, s8
    v_lshlrev_b32 v121, 16, v72
    v_and_b32 v122, s46, v72
    v_ldexp_f32 v121, v121, s47
    v_ldexp_f32 v122, v122, s47
    v_perm_b32 v72, v122, v121, s8
    v_lshlrev_b32 v121, 16, v73
    v_and_b32 v122, s46, v73
    v_ldexp_f32 v121, v121, s47
    v_ldexp_f32 v122, v122, s47
    v_perm_b32 v73, v122, v121, s8
    v_lshlrev_b32 v121, 16, v74
    v_and_b32 v122, s46, v74
    v_ldexp_f32 v121, v121, s47
    v_ldexp_f32 v122, v122, s47
    v_perm_b32 v74, v122, v121, s8
    v_lshlrev_b32 v121, 16, v75
    v_and_b32 v122, s46, v75
    v_ldexp_f32 v121, v121, s47
    v_ldexp_f32 v122, v122, s47
    v_perm_b32 v75, v122, v121, s8
    v_lshlrev_b32 v121, 16, v76
    v_and_b32 v122, s46, v76
    v_ldexp_f32 v121, v121, s47
    v_ldexp_f32 v122, v122, s47
    v_perm_b32 v76, v122, v121, s8
    v_lshlrev_b32 v121, 16, v77
    v_and_b32 v122, s46, v77
    v_ldexp_f32 v121, v121, s47
    v_ldexp_f32 v122, v122, s47
    v_perm_b32 v77, v122, v121, s8
    v_lshlrev_b32 v121, 16, v78
    v_and_b32 v122, s46, v78
    v_ldexp_f32 v121, v121, s47
    v_ldexp_f32 v122, v122, s47
    v_perm_b32 v78, v122, v121, s8
    v_lshlrev_b32 v121, 16, v79
    v_and_b32 v122, s46, v79
    v_ldexp_f32 v121, v121, s47
    v_ldexp_f32 v122, v122, s47
    v_perm_b32 v79, v122, v121, s8
    v_lshlrev_b32 v121, 16, v220
    v_and_b32 v122, s46, v220
    v_ldexp_f32 v121, v121, s7
    v_ldexp_f32 v122, v122, s7
    v_perm_b32 v220, v122, v121, s8
    v_lshlrev_b32 v121, 16, v221
    v_and_b32 v122, s46, v221
    v_ldexp_f32 v121, v121, s7
    v_ldexp_f32 v122, v122, s7
    v_perm_b32 v221, v122, v121, s8
    v_lshlrev_b32 v121, 16, v222
    v_and_b32 v122, s46, v222
    v_ldexp_f32 v121, v121, s7
    v_ldexp_f32 v122, v122, s7
    v_perm_b32 v222, v122, v121, s8
    v_lshlrev_b32 v121, 16, v223
    v_and_b32 v122, s46, v223
    v_ldexp_f32 v121, v121, s7
    v_ldexp_f32 v122, v122, s7
    v_perm_b32 v223, v122, v121, s8
    s_add_u32 s6, s47, 10
    v_cmp_lt_u32 vcc, 31, v1
    v_mov_b32 v121, s6
    v_mov_b32 v122, s7
    v_cndmask_b32 v9, v121, v122, vcc
    s_mov_b32 s52, 0
    s_mov_b32 s53, 0
    s_nop 7
    s_branch L_wconv
L_efix:
    s_waitcnt vmcnt(0) lgkmcnt(0)
    s_nop 15
    s_mul_i32 s6, s4, 104
    v_mul_u32_u24 v121, 28, v4
    v_min_u32 v122, 76, v121
    v_add_u32 v121, s6, v121
    v_add_u32 v122, s6, v122
    global_load_dwordx4 v[204:207], v121, s[16:17]
    global_load_dwordx3 v[208:210], v122, s[16:17] offset:16
    s_waitcnt vmcnt(1)
    v_lshl_add_u32 v204, v204, 8, v14
    v_lshl_add_u32 v205, v205, 8, v14
    v_lshl_add_u32 v206, v206, 8, v14
    v_lshl_add_u32 v207, v207, 8, v14
    s_waitcnt vmcnt(0)
    v_lshl_add_u32 v208, v208, 8, v14
    v_lshl_add_u32 v209, v209, 8, v14
    v_lshl_add_u32 v210, v210, 8, v14
    buffer_load_dwordx4 v[144:147], v204, s[56:59], 0 offen
    buffer_load_dwordx4 v[148:151], v205, s[56:59], 0 offen
    buffer_load_dwordx4 v[152:155], v206, s[56:59], 0 offen
    buffer_load_dwordx4 v[156:159], v207, s[56:59], 0 offen
    buffer_load_dwordx4 v[160:163], v208, s[56:59], 0 offen
    buffer_load_dwordx4 v[164:167], v209, s[56:59], 0 offen
    buffer_load_dwordx4 v[168:171], v210, s[56:59], 0 offen
    s_waitcnt vmcnt(0)
    s_mov_b32 s8, 0x07060302
    v_mov_b32 v121, 0
    v_and_b32 v122, s44, v144
    v_pk_max_u16 v121, v121, v122
    v_and_b32 v122, s44, v145
    v_pk_max_u16 v121, v121, v122
    v_and_b32 v122, s44, v146
    v_pk_max_u16 v121, v121, v122
    v_and_b32 v122, s44, v147
    v_pk_max_u16 v121, v121, v122
    v_and_b32 v122, s44, v148
    v_pk_max_u16 v121, v121, v122
    v_and_b32 v122, s44, v149
    v_pk_max_u16 v121, v121, v122
    v_and_b32 v122, s44, v150
    v_pk_max_u16 v121, v121, v122
    v_and_b32 v122, s44, v151
    v_pk_max_u16 v121, v121, v122
    v_and_b32 v122, s44, v152
    v_pk_max_u16 v121, v121, v122
    v_and_b32 v122, s44, v153
    v_pk_max_u16 v121, v121, v122
    v_and_b32 v122, s44, v154
    v_pk_max_u16 v121, v121, v122
    v_and_b32 v122, s44, v155
    v_pk_max_u16 v121, v121, v122
    v_and_b32 v122, s44, v156
    v_pk_max_u16 v121, v121, v122
    v_and_b32 v122, s44, v157
    v_pk_max_u16 v121, v121, v122
    v_and_b32 v122, s44, v158
    v_pk_max_u16 v121, v121, v122
    v_and_b32 v122, s44, v159
    v_pk_max_u16 v121, v121, v122
    v_and_b32 v122, s44, v160
    v_pk_max_u16 v121, v121, v122
    v_and_b32 v122, s44, v161
    v_pk_max_u16 v121, v121, v122
    v_and_b32 v122, s44, v162
    v_pk_max_u16 v121, v121, v122
    v_and_b32 v122, s44, v163
    v_pk_max_u16 v121, v121, v122
    v_and_b32 v122, s44, v164
    v_pk_max_u16 v121, v121, v122
    v_and_b32 v122, s44, v165
    v_pk_max_u16 v121, v121, v122
    v_and_b32 v122, s44, v166
    v_pk_max_u16 v121, v121, v122
    v_and_b32 v122, s44, v167
    v_pk_max_u16 v121, v121, v122
    v_and_b32 v122, s44, v168
    v_pk_max_u16 v121, v121, v122
    v_and_b32 v122, s44, v169
    v_pk_max_u16 v121, v121, v122
    v_and_b32 v122, s44, v170
    v_pk_max_u16 v121, v121, v122
    v_and_b32 v122, s44, v171
    v_pk_max_u16 v121, v121, v122
    v_pk_max_u16 v121, v121, v121 op_sel:[0,1] op_sel_hi:[1,0]
    s_nop 1
    v_max_u32_dpp v121, v121, v121 row_ror:8 row_mask:0xf bank_mask:0xf
    s_nop 1
    v_max_u32_dpp v121, v121, v121 row_ror:4 row_mask:0xf bank_mask:0xf
    s_nop 1
    v_max_u32_dpp v121, v121, v121 row_ror:2 row_mask:0xf bank_mask:0xf
    s_nop 1
    v_max_u32_dpp v121, v121, v121 row_ror:1 row_mask:0xf bank_mask:0xf
    s_nop 1
    v_max_u32_dpp v121, v121, v121 row_bcast:15 row_mask:0xa bank_mask:0xf
    s_nop 1
    v_max_u32_dpp v121, v121, v121 row_bcast:31 row_mask:0xc bank_mask:0xf
    s_nop 0
    v_readlane_b32 s6, v121, 63
    s_nop 0
    s_bfe_u32 s6, s6, 0x80007
    s_max_u32 s6, s6, 104
    s_min_u32 s6, s6, 190
    s_sub_u32 s6, 129, s6
    v_lshlrev_b32 v121, 16, v144
    v_and_b32 v122, s46, v144
    v_ldexp_f32 v121, v121, s6
    v_ldexp_f32 v122, v122, s6
    v_perm_b32 v144, v122, v121, s8
    v_lshlrev_b32 v121, 16, v145
    v_and_b32 v122, s46, v145
    v_ldexp_f32 v121, v121, s6
    v_ldexp_f32 v122, v122, s6
    v_perm_b32 v145, v122, v121, s8
    v_lshlrev_b32 v121, 16, v146
    v_and_b32 v122, s46, v146
    v_ldexp_f32 v121, v121, s6
    v_ldexp_f32 v122, v122, s6
    v_perm_b32 v146, v122, v121, s8
    v_lshlrev_b32 v121, 16, v147
    v_and_b32 v122, s46, v147
    v_ldexp_f32 v121, v121, s6
    v_ldexp_f32 v122, v122, s6
    v_perm_b32 v147, v122, v121, s8
    v_lshlrev_b32 v121, 16, v148
    v_and_b32 v122, s46, v148
    v_ldexp_f32 v121, v121, s6
    v_ldexp_f32 v122, v122, s6
    v_perm_b32 v148, v122, v121, s8
    v_lshlrev_b32 v121, 16, v149
    v_and_b32 v122, s46, v149
    v_ldexp_f32 v121, v121, s6
    v_ldexp_f32 v122, v122, s6
    v_perm_b32 v149, v122, v121, s8
    v_lshlrev_b32 v121, 16, v150
    v_and_b32 v122, s46, v150
    v_ldexp_f32 v121, v121, s6
    v_ldexp_f32 v122, v122, s6
    v_perm_b32 v150, v122, v121, s8
    v_lshlrev_b32 v121, 16, v151
    v_and_b32 v122, s46, v151
    v_ldexp_f32 v121, v121, s6
    v_ldexp_f32 v122, v122, s6
    v_perm_b32 v151, v122, v121, s8
    v_lshlrev_b32 v121, 16, v152
    v_and_b32 v122, s46, v152
    v_ldexp_f32 v121, v121, s6
    v_ldexp_f32 v122, v122, s6
    v_perm_b32 v152, v122, v121, s8
    v_lshlrev_b32 v121, 16, v153
    v_and_b32 v122, s46, v153
    v_ldexp_f32 v121, v121, s6
    v_ldexp_f32 v122, v122, s6
    v_perm_b32 v153, v122, v121, s8
    v_lshlrev_b32 v121, 16, v154
    v_and_b32 v122, s46, v154
    v_ldexp_f32 v121, v121, s6
    v_ldexp_f32 v122, v122, s6
    v_perm_b32 v154, v122, v121, s8
    v_lshlrev_b32 v121, 16, v155
    v_and_b32 v122, s46, v155
    v_ldexp_f32 v121, v121, s6
    v_ldexp_f32 v122, v122, s6
    v_perm_b32 v155, v122, v121, s8
    v_lshlrev_b32 v121, 16, v156
    v_and_b32 v122, s46, v156
    v_ldexp_f32 v121, v121, s6
    v_ldexp_f32 v122, v122, s6
    v_perm_b32 v156, v122, v121, s8
    v_lshlrev_b32 v121, 16, v157
    v_and_b32 v122, s46, v157
    v_ldexp_f32 v121, v121, s6
    v_ldexp_f32 v122, v122, s6
    v_perm_b32 v157, v122, v121, s8
    v_lshlrev_b32 v121, 16, v158
    v_and_b32 v122, s46, v158
    v_ldexp_f32 v121, v121, s6
    v_ldexp_f32 v122, v122, s6
    v_perm_b32 v158, v122, v121, s8
    v_lshlrev_b32 v121, 16, v159
    v_and_b32 v122, s46, v159
    v_ldexp_f32 v121, v121, s6
    v_ldexp_f32 v122, v122, s6
    v_perm_b32 v159, v122, v121, s8
    v_lshlrev_b32 v121, 16, v160
    v_and_b32 v122, s46, v160
    v_ldexp_f32 v121, v121, s6
    v_ldexp_f32 v122, v122, s6
    v_perm_b32 v160, v122, v121, s8
    v_lshlrev_b32 v121, 16, v161
    v_and_b32 v122, s46, v161
    v_ldexp_f32 v121, v121, s6
    v_ldexp_f32 v122, v122, s6
    v_perm_b32 v161, v122, v121, s8
    v_lshlrev_b32 v121, 16, v162
    v_and_b32 v122, s46, v162
    v_ldexp_f32 v121, v121, s6
    v_ldexp_f32 v122, v122, s6
    v_perm_b32 v162, v122, v121, s8
    v_lshlrev_b32 v121, 16, v163
    v_and_b32 v122, s46, v163
    v_ldexp_f32 v121, v121, s6
    v_ldexp_f32 v122, v122, s6
    v_perm_b32 v163, v122, v121, s8
    v_lshlrev_b32 v121, 16, v164
    v_and_b32 v122, s46, v164
    v_ldexp_f32 v121, v121, s6
    v_ldexp_f32 v122, v122, s6
    v_perm_b32 v164, v122, v121, s8
    v_lshlrev_b32 v121, 16, v165
    v_and_b32 v122, s46, v165
    v_ldexp_f32 v121, v121, s6
    v_ldexp_f32 v122, v122, s6
    v_perm_b32 v165, v122, v121, s8
    v_lshlrev_b32 v121, 16, v166
    v_and_b32 v122, s46, v166
    v_ldexp_f32 v121, v121, s6
    v_ldexp_f32 v122, v122, s6
    v_perm_b32 v166, v122, v121, s8
    v_lshlrev_b32 v121, 16, v167
    v_and_b32 v122, s46, v167
    v_ldexp_f32 v121, v121, s6
    v_ldexp_f32 v122, v122, s6
    v_perm_b32 v167, v122, v121, s8
    v_lshlrev_b32 v121, 16, v168
    v_and_b32 v122, s46, v168
    v_ldexp_f32 v121, v121, s6
    v_ldexp_f32 v122, v122, s6
    v_perm_b32 v168, v122, v121, s8
    v_lshlrev_b32 v121, 16, v169
    v_and_b32 v122, s46, v169
    v_ldexp_f32 v121, v121, s6
    v_ldexp_f32 v122, v122, s6
    v_perm_b32 v169, v122, v121, s8
    v_lshlrev_b32 v121, 16, v170
    v_and_b32 v122, s46, v170
    v_ldexp_f32 v121, v121, s6
    v_ldexp_f32 v122, v122, s6
    v_perm_b32 v170, v122, v121, s8
    v_lshlrev_b32 v121, 16, v171
    v_and_b32 v122, s46, v171
    v_ldexp_f32 v121, v121, s6
    v_ldexp_f32 v122, v122, s6
    v_perm_b32 v171, v122, v121, s8
    s_lshl_b32 s6, s6, 1
    v_ldexp_f32 v16, v16, s6
    v_ldexp_f32 v17, v17, s6
    v_ldexp_f32 v18, v18, s6
    v_ldexp_f32 v19, v19, s6
    v_ldexp_f32 v20, v20, s6
    v_ldexp_f32 v21, v21, s6
    v_ldexp_f32 v22, v22, s6
    v_ldexp_f32 v23, v23, s6
    v_ldexp_f32 v24, v24, s6
    v_ldexp_f32 v25, v25, s6
    v_ldexp_f32 v26, v26, s6
    v_ldexp_f32 v27, v27, s6
    v_ldexp_f32 v28, v28, s6
    v_ldexp_f32 v29, v29, s6
    v_ldexp_f32 v30, v30, s6
    v_ldexp_f32 v31, v31, s6
    v_ldexp_f32 v32, v32, s6
    v_ldexp_f32 v33, v33, s6
    v_ldexp_f32 v34, v34, s6
    v_ldexp_f32 v35, v35, s6
    v_ldexp_f32 v36, v36, s6
    v_ldexp_f32 v37, v37, s6
    v_ldexp_f32 v38, v38, s6
    v_ldexp_f32 v39, v39, s6
    v_ldexp_f32 v40, v40, s6
    v_ldexp_f32 v41, v41, s6
    v_ldexp_f32 v42, v42, s6
    v_ldexp_f32 v43, v43, s6
    v_ldexp_f32 v44, v44, s6
    v_ldexp_f32 v45, v45, s6
    v_ldexp_f32 v46, v46, s6
    v_ldexp_f32 v47, v47, s6
    s_add_u32 s7, s5, -28096
    v_add_u32 v0, s7, v15
    ds_write_b128 v0, v[16:19] offset:37888
    ds_write_b128 v0, v[20:23] offset:37952
    ds_write_b128 v0, v[24:27] offset:38016
    ds_write_b128 v0, v[28:31] offset:38080
    ds_write_b128 v0, v[32:35] offset:38144
    ds_write_b128 v0, v[36:39] offset:38208
    ds_write_b128 v0, v[40:43] offset:38272
    ds_write_b128 v0, v[44:47] offset:38336
    s_waitcnt lgkmcnt(0)
    s_add_u32 s54, s54, s6
    s_lshl_b32 s6, s6, 23
    s_sub_u32 s55, s55, s6
    s_mov_b32 s50, 0x7fc00000
    s_mov_b32 s51, 0
    s_mov_b32 s52, 0
    s_mov_b32 s53, 0
    s_nop 7
    s_branch L_econv
L_tailmax:
    s_nop 3
    v_mov_b32 v176, s14
    v_max_f32 v248, s14, v196
    s_nop 1
    v_max_f32_dpp v248, v248, v248 row_ror:8 row_mask:0xf bank_mask:0xf
    s_nop 1
    v_max_f32_dpp v248, v248, v248 row_ror:4 row_mask:0xf bank_mask:0xf
    s_nop 1
    v_max_f32_dpp v248, v248, v248 row_ror:2 row_mask:0xf bank_mask:0xf
    s_nop 1
    v_max_f32_dpp v248, v248, v248 row_ror:1 row_mask:0xf bank_mask:0xf
    s_nop 1
    v_max_f32_dpp v248, v248, v248 row_bcast:15 row_mask:0xa bank_mask:0xf
    s_nop 1
    v_max_f32_dpp v248, v248, v248 row_bcast:31 row_mask:0xc bank_mask:0xf
    s_nop 0
    v_readlane_b32 s13, v248, 63
    s_nop 1
    v_subrev_f32 v196, s13, v196
    v_subrev_f32 v176, s13, v176
    v_mul_f32 v196, s55, v196
    v_mul_f32 v176, s55, v176
    v_exp_f32 v196, v196
    v_exp_f32 v176, v176
    v_mul_f32 v199, v196, v231
    v_fma_f32 v249, v249, v176, v196
    v_fma_f32 v250, v250, v176, v199
    s_nop 3
    s_branch L_tailsum
s_endpgm
.p2align 7
.type L_tab,@object
L_tab:
.long 0x98000000, 0xa0000, 0x0, 0x0
.long 0x98020010, 0xa0004, 0x8, 0x1200010
.long 0x98040020, 0xa0008, 0x10, 0x2400020
.long 0x98060030, 0xa000c, 0x18, 0x3600030
.long 0x98080040, 0xa0010, 0x120, 0x4800040
.long 0x980a0050, 0xa0014, 0x128, 0x5a00050
.long 0x980c0060, 0xa0018, 0x130, 0x6c00060
.long 0x980e0070, 0xa001c, 0x138, 0x7e00070
.long 0x98100080, 0xa0020, 0x240, 0x9000080
.long 0x98120090, 0xa0024, 0x248, 0xa200090
.long 0x981400a0, 0xa0028, 0x250, 0xb4000a0
.long 0x981600b0, 0xa002c, 0x258, 0xc6000b0
.long 0x981800c0, 0xa0030, 0x360, 0xd8000c0
.long 0x981a00d0, 0xa0034, 0x368, 0xea000d0
.long 0x981c00e0, 0xa0038, 0x370, 0xfc000e0
.long 0x981e00f0, 0xa003c, 0x378, 0x10e000f0
.long 0x98200120, 0xa0040, 0x100980, 0x100120
.long 0x98220130, 0xa0044, 0x100988, 0x1300130
.long 0x98240140, 0xa0048, 0x100990, 0x2500140
.long 0x98260150, 0xa004c, 0x100998, 0x3700150
.long 0x98280160, 0xa0050, 0x100aa0, 0x4900160
.long 0x982a0170, 0xa0054, 0x100aa8, 0x5b00170
.long 0x982c0180, 0xa0058, 0x100ab0, 0x6d00180
.long 0x982e0190, 0xa005c, 0x100ab8, 0x7f00190
.long 0x983001a0, 0xa0060, 0x100bc0, 0x91001a0
.long 0x983201b0, 0xa0064, 0x100bc8, 0xa3001b0
.long 0x983401c0, 0xa0068, 0x100bd0, 0xb5001c0
.long 0x983601d0, 0xa006c, 0x100bd8, 0xc7001d0
.long 0x983801e0, 0xa0070, 0x100ce0, 0xd9001e0
.long 0x983a01f0, 0xa0074, 0x100ce8, 0xeb001f0
.long 0x983c0200, 0xa0078, 0x100cf0, 0xfd00200
.long 0x983e0210, 0xa007c, 0x100cf8, 0x10f00210
.long 0x98400240, 0x200, 0x201280, 0x200240
.long 0x98420250, 0x204, 0x201288, 0x1400250
.long 0x98440260, 0x208, 0x201290, 0x2600260
.long 0x98460270, 0x20c, 0x201298, 0x3800270
.long 0x98480280, 0x210, 0x2013a0, 0x4a00280
.long 0x984a0290, 0x214, 0x2013a8, 0x5c00290
.long 0x984c02a0, 0x218, 0x2013b0, 0x6e002a0
.long 0x984e02b0, 0x21c, 0x2013b8, 0x80002b0
.long 0x985002c0, 0x220, 0x2014c0, 0x92002c0
.long 0x985202d0, 0x224, 0x2014c8, 0xa4002d0
.long 0x985402e0, 0x228, 0x2014d0, 0xb6002e0
.long 0x985602f0, 0x22c, 0x2014d8, 0xc8002f0
.long 0x98580300, 0x230, 0x2015e0, 0xda00300
.long 0x985a0310, 0x234, 0x2015e8, 0xec00310
.long 0x985c0320, 0x238, 0x2015f0, 0xfe00320
.long 0x985e0330, 0x23c, 0x2015f8, 0x11000330
.long 0x98600360, 0x240, 0x301c00, 0x300360
.long 0x98620370, 0x244, 0x301c08, 0x1500370
.long 0x98640380, 0x248, 0x301c10, 0x2700380
.long 0x98660390, 0x24c, 0x301c18, 0x3900390
.long 0x986803a0, 0x250, 0x301d20, 0x4b003a0
.long 0x986a03b0, 0x254, 0x301d28, 0x5d003b0
.long 0x986c03c0, 0x258, 0x301d30, 0x6f003c0
.long 0x986e03d0, 0x25c, 0x301d38, 0x81003d0
.long 0x987003e0, 0x260, 0x301e40, 0x93003e0
.long 0x987203f0, 0x264, 0x301e48, 0xa5003f0
.long 0x98740400, 0x268, 0x301e50, 0xb700400
.long 0x98760410, 0x26c, 0x301e58, 0xc900410
.long 0x98780420, 0x270, 0x301f60, 0xdb00420
.long 0x987a0430, 0x274, 0x301f68, 0xed00430
.long 0x987c0440, 0x278, 0x301f70, 0xff00440
.long 0x987e0450, 0x27c, 0x301f78, 0x11100450
.long 0x120, 0x98000000, 0x0, 0x0
.long 0x240, 0x98400120, 0x0, 0x0
.long 0x360, 0x98800240, 0x0, 0x0
.long 0x480, 0x98c00360, 0x0, 0x0
.long 0x5a0, 0x99000480, 0x0, 0x0
.long 0x6c0, 0x994005a0, 0x0, 0x0
.long 0x7e0, 0x998006c0, 0x0, 0x0
.long 0x900, 0x99c007e0, 0x0, 0x0
.long 0xa20, 0x98100900, 0x0, 0x0
.long 0xb40, 0x98500a20, 0x0, 0x0
.long 0xc60, 0x98900a20, 0x0, 0x0
.long 0xd80, 0x98d00a20, 0x0, 0x0
.long 0xea0, 0x99100a20, 0x0, 0x0
.long 0xfc0, 0x99500a20, 0x0, 0x0
.long 0x10e0, 0x99900a20, 0x0, 0x0
.long 0x0, 0x99d00a20, 0x0, 0x0
.long 0x100130, 0x98080010, 0x0, 0x0
.long 0x100250, 0x98480130, 0x0, 0x0
.long 0x100370, 0x98880250, 0x0, 0x0
.long 0x100490, 0x98c80370, 0x0, 0x0
.long 0x1005b0, 0x99080490, 0x0, 0x0
.long 0x1006d0, 0x994805b0, 0x0, 0x0
.long 0x1007f0, 0x998806d0, 0x0, 0x0
.long 0x100910, 0x99c807f0, 0x0, 0x0
.long 0x100a30, 0x98180910, 0x0, 0x0
.long 0x100b50, 0x98580a30, 0x0, 0x0
.long 0x100c70, 0x98980a30, 0x0, 0x0
.long 0x100d90, 0x98d80a30, 0x0, 0x0
.long 0x100eb0, 0x99180a30, 0x0, 0x0
.long 0x100fd0, 0x99580a30, 0x0, 0x0
.long 0x1010f0, 0x99980a30, 0x0, 0x0
.long 0x100010, 0x99d80a30, 0x0, 0x0
.long 0x200140, 0x98040020, 0x0, 0x0
.long 0x200260, 0x98440140, 0x0, 0x0
.long 0x200380, 0x98840260, 0x0, 0x0
.long 0x2004a0, 0x98c40380, 0x0, 0x0
.long 0x2005c0, 0x990404a0, 0x0, 0x0
.long 0x2006e0, 0x994405c0, 0x0, 0x0
.long 0x200800, 0x998406e0, 0x0, 0x0
.long 0x200920, 0x99c40800, 0x0, 0x0
.long 0x200a40, 0x98140920, 0x0, 0x0
.long 0x200b60, 0x98540a40, 0x0, 0x0
.long 0x200c80, 0x98940a40, 0x0, 0x0
.long 0x200da0, 0x98d40a40, 0x0, 0x0
.long 0x200ec0, 0x99140a40, 0x0, 0x0
.long 0x200fe0, 0x99540a40, 0x0, 0x0
.long 0x201100, 0x99940a40, 0x0, 0x0
.long 0x200020, 0x99d40a40, 0x0, 0x0
.long 0x300150, 0x980c0030, 0x0, 0x0
.long 0x300270, 0x984c0150, 0x0, 0x0
.long 0x300390, 0x988c0270, 0x0, 0x0
.long 0x3004b0, 0x98cc0390, 0x0, 0x0
.long 0x3005d0, 0x990c04b0, 0x0, 0x0
.long 0x3006f0, 0x994c05d0, 0x0, 0x0
.long 0x300810, 0x998c06f0, 0x0, 0x0
.long 0x300930, 0x99cc0810, 0x0, 0x0
.long 0x300a50, 0x981c0930, 0x0, 0x0
.long 0x300b70, 0x985c0a50, 0x0, 0x0
.long 0x300c90, 0x989c0a50, 0x0, 0x0
.long 0x300db0, 0x98dc0a50, 0x0, 0x0
.long 0x300ed0, 0x991c0a50, 0x0, 0x0
.long 0x300ff0, 0x995c0a50, 0x0, 0x0
.long 0x301110, 0x999c0a50, 0x0, 0x0
.long 0x300030, 0x99dc0a50, 0x0, 0x0
.long 0x2f40, 0x1203180, 0x6c026d0, 0x9002910
.long 0x1202f44, 0x2403184, 0x7e02764, 0xa2029a4
.long 0x2402f48, 0x3603188, 0x90027f8, 0x2a38
.long 0x3602f4c, 0x480318c, 0xa20288c, 0x1202acc
.long 0x4802f50, 0x5a03190, 0x2920, 0x3602b60
.long 0x5a02f54, 0x6c03194, 0x12029b4, 0x4802bf4
.long 0x6c02f58, 0x7e03198, 0x2402a48, 0x5a02c88
.long 0x7e02f5c, 0x900319c, 0x3602adc, 0x6c02d1c
.long 0x9002f60, 0xa2031a0, 0x4802b70, 0x7e02db0
.long 0xa202f64, 0x31a4, 0x5a02c04, 0x9002e44
.long 0x2f68, 0x24031a8, 0x6c02c98, 0xa202ed8
.long 0x1202f6c, 0x36031ac, 0x7e02d2c, 0x266c
.long 0x2402f70, 0x48031b0, 0x9002dc0, 0x1202700
.long 0x3602f74, 0x5a031b4, 0xa202e54, 0x2402794
.long 0x4802f78, 0x6c031b8, 0x2ee8, 0x4802828
.long 0x5a02f7c, 0x7e031bc, 0x120267c, 0x5a028bc
.long 0x102fd0, 0x1303210, 0x6d02760, 0x91029a0
.long 0x1302fd4, 0x2503214, 0x7f027f4, 0xa302a34
.long 0x2502fd8, 0x3703218, 0x9102888, 0x102ac8
.long 0x3702fdc, 0x490321c, 0xa30291c, 0x1302b5c
.long 0x4902fe0, 0x5b03220, 0x1029b0, 0x3702bf0
.long 0x5b02fe4, 0x6d03224, 0x1302a44, 0x4902c84
.long 0x6d02fe8, 0x7f03228, 0x2502ad8, 0x5b02d18
.long 0x7f02fec, 0x910322c, 0x3702b6c, 0x6d02dac
.long 0x9102ff0, 0xa303230, 0x4902c00, 0x7f02e40
.long 0xa302ff4, 0x103234, 0x5b02c94, 0x9102ed4
.long 0x102ff8, 0x2503238, 0x6d02d28, 0xa302668
.long 0x1302ffc, 0x370323c, 0x7f02dbc, 0x1026fc
.long 0x2503000, 0x4903240, 0x9102e50, 0x1302790
.long 0x3703004, 0x5b03244, 0xa302ee4, 0x2502824
.long 0x4903008, 0x6d03248, 0x102678, 0x49028b8
.long 0x5b0300c, 0x7f0324c, 0x130270c, 0x5b0294c
.long 0x203060, 0x14032a0, 0x6e027f0, 0x9202a30
.long 0x1403064, 0x26032a4, 0x8002884, 0xa402ac4
.long 0x2603068, 0x38032a8, 0x9202918, 0x202b58
.long 0x380306c, 0x4a032ac, 0xa4029ac, 0x1402bec
.long 0x4a03070, 0x5c032b0, 0x202a40, 0x3802c80
.long 0x5c03074, 0x6e032b4, 0x1402ad4, 0x4a02d14
.long 0x6e03078, 0x80032b8, 0x2602b68, 0x5c02da8
.long 0x800307c, 0x92032bc, 0x3802bfc, 0x6e02e3c
.long 0x9203080, 0xa4032c0, 0x4a02c90, 0x8002ed0
.long 0xa403084, 0x2032c4, 0x5c02d24, 0x9202664
.long 0x203088, 0x26032c8, 0x6e02db8, 0xa4026f8
.long 0x140308c, 0x38032cc, 0x8002e4c, 0x20278c
.long 0x2603090, 0x4a032d0, 0x9202ee0, 0x1402820
.long 0x3803094, 0x5c032d4, 0xa402674, 0x26028b4
.long 0x4a03098, 0x6e032d8, 0x202708, 0x4a02948
.long 0x5c0309c, 0x80032dc, 0x140279c, 0x5c029dc
.long 0x3030f0, 0x1503330, 0x6f02880, 0x9302ac0
.long 0x15030f4, 0x2703334, 0x8102914, 0xa502b54
.long 0x27030f8, 0x3903338, 0x93029a8, 0x302be8
.long 0x39030fc, 0x4b0333c, 0xa502a3c, 0x1502c7c
.long 0x4b03100, 0x5d03340, 0x302ad0, 0x3902d10
.long 0x5d03104, 0x6f03344, 0x1502b64, 0x4b02da4
.long 0x6f03108, 0x8103348, 0x2702bf8, 0x5d02e38
.long 0x810310c, 0x930334c, 0x3902c8c, 0x6f02ecc
.long 0x9303110, 0xa503350, 0x4b02d20, 0x8102660
.long 0xa503114, 0x303354, 0x5d02db4, 0x93026f4
.long 0x303118, 0x2703358, 0x6f02e48, 0xa502788
.long 0x150311c, 0x390335c, 0x8102edc, 0x30281c
.long 0x2703120, 0x4b03360, 0x9302670, 0x15028b0
.long 0x3903124, 0x5d03364, 0xa502704, 0x2702944
.long 0x4b03128, 0x6f03368, 0x302798, 0x4b029d8
.long 0x5d0312c, 0x810336c, 0x150282c, 0x5d02a6c
.long 0x24033c0, 0x6c03010, 0x2640, 0x0
.long 0x36033c4, 0x7e030a4, 0x426d0, 0x0
.long 0x48033c8, 0x9003138, 0x82760, 0x0
.long 0x5a033cc, 0xa2031cc, 0xc27f0, 0x0
.long 0x6c033d0, 0x3260, 0x102880, 0x0
.long 0x7e033d4, 0x12032f4, 0x142910, 0x0
.long 0x90033d8, 0x2403388, 0x1829a0, 0x0
.long 0xa2033dc, 0x360341c, 0x1c2a30, 0x0
.long 0x33e0, 0x5a034b0, 0x202ac0, 0x0
.long 0x12033e4, 0x6c02fa4, 0x242b50, 0x0
.long 0x24033e8, 0x7e030a0, 0x282be0, 0x0
.long 0x36033ec, 0x9003134, 0x2c2c70, 0x0
.long 0x48033f0, 0xa2031c8, 0x302d00, 0x0
.long 0x5a033f4, 0x325c, 0x342d90, 0x0
.long 0x6c033f8, 0x12032f0, 0x382e20, 0x0
.long 0x7e033fc, 0x2403384, 0x3c2eb0, 0x0
.long 0x25033c0, 0x6d03418, 0x402650, 0x0
.long 0x37033c4, 0x7f034ac, 0x4426e0, 0x0
.long 0x49033c8, 0x9102fa0, 0x482770, 0x0
.long 0x5b033cc, 0xa303034, 0x4c2800, 0x0
.long 0x6d033d0, 0x103130, 0x502890, 0x0
.long 0x7f033d4, 0x13031c4, 0x542920, 0x0
.long 0x91033d8, 0x2503258, 0x5829b0, 0x0
.long 0xa3033dc, 0x37032ec, 0x5c2a40, 0x0
.long 0x1033e0, 0x5b03380, 0x602ad0, 0x0
.long 0x13033e4, 0x6d03414, 0x642b60, 0x0
.long 0x25033e8, 0x7f034a8, 0x682bf0, 0x0
.long 0x37033ec, 0x9102f9c, 0x6c2c80, 0x0
.long 0x49033f0, 0xa303030, 0x702d10, 0x0
.long 0x5b033f4, 0x1030c4, 0x742da0, 0x0
.long 0x6d033f8, 0x13031c0, 0x782e30, 0x0
.long 0x7f033fc, 0x2503254, 0x7c2ec0, 0x0
.long 0x2603450, 0x6e032e8, 0x802660, 0x0
.long 0x3803454, 0x800337c, 0x8426f0, 0x0
.long 0x4a03458, 0x9203410, 0x882780, 0x0
.long 0x5c0345c, 0xa4034a4, 0x8c2810, 0x0
.long 0x6e03460, 0x202f98, 0x9028a0, 0x0
.long 0x8003464, 0x140302c, 0x942930, 0x0
.long 0x9203468, 0x26030c0, 0x9829c0, 0x0
.long 0xa40346c, 0x3803154, 0x9c2a50, 0x0
.long 0x203470, 0x5c03250, 0xa02ae0, 0x0
.long 0x1403474, 0x6e032e4, 0xa42b70, 0x0
.long 0x2603478, 0x8003378, 0xa82c00, 0x0
.long 0x380347c, 0x920340c, 0xac2c90, 0x0
.long 0x4a03480, 0xa4034a0, 0xb02d20, 0x0
.long 0x5c03484, 0x202f94, 0xb42db0, 0x0
.long 0x6e03488, 0x1403028, 0xb82e40, 0x0
.long 0x800348c, 0x26030bc, 0xbc2ed0, 0x0
.long 0x2703450, 0x6f03150, 0xc02670, 0x0
.long 0x3903454, 0x81031e4, 0xc42700, 0x0
.long 0x4b03458, 0x93032e0, 0xc82790, 0x0
.long 0x5d0345c, 0xa503374, 0xcc2820, 0x0
.long 0x6f03460, 0x303408, 0xd028b0, 0x0
.long 0x8103464, 0x150349c, 0xd42940, 0x0
.long 0x9303468, 0x2702f90, 0xd829d0, 0x0
.long 0xa50346c, 0x3903024, 0xdc2a60, 0x0
.long 0x303470, 0x5d030b8, 0xe02af0, 0x0
.long 0x1503474, 0x6f0314c, 0xe42b80, 0x0
.long 0x2703478, 0x81031e0, 0xe82c10, 0x0
.long 0x390347c, 0x9303274, 0xec2ca0, 0x0
.long 0x4b03480, 0xa503370, 0xf02d30, 0x0
.long 0x5d03484, 0x303404, 0xf42dc0, 0x0
.long 0x6f03488, 0x1503498, 0xf82e50, 0x0
.long 0x810348c, 0x2702f8c, 0xfc2ee0, 0x0
L_ctab:
.long 0xffffffff, 0xffffff, 0xffff, 0xffff, 0xffffffff, 0x1fff, 0x11111111, 0x11111111, 0x7fff7fff, 0x80008000, 0xffff0000, 0x0, 0x2800000, 0x280, 0x43800000, 0x41000000, 0x40004000, 0x1, 0xa, 0x3a38aa3b
.size L_tab, .-L_tab
.section .rodata,"a"
.p2align 6
.amdhsa_kernel standalone__factorization_afm__recsys_kernel
  .amdhsa_next_free_vgpr 384
  .amdhsa_next_free_sgpr 102
  .amdhsa_accum_offset 256
  .amdhsa_group_segment_fixed_size 0
  .amdhsa_kernarg_size 88
  .amdhsa_user_sgpr_count 2
  .amdhsa_user_sgpr_kernarg_segment_ptr 1
  .amdhsa_system_sgpr_workgroup_id_x 1
.end_amdhsa_kernel
```

```asm
; @launch grid=(256,1,1) block=(256,1,1) lds=116992
.amdgcn_target "amdgcn-amd-amdhsa--gfx950"
.text
.globl standalone__factorization_afm__recsys_kernel
.p2align 12
.fill 832, 4, 0xbf800000
.p2align 8
.type standalone__factorization_afm__recsys_kernel,@function
standalone__factorization_afm__recsys_kernel:
    s_load_dwordx16 s[16:31], s[0:1], 0
    s_cmp_ge_u32 s2, 256
    s_cbranch_scc1 L_end
    s_getpc_b64 s[96:97]
L_pc:
    v_and_b32 v1, 63, v0
    v_lshlrev_b32 v244, 4, v1
    v_add_u32 v244, L_tab-L_pc, v244
    global_load_dwordx4 v[128:131], v244, s[96:97]
    s_bfe_u32 s7, s2, 0x20003
    s_lshl_b32 s7, s7, 13
    v_lshl_add_u32 v200, v0, 5, s7
    v_lshrrev_b32 v2, 6, v0
    v_min_u32 v200, L_end-L_pc, v200
    v_readfirstlane_b32 s3, v2
    global_load_dword v251, v200, s[96:97]
    global_load_dwordx3 v[132:134], v244, s[96:97] offset:1024
    v_bfe_u32 v4, v0, 4, 2
    s_and_b32 s4, s2, 7
    s_lshr_b32 s6, s2, 3
    s_lshl_b32 s4, s4, 5
    s_add_u32 s4, s4, s6
    s_lshl2_add_u32 s4, s4, s3
    s_mul_i32 s6, s4, 104
    s_add_u32 s7, s6, 76
    v_lshlrev_b32 v123, 4, v0
    v_and_b32 v14, 0xf0, v123
    v_mad_u32_u24 v121, v4, 28, s6
    v_and_b32 v126, 31, v0
    v_lshlrev_b32 v125, 6, v2
    v_min_u32 v122, s7, v121
    v_lshl_or_b32 v126, v126, 1, v125
    v_lshlrev_b32 v125, 2, v1
    v_add_u32 v112, 4096, v123
    v_add_u32 v113, 12288, v123
    v_add_u32 v114, 20480, v123
    v_add_u32 v115, 28672, v123
    s_waitcnt lgkmcnt(0)
    global_load_dwordx4 v[204:207], v121, s[16:17]
    global_load_dwordx3 v[208:210], v122, s[16:17] offset:16
    s_barrier
    global_load_dwordx4 v[48:51], v112, s[24:25] offset:-4096
    global_load_dwordx4 v[52:55], v112, s[24:25] offset:0
    global_load_dwordx4 v[56:59], v113, s[24:25] offset:-4096
    global_load_dwordx4 v[60:63], v113, s[24:25] offset:0
    global_load_dwordx4 v[64:67], v114, s[24:25] offset:-4096
    global_load_dwordx4 v[68:71], v114, s[24:25] offset:0
    global_load_dwordx4 v[72:75], v115, s[24:25] offset:-4096
    global_load_dwordx4 v[76:79], v115, s[24:25] offset:0
    global_load_dwordx4 v[220:223], v14, s[28:29]
    global_load_ushort v13, v126, s[28:29]
    global_load_ushort v12, v126, s[26:27]
    global_load_dword v252, v125, s[30:31]
    s_load_dwordx2 s[32:33], s[0:1], 64
    s_add_u32 s94, s96, L_ctab-L_pc
    s_addc_u32 s95, s97, 0
    s_load_dwordx16 s[36:51], s[94:95], 0
    s_load_dwordx4 s[52:55], s[94:95], 64
    s_mov_b32 s56, s18
    s_mov_b32 s57, s19
    s_mov_b32 s58, 25600000
    s_mov_b32 s59, 0x00020000
    s_mul_i32 s5, s3, 19008
    s_lshr_b32 s7, s3, 1
    s_mul_i32 s6, s3, 1152
    s_lshl_b32 s7, s7, 7
    s_add_u32 s6, s6, s7
    s_lshl_b32 s8, s3, 7
    s_add_u32 s5, s5, 40960
    v_add_u32 v127, s5, v125
    v_mov_b32 v124, 0
    ds_write_b32 v127, v124 offset:8928
    v_lshlrev_b32 v127, 4, v1
    v_lshl_add_u32 v3, v2, 2, v127
    s_mov_b64 exec, 0
    s_cmp_eq_u32 s3, 0
    s_cbranch_scc1 L_pad0
    s_cmp_eq_u32 s3, 1
    s_cbranch_scc1 L_pad1
    s_cmp_eq_u32 s3, 2
    s_cbranch_scc1 L_pad2
    s_branch L_pad3
L_hopret:
    s_mov_b64 exec, -1
    s_waitcnt vmcnt(16)
    v_add_u32_sdwa v5, v128, s6 dst_sel:DWORD dst_unused:UNUSED_PAD src0_sel:WORD_0 src1_sel:DWORD
    s_waitcnt vmcnt(13)
    v_lshl_add_u32 v204, v204, 8, v14
    v_lshl_add_u32 v205, v205, 8, v14
    v_lshl_add_u32 v206, v206, 8, v14
    v_lshl_add_u32 v207, v207, 8, v14
    buffer_load_dwordx4 v[144:147], v204, s[56:59], 0 offen
    buffer_load_dwordx4 v[148:151], v205, s[56:59], 0 offen
    buffer_load_dwordx4 v[152:155], v206, s[56:59], 0 offen
    buffer_load_dwordx4 v[156:159], v207, s[56:59], 0 offen
    s_waitcnt vmcnt(16)
    v_lshl_add_u32 v208, v208, 8, v14
    v_lshl_add_u32 v209, v209, 8, v14
    v_lshl_add_u32 v210, v210, 8, v14
    v_add_u32_sdwa v7, v128, s8 dst_sel:DWORD dst_unused:UNUSED_PAD src0_sel:WORD_1 src1_sel:DWORD
    v_add_u32_sdwa v8, v129, s8 dst_sel:DWORD dst_unused:UNUSED_PAD src0_sel:WORD_0 src1_sel:DWORD
    v_lshrrev_b32 v9, 16, v129
    v_and_b32 v6, 0xffff, v130
    v_lshrrev_b32 v15, 16, v130
    v_lshrrev_b32 v0, 16, v130
    v_add_u32_sdwa v203, v131, s5 dst_sel:DWORD dst_unused:UNUSED_PAD src0_sel:WORD_0 src1_sel:DWORD
    v_add_u32_sdwa v246, v131, s5 dst_sel:DWORD dst_unused:UNUSED_PAD src0_sel:WORD_1 src1_sel:DWORD
    v_add_u32_sdwa v201, v132, s5 dst_sel:DWORD dst_unused:UNUSED_PAD src0_sel:WORD_0 src1_sel:DWORD
    v_add_u32_sdwa v245, v132, s5 dst_sel:DWORD dst_unused:UNUSED_PAD src0_sel:WORD_1 src1_sel:DWORD
    v_add_u32_sdwa v202, v133, s5 dst_sel:DWORD dst_unused:UNUSED_PAD src0_sel:WORD_0 src1_sel:DWORD
    v_lshrrev_b32 v10, 16, v133
    v_add_u32 v200, s5, v134
    s_mov_b32 s13, 0xffff0000
    s_mov_b32 s90, 0x11111111
    s_mov_b32 s91, 0x11111111
L_wconv:
    s_waitcnt vmcnt(15)
    v_lshlrev_b32 v96, 16, v48
    v_and_b32 v97, s13, v48
    v_lshlrev_b32 v98, 16, v49
    v_and_b32 v99, s13, v49
    v_lshlrev_b32 v100, 16, v50
    v_and_b32 v101, s13, v50
    v_lshlrev_b32 v102, 16, v51
    v_and_b32 v103, s13, v51
    v_cvt_pkrtz_f16_f32 v16, v96, v97
    v_cvt_pkrtz_f16_f32 v17, v98, v99
    v_cvt_pkrtz_f16_f32 v18, v100, v101
    v_cvt_pkrtz_f16_f32 v19, v102, v103
    ds_write_b128 v5, v[16:19] offset:0
    v_or_b32 v248, v16, v17
    v_or3_b32 v248, v248, v18, v19
    s_waitcnt vmcnt(14)
    v_lshlrev_b32 v104, 16, v52
    v_and_b32 v105, s13, v52
    v_lshlrev_b32 v106, 16, v53
    v_and_b32 v107, s13, v53
    v_lshlrev_b32 v108, 16, v54
    v_and_b32 v109, s13, v54
    v_lshlrev_b32 v110, 16, v55
    v_and_b32 v111, s13, v55
    v_cvt_pkrtz_f16_f32 v20, v104, v105
    v_cvt_pkrtz_f16_f32 v21, v106, v107
    v_cvt_pkrtz_f16_f32 v22, v108, v109
    v_cvt_pkrtz_f16_f32 v23, v110, v111
    ds_write_b128 v5, v[20:23] offset:4736
    v_or3_b32 v248, v248, v20, v21
    v_or3_b32 v248, v248, v22, v23
    s_waitcnt vmcnt(13)
    v_lshlrev_b32 v96, 16, v56
    v_and_b32 v97, s13, v56
    v_lshlrev_b32 v98, 16, v57
    v_and_b32 v99, s13, v57
    v_lshlrev_b32 v100, 16, v58
    v_and_b32 v101, s13, v58
    v_lshlrev_b32 v102, 16, v59
    v_and_b32 v103, s13, v59
    v_cvt_pkrtz_f16_f32 v24, v96, v97
    v_cvt_pkrtz_f16_f32 v25, v98, v99
    v_cvt_pkrtz_f16_f32 v26, v100, v101
    v_cvt_pkrtz_f16_f32 v27, v102, v103
    ds_write_b128 v5, v[24:27] offset:9472
    v_or3_b32 v248, v248, v24, v25
    v_or3_b32 v248, v248, v26, v27
    s_waitcnt vmcnt(12)
    v_lshlrev_b32 v104, 16, v60
    v_and_b32 v105, s13, v60
    v_lshlrev_b32 v106, 16, v61
    v_and_b32 v107, s13, v61
    v_lshlrev_b32 v108, 16, v62
    v_and_b32 v109, s13, v62
    v_lshlrev_b32 v110, 16, v63
    v_and_b32 v111, s13, v63
    v_cvt_pkrtz_f16_f32 v28, v104, v105
    v_cvt_pkrtz_f16_f32 v29, v106, v107
    v_cvt_pkrtz_f16_f32 v30, v108, v109
    v_cvt_pkrtz_f16_f32 v31, v110, v111
    ds_write_b128 v5, v[28:31] offset:14208
    v_or3_b32 v248, v248, v28, v29
    v_or3_b32 v248, v248, v30, v31
    s_waitcnt vmcnt(11)
    v_lshlrev_b32 v96, 16, v64
    v_and_b32 v97, s13, v64
    v_lshlrev_b32 v98, 16, v65
    v_and_b32 v99, s13, v65
    v_lshlrev_b32 v100, 16, v66
    v_and_b32 v101, s13, v66
    v_lshlrev_b32 v102, 16, v67
    v_and_b32 v103, s13, v67
    v_cvt_pkrtz_f16_f32 v32, v96, v97
    v_cvt_pkrtz_f16_f32 v33, v98, v99
    v_cvt_pkrtz_f16_f32 v34, v100, v101
    v_cvt_pkrtz_f16_f32 v35, v102, v103
    ds_write_b128 v5, v[32:35] offset:18944
    v_or3_b32 v248, v248, v32, v33
    s_waitcnt vmcnt(7)
    v_dot2_f32_bf16 v112, v48, v220, 0
    v_or3_b32 v248, v248, v34, v35
    v_dot2_f32_bf16 v113, v52, v220, 0
    v_dot2_f32_bf16 v112, v49, v221, v112
    v_dot2_f32_bf16 v113, v53, v221, v113
    v_dot2_f32_bf16 v112, v50, v222, v112
    v_dot2_f32_bf16 v113, v54, v222, v113
    v_dot2_f32_bf16 v112, v51, v223, v112
    v_dot2_f32_bf16 v113, v55, v223, v113
    v_dot2_f32_bf16 v114, v56, v220, 0
    v_dot2_f32_bf16 v115, v60, v220, 0
    v_lshlrev_b32 v104, 16, v68
    v_and_b32 v105, s13, v68
    v_lshlrev_b32 v106, 16, v69
    v_and_b32 v107, s13, v69
    v_lshlrev_b32 v108, 16, v70
    v_and_b32 v109, s13, v70
    v_lshlrev_b32 v110, 16, v71
    v_and_b32 v111, s13, v71
    v_cvt_pkrtz_f16_f32 v36, v104, v105
    v_cvt_pkrtz_f16_f32 v37, v106, v107
    v_cvt_pkrtz_f16_f32 v38, v108, v109
    v_cvt_pkrtz_f16_f32 v39, v110, v111
    ds_write_b128 v5, v[36:39] offset:23680
    v_or3_b32 v248, v248, v36, v37
    v_dot2_f32_bf16 v114, v57, v221, v114
    v_or3_b32 v248, v248, v38, v39
    v_dot2_f32_bf16 v115, v61, v221, v115
    v_dot2_f32_bf16 v114, v58, v222, v114
    v_dot2_f32_bf16 v115, v62, v222, v115
    v_dot2_f32_bf16 v114, v59, v223, v114
    v_dot2_f32_bf16 v115, v63, v223, v115
    v_add_f32_dpp v112, v112, v112 row_ror:8 row_mask:0xf bank_mask:0x3
    v_dot2_f32_bf16 v116, v64, v220, 0
    v_dot2_f32_bf16 v117, v68, v220, 0
    v_dot2_f32_bf16 v116, v65, v221, v116
    v_lshlrev_b32 v96, 16, v72
    v_and_b32 v97, s13, v72
    v_lshlrev_b32 v98, 16, v73
    v_and_b32 v99, s13, v73
    v_lshlrev_b32 v100, 16, v74
    v_and_b32 v101, s13, v74
    v_lshlrev_b32 v102, 16, v75
    v_and_b32 v103, s13, v75
    v_cvt_pkrtz_f16_f32 v40, v96, v97
    v_cvt_pkrtz_f16_f32 v41, v98, v99
    v_cvt_pkrtz_f16_f32 v42, v100, v101
    v_cvt_pkrtz_f16_f32 v43, v102, v103
    ds_write_b128 v5, v[40:43] offset:28416
    v_or3_b32 v248, v248, v40, v41
    v_dot2_f32_bf16 v117, v69, v221, v117
    v_or3_b32 v248, v248, v42, v43
    v_add_f32_dpp v112, v113, v113 row_ror:8 row_mask:0xf bank_mask:0xc
    v_add_f32_dpp v114, v114, v114 row_ror:8 row_mask:0xf bank_mask:0x3
    v_dot2_f32_bf16 v116, v66, v222, v116
    v_dot2_f32_bf16 v117, v70, v222, v117
    v_dot2_f32_bf16 v116, v67, v223, v116
    v_dot2_f32_bf16 v117, v71, v223, v117
    v_add_f32_dpp v114, v115, v115 row_ror:8 row_mask:0xf bank_mask:0xc
    v_add_f32_dpp v112, v112, v112 row_half_mirror row_mask:0xf bank_mask:0x5
    v_dot2_f32_bf16 v118, v72, v220, 0
    v_lshlrev_b32 v104, 16, v76
    v_and_b32 v105, s13, v76
    v_lshlrev_b32 v106, 16, v77
    v_and_b32 v107, s13, v77
    v_lshlrev_b32 v108, 16, v78
    v_and_b32 v109, s13, v78
    v_lshlrev_b32 v110, 16, v79
    v_and_b32 v111, s13, v79
    v_cvt_pkrtz_f16_f32 v44, v104, v105
    v_cvt_pkrtz_f16_f32 v45, v106, v107
    v_cvt_pkrtz_f16_f32 v46, v108, v109
    v_cvt_pkrtz_f16_f32 v47, v110, v111
    ds_write_b128 v5, v[44:47] offset:33152
    v_or3_b32 v248, v248, v44, v45
    v_dot2_f32_bf16 v119, v76, v220, 0
    v_or3_b32 v248, v248, v46, v47
    v_dot2_f32_bf16 v118, v73, v221, v118
    v_dot2_f32_bf16 v119, v77, v221, v119
    v_add_f32_dpp v112, v114, v114 row_half_mirror row_mask:0xf bank_mask:0xa
    v_add_f32_dpp v116, v116, v116 row_ror:8 row_mask:0xf bank_mask:0x3
    v_dot2_f32_bf16 v118, v74, v222, v118
    v_dot2_f32_bf16 v119, v78, v222, v119
    v_dot2_f32_bf16 v118, v75, v223, v118
    v_dot2_f32_bf16 v119, v79, v223, v119
    v_add_f32_dpp v116, v117, v117 row_ror:8 row_mask:0xf bank_mask:0xc
    v_add_f32_dpp v112, v112, v112 quad_perm:[1,0,3,2] row_mask:0xf bank_mask:0xf
    v_cmp_lt_u32 vcc, 31, v1
    v_add_f32_dpp v118, v118, v118 row_ror:8 row_mask:0xf bank_mask:0x3
    v_add_f32_dpp v116, v116, v116 row_half_mirror row_mask:0xf bank_mask:0x5
    s_waitcnt vmcnt(5)
    v_cndmask_b32 v120, v12, v13, vcc
    v_add_f32_dpp v118, v119, v119 row_ror:8 row_mask:0xf bank_mask:0xc
    v_add_f32_dpp v112, v112, v112 quad_perm:[2,3,0,1] row_mask:0xf bank_mask:0xf
    v_lshlrev_b32 v120, 16, v120
    v_add_f32_dpp v116, v118, v118 row_half_mirror row_mask:0xf bank_mask:0xa
    v_ldexp_f32 v120, v120, v9
    ds_write_b32 v3, v248 offset:39424
    v_add_f32_dpp v116, v116, v116 quad_perm:[1,0,3,2] row_mask:0xf bank_mask:0xf
    ds_write_b32 v8, v120 offset:37888
    s_nop 0
    v_add_f32_dpp v113, v116, v116 quad_perm:[2,3,0,1] row_mask:0xf bank_mask:0xf
    s_mov_b64 exec, s[90:91]
    ds_write_b64 v7, v[112:113]
    s_mov_b64 exec, -1
    s_waitcnt lgkmcnt(0)
    s_barrier
    ds_read_b128 v[112:115], v127 offset:39424
    ds_read_b64_tr_b16 a[0:1], v6 offset:0
    ds_read_b64_tr_b16 a[2:3], v6 offset:1152
    ds_read_b64_tr_b16 a[4:5], v6 offset:9472
    ds_read_b64_tr_b16 a[6:7], v6 offset:10624
    ds_read_b64_tr_b16 a[8:9], v6 offset:18944
    ds_read_b64_tr_b16 a[10:11], v6 offset:20096
    ds_read_b64_tr_b16 a[12:13], v6 offset:28416
    ds_read_b64_tr_b16 a[14:15], v6 offset:29568
    ds_read_b64_tr_b16 a[16:17], v6 offset:32
    ds_read_b64_tr_b16 a[18:19], v6 offset:1184
    ds_read_b64_tr_b16 a[20:21], v6 offset:9504
    ds_read_b64_tr_b16 a[22:23], v6 offset:10656
    ds_read_b64_tr_b16 a[24:25], v6 offset:18976
    ds_read_b64_tr_b16 a[26:27], v6 offset:20128
    ds_read_b64_tr_b16 a[28:29], v6 offset:28448
    ds_read_b64_tr_b16 a[30:31], v6 offset:29600
    ds_read_b64_tr_b16 a[32:33], v6 offset:64
    ds_read_b64_tr_b16 a[34:35], v6 offset:1216
    ds_read_b64_tr_b16 a[36:37], v6 offset:9536
    ds_read_b64_tr_b16 a[38:39], v6 offset:10688
    ds_read_b64_tr_b16 a[40:41], v6 offset:19008
    ds_read_b64_tr_b16 a[42:43], v6 offset:20160
    ds_read_b64_tr_b16 a[44:45], v6 offset:28480
    ds_read_b64_tr_b16 a[46:47], v6 offset:29632
    ds_read_b64_tr_b16 a[48:49], v6 offset:96
    ds_read_b64_tr_b16 a[50:51], v6 offset:1248
    ds_read_b64_tr_b16 a[52:53], v6 offset:9568
    ds_read_b64_tr_b16 a[54:55], v6 offset:10720
    ds_read_b64_tr_b16 a[56:57], v6 offset:19040
    ds_read_b64_tr_b16 a[58:59], v6 offset:20192
    ds_read_b64_tr_b16 a[60:61], v6 offset:28512
    ds_read_b64_tr_b16 a[62:63], v6 offset:29664
    s_waitcnt lgkmcnt(15)
    v_or3_b32 v112, v112, v113, v114
    v_or_b32 v112, v112, v115
    v_and_b32 v121, s52, v112
    v_and_b32 v122, 0x20002000, v112
    v_cmp_ne_u32 vcc, 0, v121
    v_cmp_ge_u32 s[92:93], v122, s53
    s_cbranch_vccnz L_wfix
    s_cmp_eq_u64 s[92:93], 0
    s_cbranch_scc1 L_wfix
    buffer_load_dwordx4 v[160:163], v208, s[56:59], 0 offen
    buffer_load_dwordx4 v[164:167], v209, s[56:59], 0 offen
    buffer_load_dwordx4 v[168:171], v210, s[56:59], 0 offen
    global_load_dwordx4 v[232:235], v244, s[96:97] offset:2048
    global_load_dwordx3 v[236:238], v244, s[96:97] offset:3072
L_econv:
    s_waitcnt vmcnt(8)
    v_lshl_add_u32 v96, v144, 16, s48
    v_add_u32_sdwa v97, v144, s49 dst_sel:WORD_1 dst_unused:UNUSED_PAD src0_sel:WORD_1 src1_sel:DWORD
    v_lshl_add_u32 v98, v145, 16, s48
    v_add_u32_sdwa v99, v145, s49 dst_sel:WORD_1 dst_unused:UNUSED_PAD src0_sel:WORD_1 src1_sel:DWORD
    v_lshl_add_u32 v100, v146, 16, s48
    v_add_u32_sdwa v101, v146, s49 dst_sel:WORD_1 dst_unused:UNUSED_PAD src0_sel:WORD_1 src1_sel:DWORD
    v_lshl_add_u32 v102, v147, 16, s48
    v_add_u32_sdwa v103, v147, s49 dst_sel:WORD_1 dst_unused:UNUSED_PAD src0_sel:WORD_1 src1_sel:DWORD
    v_cvt_pkrtz_f16_f32 v172, v96, v97
    v_max_f32 v248, |v96|, |v97|
    v_cvt_pkrtz_f16_f32 v173, v98, v99
    v_max_f32 v249, |v98|, |v99|
    v_cvt_pkrtz_f16_f32 v174, v100, v101
    v_max3_f32 v248, v248, |v100|, |v101|
    v_cvt_pkrtz_f16_f32 v175, v102, v103
    v_max3_f32 v249, v249, |v102|, |v103|
    ds_write_b128 v203, v[172:175] offset:0
    ds_read_b128 v[16:19], v0 offset:37888
    ds_read_b128 v[20:23], v0 offset:37952
    ds_read_b128 v[24:27], v0 offset:38016
    ds_read_b128 v[28:31], v0 offset:38080
    ds_read_b128 v[32:35], v0 offset:38144
    s_waitcnt vmcnt(7)
    v_lshl_add_u32 v104, v148, 16, s48
    v_add_u32_sdwa v105, v148, s49 dst_sel:WORD_1 dst_unused:UNUSED_PAD src0_sel:WORD_1 src1_sel:DWORD
    v_lshl_add_u32 v106, v149, 16, s48
    v_add_u32_sdwa v107, v149, s49 dst_sel:WORD_1 dst_unused:UNUSED_PAD src0_sel:WORD_1 src1_sel:DWORD
    v_lshl_add_u32 v108, v150, 16, s48
    v_add_u32_sdwa v109, v150, s49 dst_sel:WORD_1 dst_unused:UNUSED_PAD src0_sel:WORD_1 src1_sel:DWORD
    v_lshl_add_u32 v110, v151, 16, s48
    v_add_u32_sdwa v111, v151, s49 dst_sel:WORD_1 dst_unused:UNUSED_PAD src0_sel:WORD_1 src1_sel:DWORD
    v_cvt_pkrtz_f16_f32 v176, v104, v105
    v_max3_f32 v248, v248, |v104|, |v105|
    v_cvt_pkrtz_f16_f32 v177, v106, v107
    v_max3_f32 v249, v249, |v106|, |v107|
    v_cvt_pkrtz_f16_f32 v178, v108, v109
    v_max3_f32 v248, v248, |v108|, |v109|
    v_cvt_pkrtz_f16_f32 v179, v110, v111
    v_max3_f32 v249, v249, |v110|, |v111|
    ds_write_b128 v203, v[176:179] offset:1152
    s_waitcnt vmcnt(6)
    v_lshl_add_u32 v96, v152, 16, s48
    v_add_u32_sdwa v97, v152, s49 dst_sel:WORD_1 dst_unused:UNUSED_PAD src0_sel:WORD_1 src1_sel:DWORD
    v_lshl_add_u32 v98, v153, 16, s48
    v_add_u32_sdwa v99, v153, s49 dst_sel:WORD_1 dst_unused:UNUSED_PAD src0_sel:WORD_1 src1_sel:DWORD
    v_lshl_add_u32 v100, v154, 16, s48
    v_add_u32_sdwa v101, v154, s49 dst_sel:WORD_1 dst_unused:UNUSED_PAD src0_sel:WORD_1 src1_sel:DWORD
    v_lshl_add_u32 v102, v155, 16, s48
    v_add_u32_sdwa v103, v155, s49 dst_sel:WORD_1 dst_unused:UNUSED_PAD src0_sel:WORD_1 src1_sel:DWORD
    v_cvt_pkrtz_f16_f32 v180, v96, v97
    v_cvt_pkrtz_f16_f32 v181, v98, v99
    v_cvt_pkrtz_f16_f32 v182, v100, v101
    v_cvt_pkrtz_f16_f32 v183, v102, v103
    ds_write_b128 v203, v[180:183] offset:2304
    s_waitcnt vmcnt(5)
    v_lshl_add_u32 v104, v156, 16, s48
    v_add_u32_sdwa v105, v156, s49 dst_sel:WORD_1 dst_unused:UNUSED_PAD src0_sel:WORD_1 src1_sel:DWORD
    v_lshl_add_u32 v106, v157, 16, s48
    v_add_u32_sdwa v107, v157, s49 dst_sel:WORD_1 dst_unused:UNUSED_PAD src0_sel:WORD_1 src1_sel:DWORD
    v_lshl_add_u32 v108, v158, 16, s48
    v_add_u32_sdwa v109, v158, s49 dst_sel:WORD_1 dst_unused:UNUSED_PAD src0_sel:WORD_1 src1_sel:DWORD
    v_lshl_add_u32 v110, v159, 16, s48
    v_add_u32_sdwa v111, v159, s49 dst_sel:WORD_1 dst_unused:UNUSED_PAD src0_sel:WORD_1 src1_sel:DWORD
    v_cvt_pkrtz_f16_f32 v184, v104, v105
    v_cvt_pkrtz_f16_f32 v185, v106, v107
    v_cvt_pkrtz_f16_f32 v186, v108, v109
    v_cvt_pkrtz_f16_f32 v187, v110, v111
    ds_write_b128 v203, v[184:187] offset:3456
    ds_read_b128 v[80:83], v246 offset:0
    ds_read_b128 v[128:131], v201 offset:0
    ds_read_b128 v[84:87], v246 offset:64
    ds_read_b128 v[132:135], v201 offset:64
    ds_read_b128 v[88:91], v246 offset:128
    ds_read_b128 v[136:139], v201 offset:128
    ds_read_b128 v[92:95], v246 offset:192
    ds_read_b128 v[140:143], v201 offset:192
    ds_read_b64_tr_b16 a[64:65], v6 offset:128
    ds_read_b64_tr_b16 a[66:67], v6 offset:1280
    ds_read_b64_tr_b16 a[68:69], v6 offset:9600
    ds_read_b64_tr_b16 a[70:71], v6 offset:10752
    ds_read_b64_tr_b16 a[72:73], v6 offset:19072
    ds_read_b64_tr_b16 a[74:75], v6 offset:20224
    ds_read_b64_tr_b16 a[76:77], v6 offset:28544
    ds_read_b64_tr_b16 a[78:79], v6 offset:29696
    v_max3_f32 v248, v248, |v96|, |v97|
    v_max3_f32 v249, v249, |v98|, |v99|
    v_max3_f32 v248, v248, |v100|, |v101|
    v_max3_f32 v249, v249, |v102|, |v103|
    v_max3_f32 v248, v248, |v104|, |v105|
    v_max3_f32 v249, v249, |v106|, |v107|
    v_max3_f32 v248, v248, |v108|, |v109|
    v_max3_f32 v249, v249, |v110|, |v111|
    s_waitcnt lgkmcnt(14)
    v_pk_mul_f16 v128, v128, v80
    v_pk_mul_f16 v129, v129, v81
    v_pk_mul_f16 v130, v130, v82
    v_pk_mul_f16 v131, v131, v83
    s_nop 1
    v_mfma_f32_16x16x32_f16 v[96:99], a[0:3], v[128:131], v[16:19]
    ds_read_b128 v[48:51], v15 offset:38400
    ds_read_b128 v[52:55], v15 offset:38464
    s_waitcnt lgkmcnt(14)
    v_pk_mul_f16 v132, v132, v84
    v_pk_mul_f16 v133, v133, v85
    v_mfma_f32_16x16x32_f16 v[100:103], a[16:19], v[128:131], v[20:23]
    ds_read_b128 v[56:59], v15 offset:38528
    ds_read_b128 v[60:63], v15 offset:38592
    v_pk_mul_f16 v134, v134, v86
    v_pk_mul_f16 v135, v135, v87
    v_mfma_f32_16x16x32_f16 v[104:107], a[32:35], v[128:131], v[24:27]
    ds_read_b128 v[36:39], v0 offset:38208
    ds_read_b64_tr_b16 a[80:81], v6 offset:160
    s_waitcnt lgkmcnt(15)
    v_pk_mul_f16 v136, v136, v88
    v_pk_mul_f16 v137, v137, v89
    v_mfma_f32_16x16x32_f16 v[96:99], a[4:7], v[132:135], v[96:99]
    ds_read_b64_tr_b16 a[82:83], v6 offset:1312
    ds_read_b64_tr_b16 a[84:85], v6 offset:9632
    v_pk_mul_f16 v138, v138, v90
    v_pk_mul_f16 v139, v139, v91
    v_mfma_f32_16x16x32_f16 v[100:103], a[20:23], v[132:135], v[100:103]
    ds_read_b64_tr_b16 a[86:87], v6 offset:10784
    ds_read_b64_tr_b16 a[88:89], v6 offset:19104
    s_waitcnt lgkmcnt(15)
    v_pk_mul_f16 v140, v140, v92
    v_pk_mul_f16 v141, v141, v93
    v_mfma_f32_16x16x32_f16 v[104:107], a[36:39], v[132:135], v[104:107]
    ds_read_b64_tr_b16 a[90:91], v6 offset:20256
    ds_read_b64_tr_b16 a[92:93], v6 offset:28576
    v_pk_mul_f16 v142, v142, v94
    v_pk_mul_f16 v143, v143, v95
    v_mov_b32_dpp v247, v246 row_ror:14 row_mask:0xf bank_mask:0xf
    ds_read_b128 v[156:159], v247 offset:192
    ds_read_b128 v[152:155], v247 offset:128
    ds_read_b128 v[148:151], v247 offset:64
    ds_read_b128 v[144:147], v247 offset:0
    v_mfma_f32_16x16x32_f16 v[96:99], a[8:11], v[136:139], v[96:99]
    ds_read_b64_tr_b16 a[94:95], v6 offset:29728
    ds_read_b128 v[64:67], v15 offset:38656
    ds_read2_b32 v[192:193], v10 offset0:0 offset1:8
    v_mov_b32 v251, 0xff800000
    v_mfma_f32_16x16x32_f16 v[100:103], a[24:27], v[136:139], v[100:103]
    ds_read_b128 v[40:43], v0 offset:38272
    ds_read_b64_tr_b16 a[108:109], v6 offset:28608
    v_mfma_f32_16x16x32_f16 v[104:107], a[40:43], v[136:139], v[104:107]
    ds_read_b64_tr_b16 a[110:111], v6 offset:29760
    ds_read_b64_tr_b16 a[104:105], v6 offset:19136
    v_mfma_f32_16x16x32_f16 v[96:99], a[12:15], v[140:143], v[96:99]
    ds_read_b64_tr_b16 a[106:107], v6 offset:20288
    ds_read_b64_tr_b16 a[100:101], v6 offset:9664
    v_mfma_f32_16x16x32_f16 v[100:103], a[28:31], v[140:143], v[100:103]
    ds_read_b64_tr_b16 a[102:103], v6 offset:10816
    ds_read_b64_tr_b16 a[96:97], v6 offset:192
    v_mfma_f32_16x16x32_f16 v[104:107], a[44:47], v[140:143], v[104:107]
    ds_read_b64_tr_b16 a[98:99], v6 offset:1344
    ds_read_b128 v[68:71], v15 offset:38720
    v_mfma_f32_16x16x32_f16 v[108:111], a[60:63], v[140:143], v[28:31]
    ds_read_b128 v[44:47], v0 offset:38336
    ds_read_b64_tr_b16 a[112:113], v6 offset:224
    s_waitcnt lgkmcnt(15)
    v_mul_f32 v184, |v96|, v48
    v_fma_f32 v184, |v97|, v49, v184
    v_mfma_f32_16x16x32_f16 v[108:111], a[56:59], v[136:139], v[108:111]
    ds_read_b64_tr_b16 a[114:115], v6 offset:1376
    ds_read_b64_tr_b16 a[116:117], v6 offset:9696
    v_fma_f32 v184, |v98|, v50, v184
    v_fma_f32 v184, |v99|, v51, v184
    v_mfma_f32_16x16x32_f16 v[108:111], a[52:55], v[132:135], v[108:111]
    ds_read_b64_tr_b16 a[118:119], v6 offset:10848
    ds_read_b64_tr_b16 a[120:121], v6 offset:19168
    v_pk_mul_f16 v144, v144, v80
    v_fma_f32 v184, |v100|, v52, v184
    v_mfma_f32_16x16x32_f16 v[108:111], a[48:51], v[128:131], v[108:111]
    ds_read_b64_tr_b16 a[122:123], v6 offset:20320
    ds_read_b64_tr_b16 a[124:125], v6 offset:28640
    v_and_b32 v253, s44, v252
    v_fma_f32 v184, |v101|, v53, v184
    v_mfma_f32_16x16x32_f16 v[112:115], a[64:67], v[128:131], v[32:35]
    ds_read_b64_tr_b16 a[126:127], v6 offset:29792
    ds_read_b128 v[72:75], v15 offset:38784
    v_pk_mul_f16 v145, v145, v81
    v_fma_f32 v184, |v102|, v54, v184
    v_mfma_f32_16x16x32_f16 v[112:115], a[68:71], v[132:135], v[112:115]
    ds_read_b128 v[76:79], v15 offset:38848
    v_pk_mul_f16 v146, v146, v82
    v_fma_f32 v184, |v103|, v55, v184
    v_mfma_f32_16x16x32_f16 v[112:115], a[72:75], v[136:139], v[112:115]
    v_pk_mul_f16 v147, v147, v83
    v_fma_f32 v184, |v104|, v56, v184
    v_mfma_f32_16x16x32_f16 v[112:115], a[76:79], v[140:143], v[112:115]
    v_pk_mul_f16 v148, v148, v84
    v_fma_f32 v184, |v105|, v57, v184
    s_waitcnt lgkmcnt(15)
    v_mfma_f32_16x16x32_f16 v[116:119], a[92:95], v[140:143], v[36:39]
    v_pk_mul_f16 v149, v149, v85
    v_fma_f32 v184, |v106|, v58, v184
    v_mfma_f32_16x16x32_f16 v[116:119], a[88:91], v[136:139], v[116:119]
    v_pk_mul_f16 v150, v150, v86
    v_fma_f32 v184, |v107|, v59, v184
    v_mfma_f32_16x16x32_f16 v[116:119], a[84:87], v[132:135], v[116:119]
    v_pk_mul_f16 v151, v151, v87
    v_fma_f32 v184, |v108|, v60, v184
    v_mfma_f32_16x16x32_f16 v[116:119], a[80:83], v[128:131], v[116:119]
    v_pk_mul_f16 v152, v152, v88
    v_fma_f32 v184, |v109|, v61, v184
    s_waitcnt lgkmcnt(12)
    v_mfma_f32_16x16x32_f16 v[120:123], a[96:99], v[128:131], v[40:43]
    v_pk_mul_f16 v153, v153, v89
    v_fma_f32 v184, |v110|, v62, v184
    v_mfma_f32_16x16x32_f16 v[120:123], a[100:103], v[132:135], v[120:123]
    v_pk_mul_f16 v154, v154, v90
    v_fma_f32 v184, |v111|, v63, v184
    v_mfma_f32_16x16x32_f16 v[120:123], a[104:107], v[136:139], v[120:123]
    v_pk_mul_f16 v155, v155, v91
    v_fma_f32 v184, |v112|, v64, v184
    v_mfma_f32_16x16x32_f16 v[120:123], a[108:111], v[140:143], v[120:123]
    v_pk_mul_f16 v156, v156, v92
    v_fma_f32 v184, |v113|, v65, v184
    s_waitcnt lgkmcnt(2)
    v_mfma_f32_16x16x32_f16 v[124:127], a[124:127], v[140:143], v[44:47]
    v_pk_mul_f16 v157, v157, v93
    v_fma_f32 v184, |v114|, v66, v184
    v_mfma_f32_16x16x32_f16 v[124:127], a[120:123], v[136:139], v[124:127]
    v_pk_mul_f16 v158, v158, v94
    v_fma_f32 v184, |v115|, v67, v184
    v_mfma_f32_16x16x32_f16 v[124:127], a[116:119], v[132:135], v[124:127]
    v_pk_mul_f16 v159, v159, v95
    v_fma_f32 v184, |v116|, v68, v184
    v_mfma_f32_16x16x32_f16 v[124:127], a[112:115], v[128:131], v[124:127]
    v_mov_b32_dpp v247, v246 row_ror:13 row_mask:0xf bank_mask:0xf
    v_fma_f32 v184, |v117|, v69, v184
    v_mfma_f32_16x16x32_f16 v[96:99], a[112:115], v[144:147], v[44:47]
    ds_read_b128 v[140:143], v247 offset:192
    v_fma_f32 v184, |v118|, v70, v184
    v_mfma_f32_16x16x32_f16 v[96:99], a[116:119], v[148:151], v[96:99]
    ds_read_b128 v[136:139], v247 offset:128
    v_fma_f32 v184, |v119|, v71, v184
    v_mfma_f32_16x16x32_f16 v[96:99], a[120:123], v[152:155], v[96:99]
L_pad0:
    s_cbranch_execz L_hopret
    ds_read_b128 v[132:135], v247 offset:64
    s_waitcnt lgkmcnt(4)
    v_fma_f32 v184, |v120|, v72, v184
    v_mfma_f32_16x16x32_f16 v[96:99], a[124:127], v[156:159], v[96:99]
    ds_read_b128 v[128:131], v247 offset:0
    v_fma_f32 v184, |v121|, v73, v184
    v_mfma_f32_16x16x32_f16 v[100:103], a[108:111], v[156:159], v[40:43]
    v_pk_max_u16 v254, v253, v253 op_sel:[0,1] op_sel_hi:[1,0]
    v_fma_f32 v184, |v122|, v74, v184
    v_mfma_f32_16x16x32_f16 v[100:103], a[104:107], v[152:155], v[100:103]
    v_max_f32 v255, |v192|, |v193|
    v_fma_f32 v184, |v123|, v75, v184
    v_mfma_f32_16x16x32_f16 v[100:103], a[100:103], v[148:151], v[100:103]
    v_max_u32_dpp v254, v254, v254 row_ror:8 row_mask:0xf bank_mask:0xf
    s_waitcnt lgkmcnt(4)
    v_fma_f32 v184, |v124|, v76, v184
    v_mfma_f32_16x16x32_f16 v[100:103], a[96:99], v[144:147], v[100:103]
    v_max_u32_dpp v255, v255, v255 row_ror:8 row_mask:0xf bank_mask:0xf
    v_fma_f32 v184, |v125|, v77, v184
    v_mfma_f32_16x16x32_f16 v[104:107], a[80:83], v[144:147], v[36:39]
    s_waitcnt vmcnt(4)
    v_lshl_add_u32 v220, v160, 16, s48
    v_fma_f32 v184, |v126|, v78, v184
    v_mfma_f32_16x16x32_f16 v[104:107], a[84:87], v[148:151], v[104:107]
    v_add_u32_sdwa v221, v160, s49 dst_sel:WORD_1 dst_unused:UNUSED_PAD src0_sel:WORD_1 src1_sel:DWORD
    v_fma_f32 v184, |v127|, v79, v184
    v_mfma_f32_16x16x32_f16 v[104:107], a[88:91], v[152:155], v[104:107]
    v_lshl_add_u32 v222, v161, 16, s48
    v_mul_f32 v185, |v96|, v76
    v_mfma_f32_16x16x32_f16 v[104:107], a[92:95], v[156:159], v[104:107]
    v_add_u32_sdwa v223, v161, s49 dst_sel:WORD_1 dst_unused:UNUSED_PAD src0_sel:WORD_1 src1_sel:DWORD
    v_fma_f32 v185, |v97|, v77, v185
    v_mfma_f32_16x16x32_f16 v[108:111], a[76:79], v[156:159], v[32:35]
    v_lshl_add_u32 v224, v162, 16, s48
    v_fma_f32 v185, |v98|, v78, v185
    v_mfma_f32_16x16x32_f16 v[108:111], a[72:75], v[152:155], v[108:111]
    v_add_u32_sdwa v225, v162, s49 dst_sel:WORD_1 dst_unused:UNUSED_PAD src0_sel:WORD_1 src1_sel:DWORD
    v_fma_f32 v185, |v99|, v79, v185
    v_mfma_f32_16x16x32_f16 v[108:111], a[68:71], v[148:151], v[108:111]
    v_lshl_add_u32 v226, v163, 16, s48
    v_fma_f32 v185, |v100|, v72, v185
    v_mfma_f32_16x16x32_f16 v[108:111], a[64:67], v[144:147], v[108:111]
    s_waitcnt lgkmcnt(0)
    v_pk_mul_f16 v128, v128, v80
    v_fma_f32 v185, |v101|, v73, v185
    v_mfma_f32_16x16x32_f16 v[112:115], a[48:51], v[144:147], v[28:31]
    v_pk_mul_f16 v129, v129, v81
    v_fma_f32 v185, |v102|, v74, v185
    v_mfma_f32_16x16x32_f16 v[112:115], a[52:55], v[148:151], v[112:115]
    v_pk_mul_f16 v130, v130, v82
    v_fma_f32 v185, |v103|, v75, v185
    v_mfma_f32_16x16x32_f16 v[112:115], a[56:59], v[152:155], v[112:115]
    v_pk_mul_f16 v131, v131, v83
    v_fma_f32 v185, |v104|, v68, v185
    v_mfma_f32_16x16x32_f16 v[112:115], a[60:63], v[156:159], v[112:115]
    v_pk_mul_f16 v132, v132, v84
    v_fma_f32 v185, |v105|, v69, v185
    v_mfma_f32_16x16x32_f16 v[116:119], a[44:47], v[156:159], v[24:27]
    v_pk_mul_f16 v133, v133, v85
    v_fma_f32 v185, |v106|, v70, v185
    v_mfma_f32_16x16x32_f16 v[116:119], a[40:43], v[152:155], v[116:119]
    v_pk_mul_f16 v134, v134, v86
    v_fma_f32 v185, |v107|, v71, v185
    v_mfma_f32_16x16x32_f16 v[116:119], a[36:39], v[148:151], v[116:119]
    v_pk_mul_f16 v135, v135, v87
    v_fma_f32 v185, |v108|, v64, v185
    v_mfma_f32_16x16x32_f16 v[116:119], a[32:35], v[144:147], v[116:119]
    v_pk_mul_f16 v136, v136, v88
    v_fma_f32 v185, |v109|, v65, v185
    v_mfma_f32_16x16x32_f16 v[120:123], a[16:19], v[144:147], v[20:23]
    v_pk_mul_f16 v137, v137, v89
    v_fma_f32 v185, |v110|, v66, v185
    v_mfma_f32_16x16x32_f16 v[120:123], a[20:23], v[148:151], v[120:123]
    v_pk_mul_f16 v138, v138, v90
    v_fma_f32 v185, |v111|, v67, v185
    v_mfma_f32_16x16x32_f16 v[120:123], a[24:27], v[152:155], v[120:123]
    v_pk_mul_f16 v139, v139, v91
    v_fma_f32 v185, |v112|, v60, v185
    v_mfma_f32_16x16x32_f16 v[120:123], a[28:31], v[156:159], v[120:123]
    v_pk_mul_f16 v140, v140, v92
    v_fma_f32 v185, |v113|, v61, v185
    v_mfma_f32_16x16x32_f16 v[124:127], a[12:15], v[156:159], v[16:19]
    v_pk_mul_f16 v141, v141, v93
    v_fma_f32 v185, |v114|, v62, v185
    v_mfma_f32_16x16x32_f16 v[124:127], a[8:11], v[152:155], v[124:127]
    v_pk_mul_f16 v142, v142, v94
    v_fma_f32 v185, |v115|, v63, v185
    v_mfma_f32_16x16x32_f16 v[124:127], a[4:7], v[148:151], v[124:127]
    v_pk_mul_f16 v143, v143, v95
    v_fma_f32 v185, |v116|, v56, v185
    v_mfma_f32_16x16x32_f16 v[124:127], a[0:3], v[144:147], v[124:127]
    v_mov_b32_dpp v247, v246 row_ror:12 row_mask:0xf bank_mask:0xf
    v_fma_f32 v185, |v117|, v57, v185
    v_mfma_f32_16x16x32_f16 v[96:99], a[0:3], v[128:131], v[16:19]
    ds_read_b128 v[156:159], v247 offset:192
    v_fma_f32 v185, |v118|, v58, v185
    v_mfma_f32_16x16x32_f16 v[96:99], a[4:7], v[132:135], v[96:99]
    ds_read_b128 v[152:155], v247 offset:128
    v_fma_f32 v185, |v119|, v59, v185
    v_mfma_f32_16x16x32_f16 v[96:99], a[8:11], v[136:139], v[96:99]
    ds_read_b128 v[148:151], v247 offset:64
    v_fma_f32 v185, |v120|, v52, v185
    v_mfma_f32_16x16x32_f16 v[96:99], a[12:15], v[140:143], v[96:99]
    ds_read_b128 v[144:147], v247 offset:0
    v_fma_f32 v185, |v121|, v53, v185
    v_mfma_f32_16x16x32_f16 v[100:103], a[28:31], v[140:143], v[20:23]
    v_add_u32_sdwa v227, v163, s49 dst_sel:WORD_1 dst_unused:UNUSED_PAD src0_sel:WORD_1 src1_sel:DWORD
    v_fma_f32 v185, |v122|, v54, v185
    v_mfma_f32_16x16x32_f16 v[100:103], a[24:27], v[136:139], v[100:103]
    v_cvt_pkrtz_f16_f32 v204, v220, v221
    v_fma_f32 v185, |v123|, v55, v185
    v_mfma_f32_16x16x32_f16 v[100:103], a[20:23], v[132:135], v[100:103]
    v_max3_f32 v248, v248, |v220|, |v221|
    v_fma_f32 v185, |v124|, v48, v185
    v_mfma_f32_16x16x32_f16 v[100:103], a[16:19], v[128:131], v[100:103]
    v_cvt_pkrtz_f16_f32 v205, v222, v223
    v_fma_f32 v185, |v125|, v49, v185
    v_mfma_f32_16x16x32_f16 v[104:107], a[32:35], v[128:131], v[24:27]
    v_max3_f32 v249, v249, |v222|, |v223|
    v_fma_f32 v185, |v126|, v50, v185
    v_mfma_f32_16x16x32_f16 v[104:107], a[36:39], v[132:135], v[104:107]
    v_cvt_pkrtz_f16_f32 v206, v224, v225
    v_fma_f32 v185, |v127|, v51, v185
    v_mfma_f32_16x16x32_f16 v[104:107], a[40:43], v[136:139], v[104:107]
    v_max3_f32 v248, v248, |v224|, |v225|
    v_mul_f32 v186, |v96|, v48
    v_mfma_f32_16x16x32_f16 v[104:107], a[44:47], v[140:143], v[104:107]
    v_cvt_pkrtz_f16_f32 v207, v226, v227
    v_fma_f32 v186, |v97|, v49, v186
    v_mfma_f32_16x16x32_f16 v[108:111], a[60:63], v[140:143], v[28:31]
    v_max3_f32 v249, v249, |v226|, |v227|
    v_fma_f32 v186, |v98|, v50, v186
    v_mfma_f32_16x16x32_f16 v[108:111], a[56:59], v[136:139], v[108:111]
    ds_write_b128 v203, v[204:207] offset:4608
    v_mfma_f32_16x16x32_f16 v[108:111], a[52:55], v[132:135], v[108:111]
    s_waitcnt vmcnt(3)
    v_lshl_add_u32 v220, v164, 16, s48
    v_fma_f32 v186, |v99|, v51, v186
    v_mfma_f32_16x16x32_f16 v[108:111], a[48:51], v[128:131], v[108:111]
    s_waitcnt lgkmcnt(1)
    v_pk_mul_f16 v144, v144, v80
    v_fma_f32 v186, |v100|, v52, v186
    v_mfma_f32_16x16x32_f16 v[112:115], a[64:67], v[128:131], v[32:35]
    v_pk_mul_f16 v145, v145, v81
    v_fma_f32 v186, |v101|, v53, v186
    v_mfma_f32_16x16x32_f16 v[112:115], a[68:71], v[132:135], v[112:115]
    v_pk_mul_f16 v146, v146, v82
    v_fma_f32 v186, |v102|, v54, v186
    v_mfma_f32_16x16x32_f16 v[112:115], a[72:75], v[136:139], v[112:115]
    v_pk_mul_f16 v147, v147, v83
    v_fma_f32 v186, |v103|, v55, v186
    v_mfma_f32_16x16x32_f16 v[112:115], a[76:79], v[140:143], v[112:115]
    v_pk_mul_f16 v148, v148, v84
    v_fma_f32 v186, |v104|, v56, v186
    v_mfma_f32_16x16x32_f16 v[116:119], a[92:95], v[140:143], v[36:39]
    v_pk_mul_f16 v149, v149, v85
    v_fma_f32 v186, |v105|, v57, v186
    v_mfma_f32_16x16x32_f16 v[116:119], a[88:91], v[136:139], v[116:119]
    v_pk_mul_f16 v150, v150, v86
    v_fma_f32 v186, |v106|, v58, v186
    v_mfma_f32_16x16x32_f16 v[116:119], a[84:87], v[132:135], v[116:119]
    v_pk_mul_f16 v151, v151, v87
    v_fma_f32 v186, |v107|, v59, v186
    v_mfma_f32_16x16x32_f16 v[116:119], a[80:83], v[128:131], v[116:119]
    v_pk_mul_f16 v152, v152, v88
    v_fma_f32 v186, |v108|, v60, v186
    v_mfma_f32_16x16x32_f16 v[120:123], a[96:99], v[128:131], v[40:43]
    v_pk_mul_f16 v153, v153, v89
    v_fma_f32 v186, |v109|, v61, v186
    v_mfma_f32_16x16x32_f16 v[120:123], a[100:103], v[132:135], v[120:123]
    v_pk_mul_f16 v154, v154, v90
    v_fma_f32 v186, |v110|, v62, v186
    v_mfma_f32_16x16x32_f16 v[120:123], a[104:107], v[136:139], v[120:123]
    v_pk_mul_f16 v155, v155, v91
    v_fma_f32 v186, |v111|, v63, v186
    v_mfma_f32_16x16x32_f16 v[120:123], a[108:111], v[140:143], v[120:123]
    v_pk_mul_f16 v156, v156, v92
    v_fma_f32 v186, |v112|, v64, v186
    v_mfma_f32_16x16x32_f16 v[124:127], a[124:127], v[140:143], v[44:47]
    v_pk_mul_f16 v157, v157, v93
    v_fma_f32 v186, |v113|, v65, v186
    v_mfma_f32_16x16x32_f16 v[124:127], a[120:123], v[136:139], v[124:127]
    v_pk_mul_f16 v158, v158, v94
    v_fma_f32 v186, |v114|, v66, v186
    v_mfma_f32_16x16x32_f16 v[124:127], a[116:119], v[132:135], v[124:127]
    v_pk_mul_f16 v159, v159, v95
    v_fma_f32 v186, |v115|, v67, v186
    v_mfma_f32_16x16x32_f16 v[124:127], a[112:115], v[128:131], v[124:127]
    v_mov_b32_dpp v247, v246 row_ror:11 row_mask:0xf bank_mask:0xf
    v_fma_f32 v186, |v116|, v68, v186
    v_mfma_f32_16x16x32_f16 v[96:99], a[112:115], v[144:147], v[44:47]
    ds_read_b128 v[140:143], v247 offset:192
    v_fma_f32 v186, |v117|, v69, v186
    v_mfma_f32_16x16x32_f16 v[96:99], a[116:119], v[148:151], v[96:99]
    ds_read_b128 v[136:139], v247 offset:128
    v_fma_f32 v186, |v118|, v70, v186
    v_mfma_f32_16x16x32_f16 v[96:99], a[120:123], v[152:155], v[96:99]
    ds_read_b128 v[132:135], v247 offset:64
    v_fma_f32 v186, |v119|, v71, v186
    v_mfma_f32_16x16x32_f16 v[96:99], a[124:127], v[156:159], v[96:99]
    ds_read_b128 v[128:131], v247 offset:0
    v_fma_f32 v186, |v120|, v72, v186
    v_mfma_f32_16x16x32_f16 v[100:103], a[108:111], v[156:159], v[40:43]
    v_add_u32_sdwa v221, v164, s49 dst_sel:WORD_1 dst_unused:UNUSED_PAD src0_sel:WORD_1 src1_sel:DWORD
    v_fma_f32 v186, |v121|, v73, v186
    v_mfma_f32_16x16x32_f16 v[100:103], a[104:107], v[152:155], v[100:103]
    v_lshl_add_u32 v222, v165, 16, s48
    v_fma_f32 v186, |v122|, v74, v186
    v_mfma_f32_16x16x32_f16 v[100:103], a[100:103], v[148:151], v[100:103]
    v_add_u32_sdwa v223, v165, s49 dst_sel:WORD_1 dst_unused:UNUSED_PAD src0_sel:WORD_1 src1_sel:DWORD
    v_fma_f32 v186, |v123|, v75, v186
    v_mfma_f32_16x16x32_f16 v[100:103], a[96:99], v[144:147], v[100:103]
    v_lshl_add_u32 v224, v166, 16, s48
    v_fma_f32 v186, |v124|, v76, v186
    v_mfma_f32_16x16x32_f16 v[104:107], a[80:83], v[144:147], v[36:39]
    v_add_u32_sdwa v225, v166, s49 dst_sel:WORD_1 dst_unused:UNUSED_PAD src0_sel:WORD_1 src1_sel:DWORD
    v_fma_f32 v186, |v125|, v77, v186
    v_mfma_f32_16x16x32_f16 v[104:107], a[84:87], v[148:151], v[104:107]
    v_lshl_add_u32 v226, v167, 16, s48
    v_fma_f32 v186, |v126|, v78, v186
    v_mfma_f32_16x16x32_f16 v[104:107], a[88:91], v[152:155], v[104:107]
    v_add_u32_sdwa v227, v167, s49 dst_sel:WORD_1 dst_unused:UNUSED_PAD src0_sel:WORD_1 src1_sel:DWORD
    v_fma_f32 v186, |v127|, v79, v186
    v_mfma_f32_16x16x32_f16 v[104:107], a[92:95], v[156:159], v[104:107]
    v_cvt_pkrtz_f16_f32 v208, v220, v221
    v_mul_f32 v187, |v96|, v76
    v_mfma_f32_16x16x32_f16 v[108:111], a[76:79], v[156:159], v[32:35]
    v_max3_f32 v248, v248, |v220|, |v221|
    v_fma_f32 v187, |v97|, v77, v187
    v_mfma_f32_16x16x32_f16 v[108:111], a[72:75], v[152:155], v[108:111]
    v_cvt_pkrtz_f16_f32 v209, v222, v223
    v_fma_f32 v187, |v98|, v78, v187
    v_mfma_f32_16x16x32_f16 v[108:111], a[68:71], v[148:151], v[108:111]
    v_max3_f32 v249, v249, |v222|, |v223|
    v_fma_f32 v187, |v99|, v79, v187
    v_mfma_f32_16x16x32_f16 v[108:111], a[64:67], v[144:147], v[108:111]
    s_waitcnt lgkmcnt(0)
    v_pk_mul_f16 v128, v128, v80
    v_fma_f32 v187, |v100|, v72, v187
    v_mfma_f32_16x16x32_f16 v[112:115], a[48:51], v[144:147], v[28:31]
    v_pk_mul_f16 v129, v129, v81
    v_fma_f32 v187, |v101|, v73, v187
    v_mfma_f32_16x16x32_f16 v[112:115], a[52:55], v[148:151], v[112:115]
    v_pk_mul_f16 v130, v130, v82
    v_fma_f32 v187, |v102|, v74, v187
    v_mfma_f32_16x16x32_f16 v[112:115], a[56:59], v[152:155], v[112:115]
    v_pk_mul_f16 v131, v131, v83
    v_fma_f32 v187, |v103|, v75, v187
    v_mfma_f32_16x16x32_f16 v[112:115], a[60:63], v[156:159], v[112:115]
    v_pk_mul_f16 v132, v132, v84
    v_fma_f32 v187, |v104|, v68, v187
    v_mfma_f32_16x16x32_f16 v[116:119], a[44:47], v[156:159], v[24:27]
    v_pk_mul_f16 v133, v133, v85
    v_fma_f32 v187, |v105|, v69, v187
    v_mfma_f32_16x16x32_f16 v[116:119], a[40:43], v[152:155], v[116:119]
    v_pk_mul_f16 v134, v134, v86
    v_fma_f32 v187, |v106|, v70, v187
    v_mfma_f32_16x16x32_f16 v[116:119], a[36:39], v[148:151], v[116:119]
    v_pk_mul_f16 v135, v135, v87
    v_fma_f32 v187, |v107|, v71, v187
    v_mfma_f32_16x16x32_f16 v[116:119], a[32:35], v[144:147], v[116:119]
    v_pk_mul_f16 v136, v136, v88
    v_fma_f32 v187, |v108|, v64, v187
    v_mfma_f32_16x16x32_f16 v[120:123], a[16:19], v[144:147], v[20:23]
    v_pk_mul_f16 v137, v137, v89
    v_fma_f32 v187, |v109|, v65, v187
    v_mfma_f32_16x16x32_f16 v[120:123], a[20:23], v[148:151], v[120:123]
    v_pk_mul_f16 v138, v138, v90
    v_fma_f32 v187, |v110|, v66, v187
    v_mfma_f32_16x16x32_f16 v[120:123], a[24:27], v[152:155], v[120:123]
    v_pk_mul_f16 v139, v139, v91
    v_fma_f32 v187, |v111|, v67, v187
    v_mfma_f32_16x16x32_f16 v[120:123], a[28:31], v[156:159], v[120:123]
    v_pk_mul_f16 v140, v140, v92
    v_fma_f32 v187, |v112|, v60, v187
    v_mfma_f32_16x16x32_f16 v[124:127], a[12:15], v[156:159], v[16:19]
    v_pk_mul_f16 v141, v141, v93
    v_fma_f32 v187, |v113|, v61, v187
    v_mfma_f32_16x16x32_f16 v[124:127], a[8:11], v[152:155], v[124:127]
    v_pk_mul_f16 v142, v142, v94
    v_fma_f32 v187, |v114|, v62, v187
    v_mfma_f32_16x16x32_f16 v[124:127], a[4:7], v[148:151], v[124:127]
    v_pk_mul_f16 v143, v143, v95
    v_fma_f32 v187, |v115|, v63, v187
    v_mfma_f32_16x16x32_f16 v[124:127], a[0:3], v[144:147], v[124:127]
    v_mov_b32_dpp v247, v246 row_ror:10 row_mask:0xf bank_mask:0xf
    v_fma_f32 v187, |v116|, v56, v187
    v_mfma_f32_16x16x32_f16 v[96:99], a[0:3], v[128:131], v[16:19]
    ds_read_b128 v[156:159], v247 offset:192
    v_fma_f32 v187, |v117|, v57, v187
    v_mfma_f32_16x16x32_f16 v[96:99], a[4:7], v[132:135], v[96:99]
    ds_read_b128 v[152:155], v247 offset:128
    v_fma_f32 v187, |v118|, v58, v187
    v_mfma_f32_16x16x32_f16 v[96:99], a[8:11], v[136:139], v[96:99]
    ds_read_b128 v[148:151], v247 offset:64
    v_fma_f32 v187, |v119|, v59, v187
    v_mfma_f32_16x16x32_f16 v[96:99], a[12:15], v[140:143], v[96:99]
    ds_read_b128 v[144:147], v247 offset:0
    v_fma_f32 v187, |v120|, v52, v187
    v_mfma_f32_16x16x32_f16 v[100:103], a[28:31], v[140:143], v[20:23]
    v_cvt_pkrtz_f16_f32 v210, v224, v225
    v_fma_f32 v187, |v121|, v53, v187
    v_mfma_f32_16x16x32_f16 v[100:103], a[24:27], v[136:139], v[100:103]
    v_max3_f32 v248, v248, |v224|, |v225|
    v_fma_f32 v187, |v122|, v54, v187
    v_mfma_f32_16x16x32_f16 v[100:103], a[20:23], v[132:135], v[100:103]
    v_cvt_pkrtz_f16_f32 v211, v226, v227
    v_fma_f32 v187, |v123|, v55, v187
    v_mfma_f32_16x16x32_f16 v[100:103], a[16:19], v[128:131], v[100:103]
    v_max3_f32 v249, v249, |v226|, |v227|
    v_fma_f32 v187, |v124|, v48, v187
    v_mfma_f32_16x16x32_f16 v[104:107], a[32:35], v[128:131], v[24:27]
    ds_write_b128 v203, v[208:211] offset:5472
    v_mfma_f32_16x16x32_f16 v[104:107], a[36:39], v[132:135], v[104:107]
    s_waitcnt vmcnt(2)
    v_lshl_add_u32 v220, v168, 16, s48
    v_fma_f32 v187, |v125|, v49, v187
    v_mfma_f32_16x16x32_f16 v[104:107], a[40:43], v[136:139], v[104:107]
    v_add_u32_sdwa v221, v168, s49 dst_sel:WORD_1 dst_unused:UNUSED_PAD src0_sel:WORD_1 src1_sel:DWORD
    v_fma_f32 v187, |v126|, v50, v187
    v_mfma_f32_16x16x32_f16 v[104:107], a[44:47], v[140:143], v[104:107]
    v_lshl_add_u32 v222, v169, 16, s48
    v_fma_f32 v187, |v127|, v51, v187
    v_mfma_f32_16x16x32_f16 v[108:111], a[60:63], v[140:143], v[28:31]
    v_add_u32_sdwa v223, v169, s49 dst_sel:WORD_1 dst_unused:UNUSED_PAD src0_sel:WORD_1 src1_sel:DWORD
    v_mul_f32 v188, |v96|, v48
    v_mfma_f32_16x16x32_f16 v[108:111], a[56:59], v[136:139], v[108:111]
    v_lshl_add_u32 v224, v170, 16, s48
    v_fma_f32 v188, |v97|, v49, v188
    v_mfma_f32_16x16x32_f16 v[108:111], a[52:55], v[132:135], v[108:111]
    v_add_u32_sdwa v225, v170, s49 dst_sel:WORD_1 dst_unused:UNUSED_PAD src0_sel:WORD_1 src1_sel:DWORD
    v_fma_f32 v188, |v98|, v50, v188
    v_mfma_f32_16x16x32_f16 v[108:111], a[48:51], v[128:131], v[108:111]
    s_waitcnt lgkmcnt(1)
    v_pk_mul_f16 v144, v144, v80
    v_fma_f32 v188, |v99|, v51, v188
    v_mfma_f32_16x16x32_f16 v[112:115], a[64:67], v[128:131], v[32:35]
    v_pk_mul_f16 v145, v145, v81
    v_fma_f32 v188, |v100|, v52, v188
    v_mfma_f32_16x16x32_f16 v[112:115], a[68:71], v[132:135], v[112:115]
    v_pk_mul_f16 v146, v146, v82
    v_fma_f32 v188, |v101|, v53, v188
    v_mfma_f32_16x16x32_f16 v[112:115], a[72:75], v[136:139], v[112:115]
    v_pk_mul_f16 v147, v147, v83
    v_fma_f32 v188, |v102|, v54, v188
    v_mfma_f32_16x16x32_f16 v[112:115], a[76:79], v[140:143], v[112:115]
    v_pk_mul_f16 v148, v148, v84
    v_fma_f32 v188, |v103|, v55, v188
    v_mfma_f32_16x16x32_f16 v[116:119], a[92:95], v[140:143], v[36:39]
    v_pk_mul_f16 v149, v149, v85
    v_fma_f32 v188, |v104|, v56, v188
    v_mfma_f32_16x16x32_f16 v[116:119], a[88:91], v[136:139], v[116:119]
    v_pk_mul_f16 v150, v150, v86
    v_fma_f32 v188, |v105|, v57, v188
    v_mfma_f32_16x16x32_f16 v[116:119], a[84:87], v[132:135], v[116:119]
    v_pk_mul_f16 v151, v151, v87
    v_fma_f32 v188, |v106|, v58, v188
    v_mfma_f32_16x16x32_f16 v[116:119], a[80:83], v[128:131], v[116:119]
    v_pk_mul_f16 v152, v152, v88
    v_fma_f32 v188, |v107|, v59, v188
    v_mfma_f32_16x16x32_f16 v[120:123], a[96:99], v[128:131], v[40:43]
    v_pk_mul_f16 v153, v153, v89
    v_fma_f32 v188, |v108|, v60, v188
    v_mfma_f32_16x16x32_f16 v[120:123], a[100:103], v[132:135], v[120:123]
    v_pk_mul_f16 v154, v154, v90
    v_fma_f32 v188, |v109|, v61, v188
    v_mfma_f32_16x16x32_f16 v[120:123], a[104:107], v[136:139], v[120:123]
    v_pk_mul_f16 v155, v155, v91
    v_fma_f32 v188, |v110|, v62, v188
    v_mfma_f32_16x16x32_f16 v[120:123], a[108:111], v[140:143], v[120:123]
    v_pk_mul_f16 v156, v156, v92
    v_fma_f32 v188, |v111|, v63, v188
    v_mfma_f32_16x16x32_f16 v[124:127], a[124:127], v[140:143], v[44:47]
    v_pk_mul_f16 v157, v157, v93
    v_fma_f32 v188, |v112|, v64, v188
    v_mfma_f32_16x16x32_f16 v[124:127], a[120:123], v[136:139], v[124:127]
    v_pk_mul_f16 v158, v158, v94
    v_fma_f32 v188, |v113|, v65, v188
    v_mfma_f32_16x16x32_f16 v[124:127], a[116:119], v[132:135], v[124:127]
    v_pk_mul_f16 v159, v159, v95
    v_fma_f32 v188, |v114|, v66, v188
    v_mfma_f32_16x16x32_f16 v[124:127], a[112:115], v[128:131], v[124:127]
    v_mov_b32_dpp v247, v246 row_ror:9 row_mask:0xf bank_mask:0xf
    v_fma_f32 v188, |v115|, v67, v188
    v_mfma_f32_16x16x32_f16 v[96:99], a[112:115], v[144:147], v[44:47]
    ds_read_b128 v[140:143], v247 offset:192
    v_fma_f32 v188, |v116|, v68, v188
    v_mfma_f32_16x16x32_f16 v[96:99], a[116:119], v[148:151], v[96:99]
    ds_read_b128 v[136:139], v247 offset:128
    v_fma_f32 v188, |v117|, v69, v188
    v_mfma_f32_16x16x32_f16 v[96:99], a[120:123], v[152:155], v[96:99]
    ds_read_b128 v[132:135], v247 offset:64
    v_fma_f32 v188, |v118|, v70, v188
    v_mfma_f32_16x16x32_f16 v[96:99], a[124:127], v[156:159], v[96:99]
    ds_read_b128 v[128:131], v247 offset:0
    v_fma_f32 v188, |v119|, v71, v188
    v_mfma_f32_16x16x32_f16 v[100:103], a[108:111], v[156:159], v[40:43]
    v_lshl_add_u32 v226, v171, 16, s48
    v_fma_f32 v188, |v120|, v72, v188
    v_mfma_f32_16x16x32_f16 v[100:103], a[104:107], v[152:155], v[100:103]
    v_add_u32_sdwa v227, v171, s49 dst_sel:WORD_1 dst_unused:UNUSED_PAD src0_sel:WORD_1 src1_sel:DWORD
    v_fma_f32 v188, |v121|, v73, v188
    v_mfma_f32_16x16x32_f16 v[100:103], a[100:103], v[148:151], v[100:103]
    v_cvt_pkrtz_f16_f32 v212, v220, v221
    v_fma_f32 v188, |v122|, v74, v188
    v_mfma_f32_16x16x32_f16 v[100:103], a[96:99], v[144:147], v[100:103]
    v_max3_f32 v248, v248, |v220|, |v221|
    v_fma_f32 v188, |v123|, v75, v188
    v_mfma_f32_16x16x32_f16 v[104:107], a[80:83], v[144:147], v[36:39]
    v_cvt_pkrtz_f16_f32 v213, v222, v223
    v_fma_f32 v188, |v124|, v76, v188
    v_mfma_f32_16x16x32_f16 v[104:107], a[84:87], v[148:151], v[104:107]
    v_max3_f32 v249, v249, |v222|, |v223|
    v_fma_f32 v188, |v125|, v77, v188
    v_mfma_f32_16x16x32_f16 v[104:107], a[88:91], v[152:155], v[104:107]
    v_cvt_pkrtz_f16_f32 v214, v224, v225
    v_fma_f32 v188, |v126|, v78, v188
    v_mfma_f32_16x16x32_f16 v[104:107], a[92:95], v[156:159], v[104:107]
    v_max3_f32 v248, v248, |v224|, |v225|
    v_fma_f32 v188, |v127|, v79, v188
    v_mfma_f32_16x16x32_f16 v[108:111], a[76:79], v[156:159], v[32:35]
    v_cvt_pkrtz_f16_f32 v215, v226, v227
    v_mul_f32 v189, |v96|, v76
    v_mfma_f32_16x16x32_f16 v[108:111], a[72:75], v[152:155], v[108:111]
    v_max3_f32 v249, v249, |v226|, |v227|
    v_fma_f32 v189, |v97|, v77, v189
    v_mfma_f32_16x16x32_f16 v[108:111], a[68:71], v[148:151], v[108:111]
    ds_write_b128 v203, v[212:215] offset:6336
    v_mfma_f32_16x16x32_f16 v[108:111], a[64:67], v[144:147], v[108:111]
    s_waitcnt lgkmcnt(1)
    v_pk_mul_f16 v128, v128, v80
    v_fma_f32 v189, |v98|, v78, v189
    v_mfma_f32_16x16x32_f16 v[112:115], a[48:51], v[144:147], v[28:31]
    v_pk_mul_f16 v129, v129, v81
    v_fma_f32 v189, |v99|, v79, v189
    v_mfma_f32_16x16x32_f16 v[112:115], a[52:55], v[148:151], v[112:115]
    v_pk_mul_f16 v130, v130, v82
    v_fma_f32 v189, |v100|, v72, v189
    v_mfma_f32_16x16x32_f16 v[112:115], a[56:59], v[152:155], v[112:115]
    v_pk_mul_f16 v131, v131, v83
    v_fma_f32 v189, |v101|, v73, v189
    v_mfma_f32_16x16x32_f16 v[112:115], a[60:63], v[156:159], v[112:115]
    v_pk_mul_f16 v132, v132, v84
    v_fma_f32 v189, |v102|, v74, v189
    v_mfma_f32_16x16x32_f16 v[116:119], a[44:47], v[156:159], v[24:27]
    v_pk_mul_f16 v133, v133, v85
    v_fma_f32 v189, |v103|, v75, v189
    v_mfma_f32_16x16x32_f16 v[116:119], a[40:43], v[152:155], v[116:119]
    v_pk_mul_f16 v134, v134, v86
    v_fma_f32 v189, |v104|, v68, v189
    v_mfma_f32_16x16x32_f16 v[116:119], a[36:39], v[148:151], v[116:119]
    v_pk_mul_f16 v135, v135, v87
    v_fma_f32 v189, |v105|, v69, v189
    v_mfma_f32_16x16x32_f16 v[116:119], a[32:35], v[144:147], v[116:119]
    v_pk_mul_f16 v136, v136, v88
    v_fma_f32 v189, |v106|, v70, v189
    v_mfma_f32_16x16x32_f16 v[120:123], a[16:19], v[144:147], v[20:23]
    v_pk_mul_f16 v137, v137, v89
    v_fma_f32 v189, |v107|, v71, v189
    v_mfma_f32_16x16x32_f16 v[120:123], a[20:23], v[148:151], v[120:123]
    v_pk_mul_f16 v138, v138, v90
    v_fma_f32 v189, |v108|, v64, v189
    v_mfma_f32_16x16x32_f16 v[120:123], a[24:27], v[152:155], v[120:123]
    v_pk_mul_f16 v139, v139, v91
    v_fma_f32 v189, |v109|, v65, v189
    v_mfma_f32_16x16x32_f16 v[120:123], a[28:31], v[156:159], v[120:123]
    v_pk_mul_f16 v140, v140, v92
    v_fma_f32 v189, |v110|, v66, v189
    v_mfma_f32_16x16x32_f16 v[124:127], a[12:15], v[156:159], v[16:19]
    v_pk_mul_f16 v141, v141, v93
    v_fma_f32 v189, |v111|, v67, v189
    v_mfma_f32_16x16x32_f16 v[124:127], a[8:11], v[152:155], v[124:127]
    v_pk_mul_f16 v142, v142, v94
    v_fma_f32 v189, |v112|, v60, v189
    v_mfma_f32_16x16x32_f16 v[124:127], a[4:7], v[148:151], v[124:127]
    v_pk_mul_f16 v143, v143, v95
    v_fma_f32 v189, |v113|, v61, v189
    v_mfma_f32_16x16x32_f16 v[124:127], a[0:3], v[144:147], v[124:127]
    v_max_f32 v248, v248, v249
    v_fma_f32 v189, |v114|, v62, v189
    v_mfma_f32_16x16x32_f16 v[96:99], a[0:3], v[128:131], v[16:19]
    ds_read_b128 v[156:159], v200 offset:192
    v_fma_f32 v189, |v115|, v63, v189
    v_mfma_f32_16x16x32_f16 v[96:99], a[4:7], v[132:135], v[96:99]
    ds_read_b128 v[152:155], v200 offset:128
    v_fma_f32 v189, |v116|, v56, v189
    v_mfma_f32_16x16x32_f16 v[96:99], a[8:11], v[136:139], v[96:99]
    ds_read_b128 v[148:151], v200 offset:64
    v_fma_f32 v189, |v117|, v57, v189
    v_mfma_f32_16x16x32_f16 v[96:99], a[12:15], v[140:143], v[96:99]
    ds_read_b128 v[144:147], v200 offset:0
    v_fma_f32 v189, |v118|, v58, v189
    v_mfma_f32_16x16x32_f16 v[100:103], a[28:31], v[140:143], v[20:23]
    v_cmp_le_f32 vcc, s50, v248
    v_fma_f32 v189, |v119|, v59, v189
    v_mfma_f32_16x16x32_f16 v[100:103], a[24:27], v[136:139], v[100:103]
    v_cmp_nlt_f32 s[92:93], v248, s51
    v_fma_f32 v189, |v120|, v52, v189
    v_mfma_f32_16x16x32_f16 v[100:103], a[20:23], v[132:135], v[100:103]
    s_cbranch_vccnz L_efix
    v_mfma_f32_16x16x32_f16 v[100:103], a[16:19], v[128:131], v[100:103]
    s_cmp_eq_u64 s[92:93], 0
    s_cbranch_scc1 L_efix
    v_mfma_f32_16x16x32_f16 v[104:107], a[32:35], v[128:131], v[24:27]
    ds_read_b128 v[204:207], v202 offset:4608
    v_fma_f32 v189, |v121|, v53, v189
    v_mfma_f32_16x16x32_f16 v[104:107], a[36:39], v[132:135], v[104:107]
    ds_read_b128 v[208:211], v202 offset:4672
    v_fma_f32 v189, |v122|, v54, v189
    v_mfma_f32_16x16x32_f16 v[104:107], a[40:43], v[136:139], v[104:107]
    ds_read_b128 v[212:215], v202 offset:4736
    v_fma_f32 v189, |v123|, v55, v189
    v_mfma_f32_16x16x32_f16 v[104:107], a[44:47], v[140:143], v[104:107]
    ds_read_b128 v[216:219], v202 offset:4800
    v_fma_f32 v189, |v124|, v48, v189
    v_mfma_f32_16x16x32_f16 v[108:111], a[60:63], v[140:143], v[28:31]
    s_waitcnt vmcnt(0)
    v_add_u32_sdwa v11, v238, s5 dst_sel:DWORD dst_unused:UNUSED_PAD src0_sel:WORD_1 src1_sel:DWORD
    v_fma_f32 v189, |v125|, v49, v189
    v_mfma_f32_16x16x32_f16 v[108:111], a[56:59], v[136:139], v[108:111]
L_pad1:
    s_cbranch_execz L_hopret
    v_add_u32_sdwa v238, v238, s5 dst_sel:DWORD dst_unused:UNUSED_PAD src0_sel:WORD_0 src1_sel:DWORD
    v_fma_f32 v189, |v126|, v50, v189
    v_mfma_f32_16x16x32_f16 v[108:111], a[52:55], v[132:135], v[108:111]
    v_max_u32_dpp v254, v254, v254 row_ror:4 row_mask:0xf bank_mask:0xf
    v_fma_f32 v189, |v127|, v51, v189
    v_mfma_f32_16x16x32_f16 v[108:111], a[48:51], v[128:131], v[108:111]
    s_waitcnt lgkmcnt(4)
    v_pk_mul_f16 v144, v144, v80
    v_mul_f32 v190, |v96|, v48
    v_mfma_f32_16x16x32_f16 v[112:115], a[64:67], v[128:131], v[32:35]
    v_pk_mul_f16 v145, v145, v81
    v_fma_f32 v190, |v97|, v49, v190
    v_mfma_f32_16x16x32_f16 v[112:115], a[68:71], v[132:135], v[112:115]
    v_pk_mul_f16 v146, v146, v82
    v_fma_f32 v190, |v98|, v50, v190
    v_mfma_f32_16x16x32_f16 v[112:115], a[72:75], v[136:139], v[112:115]
    v_pk_mul_f16 v147, v147, v83
    v_fma_f32 v190, |v99|, v51, v190
    v_mfma_f32_16x16x32_f16 v[112:115], a[76:79], v[140:143], v[112:115]
    v_pk_mul_f16 v148, v148, v84
    v_fma_f32 v190, |v100|, v52, v190
    v_mfma_f32_16x16x32_f16 v[116:119], a[92:95], v[140:143], v[36:39]
    v_pk_mul_f16 v149, v149, v85
    v_fma_f32 v190, |v101|, v53, v190
    v_mfma_f32_16x16x32_f16 v[116:119], a[88:91], v[136:139], v[116:119]
    v_pk_mul_f16 v150, v150, v86
    v_fma_f32 v190, |v102|, v54, v190
    v_mfma_f32_16x16x32_f16 v[116:119], a[84:87], v[132:135], v[116:119]
    v_pk_mul_f16 v151, v151, v87
    v_fma_f32 v190, |v103|, v55, v190
    v_mfma_f32_16x16x32_f16 v[116:119], a[80:83], v[128:131], v[116:119]
    v_pk_mul_f16 v152, v152, v88
    v_fma_f32 v190, |v104|, v56, v190
    v_mfma_f32_16x16x32_f16 v[120:123], a[96:99], v[128:131], v[40:43]
    v_pk_mul_f16 v153, v153, v89
    v_fma_f32 v190, |v105|, v57, v190
    v_mfma_f32_16x16x32_f16 v[120:123], a[100:103], v[132:135], v[120:123]
    v_pk_mul_f16 v154, v154, v90
    v_fma_f32 v190, |v106|, v58, v190
    v_mfma_f32_16x16x32_f16 v[120:123], a[104:107], v[136:139], v[120:123]
    v_pk_mul_f16 v155, v155, v91
    v_fma_f32 v190, |v107|, v59, v190
    v_mfma_f32_16x16x32_f16 v[120:123], a[108:111], v[140:143], v[120:123]
    v_pk_mul_f16 v156, v156, v92
    v_fma_f32 v190, |v108|, v60, v190
    v_mfma_f32_16x16x32_f16 v[124:127], a[124:127], v[140:143], v[44:47]
    v_pk_mul_f16 v157, v157, v93
    v_fma_f32 v190, |v109|, v61, v190
    v_mfma_f32_16x16x32_f16 v[124:127], a[120:123], v[136:139], v[124:127]
    v_pk_mul_f16 v158, v158, v94
    v_fma_f32 v190, |v110|, v62, v190
    v_mfma_f32_16x16x32_f16 v[124:127], a[116:119], v[132:135], v[124:127]
    v_pk_mul_f16 v159, v159, v95
    v_fma_f32 v190, |v111|, v63, v190
    v_mfma_f32_16x16x32_f16 v[124:127], a[112:115], v[128:131], v[124:127]
    v_max_u32_dpp v255, v255, v255 row_ror:4 row_mask:0xf bank_mask:0xf
    v_fma_f32 v190, |v112|, v64, v190
    v_mfma_f32_16x16x32_f16 v[96:99], a[112:115], v[144:147], v[44:47]
    ds_read_b128 v[140:143], v245 offset:4800
    v_fma_f32 v190, |v113|, v65, v190
    v_mfma_f32_16x16x32_f16 v[96:99], a[116:119], v[148:151], v[96:99]
    ds_read_b128 v[136:139], v245 offset:4736
    v_fma_f32 v190, |v114|, v66, v190
    v_mfma_f32_16x16x32_f16 v[96:99], a[120:123], v[152:155], v[96:99]
    ds_read_b128 v[132:135], v245 offset:4672
    v_fma_f32 v190, |v115|, v67, v190
    v_mfma_f32_16x16x32_f16 v[96:99], a[124:127], v[156:159], v[96:99]
    ds_read_b128 v[128:131], v245 offset:4608
    v_fma_f32 v190, |v116|, v68, v190
    v_mfma_f32_16x16x32_f16 v[100:103], a[108:111], v[156:159], v[40:43]
    v_max_u32_dpp v254, v254, v254 row_ror:2 row_mask:0xf bank_mask:0xf
    v_fma_f32 v190, |v117|, v69, v190
    v_mfma_f32_16x16x32_f16 v[100:103], a[104:107], v[152:155], v[100:103]
    v_max_u32_dpp v255, v255, v255 row_ror:2 row_mask:0xf bank_mask:0xf
    v_fma_f32 v190, |v118|, v70, v190
    v_mfma_f32_16x16x32_f16 v[100:103], a[100:103], v[148:151], v[100:103]
    v_max_u32_dpp v254, v254, v254 row_ror:1 row_mask:0xf bank_mask:0xf
    v_fma_f32 v190, |v119|, v71, v190
    v_mfma_f32_16x16x32_f16 v[100:103], a[96:99], v[144:147], v[100:103]
    v_max_u32_dpp v255, v255, v255 row_ror:1 row_mask:0xf bank_mask:0xf
    v_fma_f32 v190, |v120|, v72, v190
    v_mfma_f32_16x16x32_f16 v[104:107], a[80:83], v[144:147], v[36:39]
    v_max_u32_dpp v254, v254, v254 row_bcast:15 row_mask:0xa bank_mask:0xf
    v_fma_f32 v190, |v121|, v73, v190
    v_mfma_f32_16x16x32_f16 v[104:107], a[84:87], v[148:151], v[104:107]
    v_max_u32_dpp v255, v255, v255 row_bcast:15 row_mask:0xa bank_mask:0xf
    v_fma_f32 v190, |v122|, v74, v190
    v_mfma_f32_16x16x32_f16 v[104:107], a[88:91], v[152:155], v[104:107]
    v_max_u32_dpp v254, v254, v254 row_bcast:31 row_mask:0xc bank_mask:0xf
    v_fma_f32 v190, |v123|, v75, v190
    v_mfma_f32_16x16x32_f16 v[104:107], a[92:95], v[156:159], v[104:107]
    v_max_u32_dpp v255, v255, v255 row_bcast:31 row_mask:0xc bank_mask:0xf
    v_fma_f32 v190, |v124|, v76, v190
    v_mfma_f32_16x16x32_f16 v[108:111], a[76:79], v[156:159], v[32:35]
    v_readlane_b32 s34, v254, 63
    v_fma_f32 v190, |v125|, v77, v190
    v_mfma_f32_16x16x32_f16 v[108:111], a[72:75], v[152:155], v[108:111]
    v_readlane_b32 s35, v255, 63
    s_bfe_u32 s34, s34, 0x80007
    v_fma_f32 v190, |v126|, v78, v190
    v_mfma_f32_16x16x32_f16 v[108:111], a[68:71], v[148:151], v[108:111]
    s_max_u32 s34, s34, 60
    s_waitcnt lgkmcnt(0)
    v_pk_mul_f16 v128, v128, v80
    v_fma_f32 v190, |v127|, v79, v190
    v_mfma_f32_16x16x32_f16 v[108:111], a[64:67], v[144:147], v[108:111]
    s_sub_u32 s11, s34, 134
    v_pk_mul_f16 v129, v129, v81
    v_mul_f32 v191, |v96|, v76
    v_mfma_f32_16x16x32_f16 v[112:115], a[48:51], v[144:147], v[28:31]
    s_sub_u32 s11, s11, s54
    v_pk_mul_f16 v130, v130, v82
    v_fma_f32 v191, |v97|, v77, v191
    v_mfma_f32_16x16x32_f16 v[112:115], a[52:55], v[148:151], v[112:115]
    s_sub_u32 s34, s34, 22
    v_pk_mul_f16 v131, v131, v83
    v_fma_f32 v191, |v98|, v78, v191
    v_mfma_f32_16x16x32_f16 v[112:115], a[56:59], v[152:155], v[112:115]
    s_mul_i32 s10, s34, 0x800080
    v_pk_mul_f16 v132, v132, v84
    v_fma_f32 v191, |v99|, v79, v191
    v_mfma_f32_16x16x32_f16 v[112:115], a[60:63], v[156:159], v[112:115]
    s_lshr_b32 s35, s35, 23
    v_pk_mul_f16 v133, v133, v85
    v_fma_f32 v191, |v100|, v72, v191
    v_mfma_f32_16x16x32_f16 v[116:119], a[44:47], v[156:159], v[24:27]
    s_max_u32 s35, s35, 60
    v_pk_mul_f16 v134, v134, v86
    v_fma_f32 v191, |v101|, v73, v191
    v_mfma_f32_16x16x32_f16 v[116:119], a[40:43], v[152:155], v[116:119]
    s_sub_u32 s34, 134, s35
    v_pk_mul_f16 v135, v135, v87
    v_fma_f32 v191, |v102|, v74, v191
    v_mfma_f32_16x16x32_f16 v[116:119], a[36:39], v[148:151], v[116:119]
    s_sub_u32 s35, s35, 7
    v_pk_mul_f16 v136, v136, v88
    v_fma_f32 v191, |v103|, v75, v191
    v_mfma_f32_16x16x32_f16 v[116:119], a[32:35], v[144:147], v[116:119]
    s_lshl_b32 s12, s35, 23
    v_and_b32 v254, s45, v252
    v_fma_f32 v191, |v104|, v68, v191
    v_mfma_f32_16x16x32_f16 v[120:123], a[16:19], v[144:147], v[20:23]
    v_pk_mul_f16 v137, v137, v89
    v_fma_f32 v191, |v105|, v69, v191
    v_mfma_f32_16x16x32_f16 v[120:123], a[20:23], v[148:151], v[120:123]
    v_pk_mul_f16 v138, v138, v90
    v_fma_f32 v191, |v106|, v70, v191
    v_mfma_f32_16x16x32_f16 v[120:123], a[24:27], v[152:155], v[120:123]
    v_pk_mul_f16 v139, v139, v91
    v_fma_f32 v191, |v107|, v71, v191
    v_mfma_f32_16x16x32_f16 v[120:123], a[28:31], v[156:159], v[120:123]
    v_pk_mul_f16 v140, v140, v92
    v_fma_f32 v191, |v108|, v64, v191
    v_mfma_f32_16x16x32_f16 v[124:127], a[12:15], v[156:159], v[16:19]
    v_pk_mul_f16 v141, v141, v93
    v_fma_f32 v191, |v109|, v65, v191
    v_mfma_f32_16x16x32_f16 v[124:127], a[8:11], v[152:155], v[124:127]
    v_pk_mul_f16 v142, v142, v94
    v_fma_f32 v191, |v110|, v66, v191
    v_mfma_f32_16x16x32_f16 v[124:127], a[4:7], v[148:151], v[124:127]
    v_pk_mul_f16 v143, v143, v95
    v_fma_f32 v191, |v111|, v67, v191
    v_mfma_f32_16x16x32_f16 v[124:127], a[0:3], v[144:147], v[124:127]
    v_ldexp_f32 v192, v192, s34
    v_fma_f32 v191, |v112|, v60, v191
    v_mfma_f32_16x16x32_f16 v[96:99], a[0:3], v[128:131], v[16:19]
    ds_read_b128 v[156:159], v245 offset:5088
    v_fma_f32 v191, |v113|, v61, v191
    v_mfma_f32_16x16x32_f16 v[96:99], a[4:7], v[132:135], v[96:99]
    ds_read_b128 v[152:155], v245 offset:5024
    v_fma_f32 v191, |v114|, v62, v191
    v_mfma_f32_16x16x32_f16 v[96:99], a[8:11], v[136:139], v[96:99]
    ds_read_b128 v[148:151], v245 offset:4960
    v_fma_f32 v191, |v115|, v63, v191
    v_mfma_f32_16x16x32_f16 v[96:99], a[12:15], v[140:143], v[96:99]
    ds_read_b128 v[144:147], v245 offset:4896
    v_fma_f32 v191, |v116|, v56, v191
    v_mfma_f32_16x16x32_f16 v[100:103], a[28:31], v[140:143], v[20:23]
    v_ldexp_f32 v193, v193, s34
    v_fma_f32 v191, |v117|, v57, v191
    v_mfma_f32_16x16x32_f16 v[100:103], a[24:27], v[136:139], v[100:103]
    v_pk_sub_u16 v253, v253, s10 clamp
    v_fma_f32 v191, |v118|, v58, v191
    v_mfma_f32_16x16x32_f16 v[100:103], a[20:23], v[132:135], v[100:103]
    v_cvt_pk_f16_f32 v192, v192, v193
    v_fma_f32 v191, |v119|, v59, v191
    v_mfma_f32_16x16x32_f16 v[100:103], a[16:19], v[128:131], v[100:103]
    v_lshl_or_b32 v253, v253, 3, v254
    v_fma_f32 v191, |v120|, v52, v191
    v_mfma_f32_16x16x32_f16 v[104:107], a[32:35], v[128:131], v[24:27]
    ds_write_b32 v11, v192 offset:9216
    v_mfma_f32_16x16x32_f16 v[104:107], a[36:39], v[132:135], v[104:107]
    ds_write_b32 v11, v253 offset:9504
    v_fma_f32 v191, |v121|, v53, v191
    v_mfma_f32_16x16x32_f16 v[104:107], a[40:43], v[136:139], v[104:107]
    ds_read_b128 v[172:175], v245 offset:9408
    v_fma_f32 v191, |v122|, v54, v191
    v_mfma_f32_16x16x32_f16 v[104:107], a[44:47], v[140:143], v[104:107]
    ds_read_b128 v[168:171], v245 offset:9344
    v_fma_f32 v191, |v123|, v55, v191
    v_mfma_f32_16x16x32_f16 v[108:111], a[60:63], v[140:143], v[28:31]
    ds_read_b128 v[164:167], v245 offset:9280
    v_fma_f32 v191, |v124|, v48, v191
    v_mfma_f32_16x16x32_f16 v[108:111], a[56:59], v[136:139], v[108:111]
    ds_read_b128 v[160:163], v245 offset:9216
    v_fma_f32 v191, |v125|, v49, v191
    v_mfma_f32_16x16x32_f16 v[108:111], a[52:55], v[132:135], v[108:111]
    s_waitcnt lgkmcnt(6)
    v_pk_mul_f16 v144, v144, v80
    v_fma_f32 v191, |v126|, v50, v191
    v_mfma_f32_16x16x32_f16 v[108:111], a[48:51], v[128:131], v[108:111]
    v_pk_mul_f16 v145, v145, v81
    v_fma_f32 v191, |v127|, v51, v191
    v_mfma_f32_16x16x32_f16 v[112:115], a[64:67], v[128:131], v[32:35]
    v_pk_mul_f16 v146, v146, v82
    v_mul_f32 v176, |v96|, v48
    v_mfma_f32_16x16x32_f16 v[112:115], a[68:71], v[132:135], v[112:115]
    v_pk_mul_f16 v147, v147, v83
    v_fma_f32 v176, |v97|, v49, v176
    v_mfma_f32_16x16x32_f16 v[112:115], a[72:75], v[136:139], v[112:115]
    v_pk_mul_f16 v148, v148, v84
    v_fma_f32 v176, |v98|, v50, v176
    v_mfma_f32_16x16x32_f16 v[112:115], a[76:79], v[140:143], v[112:115]
    v_pk_mul_f16 v149, v149, v85
    v_fma_f32 v176, |v99|, v51, v176
    v_mfma_f32_16x16x32_f16 v[116:119], a[92:95], v[140:143], v[36:39]
    v_pk_mul_f16 v150, v150, v86
    v_fma_f32 v176, |v100|, v52, v176
    v_mfma_f32_16x16x32_f16 v[116:119], a[88:91], v[136:139], v[116:119]
    v_pk_mul_f16 v151, v151, v87
    v_fma_f32 v176, |v101|, v53, v176
    v_mfma_f32_16x16x32_f16 v[116:119], a[84:87], v[132:135], v[116:119]
    s_waitcnt lgkmcnt(0)
    v_pk_mul_f16 v160, v160, v80
    v_fma_f32 v176, |v102|, v54, v176
    v_mfma_f32_16x16x32_f16 v[116:119], a[80:83], v[128:131], v[116:119]
    v_pk_mul_f16 v152, v152, v88
    v_fma_f32 v176, |v103|, v55, v176
    v_mfma_f32_16x16x32_f16 v[120:123], a[96:99], v[128:131], v[40:43]
    v_pk_mul_f16 v153, v153, v89
    v_fma_f32 v176, |v104|, v56, v176
    v_mfma_f32_16x16x32_f16 v[120:123], a[100:103], v[132:135], v[120:123]
    v_pk_mul_f16 v154, v154, v90
    v_fma_f32 v176, |v105|, v57, v176
    v_mfma_f32_16x16x32_f16 v[120:123], a[104:107], v[136:139], v[120:123]
    v_pk_mul_f16 v155, v155, v91
    v_fma_f32 v176, |v106|, v58, v176
    v_mfma_f32_16x16x32_f16 v[120:123], a[108:111], v[140:143], v[120:123]
    v_pk_mul_f16 v156, v156, v92
    v_fma_f32 v176, |v107|, v59, v176
    v_mfma_f32_16x16x32_f16 v[124:127], a[124:127], v[140:143], v[44:47]
    v_pk_mul_f16 v157, v157, v93
    v_fma_f32 v176, |v108|, v60, v176
    v_mfma_f32_16x16x32_f16 v[124:127], a[120:123], v[136:139], v[124:127]
    v_pk_mul_f16 v158, v158, v94
    v_fma_f32 v176, |v109|, v61, v176
    v_mfma_f32_16x16x32_f16 v[124:127], a[116:119], v[132:135], v[124:127]
    v_pk_mul_f16 v159, v159, v95
    v_fma_f32 v176, |v110|, v62, v176
    v_mfma_f32_16x16x32_f16 v[124:127], a[112:115], v[128:131], v[124:127]
    v_pk_mul_f16 v161, v161, v81
    v_fma_f32 v176, |v111|, v63, v176
    v_mfma_f32_16x16x32_f16 v[96:99], a[112:115], v[144:147], v[44:47]
    ds_read_b128 v[140:143], v245 offset:5376
    v_fma_f32 v176, |v112|, v64, v176
    v_mfma_f32_16x16x32_f16 v[96:99], a[116:119], v[148:151], v[96:99]
    ds_read_b128 v[136:139], v245 offset:5312
    v_fma_f32 v176, |v113|, v65, v176
    v_mfma_f32_16x16x32_f16 v[96:99], a[120:123], v[152:155], v[96:99]
    ds_read_b128 v[132:135], v245 offset:5248
    v_fma_f32 v176, |v114|, v66, v176
    v_mfma_f32_16x16x32_f16 v[96:99], a[124:127], v[156:159], v[96:99]
    ds_read_b128 v[128:131], v245 offset:5184
    v_fma_f32 v176, |v115|, v67, v176
    v_mfma_f32_16x16x32_f16 v[100:103], a[108:111], v[156:159], v[40:43]
    v_pk_mul_f16 v162, v162, v82
    v_fma_f32 v176, |v116|, v68, v176
    v_mfma_f32_16x16x32_f16 v[100:103], a[104:107], v[152:155], v[100:103]
    v_pk_mul_f16 v163, v163, v83
    v_fma_f32 v176, |v117|, v69, v176
    v_mfma_f32_16x16x32_f16 v[100:103], a[100:103], v[148:151], v[100:103]
    v_pk_mul_f16 v164, v164, v84
    v_fma_f32 v176, |v118|, v70, v176
    v_mfma_f32_16x16x32_f16 v[100:103], a[96:99], v[144:147], v[100:103]
    v_pk_mul_f16 v165, v165, v85
    v_fma_f32 v176, |v119|, v71, v176
    v_mfma_f32_16x16x32_f16 v[104:107], a[80:83], v[144:147], v[36:39]
    v_pk_mul_f16 v166, v166, v86
    v_fma_f32 v176, |v120|, v72, v176
    v_mfma_f32_16x16x32_f16 v[104:107], a[84:87], v[148:151], v[104:107]
    v_pk_mul_f16 v167, v167, v87
    v_fma_f32 v176, |v121|, v73, v176
    v_mfma_f32_16x16x32_f16 v[104:107], a[88:91], v[152:155], v[104:107]
    v_pk_mul_f16 v168, v168, v88
    v_fma_f32 v176, |v122|, v74, v176
    v_mfma_f32_16x16x32_f16 v[104:107], a[92:95], v[156:159], v[104:107]
    v_pk_mul_f16 v169, v169, v89
    v_fma_f32 v176, |v123|, v75, v176
    v_mfma_f32_16x16x32_f16 v[108:111], a[76:79], v[156:159], v[32:35]
    v_pk_mul_f16 v170, v170, v90
    v_fma_f32 v176, |v124|, v76, v176
    v_mfma_f32_16x16x32_f16 v[108:111], a[72:75], v[152:155], v[108:111]
    v_pk_mul_f16 v171, v171, v91
    v_fma_f32 v176, |v125|, v77, v176
    v_mfma_f32_16x16x32_f16 v[108:111], a[68:71], v[148:151], v[108:111]
    v_pk_mul_f16 v172, v172, v92
    v_fma_f32 v176, |v126|, v78, v176
    v_mfma_f32_16x16x32_f16 v[108:111], a[64:67], v[144:147], v[108:111]
    s_waitcnt lgkmcnt(0)
    v_pk_mul_f16 v128, v128, v80
    v_fma_f32 v176, |v127|, v79, v176
    v_mfma_f32_16x16x32_f16 v[112:115], a[48:51], v[144:147], v[28:31]
    v_pk_mul_f16 v129, v129, v81
    v_mul_f32 v177, |v96|, v76
    v_mfma_f32_16x16x32_f16 v[112:115], a[52:55], v[148:151], v[112:115]
    v_pk_mul_f16 v130, v130, v82
    v_fma_f32 v177, |v97|, v77, v177
    v_mfma_f32_16x16x32_f16 v[112:115], a[56:59], v[152:155], v[112:115]
    v_pk_mul_f16 v131, v131, v83
    v_fma_f32 v177, |v98|, v78, v177
    v_mfma_f32_16x16x32_f16 v[112:115], a[60:63], v[156:159], v[112:115]
    v_pk_mul_f16 v132, v132, v84
    v_fma_f32 v177, |v99|, v79, v177
    v_mfma_f32_16x16x32_f16 v[116:119], a[44:47], v[156:159], v[24:27]
    v_pk_mul_f16 v133, v133, v85
    v_fma_f32 v177, |v100|, v72, v177
    v_mfma_f32_16x16x32_f16 v[116:119], a[40:43], v[152:155], v[116:119]
    v_pk_mul_f16 v134, v134, v86
    v_fma_f32 v177, |v101|, v73, v177
    v_mfma_f32_16x16x32_f16 v[116:119], a[36:39], v[148:151], v[116:119]
    v_pk_mul_f16 v135, v135, v87
    v_fma_f32 v177, |v102|, v74, v177
    v_mfma_f32_16x16x32_f16 v[116:119], a[32:35], v[144:147], v[116:119]
    v_pk_mul_f16 v136, v136, v88
    v_fma_f32 v177, |v103|, v75, v177
    v_mfma_f32_16x16x32_f16 v[120:123], a[16:19], v[144:147], v[20:23]
    v_pk_mul_f16 v137, v137, v89
    v_fma_f32 v177, |v104|, v68, v177
    v_mfma_f32_16x16x32_f16 v[120:123], a[20:23], v[148:151], v[120:123]
    v_pk_mul_f16 v138, v138, v90
    v_fma_f32 v177, |v105|, v69, v177
    v_mfma_f32_16x16x32_f16 v[120:123], a[24:27], v[152:155], v[120:123]
    v_pk_mul_f16 v139, v139, v91
    v_fma_f32 v177, |v106|, v70, v177
    v_mfma_f32_16x16x32_f16 v[120:123], a[28:31], v[156:159], v[120:123]
    v_pk_mul_f16 v140, v140, v92
    v_fma_f32 v177, |v107|, v71, v177
    v_mfma_f32_16x16x32_f16 v[124:127], a[12:15], v[156:159], v[16:19]
    v_pk_mul_f16 v141, v141, v93
    v_fma_f32 v177, |v108|, v64, v177
    v_mfma_f32_16x16x32_f16 v[124:127], a[8:11], v[152:155], v[124:127]
    v_pk_mul_f16 v142, v142, v94
    v_fma_f32 v177, |v109|, v65, v177
    v_mfma_f32_16x16x32_f16 v[124:127], a[4:7], v[148:151], v[124:127]
    v_pk_mul_f16 v143, v143, v95
    v_fma_f32 v177, |v110|, v66, v177
    v_mfma_f32_16x16x32_f16 v[124:127], a[0:3], v[144:147], v[124:127]
    v_pk_mul_f16 v173, v173, v93
    v_fma_f32 v177, |v111|, v67, v177
    v_mfma_f32_16x16x32_f16 v[96:99], a[0:3], v[128:131], v[16:19]
    ds_read_b128 v[156:159], v245 offset:5664
    v_fma_f32 v177, |v112|, v60, v177
    v_mfma_f32_16x16x32_f16 v[96:99], a[4:7], v[132:135], v[96:99]
    ds_read_b128 v[152:155], v245 offset:5600
    v_fma_f32 v177, |v113|, v61, v177
    v_mfma_f32_16x16x32_f16 v[96:99], a[8:11], v[136:139], v[96:99]
    ds_read_b128 v[148:151], v245 offset:5536
    v_fma_f32 v177, |v114|, v62, v177
    v_mfma_f32_16x16x32_f16 v[96:99], a[12:15], v[140:143], v[96:99]
    ds_read_b128 v[144:147], v245 offset:5472
    v_fma_f32 v177, |v115|, v63, v177
    v_mfma_f32_16x16x32_f16 v[100:103], a[28:31], v[140:143], v[20:23]
    v_pk_mul_f16 v174, v174, v94
    v_fma_f32 v177, |v116|, v56, v177
    v_mfma_f32_16x16x32_f16 v[100:103], a[24:27], v[136:139], v[100:103]
    v_pk_mul_f16 v175, v175, v95
    v_fma_f32 v177, |v117|, v57, v177
    v_mfma_f32_16x16x32_f16 v[100:103], a[20:23], v[132:135], v[100:103]
    v_add_u32_sdwa v239, v232, s5 dst_sel:DWORD dst_unused:UNUSED_PAD src0_sel:WORD_1 src1_sel:DWORD
    v_fma_f32 v177, |v118|, v58, v177
    v_mfma_f32_16x16x32_f16 v[100:103], a[16:19], v[128:131], v[100:103]
    v_add_u32_sdwa v232, v232, s5 dst_sel:DWORD dst_unused:UNUSED_PAD src0_sel:WORD_0 src1_sel:DWORD
    v_fma_f32 v177, |v119|, v59, v177
    v_mfma_f32_16x16x32_f16 v[220:223], v[160:163], v[80:83], 0
    v_add_u32_sdwa v240, v233, s5 dst_sel:DWORD dst_unused:UNUSED_PAD src0_sel:WORD_1 src1_sel:DWORD
    v_fma_f32 v177, |v120|, v52, v177
    v_mfma_f32_16x16x32_f16 v[220:223], v[164:167], v[84:87], v[220:223]
    v_add_u32_sdwa v233, v233, s5 dst_sel:DWORD dst_unused:UNUSED_PAD src0_sel:WORD_0 src1_sel:DWORD
    v_fma_f32 v177, |v121|, v53, v177
    v_mfma_f32_16x16x32_f16 v[220:223], v[168:171], v[88:91], v[220:223]
    v_add_u32_sdwa v241, v234, s5 dst_sel:DWORD dst_unused:UNUSED_PAD src0_sel:WORD_1 src1_sel:DWORD
    v_fma_f32 v177, |v122|, v54, v177
    v_mfma_f32_16x16x32_f16 v[220:223], v[172:175], v[92:95], v[220:223]
    v_add_u32_sdwa v234, v234, s5 dst_sel:DWORD dst_unused:UNUSED_PAD src0_sel:WORD_0 src1_sel:DWORD
    v_fma_f32 v177, |v123|, v55, v177
    v_mfma_f32_16x16x32_f16 v[224:227], v[172:175], v[216:219], 0
    s_waitcnt lgkmcnt(0)
    v_pk_mul_f16 v144, v144, v80
    v_fma_f32 v177, |v124|, v48, v177
    v_mfma_f32_16x16x32_f16 v[224:227], v[168:171], v[212:215], v[224:227]
    v_pk_mul_f16 v145, v145, v81
    v_fma_f32 v177, |v125|, v49, v177
    v_mfma_f32_16x16x32_f16 v[224:227], v[164:167], v[208:211], v[224:227]
    v_pk_mul_f16 v146, v146, v82
    v_fma_f32 v177, |v126|, v50, v177
    v_mfma_f32_16x16x32_f16 v[224:227], v[160:163], v[204:207], v[224:227]
    ds_read_b128 v[172:175], v245 offset:9696
    v_fma_f32 v177, |v127|, v51, v177
    v_mfma_f32_16x16x32_f16 v[104:107], a[32:35], v[128:131], v[24:27]
    ds_read_b128 v[168:171], v245 offset:9632
    v_mul_f32 v178, |v96|, v48
    v_mfma_f32_16x16x32_f16 v[104:107], a[36:39], v[132:135], v[104:107]
    ds_read_b128 v[164:167], v245 offset:9568
    v_fma_f32 v178, |v97|, v49, v178
    v_mfma_f32_16x16x32_f16 v[104:107], a[40:43], v[136:139], v[104:107]
    ds_write_b128 v238, v[220:223] offset:0
    v_mfma_f32_16x16x32_f16 v[104:107], a[44:47], v[140:143], v[104:107]
    ds_write_b128 v238, v[224:227] offset:2304
    v_mfma_f32_16x16x32_f16 v[108:111], a[60:63], v[140:143], v[28:31]
    ds_read_b128 v[160:163], v245 offset:9504
    v_fma_f32 v178, |v98|, v50, v178
    v_mfma_f32_16x16x32_f16 v[108:111], a[56:59], v[136:139], v[108:111]
    v_pk_mul_f16 v147, v147, v83
    v_fma_f32 v178, |v99|, v51, v178
    v_mfma_f32_16x16x32_f16 v[108:111], a[52:55], v[132:135], v[108:111]
    v_pk_mul_f16 v148, v148, v84
    v_fma_f32 v178, |v100|, v52, v178
    v_mfma_f32_16x16x32_f16 v[108:111], a[48:51], v[128:131], v[108:111]
    v_pk_mul_f16 v149, v149, v85
    v_fma_f32 v178, |v101|, v53, v178
    v_mfma_f32_16x16x32_f16 v[112:115], a[64:67], v[128:131], v[32:35]
    v_pk_mul_f16 v150, v150, v86
    v_fma_f32 v178, |v102|, v54, v178
    v_mfma_f32_16x16x32_f16 v[112:115], a[68:71], v[132:135], v[112:115]
    v_pk_mul_f16 v151, v151, v87
    v_fma_f32 v178, |v103|, v55, v178
    v_mfma_f32_16x16x32_f16 v[112:115], a[72:75], v[136:139], v[112:115]
    v_pk_mul_f16 v152, v152, v88
    v_fma_f32 v178, |v104|, v56, v178
    v_mfma_f32_16x16x32_f16 v[112:115], a[76:79], v[140:143], v[112:115]
    v_pk_mul_f16 v153, v153, v89
    v_fma_f32 v178, |v105|, v57, v178
    v_mfma_f32_16x16x32_f16 v[116:119], a[92:95], v[140:143], v[36:39]
    v_pk_mul_f16 v154, v154, v90
    v_fma_f32 v178, |v106|, v58, v178
    v_mfma_f32_16x16x32_f16 v[116:119], a[88:91], v[136:139], v[116:119]
    s_waitcnt lgkmcnt(0)
    v_pk_mul_f16 v160, v160, v80
    v_fma_f32 v178, |v107|, v59, v178
    v_mfma_f32_16x16x32_f16 v[116:119], a[84:87], v[132:135], v[116:119]
    v_pk_mul_f16 v161, v161, v81
    v_fma_f32 v178, |v108|, v60, v178
    v_mfma_f32_16x16x32_f16 v[116:119], a[80:83], v[128:131], v[116:119]
    v_pk_mul_f16 v162, v162, v82
    v_fma_f32 v178, |v109|, v61, v178
    v_mfma_f32_16x16x32_f16 v[120:123], a[96:99], v[128:131], v[40:43]
    v_pk_mul_f16 v163, v163, v83
    v_fma_f32 v178, |v110|, v62, v178
    v_mfma_f32_16x16x32_f16 v[120:123], a[100:103], v[132:135], v[120:123]
    v_pk_mul_f16 v164, v164, v84
    v_fma_f32 v178, |v111|, v63, v178
    v_mfma_f32_16x16x32_f16 v[120:123], a[104:107], v[136:139], v[120:123]
    v_pk_mul_f16 v155, v155, v91
    v_fma_f32 v178, |v112|, v64, v178
    v_mfma_f32_16x16x32_f16 v[120:123], a[108:111], v[140:143], v[120:123]
    v_pk_mul_f16 v156, v156, v92
    v_fma_f32 v178, |v113|, v65, v178
    v_mfma_f32_16x16x32_f16 v[124:127], a[124:127], v[140:143], v[44:47]
    v_pk_mul_f16 v157, v157, v93
    v_fma_f32 v178, |v114|, v66, v178
    v_mfma_f32_16x16x32_f16 v[124:127], a[120:123], v[136:139], v[124:127]
    v_pk_mul_f16 v158, v158, v94
    v_fma_f32 v178, |v115|, v67, v178
    v_mfma_f32_16x16x32_f16 v[124:127], a[116:119], v[132:135], v[124:127]
    v_pk_mul_f16 v159, v159, v95
    v_fma_f32 v178, |v116|, v68, v178
    v_mfma_f32_16x16x32_f16 v[124:127], a[112:115], v[128:131], v[124:127]
    v_pk_mul_f16 v165, v165, v85
    v_fma_f32 v178, |v117|, v69, v178
    v_mfma_f32_16x16x32_f16 v[96:99], a[112:115], v[144:147], v[44:47]
    ds_read_b128 v[140:143], v245 offset:5952
    v_fma_f32 v178, |v118|, v70, v178
    v_mfma_f32_16x16x32_f16 v[96:99], a[116:119], v[148:151], v[96:99]
    ds_read_b128 v[136:139], v245 offset:5888
    v_fma_f32 v178, |v119|, v71, v178
    v_mfma_f32_16x16x32_f16 v[96:99], a[120:123], v[152:155], v[96:99]
    ds_read_b128 v[132:135], v245 offset:5824
    v_fma_f32 v178, |v120|, v72, v178
    v_mfma_f32_16x16x32_f16 v[96:99], a[124:127], v[156:159], v[96:99]
    ds_read_b128 v[128:131], v245 offset:5760
    v_fma_f32 v178, |v121|, v73, v178
    v_mfma_f32_16x16x32_f16 v[100:103], a[108:111], v[156:159], v[40:43]
    v_pk_mul_f16 v166, v166, v86
    v_fma_f32 v178, |v122|, v74, v178
    v_mfma_f32_16x16x32_f16 v[100:103], a[104:107], v[152:155], v[100:103]
    v_pk_mul_f16 v167, v167, v87
    v_fma_f32 v178, |v123|, v75, v178
    v_mfma_f32_16x16x32_f16 v[100:103], a[100:103], v[148:151], v[100:103]
    v_pk_mul_f16 v168, v168, v88
    v_fma_f32 v178, |v124|, v76, v178
    v_mfma_f32_16x16x32_f16 v[100:103], a[96:99], v[144:147], v[100:103]
    v_pk_mul_f16 v169, v169, v89
    v_fma_f32 v178, |v125|, v77, v178
    v_mfma_f32_16x16x32_f16 v[104:107], a[80:83], v[144:147], v[36:39]
    v_pk_mul_f16 v170, v170, v90
    v_fma_f32 v178, |v126|, v78, v178
    v_mfma_f32_16x16x32_f16 v[104:107], a[84:87], v[148:151], v[104:107]
    v_pk_mul_f16 v171, v171, v91
    v_fma_f32 v178, |v127|, v79, v178
    v_mfma_f32_16x16x32_f16 v[104:107], a[88:91], v[152:155], v[104:107]
    v_pk_mul_f16 v172, v172, v92
    v_mul_f32 v179, |v96|, v76
    v_mfma_f32_16x16x32_f16 v[104:107], a[92:95], v[156:159], v[104:107]
    v_pk_mul_f16 v173, v173, v93
    v_fma_f32 v179, |v97|, v77, v179
    v_mfma_f32_16x16x32_f16 v[108:111], a[76:79], v[156:159], v[32:35]
    v_pk_mul_f16 v174, v174, v94
    v_fma_f32 v179, |v98|, v78, v179
    v_mfma_f32_16x16x32_f16 v[108:111], a[72:75], v[152:155], v[108:111]
L_pad2:
    s_cbranch_execz L_hopret
    v_pk_mul_f16 v175, v175, v95
    v_fma_f32 v179, |v99|, v79, v179
    v_mfma_f32_16x16x32_f16 v[108:111], a[68:71], v[148:151], v[108:111]
    s_waitcnt lgkmcnt(0)
    v_pk_mul_f16 v128, v128, v80
    v_fma_f32 v179, |v100|, v72, v179
    v_mfma_f32_16x16x32_f16 v[108:111], a[64:67], v[144:147], v[108:111]
    v_pk_mul_f16 v129, v129, v81
    v_fma_f32 v179, |v101|, v73, v179
    v_mfma_f32_16x16x32_f16 v[220:223], v[160:163], v[80:83], 0
    v_pk_mul_f16 v130, v130, v82
    v_fma_f32 v179, |v102|, v74, v179
    v_mfma_f32_16x16x32_f16 v[220:223], v[164:167], v[84:87], v[220:223]
    v_pk_mul_f16 v131, v131, v83
    v_fma_f32 v179, |v103|, v75, v179
    v_mfma_f32_16x16x32_f16 v[220:223], v[168:171], v[88:91], v[220:223]
    v_pk_mul_f16 v132, v132, v84
    v_fma_f32 v179, |v104|, v68, v179
    v_mfma_f32_16x16x32_f16 v[220:223], v[172:175], v[92:95], v[220:223]
    v_pk_mul_f16 v133, v133, v85
    v_fma_f32 v179, |v105|, v69, v179
    v_mfma_f32_16x16x32_f16 v[224:227], v[172:175], v[216:219], 0
    v_pk_mul_f16 v134, v134, v86
    v_fma_f32 v179, |v106|, v70, v179
    v_mfma_f32_16x16x32_f16 v[224:227], v[168:171], v[212:215], v[224:227]
    v_pk_mul_f16 v135, v135, v87
    v_fma_f32 v179, |v107|, v71, v179
    v_mfma_f32_16x16x32_f16 v[224:227], v[164:167], v[208:211], v[224:227]
    v_pk_mul_f16 v136, v136, v88
    v_pk_mul_f16 v137, v137, v89
    v_mfma_f32_16x16x32_f16 v[224:227], v[160:163], v[204:207], v[224:227]
    ds_read_b128 v[172:175], v245 offset:9408
    ds_read_b128 v[168:171], v245 offset:9344
    v_mfma_f32_16x16x32_f16 v[112:115], a[48:51], v[144:147], v[28:31]
    ds_read_b128 v[164:167], v245 offset:9280
    ds_read_b128 v[160:163], v245 offset:9216
    v_mfma_f32_16x16x32_f16 v[112:115], a[52:55], v[148:151], v[112:115]
    v_pk_mul_f16 v138, v138, v90
    v_pk_mul_f16 v139, v139, v91
    v_mfma_f32_16x16x32_f16 v[112:115], a[56:59], v[152:155], v[112:115]
    ds_write_b128 v238, v[220:223] offset:4608
    v_mfma_f32_16x16x32_f16 v[112:115], a[60:63], v[156:159], v[112:115]
    ds_write_b128 v238, v[224:227] offset:6912
    v_mfma_f32_16x16x32_f16 v[116:119], a[44:47], v[156:159], v[24:27]
    v_pk_mul_f16 v140, v140, v92
    v_fma_f32 v179, |v108|, v64, v179
    v_mfma_f32_16x16x32_f16 v[116:119], a[40:43], v[152:155], v[116:119]
    v_pk_mul_f16 v141, v141, v93
    v_fma_f32 v179, |v109|, v65, v179
    v_mfma_f32_16x16x32_f16 v[116:119], a[36:39], v[148:151], v[116:119]
    v_pk_mul_f16 v142, v142, v94
    v_fma_f32 v179, |v110|, v66, v179
    v_mfma_f32_16x16x32_f16 v[116:119], a[32:35], v[144:147], v[116:119]
    v_pk_mul_f16 v143, v143, v95
    v_fma_f32 v179, |v111|, v67, v179
    v_mfma_f32_16x16x32_f16 v[120:123], a[16:19], v[144:147], v[20:23]
    v_add_u32_sdwa v242, v235, s5 dst_sel:DWORD dst_unused:UNUSED_PAD src0_sel:WORD_1 src1_sel:DWORD
    v_fma_f32 v179, |v112|, v60, v179
    v_mfma_f32_16x16x32_f16 v[120:123], a[20:23], v[148:151], v[120:123]
    s_waitcnt lgkmcnt(2)
    v_pk_mul_f16 v160, v160, v204
    v_fma_f32 v179, |v113|, v61, v179
    v_mfma_f32_16x16x32_f16 v[120:123], a[24:27], v[152:155], v[120:123]
    v_pk_mul_f16 v161, v161, v205
    v_fma_f32 v179, |v114|, v62, v179
    v_mfma_f32_16x16x32_f16 v[120:123], a[28:31], v[156:159], v[120:123]
    v_pk_mul_f16 v162, v162, v206
    v_fma_f32 v179, |v115|, v63, v179
    v_mfma_f32_16x16x32_f16 v[124:127], a[12:15], v[156:159], v[16:19]
    v_pk_mul_f16 v163, v163, v207
    v_fma_f32 v179, |v116|, v56, v179
    v_mfma_f32_16x16x32_f16 v[124:127], a[8:11], v[152:155], v[124:127]
    v_pk_mul_f16 v164, v164, v208
    v_fma_f32 v179, |v117|, v57, v179
    v_mfma_f32_16x16x32_f16 v[124:127], a[4:7], v[148:151], v[124:127]
    v_pk_mul_f16 v165, v165, v209
    v_fma_f32 v179, |v118|, v58, v179
    v_mfma_f32_16x16x32_f16 v[124:127], a[0:3], v[144:147], v[124:127]
    v_pk_mul_f16 v166, v166, v210
    v_fma_f32 v179, |v119|, v59, v179
    v_mfma_f32_16x16x32_f16 v[96:99], a[0:3], v[128:131], v[16:19]
    ds_read_b128 v[156:159], v245 offset:6240
    v_fma_f32 v179, |v120|, v52, v179
    v_mfma_f32_16x16x32_f16 v[96:99], a[4:7], v[132:135], v[96:99]
    ds_read_b128 v[152:155], v245 offset:6176
    v_fma_f32 v179, |v121|, v53, v179
    v_mfma_f32_16x16x32_f16 v[96:99], a[8:11], v[136:139], v[96:99]
    ds_read_b128 v[148:151], v245 offset:6112
    v_fma_f32 v179, |v122|, v54, v179
    v_mfma_f32_16x16x32_f16 v[96:99], a[12:15], v[140:143], v[96:99]
    ds_read_b128 v[144:147], v245 offset:6048
    v_fma_f32 v179, |v123|, v55, v179
    v_mfma_f32_16x16x32_f16 v[100:103], a[28:31], v[140:143], v[20:23]
    v_pk_mul_f16 v167, v167, v211
    v_fma_f32 v179, |v124|, v48, v179
    v_mfma_f32_16x16x32_f16 v[100:103], a[24:27], v[136:139], v[100:103]
    v_pk_mul_f16 v168, v168, v212
    v_fma_f32 v179, |v125|, v49, v179
    v_mfma_f32_16x16x32_f16 v[100:103], a[20:23], v[132:135], v[100:103]
    v_pk_mul_f16 v169, v169, v213
    v_fma_f32 v179, |v126|, v50, v179
    v_mfma_f32_16x16x32_f16 v[100:103], a[16:19], v[128:131], v[100:103]
    v_pk_mul_f16 v170, v170, v214
    v_fma_f32 v179, |v127|, v51, v179
    v_mfma_f32_16x16x32_f16 v[104:107], a[32:35], v[128:131], v[24:27]
    v_pk_mul_f16 v171, v171, v215
    v_mul_f32 v180, |v96|, v48
    v_mfma_f32_16x16x32_f16 v[104:107], a[36:39], v[132:135], v[104:107]
    v_pk_mul_f16 v172, v172, v216
    v_fma_f32 v180, |v97|, v49, v180
    v_mfma_f32_16x16x32_f16 v[104:107], a[40:43], v[136:139], v[104:107]
    v_pk_mul_f16 v173, v173, v217
    v_fma_f32 v180, |v98|, v50, v180
    v_mfma_f32_16x16x32_f16 v[104:107], a[44:47], v[140:143], v[104:107]
    v_pk_mul_f16 v174, v174, v218
    v_fma_f32 v180, |v99|, v51, v180
    v_mfma_f32_16x16x32_f16 v[108:111], a[60:63], v[140:143], v[28:31]
    v_pk_mul_f16 v175, v175, v219
    v_fma_f32 v180, |v100|, v52, v180
    v_mfma_f32_16x16x32_f16 v[108:111], a[56:59], v[136:139], v[108:111]
    s_waitcnt lgkmcnt(0)
    v_pk_mul_f16 v144, v144, v80
    v_fma_f32 v180, |v101|, v53, v180
    v_mfma_f32_16x16x32_f16 v[108:111], a[52:55], v[132:135], v[108:111]
    v_pk_mul_f16 v145, v145, v81
    v_fma_f32 v180, |v102|, v54, v180
    v_mfma_f32_16x16x32_f16 v[108:111], a[48:51], v[128:131], v[108:111]
    v_pk_mul_f16 v146, v146, v82
    v_fma_f32 v180, |v103|, v55, v180
    v_mfma_f32_16x16x32_f16 v[228:231], v[160:163], v[204:207], 0
    v_pk_mul_f16 v147, v147, v83
    v_fma_f32 v180, |v104|, v56, v180
    v_mfma_f32_16x16x32_f16 v[228:231], v[164:167], v[208:211], v[228:231]
    v_pk_mul_f16 v148, v148, v84
    v_fma_f32 v180, |v105|, v57, v180
    v_mfma_f32_16x16x32_f16 v[228:231], v[168:171], v[212:215], v[228:231]
    v_pk_mul_f16 v149, v149, v85
    v_fma_f32 v180, |v106|, v58, v180
    v_mfma_f32_16x16x32_f16 v[228:231], v[172:175], v[216:219], v[228:231]
    ds_read_b128 v[172:175], v245 offset:9696
    v_fma_f32 v180, |v107|, v59, v180
    v_mfma_f32_16x16x32_f16 v[112:115], a[64:67], v[128:131], v[32:35]
    ds_read_b128 v[168:171], v245 offset:9632
    ds_read_b128 v[164:167], v245 offset:9568
    v_mfma_f32_16x16x32_f16 v[112:115], a[68:71], v[132:135], v[112:115]
    ds_read_b128 v[160:163], v245 offset:9504
    v_pk_mul_f16 v150, v150, v86
    v_mfma_f32_16x16x32_f16 v[112:115], a[72:75], v[136:139], v[112:115]
    ds_write_b128 v238, v[228:231] offset:2368
    v_mfma_f32_16x16x32_f16 v[112:115], a[76:79], v[140:143], v[112:115]
    v_pk_mul_f16 v151, v151, v87
    v_fma_f32 v180, |v108|, v60, v180
    v_mfma_f32_16x16x32_f16 v[116:119], a[92:95], v[140:143], v[36:39]
    v_pk_mul_f16 v152, v152, v88
    v_fma_f32 v180, |v109|, v61, v180
    v_mfma_f32_16x16x32_f16 v[116:119], a[88:91], v[136:139], v[116:119]
    v_pk_mul_f16 v153, v153, v89
    v_fma_f32 v180, |v110|, v62, v180
    v_mfma_f32_16x16x32_f16 v[116:119], a[84:87], v[132:135], v[116:119]
    v_pk_mul_f16 v154, v154, v90
    v_fma_f32 v180, |v111|, v63, v180
    v_mfma_f32_16x16x32_f16 v[116:119], a[80:83], v[128:131], v[116:119]
    v_pk_mul_f16 v155, v155, v91
    v_fma_f32 v180, |v112|, v64, v180
    v_mfma_f32_16x16x32_f16 v[120:123], a[96:99], v[128:131], v[40:43]
    v_pk_mul_f16 v156, v156, v92
    v_fma_f32 v180, |v113|, v65, v180
    v_mfma_f32_16x16x32_f16 v[120:123], a[100:103], v[132:135], v[120:123]
    v_pk_mul_f16 v157, v157, v93
    v_fma_f32 v180, |v114|, v66, v180
    v_mfma_f32_16x16x32_f16 v[120:123], a[104:107], v[136:139], v[120:123]
    s_waitcnt lgkmcnt(1)
    v_pk_mul_f16 v160, v160, v204
    v_fma_f32 v180, |v115|, v67, v180
    v_mfma_f32_16x16x32_f16 v[120:123], a[108:111], v[140:143], v[120:123]
    v_pk_mul_f16 v161, v161, v205
    v_fma_f32 v180, |v116|, v68, v180
    v_mfma_f32_16x16x32_f16 v[124:127], a[124:127], v[140:143], v[44:47]
    v_pk_mul_f16 v162, v162, v206
    v_fma_f32 v180, |v117|, v69, v180
    v_mfma_f32_16x16x32_f16 v[124:127], a[120:123], v[136:139], v[124:127]
    v_pk_mul_f16 v158, v158, v94
    v_fma_f32 v180, |v118|, v70, v180
    v_mfma_f32_16x16x32_f16 v[124:127], a[116:119], v[132:135], v[124:127]
    v_pk_mul_f16 v159, v159, v95
    v_fma_f32 v180, |v119|, v71, v180
    v_mfma_f32_16x16x32_f16 v[124:127], a[112:115], v[128:131], v[124:127]
    v_pk_mul_f16 v163, v163, v207
    v_fma_f32 v180, |v120|, v72, v180
    v_mfma_f32_16x16x32_f16 v[96:99], a[112:115], v[144:147], v[44:47]
    ds_read_b128 v[140:143], v245 offset:6528
    v_fma_f32 v180, |v121|, v73, v180
    v_mfma_f32_16x16x32_f16 v[96:99], a[116:119], v[148:151], v[96:99]
    ds_read_b128 v[136:139], v245 offset:6464
    v_fma_f32 v180, |v122|, v74, v180
    v_mfma_f32_16x16x32_f16 v[96:99], a[120:123], v[152:155], v[96:99]
    ds_read_b128 v[132:135], v245 offset:6400
    v_fma_f32 v180, |v123|, v75, v180
    v_mfma_f32_16x16x32_f16 v[96:99], a[124:127], v[156:159], v[96:99]
    ds_read_b128 v[128:131], v245 offset:6336
    v_fma_f32 v180, |v124|, v76, v180
    v_mfma_f32_16x16x32_f16 v[100:103], a[108:111], v[156:159], v[40:43]
    v_pk_mul_f16 v164, v164, v208
    v_fma_f32 v180, |v125|, v77, v180
    v_mfma_f32_16x16x32_f16 v[100:103], a[104:107], v[152:155], v[100:103]
    v_pk_mul_f16 v165, v165, v209
    v_fma_f32 v180, |v126|, v78, v180
    v_mfma_f32_16x16x32_f16 v[100:103], a[100:103], v[148:151], v[100:103]
    v_pk_mul_f16 v166, v166, v210
    v_fma_f32 v180, |v127|, v79, v180
    v_mfma_f32_16x16x32_f16 v[100:103], a[96:99], v[144:147], v[100:103]
    v_pk_mul_f16 v167, v167, v211
    v_mul_f32 v181, |v96|, v76
    v_mfma_f32_16x16x32_f16 v[104:107], a[80:83], v[144:147], v[36:39]
    v_pk_mul_f16 v168, v168, v212
    v_fma_f32 v181, |v97|, v77, v181
    v_mfma_f32_16x16x32_f16 v[104:107], a[84:87], v[148:151], v[104:107]
    v_pk_mul_f16 v169, v169, v213
    v_fma_f32 v181, |v98|, v78, v181
    v_mfma_f32_16x16x32_f16 v[104:107], a[88:91], v[152:155], v[104:107]
    v_pk_mul_f16 v170, v170, v214
    v_fma_f32 v181, |v99|, v79, v181
    v_mfma_f32_16x16x32_f16 v[104:107], a[92:95], v[156:159], v[104:107]
    v_pk_mul_f16 v171, v171, v215
    v_fma_f32 v181, |v100|, v72, v181
    v_mfma_f32_16x16x32_f16 v[108:111], a[76:79], v[156:159], v[32:35]
    v_pk_mul_f16 v172, v172, v216
    v_fma_f32 v181, |v101|, v73, v181
    v_mfma_f32_16x16x32_f16 v[108:111], a[72:75], v[152:155], v[108:111]
    v_pk_mul_f16 v173, v173, v217
    v_fma_f32 v181, |v102|, v74, v181
    v_mfma_f32_16x16x32_f16 v[108:111], a[68:71], v[148:151], v[108:111]
    v_pk_mul_f16 v174, v174, v218
    v_fma_f32 v181, |v103|, v75, v181
    v_mfma_f32_16x16x32_f16 v[108:111], a[64:67], v[144:147], v[108:111]
    s_waitcnt lgkmcnt(0)
    v_pk_mul_f16 v128, v128, v80
    v_fma_f32 v181, |v104|, v68, v181
    v_mfma_f32_16x16x32_f16 v[112:115], a[48:51], v[144:147], v[28:31]
    v_pk_mul_f16 v129, v129, v81
    v_fma_f32 v181, |v105|, v69, v181
    v_mfma_f32_16x16x32_f16 v[112:115], a[52:55], v[148:151], v[112:115]
    v_pk_mul_f16 v130, v130, v82
    v_fma_f32 v181, |v106|, v70, v181
    v_mfma_f32_16x16x32_f16 v[112:115], a[56:59], v[152:155], v[112:115]
    v_pk_mul_f16 v131, v131, v83
    v_fma_f32 v181, |v107|, v71, v181
    v_mfma_f32_16x16x32_f16 v[112:115], a[60:63], v[156:159], v[112:115]
    v_pk_mul_f16 v132, v132, v84
    v_fma_f32 v181, |v108|, v64, v181
    v_mfma_f32_16x16x32_f16 v[116:119], a[44:47], v[156:159], v[24:27]
    v_pk_mul_f16 v133, v133, v85
    v_fma_f32 v181, |v109|, v65, v181
    v_mfma_f32_16x16x32_f16 v[116:119], a[40:43], v[152:155], v[116:119]
    v_pk_mul_f16 v134, v134, v86
    v_fma_f32 v181, |v110|, v66, v181
    v_mfma_f32_16x16x32_f16 v[116:119], a[36:39], v[148:151], v[116:119]
    v_pk_mul_f16 v135, v135, v87
    v_fma_f32 v181, |v111|, v67, v181
    v_mfma_f32_16x16x32_f16 v[116:119], a[32:35], v[144:147], v[116:119]
    v_pk_mul_f16 v136, v136, v88
    v_fma_f32 v181, |v112|, v60, v181
    v_mfma_f32_16x16x32_f16 v[120:123], a[16:19], v[144:147], v[20:23]
    v_pk_mul_f16 v137, v137, v89
    v_fma_f32 v181, |v113|, v61, v181
    v_mfma_f32_16x16x32_f16 v[120:123], a[20:23], v[148:151], v[120:123]
    v_pk_mul_f16 v138, v138, v90
    v_fma_f32 v181, |v114|, v62, v181
    v_mfma_f32_16x16x32_f16 v[120:123], a[24:27], v[152:155], v[120:123]
    v_pk_mul_f16 v139, v139, v91
    v_fma_f32 v181, |v115|, v63, v181
    v_mfma_f32_16x16x32_f16 v[120:123], a[28:31], v[156:159], v[120:123]
    v_pk_mul_f16 v140, v140, v92
    v_fma_f32 v181, |v116|, v56, v181
    v_mfma_f32_16x16x32_f16 v[124:127], a[12:15], v[156:159], v[16:19]
    v_pk_mul_f16 v141, v141, v93
    v_fma_f32 v181, |v117|, v57, v181
    v_mfma_f32_16x16x32_f16 v[124:127], a[8:11], v[152:155], v[124:127]
    v_pk_mul_f16 v142, v142, v94
    v_fma_f32 v181, |v118|, v58, v181
    v_mfma_f32_16x16x32_f16 v[124:127], a[4:7], v[148:151], v[124:127]
    v_pk_mul_f16 v143, v143, v95
    v_fma_f32 v181, |v119|, v59, v181
    v_mfma_f32_16x16x32_f16 v[124:127], a[0:3], v[144:147], v[124:127]
    v_pk_mul_f16 v175, v175, v219
    v_fma_f32 v181, |v120|, v52, v181
    v_mfma_f32_16x16x32_f16 v[96:99], a[0:3], v[128:131], v[16:19]
    ds_read_b128 v[156:159], v245 offset:6816
    v_fma_f32 v181, |v121|, v53, v181
    v_mfma_f32_16x16x32_f16 v[96:99], a[4:7], v[132:135], v[96:99]
    ds_read_b128 v[152:155], v245 offset:6752
    v_fma_f32 v181, |v122|, v54, v181
    v_mfma_f32_16x16x32_f16 v[96:99], a[8:11], v[136:139], v[96:99]
    ds_read_b128 v[148:151], v245 offset:6688
    v_fma_f32 v181, |v123|, v55, v181
    v_mfma_f32_16x16x32_f16 v[96:99], a[12:15], v[140:143], v[96:99]
    ds_read_b128 v[144:147], v245 offset:6624
    v_fma_f32 v181, |v124|, v48, v181
    v_mfma_f32_16x16x32_f16 v[228:231], v[160:163], v[204:207], 0
    v_add_u32_sdwa v235, v235, s5 dst_sel:DWORD dst_unused:UNUSED_PAD src0_sel:WORD_0 src1_sel:DWORD
    v_fma_f32 v181, |v125|, v49, v181
    v_mfma_f32_16x16x32_f16 v[228:231], v[164:167], v[208:211], v[228:231]
    v_add_u32_sdwa v243, v236, s5 dst_sel:DWORD dst_unused:UNUSED_PAD src0_sel:WORD_1 src1_sel:DWORD
    v_fma_f32 v181, |v126|, v50, v181
    v_mfma_f32_16x16x32_f16 v[228:231], v[168:171], v[212:215], v[228:231]
    v_add_u32_sdwa v236, v236, s5 dst_sel:DWORD dst_unused:UNUSED_PAD src0_sel:WORD_0 src1_sel:DWORD
    v_fma_f32 v181, |v127|, v51, v181
    v_mfma_f32_16x16x32_f16 v[228:231], v[172:175], v[216:219], v[228:231]
    v_add_u32_sdwa v244, v237, s5 dst_sel:DWORD dst_unused:UNUSED_PAD src0_sel:WORD_1 src1_sel:DWORD
    v_add_u32_sdwa v237, v237, s5 dst_sel:DWORD dst_unused:UNUSED_PAD src0_sel:WORD_0 src1_sel:DWORD
    v_mfma_f32_16x16x32_f16 v[100:103], a[28:31], v[140:143], v[20:23]
    v_permlane32_swap_b32 v184, v186
    v_mfma_f32_16x16x32_f16 v[100:103], a[24:27], v[136:139], v[100:103]
    v_permlane32_swap_b32 v185, v187
    v_mfma_f32_16x16x32_f16 v[100:103], a[20:23], v[132:135], v[100:103]
    v_add_f32 v184, v184, v186
    v_mul_f32 v182, |v96|, v48
    v_mfma_f32_16x16x32_f16 v[100:103], a[16:19], v[128:131], v[100:103]
    ds_write_b128 v238, v[228:231] offset:6976
    v_mfma_f32_16x16x32_f16 v[104:107], a[32:35], v[128:131], v[24:27]
    ds_read2st64_b32 v[230:231], v237 offset0:0 offset1:18
    v_fma_f32 v182, |v97|, v49, v182
    v_mfma_f32_16x16x32_f16 v[104:107], a[36:39], v[132:135], v[104:107]
    ds_read2st64_b32 v[228:229], v236 offset0:0 offset1:18
    v_fma_f32 v182, |v98|, v50, v182
    v_mfma_f32_16x16x32_f16 v[104:107], a[40:43], v[136:139], v[104:107]
    ds_read2st64_b32 v[222:223], v233 offset0:0 offset1:18
    v_fma_f32 v182, |v99|, v51, v182
    v_mfma_f32_16x16x32_f16 v[104:107], a[44:47], v[140:143], v[104:107]
    ds_read2st64_b32 v[220:221], v232 offset0:0 offset1:18
    v_fma_f32 v182, |v100|, v52, v182
    v_mfma_f32_16x16x32_f16 v[108:111], a[60:63], v[140:143], v[28:31]
    ds_read2st64_b32 v[226:227], v235 offset0:0 offset1:18
    v_fma_f32 v182, |v101|, v53, v182
    v_mfma_f32_16x16x32_f16 v[108:111], a[56:59], v[136:139], v[108:111]
    ds_read2st64_b32 v[224:225], v234 offset0:0 offset1:18
    v_fma_f32 v182, |v102|, v54, v182
    v_mfma_f32_16x16x32_f16 v[108:111], a[52:55], v[132:135], v[108:111]
    s_waitcnt lgkmcnt(7)
    v_pk_mul_f16 v144, v144, v80
    v_fma_f32 v182, |v103|, v55, v182
    v_mfma_f32_16x16x32_f16 v[108:111], a[48:51], v[128:131], v[108:111]
    v_pk_mul_f16 v145, v145, v81
    v_fma_f32 v182, |v104|, v56, v182
    v_mfma_f32_16x16x32_f16 v[112:115], a[64:67], v[128:131], v[32:35]
    v_pk_mul_f16 v146, v146, v82
    v_fma_f32 v182, |v105|, v57, v182
    v_mfma_f32_16x16x32_f16 v[112:115], a[68:71], v[132:135], v[112:115]
    v_pk_mul_f16 v147, v147, v83
    v_fma_f32 v182, |v106|, v58, v182
    v_mfma_f32_16x16x32_f16 v[112:115], a[72:75], v[136:139], v[112:115]
    v_pk_mul_f16 v148, v148, v84
    v_fma_f32 v182, |v107|, v59, v182
    v_mfma_f32_16x16x32_f16 v[112:115], a[76:79], v[140:143], v[112:115]
    v_pk_mul_f16 v149, v149, v85
    v_fma_f32 v182, |v108|, v60, v182
    v_mfma_f32_16x16x32_f16 v[116:119], a[92:95], v[140:143], v[36:39]
    v_pk_mul_f16 v150, v150, v86
    v_fma_f32 v182, |v109|, v61, v182
    v_mfma_f32_16x16x32_f16 v[116:119], a[88:91], v[136:139], v[116:119]
    v_pk_mul_f16 v151, v151, v87
    v_fma_f32 v182, |v110|, v62, v182
    v_mfma_f32_16x16x32_f16 v[116:119], a[84:87], v[132:135], v[116:119]
    v_pk_mul_f16 v152, v152, v88
    v_fma_f32 v182, |v111|, v63, v182
    v_mfma_f32_16x16x32_f16 v[116:119], a[80:83], v[128:131], v[116:119]
    v_pk_mul_f16 v153, v153, v89
    v_fma_f32 v182, |v112|, v64, v182
    v_mfma_f32_16x16x32_f16 v[120:123], a[96:99], v[128:131], v[40:43]
    v_pk_mul_f16 v154, v154, v90
    v_fma_f32 v182, |v113|, v65, v182
    v_mfma_f32_16x16x32_f16 v[120:123], a[100:103], v[132:135], v[120:123]
    v_pk_mul_f16 v155, v155, v91
    v_fma_f32 v182, |v114|, v66, v182
    v_mfma_f32_16x16x32_f16 v[120:123], a[104:107], v[136:139], v[120:123]
    v_pk_mul_f16 v156, v156, v92
    v_fma_f32 v182, |v115|, v67, v182
    v_mfma_f32_16x16x32_f16 v[120:123], a[108:111], v[140:143], v[120:123]
    v_pk_mul_f16 v157, v157, v93
    v_fma_f32 v182, |v116|, v68, v182
    v_mfma_f32_16x16x32_f16 v[124:127], a[124:127], v[140:143], v[44:47]
    v_pk_mul_f16 v158, v158, v94
    v_fma_f32 v182, |v117|, v69, v182
    v_mfma_f32_16x16x32_f16 v[124:127], a[120:123], v[136:139], v[124:127]
    v_pk_mul_f16 v159, v159, v95
    v_fma_f32 v182, |v118|, v70, v182
    v_mfma_f32_16x16x32_f16 v[124:127], a[116:119], v[132:135], v[124:127]
    v_add_f32 v185, v185, v187
    v_fma_f32 v182, |v119|, v71, v182
    v_mfma_f32_16x16x32_f16 v[124:127], a[112:115], v[128:131], v[124:127]
    v_permlane16_swap_b32 v184, v185
    v_mfma_f32_16x16x32_f16 v[96:99], a[112:115], v[144:147], v[44:47]
    ds_read_b128 v[140:143], v245 offset:7104
    v_fma_f32 v182, |v120|, v72, v182
    v_mfma_f32_16x16x32_f16 v[96:99], a[116:119], v[148:151], v[96:99]
    ds_read_b128 v[136:139], v245 offset:7040
    v_fma_f32 v182, |v121|, v73, v182
    v_mfma_f32_16x16x32_f16 v[96:99], a[120:123], v[152:155], v[96:99]
    ds_read_b128 v[132:135], v245 offset:6976
    v_fma_f32 v182, |v122|, v74, v182
    v_mfma_f32_16x16x32_f16 v[96:99], a[124:127], v[156:159], v[96:99]
    ds_read_b128 v[128:131], v245 offset:6912
    v_fma_f32 v182, |v123|, v75, v182
    v_mfma_f32_16x16x32_f16 v[100:103], a[108:111], v[156:159], v[40:43]
    v_add_f32 v184, v184, v185
    v_fma_f32 v182, |v124|, v76, v182
    v_mfma_f32_16x16x32_f16 v[100:103], a[104:107], v[152:155], v[100:103]
    s_waitcnt lgkmcnt(4)
    v_fma_f32 v184, v224, s12, v184
    v_fma_f32 v182, |v125|, v77, v182
    v_mfma_f32_16x16x32_f16 v[100:103], a[100:103], v[148:151], v[100:103]
    v_permlane32_swap_b32 v188, v190
    v_mfma_f32_16x16x32_f16 v[100:103], a[96:99], v[144:147], v[100:103]
    v_permlane32_swap_b32 v189, v191
    v_mfma_f32_16x16x32_f16 v[104:107], a[80:83], v[144:147], v[36:39]
    v_add_f32 v188, v188, v190
    v_fma_f32 v182, |v126|, v78, v182
    v_mfma_f32_16x16x32_f16 v[104:107], a[84:87], v[148:151], v[104:107]
    v_add_f32 v189, v189, v191
    v_fma_f32 v182, |v127|, v79, v182
    v_mfma_f32_16x16x32_f16 v[104:107], a[88:91], v[152:155], v[104:107]
    v_permlane16_swap_b32 v188, v189
    v_mfma_f32_16x16x32_f16 v[104:107], a[92:95], v[156:159], v[104:107]
    v_add_f32 v188, v188, v189
    v_mul_f32 v183, |v96|, v76
    v_mfma_f32_16x16x32_f16 v[108:111], a[76:79], v[156:159], v[32:35]
    s_waitcnt lgkmcnt(0)
    v_pk_mul_f16 v128, v128, v80
    v_fma_f32 v183, |v97|, v77, v183
    v_mfma_f32_16x16x32_f16 v[108:111], a[72:75], v[152:155], v[108:111]
    v_pk_mul_f16 v129, v129, v81
    v_fma_f32 v183, |v98|, v78, v183
    v_mfma_f32_16x16x32_f16 v[108:111], a[68:71], v[148:151], v[108:111]
    v_pk_mul_f16 v130, v130, v82
    v_fma_f32 v183, |v99|, v79, v183
    v_mfma_f32_16x16x32_f16 v[108:111], a[64:67], v[144:147], v[108:111]
    v_pk_mul_f16 v131, v131, v83
    v_fma_f32 v183, |v100|, v72, v183
    v_mfma_f32_16x16x32_f16 v[112:115], a[48:51], v[144:147], v[28:31]
    v_pk_mul_f16 v132, v132, v84
    v_fma_f32 v183, |v101|, v73, v183
    v_mfma_f32_16x16x32_f16 v[112:115], a[52:55], v[148:151], v[112:115]
    v_pk_mul_f16 v133, v133, v85
    v_fma_f32 v183, |v102|, v74, v183
    v_mfma_f32_16x16x32_f16 v[112:115], a[56:59], v[152:155], v[112:115]
    v_pk_mul_f16 v134, v134, v86
    v_fma_f32 v183, |v103|, v75, v183
    v_mfma_f32_16x16x32_f16 v[112:115], a[60:63], v[156:159], v[112:115]
    v_pk_mul_f16 v135, v135, v87
    v_fma_f32 v183, |v104|, v68, v183
    v_mfma_f32_16x16x32_f16 v[116:119], a[44:47], v[156:159], v[24:27]
    v_pk_mul_f16 v136, v136, v88
    v_fma_f32 v183, |v105|, v69, v183
    v_mfma_f32_16x16x32_f16 v[116:119], a[40:43], v[152:155], v[116:119]
    v_pk_mul_f16 v137, v137, v89
    v_fma_f32 v183, |v106|, v70, v183
    v_mfma_f32_16x16x32_f16 v[116:119], a[36:39], v[148:151], v[116:119]
    v_pk_mul_f16 v138, v138, v90
    v_fma_f32 v183, |v107|, v71, v183
    v_mfma_f32_16x16x32_f16 v[116:119], a[32:35], v[144:147], v[116:119]
    v_pk_mul_f16 v139, v139, v91
    v_fma_f32 v183, |v108|, v64, v183
    v_mfma_f32_16x16x32_f16 v[120:123], a[16:19], v[144:147], v[20:23]
    v_pk_mul_f16 v140, v140, v92
    v_fma_f32 v183, |v109|, v65, v183
    v_mfma_f32_16x16x32_f16 v[120:123], a[20:23], v[148:151], v[120:123]
    v_pk_mul_f16 v141, v141, v93
    v_fma_f32 v183, |v110|, v66, v183
    v_mfma_f32_16x16x32_f16 v[120:123], a[24:27], v[152:155], v[120:123]
    v_pk_mul_f16 v142, v142, v94
    v_fma_f32 v183, |v111|, v67, v183
    v_mfma_f32_16x16x32_f16 v[120:123], a[28:31], v[156:159], v[120:123]
    v_pk_mul_f16 v143, v143, v95
    v_fma_f32 v183, |v112|, v60, v183
    v_mfma_f32_16x16x32_f16 v[124:127], a[12:15], v[156:159], v[16:19]
    v_fma_f32 v188, v226, s12, v188
    v_fma_f32 v183, |v113|, v61, v183
    v_mfma_f32_16x16x32_f16 v[124:127], a[8:11], v[152:155], v[124:127]
    v_cndmask_b32 v188, v251, v188, s[36:37]
    v_fma_f32 v183, |v114|, v62, v183
    v_mfma_f32_16x16x32_f16 v[124:127], a[4:7], v[148:151], v[124:127]
    v_permlane32_swap_b32 v176, v178
    v_mfma_f32_16x16x32_f16 v[124:127], a[0:3], v[144:147], v[124:127]
    v_permlane32_swap_b32 v177, v179
    v_mfma_f32_16x16x32_f16 v[96:99], a[0:3], v[128:131], v[16:19]
    ds_read_b128 v[156:159], v245 offset:7392
    v_fma_f32 v183, |v115|, v63, v183
    v_mfma_f32_16x16x32_f16 v[96:99], a[4:7], v[132:135], v[96:99]
    ds_read_b128 v[152:155], v245 offset:7328
    v_fma_f32 v183, |v116|, v56, v183
    v_mfma_f32_16x16x32_f16 v[96:99], a[8:11], v[136:139], v[96:99]
    ds_read_b128 v[148:151], v245 offset:7264
    v_fma_f32 v183, |v117|, v57, v183
    v_mfma_f32_16x16x32_f16 v[96:99], a[12:15], v[140:143], v[96:99]
    ds_read_b128 v[144:147], v245 offset:7200
    v_fma_f32 v183, |v118|, v58, v183
    v_mfma_f32_16x16x32_f16 v[100:103], a[28:31], v[140:143], v[20:23]
    v_add_f32 v176, v176, v178
    v_fma_f32 v183, |v119|, v59, v183
    v_mfma_f32_16x16x32_f16 v[100:103], a[24:27], v[136:139], v[100:103]
    v_add_f32 v177, v177, v179
    v_fma_f32 v183, |v120|, v52, v183
    v_mfma_f32_16x16x32_f16 v[100:103], a[20:23], v[132:135], v[100:103]
    v_permlane16_swap_b32 v176, v177
    v_mfma_f32_16x16x32_f16 v[100:103], a[16:19], v[128:131], v[100:103]
    v_add_f32 v176, v176, v177
    v_fma_f32 v183, |v121|, v53, v183
    v_mfma_f32_16x16x32_f16 v[104:107], a[32:35], v[128:131], v[24:27]
    v_fma_f32 v176, v220, s12, v176
    v_fma_f32 v183, |v122|, v54, v183
    v_mfma_f32_16x16x32_f16 v[104:107], a[36:39], v[132:135], v[104:107]
    v_max3_f32 v248, v184, v188, v176
    v_fma_f32 v183, |v123|, v55, v183
    v_mfma_f32_16x16x32_f16 v[104:107], a[40:43], v[136:139], v[104:107]
    v_fma_f32 v183, |v124|, v48, v183
    v_fma_f32 v183, |v125|, v49, v183
    v_mfma_f32_16x16x32_f16 v[104:107], a[44:47], v[140:143], v[104:107]
    v_fma_f32 v183, |v126|, v50, v183
    v_fma_f32 v183, |v127|, v51, v183
    v_mfma_f32_16x16x32_f16 v[108:111], a[60:63], v[140:143], v[28:31]
    s_waitcnt lgkmcnt(0)
    v_pk_mul_f16 v144, v144, v80
    v_mul_f32 v192, |v96|, v48
    v_mfma_f32_16x16x32_f16 v[108:111], a[56:59], v[136:139], v[108:111]
L_pad3:
    s_cbranch_execz L_hopret
    v_pk_mul_f16 v145, v145, v81
    v_fma_f32 v192, |v97|, v49, v192
    v_mfma_f32_16x16x32_f16 v[108:111], a[52:55], v[132:135], v[108:111]
    v_pk_mul_f16 v146, v146, v82
    v_fma_f32 v192, |v98|, v50, v192
    v_mfma_f32_16x16x32_f16 v[108:111], a[48:51], v[128:131], v[108:111]
    v_pk_mul_f16 v147, v147, v83
    v_fma_f32 v192, |v99|, v51, v192
    v_mfma_f32_16x16x32_f16 v[112:115], a[64:67], v[128:131], v[32:35]
    v_pk_mul_f16 v148, v148, v84
    v_fma_f32 v192, |v100|, v52, v192
    v_mfma_f32_16x16x32_f16 v[112:115], a[68:71], v[132:135], v[112:115]
    v_pk_mul_f16 v149, v149, v85
    v_fma_f32 v192, |v101|, v53, v192
    v_mfma_f32_16x16x32_f16 v[112:115], a[72:75], v[136:139], v[112:115]
    v_pk_mul_f16 v150, v150, v86
    v_fma_f32 v192, |v102|, v54, v192
    v_mfma_f32_16x16x32_f16 v[112:115], a[76:79], v[140:143], v[112:115]
    v_pk_mul_f16 v151, v151, v87
    v_fma_f32 v192, |v103|, v55, v192
    v_mfma_f32_16x16x32_f16 v[116:119], a[92:95], v[140:143], v[36:39]
    v_pk_mul_f16 v152, v152, v88
    v_fma_f32 v192, |v104|, v56, v192
    v_mfma_f32_16x16x32_f16 v[116:119], a[88:91], v[136:139], v[116:119]
    v_pk_mul_f16 v153, v153, v89
    v_fma_f32 v192, |v105|, v57, v192
    v_mfma_f32_16x16x32_f16 v[116:119], a[84:87], v[132:135], v[116:119]
    v_pk_mul_f16 v154, v154, v90
    v_fma_f32 v192, |v106|, v58, v192
    v_mfma_f32_16x16x32_f16 v[116:119], a[80:83], v[128:131], v[116:119]
    v_pk_mul_f16 v155, v155, v91
    v_fma_f32 v192, |v107|, v59, v192
    v_mfma_f32_16x16x32_f16 v[120:123], a[96:99], v[128:131], v[40:43]
    v_pk_mul_f16 v156, v156, v92
    v_fma_f32 v192, |v108|, v60, v192
    v_mfma_f32_16x16x32_f16 v[120:123], a[100:103], v[132:135], v[120:123]
    v_pk_mul_f16 v157, v157, v93
    v_fma_f32 v192, |v109|, v61, v192
    v_mfma_f32_16x16x32_f16 v[120:123], a[104:107], v[136:139], v[120:123]
    v_pk_mul_f16 v158, v158, v94
    v_fma_f32 v192, |v110|, v62, v192
    v_mfma_f32_16x16x32_f16 v[120:123], a[108:111], v[140:143], v[120:123]
    v_pk_mul_f16 v159, v159, v95
    v_fma_f32 v192, |v111|, v63, v192
    v_mfma_f32_16x16x32_f16 v[124:127], a[124:127], v[140:143], v[44:47]
    ds_read_b128 v[216:219], v239 offset:4800
    v_fma_f32 v192, |v112|, v64, v192
    v_mfma_f32_16x16x32_f16 v[124:127], a[120:123], v[136:139], v[124:127]
    ds_read_b128 v[212:215], v239 offset:4736
    v_fma_f32 v192, |v113|, v65, v192
    v_mfma_f32_16x16x32_f16 v[124:127], a[116:119], v[132:135], v[124:127]
    ds_read_b128 v[208:211], v239 offset:4672
    v_fma_f32 v192, |v114|, v66, v192
    v_mfma_f32_16x16x32_f16 v[124:127], a[112:115], v[128:131], v[124:127]
    ds_read_b128 v[204:207], v239 offset:4608
    v_fma_f32 v192, |v115|, v67, v192
    v_mfma_f32_16x16x32_f16 v[96:99], a[112:115], v[144:147], v[44:47]
    ds_read_b128 v[140:143], v240 offset:4800
    v_fma_f32 v192, |v116|, v68, v192
    v_mfma_f32_16x16x32_f16 v[96:99], a[116:119], v[148:151], v[96:99]
    ds_read_b128 v[136:139], v240 offset:4736
    v_fma_f32 v192, |v117|, v69, v192
    v_mfma_f32_16x16x32_f16 v[96:99], a[120:123], v[152:155], v[96:99]
    ds_read_b128 v[132:135], v240 offset:4672
    v_fma_f32 v192, |v118|, v70, v192
    v_mfma_f32_16x16x32_f16 v[96:99], a[124:127], v[156:159], v[96:99]
    ds_read_b128 v[128:131], v240 offset:4608
    v_fma_f32 v192, |v119|, v71, v192
    v_mfma_f32_16x16x32_f16 v[100:103], a[108:111], v[156:159], v[40:43]
    v_permlane32_swap_b32 v180, v182
    v_mfma_f32_16x16x32_f16 v[100:103], a[104:107], v[152:155], v[100:103]
    v_permlane32_swap_b32 v181, v183
    v_mfma_f32_16x16x32_f16 v[100:103], a[100:103], v[148:151], v[100:103]
    v_add_f32 v180, v180, v182
    v_fma_f32 v192, |v120|, v72, v192
    v_mfma_f32_16x16x32_f16 v[100:103], a[96:99], v[144:147], v[100:103]
    v_add_f32 v181, v181, v183
    v_fma_f32 v192, |v121|, v73, v192
    v_mfma_f32_16x16x32_f16 v[104:107], a[80:83], v[144:147], v[36:39]
    v_permlane16_swap_b32 v180, v181
    v_mfma_f32_16x16x32_f16 v[104:107], a[84:87], v[148:151], v[104:107]
    v_add_f32 v180, v180, v181
    v_fma_f32 v192, |v122|, v74, v192
    v_mfma_f32_16x16x32_f16 v[104:107], a[88:91], v[152:155], v[104:107]
    v_fma_f32 v180, v222, s12, v180
    v_fma_f32 v192, |v123|, v75, v192
    v_mfma_f32_16x16x32_f16 v[104:107], a[92:95], v[156:159], v[104:107]
    v_fma_f32 v192, |v124|, v76, v192
    v_fma_f32 v192, |v125|, v77, v192
    v_mfma_f32_16x16x32_f16 v[108:111], a[76:79], v[156:159], v[32:35]
    s_waitcnt lgkmcnt(0)
    v_pk_mul_f16 v128, v128, v204
    v_fma_f32 v192, |v126|, v78, v192
    v_mfma_f32_16x16x32_f16 v[108:111], a[72:75], v[152:155], v[108:111]
    v_pk_mul_f16 v129, v129, v205
    v_fma_f32 v192, |v127|, v79, v192
    v_mfma_f32_16x16x32_f16 v[108:111], a[68:71], v[148:151], v[108:111]
    v_pk_mul_f16 v130, v130, v206
    v_mul_f32 v194, |v96|, v76
    v_mfma_f32_16x16x32_f16 v[108:111], a[64:67], v[144:147], v[108:111]
    v_pk_mul_f16 v131, v131, v207
    v_fma_f32 v194, |v97|, v77, v194
    v_mfma_f32_16x16x32_f16 v[112:115], a[48:51], v[144:147], v[28:31]
    v_pk_mul_f16 v132, v132, v208
    v_fma_f32 v194, |v98|, v78, v194
    v_mfma_f32_16x16x32_f16 v[112:115], a[52:55], v[148:151], v[112:115]
    v_pk_mul_f16 v133, v133, v209
    v_fma_f32 v194, |v99|, v79, v194
    v_mfma_f32_16x16x32_f16 v[112:115], a[56:59], v[152:155], v[112:115]
    v_pk_mul_f16 v134, v134, v210
    v_fma_f32 v194, |v100|, v72, v194
    v_mfma_f32_16x16x32_f16 v[112:115], a[60:63], v[156:159], v[112:115]
    v_pk_mul_f16 v135, v135, v211
    v_fma_f32 v194, |v101|, v73, v194
    v_mfma_f32_16x16x32_f16 v[116:119], a[44:47], v[156:159], v[24:27]
    v_pk_mul_f16 v136, v136, v212
    v_fma_f32 v194, |v102|, v74, v194
    v_mfma_f32_16x16x32_f16 v[116:119], a[40:43], v[152:155], v[116:119]
    v_pk_mul_f16 v137, v137, v213
    v_fma_f32 v194, |v103|, v75, v194
    v_mfma_f32_16x16x32_f16 v[116:119], a[36:39], v[148:151], v[116:119]
    v_pk_mul_f16 v138, v138, v214
    v_fma_f32 v194, |v104|, v68, v194
    v_mfma_f32_16x16x32_f16 v[116:119], a[32:35], v[144:147], v[116:119]
    v_pk_mul_f16 v139, v139, v215
    v_fma_f32 v194, |v105|, v69, v194
    v_mfma_f32_16x16x32_f16 v[120:123], a[16:19], v[144:147], v[20:23]
    v_pk_mul_f16 v140, v140, v216
    v_fma_f32 v194, |v106|, v70, v194
    v_mfma_f32_16x16x32_f16 v[120:123], a[20:23], v[148:151], v[120:123]
    v_pk_mul_f16 v141, v141, v217
    v_fma_f32 v194, |v107|, v71, v194
    v_mfma_f32_16x16x32_f16 v[120:123], a[24:27], v[152:155], v[120:123]
    v_pk_mul_f16 v142, v142, v218
    v_fma_f32 v194, |v108|, v64, v194
    v_mfma_f32_16x16x32_f16 v[120:123], a[28:31], v[156:159], v[120:123]
    v_pk_mul_f16 v143, v143, v219
    v_fma_f32 v194, |v109|, v65, v194
    v_mfma_f32_16x16x32_f16 v[124:127], a[12:15], v[156:159], v[16:19]
    ds_read_b128 v[216:219], v243 offset:4800
    v_fma_f32 v194, |v110|, v66, v194
    v_mfma_f32_16x16x32_f16 v[124:127], a[8:11], v[152:155], v[124:127]
    ds_read_b128 v[212:215], v243 offset:4736
    v_fma_f32 v194, |v111|, v67, v194
    v_mfma_f32_16x16x32_f16 v[124:127], a[4:7], v[148:151], v[124:127]
    ds_read_b128 v[208:211], v243 offset:4672
    v_fma_f32 v194, |v112|, v60, v194
    v_mfma_f32_16x16x32_f16 v[124:127], a[0:3], v[144:147], v[124:127]
    ds_read_b128 v[204:207], v243 offset:4608
    v_fma_f32 v194, |v113|, v61, v194
    v_mfma_f32_16x16x32_f16 v[96:99], a[0:3], v[128:131], v[16:19]
    ds_read_b128 v[156:159], v244 offset:4800
    v_fma_f32 v194, |v114|, v62, v194
    v_mfma_f32_16x16x32_f16 v[96:99], a[4:7], v[132:135], v[96:99]
    ds_read_b128 v[152:155], v244 offset:4736
    v_fma_f32 v194, |v115|, v63, v194
    v_mfma_f32_16x16x32_f16 v[96:99], a[8:11], v[136:139], v[96:99]
    ds_read_b128 v[148:151], v244 offset:4672
    v_fma_f32 v194, |v116|, v56, v194
    v_mfma_f32_16x16x32_f16 v[96:99], a[12:15], v[140:143], v[96:99]
    ds_read_b128 v[144:147], v244 offset:4608
    v_fma_f32 v194, |v117|, v57, v194
    v_mfma_f32_16x16x32_f16 v[100:103], a[28:31], v[140:143], v[20:23]
    v_fma_f32 v194, |v118|, v58, v194
    v_fma_f32 v194, |v119|, v59, v194
    v_mfma_f32_16x16x32_f16 v[100:103], a[24:27], v[136:139], v[100:103]
    v_fma_f32 v194, |v120|, v52, v194
    v_fma_f32 v194, |v121|, v53, v194
    v_mfma_f32_16x16x32_f16 v[100:103], a[20:23], v[132:135], v[100:103]
    v_fma_f32 v194, |v122|, v54, v194
    v_fma_f32 v194, |v123|, v55, v194
    v_mfma_f32_16x16x32_f16 v[100:103], a[16:19], v[128:131], v[100:103]
    v_fma_f32 v194, |v124|, v48, v194
    v_fma_f32 v194, |v125|, v49, v194
    v_mfma_f32_16x16x32_f16 v[104:107], a[32:35], v[128:131], v[24:27]
    v_fma_f32 v194, |v126|, v50, v194
    v_mfma_f32_16x16x32_f16 v[104:107], a[36:39], v[132:135], v[104:107]
    v_fma_f32 v194, |v127|, v51, v194
    v_mul_f32 v196, |v96|, v48
    v_mfma_f32_16x16x32_f16 v[104:107], a[40:43], v[136:139], v[104:107]
    v_permlane32_swap_b32 v192, v194
    v_mfma_f32_16x16x32_f16 v[104:107], a[44:47], v[140:143], v[104:107]
    v_add_f32 v192, v192, v194
    v_fma_f32 v196, |v97|, v49, v196
    v_mfma_f32_16x16x32_f16 v[108:111], a[60:63], v[140:143], v[28:31]
    s_waitcnt lgkmcnt(0)
    v_pk_mul_f16 v144, v144, v204
    v_fma_f32 v196, |v98|, v50, v196
    v_mfma_f32_16x16x32_f16 v[108:111], a[56:59], v[136:139], v[108:111]
    v_pk_mul_f16 v145, v145, v205
    v_fma_f32 v196, |v99|, v51, v196
    v_mfma_f32_16x16x32_f16 v[108:111], a[52:55], v[132:135], v[108:111]
    v_pk_mul_f16 v146, v146, v206
    v_fma_f32 v196, |v100|, v52, v196
    v_mfma_f32_16x16x32_f16 v[108:111], a[48:51], v[128:131], v[108:111]
    v_pk_mul_f16 v147, v147, v207
    v_fma_f32 v196, |v101|, v53, v196
    v_mfma_f32_16x16x32_f16 v[112:115], a[64:67], v[128:131], v[32:35]
    v_pk_mul_f16 v148, v148, v208
    v_fma_f32 v196, |v102|, v54, v196
    v_mfma_f32_16x16x32_f16 v[112:115], a[68:71], v[132:135], v[112:115]
    v_pk_mul_f16 v149, v149, v209
    v_fma_f32 v196, |v103|, v55, v196
    v_mfma_f32_16x16x32_f16 v[112:115], a[72:75], v[136:139], v[112:115]
    v_pk_mul_f16 v150, v150, v210
    v_fma_f32 v196, |v104|, v56, v196
    v_mfma_f32_16x16x32_f16 v[112:115], a[76:79], v[140:143], v[112:115]
    v_pk_mul_f16 v151, v151, v211
    v_fma_f32 v196, |v105|, v57, v196
    v_mfma_f32_16x16x32_f16 v[116:119], a[92:95], v[140:143], v[36:39]
    v_pk_mul_f16 v152, v152, v212
    v_fma_f32 v196, |v106|, v58, v196
    v_mfma_f32_16x16x32_f16 v[116:119], a[88:91], v[136:139], v[116:119]
    v_pk_mul_f16 v153, v153, v213
    v_fma_f32 v196, |v107|, v59, v196
    v_mfma_f32_16x16x32_f16 v[116:119], a[84:87], v[132:135], v[116:119]
    v_pk_mul_f16 v154, v154, v214
    v_fma_f32 v196, |v108|, v60, v196
    v_mfma_f32_16x16x32_f16 v[116:119], a[80:83], v[128:131], v[116:119]
    v_pk_mul_f16 v155, v155, v215
    v_fma_f32 v196, |v109|, v61, v196
    v_mfma_f32_16x16x32_f16 v[120:123], a[96:99], v[128:131], v[40:43]
    v_pk_mul_f16 v156, v156, v216
    v_fma_f32 v196, |v110|, v62, v196
    v_mfma_f32_16x16x32_f16 v[120:123], a[100:103], v[132:135], v[120:123]
    v_pk_mul_f16 v157, v157, v217
    v_fma_f32 v196, |v111|, v63, v196
    v_mfma_f32_16x16x32_f16 v[120:123], a[104:107], v[136:139], v[120:123]
    v_pk_mul_f16 v158, v158, v218
    v_fma_f32 v196, |v112|, v64, v196
    v_mfma_f32_16x16x32_f16 v[120:123], a[108:111], v[140:143], v[120:123]
    v_pk_mul_f16 v159, v159, v219
    v_fma_f32 v196, |v113|, v65, v196
    v_mfma_f32_16x16x32_f16 v[124:127], a[124:127], v[140:143], v[44:47]
    ds_read_b128 v[216:219], v241 offset:4800
    v_fma_f32 v196, |v114|, v66, v196
    v_mfma_f32_16x16x32_f16 v[124:127], a[120:123], v[136:139], v[124:127]
    ds_read_b128 v[212:215], v241 offset:4736
    v_fma_f32 v196, |v115|, v67, v196
    v_mfma_f32_16x16x32_f16 v[124:127], a[116:119], v[132:135], v[124:127]
    ds_read_b128 v[208:211], v241 offset:4672
    v_fma_f32 v196, |v116|, v68, v196
    v_mfma_f32_16x16x32_f16 v[124:127], a[112:115], v[128:131], v[124:127]
    ds_read_b128 v[204:207], v241 offset:4608
    v_fma_f32 v196, |v117|, v69, v196
    v_mfma_f32_16x16x32_f16 v[96:99], a[112:115], v[144:147], v[44:47]
    ds_read_b128 v[140:143], v242 offset:4800
    v_fma_f32 v196, |v118|, v70, v196
    v_mfma_f32_16x16x32_f16 v[96:99], a[116:119], v[148:151], v[96:99]
    ds_read_b128 v[136:139], v242 offset:4736
    v_fma_f32 v196, |v119|, v71, v196
    v_mfma_f32_16x16x32_f16 v[96:99], a[120:123], v[152:155], v[96:99]
    ds_read_b128 v[132:135], v242 offset:4672
    v_fma_f32 v196, |v120|, v72, v196
    v_mfma_f32_16x16x32_f16 v[96:99], a[124:127], v[156:159], v[96:99]
    ds_read_b128 v[128:131], v242 offset:4608
    v_fma_f32 v196, |v121|, v73, v196
    v_mfma_f32_16x16x32_f16 v[100:103], a[108:111], v[156:159], v[40:43]
    v_mov_b32 v193, v192
    v_fma_f32 v196, |v122|, v74, v196
    v_mfma_f32_16x16x32_f16 v[100:103], a[104:107], v[152:155], v[100:103]
    v_permlane16_swap_b32 v192, v193
    v_mfma_f32_16x16x32_f16 v[100:103], a[100:103], v[148:151], v[100:103]
    v_add_f32 v192, v192, v193
    v_fma_f32 v196, |v123|, v75, v196
    v_mfma_f32_16x16x32_f16 v[100:103], a[96:99], v[144:147], v[100:103]
    v_fma_f32 v192, v228, s12, v192
    v_fma_f32 v196, |v124|, v76, v196
    v_mfma_f32_16x16x32_f16 v[104:107], a[80:83], v[144:147], v[36:39]
    v_cndmask_b32 v192, v251, v192, s[38:39]
    v_fma_f32 v196, |v125|, v77, v196
    v_mfma_f32_16x16x32_f16 v[104:107], a[84:87], v[148:151], v[104:107]
    v_max3_f32 v248, v248, v180, v192
    v_fma_f32 v196, |v126|, v78, v196
    v_mfma_f32_16x16x32_f16 v[104:107], a[88:91], v[152:155], v[104:107]
    v_max_f32_dpp v248, v248, v248 row_ror:8 row_mask:0xf bank_mask:0xf
    v_fma_f32 v196, |v127|, v79, v196
    v_mfma_f32_16x16x32_f16 v[104:107], a[92:95], v[156:159], v[104:107]
    v_max_f32_dpp v248, v248, v248 row_ror:4 row_mask:0xf bank_mask:0xf
    v_mul_f32 v198, |v96|, v76
    v_mfma_f32_16x16x32_f16 v[108:111], a[76:79], v[156:159], v[32:35]
    s_waitcnt lgkmcnt(0)
    v_pk_mul_f16 v128, v128, v204
    v_fma_f32 v198, |v97|, v77, v198
    v_mfma_f32_16x16x32_f16 v[108:111], a[72:75], v[152:155], v[108:111]
    v_pk_mul_f16 v129, v129, v205
    v_fma_f32 v198, |v98|, v78, v198
    v_mfma_f32_16x16x32_f16 v[108:111], a[68:71], v[148:151], v[108:111]
    v_pk_mul_f16 v130, v130, v206
    v_fma_f32 v198, |v99|, v79, v198
    v_mfma_f32_16x16x32_f16 v[108:111], a[64:67], v[144:147], v[108:111]
    v_pk_mul_f16 v131, v131, v207
    v_fma_f32 v198, |v100|, v72, v198
    v_mfma_f32_16x16x32_f16 v[112:115], a[48:51], v[144:147], v[28:31]
    v_pk_mul_f16 v132, v132, v208
    v_fma_f32 v198, |v101|, v73, v198
    v_mfma_f32_16x16x32_f16 v[112:115], a[52:55], v[148:151], v[112:115]
    v_pk_mul_f16 v133, v133, v209
    v_fma_f32 v198, |v102|, v74, v198
    v_mfma_f32_16x16x32_f16 v[112:115], a[56:59], v[152:155], v[112:115]
    v_pk_mul_f16 v134, v134, v210
    v_fma_f32 v198, |v103|, v75, v198
    v_mfma_f32_16x16x32_f16 v[112:115], a[60:63], v[156:159], v[112:115]
    v_pk_mul_f16 v135, v135, v211
    v_fma_f32 v198, |v104|, v68, v198
    v_mfma_f32_16x16x32_f16 v[116:119], a[44:47], v[156:159], v[24:27]
    v_pk_mul_f16 v136, v136, v212
    v_fma_f32 v198, |v105|, v69, v198
    v_mfma_f32_16x16x32_f16 v[116:119], a[40:43], v[152:155], v[116:119]
    v_pk_mul_f16 v137, v137, v213
    v_fma_f32 v198, |v106|, v70, v198
    v_mfma_f32_16x16x32_f16 v[116:119], a[36:39], v[148:151], v[116:119]
    v_pk_mul_f16 v138, v138, v214
    v_fma_f32 v198, |v107|, v71, v198
    v_mfma_f32_16x16x32_f16 v[116:119], a[32:35], v[144:147], v[116:119]
    v_pk_mul_f16 v139, v139, v215
    v_fma_f32 v198, |v108|, v64, v198
    v_mfma_f32_16x16x32_f16 v[120:123], a[16:19], v[144:147], v[20:23]
    v_pk_mul_f16 v140, v140, v216
    v_fma_f32 v198, |v109|, v65, v198
    v_mfma_f32_16x16x32_f16 v[120:123], a[20:23], v[148:151], v[120:123]
    v_pk_mul_f16 v141, v141, v217
    v_fma_f32 v198, |v110|, v66, v198
    v_mfma_f32_16x16x32_f16 v[120:123], a[24:27], v[152:155], v[120:123]
    v_pk_mul_f16 v142, v142, v218
    v_fma_f32 v198, |v111|, v67, v198
    v_mfma_f32_16x16x32_f16 v[120:123], a[28:31], v[156:159], v[120:123]
    v_pk_mul_f16 v143, v143, v219
    v_fma_f32 v198, |v112|, v60, v198
    v_mfma_f32_16x16x32_f16 v[124:127], a[12:15], v[156:159], v[16:19]
    v_max_f32_dpp v248, v248, v248 row_ror:2 row_mask:0xf bank_mask:0xf
    v_fma_f32 v198, |v113|, v61, v198
    v_mfma_f32_16x16x32_f16 v[124:127], a[8:11], v[152:155], v[124:127]
    v_max_f32_dpp v248, v248, v248 row_ror:1 row_mask:0xf bank_mask:0xf
    v_fma_f32 v198, |v114|, v62, v198
    v_mfma_f32_16x16x32_f16 v[124:127], a[4:7], v[148:151], v[124:127]
    v_max_f32_dpp v248, v248, v248 row_bcast:15 row_mask:0xa bank_mask:0xf
    v_fma_f32 v198, |v115|, v63, v198
    v_mfma_f32_16x16x32_f16 v[124:127], a[0:3], v[144:147], v[124:127]
    v_max_f32_dpp v248, v248, v248 row_bcast:31 row_mask:0xc bank_mask:0xf
    v_fma_f32 v198, |v116|, v56, v198
    v_mfma_f32_16x16x32_f16 v[96:99], a[0:3], v[128:131], v[16:19]
    v_readlane_b32 s14, v248, 63
    v_fma_f32 v198, |v117|, v57, v198
    v_mfma_f32_16x16x32_f16 v[96:99], a[4:7], v[132:135], v[96:99]
    v_subrev_f32 v184, s14, v184
    v_fma_f32 v198, |v118|, v58, v198
    v_mfma_f32_16x16x32_f16 v[96:99], a[8:11], v[136:139], v[96:99]
    v_subrev_f32 v188, s14, v188
    v_fma_f32 v198, |v119|, v59, v198
    v_mfma_f32_16x16x32_f16 v[96:99], a[12:15], v[140:143], v[96:99]
    v_subrev_f32 v176, s14, v176
    v_fma_f32 v198, |v120|, v52, v198
    v_mfma_f32_16x16x32_f16 v[100:103], a[28:31], v[140:143], v[20:23]
    v_subrev_f32 v180, s14, v180
    v_fma_f32 v198, |v121|, v53, v198
    v_mfma_f32_16x16x32_f16 v[100:103], a[24:27], v[136:139], v[100:103]
    v_subrev_f32 v192, s14, v192
    v_fma_f32 v198, |v122|, v54, v198
    v_mfma_f32_16x16x32_f16 v[100:103], a[20:23], v[132:135], v[100:103]
    v_mul_f32 v184, s55, v184
    v_fma_f32 v198, |v123|, v55, v198
    v_mfma_f32_16x16x32_f16 v[100:103], a[16:19], v[128:131], v[100:103]
    v_mul_f32 v188, s55, v188
    v_fma_f32 v198, |v124|, v48, v198
    v_mfma_f32_16x16x32_f16 v[104:107], a[32:35], v[128:131], v[24:27]
    v_mul_f32 v176, s55, v176
    v_fma_f32 v198, |v125|, v49, v198
    v_mfma_f32_16x16x32_f16 v[104:107], a[36:39], v[132:135], v[104:107]
    v_mul_f32 v180, s55, v180
    v_fma_f32 v198, |v126|, v50, v198
    v_mfma_f32_16x16x32_f16 v[104:107], a[40:43], v[136:139], v[104:107]
    v_mul_f32 v192, s55, v192
    v_fma_f32 v198, |v127|, v51, v198
    v_mfma_f32_16x16x32_f16 v[104:107], a[44:47], v[140:143], v[104:107]
    v_exp_f32 v184, v184
    v_mfma_f32_16x16x32_f16 v[108:111], a[60:63], v[140:143], v[28:31]
    v_exp_f32 v188, v188
    v_mfma_f32_16x16x32_f16 v[108:111], a[56:59], v[136:139], v[108:111]
    v_exp_f32 v176, v176
    v_mfma_f32_16x16x32_f16 v[108:111], a[52:55], v[132:135], v[108:111]
    v_exp_f32 v180, v180
    v_mfma_f32_16x16x32_f16 v[108:111], a[48:51], v[128:131], v[108:111]
    v_exp_f32 v192, v192
    v_mfma_f32_16x16x32_f16 v[112:115], a[64:67], v[128:131], v[32:35]
    v_add_f32 v249, v184, v188
    v_mul_f32 v197, |v96|, v48
    v_mfma_f32_16x16x32_f16 v[112:115], a[68:71], v[132:135], v[112:115]
    v_mul_f32 v250, v184, v225
    v_mul_f32 v200, |v97|, v49
    v_mfma_f32_16x16x32_f16 v[112:115], a[72:75], v[136:139], v[112:115]
    v_fmac_f32 v250, v188, v227
    v_fma_f32 v197, |v98|, v50, v197
    v_mfma_f32_16x16x32_f16 v[112:115], a[76:79], v[140:143], v[112:115]
    v_add_f32 v249, v249, v176
    v_fma_f32 v200, |v99|, v51, v200
    v_mfma_f32_16x16x32_f16 v[116:119], a[92:95], v[140:143], v[36:39]
    v_fmac_f32 v250, v176, v221
    v_fma_f32 v197, |v100|, v52, v197
    v_mfma_f32_16x16x32_f16 v[116:119], a[88:91], v[136:139], v[116:119]
    v_add_f32 v249, v249, v180
    v_fma_f32 v200, |v101|, v53, v200
    v_mfma_f32_16x16x32_f16 v[116:119], a[84:87], v[132:135], v[116:119]
    v_fmac_f32 v250, v180, v223
    v_fma_f32 v197, |v102|, v54, v197
    v_mfma_f32_16x16x32_f16 v[116:119], a[80:83], v[128:131], v[116:119]
    v_add_f32 v249, v249, v192
    v_fma_f32 v200, |v103|, v55, v200
    v_mfma_f32_16x16x32_f16 v[120:123], a[96:99], v[128:131], v[40:43]
    v_fmac_f32 v250, v192, v229
    s_lshl_b32 s6, s4, 1
    v_fma_f32 v197, |v104|, v56, v197
    v_mfma_f32_16x16x32_f16 v[120:123], a[100:103], v[132:135], v[120:123]
    v_mov_b32 v2, s6
    v_fma_f32 v200, |v105|, v57, v200
    v_mfma_f32_16x16x32_f16 v[120:123], a[104:107], v[136:139], v[120:123]
    v_permlane32_swap_b32 v196, v198
    v_mfma_f32_16x16x32_f16 v[120:123], a[108:111], v[140:143], v[120:123]
    v_add_f32 v196, v196, v198
    v_fma_f32 v197, |v106|, v58, v197
    v_mfma_f32_16x16x32_f16 v[124:127], a[124:127], v[140:143], v[44:47]
    v_fma_f32 v200, |v107|, v59, v200
    v_fma_f32 v197, |v108|, v60, v197
    v_mfma_f32_16x16x32_f16 v[124:127], a[120:123], v[136:139], v[124:127]
    v_fma_f32 v200, |v109|, v61, v200
    v_fma_f32 v197, |v110|, v62, v197
    v_mfma_f32_16x16x32_f16 v[124:127], a[116:119], v[132:135], v[124:127]
    v_fma_f32 v200, |v111|, v63, v200
    v_fma_f32 v197, |v112|, v64, v197
    v_mfma_f32_16x16x32_f16 v[124:127], a[112:115], v[128:131], v[124:127]
    v_fma_f32 v200, |v113|, v65, v200
    v_fma_f32 v197, |v114|, v66, v197
    v_fma_f32 v200, |v115|, v67, v200
    v_fma_f32 v197, |v116|, v68, v197
    v_fma_f32 v200, |v117|, v69, v200
    v_fma_f32 v197, |v118|, v70, v197
    v_fma_f32 v200, |v119|, v71, v200
    v_fma_f32 v197, |v120|, v72, v197
    v_fma_f32 v200, |v121|, v73, v200
    v_fma_f32 v197, |v122|, v74, v197
    v_fma_f32 v200, |v123|, v75, v200
    v_fma_f32 v197, |v124|, v76, v197
    v_fma_f32 v200, |v125|, v77, v200
    v_fma_f32 v197, |v126|, v78, v197
    v_fma_f32 v200, |v127|, v79, v200
    v_add_f32 v197, v197, v200
    s_nop 1
    v_permlane32_swap_b32 v197, v199
    v_add_f32 v197, v197, v199
    s_nop 1
    v_permlane16_swap_b32 v196, v197
    v_fma_f32 v196, v230, s12, v196
    v_add_f32 v196, v196, v197
    v_cndmask_b32 v196, v251, v196, s[40:41]
    v_subrev_f32 v197, s14, v196
    v_mul_f32 v197, s55, v197
    v_cmp_lt_f32 vcc, 4.0, v197
    v_exp_f32 v197, v197
    s_cbranch_vccnz L_tailmax
    v_add_f32 v249, v249, v197
    v_fmac_f32 v250, v197, v231
L_tailsum:
    s_nop 0
    v_add_f32_dpp v249, v249, v249 row_ror:8 row_mask:0xf bank_mask:0xf
    v_add_f32_dpp v250, v250, v250 row_ror:8 row_mask:0xf bank_mask:0xf
    s_nop 0
    v_add_f32_dpp v249, v249, v249 row_ror:4 row_mask:0xf bank_mask:0xf
    v_add_f32_dpp v250, v250, v250 row_ror:4 row_mask:0xf bank_mask:0xf
    s_nop 0
    v_add_f32_dpp v249, v249, v249 row_ror:2 row_mask:0xf bank_mask:0xf
    v_add_f32_dpp v250, v250, v250 row_ror:2 row_mask:0xf bank_mask:0xf
    s_nop 0
    v_add_f32_dpp v249, v249, v249 row_ror:1 row_mask:0xf bank_mask:0xf
    v_add_f32_dpp v250, v250, v250 row_ror:1 row_mask:0xf bank_mask:0xf
    s_nop 0
    v_add_f32_dpp v249, v249, v249 row_bcast:15 row_mask:0xa bank_mask:0xf
    v_add_f32_dpp v250, v250, v250 row_bcast:15 row_mask:0xa bank_mask:0xf
    s_nop 0
    v_add_f32_dpp v249, v249, v249 row_bcast:31 row_mask:0xc bank_mask:0xf
    v_add_f32_dpp v250, v250, v250 row_bcast:31 row_mask:0xc bank_mask:0xf
    v_rcp_f32 v249, v249
    v_ldexp_f32 v250, v250, s11
    s_mov_b32 exec_lo, 0
    s_mov_b32 exec_hi, 0x80000000
    v_mul_f32 v250, v250, v249
    v_cvt_pk_bf16_f32 v250, v250, v250
    global_store_short v2, v250, s[32:33]
L_end:
    s_endpgm
L_wfix:
    s_waitcnt lgkmcnt(0)
    s_nop 7
    s_mov_b32 s8, 0x07060302
    v_mov_b32 v121, 0
    v_and_b32 v122, s44, v48
    v_pk_max_u16 v121, v121, v122
    v_and_b32 v122, s44, v49
    v_pk_max_u16 v121, v121, v122
    v_and_b32 v122, s44, v50
    v_pk_max_u16 v121, v121, v122
    v_and_b32 v122, s44, v51
    v_pk_max_u16 v121, v121, v122
    v_and_b32 v122, s44, v52
    v_pk_max_u16 v121, v121, v122
    v_and_b32 v122, s44, v53
    v_pk_max_u16 v121, v121, v122
    v_and_b32 v122, s44, v54
    v_pk_max_u16 v121, v121, v122
    v_and_b32 v122, s44, v55
    v_pk_max_u16 v121, v121, v122
    v_and_b32 v122, s44, v56
    v_pk_max_u16 v121, v121, v122
    v_and_b32 v122, s44, v57
    v_pk_max_u16 v121, v121, v122
    v_and_b32 v122, s44, v58
    v_pk_max_u16 v121, v121, v122
    v_and_b32 v122, s44, v59
    v_pk_max_u16 v121, v121, v122
    v_and_b32 v122, s44, v60
    v_pk_max_u16 v121, v121, v122
    v_and_b32 v122, s44, v61
    v_pk_max_u16 v121, v121, v122
    v_and_b32 v122, s44, v62
    v_pk_max_u16 v121, v121, v122
    v_and_b32 v122, s44, v63
    v_pk_max_u16 v121, v121, v122
    v_and_b32 v122, s44, v64
    v_pk_max_u16 v121, v121, v122
    v_and_b32 v122, s44, v65
    v_pk_max_u16 v121, v121, v122
    v_and_b32 v122, s44, v66
    v_pk_max_u16 v121, v121, v122
    v_and_b32 v122, s44, v67
    v_pk_max_u16 v121, v121, v122
    v_and_b32 v122, s44, v68
    v_pk_max_u16 v121, v121, v122
    v_and_b32 v122, s44, v69
    v_pk_max_u16 v121, v121, v122
    v_and_b32 v122, s44, v70
    v_pk_max_u16 v121, v121, v122
    v_and_b32 v122, s44, v71
    v_pk_max_u16 v121, v121, v122
    v_and_b32 v122, s44, v72
    v_pk_max_u16 v121, v121, v122
    v_and_b32 v122, s44, v73
    v_pk_max_u16 v121, v121, v122
    v_and_b32 v122, s44, v74
    v_pk_max_u16 v121, v121, v122
    v_and_b32 v122, s44, v75
    v_pk_max_u16 v121, v121, v122
    v_and_b32 v122, s44, v76
    v_pk_max_u16 v121, v121, v122
    v_and_b32 v122, s44, v77
    v_pk_max_u16 v121, v121, v122
    v_and_b32 v122, s44, v78
    v_pk_max_u16 v121, v121, v122
    v_and_b32 v122, s44, v79
    v_pk_max_u16 v121, v121, v122
    s_barrier
    ds_write_b32 v3, v121 offset:39424
    s_waitcnt lgkmcnt(0)
    s_barrier
    ds_read_b128 v[112:115], v127 offset:39424
    s_waitcnt lgkmcnt(0)
    v_pk_max_u16 v121, v121, v112
    v_pk_max_u16 v121, v121, v113
    v_pk_max_u16 v121, v121, v114
    v_pk_max_u16 v121, v121, v115
    s_barrier
    v_pk_max_u16 v121, v121, v121 op_sel:[0,1] op_sel_hi:[1,0]
    s_nop 1
    v_max_u32_dpp v121, v121, v121 row_ror:8 row_mask:0xf bank_mask:0xf
    s_nop 1
    v_max_u32_dpp v121, v121, v121 row_ror:4 row_mask:0xf bank_mask:0xf
    s_nop 1
    v_max_u32_dpp v121, v121, v121 row_ror:2 row_mask:0xf bank_mask:0xf
    s_nop 1
    v_max_u32_dpp v121, v121, v121 row_ror:1 row_mask:0xf bank_mask:0xf
    s_nop 1
    v_max_u32_dpp v121, v121, v121 row_bcast:15 row_mask:0xa bank_mask:0xf
    s_nop 1
    v_max_u32_dpp v121, v121, v121 row_bcast:31 row_mask:0xc bank_mask:0xf
    s_nop 0
    v_readlane_b32 s6, v121, 63
    s_nop 0
    s_bfe_u32 s6, s6, 0x80007
    s_max_u32 s6, s6, 87
    s_sub_u32 s47, 127, s6
    s_sub_u32 s7, 0, s47
    v_lshlrev_b32 v121, 16, v48
    v_and_b32 v122, s46, v48
    v_ldexp_f32 v121, v121, s47
    v_ldexp_f32 v122, v122, s47
    v_perm_b32 v48, v122, v121, s8
    v_lshlrev_b32 v121, 16, v49
    v_and_b32 v122, s46, v49
    v_ldexp_f32 v121, v121, s47
    v_ldexp_f32 v122, v122, s47
    v_perm_b32 v49, v122, v121, s8
    v_lshlrev_b32 v121, 16, v50
    v_and_b32 v122, s46, v50
    v_ldexp_f32 v121, v121, s47
    v_ldexp_f32 v122, v122, s47
    v_perm_b32 v50, v122, v121, s8
    v_lshlrev_b32 v121, 16, v51
    v_and_b32 v122, s46, v51
    v_ldexp_f32 v121, v121, s47
    v_ldexp_f32 v122, v122, s47
    v_perm_b32 v51, v122, v121, s8
    v_lshlrev_b32 v121, 16, v52
    v_and_b32 v122, s46, v52
    v_ldexp_f32 v121, v121, s47
    v_ldexp_f32 v122, v122, s47
    v_perm_b32 v52, v122, v121, s8
    v_lshlrev_b32 v121, 16, v53
    v_and_b32 v122, s46, v53
    v_ldexp_f32 v121, v121, s47
    v_ldexp_f32 v122, v122, s47
    v_perm_b32 v53, v122, v121, s8
    v_lshlrev_b32 v121, 16, v54
    v_and_b32 v122, s46, v54
    v_ldexp_f32 v121, v121, s47
    v_ldexp_f32 v122, v122, s47
    v_perm_b32 v54, v122, v121, s8
    v_lshlrev_b32 v121, 16, v55
    v_and_b32 v122, s46, v55
    v_ldexp_f32 v121, v121, s47
    v_ldexp_f32 v122, v122, s47
    v_perm_b32 v55, v122, v121, s8
    v_lshlrev_b32 v121, 16, v56
    v_and_b32 v122, s46, v56
    v_ldexp_f32 v121, v121, s47
    v_ldexp_f32 v122, v122, s47
    v_perm_b32 v56, v122, v121, s8
    v_lshlrev_b32 v121, 16, v57
    v_and_b32 v122, s46, v57
    v_ldexp_f32 v121, v121, s47
    v_ldexp_f32 v122, v122, s47
    v_perm_b32 v57, v122, v121, s8
    v_lshlrev_b32 v121, 16, v58
    v_and_b32 v122, s46, v58
    v_ldexp_f32 v121, v121, s47
    v_ldexp_f32 v122, v122, s47
    v_perm_b32 v58, v122, v121, s8
    v_lshlrev_b32 v121, 16, v59
    v_and_b32 v122, s46, v59
    v_ldexp_f32 v121, v121, s47
    v_ldexp_f32 v122, v122, s47
    v_perm_b32 v59, v122, v121, s8
    v_lshlrev_b32 v121, 16, v60
    v_and_b32 v122, s46, v60
    v_ldexp_f32 v121, v121, s47
    v_ldexp_f32 v122, v122, s47
    v_perm_b32 v60, v122, v121, s8
    v_lshlrev_b32 v121, 16, v61
    v_and_b32 v122, s46, v61
    v_ldexp_f32 v121, v121, s47
    v_ldexp_f32 v122, v122, s47
    v_perm_b32 v61, v122, v121, s8
    v_lshlrev_b32 v121, 16, v62
    v_and_b32 v122, s46, v62
    v_ldexp_f32 v121, v121, s47
    v_ldexp_f32 v122, v122, s47
    v_perm_b32 v62, v122, v121, s8
    v_lshlrev_b32 v121, 16, v63
    v_and_b32 v122, s46, v63
    v_ldexp_f32 v121, v121, s47
    v_ldexp_f32 v122, v122, s47
    v_perm_b32 v63, v122, v121, s8
    v_lshlrev_b32 v121, 16, v64
    v_and_b32 v122, s46, v64
    v_ldexp_f32 v121, v121, s47
    v_ldexp_f32 v122, v122, s47
    v_perm_b32 v64, v122, v121, s8
    v_lshlrev_b32 v121, 16, v65
    v_and_b32 v122, s46, v65
    v_ldexp_f32 v121, v121, s47
    v_ldexp_f32 v122, v122, s47
    v_perm_b32 v65, v122, v121, s8
    v_lshlrev_b32 v121, 16, v66
    v_and_b32 v122, s46, v66
    v_ldexp_f32 v121, v121, s47
    v_ldexp_f32 v122, v122, s47
    v_perm_b32 v66, v122, v121, s8
    v_lshlrev_b32 v121, 16, v67
    v_and_b32 v122, s46, v67
    v_ldexp_f32 v121, v121, s47
    v_ldexp_f32 v122, v122, s47
    v_perm_b32 v67, v122, v121, s8
    v_lshlrev_b32 v121, 16, v68
    v_and_b32 v122, s46, v68
    v_ldexp_f32 v121, v121, s47
    v_ldexp_f32 v122, v122, s47
    v_perm_b32 v68, v122, v121, s8
    v_lshlrev_b32 v121, 16, v69
    v_and_b32 v122, s46, v69
    v_ldexp_f32 v121, v121, s47
    v_ldexp_f32 v122, v122, s47
    v_perm_b32 v69, v122, v121, s8
    v_lshlrev_b32 v121, 16, v70
    v_and_b32 v122, s46, v70
    v_ldexp_f32 v121, v121, s47
    v_ldexp_f32 v122, v122, s47
    v_perm_b32 v70, v122, v121, s8
    v_lshlrev_b32 v121, 16, v71
    v_and_b32 v122, s46, v71
    v_ldexp_f32 v121, v121, s47
    v_ldexp_f32 v122, v122, s47
    v_perm_b32 v71, v122, v121, s8
    v_lshlrev_b32 v121, 16, v72
    v_and_b32 v122, s46, v72
    v_ldexp_f32 v121, v121, s47
    v_ldexp_f32 v122, v122, s47
    v_perm_b32 v72, v122, v121, s8
    v_lshlrev_b32 v121, 16, v73
    v_and_b32 v122, s46, v73
    v_ldexp_f32 v121, v121, s47
    v_ldexp_f32 v122, v122, s47
    v_perm_b32 v73, v122, v121, s8
    v_lshlrev_b32 v121, 16, v74
    v_and_b32 v122, s46, v74
    v_ldexp_f32 v121, v121, s47
    v_ldexp_f32 v122, v122, s47
    v_perm_b32 v74, v122, v121, s8
    v_lshlrev_b32 v121, 16, v75
    v_and_b32 v122, s46, v75
    v_ldexp_f32 v121, v121, s47
    v_ldexp_f32 v122, v122, s47
    v_perm_b32 v75, v122, v121, s8
    v_lshlrev_b32 v121, 16, v76
    v_and_b32 v122, s46, v76
    v_ldexp_f32 v121, v121, s47
    v_ldexp_f32 v122, v122, s47
    v_perm_b32 v76, v122, v121, s8
    v_lshlrev_b32 v121, 16, v77
    v_and_b32 v122, s46, v77
    v_ldexp_f32 v121, v121, s47
    v_ldexp_f32 v122, v122, s47
    v_perm_b32 v77, v122, v121, s8
    v_lshlrev_b32 v121, 16, v78
    v_and_b32 v122, s46, v78
    v_ldexp_f32 v121, v121, s47
    v_ldexp_f32 v122, v122, s47
    v_perm_b32 v78, v122, v121, s8
    v_lshlrev_b32 v121, 16, v79
    v_and_b32 v122, s46, v79
    v_ldexp_f32 v121, v121, s47
    v_ldexp_f32 v122, v122, s47
    v_perm_b32 v79, v122, v121, s8
    v_lshlrev_b32 v121, 16, v220
    v_and_b32 v122, s46, v220
    v_ldexp_f32 v121, v121, s7
    v_ldexp_f32 v122, v122, s7
    v_perm_b32 v220, v122, v121, s8
    v_lshlrev_b32 v121, 16, v221
    v_and_b32 v122, s46, v221
    v_ldexp_f32 v121, v121, s7
    v_ldexp_f32 v122, v122, s7
    v_perm_b32 v221, v122, v121, s8
    v_lshlrev_b32 v121, 16, v222
    v_and_b32 v122, s46, v222
    v_ldexp_f32 v121, v121, s7
    v_ldexp_f32 v122, v122, s7
    v_perm_b32 v222, v122, v121, s8
    v_lshlrev_b32 v121, 16, v223
    v_and_b32 v122, s46, v223
    v_ldexp_f32 v121, v121, s7
    v_ldexp_f32 v122, v122, s7
    v_perm_b32 v223, v122, v121, s8
    s_add_u32 s6, s47, 10
    v_cmp_lt_u32 vcc, 31, v1
    v_mov_b32 v121, s6
    v_mov_b32 v122, s7
    v_cndmask_b32 v9, v121, v122, vcc
    s_mov_b32 s52, 0
    s_mov_b32 s53, 0
    s_nop 7
    s_branch L_wconv
L_efix:
    s_waitcnt vmcnt(0) lgkmcnt(0)
    s_nop 15
    s_mul_i32 s6, s4, 104
    v_mul_u32_u24 v121, 28, v4
    v_min_u32 v122, 76, v121
    v_add_u32 v121, s6, v121
    v_add_u32 v122, s6, v122
    global_load_dwordx4 v[204:207], v121, s[16:17]
    global_load_dwordx3 v[208:210], v122, s[16:17] offset:16
    s_waitcnt vmcnt(1)
    v_lshl_add_u32 v204, v204, 8, v14
    v_lshl_add_u32 v205, v205, 8, v14
    v_lshl_add_u32 v206, v206, 8, v14
    v_lshl_add_u32 v207, v207, 8, v14
    s_waitcnt vmcnt(0)
    v_lshl_add_u32 v208, v208, 8, v14
    v_lshl_add_u32 v209, v209, 8, v14
    v_lshl_add_u32 v210, v210, 8, v14
    buffer_load_dwordx4 v[144:147], v204, s[56:59], 0 offen
    buffer_load_dwordx4 v[148:151], v205, s[56:59], 0 offen
    buffer_load_dwordx4 v[152:155], v206, s[56:59], 0 offen
    buffer_load_dwordx4 v[156:159], v207, s[56:59], 0 offen
    buffer_load_dwordx4 v[160:163], v208, s[56:59], 0 offen
    buffer_load_dwordx4 v[164:167], v209, s[56:59], 0 offen
    buffer_load_dwordx4 v[168:171], v210, s[56:59], 0 offen
    s_waitcnt vmcnt(0)
    s_mov_b32 s8, 0x07060302
    v_mov_b32 v121, 0
    v_and_b32 v122, s44, v144
    v_pk_max_u16 v121, v121, v122
    v_and_b32 v122, s44, v145
    v_pk_max_u16 v121, v121, v122
    v_and_b32 v122, s44, v146
    v_pk_max_u16 v121, v121, v122
    v_and_b32 v122, s44, v147
    v_pk_max_u16 v121, v121, v122
    v_and_b32 v122, s44, v148
    v_pk_max_u16 v121, v121, v122
    v_and_b32 v122, s44, v149
    v_pk_max_u16 v121, v121, v122
    v_and_b32 v122, s44, v150
    v_pk_max_u16 v121, v121, v122
    v_and_b32 v122, s44, v151
    v_pk_max_u16 v121, v121, v122
    v_and_b32 v122, s44, v152
    v_pk_max_u16 v121, v121, v122
    v_and_b32 v122, s44, v153
    v_pk_max_u16 v121, v121, v122
    v_and_b32 v122, s44, v154
    v_pk_max_u16 v121, v121, v122
    v_and_b32 v122, s44, v155
    v_pk_max_u16 v121, v121, v122
    v_and_b32 v122, s44, v156
    v_pk_max_u16 v121, v121, v122
    v_and_b32 v122, s44, v157
    v_pk_max_u16 v121, v121, v122
    v_and_b32 v122, s44, v158
    v_pk_max_u16 v121, v121, v122
    v_and_b32 v122, s44, v159
    v_pk_max_u16 v121, v121, v122
    v_and_b32 v122, s44, v160
    v_pk_max_u16 v121, v121, v122
    v_and_b32 v122, s44, v161
    v_pk_max_u16 v121, v121, v122
    v_and_b32 v122, s44, v162
    v_pk_max_u16 v121, v121, v122
    v_and_b32 v122, s44, v163
    v_pk_max_u16 v121, v121, v122
    v_and_b32 v122, s44, v164
    v_pk_max_u16 v121, v121, v122
    v_and_b32 v122, s44, v165
    v_pk_max_u16 v121, v121, v122
    v_and_b32 v122, s44, v166
    v_pk_max_u16 v121, v121, v122
    v_and_b32 v122, s44, v167
    v_pk_max_u16 v121, v121, v122
    v_and_b32 v122, s44, v168
    v_pk_max_u16 v121, v121, v122
    v_and_b32 v122, s44, v169
    v_pk_max_u16 v121, v121, v122
    v_and_b32 v122, s44, v170
    v_pk_max_u16 v121, v121, v122
    v_and_b32 v122, s44, v171
    v_pk_max_u16 v121, v121, v122
    v_pk_max_u16 v121, v121, v121 op_sel:[0,1] op_sel_hi:[1,0]
    s_nop 1
    v_max_u32_dpp v121, v121, v121 row_ror:8 row_mask:0xf bank_mask:0xf
    s_nop 1
    v_max_u32_dpp v121, v121, v121 row_ror:4 row_mask:0xf bank_mask:0xf
    s_nop 1
    v_max_u32_dpp v121, v121, v121 row_ror:2 row_mask:0xf bank_mask:0xf
    s_nop 1
    v_max_u32_dpp v121, v121, v121 row_ror:1 row_mask:0xf bank_mask:0xf
    s_nop 1
    v_max_u32_dpp v121, v121, v121 row_bcast:15 row_mask:0xa bank_mask:0xf
    s_nop 1
    v_max_u32_dpp v121, v121, v121 row_bcast:31 row_mask:0xc bank_mask:0xf
    s_nop 0
    v_readlane_b32 s6, v121, 63
    s_nop 0
    s_bfe_u32 s6, s6, 0x80007
    s_max_u32 s6, s6, 104
    s_min_u32 s6, s6, 190
    s_sub_u32 s6, 129, s6
    v_lshlrev_b32 v121, 16, v144
    v_and_b32 v122, s46, v144
    v_ldexp_f32 v121, v121, s6
    v_ldexp_f32 v122, v122, s6
    v_perm_b32 v144, v122, v121, s8
    v_lshlrev_b32 v121, 16, v145
    v_and_b32 v122, s46, v145
    v_ldexp_f32 v121, v121, s6
    v_ldexp_f32 v122, v122, s6
    v_perm_b32 v145, v122, v121, s8
    v_lshlrev_b32 v121, 16, v146
    v_and_b32 v122, s46, v146
    v_ldexp_f32 v121, v121, s6
    v_ldexp_f32 v122, v122, s6
    v_perm_b32 v146, v122, v121, s8
    v_lshlrev_b32 v121, 16, v147
    v_and_b32 v122, s46, v147
    v_ldexp_f32 v121, v121, s6
    v_ldexp_f32 v122, v122, s6
    v_perm_b32 v147, v122, v121, s8
    v_lshlrev_b32 v121, 16, v148
    v_and_b32 v122, s46, v148
    v_ldexp_f32 v121, v121, s6
    v_ldexp_f32 v122, v122, s6
    v_perm_b32 v148, v122, v121, s8
    v_lshlrev_b32 v121, 16, v149
    v_and_b32 v122, s46, v149
    v_ldexp_f32 v121, v121, s6
    v_ldexp_f32 v122, v122, s6
    v_perm_b32 v149, v122, v121, s8
    v_lshlrev_b32 v121, 16, v150
    v_and_b32 v122, s46, v150
    v_ldexp_f32 v121, v121, s6
    v_ldexp_f32 v122, v122, s6
    v_perm_b32 v150, v122, v121, s8
    v_lshlrev_b32 v121, 16, v151
    v_and_b32 v122, s46, v151
    v_ldexp_f32 v121, v121, s6
    v_ldexp_f32 v122, v122, s6
    v_perm_b32 v151, v122, v121, s8
    v_lshlrev_b32 v121, 16, v152
    v_and_b32 v122, s46, v152
    v_ldexp_f32 v121, v121, s6
    v_ldexp_f32 v122, v122, s6
    v_perm_b32 v152, v122, v121, s8
    v_lshlrev_b32 v121, 16, v153
    v_and_b32 v122, s46, v153
    v_ldexp_f32 v121, v121, s6
    v_ldexp_f32 v122, v122, s6
    v_perm_b32 v153, v122, v121, s8
    v_lshlrev_b32 v121, 16, v154
    v_and_b32 v122, s46, v154
    v_ldexp_f32 v121, v121, s6
    v_ldexp_f32 v122, v122, s6
    v_perm_b32 v154, v122, v121, s8
    v_lshlrev_b32 v121, 16, v155
    v_and_b32 v122, s46, v155
    v_ldexp_f32 v121, v121, s6
    v_ldexp_f32 v122, v122, s6
    v_perm_b32 v155, v122, v121, s8
    v_lshlrev_b32 v121, 16, v156
    v_and_b32 v122, s46, v156
    v_ldexp_f32 v121, v121, s6
    v_ldexp_f32 v122, v122, s6
    v_perm_b32 v156, v122, v121, s8
    v_lshlrev_b32 v121, 16, v157
    v_and_b32 v122, s46, v157
    v_ldexp_f32 v121, v121, s6
    v_ldexp_f32 v122, v122, s6
    v_perm_b32 v157, v122, v121, s8
    v_lshlrev_b32 v121, 16, v158
    v_and_b32 v122, s46, v158
    v_ldexp_f32 v121, v121, s6
    v_ldexp_f32 v122, v122, s6
    v_perm_b32 v158, v122, v121, s8
    v_lshlrev_b32 v121, 16, v159
    v_and_b32 v122, s46, v159
    v_ldexp_f32 v121, v121, s6
    v_ldexp_f32 v122, v122, s6
    v_perm_b32 v159, v122, v121, s8
    v_lshlrev_b32 v121, 16, v160
    v_and_b32 v122, s46, v160
    v_ldexp_f32 v121, v121, s6
    v_ldexp_f32 v122, v122, s6
    v_perm_b32 v160, v122, v121, s8
    v_lshlrev_b32 v121, 16, v161
    v_and_b32 v122, s46, v161
    v_ldexp_f32 v121, v121, s6
    v_ldexp_f32 v122, v122, s6
    v_perm_b32 v161, v122, v121, s8
    v_lshlrev_b32 v121, 16, v162
    v_and_b32 v122, s46, v162
    v_ldexp_f32 v121, v121, s6
    v_ldexp_f32 v122, v122, s6
    v_perm_b32 v162, v122, v121, s8
    v_lshlrev_b32 v121, 16, v163
    v_and_b32 v122, s46, v163
    v_ldexp_f32 v121, v121, s6
    v_ldexp_f32 v122, v122, s6
    v_perm_b32 v163, v122, v121, s8
    v_lshlrev_b32 v121, 16, v164
    v_and_b32 v122, s46, v164
    v_ldexp_f32 v121, v121, s6
    v_ldexp_f32 v122, v122, s6
    v_perm_b32 v164, v122, v121, s8
    v_lshlrev_b32 v121, 16, v165
    v_and_b32 v122, s46, v165
    v_ldexp_f32 v121, v121, s6
    v_ldexp_f32 v122, v122, s6
    v_perm_b32 v165, v122, v121, s8
    v_lshlrev_b32 v121, 16, v166
    v_and_b32 v122, s46, v166
    v_ldexp_f32 v121, v121, s6
    v_ldexp_f32 v122, v122, s6
    v_perm_b32 v166, v122, v121, s8
    v_lshlrev_b32 v121, 16, v167
    v_and_b32 v122, s46, v167
    v_ldexp_f32 v121, v121, s6
    v_ldexp_f32 v122, v122, s6
    v_perm_b32 v167, v122, v121, s8
    v_lshlrev_b32 v121, 16, v168
    v_and_b32 v122, s46, v168
    v_ldexp_f32 v121, v121, s6
    v_ldexp_f32 v122, v122, s6
    v_perm_b32 v168, v122, v121, s8
    v_lshlrev_b32 v121, 16, v169
    v_and_b32 v122, s46, v169
    v_ldexp_f32 v121, v121, s6
    v_ldexp_f32 v122, v122, s6
    v_perm_b32 v169, v122, v121, s8
    v_lshlrev_b32 v121, 16, v170
    v_and_b32 v122, s46, v170
    v_ldexp_f32 v121, v121, s6
    v_ldexp_f32 v122, v122, s6
    v_perm_b32 v170, v122, v121, s8
    v_lshlrev_b32 v121, 16, v171
    v_and_b32 v122, s46, v171
    v_ldexp_f32 v121, v121, s6
    v_ldexp_f32 v122, v122, s6
    v_perm_b32 v171, v122, v121, s8
    s_lshl_b32 s6, s6, 1
    v_ldexp_f32 v16, v16, s6
    v_ldexp_f32 v17, v17, s6
    v_ldexp_f32 v18, v18, s6
    v_ldexp_f32 v19, v19, s6
    v_ldexp_f32 v20, v20, s6
    v_ldexp_f32 v21, v21, s6
    v_ldexp_f32 v22, v22, s6
    v_ldexp_f32 v23, v23, s6
    v_ldexp_f32 v24, v24, s6
    v_ldexp_f32 v25, v25, s6
    v_ldexp_f32 v26, v26, s6
    v_ldexp_f32 v27, v27, s6
    v_ldexp_f32 v28, v28, s6
    v_ldexp_f32 v29, v29, s6
    v_ldexp_f32 v30, v30, s6
    v_ldexp_f32 v31, v31, s6
    v_ldexp_f32 v32, v32, s6
    v_ldexp_f32 v33, v33, s6
    v_ldexp_f32 v34, v34, s6
    v_ldexp_f32 v35, v35, s6
    v_ldexp_f32 v36, v36, s6
    v_ldexp_f32 v37, v37, s6
    v_ldexp_f32 v38, v38, s6
    v_ldexp_f32 v39, v39, s6
    v_ldexp_f32 v40, v40, s6
    v_ldexp_f32 v41, v41, s6
    v_ldexp_f32 v42, v42, s6
    v_ldexp_f32 v43, v43, s6
    v_ldexp_f32 v44, v44, s6
    v_ldexp_f32 v45, v45, s6
    v_ldexp_f32 v46, v46, s6
    v_ldexp_f32 v47, v47, s6
    s_add_u32 s7, s5, -28096
    v_add_u32 v0, s7, v15
    ds_write_b128 v0, v[16:19] offset:37888
    ds_write_b128 v0, v[20:23] offset:37952
    ds_write_b128 v0, v[24:27] offset:38016
    ds_write_b128 v0, v[28:31] offset:38080
    ds_write_b128 v0, v[32:35] offset:38144
    ds_write_b128 v0, v[36:39] offset:38208
    ds_write_b128 v0, v[40:43] offset:38272
    ds_write_b128 v0, v[44:47] offset:38336
    s_waitcnt lgkmcnt(0)
    s_add_u32 s54, s54, s6
    s_lshl_b32 s6, s6, 23
    s_sub_u32 s55, s55, s6
    s_mov_b32 s50, 0x7fc00000
    s_mov_b32 s51, 0
    s_mov_b32 s52, 0
    s_mov_b32 s53, 0
    s_nop 7
    s_branch L_econv
L_tailmax:
    s_nop 3
    v_mov_b32 v176, s14
    v_max_f32 v248, s14, v196
    s_nop 1
    v_max_f32_dpp v248, v248, v248 row_ror:8 row_mask:0xf bank_mask:0xf
    s_nop 1
    v_max_f32_dpp v248, v248, v248 row_ror:4 row_mask:0xf bank_mask:0xf
    s_nop 1
    v_max_f32_dpp v248, v248, v248 row_ror:2 row_mask:0xf bank_mask:0xf
    s_nop 1
    v_max_f32_dpp v248, v248, v248 row_ror:1 row_mask:0xf bank_mask:0xf
    s_nop 1
    v_max_f32_dpp v248, v248, v248 row_bcast:15 row_mask:0xa bank_mask:0xf
    s_nop 1
    v_max_f32_dpp v248, v248, v248 row_bcast:31 row_mask:0xc bank_mask:0xf
    s_nop 0
    v_readlane_b32 s13, v248, 63
    s_nop 1
    v_subrev_f32 v196, s13, v196
    v_subrev_f32 v176, s13, v176
    v_mul_f32 v196, s55, v196
    v_mul_f32 v176, s55, v176
    v_exp_f32 v196, v196
    v_exp_f32 v176, v176
    v_mul_f32 v199, v196, v231
    v_fma_f32 v249, v249, v176, v196
    v_fma_f32 v250, v250, v176, v199
    s_nop 3
    s_branch L_tailsum
s_endpgm
.p2align 7
.type L_tab,@object
L_tab:
.long 0x98000000, 0xa0000, 0x0, 0x0
.long 0x98020010, 0xa0004, 0x8, 0x1200010
.long 0x98040020, 0xa0008, 0x10, 0x2400020
.long 0x98060030, 0xa000c, 0x18, 0x3600030
.long 0x98080040, 0xa0010, 0x120, 0x4800040
.long 0x980a0050, 0xa0014, 0x128, 0x5a00050
.long 0x980c0060, 0xa0018, 0x130, 0x6c00060
.long 0x980e0070, 0xa001c, 0x138, 0x7e00070
.long 0x98100080, 0xa0020, 0x240, 0x9000080
.long 0x98120090, 0xa0024, 0x248, 0xa200090
.long 0x981400a0, 0xa0028, 0x250, 0xb4000a0
.long 0x981600b0, 0xa002c, 0x258, 0xc6000b0
.long 0x981800c0, 0xa0030, 0x360, 0xd8000c0
.long 0x981a00d0, 0xa0034, 0x368, 0xea000d0
.long 0x981c00e0, 0xa0038, 0x370, 0xfc000e0
.long 0x981e00f0, 0xa003c, 0x378, 0x10e000f0
.long 0x98200120, 0xa0040, 0x100980, 0x100120
.long 0x98220130, 0xa0044, 0x100988, 0x1300130
.long 0x98240140, 0xa0048, 0x100990, 0x2500140
.long 0x98260150, 0xa004c, 0x100998, 0x3700150
.long 0x98280160, 0xa0050, 0x100aa0, 0x4900160
.long 0x982a0170, 0xa0054, 0x100aa8, 0x5b00170
.long 0x982c0180, 0xa0058, 0x100ab0, 0x6d00180
.long 0x982e0190, 0xa005c, 0x100ab8, 0x7f00190
.long 0x983001a0, 0xa0060, 0x100bc0, 0x91001a0
.long 0x983201b0, 0xa0064, 0x100bc8, 0xa3001b0
.long 0x983401c0, 0xa0068, 0x100bd0, 0xb5001c0
.long 0x983601d0, 0xa006c, 0x100bd8, 0xc7001d0
.long 0x983801e0, 0xa0070, 0x100ce0, 0xd9001e0
.long 0x983a01f0, 0xa0074, 0x100ce8, 0xeb001f0
.long 0x983c0200, 0xa0078, 0x100cf0, 0xfd00200
.long 0x983e0210, 0xa007c, 0x100cf8, 0x10f00210
.long 0x98400240, 0x200, 0x201280, 0x200240
.long 0x98420250, 0x204, 0x201288, 0x1400250
.long 0x98440260, 0x208, 0x201290, 0x2600260
.long 0x98460270, 0x20c, 0x201298, 0x3800270
.long 0x98480280, 0x210, 0x2013a0, 0x4a00280
.long 0x984a0290, 0x214, 0x2013a8, 0x5c00290
.long 0x984c02a0, 0x218, 0x2013b0, 0x6e002a0
.long 0x984e02b0, 0x21c, 0x2013b8, 0x80002b0
.long 0x985002c0, 0x220, 0x2014c0, 0x92002c0
.long 0x985202d0, 0x224, 0x2014c8, 0xa4002d0
.long 0x985402e0, 0x228, 0x2014d0, 0xb6002e0
.long 0x985602f0, 0x22c, 0x2014d8, 0xc8002f0
.long 0x98580300, 0x230, 0x2015e0, 0xda00300
.long 0x985a0310, 0x234, 0x2015e8, 0xec00310
.long 0x985c0320, 0x238, 0x2015f0, 0xfe00320
.long 0x985e0330, 0x23c, 0x2015f8, 0x11000330
.long 0x98600360, 0x240, 0x301c00, 0x300360
.long 0x98620370, 0x244, 0x301c08, 0x1500370
.long 0x98640380, 0x248, 0x301c10, 0x2700380
.long 0x98660390, 0x24c, 0x301c18, 0x3900390
.long 0x986803a0, 0x250, 0x301d20, 0x4b003a0
.long 0x986a03b0, 0x254, 0x301d28, 0x5d003b0
.long 0x986c03c0, 0x258, 0x301d30, 0x6f003c0
.long 0x986e03d0, 0x25c, 0x301d38, 0x81003d0
.long 0x987003e0, 0x260, 0x301e40, 0x93003e0
.long 0x987203f0, 0x264, 0x301e48, 0xa5003f0
.long 0x98740400, 0x268, 0x301e50, 0xb700400
.long 0x98760410, 0x26c, 0x301e58, 0xc900410
.long 0x98780420, 0x270, 0x301f60, 0xdb00420
.long 0x987a0430, 0x274, 0x301f68, 0xed00430
.long 0x987c0440, 0x278, 0x301f70, 0xff00440
.long 0x987e0450, 0x27c, 0x301f78, 0x11100450
.long 0x120, 0x98000000, 0x900, 0x0
.long 0x240, 0x98400120, 0xa20, 0x0
.long 0x360, 0x98800240, 0xb40, 0x0
.long 0x480, 0x98c00360, 0xc60, 0x0
.long 0x5a0, 0x99000480, 0xd80, 0x0
.long 0x6c0, 0x994005a0, 0xea0, 0x0
.long 0x7e0, 0x998006c0, 0xfc0, 0x0
.long 0x900, 0x99c007e0, 0x10e0, 0x0
.long 0xa20, 0x98100900, 0x22e0, 0x0
.long 0xb40, 0x98500a20, 0x22e0, 0x0
.long 0xc60, 0x989010e0, 0x22e0, 0x0
.long 0xd80, 0x98d010e0, 0x22e0, 0x0
.long 0xea0, 0x991010e0, 0x22e0, 0x0
.long 0xfc0, 0x995010e0, 0x22e0, 0x0
.long 0x10e0, 0x999010e0, 0x22e0, 0x0
.long 0x0, 0x99d010e0, 0x22e0, 0x0
.long 0x100130, 0x98080010, 0x910, 0x0
.long 0x100250, 0x98480130, 0xa30, 0x0
.long 0x100370, 0x98880250, 0xb50, 0x0
.long 0x100490, 0x98c80370, 0xc70, 0x0
.long 0x1005b0, 0x99080490, 0xd90, 0x0
.long 0x1006d0, 0x994805b0, 0xeb0, 0x0
.long 0x1007f0, 0x998806d0, 0xfd0, 0x0
.long 0x100910, 0x99c807f0, 0x10f0, 0x0
.long 0x100a30, 0x98180910, 0x22f0, 0x0
.long 0x100b50, 0x98580a30, 0x22f0, 0x0
.long 0x100c70, 0x989810f0, 0x22f0, 0x0
.long 0x100d90, 0x98d810f0, 0x22f0, 0x0
.long 0x100eb0, 0x991810f0, 0x22f0, 0x0
.long 0x100fd0, 0x995810f0, 0x22f0, 0x0
.long 0x1010f0, 0x999810f0, 0x22f0, 0x0
.long 0x100010, 0x99d810f0, 0x22f0, 0x0
.long 0x200140, 0x98040020, 0x920, 0x0
.long 0x200260, 0x98440140, 0xa40, 0x0
.long 0x200380, 0x98840260, 0xb60, 0x0
.long 0x2004a0, 0x98c40380, 0xc80, 0x0
.long 0x2005c0, 0x990404a0, 0xda0, 0x0
.long 0x2006e0, 0x994405c0, 0xec0, 0x0
.long 0x200800, 0x998406e0, 0xfe0, 0x0
.long 0x200920, 0x99c40800, 0x1100, 0x0
.long 0x200a40, 0x98140920, 0x2300, 0x0
.long 0x200b60, 0x98540a40, 0x2300, 0x0
.long 0x200c80, 0x98941100, 0x2300, 0x0
.long 0x200da0, 0x98d41100, 0x2300, 0x0
.long 0x200ec0, 0x99141100, 0x2300, 0x0
.long 0x200fe0, 0x99541100, 0x2300, 0x0
.long 0x201100, 0x99941100, 0x2300, 0x0
.long 0x200020, 0x99d41100, 0x2300, 0x0
.long 0x300150, 0x980c0030, 0x930, 0x0
.long 0x300270, 0x984c0150, 0xa50, 0x0
.long 0x300390, 0x988c0270, 0xb70, 0x0
.long 0x3004b0, 0x98cc0390, 0xc90, 0x0
.long 0x3005d0, 0x990c04b0, 0xdb0, 0x0
.long 0x3006f0, 0x994c05d0, 0xed0, 0x0
.long 0x300810, 0x998c06f0, 0xff0, 0x0
.long 0x300930, 0x99cc0810, 0x1110, 0x0
.long 0x300a50, 0x981c0930, 0x2310, 0x0
.long 0x300b70, 0x985c0a50, 0x2310, 0x0
.long 0x300c90, 0x989c1110, 0x2310, 0x0
.long 0x300db0, 0x98dc1110, 0x2310, 0x0
.long 0x300ed0, 0x991c1110, 0x2310, 0x0
.long 0x300ff0, 0x995c1110, 0x2310, 0x0
.long 0x301110, 0x999c1110, 0x2310, 0x0
.long 0x300030, 0x99dc1110, 0x2310, 0x0
.long 0x2f40, 0x1203180, 0x6c026d0, 0x9002910
.long 0x1202f44, 0x2403184, 0x7e02764, 0xa2029a4
.long 0x2402f48, 0x3603188, 0x90027f8, 0x2a38
.long 0x3602f4c, 0x480318c, 0xa20288c, 0x1202acc
.long 0x4802f50, 0x5a03190, 0x2920, 0x3602b60
.long 0x5a02f54, 0x6c03194, 0x12029b4, 0x4802bf4
.long 0x6c02f58, 0x7e03198, 0x2402a48, 0x5a02c88
.long 0x7e02f5c, 0x900319c, 0x3602adc, 0x6c02d1c
.long 0x9002f60, 0xa2031a0, 0x4802b70, 0x7e02db0
.long 0xa202f64, 0x31a4, 0x5a02c04, 0x9002e44
.long 0x2f68, 0x24031a8, 0x6c02c98, 0xa202ed8
.long 0x1202f6c, 0x36031ac, 0x7e02d2c, 0x266c
.long 0x2402f70, 0x48031b0, 0x9002dc0, 0x1202700
.long 0x3602f74, 0x5a031b4, 0xa202e54, 0x2402794
.long 0x4802f78, 0x6c031b8, 0x2ee8, 0x4802828
.long 0x5a02f7c, 0x7e031bc, 0x120267c, 0x5a028bc
.long 0x102fd0, 0x1303210, 0x6d02760, 0x91029a0
.long 0x1302fd4, 0x2503214, 0x7f027f4, 0xa302a34
.long 0x2502fd8, 0x3703218, 0x9102888, 0x102ac8
.long 0x3702fdc, 0x490321c, 0xa30291c, 0x1302b5c
.long 0x4902fe0, 0x5b03220, 0x1029b0, 0x3702bf0
.long 0x5b02fe4, 0x6d03224, 0x1302a44, 0x4902c84
.long 0x6d02fe8, 0x7f03228, 0x2502ad8, 0x5b02d18
.long 0x7f02fec, 0x910322c, 0x3702b6c, 0x6d02dac
.long 0x9102ff0, 0xa303230, 0x4902c00, 0x7f02e40
.long 0xa302ff4, 0x103234, 0x5b02c94, 0x9102ed4
.long 0x102ff8, 0x2503238, 0x6d02d28, 0xa302668
.long 0x1302ffc, 0x370323c, 0x7f02dbc, 0x1026fc
.long 0x2503000, 0x4903240, 0x9102e50, 0x1302790
.long 0x3703004, 0x5b03244, 0xa302ee4, 0x2502824
.long 0x4903008, 0x6d03248, 0x102678, 0x49028b8
.long 0x5b0300c, 0x7f0324c, 0x130270c, 0x5b0294c
.long 0x203060, 0x14032a0, 0x6e027f0, 0x9202a30
.long 0x1403064, 0x26032a4, 0x8002884, 0xa402ac4
.long 0x2603068, 0x38032a8, 0x9202918, 0x202b58
.long 0x380306c, 0x4a032ac, 0xa4029ac, 0x1402bec
.long 0x4a03070, 0x5c032b0, 0x202a40, 0x3802c80
.long 0x5c03074, 0x6e032b4, 0x1402ad4, 0x4a02d14
.long 0x6e03078, 0x80032b8, 0x2602b68, 0x5c02da8
.long 0x800307c, 0x92032bc, 0x3802bfc, 0x6e02e3c
.long 0x9203080, 0xa4032c0, 0x4a02c90, 0x8002ed0
.long 0xa403084, 0x2032c4, 0x5c02d24, 0x9202664
.long 0x203088, 0x26032c8, 0x6e02db8, 0xa4026f8
.long 0x140308c, 0x38032cc, 0x8002e4c, 0x20278c
.long 0x2603090, 0x4a032d0, 0x9202ee0, 0x1402820
.long 0x3803094, 0x5c032d4, 0xa402674, 0x26028b4
.long 0x4a03098, 0x6e032d8, 0x202708, 0x4a02948
.long 0x5c0309c, 0x80032dc, 0x140279c, 0x5c029dc
.long 0x3030f0, 0x1503330, 0x6f02880, 0x9302ac0
.long 0x15030f4, 0x2703334, 0x8102914, 0xa502b54
.long 0x27030f8, 0x3903338, 0x93029a8, 0x302be8
.long 0x39030fc, 0x4b0333c, 0xa502a3c, 0x1502c7c
.long 0x4b03100, 0x5d03340, 0x302ad0, 0x3902d10
.long 0x5d03104, 0x6f03344, 0x1502b64, 0x4b02da4
.long 0x6f03108, 0x8103348, 0x2702bf8, 0x5d02e38
.long 0x810310c, 0x930334c, 0x3902c8c, 0x6f02ecc
.long 0x9303110, 0xa503350, 0x4b02d20, 0x8102660
.long 0xa503114, 0x303354, 0x5d02db4, 0x93026f4
.long 0x303118, 0x2703358, 0x6f02e48, 0xa502788
.long 0x150311c, 0x390335c, 0x8102edc, 0x30281c
.long 0x2703120, 0x4b03360, 0x9302670, 0x15028b0
.long 0x3903124, 0x5d03364, 0xa502704, 0x2702944
.long 0x4b03128, 0x6f03368, 0x302798, 0x4b029d8
.long 0x5d0312c, 0x810336c, 0x150282c, 0x5d02a6c
.long 0x24033c0, 0x6c03010, 0x2640, 0x0
.long 0x36033c4, 0x7e030a4, 0x426d0, 0x0
.long 0x48033c8, 0x9003138, 0x82760, 0x0
.long 0x5a033cc, 0xa2031cc, 0xc27f0, 0x0
.long 0x6c033d0, 0x3260, 0x102880, 0x0
.long 0x7e033d4, 0x12032f4, 0x142910, 0x0
.long 0x90033d8, 0x2403388, 0x1829a0, 0x0
.long 0xa2033dc, 0x360341c, 0x1c2a30, 0x0
.long 0x33e0, 0x5a034b0, 0x202ac0, 0x0
.long 0x12033e4, 0x6c02fa4, 0x242b50, 0x0
.long 0x24033e8, 0x7e030a0, 0x282be0, 0x0
.long 0x36033ec, 0x9003134, 0x2c2c70, 0x0
.long 0x48033f0, 0xa2031c8, 0x302d00, 0x0
.long 0x10e033f4, 0x325c, 0x342d90, 0x0
.long 0x10e033f8, 0x12032f0, 0x382e20, 0x0
.long 0x10e033fc, 0x2403384, 0x3c2eb0, 0x0
.long 0x25033c0, 0x6d03418, 0x402650, 0x0
.long 0x37033c4, 0x7f034ac, 0x4426e0, 0x0
.long 0x49033c8, 0x9102fa0, 0x482770, 0x0
.long 0x5b033cc, 0xa303034, 0x4c2800, 0x0
.long 0x6d033d0, 0x103130, 0x502890, 0x0
.long 0x7f033d4, 0x13031c4, 0x542920, 0x0
.long 0x91033d8, 0x2503258, 0x5829b0, 0x0
.long 0xa3033dc, 0x37032ec, 0x5c2a40, 0x0
.long 0x1033e0, 0x5b03380, 0x602ad0, 0x0
.long 0x13033e4, 0x6d03414, 0x642b60, 0x0
.long 0x25033e8, 0x7f034a8, 0x682bf0, 0x0
.long 0x37033ec, 0x9102f9c, 0x6c2c80, 0x0
.long 0x49033f0, 0xa303030, 0x702d10, 0x0
.long 0x10f033f4, 0x1030c4, 0x742da0, 0x0
.long 0x10f033f8, 0x13031c0, 0x782e30, 0x0
.long 0x10f033fc, 0x2503254, 0x7c2ec0, 0x0
.long 0x2603450, 0x6e032e8, 0x802660, 0x0
.long 0x3803454, 0x800337c, 0x8426f0, 0x0
.long 0x4a03458, 0x9203410, 0x882780, 0x0
.long 0x5c0345c, 0xa4034a4, 0x8c2810, 0x0
.long 0x6e03460, 0x202f98, 0x9028a0, 0x0
.long 0x8003464, 0x140302c, 0x942930, 0x0
.long 0x9203468, 0x26030c0, 0x9829c0, 0x0
.long 0xa40346c, 0x3803154, 0x9c2a50, 0x0
.long 0x203470, 0x5c03250, 0xa02ae0, 0x0
.long 0x1403474, 0x6e032e4, 0xa42b70, 0x0
.long 0x2603478, 0x8003378, 0xa82c00, 0x0
.long 0x380347c, 0x920340c, 0xac2c90, 0x0
.long 0x4a03480, 0xa4034a0, 0xb02d20, 0x0
.long 0x11003484, 0x202f94, 0xb42db0, 0x0
.long 0x11003488, 0x1403028, 0xb82e40, 0x0
.long 0x1100348c, 0x26030bc, 0xbc2ed0, 0x0
.long 0x2703450, 0x6f03150, 0xc02670, 0x0
.long 0x3903454, 0x81031e4, 0xc42700, 0x0
.long 0x4b03458, 0x93032e0, 0xc82790, 0x0
.long 0x5d0345c, 0xa503374, 0xcc2820, 0x0
.long 0x6f03460, 0x303408, 0xd028b0, 0x0
.long 0x8103464, 0x150349c, 0xd42940, 0x0
.long 0x9303468, 0x2702f90, 0xd829d0, 0x0
.long 0xa50346c, 0x3903024, 0xdc2a60, 0x0
.long 0x303470, 0x5d030b8, 0xe02af0, 0x0
.long 0x1503474, 0x6f0314c, 0xe42b80, 0x0
.long 0x2703478, 0x81031e0, 0xe82c10, 0x0
.long 0x390347c, 0x9303274, 0xec2ca0, 0x0
.long 0x4b03480, 0xa503370, 0xf02d30, 0x0
.long 0x11103484, 0x303404, 0xf42dc0, 0x0
.long 0x11103488, 0x1503498, 0xf82e50, 0x0
.long 0x1110348c, 0x2702f8c, 0xfc2ee0, 0x0
L_ctab:
.long 0xffffffff, 0xffffff, 0xffff, 0xffff, 0xffffffff, 0x1fff, 0x11111111, 0x11111111, 0x7fff7fff, 0x80008000, 0xffff0000, 0x0, 0x2800000, 0x280, 0x43800000, 0x41000000, 0x40004000, 0x1, 0xa, 0x3a38aa3b
.size L_tab, .-L_tab
.section .rodata,"a"
.p2align 6
.amdhsa_kernel standalone__factorization_afm__recsys_kernel
  .amdhsa_next_free_vgpr 384
  .amdhsa_next_free_sgpr 102
  .amdhsa_accum_offset 256
  .amdhsa_group_segment_fixed_size 0
  .amdhsa_kernarg_size 88
  .amdhsa_user_sgpr_count 2
  .amdhsa_user_sgpr_kernarg_segment_ptr 1
  .amdhsa_system_sgpr_workgroup_id_x 1
.end_amdhsa_kernel
```
